```python
import torch

def _softmax(x, axis=-1):
    return torch.softmax(x, dim=axis)

def _gelu(x):
    return torch.nn.functional.gelu(x, approximate='tanh')

def _silu(x):
    return torch.nn.functional.silu(x)

def _sigmoid(x):
    return torch.sigmoid(x)

def _layernorm(x, axis=-1, eps=1e-05):
    m = x.mean(dim=axis, keepdim=True)
    v = x.var(dim=axis, keepdim=True, unbiased=False)
    return (x - m) / torch.sqrt(v + eps)

def _scatter_add(tgt, idx, src, axis=0):
    return tgt.clone().index_add_(axis, idx, src)

def _segment_sum(src, seg, n):
    out = torch.zeros((n,) + src.shape[1:], dtype=src.dtype)
    return out.index_add_(0, seg, src)

def _pad(x, pw):
    flat = tuple((v for pair in reversed(pw) for v in pair))
    return torch.nn.functional.pad(x, flat)
kernel_name = 'adaLN_cond__sliding_local_dilated__glu_gated_swiglu__prompt'

def setup_inputs():

    _w = lambda a: (lambda t: t.to(torch.bfloat16) if t.is_floating_point() else t)(torch.as_tensor(a))

    def _A_setup():
        B, S, D = (1, 2048, 1024)
        return {'x': _w((lambda *s: torch.randn(*s, dtype=torch.bfloat16) * 0.05)(B, S, D)), 'wqkv': _w((lambda *s: torch.randn(*s, dtype=torch.bfloat16) * 0.05)(D, 3 * D)), 'wo': _w((lambda *s: torch.randn(*s, dtype=torch.bfloat16) * 0.05)(D, D))}
    _A_in = _A_setup()

    def _B_setup():
        B, S, D, F = (1, 2048, 1024, 3584)
        return {'x': _w((lambda *s: torch.randn(*s, dtype=torch.bfloat16) * 0.05)(B, S, D)), 'w1': _w((lambda *s: torch.randn(*s, dtype=torch.bfloat16) * 0.8)(D, F) * (2.0 / D) ** 0.5), 'w3': _w((lambda *s: torch.randn(*s, dtype=torch.bfloat16) * 0.8)(D, F) * (2.0 / D) ** 0.5), 'w2': _w((lambda *s: torch.randn(*s, dtype=torch.bfloat16) * 0.8)(F, D) * (2.0 / F) ** 0.5)}
    _B_in = _B_setup()
    return {'A_x': _A_in['x'], 'A_wqkv': _A_in['wqkv'], 'A_wo': _A_in['wo'], 'B_x': _B_in['x'], 'B_w1': _B_in['w1'], 'B_w3': _B_in['w3'], 'B_w2': _B_in['w2'], 'c': _w((lambda *s: torch.randn(*s, dtype=torch.bfloat16) * 0.1)(1, 1024) * 8.0), 'w_mod': _w((lambda *s: torch.randn(*s, dtype=torch.bfloat16) * 0.1)(1024, 6 * 1024) * 1024 ** (-0.5) * 8.0)}

def reference(A_x, A_wqkv, A_wo, B_x, B_w1, B_w3, B_w2, c, w_mod):

    def _A_ref(x, wqkv, wo):
        B, S, D = x.shape
        H = 32
        Dh = D // H
        W, dil = (8, 2)
        qkv = (lambda x, *d: x.permute(*d))((x @ wqkv).reshape(B, S, 3, H, Dh), 2, 0, 3, 1, 4)
        q, k, v = (qkv[0], qkv[1], qkv[2])
        scale = Dh ** (-0.5)
        pos = torch.arange(S)
        off = torch.arange(W) * dil
        idx = pos[:, None] - off[None, :]
        mask = idx >= 0
        idx_c = torch.where(mask, idx, 0).reshape(-1)
        kg = k[:, :, idx_c, :].reshape(B, H, S, W, Dh)
        vg = v[:, :, idx_c, :].reshape(B, H, S, W, Dh)
        logits = torch.einsum('bhsd,bhswd->bhsw', q, kg) * scale
        logits = torch.where(mask[None, None, :, :], logits, -1000000000.0)
        attn = _softmax(logits, axis=-1)
        o = torch.einsum('bhsw,bhswd->bhsd', attn, vg)
        return (lambda x, *d: x.permute(*d))(o, 0, 2, 1, 3).reshape(B, S, D) @ wo

    def _B_ref(x, w1, w3, w2):
        gate = torch.einsum('bsd,df->bsf', x, w1)
        up = torch.einsum('bsd,df->bsf', x, w3)
        h = _silu(gate) * up
        out = torch.einsum('bsf,fd->bsd', h, w2)
        return out
    x = A_x
    mod = (_silu(c) @ w_mod).reshape(c.shape[0], 6, 1, -1)
    sa, ca, ga, sb, cb, gb = (mod[:, 0].clone(), mod[:, 1].clone(), mod[:, 2].clone(), mod[:, 3].clone(), mod[:, 4].clone(), mod[:, 5].clone())
    h = _layernorm(x, axis=-1) * (1 + ca) + sa
    x = x + ga * _A_ref(h, A_wqkv, A_wo)
    h = _layernorm(x, axis=-1) * (1 + cb) + sb
    x = x + gb * _B_ref(h, B_w1, B_w3, B_w2)
    return x
```

```asm
; @launch grid=(256,1,1) block=(256,1,1) lds=163840
.amdgcn_target "amdgcn-amd-amdhsa--gfx950"
.text
.globl adaLN_cond__sliding_local_dilated__glu_gated_swiglu__prompt_kernel
.p2align 8
.type adaLN_cond__sliding_local_dilated__glu_gated_swiglu__prompt_kernel,@function
adaLN_cond__sliding_local_dilated__glu_gated_swiglu__prompt_kernel:
s_cmp_ge_u32 s2, 256
s_cbranch_scc1 K_end
s_load_dwordx16 s[12:27], s[0:1], 32
s_load_dwordx4 s[4:7], s[0:1], 0
s_load_dwordx2 s[8:9], s[0:1], 16
v_lshrrev_b32 v2, 6, v0
v_and_b32 v1, 63, v0
v_readfirstlane_b32 s72, v2
s_and_b32 s3, s2, 7
s_lshr_b32 s78, s2, 3
s_and_b32 s74, s3, 1
s_lshl_b32 s74, s74, 3
s_and_b32 s79, s78, 7
s_add_u32 s74, s74, s79
s_lshr_b32 s73, s3, 1
s_lshl_b32 s73, s73, 2
s_lshr_b32 s79, s78, 3
s_add_u32 s73, s73, s79
s_mov_b32 s96, 0x7ffffff0
v_lshlrev_b32 v46, 4, v1
v_mov_b32 v52, 1
s_lshl_b32 s76, s72, 13
s_lshl_b32 s79, s73, 2
s_add_u32 s79, s79, s72
s_lshl_b32 s88, s79, 16
s_mul_i32 s89, s79, 229376
v_lshrrev_b32 v2, 3, v1
v_lshlrev_b32 v2, 11, v2
v_add_u32 v2, s88, v2
v_and_b32 v3, 7, v1
v_lshrrev_b32 v4, 4, v1
v_xor_b32 v3, v3, v4
v_lshl_add_u32 v192, v3, 4, v2
v_xor_b32 v193, 64, v192
v_add_u32 v194, 30720, v192
v_add_u32 v195, 46080, v193
v_add_u32 v193, 15360, v193
s_waitcnt lgkmcnt(0)
s_getpc_b64 s[0:1]
K_pc:
s_mov_b32 s60, s26
s_mov_b32 s61, s27
s_mov_b32 s62, 0x4800000
s_mov_b32 s63, 0x20000
s_mov_b32 s28, s4
s_mov_b32 s29, s5
s_mov_b32 s30, 0x400000
s_mov_b32 s31, 0x20000
s_mov_b32 s56, s20
s_mov_b32 s57, s21
s_mov_b32 s58, 0xc00000
s_mov_b32 s59, 0x20000
s_cmp_lg_u32 s72, 0
s_cbranch_scc1 K_notw0
s_bfe_u32 s78, s2, 0x10003
s_and_b32 s79, s2, 7
s_lshl_b32 s79, s79, 1
s_or_b32 s78, s78, s79
s_and_b32 s79, s2, 0x30
s_or_b32 s90, s78, s79
s_lshr_b32 s91, s2, 6
v_lshrrev_b32 v2, 2, v1
s_movk_i32 s80, 12288
v_mul_u32_u24 v2, s80, v2
v_bfe_u32 v3, v1, 4, 1
v_lshlrev_b32 v3, 1, v3
v_and_b32 v4, 3, v1
v_xor_b32 v3, v3, v4
v_lshl_add_u32 v128, v3, 4, v2
v_add_u32 v129, 195584, v128
v_add_u32 v130, 391168, v128
v_add_u32 v131, 586752, v128
s_mul_i32 s78, s91, 3145728
s_lshl_b32 s79, s90, 6
s_add_u32 s78, s78, s79
s_mov_b32 s68, s18
s_mov_b32 s69, s19
s_mov_b32 s70, 0x800
s_mov_b32 s71, 0x20000
s_lshl_b32 s79, s91, 9
v_lshlrev_b32 v5, 3, v1
buffer_load_dwordx2 v[132:133], v5, s[68:71], s79 offen
s_mov_b32 m0, 147456
s_nop 0
buffer_load_dwordx4 v128, s[56:59], s78 offen offset:0 lds
buffer_load_dwordx4 v129, s[56:59], s78 offen offset:1024 lds
buffer_load_dwordx4 v130, s[56:59], s78 offen offset:2048 lds
buffer_load_dwordx4 v131, s[56:59], s78 offen offset:3072 lds
s_mov_b32 m0, 151552
s_add_u32 s78, s78, 786432
buffer_load_dwordx4 v128, s[56:59], s78 offen offset:0 lds
buffer_load_dwordx4 v129, s[56:59], s78 offen offset:1024 lds
buffer_load_dwordx4 v130, s[56:59], s78 offen offset:2048 lds
buffer_load_dwordx4 v131, s[56:59], s78 offen offset:3072 lds
s_mov_b32 m0, 155648
s_add_u32 s78, s78, 786432
buffer_load_dwordx4 v128, s[56:59], s78 offen offset:0 lds
buffer_load_dwordx4 v129, s[56:59], s78 offen offset:1024 lds
buffer_load_dwordx4 v130, s[56:59], s78 offen offset:2048 lds
buffer_load_dwordx4 v131, s[56:59], s78 offen offset:3072 lds
s_mov_b32 m0, 159744
s_add_u32 s78, s78, 786432
buffer_load_dwordx4 v128, s[56:59], s78 offen offset:0 lds
buffer_load_dwordx4 v129, s[56:59], s78 offen offset:1024 lds
buffer_load_dwordx4 v130, s[56:59], s78 offen offset:2048 lds
buffer_load_dwordx4 v131, s[56:59], s78 offen offset:3072 lds
s_lshl_b32 s78, s73, 4
s_add_u32 s78, s78, s74
s_lshl_b32 s78, s78, 10
s_add_u32 s78, s78, 32768
v_lshl_add_u32 v5, v1, 7, s78
v_cmp_gt_u32 vcc, 8, v1
v_mov_b32 v6, s96
s_nop 0
v_cndmask_b32 v5, v6, v5, vcc
s_and_b32 s78, s2, 127
s_lshl_b32 s78, s78, 7
s_add_u32 s78, s78, 16384
v_writelane_b32 v5, s78, 8
v_mov_b32 v6, 0
buffer_store_dword v6, v5, s[60:63], 0 offen sc1
s_waitcnt vmcnt(17)
v_lshlrev_b32 v136, 16, v132
v_and_b32 v137, 0xffff0000, v132
v_lshlrev_b32 v138, 16, v133
v_and_b32 v139, 0xffff0000, v133
v_mul_f32 v140, 0xbfb8aa3b, v136
v_mul_f32 v141, 0xbfb8aa3b, v137
v_mul_f32 v142, 0xbfb8aa3b, v138
v_mul_f32 v143, 0xbfb8aa3b, v139
v_exp_f32 v140, v140
v_exp_f32 v141, v141
v_exp_f32 v142, v142
v_exp_f32 v143, v143
v_add_f32 v140, 1.0, v140
v_add_f32 v141, 1.0, v141
v_add_f32 v142, 1.0, v142
v_add_f32 v143, 1.0, v143
v_rcp_f32 v140, v140
v_rcp_f32 v141, v141
v_rcp_f32 v142, v142
v_rcp_f32 v143, v143
v_mul_f32 v136, v136, v140
v_mul_f32 v137, v137, v141
v_mul_f32 v138, v138, v142
v_mul_f32 v139, v139, v143
v_cvt_pk_bf16_f32 v140, v136, v137
v_cvt_pk_bf16_f32 v141, v138, v139
v_lshrrev_b32 v2, 3, v1
v_lshlrev_b32 v2, 6, v2
v_and_b32 v3, 3, v1
v_lshl_add_u32 v2, v3, 4, v2
v_bfe_u32 v3, v1, 2, 1
v_lshl_add_u32 v2, v3, 3, v2
v_add_u32 v2, 143872, v2
ds_write_b64 v2, v[140:141]
v_and_b32 v5, 48, v1
v_add_u32 v5, 143872, v5
s_waitcnt lgkmcnt(0)
ds_read_b128 v[160:163], v5 offset:0
ds_read_b128 v[164:167], v5 offset:64
ds_read_b128 v[168:171], v5 offset:128
ds_read_b128 v[172:175], v5 offset:192
ds_read_b128 v[176:179], v5 offset:256
ds_read_b128 v[180:183], v5 offset:320
ds_read_b128 v[184:187], v5 offset:384
ds_read_b128 v[188:191], v5 offset:448
v_lshrrev_b32 v2, 2, v1
v_lshlrev_b32 v2, 6, v2
v_bfe_u32 v3, v1, 1, 1
v_bfe_u32 v4, v1, 4, 1
v_lshl_or_b32 v3, v4, 1, v3
v_lshl_add_u32 v2, v3, 4, v2
v_and_b32 v3, 1, v1
v_lshl_add_u32 v6, v3, 3, v2
v_xor_b32 v7, 32, v6
v_add_u32 v6, 147456, v6
v_add_u32 v7, 147456, v7
s_lshl_b32 s78, s91, 13
s_lshl_b32 s79, s90, 7
s_add_u32 s78, s78, s79
s_add_u32 s78, s78, 524288
v_and_b32 v2, 15, v1
v_and_b32 v3, 48, v1
v_lshl_add_u32 v3, v2, 6, v3
v_add_u32 v3, s78, v3
v_cmp_gt_u32 vcc, 2, v2
v_mov_b32 v4, s96
s_nop 0
v_cndmask_b32 v8, v4, v3, vcc
s_and_b32 s78, s2, 7
s_lshl_b32 s78, s78, 11
v_lshl_add_u32 v3, v1, 7, s78
v_cmp_gt_u32 vcc, 16, v1
s_nop 1
v_cndmask_b32 v9, v4, v3, vcc
s_mov_b32 s68, s24
s_mov_b32 s69, s25
s_mov_b32 s70, 0x100
s_mov_b32 s71, 0x20000
v_mov_b32 v49, 0
v_cmp_eq_u32 vcc, 1, v2
s_waitcnt vmcnt(1)
buffer_load_dword v51, v49, s[68:71], 0 offen sc1
ds_read_b64_tr_b16 v[80:81], v6 offset:0
ds_read_b64_tr_b16 v[82:83], v6 offset:1024
ds_read_b64_tr_b16 v[84:85], v7 offset:0
ds_read_b64_tr_b16 v[86:87], v7 offset:1024
ds_read_b64_tr_b16 v[88:89], v6 offset:2048
ds_read_b64_tr_b16 v[90:91], v6 offset:3072
ds_read_b64_tr_b16 v[92:93], v7 offset:2048
ds_read_b64_tr_b16 v[94:95], v7 offset:3072
ds_read_b64_tr_b16 v[96:97], v6 offset:4096
ds_read_b64_tr_b16 v[98:99], v6 offset:5120
ds_read_b64_tr_b16 v[100:101], v7 offset:4096
ds_read_b64_tr_b16 v[102:103], v7 offset:5120
ds_read_b64_tr_b16 v[104:105], v6 offset:6144
ds_read_b64_tr_b16 v[106:107], v6 offset:7168
ds_read_b64_tr_b16 v[108:109], v7 offset:6144
ds_read_b64_tr_b16 v[110:111], v7 offset:7168
ds_read_b64_tr_b16 v[112:113], v6 offset:8192
ds_read_b64_tr_b16 v[114:115], v6 offset:9216
ds_read_b64_tr_b16 v[116:117], v7 offset:8192
ds_read_b64_tr_b16 v[118:119], v7 offset:9216
ds_read_b64_tr_b16 v[120:121], v6 offset:10240
ds_read_b64_tr_b16 v[122:123], v6 offset:11264
ds_read_b64_tr_b16 v[124:125], v7 offset:10240
ds_read_b64_tr_b16 v[126:127], v7 offset:11264
ds_read_b64_tr_b16 v[128:129], v6 offset:12288
ds_read_b64_tr_b16 v[130:131], v6 offset:13312
ds_read_b64_tr_b16 v[132:133], v7 offset:12288
ds_read_b64_tr_b16 v[134:135], v7 offset:13312
ds_read_b64_tr_b16 v[136:137], v6 offset:14336
ds_read_b64_tr_b16 v[138:139], v6 offset:15360
ds_read_b64_tr_b16 v[140:141], v7 offset:14336
ds_read_b64_tr_b16 v[142:143], v7 offset:15360
s_waitcnt lgkmcnt(15)
v_mfma_f32_16x16x32_bf16 v[224:227], v[80:83], v[160:163], 0
v_mfma_f32_16x16x32_bf16 v[228:231], v[84:87], v[160:163], 0
v_mfma_f32_16x16x32_bf16 v[224:227], v[88:91], v[164:167], v[224:227]
v_mfma_f32_16x16x32_bf16 v[228:231], v[92:95], v[164:167], v[228:231]
v_mfma_f32_16x16x32_bf16 v[224:227], v[96:99], v[168:171], v[224:227]
v_mfma_f32_16x16x32_bf16 v[228:231], v[100:103], v[168:171], v[228:231]
v_mfma_f32_16x16x32_bf16 v[224:227], v[104:107], v[172:175], v[224:227]
v_mfma_f32_16x16x32_bf16 v[228:231], v[108:111], v[172:175], v[228:231]
s_waitcnt lgkmcnt(14)
v_mfma_f32_16x16x32_bf16 v[224:227], v[112:115], v[176:179], v[224:227]
s_waitcnt lgkmcnt(12)
v_mfma_f32_16x16x32_bf16 v[228:231], v[116:119], v[176:179], v[228:231]
s_waitcnt lgkmcnt(10)
v_mfma_f32_16x16x32_bf16 v[224:227], v[120:123], v[180:183], v[224:227]
s_waitcnt lgkmcnt(8)
v_mfma_f32_16x16x32_bf16 v[228:231], v[124:127], v[180:183], v[228:231]
s_waitcnt lgkmcnt(6)
v_mfma_f32_16x16x32_bf16 v[224:227], v[128:131], v[184:187], v[224:227]
s_waitcnt lgkmcnt(4)
v_mfma_f32_16x16x32_bf16 v[228:231], v[132:135], v[184:187], v[228:231]
s_waitcnt lgkmcnt(2)
v_mfma_f32_16x16x32_bf16 v[224:227], v[136:139], v[188:191], v[224:227]
s_waitcnt lgkmcnt(0)
v_mfma_f32_16x16x32_bf16 v[228:231], v[140:143], v[188:191], v[228:231]
s_nop 7
v_cndmask_b32 v224, v224, v228, vcc
v_cndmask_b32 v225, v225, v229, vcc
v_cndmask_b32 v226, v226, v230, vcc
v_cndmask_b32 v227, v227, v231, vcc
buffer_store_dwordx4 v[224:227], v8, s[60:63], 0 offen sc1
s_waitcnt vmcnt(0)
s_mov_b32 s81, 0
K_dbgchk:
v_cmp_ne_u32 vcc, 1, v51
s_cbranch_vccz K_dbgok
s_sleep 4
buffer_load_dword v51, v49, s[68:71], 0 offen sc1
s_add_u32 s81, s81, 1
s_cmp_lt_u32 s81, 0x40000
s_waitcnt vmcnt(0)
s_cbranch_scc1 K_dbgchk
K_dbgok:
buffer_atomic_add v52, v9, s[60:63], 0 offen sc1
s_branch K_xs
K_notw0:
s_lshr_b32 s78, s2, 3
s_mul_i32 s78, s78, 3
s_add_u32 s78, s78, s72
s_lshl_b32 s79, s78, 8
v_lshl_add_u32 v2, v1, 2, s79
global_load_dword v57, v2, s[0:1]
s_and_b32 s78, s74, 7
s_lshl_b32 s78, s78, 15
s_lshl_b32 s79, s73, 18
s_add_u32 s78, s78, s79
s_add_u32 s79, s78, s76
v_lshlrev_b32 v3, 7, v1
buffer_load_dword v57, v3, s[28:31], s79 offen
s_cmp_lg_u32 s72, 3
s_cbranch_scc1 K_nx
buffer_load_dword v57, v3, s[28:31], s78 offen
K_nx:
s_lshl_b32 s78, s2, 2
s_add_u32 s78, s78, s72
s_cmp_lg_u32 s78, 1
s_cbranch_scc1 K_xs
v_lshlrev_b32 v2, 7, v1
v_mov_b32 v3, 0
s_movk_i32 s78, 8192
s_mov_b32 s68, s24
s_mov_b32 s69, s25
s_mov_b32 s70, 0x100
s_mov_b32 s71, 0x20000
buffer_store_dword v3, v2, s[60:63], 0 offen sc1
buffer_store_dword v3, v2, s[60:63], s78 offen sc1
v_lshlrev_b32 v2, 8, v1
s_waitcnt vmcnt(0)
buffer_store_dword v52, v2, s[68:71], 0 offen sc1
K_xs:
s_nop 15
s_nop 3
s_lshl_b32 s91, s72, 15
s_add_u32 m0, s91, 0
s_movk_i32 s77, 0
buffer_load_dwordx4 v192, s[28:31], s77 offen offset:0 lds
buffer_load_dwordx4 v193, s[28:31], s77 offen offset:1024 lds
buffer_load_dwordx4 v194, s[28:31], s77 offen offset:2048 lds
buffer_load_dwordx4 v195, s[28:31], s77 offen offset:3072 lds
s_add_u32 m0, s91, 4096
s_movk_i32 s77, 128
buffer_load_dwordx4 v192, s[28:31], s77 offen offset:0 lds
buffer_load_dwordx4 v193, s[28:31], s77 offen offset:1024 lds
buffer_load_dwordx4 v194, s[28:31], s77 offen offset:2048 lds
buffer_load_dwordx4 v195, s[28:31], s77 offen offset:3072 lds
s_add_u32 m0, s91, 8192
s_movk_i32 s77, 256
buffer_load_dwordx4 v192, s[28:31], s77 offen offset:0 lds
buffer_load_dwordx4 v193, s[28:31], s77 offen offset:1024 lds
buffer_load_dwordx4 v194, s[28:31], s77 offen offset:2048 lds
buffer_load_dwordx4 v195, s[28:31], s77 offen offset:3072 lds
s_mov_b32 s32, s6
s_mov_b32 s33, s7
s_mov_b32 s34, 0x600000
s_mov_b32 s35, 0x20000
s_mov_b32 s36, s8
s_mov_b32 s37, s9
s_mov_b32 s38, 0x200000
s_mov_b32 s39, 0x20000
s_mov_b32 s40, s12
s_mov_b32 s41, s13
s_mov_b32 s42, 0x700000
s_mov_b32 s43, 0x20000
s_mov_b32 s44, s14
s_mov_b32 s45, s15
s_mov_b32 s46, 0x700000
s_mov_b32 s47, 0x20000
s_mov_b32 s48, s16
s_mov_b32 s49, s17
s_mov_b32 s50, 0x700000
s_mov_b32 s51, 0x20000
s_mov_b32 s64, s22
s_mov_b32 s65, s23
s_mov_b32 s66, 0x400000
s_mov_b32 s67, 0x20000
s_cmp_ge_u32 s72, 2
s_cselect_b32 s52, s14, s12
s_cselect_b32 s53, s15, s13
s_mov_b32 s54, 0x700000
s_mov_b32 s55, 0x20000
v_bfe_u32 v2, v1, 2, 3
v_and_b32 v3, 6, v2
v_bfe_u32 v4, v1, 1, 1
v_xor_b32 v3, v3, v4
v_lshlrev_b32 v3, 4, v3
v_lshl_add_u32 v3, v2, 7, v3
v_and_b32 v4, 1, v1
v_lshl_add_u32 v3, v4, 3, v3
v_lshrrev_b32 v4, 5, v1
v_lshl_add_u32 v10, v4, 13, v3
v_xor_b32 v11, 32, v10
v_xor_b32 v12, 64, v10
v_xor_b32 v13, 96, v10
v_add_u32 v14, 0x10000, v10
v_add_u32 v15, 0x10000, v11
v_add_u32 v16, 0x10000, v12
v_add_u32 v17, 0x10000, v13
v_lshrrev_b32 v2, 2, v1
v_lshlrev_b32 v2, 6, v2
v_bfe_u32 v3, v1, 1, 1
v_bfe_u32 v4, v1, 4, 1
v_lshl_or_b32 v3, v4, 1, v3
v_lshl_add_u32 v2, v3, 4, v2
v_and_b32 v3, 1, v1
v_lshl_add_u32 v18, v3, 3, v2
v_xor_b32 v19, 32, v18
v_add_u32 v20, 0x10000, v18
v_add_u32 v21, 0x10000, v19
v_lshrrev_b32 v2, 3, v1
v_and_b32 v3, 6, v2
v_and_b32 v4, 7, v1
v_xor_b32 v3, v3, v4
v_lshlrev_b32 v3, 4, v3
s_lshl_b32 s78, s72, 3
v_add_u32 v4, s78, v2
s_movk_i32 s79, 2048
v_mad_u32_u24 v26, v4, s79, v3
v_add_u32 v27, 64512, v26
v_add_u32 v28, 129024, v26
v_add_u32 v29, 193536, v26
s_movk_i32 s79, 7168
v_mad_u32_u24 v30, v4, s79, v3
v_add_u32 v31, 228352, v30
v_add_u32 v32, 456704, v30
v_add_u32 v33, 685056, v30
s_movk_i32 s79, 12288
v_mad_u32_u24 v38, v4, s79, v3
v_add_u32 v39, 392192, v38
v_add_u32 v40, 784384, v38
v_add_u32 v41, 1176576, v38
s_and_b32 s78, s72, 1
s_lshl_b32 s78, s78, 4
s_lshr_b32 s79, s72, 1
s_lshl_b32 s79, s79, 2
s_add_u32 s79, s78, s79
v_and_b32 v4, 4, v2
v_add3_u32 v4, v4, v2, s79
s_movk_i32 s79, 6144
v_mad_u32_u24 v22, v4, s79, v3
v_add_u32 v23, 195584, v22
v_add_u32 v24, 391168, v22
v_add_u32 v25, 586752, v22
v_lshrrev_b32 v2, 2, v1
s_movk_i32 s80, 7168
v_mul_u32_u24 v2, s80, v2
v_bfe_u32 v3, v1, 4, 1
v_lshlrev_b32 v3, 1, v3
v_and_b32 v4, 3, v1
v_xor_b32 v3, v3, v4
v_lshl_add_u32 v34, v3, 4, v2
s_mul_i32 s78, s78, 7168
v_add_u32 v34, s78, v34
v_add_u32 v35, 228352, v34
v_add_u32 v36, 456704, v34
v_add_u32 v37, 685056, v34
s_lshl_b32 s82, s74, 7
s_and_b32 s78, s74, 3
s_lshl_b32 s75, s78, 2
s_lshr_b32 s79, s74, 2
s_add_u32 s75, s75, s79
s_lshl_b32 s83, s75, 7
s_mul_i32 s84, s74, 448
s_bitcmp1_b32 s74, 0
s_cselect_b32 s78, 0, 384
s_cselect_b32 s79, 64, 0
s_add_u32 s85, s84, s78
s_add_u32 s84, s84, s79
s_lshr_b32 s78, s2, 6
s_mul_i32 s86, s78, 3145728
s_and_b32 s78, s2, 63
s_lshl_b32 s78, s78, 7
s_add_u32 s86, s86, s78
s_add_u32 s86, s86, 4096
s_lshl_b32 s78, s72, 11
v_lshl_add_u32 v9, v1, 5, s78
s_lshl_b32 s78, s2, 2
s_add_u32 s78, s78, s72
s_mul_i32 s78, s78, 2048
v_lshl_add_u32 v2, v1, 7, s78
v_cmp_gt_u32 vcc, 16, v1
v_mov_b32 v3, s96
s_nop 0
v_cndmask_b32 v8, v3, v2, vcc
v_and_b32 v2, 31, v0
v_mul_u32_u24 v2, 272, v2
v_add_u32 v2, 131328, v2
v_mov_b32 v4, 0
v_mov_b32 v5, 0
v_mov_b32 v6, 0
v_mov_b32 v7, 0
ds_write_b128 v2, v[4:7]
s_add_u32 m0, s91, 12288
s_movk_i32 s77, 384
buffer_load_dwordx4 v192, s[28:31], s77 offen offset:0 lds
buffer_load_dwordx4 v193, s[28:31], s77 offen offset:1024 lds
buffer_load_dwordx4 v194, s[28:31], s77 offen offset:2048 lds
buffer_load_dwordx4 v195, s[28:31], s77 offen offset:3072 lds
s_add_u32 m0, s91, 16384
s_movk_i32 s77, 512
buffer_load_dwordx4 v192, s[28:31], s77 offen offset:0 lds
buffer_load_dwordx4 v193, s[28:31], s77 offen offset:1024 lds
buffer_load_dwordx4 v194, s[28:31], s77 offen offset:2048 lds
buffer_load_dwordx4 v195, s[28:31], s77 offen offset:3072 lds
s_add_u32 m0, s91, 20480
s_movk_i32 s77, 640
buffer_load_dwordx4 v192, s[28:31], s77 offen offset:0 lds
buffer_load_dwordx4 v193, s[28:31], s77 offen offset:1024 lds
buffer_load_dwordx4 v194, s[28:31], s77 offen offset:2048 lds
buffer_load_dwordx4 v195, s[28:31], s77 offen offset:3072 lds
s_add_u32 m0, s91, 24576
s_movk_i32 s77, 768
buffer_load_dwordx4 v192, s[28:31], s77 offen offset:0 lds
buffer_load_dwordx4 v193, s[28:31], s77 offen offset:1024 lds
buffer_load_dwordx4 v194, s[28:31], s77 offen offset:2048 lds
buffer_load_dwordx4 v195, s[28:31], s77 offen offset:3072 lds
s_add_u32 m0, s91, 28672
s_movk_i32 s77, 896
buffer_load_dwordx4 v192, s[28:31], s77 offen offset:0 lds
buffer_load_dwordx4 v193, s[28:31], s77 offen offset:1024 lds
buffer_load_dwordx4 v194, s[28:31], s77 offen offset:2048 lds
buffer_load_dwordx4 v195, s[28:31], s77 offen offset:3072 lds
v_and_b32 v2, 15, v1
v_lshrrev_b32 v3, 1, v2
v_lshrrev_b32 v4, 4, v1
v_xor_b32 v3, v3, v4
v_lshlrev_b32 v3, 4, v3
v_lshl_add_u32 v3, v2, 7, v3
v_add_u32 v196, s91, v3
v_xor_b32 v197, 64, v196
v_mov_b32 v200, 0x3f803f80
v_mov_b32 v201, 0x3f803f80
v_mov_b32 v202, 0x3f803f80
v_mov_b32 v203, 0x3f803f80
s_waitcnt vmcnt(28)
ds_read_b128 a[0:3], v196 offset:0
ds_read_b128 a[4:7], v196 offset:2048
ds_read_b128 a[8:11], v197 offset:0
ds_read_b128 a[12:15], v197 offset:2048
s_waitcnt vmcnt(24)
ds_read_b128 a[16:19], v196 offset:4096
ds_read_b128 a[20:23], v196 offset:6144
ds_read_b128 a[24:27], v197 offset:4096
ds_read_b128 a[28:31], v197 offset:6144
s_waitcnt lgkmcnt(4)
s_add_u32 m0, s91, 0
s_movk_i32 s77, 1024
buffer_load_dwordx4 v192, s[28:31], s77 offen offset:0 lds
buffer_load_dwordx4 v193, s[28:31], s77 offen offset:1024 lds
buffer_load_dwordx4 v194, s[28:31], s77 offen offset:2048 lds
buffer_load_dwordx4 v195, s[28:31], s77 offen offset:3072 lds
v_mfma_f32_16x16x32_bf16 v[204:207], v[200:203], a[0:3], 0
v_mfma_f32_16x16x32_bf16 v[212:215], a[0:3], a[0:3], 0
v_mfma_f32_16x16x32_bf16 v[208:211], v[200:203], a[4:7], 0
v_mfma_f32_16x16x32_bf16 v[216:219], a[4:7], a[4:7], 0
v_mfma_f32_16x16x32_bf16 v[204:207], v[200:203], a[8:11], v[204:207]
v_mfma_f32_16x16x32_bf16 v[212:215], a[8:11], a[8:11], v[212:215]
v_mfma_f32_16x16x32_bf16 v[208:211], v[200:203], a[12:15], v[208:211]
v_mfma_f32_16x16x32_bf16 v[216:219], a[12:15], a[12:15], v[216:219]
s_waitcnt vmcnt(24)
ds_read_b128 a[32:35], v196 offset:8192
ds_read_b128 a[36:39], v196 offset:10240
ds_read_b128 a[40:43], v197 offset:8192
ds_read_b128 a[44:47], v197 offset:10240
s_waitcnt lgkmcnt(4)
s_add_u32 m0, s91, 4096
s_movk_i32 s77, 1152
buffer_load_dwordx4 v192, s[28:31], s77 offen offset:0 lds
buffer_load_dwordx4 v193, s[28:31], s77 offen offset:1024 lds
buffer_load_dwordx4 v194, s[28:31], s77 offen offset:2048 lds
buffer_load_dwordx4 v195, s[28:31], s77 offen offset:3072 lds
v_mfma_f32_16x16x32_bf16 v[204:207], v[200:203], a[16:19], v[204:207]
v_mfma_f32_16x16x32_bf16 v[212:215], a[16:19], a[16:19], v[212:215]
v_mfma_f32_16x16x32_bf16 v[208:211], v[200:203], a[20:23], v[208:211]
v_mfma_f32_16x16x32_bf16 v[216:219], a[20:23], a[20:23], v[216:219]
v_mfma_f32_16x16x32_bf16 v[204:207], v[200:203], a[24:27], v[204:207]
v_mfma_f32_16x16x32_bf16 v[212:215], a[24:27], a[24:27], v[212:215]
v_mfma_f32_16x16x32_bf16 v[208:211], v[200:203], a[28:31], v[208:211]
v_mfma_f32_16x16x32_bf16 v[216:219], a[28:31], a[28:31], v[216:219]
s_waitcnt vmcnt(24)
ds_read_b128 a[48:51], v196 offset:12288
ds_read_b128 a[52:55], v196 offset:14336
ds_read_b128 a[56:59], v197 offset:12288
ds_read_b128 a[60:63], v197 offset:14336
s_waitcnt lgkmcnt(4)
s_add_u32 m0, s91, 8192
s_movk_i32 s77, 1280
buffer_load_dwordx4 v192, s[28:31], s77 offen offset:0 lds
buffer_load_dwordx4 v193, s[28:31], s77 offen offset:1024 lds
buffer_load_dwordx4 v194, s[28:31], s77 offen offset:2048 lds
buffer_load_dwordx4 v195, s[28:31], s77 offen offset:3072 lds
v_mfma_f32_16x16x32_bf16 v[204:207], v[200:203], a[32:35], v[204:207]
v_mfma_f32_16x16x32_bf16 v[212:215], a[32:35], a[32:35], v[212:215]
v_mfma_f32_16x16x32_bf16 v[208:211], v[200:203], a[36:39], v[208:211]
v_mfma_f32_16x16x32_bf16 v[216:219], a[36:39], a[36:39], v[216:219]
v_mfma_f32_16x16x32_bf16 v[204:207], v[200:203], a[40:43], v[204:207]
v_mfma_f32_16x16x32_bf16 v[212:215], a[40:43], a[40:43], v[212:215]
v_mfma_f32_16x16x32_bf16 v[208:211], v[200:203], a[44:47], v[208:211]
v_mfma_f32_16x16x32_bf16 v[216:219], a[44:47], a[44:47], v[216:219]
s_waitcnt vmcnt(24)
ds_read_b128 a[64:67], v196 offset:16384
ds_read_b128 a[68:71], v196 offset:18432
ds_read_b128 a[72:75], v197 offset:16384
ds_read_b128 a[76:79], v197 offset:18432
s_waitcnt lgkmcnt(4)
s_add_u32 m0, s91, 12288
s_movk_i32 s77, 1408
buffer_load_dwordx4 v192, s[28:31], s77 offen offset:0 lds
buffer_load_dwordx4 v193, s[28:31], s77 offen offset:1024 lds
buffer_load_dwordx4 v194, s[28:31], s77 offen offset:2048 lds
buffer_load_dwordx4 v195, s[28:31], s77 offen offset:3072 lds
v_mfma_f32_16x16x32_bf16 v[204:207], v[200:203], a[48:51], v[204:207]
v_mfma_f32_16x16x32_bf16 v[212:215], a[48:51], a[48:51], v[212:215]
v_mfma_f32_16x16x32_bf16 v[208:211], v[200:203], a[52:55], v[208:211]
v_mfma_f32_16x16x32_bf16 v[216:219], a[52:55], a[52:55], v[216:219]
v_mfma_f32_16x16x32_bf16 v[204:207], v[200:203], a[56:59], v[204:207]
v_mfma_f32_16x16x32_bf16 v[212:215], a[56:59], a[56:59], v[212:215]
v_mfma_f32_16x16x32_bf16 v[208:211], v[200:203], a[60:63], v[208:211]
v_mfma_f32_16x16x32_bf16 v[216:219], a[60:63], a[60:63], v[216:219]
s_waitcnt vmcnt(24)
ds_read_b128 a[80:83], v196 offset:20480
ds_read_b128 a[84:87], v196 offset:22528
ds_read_b128 a[88:91], v197 offset:20480
ds_read_b128 a[92:95], v197 offset:22528
s_waitcnt lgkmcnt(4)
s_add_u32 m0, s91, 16384
s_movk_i32 s77, 1536
buffer_load_dwordx4 v192, s[28:31], s77 offen offset:0 lds
buffer_load_dwordx4 v193, s[28:31], s77 offen offset:1024 lds
buffer_load_dwordx4 v194, s[28:31], s77 offen offset:2048 lds
buffer_load_dwordx4 v195, s[28:31], s77 offen offset:3072 lds
v_mfma_f32_16x16x32_bf16 v[204:207], v[200:203], a[64:67], v[204:207]
v_mfma_f32_16x16x32_bf16 v[212:215], a[64:67], a[64:67], v[212:215]
v_mfma_f32_16x16x32_bf16 v[208:211], v[200:203], a[68:71], v[208:211]
v_mfma_f32_16x16x32_bf16 v[216:219], a[68:71], a[68:71], v[216:219]
v_mfma_f32_16x16x32_bf16 v[204:207], v[200:203], a[72:75], v[204:207]
v_mfma_f32_16x16x32_bf16 v[212:215], a[72:75], a[72:75], v[212:215]
v_mfma_f32_16x16x32_bf16 v[208:211], v[200:203], a[76:79], v[208:211]
v_mfma_f32_16x16x32_bf16 v[216:219], a[76:79], a[76:79], v[216:219]
s_waitcnt vmcnt(24)
ds_read_b128 a[96:99], v196 offset:24576
ds_read_b128 a[100:103], v196 offset:26624
ds_read_b128 a[104:107], v197 offset:24576
ds_read_b128 a[108:111], v197 offset:26624
s_waitcnt lgkmcnt(4)
s_add_u32 m0, s91, 20480
s_movk_i32 s77, 1664
buffer_load_dwordx4 v192, s[28:31], s77 offen offset:0 lds
buffer_load_dwordx4 v193, s[28:31], s77 offen offset:1024 lds
buffer_load_dwordx4 v194, s[28:31], s77 offen offset:2048 lds
buffer_load_dwordx4 v195, s[28:31], s77 offen offset:3072 lds
v_mfma_f32_16x16x32_bf16 v[204:207], v[200:203], a[80:83], v[204:207]
v_mfma_f32_16x16x32_bf16 v[212:215], a[80:83], a[80:83], v[212:215]
v_mfma_f32_16x16x32_bf16 v[208:211], v[200:203], a[84:87], v[208:211]
v_mfma_f32_16x16x32_bf16 v[216:219], a[84:87], a[84:87], v[216:219]
v_mfma_f32_16x16x32_bf16 v[204:207], v[200:203], a[88:91], v[204:207]
v_mfma_f32_16x16x32_bf16 v[212:215], a[88:91], a[88:91], v[212:215]
v_mfma_f32_16x16x32_bf16 v[208:211], v[200:203], a[92:95], v[208:211]
v_mfma_f32_16x16x32_bf16 v[216:219], a[92:95], a[92:95], v[216:219]
s_waitcnt vmcnt(24)
ds_read_b128 a[112:115], v196 offset:28672
ds_read_b128 a[116:119], v196 offset:30720
ds_read_b128 a[120:123], v197 offset:28672
ds_read_b128 a[124:127], v197 offset:30720
s_waitcnt lgkmcnt(4)
s_add_u32 m0, s91, 24576
s_movk_i32 s77, 1792
buffer_load_dwordx4 v192, s[28:31], s77 offen offset:0 lds
buffer_load_dwordx4 v193, s[28:31], s77 offen offset:1024 lds
buffer_load_dwordx4 v194, s[28:31], s77 offen offset:2048 lds
buffer_load_dwordx4 v195, s[28:31], s77 offen offset:3072 lds
v_mfma_f32_16x16x32_bf16 v[204:207], v[200:203], a[96:99], v[204:207]
v_mfma_f32_16x16x32_bf16 v[212:215], a[96:99], a[96:99], v[212:215]
v_mfma_f32_16x16x32_bf16 v[208:211], v[200:203], a[100:103], v[208:211]
v_mfma_f32_16x16x32_bf16 v[216:219], a[100:103], a[100:103], v[216:219]
v_mfma_f32_16x16x32_bf16 v[204:207], v[200:203], a[104:107], v[204:207]
v_mfma_f32_16x16x32_bf16 v[212:215], a[104:107], a[104:107], v[212:215]
v_mfma_f32_16x16x32_bf16 v[208:211], v[200:203], a[108:111], v[208:211]
v_mfma_f32_16x16x32_bf16 v[216:219], a[108:111], a[108:111], v[216:219]
s_waitcnt vmcnt(24)
ds_read_b128 a[128:131], v196 offset:0
ds_read_b128 a[132:135], v196 offset:2048
ds_read_b128 a[136:139], v197 offset:0
ds_read_b128 a[140:143], v197 offset:2048
s_waitcnt lgkmcnt(4)
s_add_u32 m0, s91, 28672
s_movk_i32 s77, 1920
buffer_load_dwordx4 v192, s[28:31], s77 offen offset:0 lds
buffer_load_dwordx4 v193, s[28:31], s77 offen offset:1024 lds
buffer_load_dwordx4 v194, s[28:31], s77 offen offset:2048 lds
buffer_load_dwordx4 v195, s[28:31], s77 offen offset:3072 lds
v_mfma_f32_16x16x32_bf16 v[204:207], v[200:203], a[112:115], v[204:207]
v_mfma_f32_16x16x32_bf16 v[212:215], a[112:115], a[112:115], v[212:215]
v_mfma_f32_16x16x32_bf16 v[208:211], v[200:203], a[116:119], v[208:211]
v_mfma_f32_16x16x32_bf16 v[216:219], a[116:119], a[116:119], v[216:219]
v_mfma_f32_16x16x32_bf16 v[204:207], v[200:203], a[120:123], v[204:207]
v_mfma_f32_16x16x32_bf16 v[212:215], a[120:123], a[120:123], v[212:215]
v_mfma_f32_16x16x32_bf16 v[208:211], v[200:203], a[124:127], v[208:211]
v_mfma_f32_16x16x32_bf16 v[216:219], a[124:127], a[124:127], v[216:219]
s_waitcnt vmcnt(24)
ds_read_b128 a[144:147], v196 offset:4096
ds_read_b128 a[148:151], v196 offset:6144
ds_read_b128 a[152:155], v197 offset:4096
ds_read_b128 a[156:159], v197 offset:6144
s_waitcnt lgkmcnt(4)
v_mfma_f32_16x16x32_bf16 v[204:207], v[200:203], a[128:131], v[204:207]
v_mfma_f32_16x16x32_bf16 v[212:215], a[128:131], a[128:131], v[212:215]
v_mfma_f32_16x16x32_bf16 v[208:211], v[200:203], a[132:135], v[208:211]
v_mfma_f32_16x16x32_bf16 v[216:219], a[132:135], a[132:135], v[216:219]
v_mfma_f32_16x16x32_bf16 v[204:207], v[200:203], a[136:139], v[204:207]
v_mfma_f32_16x16x32_bf16 v[212:215], a[136:139], a[136:139], v[212:215]
v_mfma_f32_16x16x32_bf16 v[208:211], v[200:203], a[140:143], v[208:211]
v_mfma_f32_16x16x32_bf16 v[216:219], a[140:143], a[140:143], v[216:219]
s_waitcnt vmcnt(20)
ds_read_b128 a[160:163], v196 offset:8192
ds_read_b128 a[164:167], v196 offset:10240
ds_read_b128 a[168:171], v197 offset:8192
ds_read_b128 a[172:175], v197 offset:10240
s_waitcnt lgkmcnt(4)
v_mfma_f32_16x16x32_bf16 v[204:207], v[200:203], a[144:147], v[204:207]
v_mfma_f32_16x16x32_bf16 v[212:215], a[144:147], a[144:147], v[212:215]
v_mfma_f32_16x16x32_bf16 v[208:211], v[200:203], a[148:151], v[208:211]
v_mfma_f32_16x16x32_bf16 v[216:219], a[148:151], a[148:151], v[216:219]
v_mfma_f32_16x16x32_bf16 v[204:207], v[200:203], a[152:155], v[204:207]
v_mfma_f32_16x16x32_bf16 v[212:215], a[152:155], a[152:155], v[212:215]
v_mfma_f32_16x16x32_bf16 v[208:211], v[200:203], a[156:159], v[208:211]
v_mfma_f32_16x16x32_bf16 v[216:219], a[156:159], a[156:159], v[216:219]
s_waitcnt vmcnt(16)
ds_read_b128 a[176:179], v196 offset:12288
ds_read_b128 a[180:183], v196 offset:14336
ds_read_b128 a[184:187], v197 offset:12288
ds_read_b128 a[188:191], v197 offset:14336
s_waitcnt lgkmcnt(4)
v_mfma_f32_16x16x32_bf16 v[204:207], v[200:203], a[160:163], v[204:207]
v_mfma_f32_16x16x32_bf16 v[212:215], a[160:163], a[160:163], v[212:215]
v_mfma_f32_16x16x32_bf16 v[208:211], v[200:203], a[164:167], v[208:211]
v_mfma_f32_16x16x32_bf16 v[216:219], a[164:167], a[164:167], v[216:219]
v_mfma_f32_16x16x32_bf16 v[204:207], v[200:203], a[168:171], v[204:207]
v_mfma_f32_16x16x32_bf16 v[212:215], a[168:171], a[168:171], v[212:215]
v_mfma_f32_16x16x32_bf16 v[208:211], v[200:203], a[172:175], v[208:211]
v_mfma_f32_16x16x32_bf16 v[216:219], a[172:175], a[172:175], v[216:219]
s_waitcnt vmcnt(12)
ds_read_b128 a[192:195], v196 offset:16384
ds_read_b128 a[196:199], v196 offset:18432
ds_read_b128 a[200:203], v197 offset:16384
ds_read_b128 a[204:207], v197 offset:18432
s_waitcnt lgkmcnt(4)
v_mfma_f32_16x16x32_bf16 v[204:207], v[200:203], a[176:179], v[204:207]
v_mfma_f32_16x16x32_bf16 v[212:215], a[176:179], a[176:179], v[212:215]
v_mfma_f32_16x16x32_bf16 v[208:211], v[200:203], a[180:183], v[208:211]
v_mfma_f32_16x16x32_bf16 v[216:219], a[180:183], a[180:183], v[216:219]
v_mfma_f32_16x16x32_bf16 v[204:207], v[200:203], a[184:187], v[204:207]
v_mfma_f32_16x16x32_bf16 v[212:215], a[184:187], a[184:187], v[212:215]
v_mfma_f32_16x16x32_bf16 v[208:211], v[200:203], a[188:191], v[208:211]
v_mfma_f32_16x16x32_bf16 v[216:219], a[188:191], a[188:191], v[216:219]
s_waitcnt vmcnt(8)
ds_read_b128 a[208:211], v196 offset:20480
ds_read_b128 a[212:215], v196 offset:22528
ds_read_b128 a[216:219], v197 offset:20480
ds_read_b128 a[220:223], v197 offset:22528
s_waitcnt lgkmcnt(4)
v_mfma_f32_16x16x32_bf16 v[204:207], v[200:203], a[192:195], v[204:207]
v_mfma_f32_16x16x32_bf16 v[212:215], a[192:195], a[192:195], v[212:215]
v_mfma_f32_16x16x32_bf16 v[208:211], v[200:203], a[196:199], v[208:211]
v_mfma_f32_16x16x32_bf16 v[216:219], a[196:199], a[196:199], v[216:219]
v_mfma_f32_16x16x32_bf16 v[204:207], v[200:203], a[200:203], v[204:207]
v_mfma_f32_16x16x32_bf16 v[212:215], a[200:203], a[200:203], v[212:215]
v_mfma_f32_16x16x32_bf16 v[208:211], v[200:203], a[204:207], v[208:211]
v_mfma_f32_16x16x32_bf16 v[216:219], a[204:207], a[204:207], v[216:219]
s_waitcnt vmcnt(4)
ds_read_b128 a[224:227], v196 offset:24576
ds_read_b128 a[228:231], v196 offset:26624
ds_read_b128 a[232:235], v197 offset:24576
ds_read_b128 a[236:239], v197 offset:26624
s_waitcnt lgkmcnt(4)
v_mfma_f32_16x16x32_bf16 v[204:207], v[200:203], a[208:211], v[204:207]
v_mfma_f32_16x16x32_bf16 v[212:215], a[208:211], a[208:211], v[212:215]
v_mfma_f32_16x16x32_bf16 v[208:211], v[200:203], a[212:215], v[208:211]
v_mfma_f32_16x16x32_bf16 v[216:219], a[212:215], a[212:215], v[216:219]
v_mfma_f32_16x16x32_bf16 v[204:207], v[200:203], a[216:219], v[204:207]
v_mfma_f32_16x16x32_bf16 v[212:215], a[216:219], a[216:219], v[212:215]
v_mfma_f32_16x16x32_bf16 v[208:211], v[200:203], a[220:223], v[208:211]
v_mfma_f32_16x16x32_bf16 v[216:219], a[220:223], a[220:223], v[216:219]
s_waitcnt vmcnt(0)
ds_read_b128 a[240:243], v196 offset:28672
ds_read_b128 a[244:247], v196 offset:30720
ds_read_b128 a[248:251], v197 offset:28672
ds_read_b128 a[252:255], v197 offset:30720
s_waitcnt lgkmcnt(4)
v_mfma_f32_16x16x32_bf16 v[204:207], v[200:203], a[224:227], v[204:207]
v_mfma_f32_16x16x32_bf16 v[212:215], a[224:227], a[224:227], v[212:215]
v_mfma_f32_16x16x32_bf16 v[208:211], v[200:203], a[228:231], v[208:211]
v_mfma_f32_16x16x32_bf16 v[216:219], a[228:231], a[228:231], v[216:219]
v_mfma_f32_16x16x32_bf16 v[204:207], v[200:203], a[232:235], v[204:207]
v_mfma_f32_16x16x32_bf16 v[212:215], a[232:235], a[232:235], v[212:215]
v_mfma_f32_16x16x32_bf16 v[208:211], v[200:203], a[236:239], v[208:211]
v_mfma_f32_16x16x32_bf16 v[216:219], a[236:239], a[236:239], v[216:219]
s_waitcnt lgkmcnt(3)
v_mfma_f32_16x16x32_bf16 v[204:207], v[200:203], a[240:243], v[204:207]
v_mfma_f32_16x16x32_bf16 v[212:215], a[240:243], a[240:243], v[212:215]
s_waitcnt lgkmcnt(2)
v_mfma_f32_16x16x32_bf16 v[208:211], v[200:203], a[244:247], v[208:211]
v_mfma_f32_16x16x32_bf16 v[216:219], a[244:247], a[244:247], v[216:219]
s_waitcnt lgkmcnt(1)
v_mfma_f32_16x16x32_bf16 v[204:207], v[200:203], a[248:251], v[204:207]
v_mfma_f32_16x16x32_bf16 v[212:215], a[248:251], a[248:251], v[212:215]
s_waitcnt lgkmcnt(0)
v_mfma_f32_16x16x32_bf16 v[208:211], v[200:203], a[252:255], v[208:211]
v_mfma_f32_16x16x32_bf16 v[216:219], a[252:255], a[252:255], v[216:219]
s_lshr_b32 s78, s2, 4
s_lshl_b32 s78, s78, 7
s_add_u32 s78, s78, 0
v_lshl_add_u32 v2, v1, 11, s78
v_cmp_gt_u32 vcc, 8, v0
v_mov_b32 v3, s96
s_nop 0
v_cndmask_b32 v49, v3, v2, vcc
v_mov_b32 v2, 32
v_cndmask_b32 v50, 0, v2, vcc
v_mov_b32 v51, 0
buffer_atomic_add v51, v49, s[60:63], 0 offen sc0 sc1
v_and_b32 v2, 3, v1
v_cmp_eq_u32 vcc, 1, v2
s_nop 1
v_cndmask_b32 v212, v212, v213, vcc
v_cndmask_b32 v216, v216, v217, vcc
v_cmp_eq_u32 vcc, 2, v2
s_nop 1
v_cndmask_b32 v212, v212, v214, vcc
v_cndmask_b32 v216, v216, v218, vcc
v_cmp_eq_u32 vcc, 3, v2
s_nop 1
v_cndmask_b32 v212, v212, v215, vcc
v_cndmask_b32 v216, v216, v219, vcc
v_and_b32 v2, 15, v1
v_lshrrev_b32 v3, 2, v2
v_lshl_add_u32 v2, v3, 4, v2
v_lshlrev_b32 v2, 2, v2
ds_bpermute_b32 v213, v2, v212
ds_bpermute_b32 v217, v2, v216
v_mul_f32 v204, 0x3a800000, v204
v_mul_f32 v208, 0x3a800000, v208
v_mul_f32 v205, v204, v204
v_mul_f32 v209, v208, v208
s_waitcnt lgkmcnt(1)
v_mul_f32 v213, 0x3a800000, v213
s_waitcnt lgkmcnt(0)
v_mul_f32 v217, 0x3a800000, v217
v_sub_f32 v213, v213, v205
v_sub_f32 v217, v217, v209
v_max_f32 v213, 0, v213
v_max_f32 v217, 0, v217
v_cvt_pk_bf16_f32 v206, v213, v213
v_lshlrev_b32 v213, 16, v206
v_cvt_pk_bf16_f32 v210, v217, v217
v_lshlrev_b32 v217, 16, v210
v_add_f32 v213, 0x3727c5ac, v213
v_add_f32 v217, 0x3727c5ac, v217
v_cvt_pk_bf16_f32 v206, v213, v213
v_lshlrev_b32 v213, 16, v206
v_cvt_pk_bf16_f32 v210, v217, v217
v_lshlrev_b32 v217, 16, v210
v_sqrt_f32 v213, v213
v_sqrt_f32 v217, v217
v_sub_f32 v204, 0, v204
v_sub_f32 v208, 0, v208
v_cmp_gt_u32 vcc, 16, v1
v_cvt_pk_bf16_f32 v206, v213, v204
v_cvt_pk_bf16_f32 v210, v217, v208
v_lshlrev_b32 v76, 16, v206
v_lshlrev_b32 v77, 16, v210
v_cndmask_b32 v68, 0, v206, vcc
v_mov_b32 v69, 0
v_mov_b32 v70, 0
v_mov_b32 v71, v68
v_cndmask_b32 v72, 0, v210, vcc
v_mov_b32 v73, 0
v_mov_b32 v74, 0
v_mov_b32 v75, v72
v_rcp_f32 v58, v76
v_rcp_f32 v59, v77
v_and_b32 v2, 48, v1
v_add_u32 v3, 0, v2
v_add_u32 v4, 4, v2
v_add_u32 v5, 8, v2
v_add_u32 v6, 12, v2
ds_bpermute_b32 v60, v3, v58
ds_bpermute_b32 v61, v4, v58
ds_bpermute_b32 v62, v5, v58
ds_bpermute_b32 v63, v6, v58
ds_bpermute_b32 v64, v3, v59
ds_bpermute_b32 v65, v4, v59
ds_bpermute_b32 v66, v5, v59
ds_bpermute_b32 v67, v6, v59
s_waitcnt vmcnt(0)
v_cmp_lt_u32 vcc, v51, v50
s_cbranch_vccnz pl_1_slow
pl_1_ok:
s_waitcnt lgkmcnt(0)
s_barrier
v_lshlrev_b32 v2, 4, v0
s_mov_b32 s78, 0x80000
buffer_load_dwordx4 v[80:83], v2, s[60:63], s78 offen sc1
s_mov_b32 s78, 0x82000
buffer_load_dwordx4 v[84:87], v2, s[60:63], s78 offen sc1
s_mov_b32 s78, 0x84000
buffer_load_dwordx4 v[88:91], v2, s[60:63], s78 offen sc1
s_mov_b32 s78, 0x86000
buffer_load_dwordx4 v[92:95], v2, s[60:63], s78 offen sc1
s_mov_b32 s78, 0x81000
buffer_load_dwordx4 v[96:99], v2, s[60:63], s78 offen sc1
s_mov_b32 s78, 0x83000
buffer_load_dwordx4 v[100:103], v2, s[60:63], s78 offen sc1
s_mov_b32 s78, 0x85000
buffer_load_dwordx4 v[104:107], v2, s[60:63], s78 offen sc1
s_mov_b32 s78, 0x87000
buffer_load_dwordx4 v[108:111], v2, s[60:63], s78 offen sc1
s_add_u32 m0, s76, 0
s_add_u32 s77, s82, 0x800
buffer_load_dwordx4 v22, s[32:35], s77 offen offset:0 lds
buffer_load_dwordx4 v23, s[32:35], s77 offen offset:1024 lds
buffer_load_dwordx4 v24, s[32:35], s77 offen offset:2048 lds
buffer_load_dwordx4 v25, s[32:35], s77 offen offset:3072 lds
s_add_u32 m0, s76, 4096
s_add_u32 s77, s82, 0xc0800
buffer_load_dwordx4 v22, s[32:35], s77 offen offset:0 lds
buffer_load_dwordx4 v23, s[32:35], s77 offen offset:1024 lds
buffer_load_dwordx4 v24, s[32:35], s77 offen offset:2048 lds
buffer_load_dwordx4 v25, s[32:35], s77 offen offset:3072 lds
v_and_b32 v2, 15, v1
v_lshrrev_b32 v3, 4, v1
v_lshlrev_b32 v3, 2, v3
v_sub_u32 v3, v2, v3
s_mov_b32 s78, 0x80000001
v_sub_u32 v4, -2, v3
v_and_b32 v4, s78, v4
v_cmp_eq_u32 s[4:5], 0, v4
v_subrev_u32 v4, 0, v3
v_and_b32 v4, s78, v4
v_cmp_eq_u32 s[12:13], 0, v4
v_sub_u32 v4, -1, v3
v_and_b32 v4, s78, v4
v_cmp_eq_u32 s[6:7], 0, v4
v_subrev_u32 v4, 1, v3
v_and_b32 v4, s78, v4
v_cmp_eq_u32 s[14:15], 0, v4
v_sub_u32 v4, 0, v3
v_and_b32 v4, s78, v4
v_cmp_eq_u32 s[8:9], 0, v4
v_subrev_u32 v4, 2, v3
v_and_b32 v4, s78, v4
v_cmp_eq_u32 s[16:17], 0, v4
v_sub_u32 v4, 1, v3
v_and_b32 v4, s78, v4
v_cmp_eq_u32 s[10:11], 0, v4
v_subrev_u32 v4, 3, v3
v_and_b32 v4, s78, v4
v_cmp_eq_u32 s[18:19], 0, v4
s_cmp_eq_u32 s88, 0
s_cselect_b64 s[20:21], 0, s[4:5]
s_cselect_b64 s[22:23], 0, s[6:7]
s_cselect_b64 s[24:25], 0, s[8:9]
s_cselect_b64 s[26:27], 0, s[10:11]
v_lshrrev_b32 v2, 3, v0
v_bfe_u32 v3, v0, 1, 2
v_and_b32 v4, 1, v0
v_mul_u32_u24 v5, 272, v2
v_lshl_add_u32 v5, v3, 6, v5
v_lshl_add_u32 v5, v4, 3, v5
v_add_u32 v5, 131072, v5
v_lshlrev_b32 v6, 7, v2
v_lshl_add_u32 v6, v3, 5, v6
v_lshl_add_u32 v6, v4, 2, v6
v_add_u32 v6, 139776, v6
v_mov_b32 v113, 0
v_mov_b32 v115, 0
v_mov_b32 v116, 0
v_mov_b32 v118, 0
s_waitcnt vmcnt(14)
v_pk_add_f32 v[80:81], v[80:81], v[84:85]
s_waitcnt vmcnt(12)
v_pk_add_f32 v[88:89], v[88:89], v[92:93]
v_pk_add_f32 v[82:83], v[82:83], v[86:87]
v_pk_add_f32 v[90:91], v[90:91], v[94:95]
v_pk_add_f32 v[80:81], v[80:81], v[88:89]
v_pk_add_f32 v[82:83], v[82:83], v[90:91]
s_waitcnt vmcnt(10)
v_pk_add_f32 v[96:97], v[96:97], v[100:101]
s_waitcnt vmcnt(8)
v_pk_add_f32 v[104:105], v[104:105], v[108:109]
v_pk_add_f32 v[98:99], v[98:99], v[102:103]
v_pk_add_f32 v[106:107], v[106:107], v[110:111]
v_pk_add_f32 v[96:97], v[96:97], v[104:105]
v_pk_add_f32 v[98:99], v[98:99], v[106:107]
v_cvt_pk_bf16_f32 v100, v96, v97
v_cvt_pk_bf16_f32 v102, v98, v99
v_lshlrev_b32 v96, 16, v100
v_and_b32 v97, 0xffff0000, v100
v_lshlrev_b32 v98, 16, v102
v_and_b32 v99, 0xffff0000, v102
v_add_f32 v96, 1.0, v96
v_add_f32 v97, 1.0, v97
v_add_f32 v98, 1.0, v98
v_add_f32 v99, 1.0, v99
v_cvt_pk_bf16_f32 v120, v80, v96
v_cvt_pk_bf16_f32 v121, v81, v97
v_cvt_pk_bf16_f32 v122, v82, v98
v_cvt_pk_bf16_f32 v123, v83, v99
v_lshrrev_b32 v112, 16, v120
v_and_b32 v114, 0xffff0000, v121
v_lshrrev_b32 v117, 16, v122
v_and_b32 v119, 0xffff0000, v123
ds_write_b64 v5, v[112:113] offset:0
ds_write_b64 v5, v[114:115] offset:16
ds_write_b64 v5, v[116:117] offset:32
ds_write_b64 v5, v[118:119] offset:48
ds_write2_b32 v6, v120, v121 offset0:0 offset1:2
ds_write2_b32 v6, v122, v123 offset0:4 offset1:6
s_waitcnt lgkmcnt(0)
s_barrier
v_and_b32 v2, 15, v1
v_lshrrev_b32 v3, 2, v2
v_lshrrev_b32 v4, 4, v1
v_cmp_eq_u32 vcc, v3, v4
v_lshlrev_b32 v3, 4, v2
v_mov_b32 v4, 256
v_cndmask_b32 v3, v4, v3, vcc
v_add_u32 v53, 131072, v3
v_lshlrev_b32 v2, 3, v2
v_add_u32 v54, 139776, v2
ds_read_b128 v[128:131], v53 offset:0
ds_read_b64 v[132:133], v54 offset:0
ds_read_b128 v[136:139], v53 offset:272
ds_read_b64 v[140:141], v54 offset:128
ds_read_b128 v[144:147], v53 offset:544
ds_read_b64 v[148:149], v54 offset:256
s_waitcnt lgkmcnt(4)
v_mfma_f32_16x16x16_bf16 v[160:163], v[132:133], v[68:69], 0
v_mfma_f32_16x16x16_bf16 v[164:167], v[132:133], v[70:71], 0
ds_read_b128 v[152:155], v53 offset:816
v_mfma_f32_16x16x16_bf16 v[160:163], v[128:129], a[0:1], v[160:163]
v_mfma_f32_16x16x16_bf16 v[164:167], v[130:131], a[2:3], v[164:167]
s_add_u32 m0, s76, 32768
s_add_u32 s77, s82, 0x180800
buffer_load_dwordx4 v22, s[32:35], s77 offen offset:0 lds
buffer_load_dwordx4 v23, s[32:35], s77 offen offset:1024 lds
buffer_load_dwordx4 v24, s[32:35], s77 offen offset:2048 lds
buffer_load_dwordx4 v25, s[32:35], s77 offen offset:3072 lds
v_mfma_f32_16x16x16_bf16 v[168:171], v[132:133], v[72:73], 0
v_mfma_f32_16x16x16_bf16 v[172:175], v[132:133], v[74:75], 0
ds_read_b64 v[156:157], v54 offset:384
v_mfma_f32_16x16x16_bf16 v[168:171], v[128:129], a[4:5], v[168:171]
v_mfma_f32_16x16x16_bf16 v[172:175], v[130:131], a[6:7], v[172:175]
s_waitcnt lgkmcnt(4)
v_mfma_f32_16x16x16_bf16 v[176:179], v[140:141], v[68:69], 0
v_cvt_pk_bf16_f32 v160, v160, v161
v_cvt_pk_bf16_f32 v161, v162, v163
v_mfma_f32_16x16x16_bf16 v[180:183], v[140:141], v[70:71], 0
v_cvt_pk_bf16_f32 v164, v164, v165
v_cvt_pk_bf16_f32 v165, v166, v167
ds_read_b128 v[128:131], v53 offset:1088
v_mfma_f32_16x16x16_bf16 v[176:179], v[136:137], a[8:9], v[176:179]
v_accvgpr_write_b32 a0, v160
v_accvgpr_write_b32 a1, v161
v_mfma_f32_16x16x16_bf16 v[180:183], v[138:139], a[10:11], v[180:183]
v_accvgpr_write_b32 a2, v164
v_accvgpr_write_b32 a3, v165
s_add_u32 m0, s76, 36864
s_add_u32 s77, s82, 0x240800
buffer_load_dwordx4 v22, s[32:35], s77 offen offset:0 lds
buffer_load_dwordx4 v23, s[32:35], s77 offen offset:1024 lds
buffer_load_dwordx4 v24, s[32:35], s77 offen offset:2048 lds
buffer_load_dwordx4 v25, s[32:35], s77 offen offset:3072 lds
v_mfma_f32_16x16x16_bf16 v[184:187], v[140:141], v[72:73], 0
v_cvt_pk_bf16_f32 v168, v168, v169
v_cvt_pk_bf16_f32 v169, v170, v171
v_mfma_f32_16x16x16_bf16 v[188:191], v[140:141], v[74:75], 0
v_cvt_pk_bf16_f32 v172, v172, v173
v_cvt_pk_bf16_f32 v173, v174, v175
ds_read_b64 v[132:133], v54 offset:512
v_mfma_f32_16x16x16_bf16 v[184:187], v[136:137], a[12:13], v[184:187]
v_accvgpr_write_b32 a4, v168
v_accvgpr_write_b32 a5, v169
v_mfma_f32_16x16x16_bf16 v[188:191], v[138:139], a[14:15], v[188:191]
v_accvgpr_write_b32 a6, v172
v_accvgpr_write_b32 a7, v173
s_waitcnt lgkmcnt(4)
v_mfma_f32_16x16x16_bf16 v[160:163], v[148:149], v[68:69], 0
v_cvt_pk_bf16_f32 v176, v176, v177
v_cvt_pk_bf16_f32 v177, v178, v179
v_mfma_f32_16x16x16_bf16 v[164:167], v[148:149], v[70:71], 0
v_cvt_pk_bf16_f32 v180, v180, v181
v_cvt_pk_bf16_f32 v181, v182, v183
ds_read_b128 v[136:139], v53 offset:1360
v_mfma_f32_16x16x16_bf16 v[160:163], v[144:145], a[16:17], v[160:163]
v_accvgpr_write_b32 a8, v176
v_accvgpr_write_b32 a9, v177
v_mfma_f32_16x16x16_bf16 v[164:167], v[146:147], a[18:19], v[164:167]
v_accvgpr_write_b32 a10, v180
v_accvgpr_write_b32 a11, v181
s_add_u32 m0, s76, 65536
s_add_u32 s77, s82, 0x300800
buffer_load_dwordx4 v22, s[32:35], s77 offen offset:0 lds
buffer_load_dwordx4 v23, s[32:35], s77 offen offset:1024 lds
buffer_load_dwordx4 v24, s[32:35], s77 offen offset:2048 lds
buffer_load_dwordx4 v25, s[32:35], s77 offen offset:3072 lds
v_mfma_f32_16x16x16_bf16 v[168:171], v[148:149], v[72:73], 0
v_cvt_pk_bf16_f32 v184, v184, v185
v_cvt_pk_bf16_f32 v185, v186, v187
v_mfma_f32_16x16x16_bf16 v[172:175], v[148:149], v[74:75], 0
v_cvt_pk_bf16_f32 v188, v188, v189
v_cvt_pk_bf16_f32 v189, v190, v191
ds_read_b64 v[140:141], v54 offset:640
v_mfma_f32_16x16x16_bf16 v[168:171], v[144:145], a[20:21], v[168:171]
v_accvgpr_write_b32 a12, v184
v_accvgpr_write_b32 a13, v185
v_mfma_f32_16x16x16_bf16 v[172:175], v[146:147], a[22:23], v[172:175]
v_accvgpr_write_b32 a14, v188
v_accvgpr_write_b32 a15, v189
s_waitcnt lgkmcnt(4)
v_mfma_f32_16x16x16_bf16 v[176:179], v[156:157], v[68:69], 0
v_cvt_pk_bf16_f32 v160, v160, v161
v_cvt_pk_bf16_f32 v161, v162, v163
v_mfma_f32_16x16x16_bf16 v[180:183], v[156:157], v[70:71], 0
v_cvt_pk_bf16_f32 v164, v164, v165
v_cvt_pk_bf16_f32 v165, v166, v167
ds_read_b128 v[144:147], v53 offset:1632
v_mfma_f32_16x16x16_bf16 v[176:179], v[152:153], a[24:25], v[176:179]
v_accvgpr_write_b32 a16, v160
v_accvgpr_write_b32 a17, v161
v_mfma_f32_16x16x16_bf16 v[180:183], v[154:155], a[26:27], v[180:183]
v_accvgpr_write_b32 a18, v164
v_accvgpr_write_b32 a19, v165
s_add_u32 m0, s76, 69632
s_add_u32 s77, s82, 0x3c0800
buffer_load_dwordx4 v22, s[32:35], s77 offen offset:0 lds
buffer_load_dwordx4 v23, s[32:35], s77 offen offset:1024 lds
buffer_load_dwordx4 v24, s[32:35], s77 offen offset:2048 lds
buffer_load_dwordx4 v25, s[32:35], s77 offen offset:3072 lds
v_mfma_f32_16x16x16_bf16 v[184:187], v[156:157], v[72:73], 0
v_cvt_pk_bf16_f32 v168, v168, v169
v_cvt_pk_bf16_f32 v169, v170, v171
v_mfma_f32_16x16x16_bf16 v[188:191], v[156:157], v[74:75], 0
v_cvt_pk_bf16_f32 v172, v172, v173
v_cvt_pk_bf16_f32 v173, v174, v175
ds_read_b64 v[148:149], v54 offset:768
v_mfma_f32_16x16x16_bf16 v[184:187], v[152:153], a[28:29], v[184:187]
v_accvgpr_write_b32 a20, v168
v_accvgpr_write_b32 a21, v169
v_mfma_f32_16x16x16_bf16 v[188:191], v[154:155], a[30:31], v[188:191]
v_accvgpr_write_b32 a22, v172
v_accvgpr_write_b32 a23, v173
s_waitcnt lgkmcnt(4)
v_mfma_f32_16x16x16_bf16 v[160:163], v[132:133], v[68:69], 0
v_cvt_pk_bf16_f32 v176, v176, v177
v_cvt_pk_bf16_f32 v177, v178, v179
v_mfma_f32_16x16x16_bf16 v[164:167], v[132:133], v[70:71], 0
v_cvt_pk_bf16_f32 v180, v180, v181
v_cvt_pk_bf16_f32 v181, v182, v183
ds_read_b128 v[152:155], v53 offset:1904
v_mfma_f32_16x16x16_bf16 v[160:163], v[128:129], a[32:33], v[160:163]
v_accvgpr_write_b32 a24, v176
v_accvgpr_write_b32 a25, v177
v_mfma_f32_16x16x16_bf16 v[164:167], v[130:131], a[34:35], v[164:167]
v_accvgpr_write_b32 a26, v180
v_accvgpr_write_b32 a27, v181
s_add_u32 s70, s0, S_K_M - K_pc + 0
s_addc_u32 s71, s1, 0
global_load_dword v57, v9, s[70:71]
v_mfma_f32_16x16x16_bf16 v[168:171], v[132:133], v[72:73], 0
v_cvt_pk_bf16_f32 v184, v184, v185
v_cvt_pk_bf16_f32 v185, v186, v187
v_mfma_f32_16x16x16_bf16 v[172:175], v[132:133], v[74:75], 0
v_cvt_pk_bf16_f32 v188, v188, v189
v_cvt_pk_bf16_f32 v189, v190, v191
ds_read_b64 v[156:157], v54 offset:896
v_mfma_f32_16x16x16_bf16 v[168:171], v[128:129], a[36:37], v[168:171]
v_accvgpr_write_b32 a28, v184
v_accvgpr_write_b32 a29, v185
v_mfma_f32_16x16x16_bf16 v[172:175], v[130:131], a[38:39], v[172:175]
v_accvgpr_write_b32 a30, v188
v_accvgpr_write_b32 a31, v189
s_waitcnt lgkmcnt(4)
v_mfma_f32_16x16x16_bf16 v[176:179], v[140:141], v[68:69], 0
v_cvt_pk_bf16_f32 v160, v160, v161
v_cvt_pk_bf16_f32 v161, v162, v163
v_mfma_f32_16x16x16_bf16 v[180:183], v[140:141], v[70:71], 0
v_cvt_pk_bf16_f32 v164, v164, v165
v_cvt_pk_bf16_f32 v165, v166, v167
ds_read_b128 v[128:131], v53 offset:2176
v_mfma_f32_16x16x16_bf16 v[176:179], v[136:137], a[40:41], v[176:179]
v_accvgpr_write_b32 a32, v160
v_accvgpr_write_b32 a33, v161
v_mfma_f32_16x16x16_bf16 v[180:183], v[138:139], a[42:43], v[180:183]
v_accvgpr_write_b32 a34, v164
v_accvgpr_write_b32 a35, v165
v_mfma_f32_16x16x16_bf16 v[184:187], v[140:141], v[72:73], 0
v_cvt_pk_bf16_f32 v168, v168, v169
v_cvt_pk_bf16_f32 v169, v170, v171
v_mfma_f32_16x16x16_bf16 v[188:191], v[140:141], v[74:75], 0
v_cvt_pk_bf16_f32 v172, v172, v173
v_cvt_pk_bf16_f32 v173, v174, v175
ds_read_b64 v[132:133], v54 offset:1024
v_mfma_f32_16x16x16_bf16 v[184:187], v[136:137], a[44:45], v[184:187]
v_accvgpr_write_b32 a36, v168
v_accvgpr_write_b32 a37, v169
v_mfma_f32_16x16x16_bf16 v[188:191], v[138:139], a[46:47], v[188:191]
v_accvgpr_write_b32 a38, v172
v_accvgpr_write_b32 a39, v173
s_waitcnt lgkmcnt(4)
v_mfma_f32_16x16x16_bf16 v[160:163], v[148:149], v[68:69], 0
v_cvt_pk_bf16_f32 v176, v176, v177
v_cvt_pk_bf16_f32 v177, v178, v179
v_mfma_f32_16x16x16_bf16 v[164:167], v[148:149], v[70:71], 0
v_cvt_pk_bf16_f32 v180, v180, v181
v_cvt_pk_bf16_f32 v181, v182, v183
ds_read_b128 v[136:139], v53 offset:2448
v_mfma_f32_16x16x16_bf16 v[160:163], v[144:145], a[48:49], v[160:163]
v_accvgpr_write_b32 a40, v176
v_accvgpr_write_b32 a41, v177
v_mfma_f32_16x16x16_bf16 v[164:167], v[146:147], a[50:51], v[164:167]
v_accvgpr_write_b32 a42, v180
v_accvgpr_write_b32 a43, v181
v_mfma_f32_16x16x16_bf16 v[168:171], v[148:149], v[72:73], 0
v_cvt_pk_bf16_f32 v184, v184, v185
v_cvt_pk_bf16_f32 v185, v186, v187
v_mfma_f32_16x16x16_bf16 v[172:175], v[148:149], v[74:75], 0
v_cvt_pk_bf16_f32 v188, v188, v189
v_cvt_pk_bf16_f32 v189, v190, v191
ds_read_b64 v[140:141], v54 offset:1152
v_mfma_f32_16x16x16_bf16 v[168:171], v[144:145], a[52:53], v[168:171]
v_accvgpr_write_b32 a44, v184
v_accvgpr_write_b32 a45, v185
v_mfma_f32_16x16x16_bf16 v[172:175], v[146:147], a[54:55], v[172:175]
v_accvgpr_write_b32 a46, v188
v_accvgpr_write_b32 a47, v189
s_waitcnt lgkmcnt(4)
v_mfma_f32_16x16x16_bf16 v[176:179], v[156:157], v[68:69], 0
v_cvt_pk_bf16_f32 v160, v160, v161
v_cvt_pk_bf16_f32 v161, v162, v163
v_mfma_f32_16x16x16_bf16 v[180:183], v[156:157], v[70:71], 0
v_cvt_pk_bf16_f32 v164, v164, v165
v_cvt_pk_bf16_f32 v165, v166, v167
ds_read_b128 v[144:147], v53 offset:2720
v_mfma_f32_16x16x16_bf16 v[176:179], v[152:153], a[56:57], v[176:179]
v_accvgpr_write_b32 a48, v160
v_accvgpr_write_b32 a49, v161
v_mfma_f32_16x16x16_bf16 v[180:183], v[154:155], a[58:59], v[180:183]
v_accvgpr_write_b32 a50, v164
v_accvgpr_write_b32 a51, v165
s_mov_b32 s3, 0x0
buffer_load_dword v57, v8, s[32:35], s3 offen
v_mfma_f32_16x16x16_bf16 v[184:187], v[156:157], v[72:73], 0
v_cvt_pk_bf16_f32 v168, v168, v169
v_cvt_pk_bf16_f32 v169, v170, v171
v_mfma_f32_16x16x16_bf16 v[188:191], v[156:157], v[74:75], 0
v_cvt_pk_bf16_f32 v172, v172, v173
v_cvt_pk_bf16_f32 v173, v174, v175
ds_read_b64 v[148:149], v54 offset:1280
v_mfma_f32_16x16x16_bf16 v[184:187], v[152:153], a[60:61], v[184:187]
v_accvgpr_write_b32 a52, v168
v_accvgpr_write_b32 a53, v169
v_mfma_f32_16x16x16_bf16 v[188:191], v[154:155], a[62:63], v[188:191]
v_accvgpr_write_b32 a54, v172
v_accvgpr_write_b32 a55, v173
s_waitcnt lgkmcnt(4)
v_mfma_f32_16x16x16_bf16 v[160:163], v[132:133], v[68:69], 0
v_cvt_pk_bf16_f32 v176, v176, v177
v_cvt_pk_bf16_f32 v177, v178, v179
v_mfma_f32_16x16x16_bf16 v[164:167], v[132:133], v[70:71], 0
v_cvt_pk_bf16_f32 v180, v180, v181
v_cvt_pk_bf16_f32 v181, v182, v183
ds_read_b128 v[152:155], v53 offset:2992
v_mfma_f32_16x16x16_bf16 v[160:163], v[128:129], a[64:65], v[160:163]
v_accvgpr_write_b32 a56, v176
v_accvgpr_write_b32 a57, v177
v_mfma_f32_16x16x16_bf16 v[164:167], v[130:131], a[66:67], v[164:167]
v_accvgpr_write_b32 a58, v180
v_accvgpr_write_b32 a59, v181
v_mfma_f32_16x16x16_bf16 v[168:171], v[132:133], v[72:73], 0
v_cvt_pk_bf16_f32 v184, v184, v185
v_cvt_pk_bf16_f32 v185, v186, v187
v_mfma_f32_16x16x16_bf16 v[172:175], v[132:133], v[74:75], 0
v_cvt_pk_bf16_f32 v188, v188, v189
v_cvt_pk_bf16_f32 v189, v190, v191
ds_read_b64 v[156:157], v54 offset:1408
v_mfma_f32_16x16x16_bf16 v[168:171], v[128:129], a[68:69], v[168:171]
v_accvgpr_write_b32 a60, v184
v_accvgpr_write_b32 a61, v185
v_mfma_f32_16x16x16_bf16 v[172:175], v[130:131], a[70:71], v[172:175]
v_accvgpr_write_b32 a62, v188
v_accvgpr_write_b32 a63, v189
s_waitcnt lgkmcnt(4)
v_mfma_f32_16x16x16_bf16 v[176:179], v[140:141], v[68:69], 0
v_cvt_pk_bf16_f32 v160, v160, v161
v_cvt_pk_bf16_f32 v161, v162, v163
v_mfma_f32_16x16x16_bf16 v[180:183], v[140:141], v[70:71], 0
v_cvt_pk_bf16_f32 v164, v164, v165
v_cvt_pk_bf16_f32 v165, v166, v167
ds_read_b128 v[128:131], v53 offset:3264
v_mfma_f32_16x16x16_bf16 v[176:179], v[136:137], a[72:73], v[176:179]
v_accvgpr_write_b32 a64, v160
v_accvgpr_write_b32 a65, v161
v_mfma_f32_16x16x16_bf16 v[180:183], v[138:139], a[74:75], v[180:183]
v_accvgpr_write_b32 a66, v164
v_accvgpr_write_b32 a67, v165
v_mfma_f32_16x16x16_bf16 v[184:187], v[140:141], v[72:73], 0
v_cvt_pk_bf16_f32 v168, v168, v169
v_cvt_pk_bf16_f32 v169, v170, v171
v_mfma_f32_16x16x16_bf16 v[188:191], v[140:141], v[74:75], 0
v_cvt_pk_bf16_f32 v172, v172, v173
v_cvt_pk_bf16_f32 v173, v174, v175
ds_read_b64 v[132:133], v54 offset:1536
v_mfma_f32_16x16x16_bf16 v[184:187], v[136:137], a[76:77], v[184:187]
v_accvgpr_write_b32 a68, v168
v_accvgpr_write_b32 a69, v169
v_mfma_f32_16x16x16_bf16 v[188:191], v[138:139], a[78:79], v[188:191]
v_accvgpr_write_b32 a70, v172
v_accvgpr_write_b32 a71, v173
s_waitcnt lgkmcnt(4)
v_mfma_f32_16x16x16_bf16 v[160:163], v[148:149], v[68:69], 0
v_cvt_pk_bf16_f32 v176, v176, v177
v_cvt_pk_bf16_f32 v177, v178, v179
v_mfma_f32_16x16x16_bf16 v[164:167], v[148:149], v[70:71], 0
v_cvt_pk_bf16_f32 v180, v180, v181
v_cvt_pk_bf16_f32 v181, v182, v183
ds_read_b128 v[136:139], v53 offset:3536
v_mfma_f32_16x16x16_bf16 v[160:163], v[144:145], a[80:81], v[160:163]
v_accvgpr_write_b32 a72, v176
v_accvgpr_write_b32 a73, v177
v_mfma_f32_16x16x16_bf16 v[164:167], v[146:147], a[82:83], v[164:167]
v_accvgpr_write_b32 a74, v180
v_accvgpr_write_b32 a75, v181
s_mov_b32 s3, 0x200000
buffer_load_dword v57, v8, s[32:35], s3 offen
v_mfma_f32_16x16x16_bf16 v[168:171], v[148:149], v[72:73], 0
v_cvt_pk_bf16_f32 v184, v184, v185
v_cvt_pk_bf16_f32 v185, v186, v187
v_mfma_f32_16x16x16_bf16 v[172:175], v[148:149], v[74:75], 0
v_cvt_pk_bf16_f32 v188, v188, v189
v_cvt_pk_bf16_f32 v189, v190, v191
ds_read_b64 v[140:141], v54 offset:1664
v_mfma_f32_16x16x16_bf16 v[168:171], v[144:145], a[84:85], v[168:171]
v_accvgpr_write_b32 a76, v184
v_accvgpr_write_b32 a77, v185
v_mfma_f32_16x16x16_bf16 v[172:175], v[146:147], a[86:87], v[172:175]
v_accvgpr_write_b32 a78, v188
v_accvgpr_write_b32 a79, v189
s_waitcnt lgkmcnt(4)
v_mfma_f32_16x16x16_bf16 v[176:179], v[156:157], v[68:69], 0
v_cvt_pk_bf16_f32 v160, v160, v161
v_cvt_pk_bf16_f32 v161, v162, v163
v_mfma_f32_16x16x16_bf16 v[180:183], v[156:157], v[70:71], 0
v_cvt_pk_bf16_f32 v164, v164, v165
v_cvt_pk_bf16_f32 v165, v166, v167
ds_read_b128 v[144:147], v53 offset:3808
v_mfma_f32_16x16x16_bf16 v[176:179], v[152:153], a[88:89], v[176:179]
v_accvgpr_write_b32 a80, v160
v_accvgpr_write_b32 a81, v161
v_mfma_f32_16x16x16_bf16 v[180:183], v[154:155], a[90:91], v[180:183]
v_accvgpr_write_b32 a82, v164
v_accvgpr_write_b32 a83, v165
v_mfma_f32_16x16x16_bf16 v[184:187], v[156:157], v[72:73], 0
v_cvt_pk_bf16_f32 v168, v168, v169
v_cvt_pk_bf16_f32 v169, v170, v171
v_mfma_f32_16x16x16_bf16 v[188:191], v[156:157], v[74:75], 0
v_cvt_pk_bf16_f32 v172, v172, v173
v_cvt_pk_bf16_f32 v173, v174, v175
ds_read_b64 v[148:149], v54 offset:1792
v_mfma_f32_16x16x16_bf16 v[184:187], v[152:153], a[92:93], v[184:187]
v_accvgpr_write_b32 a84, v168
v_accvgpr_write_b32 a85, v169
v_mfma_f32_16x16x16_bf16 v[188:191], v[154:155], a[94:95], v[188:191]
v_accvgpr_write_b32 a86, v172
v_accvgpr_write_b32 a87, v173
s_waitcnt lgkmcnt(4)
v_mfma_f32_16x16x16_bf16 v[160:163], v[132:133], v[68:69], 0
v_cvt_pk_bf16_f32 v176, v176, v177
v_cvt_pk_bf16_f32 v177, v178, v179
v_mfma_f32_16x16x16_bf16 v[164:167], v[132:133], v[70:71], 0
v_cvt_pk_bf16_f32 v180, v180, v181
v_cvt_pk_bf16_f32 v181, v182, v183
ds_read_b128 v[152:155], v53 offset:4080
v_mfma_f32_16x16x16_bf16 v[160:163], v[128:129], a[96:97], v[160:163]
v_accvgpr_write_b32 a88, v176
v_accvgpr_write_b32 a89, v177
v_mfma_f32_16x16x16_bf16 v[164:167], v[130:131], a[98:99], v[164:167]
v_accvgpr_write_b32 a90, v180
v_accvgpr_write_b32 a91, v181
v_mfma_f32_16x16x16_bf16 v[168:171], v[132:133], v[72:73], 0
v_cvt_pk_bf16_f32 v184, v184, v185
v_cvt_pk_bf16_f32 v185, v186, v187
v_mfma_f32_16x16x16_bf16 v[172:175], v[132:133], v[74:75], 0
v_cvt_pk_bf16_f32 v188, v188, v189
v_cvt_pk_bf16_f32 v189, v190, v191
ds_read_b64 v[156:157], v54 offset:1920
v_mfma_f32_16x16x16_bf16 v[168:171], v[128:129], a[100:101], v[168:171]
v_accvgpr_write_b32 a92, v184
v_accvgpr_write_b32 a93, v185
v_mfma_f32_16x16x16_bf16 v[172:175], v[130:131], a[102:103], v[172:175]
v_accvgpr_write_b32 a94, v188
v_accvgpr_write_b32 a95, v189
s_waitcnt lgkmcnt(4)
v_mfma_f32_16x16x16_bf16 v[176:179], v[140:141], v[68:69], 0
v_cvt_pk_bf16_f32 v160, v160, v161
v_cvt_pk_bf16_f32 v161, v162, v163
v_mfma_f32_16x16x16_bf16 v[180:183], v[140:141], v[70:71], 0
v_cvt_pk_bf16_f32 v164, v164, v165
v_cvt_pk_bf16_f32 v165, v166, v167
ds_read_b128 v[128:131], v53 offset:4352
v_mfma_f32_16x16x16_bf16 v[176:179], v[136:137], a[104:105], v[176:179]
v_accvgpr_write_b32 a96, v160
v_accvgpr_write_b32 a97, v161
v_mfma_f32_16x16x16_bf16 v[180:183], v[138:139], a[106:107], v[180:183]
v_accvgpr_write_b32 a98, v164
v_accvgpr_write_b32 a99, v165
s_mov_b32 s3, 0x400000
buffer_load_dword v57, v8, s[32:35], s3 offen
v_mfma_f32_16x16x16_bf16 v[184:187], v[140:141], v[72:73], 0
v_cvt_pk_bf16_f32 v168, v168, v169
v_cvt_pk_bf16_f32 v169, v170, v171
v_mfma_f32_16x16x16_bf16 v[188:191], v[140:141], v[74:75], 0
v_cvt_pk_bf16_f32 v172, v172, v173
v_cvt_pk_bf16_f32 v173, v174, v175
ds_read_b64 v[132:133], v54 offset:2048
v_mfma_f32_16x16x16_bf16 v[184:187], v[136:137], a[108:109], v[184:187]
v_accvgpr_write_b32 a100, v168
v_accvgpr_write_b32 a101, v169
v_mfma_f32_16x16x16_bf16 v[188:191], v[138:139], a[110:111], v[188:191]
v_accvgpr_write_b32 a102, v172
v_accvgpr_write_b32 a103, v173
s_waitcnt lgkmcnt(4)
v_mfma_f32_16x16x16_bf16 v[160:163], v[148:149], v[68:69], 0
v_cvt_pk_bf16_f32 v176, v176, v177
v_cvt_pk_bf16_f32 v177, v178, v179
v_mfma_f32_16x16x16_bf16 v[164:167], v[148:149], v[70:71], 0
v_cvt_pk_bf16_f32 v180, v180, v181
v_cvt_pk_bf16_f32 v181, v182, v183
ds_read_b128 v[136:139], v53 offset:4624
v_mfma_f32_16x16x16_bf16 v[160:163], v[144:145], a[112:113], v[160:163]
v_accvgpr_write_b32 a104, v176
v_accvgpr_write_b32 a105, v177
v_mfma_f32_16x16x16_bf16 v[164:167], v[146:147], a[114:115], v[164:167]
v_accvgpr_write_b32 a106, v180
v_accvgpr_write_b32 a107, v181
v_mfma_f32_16x16x16_bf16 v[168:171], v[148:149], v[72:73], 0
v_cvt_pk_bf16_f32 v184, v184, v185
v_cvt_pk_bf16_f32 v185, v186, v187
v_mfma_f32_16x16x16_bf16 v[172:175], v[148:149], v[74:75], 0
v_cvt_pk_bf16_f32 v188, v188, v189
v_cvt_pk_bf16_f32 v189, v190, v191
ds_read_b64 v[140:141], v54 offset:2176
v_mfma_f32_16x16x16_bf16 v[168:171], v[144:145], a[116:117], v[168:171]
v_accvgpr_write_b32 a108, v184
v_accvgpr_write_b32 a109, v185
v_mfma_f32_16x16x16_bf16 v[172:175], v[146:147], a[118:119], v[172:175]
v_accvgpr_write_b32 a110, v188
v_accvgpr_write_b32 a111, v189
s_waitcnt lgkmcnt(4)
v_mfma_f32_16x16x16_bf16 v[176:179], v[156:157], v[68:69], 0
v_cvt_pk_bf16_f32 v160, v160, v161
v_cvt_pk_bf16_f32 v161, v162, v163
v_mfma_f32_16x16x16_bf16 v[180:183], v[156:157], v[70:71], 0
v_cvt_pk_bf16_f32 v164, v164, v165
v_cvt_pk_bf16_f32 v165, v166, v167
ds_read_b128 v[144:147], v53 offset:4896
v_mfma_f32_16x16x16_bf16 v[176:179], v[152:153], a[120:121], v[176:179]
v_accvgpr_write_b32 a112, v160
v_accvgpr_write_b32 a113, v161
v_mfma_f32_16x16x16_bf16 v[180:183], v[154:155], a[122:123], v[180:183]
v_accvgpr_write_b32 a114, v164
v_accvgpr_write_b32 a115, v165
v_mfma_f32_16x16x16_bf16 v[184:187], v[156:157], v[72:73], 0
v_cvt_pk_bf16_f32 v168, v168, v169
v_cvt_pk_bf16_f32 v169, v170, v171
v_mfma_f32_16x16x16_bf16 v[188:191], v[156:157], v[74:75], 0
v_cvt_pk_bf16_f32 v172, v172, v173
v_cvt_pk_bf16_f32 v173, v174, v175
ds_read_b64 v[148:149], v54 offset:2304
v_mfma_f32_16x16x16_bf16 v[184:187], v[152:153], a[124:125], v[184:187]
v_accvgpr_write_b32 a116, v168
v_accvgpr_write_b32 a117, v169
v_mfma_f32_16x16x16_bf16 v[188:191], v[154:155], a[126:127], v[188:191]
v_accvgpr_write_b32 a118, v172
v_accvgpr_write_b32 a119, v173
s_waitcnt lgkmcnt(4)
v_mfma_f32_16x16x16_bf16 v[160:163], v[132:133], v[68:69], 0
v_cvt_pk_bf16_f32 v176, v176, v177
v_cvt_pk_bf16_f32 v177, v178, v179
v_mfma_f32_16x16x16_bf16 v[164:167], v[132:133], v[70:71], 0
v_cvt_pk_bf16_f32 v180, v180, v181
v_cvt_pk_bf16_f32 v181, v182, v183
ds_read_b128 v[152:155], v53 offset:5168
v_mfma_f32_16x16x16_bf16 v[160:163], v[128:129], a[128:129], v[160:163]
v_accvgpr_write_b32 a120, v176
v_accvgpr_write_b32 a121, v177
v_mfma_f32_16x16x16_bf16 v[164:167], v[130:131], a[130:131], v[164:167]
v_accvgpr_write_b32 a122, v180
v_accvgpr_write_b32 a123, v181
s_mov_b32 s3, 0x0
buffer_load_dword v57, v8, s[36:39], s3 offen
v_mfma_f32_16x16x16_bf16 v[168:171], v[132:133], v[72:73], 0
v_cvt_pk_bf16_f32 v184, v184, v185
v_cvt_pk_bf16_f32 v185, v186, v187
v_mfma_f32_16x16x16_bf16 v[172:175], v[132:133], v[74:75], 0
v_cvt_pk_bf16_f32 v188, v188, v189
v_cvt_pk_bf16_f32 v189, v190, v191
ds_read_b64 v[156:157], v54 offset:2432
v_mfma_f32_16x16x16_bf16 v[168:171], v[128:129], a[132:133], v[168:171]
v_accvgpr_write_b32 a124, v184
v_accvgpr_write_b32 a125, v185
v_mfma_f32_16x16x16_bf16 v[172:175], v[130:131], a[134:135], v[172:175]
v_accvgpr_write_b32 a126, v188
v_accvgpr_write_b32 a127, v189
s_waitcnt lgkmcnt(4)
v_mfma_f32_16x16x16_bf16 v[176:179], v[140:141], v[68:69], 0
v_cvt_pk_bf16_f32 v160, v160, v161
v_cvt_pk_bf16_f32 v161, v162, v163
v_mfma_f32_16x16x16_bf16 v[180:183], v[140:141], v[70:71], 0
v_cvt_pk_bf16_f32 v164, v164, v165
v_cvt_pk_bf16_f32 v165, v166, v167
ds_read_b128 v[128:131], v53 offset:5440
v_mfma_f32_16x16x16_bf16 v[176:179], v[136:137], a[136:137], v[176:179]
v_accvgpr_write_b32 a128, v160
v_accvgpr_write_b32 a129, v161
v_mfma_f32_16x16x16_bf16 v[180:183], v[138:139], a[138:139], v[180:183]
v_accvgpr_write_b32 a130, v164
v_accvgpr_write_b32 a131, v165
v_mfma_f32_16x16x16_bf16 v[184:187], v[140:141], v[72:73], 0
v_cvt_pk_bf16_f32 v168, v168, v169
v_cvt_pk_bf16_f32 v169, v170, v171
v_mfma_f32_16x16x16_bf16 v[188:191], v[140:141], v[74:75], 0
v_cvt_pk_bf16_f32 v172, v172, v173
v_cvt_pk_bf16_f32 v173, v174, v175
ds_read_b64 v[132:133], v54 offset:2560
v_mfma_f32_16x16x16_bf16 v[184:187], v[136:137], a[140:141], v[184:187]
v_accvgpr_write_b32 a132, v168
v_accvgpr_write_b32 a133, v169
v_mfma_f32_16x16x16_bf16 v[188:191], v[138:139], a[142:143], v[188:191]
v_accvgpr_write_b32 a134, v172
v_accvgpr_write_b32 a135, v173
s_waitcnt lgkmcnt(4)
v_mfma_f32_16x16x16_bf16 v[160:163], v[148:149], v[68:69], 0
v_cvt_pk_bf16_f32 v176, v176, v177
v_cvt_pk_bf16_f32 v177, v178, v179
v_mfma_f32_16x16x16_bf16 v[164:167], v[148:149], v[70:71], 0
v_cvt_pk_bf16_f32 v180, v180, v181
v_cvt_pk_bf16_f32 v181, v182, v183
ds_read_b128 v[136:139], v53 offset:5712
v_mfma_f32_16x16x16_bf16 v[160:163], v[144:145], a[144:145], v[160:163]
v_accvgpr_write_b32 a136, v176
v_accvgpr_write_b32 a137, v177
v_mfma_f32_16x16x16_bf16 v[164:167], v[146:147], a[146:147], v[164:167]
v_accvgpr_write_b32 a138, v180
v_accvgpr_write_b32 a139, v181
v_mfma_f32_16x16x16_bf16 v[168:171], v[148:149], v[72:73], 0
v_cvt_pk_bf16_f32 v184, v184, v185
v_cvt_pk_bf16_f32 v185, v186, v187
v_mfma_f32_16x16x16_bf16 v[172:175], v[148:149], v[74:75], 0
v_cvt_pk_bf16_f32 v188, v188, v189
v_cvt_pk_bf16_f32 v189, v190, v191
ds_read_b64 v[140:141], v54 offset:2688
v_mfma_f32_16x16x16_bf16 v[168:171], v[144:145], a[148:149], v[168:171]
v_accvgpr_write_b32 a140, v184
v_accvgpr_write_b32 a141, v185
v_mfma_f32_16x16x16_bf16 v[172:175], v[146:147], a[150:151], v[172:175]
v_accvgpr_write_b32 a142, v188
v_accvgpr_write_b32 a143, v189
s_waitcnt lgkmcnt(4)
v_mfma_f32_16x16x16_bf16 v[176:179], v[156:157], v[68:69], 0
v_cvt_pk_bf16_f32 v160, v160, v161
v_cvt_pk_bf16_f32 v161, v162, v163
v_mfma_f32_16x16x16_bf16 v[180:183], v[156:157], v[70:71], 0
v_cvt_pk_bf16_f32 v164, v164, v165
v_cvt_pk_bf16_f32 v165, v166, v167
ds_read_b128 v[144:147], v53 offset:5984
v_mfma_f32_16x16x16_bf16 v[176:179], v[152:153], a[152:153], v[176:179]
v_accvgpr_write_b32 a144, v160
v_accvgpr_write_b32 a145, v161
v_mfma_f32_16x16x16_bf16 v[180:183], v[154:155], a[154:155], v[180:183]
v_accvgpr_write_b32 a146, v164
v_accvgpr_write_b32 a147, v165
v_mfma_f32_16x16x16_bf16 v[184:187], v[156:157], v[72:73], 0
v_cvt_pk_bf16_f32 v168, v168, v169
v_cvt_pk_bf16_f32 v169, v170, v171
v_mfma_f32_16x16x16_bf16 v[188:191], v[156:157], v[74:75], 0
v_cvt_pk_bf16_f32 v172, v172, v173
v_cvt_pk_bf16_f32 v173, v174, v175
ds_read_b64 v[148:149], v54 offset:2816
v_mfma_f32_16x16x16_bf16 v[184:187], v[152:153], a[156:157], v[184:187]
v_accvgpr_write_b32 a148, v168
v_accvgpr_write_b32 a149, v169
v_mfma_f32_16x16x16_bf16 v[188:191], v[154:155], a[158:159], v[188:191]
v_accvgpr_write_b32 a150, v172
v_accvgpr_write_b32 a151, v173
s_waitcnt lgkmcnt(4)
v_mfma_f32_16x16x16_bf16 v[160:163], v[132:133], v[68:69], 0
v_cvt_pk_bf16_f32 v176, v176, v177
v_cvt_pk_bf16_f32 v177, v178, v179
v_mfma_f32_16x16x16_bf16 v[164:167], v[132:133], v[70:71], 0
v_cvt_pk_bf16_f32 v180, v180, v181
v_cvt_pk_bf16_f32 v181, v182, v183
ds_read_b128 v[152:155], v53 offset:6256
v_mfma_f32_16x16x16_bf16 v[160:163], v[128:129], a[160:161], v[160:163]
v_accvgpr_write_b32 a152, v176
v_accvgpr_write_b32 a153, v177
v_mfma_f32_16x16x16_bf16 v[164:167], v[130:131], a[162:163], v[164:167]
v_accvgpr_write_b32 a154, v180
v_accvgpr_write_b32 a155, v181
v_mfma_f32_16x16x16_bf16 v[168:171], v[132:133], v[72:73], 0
v_cvt_pk_bf16_f32 v184, v184, v185
v_cvt_pk_bf16_f32 v185, v186, v187
v_mfma_f32_16x16x16_bf16 v[172:175], v[132:133], v[74:75], 0
v_cvt_pk_bf16_f32 v188, v188, v189
v_cvt_pk_bf16_f32 v189, v190, v191
ds_read_b64 v[156:157], v54 offset:2944
v_mfma_f32_16x16x16_bf16 v[168:171], v[128:129], a[164:165], v[168:171]
v_accvgpr_write_b32 a156, v184
v_accvgpr_write_b32 a157, v185
v_mfma_f32_16x16x16_bf16 v[172:175], v[130:131], a[166:167], v[172:175]
v_accvgpr_write_b32 a158, v188
v_accvgpr_write_b32 a159, v189
s_waitcnt lgkmcnt(4)
v_mfma_f32_16x16x16_bf16 v[176:179], v[140:141], v[68:69], 0
v_cvt_pk_bf16_f32 v160, v160, v161
v_cvt_pk_bf16_f32 v161, v162, v163
v_mfma_f32_16x16x16_bf16 v[180:183], v[140:141], v[70:71], 0
v_cvt_pk_bf16_f32 v164, v164, v165
v_cvt_pk_bf16_f32 v165, v166, v167
ds_read_b128 v[128:131], v53 offset:6528
v_mfma_f32_16x16x16_bf16 v[176:179], v[136:137], a[168:169], v[176:179]
v_accvgpr_write_b32 a160, v160
v_accvgpr_write_b32 a161, v161
v_mfma_f32_16x16x16_bf16 v[180:183], v[138:139], a[170:171], v[180:183]
v_accvgpr_write_b32 a162, v164
v_accvgpr_write_b32 a163, v165
v_mfma_f32_16x16x16_bf16 v[184:187], v[140:141], v[72:73], 0
v_cvt_pk_bf16_f32 v168, v168, v169
v_cvt_pk_bf16_f32 v169, v170, v171
v_mfma_f32_16x16x16_bf16 v[188:191], v[140:141], v[74:75], 0
v_cvt_pk_bf16_f32 v172, v172, v173
v_cvt_pk_bf16_f32 v173, v174, v175
ds_read_b64 v[132:133], v54 offset:3072
v_mfma_f32_16x16x16_bf16 v[184:187], v[136:137], a[172:173], v[184:187]
v_accvgpr_write_b32 a164, v168
v_accvgpr_write_b32 a165, v169
v_mfma_f32_16x16x16_bf16 v[188:191], v[138:139], a[174:175], v[188:191]
v_accvgpr_write_b32 a166, v172
v_accvgpr_write_b32 a167, v173
s_waitcnt lgkmcnt(4)
v_mfma_f32_16x16x16_bf16 v[160:163], v[148:149], v[68:69], 0
v_cvt_pk_bf16_f32 v176, v176, v177
v_cvt_pk_bf16_f32 v177, v178, v179
v_mfma_f32_16x16x16_bf16 v[164:167], v[148:149], v[70:71], 0
v_cvt_pk_bf16_f32 v180, v180, v181
v_cvt_pk_bf16_f32 v181, v182, v183
ds_read_b128 v[136:139], v53 offset:6800
v_mfma_f32_16x16x16_bf16 v[160:163], v[144:145], a[176:177], v[160:163]
v_accvgpr_write_b32 a168, v176
v_accvgpr_write_b32 a169, v177
v_mfma_f32_16x16x16_bf16 v[164:167], v[146:147], a[178:179], v[164:167]
v_accvgpr_write_b32 a170, v180
v_accvgpr_write_b32 a171, v181
v_mfma_f32_16x16x16_bf16 v[168:171], v[148:149], v[72:73], 0
v_cvt_pk_bf16_f32 v184, v184, v185
v_cvt_pk_bf16_f32 v185, v186, v187
v_mfma_f32_16x16x16_bf16 v[172:175], v[148:149], v[74:75], 0
v_cvt_pk_bf16_f32 v188, v188, v189
v_cvt_pk_bf16_f32 v189, v190, v191
ds_read_b64 v[140:141], v54 offset:3200
v_mfma_f32_16x16x16_bf16 v[168:171], v[144:145], a[180:181], v[168:171]
v_accvgpr_write_b32 a172, v184
v_accvgpr_write_b32 a173, v185
v_mfma_f32_16x16x16_bf16 v[172:175], v[146:147], a[182:183], v[172:175]
v_accvgpr_write_b32 a174, v188
v_accvgpr_write_b32 a175, v189
s_waitcnt lgkmcnt(4)
v_mfma_f32_16x16x16_bf16 v[176:179], v[156:157], v[68:69], 0
v_cvt_pk_bf16_f32 v160, v160, v161
v_cvt_pk_bf16_f32 v161, v162, v163
v_mfma_f32_16x16x16_bf16 v[180:183], v[156:157], v[70:71], 0
v_cvt_pk_bf16_f32 v164, v164, v165
v_cvt_pk_bf16_f32 v165, v166, v167
ds_read_b128 v[144:147], v53 offset:7072
v_mfma_f32_16x16x16_bf16 v[176:179], v[152:153], a[184:185], v[176:179]
v_accvgpr_write_b32 a176, v160
v_accvgpr_write_b32 a177, v161
v_mfma_f32_16x16x16_bf16 v[180:183], v[154:155], a[186:187], v[180:183]
v_accvgpr_write_b32 a178, v164
v_accvgpr_write_b32 a179, v165
v_mfma_f32_16x16x16_bf16 v[184:187], v[156:157], v[72:73], 0
v_cvt_pk_bf16_f32 v168, v168, v169
v_cvt_pk_bf16_f32 v169, v170, v171
v_mfma_f32_16x16x16_bf16 v[188:191], v[156:157], v[74:75], 0
v_cvt_pk_bf16_f32 v172, v172, v173
v_cvt_pk_bf16_f32 v173, v174, v175
ds_read_b64 v[148:149], v54 offset:3328
v_mfma_f32_16x16x16_bf16 v[184:187], v[152:153], a[188:189], v[184:187]
v_accvgpr_write_b32 a180, v168
v_accvgpr_write_b32 a181, v169
v_mfma_f32_16x16x16_bf16 v[188:191], v[154:155], a[190:191], v[188:191]
v_accvgpr_write_b32 a182, v172
v_accvgpr_write_b32 a183, v173
s_waitcnt lgkmcnt(4)
v_mfma_f32_16x16x16_bf16 v[160:163], v[132:133], v[68:69], 0
v_cvt_pk_bf16_f32 v176, v176, v177
v_cvt_pk_bf16_f32 v177, v178, v179
v_mfma_f32_16x16x16_bf16 v[164:167], v[132:133], v[70:71], 0
v_cvt_pk_bf16_f32 v180, v180, v181
v_cvt_pk_bf16_f32 v181, v182, v183
ds_read_b128 v[152:155], v53 offset:7344
v_mfma_f32_16x16x16_bf16 v[160:163], v[128:129], a[192:193], v[160:163]
v_accvgpr_write_b32 a184, v176
v_accvgpr_write_b32 a185, v177
v_mfma_f32_16x16x16_bf16 v[164:167], v[130:131], a[194:195], v[164:167]
v_accvgpr_write_b32 a186, v180
v_accvgpr_write_b32 a187, v181
v_mfma_f32_16x16x16_bf16 v[168:171], v[132:133], v[72:73], 0
v_cvt_pk_bf16_f32 v184, v184, v185
v_cvt_pk_bf16_f32 v185, v186, v187
v_mfma_f32_16x16x16_bf16 v[172:175], v[132:133], v[74:75], 0
v_cvt_pk_bf16_f32 v188, v188, v189
v_cvt_pk_bf16_f32 v189, v190, v191
ds_read_b64 v[156:157], v54 offset:3456
v_mfma_f32_16x16x16_bf16 v[168:171], v[128:129], a[196:197], v[168:171]
v_accvgpr_write_b32 a188, v184
v_accvgpr_write_b32 a189, v185
v_mfma_f32_16x16x16_bf16 v[172:175], v[130:131], a[198:199], v[172:175]
v_accvgpr_write_b32 a190, v188
v_accvgpr_write_b32 a191, v189
s_waitcnt lgkmcnt(4)
v_mfma_f32_16x16x16_bf16 v[176:179], v[140:141], v[68:69], 0
v_cvt_pk_bf16_f32 v160, v160, v161
v_cvt_pk_bf16_f32 v161, v162, v163
v_mfma_f32_16x16x16_bf16 v[180:183], v[140:141], v[70:71], 0
v_cvt_pk_bf16_f32 v164, v164, v165
v_cvt_pk_bf16_f32 v165, v166, v167
ds_read_b128 v[128:131], v53 offset:7616
v_mfma_f32_16x16x16_bf16 v[176:179], v[136:137], a[200:201], v[176:179]
v_accvgpr_write_b32 a192, v160
v_accvgpr_write_b32 a193, v161
v_mfma_f32_16x16x16_bf16 v[180:183], v[138:139], a[202:203], v[180:183]
v_accvgpr_write_b32 a194, v164
v_accvgpr_write_b32 a195, v165
v_mfma_f32_16x16x16_bf16 v[184:187], v[140:141], v[72:73], 0
v_cvt_pk_bf16_f32 v168, v168, v169
v_cvt_pk_bf16_f32 v169, v170, v171
v_mfma_f32_16x16x16_bf16 v[188:191], v[140:141], v[74:75], 0
v_cvt_pk_bf16_f32 v172, v172, v173
v_cvt_pk_bf16_f32 v173, v174, v175
ds_read_b64 v[132:133], v54 offset:3584
v_mfma_f32_16x16x16_bf16 v[184:187], v[136:137], a[204:205], v[184:187]
v_accvgpr_write_b32 a196, v168
v_accvgpr_write_b32 a197, v169
v_mfma_f32_16x16x16_bf16 v[188:191], v[138:139], a[206:207], v[188:191]
v_accvgpr_write_b32 a198, v172
v_accvgpr_write_b32 a199, v173
s_waitcnt lgkmcnt(4)
v_mfma_f32_16x16x16_bf16 v[160:163], v[148:149], v[68:69], 0
v_cvt_pk_bf16_f32 v176, v176, v177
v_cvt_pk_bf16_f32 v177, v178, v179
v_mfma_f32_16x16x16_bf16 v[164:167], v[148:149], v[70:71], 0
v_cvt_pk_bf16_f32 v180, v180, v181
v_cvt_pk_bf16_f32 v181, v182, v183
ds_read_b128 v[136:139], v53 offset:7888
v_mfma_f32_16x16x16_bf16 v[160:163], v[144:145], a[208:209], v[160:163]
v_accvgpr_write_b32 a200, v176
v_accvgpr_write_b32 a201, v177
v_mfma_f32_16x16x16_bf16 v[164:167], v[146:147], a[210:211], v[164:167]
v_accvgpr_write_b32 a202, v180
v_accvgpr_write_b32 a203, v181
v_mfma_f32_16x16x16_bf16 v[168:171], v[148:149], v[72:73], 0
v_cvt_pk_bf16_f32 v184, v184, v185
v_cvt_pk_bf16_f32 v185, v186, v187
v_mfma_f32_16x16x16_bf16 v[172:175], v[148:149], v[74:75], 0
v_cvt_pk_bf16_f32 v188, v188, v189
v_cvt_pk_bf16_f32 v189, v190, v191
ds_read_b64 v[140:141], v54 offset:3712
v_mfma_f32_16x16x16_bf16 v[168:171], v[144:145], a[212:213], v[168:171]
v_accvgpr_write_b32 a204, v184
v_accvgpr_write_b32 a205, v185
v_mfma_f32_16x16x16_bf16 v[172:175], v[146:147], a[214:215], v[172:175]
v_accvgpr_write_b32 a206, v188
v_accvgpr_write_b32 a207, v189
s_waitcnt lgkmcnt(4)
v_mfma_f32_16x16x16_bf16 v[176:179], v[156:157], v[68:69], 0
v_cvt_pk_bf16_f32 v160, v160, v161
v_cvt_pk_bf16_f32 v161, v162, v163
v_mfma_f32_16x16x16_bf16 v[180:183], v[156:157], v[70:71], 0
v_cvt_pk_bf16_f32 v164, v164, v165
v_cvt_pk_bf16_f32 v165, v166, v167
ds_read_b128 v[144:147], v53 offset:8160
v_mfma_f32_16x16x16_bf16 v[176:179], v[152:153], a[216:217], v[176:179]
v_accvgpr_write_b32 a208, v160
v_accvgpr_write_b32 a209, v161
v_mfma_f32_16x16x16_bf16 v[180:183], v[154:155], a[218:219], v[180:183]
v_accvgpr_write_b32 a210, v164
v_accvgpr_write_b32 a211, v165
v_mfma_f32_16x16x16_bf16 v[184:187], v[156:157], v[72:73], 0
v_cvt_pk_bf16_f32 v168, v168, v169
v_cvt_pk_bf16_f32 v169, v170, v171
v_mfma_f32_16x16x16_bf16 v[188:191], v[156:157], v[74:75], 0
v_cvt_pk_bf16_f32 v172, v172, v173
v_cvt_pk_bf16_f32 v173, v174, v175
ds_read_b64 v[148:149], v54 offset:3840
v_mfma_f32_16x16x16_bf16 v[184:187], v[152:153], a[220:221], v[184:187]
v_accvgpr_write_b32 a212, v168
v_accvgpr_write_b32 a213, v169
v_mfma_f32_16x16x16_bf16 v[188:191], v[154:155], a[222:223], v[188:191]
v_accvgpr_write_b32 a214, v172
v_accvgpr_write_b32 a215, v173
s_waitcnt lgkmcnt(4)
v_mfma_f32_16x16x16_bf16 v[160:163], v[132:133], v[68:69], 0
v_cvt_pk_bf16_f32 v176, v176, v177
v_cvt_pk_bf16_f32 v177, v178, v179
v_mfma_f32_16x16x16_bf16 v[164:167], v[132:133], v[70:71], 0
v_cvt_pk_bf16_f32 v180, v180, v181
v_cvt_pk_bf16_f32 v181, v182, v183
ds_read_b128 v[152:155], v53 offset:8432
v_mfma_f32_16x16x16_bf16 v[160:163], v[128:129], a[224:225], v[160:163]
v_accvgpr_write_b32 a216, v176
v_accvgpr_write_b32 a217, v177
v_mfma_f32_16x16x16_bf16 v[164:167], v[130:131], a[226:227], v[164:167]
v_accvgpr_write_b32 a218, v180
v_accvgpr_write_b32 a219, v181
v_mfma_f32_16x16x16_bf16 v[168:171], v[132:133], v[72:73], 0
v_cvt_pk_bf16_f32 v184, v184, v185
v_cvt_pk_bf16_f32 v185, v186, v187
v_mfma_f32_16x16x16_bf16 v[172:175], v[132:133], v[74:75], 0
v_cvt_pk_bf16_f32 v188, v188, v189
v_cvt_pk_bf16_f32 v189, v190, v191
ds_read_b64 v[156:157], v54 offset:3968
v_mfma_f32_16x16x16_bf16 v[168:171], v[128:129], a[228:229], v[168:171]
v_accvgpr_write_b32 a220, v184
v_accvgpr_write_b32 a221, v185
v_mfma_f32_16x16x16_bf16 v[172:175], v[130:131], a[230:231], v[172:175]
v_accvgpr_write_b32 a222, v188
v_accvgpr_write_b32 a223, v189
s_waitcnt lgkmcnt(4)
v_mfma_f32_16x16x16_bf16 v[176:179], v[140:141], v[68:69], 0
v_cvt_pk_bf16_f32 v160, v160, v161
v_cvt_pk_bf16_f32 v161, v162, v163
v_mfma_f32_16x16x16_bf16 v[180:183], v[140:141], v[70:71], 0
v_cvt_pk_bf16_f32 v164, v164, v165
v_cvt_pk_bf16_f32 v165, v166, v167
v_mfma_f32_16x16x16_bf16 v[176:179], v[136:137], a[232:233], v[176:179]
v_accvgpr_write_b32 a224, v160
v_accvgpr_write_b32 a225, v161
v_mfma_f32_16x16x16_bf16 v[180:183], v[138:139], a[234:235], v[180:183]
v_accvgpr_write_b32 a226, v164
v_accvgpr_write_b32 a227, v165
v_mfma_f32_16x16x16_bf16 v[184:187], v[140:141], v[72:73], 0
v_cvt_pk_bf16_f32 v168, v168, v169
v_cvt_pk_bf16_f32 v169, v170, v171
v_mfma_f32_16x16x16_bf16 v[188:191], v[140:141], v[74:75], 0
v_cvt_pk_bf16_f32 v172, v172, v173
v_cvt_pk_bf16_f32 v173, v174, v175
v_mfma_f32_16x16x16_bf16 v[184:187], v[136:137], a[236:237], v[184:187]
v_accvgpr_write_b32 a228, v168
v_accvgpr_write_b32 a229, v169
v_mfma_f32_16x16x16_bf16 v[188:191], v[138:139], a[238:239], v[188:191]
v_accvgpr_write_b32 a230, v172
v_accvgpr_write_b32 a231, v173
s_waitcnt lgkmcnt(2)
v_mfma_f32_16x16x16_bf16 v[160:163], v[148:149], v[68:69], 0
v_cvt_pk_bf16_f32 v176, v176, v177
v_cvt_pk_bf16_f32 v177, v178, v179
v_mfma_f32_16x16x16_bf16 v[164:167], v[148:149], v[70:71], 0
v_cvt_pk_bf16_f32 v180, v180, v181
v_cvt_pk_bf16_f32 v181, v182, v183
v_mfma_f32_16x16x16_bf16 v[160:163], v[144:145], a[240:241], v[160:163]
v_accvgpr_write_b32 a232, v176
v_accvgpr_write_b32 a233, v177
v_mfma_f32_16x16x16_bf16 v[164:167], v[146:147], a[242:243], v[164:167]
v_accvgpr_write_b32 a234, v180
v_accvgpr_write_b32 a235, v181
v_mfma_f32_16x16x16_bf16 v[168:171], v[148:149], v[72:73], 0
v_cvt_pk_bf16_f32 v184, v184, v185
v_cvt_pk_bf16_f32 v185, v186, v187
v_mfma_f32_16x16x16_bf16 v[172:175], v[148:149], v[74:75], 0
v_cvt_pk_bf16_f32 v188, v188, v189
v_cvt_pk_bf16_f32 v189, v190, v191
v_mfma_f32_16x16x16_bf16 v[168:171], v[144:145], a[244:245], v[168:171]
v_accvgpr_write_b32 a236, v184
v_accvgpr_write_b32 a237, v185
v_mfma_f32_16x16x16_bf16 v[172:175], v[146:147], a[246:247], v[172:175]
v_accvgpr_write_b32 a238, v188
v_accvgpr_write_b32 a239, v189
s_waitcnt lgkmcnt(0)
v_mfma_f32_16x16x16_bf16 v[176:179], v[156:157], v[68:69], 0
v_cvt_pk_bf16_f32 v160, v160, v161
v_cvt_pk_bf16_f32 v161, v162, v163
v_mfma_f32_16x16x16_bf16 v[180:183], v[156:157], v[70:71], 0
v_cvt_pk_bf16_f32 v164, v164, v165
v_cvt_pk_bf16_f32 v165, v166, v167
v_mfma_f32_16x16x16_bf16 v[176:179], v[152:153], a[248:249], v[176:179]
v_accvgpr_write_b32 a240, v160
v_accvgpr_write_b32 a241, v161
v_mfma_f32_16x16x16_bf16 v[180:183], v[154:155], a[250:251], v[180:183]
v_accvgpr_write_b32 a242, v164
v_accvgpr_write_b32 a243, v165
v_mfma_f32_16x16x16_bf16 v[184:187], v[156:157], v[72:73], 0
v_cvt_pk_bf16_f32 v168, v168, v169
v_cvt_pk_bf16_f32 v169, v170, v171
v_mfma_f32_16x16x16_bf16 v[188:191], v[156:157], v[74:75], 0
v_cvt_pk_bf16_f32 v172, v172, v173
v_cvt_pk_bf16_f32 v173, v174, v175
v_mfma_f32_16x16x16_bf16 v[184:187], v[152:153], a[252:253], v[184:187]
v_accvgpr_write_b32 a244, v168
v_accvgpr_write_b32 a245, v169
v_mfma_f32_16x16x16_bf16 v[188:191], v[154:155], a[254:255], v[188:191]
v_accvgpr_write_b32 a246, v172
v_accvgpr_write_b32 a247, v173
v_cvt_pk_bf16_f32 v176, v176, v177
v_cvt_pk_bf16_f32 v177, v178, v179
v_cvt_pk_bf16_f32 v180, v180, v181
v_cvt_pk_bf16_f32 v181, v182, v183
v_accvgpr_write_b32 a248, v176
v_accvgpr_write_b32 a249, v177
v_accvgpr_write_b32 a250, v180
v_accvgpr_write_b32 a251, v181
v_cvt_pk_bf16_f32 v184, v184, v185
v_cvt_pk_bf16_f32 v185, v186, v187
v_cvt_pk_bf16_f32 v188, v188, v189
v_cvt_pk_bf16_f32 v189, v190, v191
v_accvgpr_write_b32 a252, v184
v_accvgpr_write_b32 a253, v185
v_accvgpr_write_b32 a254, v188
v_accvgpr_write_b32 a255, v189
s_waitcnt vmcnt(21)
s_barrier
ds_read_b64_tr_b16 v[80:81], v10 offset:0
ds_read_b64_tr_b16 v[82:83], v10 offset:16384
ds_read_b64_tr_b16 v[84:85], v11 offset:0
ds_read_b64_tr_b16 v[86:87], v11 offset:16384
ds_read_b64_tr_b16 v[88:89], v12 offset:0
ds_read_b64_tr_b16 v[90:91], v12 offset:16384
ds_read_b64_tr_b16 v[92:93], v13 offset:0
ds_read_b64_tr_b16 v[94:95], v13 offset:16384
ds_read_b64_tr_b16 v[96:97], v10 offset:1024
ds_read_b64_tr_b16 v[98:99], v10 offset:17408
ds_read_b64_tr_b16 v[100:101], v11 offset:1024
ds_read_b64_tr_b16 v[102:103], v11 offset:17408
ds_read_b64_tr_b16 v[104:105], v12 offset:1024
ds_read_b64_tr_b16 v[106:107], v12 offset:17408
ds_read_b64_tr_b16 v[108:109], v13 offset:1024
ds_read_b64_tr_b16 v[110:111], v13 offset:17408
S_K_M:
s_waitcnt lgkmcnt(14)
v_mfma_f32_16x16x32_bf16 v[128:131], v[80:83], a[0:3], 0
s_add_u32 m0, s76, 98304
s_add_u32 s77, s82, 0x480800
v_mfma_f32_16x16x32_bf16 v[144:147], v[80:83], a[4:7], 0
ds_read_b64_tr_b16 v[112:113], v10 offset:2048
s_waitcnt lgkmcnt(13)
v_mfma_f32_16x16x32_bf16 v[132:135], v[84:87], a[0:3], 0
buffer_load_dwordx4 v22, s[32:35], s77 offen offset:0 lds
v_mfma_f32_16x16x32_bf16 v[148:151], v[84:87], a[4:7], 0
ds_read_b64_tr_b16 v[114:115], v10 offset:18432
s_waitcnt lgkmcnt(12)
v_mfma_f32_16x16x32_bf16 v[136:139], v[88:91], a[0:3], 0
ds_read_b64_tr_b16 v[116:117], v11 offset:2048
ds_read_b64_tr_b16 v[118:119], v11 offset:18432
v_mfma_f32_16x16x32_bf16 v[152:155], v[88:91], a[4:7], 0
ds_read_b64_tr_b16 v[120:121], v12 offset:2048
s_waitcnt lgkmcnt(13)
v_mfma_f32_16x16x32_bf16 v[140:143], v[92:95], a[0:3], 0
s_lshl_b32 s78, s72, 5
v_xor_b32 v55, s78, v10
v_mfma_f32_16x16x32_bf16 v[156:159], v[92:95], a[4:7], 0
ds_read_b64_tr_b16 v[122:123], v12 offset:18432
s_waitcnt lgkmcnt(6)
v_mfma_f32_16x16x32_bf16 v[128:131], v[96:99], a[8:11], v[128:131]
ds_read_b64_tr_b16 v[124:125], v13 offset:2048
v_and_b32 v2, 48, v1
v_mfma_f32_16x16x32_bf16 v[144:147], v[96:99], a[12:15], v[144:147]
ds_read_b64_tr_b16 v[126:127], v13 offset:18432
v_add_u32 v2, 143872, v2
v_mfma_f32_16x16x32_bf16 v[132:135], v[100:103], a[8:11], v[132:135]
ds_read_b64_tr_b16 v[80:81], v10 offset:3072
ds_read_b128 v[160:163], v2 offset:0
v_mfma_f32_16x16x32_bf16 v[148:151], v[100:103], a[12:15], v[148:151]
ds_read_b64_tr_b16 v[82:83], v10 offset:19456
ds_read_b128 v[164:167], v2 offset:64
v_mfma_f32_16x16x32_bf16 v[136:139], v[104:107], a[8:11], v[136:139]
ds_read_b64_tr_b16 v[84:85], v11 offset:3072
ds_read_b128 v[168:171], v2 offset:128
v_mfma_f32_16x16x32_bf16 v[152:155], v[104:107], a[12:15], v[152:155]
ds_read_b64_tr_b16 v[86:87], v11 offset:19456
ds_read_b128 v[172:175], v2 offset:192
v_mfma_f32_16x16x32_bf16 v[140:143], v[108:111], a[8:11], v[140:143]
ds_read_b64_tr_b16 v[88:89], v12 offset:3072
ds_read_b128 v[176:179], v2 offset:256
v_mfma_f32_16x16x32_bf16 v[156:159], v[108:111], a[12:15], v[156:159]
ds_read_b64_tr_b16 v[90:91], v12 offset:19456
s_waitcnt lgkmcnt(12)
v_mfma_f32_16x16x32_bf16 v[128:131], v[112:115], a[16:19], v[128:131]
ds_read_b64_tr_b16 v[92:93], v13 offset:3072
ds_read_b128 v[180:183], v2 offset:320
v_mfma_f32_16x16x32_bf16 v[144:147], v[112:115], a[20:23], v[144:147]
ds_read_b64_tr_b16 v[94:95], v13 offset:19456
ds_read_b128 v[184:187], v2 offset:384
v_mfma_f32_16x16x32_bf16 v[132:135], v[116:119], a[16:19], v[132:135]
ds_read_b64_tr_b16 v[96:97], v10 offset:4096
ds_read_b128 v[188:191], v2 offset:448
v_mfma_f32_16x16x32_bf16 v[148:151], v[116:119], a[20:23], v[148:151]
ds_read_b64_tr_b16 v[98:99], v10 offset:20480
v_and_b32 v3, 15, v1
v_mfma_f32_16x16x32_bf16 v[136:139], v[120:123], a[16:19], v[136:139]
ds_read_b64_tr_b16 v[100:101], v11 offset:4096
v_lshlrev_b32 v3, 11, v3
v_mfma_f32_16x16x32_bf16 v[152:155], v[120:123], a[20:23], v[152:155]
ds_read_b64_tr_b16 v[102:103], v11 offset:20480
s_waitcnt lgkmcnt(10)
v_mfma_f32_16x16x32_bf16 v[140:143], v[124:127], a[16:19], v[140:143]
ds_read_b64_tr_b16 v[104:105], v12 offset:4096
v_lshrrev_b32 v4, 4, v1
v_mfma_f32_16x16x32_bf16 v[156:159], v[124:127], a[20:23], v[156:159]
ds_read_b64_tr_b16 v[106:107], v12 offset:20480
v_lshl_add_u32 v3, v4, 3, v3
v_mfma_f32_16x16x32_bf16 v[128:131], v[80:83], a[24:27], v[128:131]
ds_read_b64_tr_b16 v[108:109], v13 offset:4096
ds_read_b64_tr_b16 v[110:111], v13 offset:20480
v_mfma_f32_16x16x32_bf16 v[144:147], v[80:83], a[28:31], v[144:147]
buffer_load_dwordx4 v23, s[32:35], s77 offen offset:1024 lds
v_mfma_f32_16x16x32_bf16 v[132:135], v[84:87], a[24:27], v[132:135]
ds_read_b64_tr_b16 v[112:113], v10 offset:5120
ds_read_b64_tr_b16 v[114:115], v10 offset:21504
v_mfma_f32_16x16x32_bf16 v[148:151], v[84:87], a[28:31], v[148:151]
ds_read_b64_tr_b16 v[116:117], v11 offset:5120
s_waitcnt lgkmcnt(8)
v_mfma_f32_16x16x32_bf16 v[136:139], v[88:91], a[24:27], v[136:139]
s_add_u32 s91, s88, s83
s_add_u32 s91, s91, 0
v_mfma_f32_16x16x32_bf16 v[152:155], v[88:91], a[28:31], v[152:155]
ds_read_b64_tr_b16 v[118:119], v11 offset:21504
ds_read_b64_tr_b16 v[120:121], v12 offset:5120
v_mfma_f32_16x16x32_bf16 v[140:143], v[92:95], a[24:27], v[140:143]
buffer_load_dwordx4 v24, s[32:35], s77 offen offset:2048 lds
v_mfma_f32_16x16x32_bf16 v[156:159], v[92:95], a[28:31], v[156:159]
ds_read_b64_tr_b16 v[122:123], v12 offset:21504
ds_read_b64_tr_b16 v[124:125], v13 offset:5120
v_mfma_f32_16x16x32_bf16 v[128:131], v[96:99], a[32:35], v[128:131]
buffer_load_dwordx2 v[216:217], v3, s[28:31], s91 offen offset:0
v_mfma_f32_16x16x32_bf16 v[144:147], v[96:99], a[36:39], v[144:147]
ds_read_b64_tr_b16 v[126:127], v13 offset:21504
s_waitcnt lgkmcnt(6)
v_mfma_f32_16x16x32_bf16 v[132:135], v[100:103], a[32:35], v[132:135]
ds_read_b64_tr_b16 v[80:81], v10 offset:6144
ds_read_b64_tr_b16 v[82:83], v10 offset:22528
v_mfma_f32_16x16x32_bf16 v[148:151], v[100:103], a[36:39], v[148:151]
buffer_load_dwordx4 v25, s[32:35], s77 offen offset:3072 lds
v_mfma_f32_16x16x32_bf16 v[136:139], v[104:107], a[32:35], v[136:139]
ds_read_b64_tr_b16 v[84:85], v11 offset:6144
ds_read_b64_tr_b16 v[86:87], v11 offset:22528
v_mfma_f32_16x16x32_bf16 v[152:155], v[104:107], a[36:39], v[152:155]
s_add_u32 s70, s0, S_V - K_pc + 0
s_addc_u32 s71, s1, 0
global_load_dword v57, v9, s[70:71]
v_mfma_f32_16x16x32_bf16 v[140:143], v[108:111], a[32:35], v[140:143]
ds_read_b64_tr_b16 v[88:89], v12 offset:6144
s_mov_b32 s3, 0x0
v_mfma_f32_16x16x32_bf16 v[156:159], v[108:111], a[36:39], v[156:159]
ds_read_b64_tr_b16 v[90:91], v12 offset:22528
ds_read_b64_tr_b16 v[92:93], v13 offset:6144
v_mfma_f32_16x16x32_bf16 v[128:131], v[112:115], a[40:43], v[128:131]
s_add_u32 m0, s76, 102400
s_add_u32 s77, s82, 0x540800
v_mfma_f32_16x16x32_bf16 v[144:147], v[112:115], a[44:47], v[144:147]
ds_read_b64_tr_b16 v[94:95], v13 offset:22528
s_waitcnt lgkmcnt(6)
v_mfma_f32_16x16x32_bf16 v[132:135], v[116:119], a[40:43], v[132:135]
ds_read_b64_tr_b16 v[96:97], v10 offset:7168
ds_read_b64_tr_b16 v[98:99], v10 offset:23552
v_mfma_f32_16x16x32_bf16 v[148:151], v[116:119], a[44:47], v[148:151]
buffer_load_dwordx4 v22, s[32:35], s77 offen offset:0 lds
v_mfma_f32_16x16x32_bf16 v[136:139], v[120:123], a[40:43], v[136:139]
ds_read_b64_tr_b16 v[100:101], v11 offset:7168
ds_read_b64_tr_b16 v[102:103], v11 offset:23552
v_mfma_f32_16x16x32_bf16 v[152:155], v[120:123], a[44:47], v[152:155]
buffer_load_dwordx2 v[218:219], v3, s[28:31], s91 offen offset:32
v_mfma_f32_16x16x32_bf16 v[140:143], v[124:127], a[40:43], v[140:143]
ds_read_b64_tr_b16 v[104:105], v12 offset:7168
ds_read_b64_tr_b16 v[106:107], v12 offset:23552
v_mfma_f32_16x16x32_bf16 v[156:159], v[124:127], a[44:47], v[156:159]
buffer_load_dword v57, v8, s[40:43], s3 offen
v_mfma_f32_16x16x32_bf16 v[128:131], v[80:83], a[48:51], v[128:131]
ds_read_b64_tr_b16 v[108:109], v13 offset:7168
ds_read_b64_tr_b16 v[110:111], v13 offset:23552
v_mfma_f32_16x16x32_bf16 v[144:147], v[80:83], a[52:55], v[144:147]
s_waitcnt lgkmcnt(6)
v_mfma_f32_16x16x32_bf16 v[132:135], v[84:87], a[48:51], v[132:135]
buffer_load_dwordx4 v23, s[32:35], s77 offen offset:1024 lds
v_mfma_f32_16x16x32_bf16 v[148:151], v[84:87], a[52:55], v[148:151]
buffer_load_dwordx4 v24, s[32:35], s77 offen offset:2048 lds
v_mfma_f32_16x16x32_bf16 v[136:139], v[88:91], a[48:51], v[136:139]
buffer_load_dwordx4 v25, s[32:35], s77 offen offset:3072 lds
v_mfma_f32_16x16x32_bf16 v[152:155], v[88:91], a[52:55], v[152:155]
s_waitcnt vmcnt(25) lgkmcnt(0)
s_barrier
v_mfma_f32_16x16x32_bf16 v[140:143], v[92:95], a[48:51], v[140:143]
ds_read_b64_tr_b16 v[112:113], v10 offset:32768
ds_read_b64_tr_b16 v[114:115], v10 offset:49152
v_mfma_f32_16x16x32_bf16 v[156:159], v[92:95], a[52:55], v[156:159]
ds_read_b64_tr_b16 v[116:117], v11 offset:32768
ds_read_b64_tr_b16 v[118:119], v11 offset:49152
v_mfma_f32_16x16x32_bf16 v[128:131], v[96:99], a[56:59], v[128:131]
ds_read_b64_tr_b16 v[120:121], v12 offset:32768
ds_read_b64_tr_b16 v[122:123], v12 offset:49152
v_mfma_f32_16x16x32_bf16 v[144:147], v[96:99], a[60:63], v[144:147]
ds_read_b64_tr_b16 v[124:125], v13 offset:32768
ds_read_b64_tr_b16 v[126:127], v13 offset:49152
v_mfma_f32_16x16x32_bf16 v[132:135], v[100:103], a[56:59], v[132:135]
ds_read_b64_tr_b16 v[80:81], v10 offset:33792
s_add_u32 m0, s76, 0
v_mfma_f32_16x16x32_bf16 v[148:151], v[100:103], a[60:63], v[148:151]
ds_read_b64_tr_b16 v[82:83], v10 offset:50176
s_add_u32 s77, s86, 0x0
v_mfma_f32_16x16x32_bf16 v[136:139], v[104:107], a[56:59], v[136:139]
ds_read_b64_tr_b16 v[84:85], v11 offset:33792
ds_read_b64_tr_b16 v[86:87], v11 offset:50176
v_mfma_f32_16x16x32_bf16 v[152:155], v[104:107], a[60:63], v[152:155]
buffer_load_dwordx4 v38, s[56:59], s77 offen offset:0 lds
v_mfma_f32_16x16x32_bf16 v[140:143], v[108:111], a[56:59], v[140:143]
ds_read_b64_tr_b16 v[88:89], v12 offset:33792
ds_read_b64_tr_b16 v[90:91], v12 offset:50176
v_mfma_f32_16x16x32_bf16 v[156:159], v[108:111], a[60:63], v[156:159]
ds_read_b64_tr_b16 v[92:93], v13 offset:33792
s_waitcnt lgkmcnt(9)
v_mfma_f32_16x16x32_bf16 v[128:131], v[112:115], a[64:67], v[128:131]
buffer_load_dwordx2 v[220:221], v3, s[28:31], s91 offen offset:64
v_mfma_f32_16x16x32_bf16 v[144:147], v[112:115], a[68:71], v[144:147]
ds_read_b64_tr_b16 v[94:95], v13 offset:50176
ds_read_b64_tr_b16 v[96:97], v10 offset:34816
v_mfma_f32_16x16x32_bf16 v[132:135], v[116:119], a[64:67], v[132:135]
buffer_load_dwordx4 v39, s[56:59], s77 offen offset:1024 lds
v_mfma_f32_16x16x32_bf16 v[148:151], v[116:119], a[68:71], v[148:151]
ds_read_b64_tr_b16 v[98:99], v10 offset:51200
ds_read_b64_tr_b16 v[100:101], v11 offset:34816
v_mfma_f32_16x16x32_bf16 v[136:139], v[120:123], a[64:67], v[136:139]
ds_read_b64_tr_b16 v[102:103], v11 offset:51200
v_mfma_f32_16x16x32_bf16 v[152:155], v[120:123], a[68:71], v[152:155]
ds_read_b64_tr_b16 v[104:105], v12 offset:34816
s_waitcnt lgkmcnt(7)
v_mfma_f32_16x16x32_bf16 v[140:143], v[124:127], a[64:67], v[140:143]
ds_read_b64_tr_b16 v[106:107], v12 offset:51200
ds_read_b64_tr_b16 v[108:109], v13 offset:34816
v_mfma_f32_16x16x32_bf16 v[156:159], v[124:127], a[68:71], v[156:159]
buffer_load_dwordx4 v40, s[56:59], s77 offen offset:2048 lds
v_mfma_f32_16x16x32_bf16 v[128:131], v[80:83], a[72:75], v[128:131]
buffer_load_dwordx2 v[222:223], v3, s[28:31], s91 offen offset:96
v_mfma_f32_16x16x32_bf16 v[144:147], v[80:83], a[76:79], v[144:147]
ds_read_b64_tr_b16 v[110:111], v13 offset:51200
ds_read_b64_tr_b16 v[112:113], v10 offset:35840
v_mfma_f32_16x16x32_bf16 v[132:135], v[84:87], a[72:75], v[132:135]
ds_read_b64_tr_b16 v[114:115], v10 offset:52224
v_mfma_f32_16x16x32_bf16 v[148:151], v[84:87], a[76:79], v[148:151]
ds_read_b64_tr_b16 v[116:117], v11 offset:35840
ds_read_b64_tr_b16 v[118:119], v11 offset:52224
v_mfma_f32_16x16x32_bf16 v[136:139], v[88:91], a[72:75], v[136:139]
buffer_load_dwordx4 v41, s[56:59], s77 offen offset:3072 lds
v_mfma_f32_16x16x32_bf16 v[152:155], v[88:91], a[76:79], v[152:155]
ds_read_b64_tr_b16 v[120:121], v12 offset:35840
s_waitcnt lgkmcnt(6)
v_mfma_f32_16x16x32_bf16 v[140:143], v[92:95], a[72:75], v[140:143]
ds_read_b64_tr_b16 v[122:123], v12 offset:52224
ds_read_b64_tr_b16 v[124:125], v13 offset:35840
v_mfma_f32_16x16x32_bf16 v[156:159], v[92:95], a[76:79], v[156:159]
s_add_u32 s91, s88, s83
s_add_u32 s91, s91, 32768
v_mfma_f32_16x16x32_bf16 v[128:131], v[96:99], a[80:83], v[128:131]
buffer_load_dwordx2 v[248:249], v3, s[28:31], s91 offen offset:0
v_mfma_f32_16x16x32_bf16 v[144:147], v[96:99], a[84:87], v[144:147]
ds_read_b64_tr_b16 v[126:127], v13 offset:52224
s_add_u32 m0, s76, 4096
v_mfma_f32_16x16x32_bf16 v[132:135], v[100:103], a[80:83], v[132:135]
ds_read_b64_tr_b16 v[80:81], v10 offset:36864
s_add_u32 s77, s86, 0x180000
v_mfma_f32_16x16x32_bf16 v[148:151], v[100:103], a[84:87], v[148:151]
ds_read_b64_tr_b16 v[82:83], v10 offset:53248
ds_read_b64_tr_b16 v[84:85], v11 offset:36864
v_mfma_f32_16x16x32_bf16 v[136:139], v[104:107], a[80:83], v[136:139]
buffer_load_dwordx4 v38, s[56:59], s77 offen offset:0 lds
v_mfma_f32_16x16x32_bf16 v[152:155], v[104:107], a[84:87], v[152:155]
ds_read_b64_tr_b16 v[86:87], v11 offset:53248
s_waitcnt lgkmcnt(5)
v_mfma_f32_16x16x32_bf16 v[140:143], v[108:111], a[80:83], v[140:143]
ds_read_b64_tr_b16 v[88:89], v12 offset:36864
ds_read_b64_tr_b16 v[90:91], v12 offset:53248
v_mfma_f32_16x16x32_bf16 v[156:159], v[108:111], a[84:87], v[156:159]
ds_read_b64_tr_b16 v[92:93], v13 offset:36864
v_mfma_f32_16x16x32_bf16 v[128:131], v[112:115], a[88:91], v[128:131]
ds_read_b64_tr_b16 v[94:95], v13 offset:53248
ds_read_b64_tr_b16 v[96:97], v10 offset:37888
v_mfma_f32_16x16x32_bf16 v[144:147], v[112:115], a[92:95], v[144:147]
buffer_load_dwordx4 v39, s[56:59], s77 offen offset:1024 lds
v_mfma_f32_16x16x32_bf16 v[132:135], v[116:119], a[88:91], v[132:135]
buffer_load_dwordx2 v[250:251], v3, s[28:31], s91 offen offset:32
v_mfma_f32_16x16x32_bf16 v[148:151], v[116:119], a[92:95], v[148:151]
ds_read_b64_tr_b16 v[98:99], v10 offset:54272
ds_read_b64_tr_b16 v[100:101], v11 offset:37888
v_mfma_f32_16x16x32_bf16 v[136:139], v[120:123], a[88:91], v[136:139]
ds_read_b64_tr_b16 v[102:103], v11 offset:54272
v_mfma_f32_16x16x32_bf16 v[152:155], v[120:123], a[92:95], v[152:155]
ds_read_b64_tr_b16 v[104:105], v12 offset:37888
s_waitcnt lgkmcnt(7)
v_mfma_f32_16x16x32_bf16 v[140:143], v[124:127], a[88:91], v[140:143]
buffer_load_dwordx4 v40, s[56:59], s77 offen offset:2048 lds
v_mfma_f32_16x16x32_bf16 v[156:159], v[124:127], a[92:95], v[156:159]
ds_read_b64_tr_b16 v[106:107], v12 offset:54272
ds_read_b64_tr_b16 v[108:109], v13 offset:37888
v_mfma_f32_16x16x32_bf16 v[128:131], v[80:83], a[96:99], v[128:131]
ds_read_b64_tr_b16 v[110:111], v13 offset:54272
v_mfma_f32_16x16x32_bf16 v[144:147], v[80:83], a[100:103], v[144:147]
buffer_load_dwordx2 v[252:253], v3, s[28:31], s91 offen offset:64
v_mfma_f32_16x16x32_bf16 v[132:135], v[84:87], a[96:99], v[132:135]
ds_read_b64_tr_b16 v[112:113], v10 offset:38912
ds_read_b64_tr_b16 v[114:115], v10 offset:55296
v_mfma_f32_16x16x32_bf16 v[148:151], v[84:87], a[100:103], v[148:151]
buffer_load_dwordx4 v41, s[56:59], s77 offen offset:3072 lds
v_mfma_f32_16x16x32_bf16 v[136:139], v[88:91], a[96:99], v[136:139]
ds_read_b64_tr_b16 v[116:117], v11 offset:38912
ds_read_b64_tr_b16 v[118:119], v11 offset:55296
v_mfma_f32_16x16x32_bf16 v[152:155], v[88:91], a[100:103], v[152:155]
ds_read_b64_tr_b16 v[120:121], v12 offset:38912
s_waitcnt lgkmcnt(8)
v_mfma_f32_16x16x32_bf16 v[140:143], v[92:95], a[96:99], v[140:143]
ds_read_b64_tr_b16 v[122:123], v12 offset:55296
ds_read_b64_tr_b16 v[124:125], v13 offset:38912
v_mfma_f32_16x16x32_bf16 v[156:159], v[92:95], a[100:103], v[156:159]
ds_read_b64_tr_b16 v[126:127], v13 offset:55296
v_mfma_f32_16x16x32_bf16 v[128:131], v[96:99], a[104:107], v[128:131]
buffer_load_dwordx2 v[254:255], v3, s[28:31], s91 offen offset:96
v_mfma_f32_16x16x32_bf16 v[144:147], v[96:99], a[108:111], v[144:147]
ds_read_b64_tr_b16 v[80:81], v10 offset:39936
ds_read_b64_tr_b16 v[82:83], v10 offset:56320
v_mfma_f32_16x16x32_bf16 v[132:135], v[100:103], a[104:107], v[132:135]
ds_read_b64_tr_b16 v[84:85], v11 offset:39936
v_mfma_f32_16x16x32_bf16 v[148:151], v[100:103], a[108:111], v[148:151]
ds_read_b64_tr_b16 v[86:87], v11 offset:56320
s_waitcnt lgkmcnt(8)
v_mfma_f32_16x16x32_bf16 v[136:139], v[104:107], a[104:107], v[136:139]
ds_read_b64_tr_b16 v[88:89], v12 offset:39936
ds_read_b64_tr_b16 v[90:91], v12 offset:56320
v_mfma_f32_16x16x32_bf16 v[152:155], v[104:107], a[108:111], v[152:155]
ds_read_b64_tr_b16 v[92:93], v13 offset:39936
v_mfma_f32_16x16x32_bf16 v[140:143], v[108:111], a[104:107], v[140:143]
ds_read_b64_tr_b16 v[94:95], v13 offset:56320
v_mfma_f32_16x16x32_bf16 v[156:159], v[108:111], a[108:111], v[156:159]
v_mfma_f32_16x16x32_bf16 v[128:131], v[112:115], a[112:115], v[128:131]
v_mfma_f32_16x16x32_bf16 v[144:147], v[112:115], a[116:119], v[144:147]
v_mfma_f32_16x16x32_bf16 v[132:135], v[116:119], a[112:115], v[132:135]
v_mfma_f32_16x16x32_bf16 v[148:151], v[116:119], a[116:119], v[148:151]
s_waitcnt vmcnt(31) lgkmcnt(0)
s_barrier
v_mfma_f32_16x16x32_bf16 v[136:139], v[120:123], a[112:115], v[136:139]
ds_read_b64_tr_b16 v[96:97], v14 offset:0
ds_read_b64_tr_b16 v[98:99], v14 offset:16384
v_mfma_f32_16x16x32_bf16 v[152:155], v[120:123], a[116:119], v[152:155]
ds_read_b64_tr_b16 v[100:101], v15 offset:0
ds_read_b64_tr_b16 v[102:103], v15 offset:16384
v_mfma_f32_16x16x32_bf16 v[140:143], v[124:127], a[112:115], v[140:143]
ds_read_b64_tr_b16 v[104:105], v16 offset:0
s_add_u32 m0, s76, 32768
v_mfma_f32_16x16x32_bf16 v[156:159], v[124:127], a[116:119], v[156:159]
ds_read_b64_tr_b16 v[106:107], v16 offset:16384
s_add_u32 s77, s82, 0x1000
v_mfma_f32_16x16x32_bf16 v[128:131], v[80:83], a[120:123], v[128:131]
ds_read_b64_tr_b16 v[108:109], v17 offset:0
ds_read_b64_tr_b16 v[110:111], v17 offset:16384
v_mfma_f32_16x16x32_bf16 v[144:147], v[80:83], a[124:127], v[144:147]
buffer_load_dwordx4 v22, s[32:35], s77 offen offset:0 lds
v_mfma_f32_16x16x32_bf16 v[132:135], v[84:87], a[120:123], v[132:135]
ds_read_b64_tr_b16 v[112:113], v14 offset:1024
ds_read_b64_tr_b16 v[114:115], v14 offset:17408
v_mfma_f32_16x16x32_bf16 v[148:151], v[84:87], a[124:127], v[148:151]
ds_read_b64_tr_b16 v[116:117], v15 offset:1024
v_mfma_f32_16x16x32_bf16 v[136:139], v[88:91], a[120:123], v[136:139]
ds_read_b64_tr_b16 v[118:119], v15 offset:17408
ds_read_b64_tr_b16 v[120:121], v16 offset:1024
v_mfma_f32_16x16x32_bf16 v[152:155], v[88:91], a[124:127], v[152:155]
ds_read_b64_tr_b16 v[122:123], v16 offset:17408
v_mfma_f32_16x16x32_bf16 v[140:143], v[92:95], a[120:123], v[140:143]
buffer_load_dwordx4 v23, s[32:35], s77 offen offset:1024 lds
v_mfma_f32_16x16x32_bf16 v[156:159], v[92:95], a[124:127], v[156:159]
ds_read_b64_tr_b16 v[124:125], v17 offset:1024
s_waitcnt lgkmcnt(7)
v_mfma_f32_16x16x32_bf16 v[128:131], v[96:99], a[128:131], v[128:131]
ds_read_b64_tr_b16 v[126:127], v17 offset:17408
ds_read_b64_tr_b16 v[80:81], v14 offset:2048
v_mfma_f32_16x16x32_bf16 v[144:147], v[96:99], a[132:135], v[144:147]
ds_read_b64_tr_b16 v[82:83], v14 offset:18432
v_mfma_f32_16x16x32_bf16 v[132:135], v[100:103], a[128:131], v[132:135]
ds_read_b64_tr_b16 v[84:85], v15 offset:2048
ds_read_b64_tr_b16 v[86:87], v15 offset:18432
v_mfma_f32_16x16x32_bf16 v[148:151], v[100:103], a[132:135], v[148:151]
buffer_load_dwordx4 v24, s[32:35], s77 offen offset:2048 lds
v_mfma_f32_16x16x32_bf16 v[136:139], v[104:107], a[128:131], v[136:139]
s_mov_b32 s3, 0x0
ds_read_b64_tr_b16 v[88:89], v16 offset:2048
v_mfma_f32_16x16x32_bf16 v[152:155], v[104:107], a[132:135], v[152:155]
buffer_load_dword v57, v8, s[44:47], s3 offen
v_mfma_f32_16x16x32_bf16 v[140:143], v[108:111], a[128:131], v[140:143]
ds_read_b64_tr_b16 v[90:91], v16 offset:18432
ds_read_b64_tr_b16 v[92:93], v17 offset:2048
v_mfma_f32_16x16x32_bf16 v[156:159], v[108:111], a[132:135], v[156:159]
ds_read_b64_tr_b16 v[94:95], v17 offset:18432
s_waitcnt lgkmcnt(7)
v_mfma_f32_16x16x32_bf16 v[128:131], v[112:115], a[136:139], v[128:131]
buffer_load_dwordx4 v25, s[32:35], s77 offen offset:3072 lds
v_mfma_f32_16x16x32_bf16 v[144:147], v[112:115], a[140:143], v[144:147]
ds_read_b64_tr_b16 v[96:97], v14 offset:3072
ds_read_b64_tr_b16 v[98:99], v14 offset:19456
v_mfma_f32_16x16x32_bf16 v[132:135], v[116:119], a[136:139], v[132:135]
ds_read_b64_tr_b16 v[100:101], v15 offset:3072
v_mfma_f32_16x16x32_bf16 v[148:151], v[116:119], a[140:143], v[148:151]
ds_read_b64_tr_b16 v[102:103], v15 offset:19456
ds_read_b64_tr_b16 v[104:105], v16 offset:3072
v_mfma_f32_16x16x32_bf16 v[136:139], v[120:123], a[136:139], v[136:139]
ds_read_b64_tr_b16 v[106:107], v16 offset:19456
v_mfma_f32_16x16x32_bf16 v[152:155], v[120:123], a[140:143], v[152:155]
s_add_u32 m0, s76, 36864
s_add_u32 s77, s82, 0xc1000
v_mfma_f32_16x16x32_bf16 v[140:143], v[124:127], a[136:139], v[140:143]
buffer_load_dwordx4 v22, s[32:35], s77 offen offset:0 lds
v_mfma_f32_16x16x32_bf16 v[156:159], v[124:127], a[140:143], v[156:159]
ds_read_b64_tr_b16 v[108:109], v17 offset:3072
s_waitcnt lgkmcnt(7)
v_mfma_f32_16x16x32_bf16 v[128:131], v[80:83], a[144:147], v[128:131]
ds_read_b64_tr_b16 v[110:111], v17 offset:19456
ds_read_b64_tr_b16 v[112:113], v14 offset:4096
v_mfma_f32_16x16x32_bf16 v[144:147], v[80:83], a[148:151], v[144:147]
ds_read_b64_tr_b16 v[114:115], v14 offset:20480
v_mfma_f32_16x16x32_bf16 v[132:135], v[84:87], a[144:147], v[132:135]
ds_read_b64_tr_b16 v[116:117], v15 offset:4096
ds_read_b64_tr_b16 v[118:119], v15 offset:20480
v_mfma_f32_16x16x32_bf16 v[148:151], v[84:87], a[148:151], v[148:151]
buffer_load_dwordx4 v23, s[32:35], s77 offen offset:1024 lds
v_mfma_f32_16x16x32_bf16 v[136:139], v[88:91], a[144:147], v[136:139]
ds_read_b64_tr_b16 v[120:121], v16 offset:4096
ds_read_b64_tr_b16 v[122:123], v16 offset:20480
v_mfma_f32_16x16x32_bf16 v[152:155], v[88:91], a[148:151], v[152:155]
ds_read_b64_tr_b16 v[124:125], v17 offset:4096
v_mfma_f32_16x16x32_bf16 v[140:143], v[92:95], a[144:147], v[140:143]
ds_read_b64_tr_b16 v[126:127], v17 offset:20480
ds_read_b64_tr_b16 v[80:81], v14 offset:5120
v_mfma_f32_16x16x32_bf16 v[156:159], v[92:95], a[148:151], v[156:159]
ds_read_b64_tr_b16 v[82:83], v14 offset:21504
s_waitcnt lgkmcnt(9)
v_mfma_f32_16x16x32_bf16 v[128:131], v[96:99], a[152:155], v[128:131]
buffer_load_dwordx4 v24, s[32:35], s77 offen offset:2048 lds
v_mfma_f32_16x16x32_bf16 v[144:147], v[96:99], a[156:159], v[144:147]
ds_read_b64_tr_b16 v[84:85], v15 offset:5120
ds_read_b64_tr_b16 v[86:87], v15 offset:21504
v_mfma_f32_16x16x32_bf16 v[132:135], v[100:103], a[152:155], v[132:135]
ds_read_b64_tr_b16 v[88:89], v16 offset:5120
v_mfma_f32_16x16x32_bf16 v[148:151], v[100:103], a[156:159], v[148:151]
ds_read_b64_tr_b16 v[90:91], v16 offset:21504
ds_read_b64_tr_b16 v[92:93], v17 offset:5120
v_mfma_f32_16x16x32_bf16 v[136:139], v[104:107], a[152:155], v[136:139]
ds_read_b64_tr_b16 v[94:95], v17 offset:21504
v_mfma_f32_16x16x32_bf16 v[152:155], v[104:107], a[156:159], v[152:155]
buffer_load_dwordx4 v25, s[32:35], s77 offen offset:3072 lds
v_mfma_f32_16x16x32_bf16 v[140:143], v[108:111], a[152:155], v[140:143]
ds_read_b64_tr_b16 v[96:97], v14 offset:6144
ds_read_b64_tr_b16 v[98:99], v14 offset:22528
v_mfma_f32_16x16x32_bf16 v[156:159], v[108:111], a[156:159], v[156:159]
ds_read_b64_tr_b16 v[100:101], v15 offset:6144
s_waitcnt lgkmcnt(9)
v_mfma_f32_16x16x32_bf16 v[128:131], v[112:115], a[160:163], v[128:131]
ds_read_b64_tr_b16 v[102:103], v15 offset:22528
ds_read_b64_tr_b16 v[104:105], v16 offset:6144
v_mfma_f32_16x16x32_bf16 v[144:147], v[112:115], a[164:167], v[144:147]
ds_read_b64_tr_b16 v[106:107], v16 offset:22528
v_mfma_f32_16x16x32_bf16 v[132:135], v[116:119], a[160:163], v[132:135]
ds_read_b64_tr_b16 v[108:109], v17 offset:6144
ds_read_b64_tr_b16 v[110:111], v17 offset:22528
v_mfma_f32_16x16x32_bf16 v[148:151], v[116:119], a[164:167], v[148:151]
ds_read_b64_tr_b16 v[112:113], v14 offset:7168
v_mfma_f32_16x16x32_bf16 v[136:139], v[120:123], a[160:163], v[136:139]
ds_read_b64_tr_b16 v[114:115], v14 offset:23552
ds_read_b64_tr_b16 v[116:117], v15 offset:7168
v_mfma_f32_16x16x32_bf16 v[152:155], v[120:123], a[164:167], v[152:155]
ds_read_b64_tr_b16 v[118:119], v15 offset:23552
v_mfma_f32_16x16x32_bf16 v[140:143], v[124:127], a[160:163], v[140:143]
ds_read_b64_tr_b16 v[120:121], v16 offset:7168
v_mfma_f32_16x16x32_bf16 v[156:159], v[124:127], a[164:167], v[156:159]
ds_read_b64_tr_b16 v[122:123], v16 offset:23552
v_mfma_f32_16x16x32_bf16 v[128:131], v[80:83], a[168:171], v[128:131]
ds_read_b64_tr_b16 v[124:125], v17 offset:7168
v_mfma_f32_16x16x32_bf16 v[144:147], v[80:83], a[172:175], v[144:147]
ds_read_b64_tr_b16 v[126:127], v17 offset:23552
s_waitcnt lgkmcnt(8)
v_mfma_f32_16x16x32_bf16 v[132:135], v[84:87], a[168:171], v[132:135]
v_mfma_f32_16x16x32_bf16 v[148:151], v[84:87], a[172:175], v[148:151]
v_mfma_f32_16x16x32_bf16 v[136:139], v[88:91], a[168:171], v[136:139]
v_mfma_f32_16x16x32_bf16 v[152:155], v[88:91], a[172:175], v[152:155]
v_mfma_f32_16x16x32_bf16 v[140:143], v[92:95], a[168:171], v[140:143]
s_waitcnt vmcnt(23) lgkmcnt(0)
s_barrier
v_mfma_f32_16x16x32_bf16 v[156:159], v[92:95], a[172:175], v[156:159]
s_add_u32 m0, s76, 65536
s_add_u32 s77, s82, 0x181000
v_mfma_f32_16x16x32_bf16 v[128:131], v[96:99], a[176:179], v[128:131]
buffer_load_dwordx4 v22, s[32:35], s77 offen offset:0 lds
v_mfma_f32_16x16x32_bf16 v[144:147], v[96:99], a[180:183], v[144:147]
ds_read_b64_tr_b16 v[80:81], v14 offset:32768
ds_read_b64_tr_b16 v[82:83], v14 offset:49152
v_mfma_f32_16x16x32_bf16 v[132:135], v[100:103], a[176:179], v[132:135]
ds_read_b64_tr_b16 v[84:85], v15 offset:32768
v_mfma_f32_16x16x32_bf16 v[148:151], v[100:103], a[180:183], v[148:151]
ds_read_b64_tr_b16 v[86:87], v15 offset:49152
ds_read_b64_tr_b16 v[88:89], v16 offset:32768
v_mfma_f32_16x16x32_bf16 v[136:139], v[104:107], a[176:179], v[136:139]
ds_read_b64_tr_b16 v[90:91], v16 offset:49152
v_mfma_f32_16x16x32_bf16 v[152:155], v[104:107], a[180:183], v[152:155]
buffer_load_dwordx4 v23, s[32:35], s77 offen offset:1024 lds
v_mfma_f32_16x16x32_bf16 v[140:143], v[108:111], a[176:179], v[140:143]
ds_read_b64_tr_b16 v[92:93], v17 offset:32768
ds_read_b64_tr_b16 v[94:95], v17 offset:49152
v_mfma_f32_16x16x32_bf16 v[156:159], v[108:111], a[180:183], v[156:159]
ds_read_b64_tr_b16 v[96:97], v14 offset:33792
v_mfma_f32_16x16x32_bf16 v[128:131], v[112:115], a[184:187], v[128:131]
ds_read_b64_tr_b16 v[98:99], v14 offset:50176
ds_read_b64_tr_b16 v[100:101], v15 offset:33792
v_mfma_f32_16x16x32_bf16 v[144:147], v[112:115], a[188:191], v[144:147]
ds_read_b64_tr_b16 v[102:103], v15 offset:50176
v_mfma_f32_16x16x32_bf16 v[132:135], v[116:119], a[184:187], v[132:135]
buffer_load_dwordx4 v24, s[32:35], s77 offen offset:2048 lds
v_mfma_f32_16x16x32_bf16 v[148:151], v[116:119], a[188:191], v[148:151]
ds_read_b64_tr_b16 v[104:105], v16 offset:33792
ds_read_b64_tr_b16 v[106:107], v16 offset:50176
v_mfma_f32_16x16x32_bf16 v[136:139], v[120:123], a[184:187], v[136:139]
ds_read_b64_tr_b16 v[108:109], v17 offset:33792
v_mfma_f32_16x16x32_bf16 v[152:155], v[120:123], a[188:191], v[152:155]
ds_read_b64_tr_b16 v[110:111], v17 offset:50176
ds_read_b64_tr_b16 v[112:113], v14 offset:34816
v_mfma_f32_16x16x32_bf16 v[140:143], v[124:127], a[184:187], v[140:143]
ds_read_b64_tr_b16 v[114:115], v14 offset:51200
v_mfma_f32_16x16x32_bf16 v[156:159], v[124:127], a[188:191], v[156:159]
ds_read_b64_tr_b16 v[116:117], v15 offset:34816
s_waitcnt lgkmcnt(8)
v_mfma_f32_16x16x32_bf16 v[128:131], v[80:83], a[192:195], v[128:131]
buffer_load_dwordx4 v25, s[32:35], s77 offen offset:3072 lds
v_mfma_f32_16x16x32_bf16 v[144:147], v[80:83], a[196:199], v[144:147]
ds_read_b64_tr_b16 v[118:119], v15 offset:51200
ds_read_b64_tr_b16 v[120:121], v16 offset:34816
v_mfma_f32_16x16x32_bf16 v[132:135], v[84:87], a[192:195], v[132:135]
ds_read_b64_tr_b16 v[122:123], v16 offset:51200
v_mfma_f32_16x16x32_bf16 v[148:151], v[84:87], a[196:199], v[148:151]
ds_read_b64_tr_b16 v[124:125], v17 offset:34816
ds_read_b64_tr_b16 v[126:127], v17 offset:51200
v_mfma_f32_16x16x32_bf16 v[136:139], v[88:91], a[192:195], v[136:139]
ds_read_b64_tr_b16 v[80:81], v14 offset:35840
v_mfma_f32_16x16x32_bf16 v[152:155], v[88:91], a[196:199], v[152:155]
s_add_u32 m0, s76, 69632
s_add_u32 s77, s82, 0x241000
v_mfma_f32_16x16x32_bf16 v[140:143], v[92:95], a[192:195], v[140:143]
buffer_load_dwordx4 v22, s[32:35], s77 offen offset:0 lds
v_mfma_f32_16x16x32_bf16 v[156:159], v[92:95], a[196:199], v[156:159]
ds_read_b64_tr_b16 v[82:83], v14 offset:52224
ds_read_b64_tr_b16 v[84:85], v15 offset:35840
v_mfma_f32_16x16x32_bf16 v[128:131], v[96:99], a[200:203], v[128:131]
ds_read_b64_tr_b16 v[86:87], v15 offset:52224
v_mfma_f32_16x16x32_bf16 v[144:147], v[96:99], a[204:207], v[144:147]
ds_read_b64_tr_b16 v[88:89], v16 offset:35840
s_waitcnt lgkmcnt(7)
v_mfma_f32_16x16x32_bf16 v[132:135], v[100:103], a[200:203], v[132:135]
ds_read_b64_tr_b16 v[90:91], v16 offset:52224
ds_read_b64_tr_b16 v[92:93], v17 offset:35840
v_mfma_f32_16x16x32_bf16 v[148:151], v[100:103], a[204:207], v[148:151]
buffer_load_dwordx4 v23, s[32:35], s77 offen offset:1024 lds
v_mfma_f32_16x16x32_bf16 v[136:139], v[104:107], a[200:203], v[136:139]
ds_read_b64_tr_b16 v[94:95], v17 offset:52224
ds_read_b64_tr_b16 v[96:97], v14 offset:36864
v_mfma_f32_16x16x32_bf16 v[152:155], v[104:107], a[204:207], v[152:155]
ds_read_b64_tr_b16 v[98:99], v14 offset:53248
v_mfma_f32_16x16x32_bf16 v[140:143], v[108:111], a[200:203], v[140:143]
ds_read_b64_tr_b16 v[100:101], v15 offset:36864
ds_read_b64_tr_b16 v[102:103], v15 offset:53248
v_mfma_f32_16x16x32_bf16 v[156:159], v[108:111], a[204:207], v[156:159]
ds_read_b64_tr_b16 v[104:105], v16 offset:36864
v_mfma_f32_16x16x32_bf16 v[128:131], v[112:115], a[208:211], v[128:131]
buffer_load_dwordx4 v24, s[32:35], s77 offen offset:2048 lds
v_mfma_f32_16x16x32_bf16 v[144:147], v[112:115], a[212:215], v[144:147]
ds_read_b64_tr_b16 v[106:107], v16 offset:53248
ds_read_b64_tr_b16 v[108:109], v17 offset:36864
v_mfma_f32_16x16x32_bf16 v[132:135], v[116:119], a[208:211], v[132:135]
ds_read_b64_tr_b16 v[110:111], v17 offset:53248
v_mfma_f32_16x16x32_bf16 v[148:151], v[116:119], a[212:215], v[148:151]
ds_read_b64_tr_b16 v[112:113], v14 offset:37888
ds_read_b64_tr_b16 v[114:115], v14 offset:54272
v_mfma_f32_16x16x32_bf16 v[136:139], v[120:123], a[208:211], v[136:139]
ds_read_b64_tr_b16 v[116:117], v15 offset:37888
v_mfma_f32_16x16x32_bf16 v[152:155], v[120:123], a[212:215], v[152:155]
ds_read_b64_tr_b16 v[118:119], v15 offset:54272
s_waitcnt lgkmcnt(8)
v_mfma_f32_16x16x32_bf16 v[140:143], v[124:127], a[208:211], v[140:143]
buffer_load_dwordx4 v25, s[32:35], s77 offen offset:3072 lds
v_mfma_f32_16x16x32_bf16 v[156:159], v[124:127], a[212:215], v[156:159]
ds_read_b64_tr_b16 v[120:121], v16 offset:37888
ds_read_b64_tr_b16 v[122:123], v16 offset:54272
v_mfma_f32_16x16x32_bf16 v[128:131], v[80:83], a[216:219], v[128:131]
ds_read_b64_tr_b16 v[124:125], v17 offset:37888
v_mfma_f32_16x16x32_bf16 v[144:147], v[80:83], a[220:223], v[144:147]
ds_read_b64_tr_b16 v[126:127], v17 offset:54272
v_mfma_f32_16x16x32_bf16 v[132:135], v[84:87], a[216:219], v[132:135]
ds_read_b64_tr_b16 v[80:81], v14 offset:38912
v_mfma_f32_16x16x32_bf16 v[148:151], v[84:87], a[220:223], v[148:151]
ds_read_b64_tr_b16 v[82:83], v14 offset:55296
v_mfma_f32_16x16x32_bf16 v[136:139], v[88:91], a[216:219], v[136:139]
ds_read_b64_tr_b16 v[84:85], v15 offset:38912
v_mfma_f32_16x16x32_bf16 v[152:155], v[88:91], a[220:223], v[152:155]
ds_read_b64_tr_b16 v[86:87], v15 offset:55296
v_mfma_f32_16x16x32_bf16 v[140:143], v[92:95], a[216:219], v[140:143]
ds_read_b64_tr_b16 v[88:89], v16 offset:38912
v_mfma_f32_16x16x32_bf16 v[156:159], v[92:95], a[220:223], v[156:159]
ds_read_b64_tr_b16 v[90:91], v16 offset:55296
v_mfma_f32_16x16x32_bf16 v[128:131], v[96:99], a[224:227], v[128:131]
ds_read_b64_tr_b16 v[92:93], v17 offset:38912
v_mfma_f32_16x16x32_bf16 v[144:147], v[96:99], a[228:231], v[144:147]
ds_read_b64_tr_b16 v[94:95], v17 offset:55296
v_mfma_f32_16x16x32_bf16 v[132:135], v[100:103], a[224:227], v[132:135]
ds_read_b64_tr_b16 v[96:97], v14 offset:39936
v_mfma_f32_16x16x32_bf16 v[148:151], v[100:103], a[228:231], v[148:151]
ds_read_b64_tr_b16 v[98:99], v14 offset:56320
s_waitcnt lgkmcnt(7)
v_mfma_f32_16x16x32_bf16 v[136:139], v[104:107], a[224:227], v[136:139]
ds_read_b64_tr_b16 v[100:101], v15 offset:39936
v_mfma_f32_16x16x32_bf16 v[152:155], v[104:107], a[228:231], v[152:155]
ds_read_b64_tr_b16 v[102:103], v15 offset:56320
v_mfma_f32_16x16x32_bf16 v[140:143], v[108:111], a[224:227], v[140:143]
ds_read_b64_tr_b16 v[104:105], v16 offset:39936
v_mfma_f32_16x16x32_bf16 v[156:159], v[108:111], a[228:231], v[156:159]
ds_read_b64_tr_b16 v[106:107], v16 offset:56320
v_mfma_f32_16x16x32_bf16 v[128:131], v[112:115], a[232:235], v[128:131]
ds_read_b64_tr_b16 v[108:109], v17 offset:39936
v_mfma_f32_16x16x32_bf16 v[144:147], v[112:115], a[236:239], v[144:147]
ds_read_b64_tr_b16 v[110:111], v17 offset:56320
v_mfma_f32_16x16x32_bf16 v[132:135], v[116:119], a[232:235], v[132:135]
v_mfma_f32_16x16x32_bf16 v[148:151], v[116:119], a[236:239], v[148:151]
v_mfma_f32_16x16x32_bf16 v[136:139], v[120:123], a[232:235], v[136:139]
v_mfma_f32_16x16x32_bf16 v[152:155], v[120:123], a[236:239], v[152:155]
v_mfma_f32_16x16x32_bf16 v[140:143], v[124:127], a[232:235], v[140:143]
s_waitcnt vmcnt(18) lgkmcnt(0)
s_barrier
v_mfma_f32_16x16x32_bf16 v[156:159], v[124:127], a[236:239], v[156:159]
s_add_u32 m0, s76, 98304
s_add_u32 s77, s82, 0x301000
v_mfma_f32_16x16x32_bf16 v[128:131], v[80:83], a[240:243], v[128:131]
buffer_load_dwordx4 v22, s[32:35], s77 offen offset:0 lds
v_mfma_f32_16x16x32_bf16 v[144:147], v[80:83], a[244:247], v[144:147]
ds_read_b64_tr_b16 v[112:113], v55 offset:0
ds_read_b64_tr_b16 v[114:115], v55 offset:16384
v_mfma_f32_16x16x32_bf16 v[132:135], v[84:87], a[240:243], v[132:135]
ds_read_b64_tr_b16 v[116:117], v55 offset:1024
v_mfma_f32_16x16x32_bf16 v[148:151], v[84:87], a[244:247], v[148:151]
ds_read_b64_tr_b16 v[118:119], v55 offset:17408
ds_read_b64_tr_b16 v[120:121], v55 offset:2048
v_mfma_f32_16x16x32_bf16 v[136:139], v[88:91], a[240:243], v[136:139]
ds_read_b64_tr_b16 v[122:123], v55 offset:18432
v_mfma_f32_16x16x32_bf16 v[152:155], v[88:91], a[244:247], v[152:155]
buffer_load_dwordx4 v23, s[32:35], s77 offen offset:1024 lds
v_mfma_f32_16x16x32_bf16 v[140:143], v[92:95], a[240:243], v[140:143]
ds_read_b64_tr_b16 v[124:125], v55 offset:3072
ds_read_b64_tr_b16 v[126:127], v55 offset:19456
v_mfma_f32_16x16x32_bf16 v[156:159], v[92:95], a[244:247], v[156:159]
ds_read_b64_tr_b16 v[80:81], v55 offset:4096
v_mfma_f32_16x16x32_bf16 v[128:131], v[96:99], a[248:251], v[128:131]
ds_read_b64_tr_b16 v[82:83], v55 offset:20480
ds_read_b64_tr_b16 v[84:85], v55 offset:5120
v_mfma_f32_16x16x32_bf16 v[144:147], v[96:99], a[252:255], v[144:147]
ds_read_b64_tr_b16 v[86:87], v55 offset:21504
v_mfma_f32_16x16x32_bf16 v[132:135], v[100:103], a[248:251], v[132:135]
buffer_load_dwordx4 v24, s[32:35], s77 offen offset:2048 lds
v_mfma_f32_16x16x32_bf16 v[148:151], v[100:103], a[252:255], v[148:151]
ds_read_b64_tr_b16 v[88:89], v55 offset:6144
ds_read_b64_tr_b16 v[90:91], v55 offset:22528
v_mfma_f32_16x16x32_bf16 v[136:139], v[104:107], a[248:251], v[136:139]
ds_read_b64_tr_b16 v[92:93], v55 offset:7168
v_mfma_f32_16x16x32_bf16 v[152:155], v[104:107], a[252:255], v[152:155]
ds_read_b64_tr_b16 v[94:95], v55 offset:23552
v_mfma_f32_16x16x32_bf16 v[140:143], v[108:111], a[248:251], v[140:143]
buffer_load_dwordx4 v25, s[32:35], s77 offen offset:3072 lds
v_mfma_f32_16x16x32_bf16 v[156:159], v[108:111], a[252:255], v[156:159]
s_add_u32 m0, s76, 102400
s_waitcnt lgkmcnt(5)
v_mfma_f32_16x16x32_bf16 v[76:79], v[112:115], v[160:163], 0
s_add_u32 s77, s82, 0x3c1000
v_mfma_f32_16x16x32_bf16 v[76:79], v[116:119], v[164:167], v[76:79]
buffer_load_dwordx4 v22, s[32:35], s77 offen offset:0 lds
v_mfma_f32_16x16x32_bf16 v[76:79], v[120:123], v[168:171], v[76:79]
s_waitcnt vmcnt(13) lgkmcnt(0)
s_barrier
v_mfma_f32_16x16x32_bf16 v[76:79], v[124:127], v[172:175], v[76:79]
ds_read_b64_tr_b16 v[96:97], v10 offset:32768
ds_read_b64_tr_b16 v[98:99], v10 offset:49152
v_mfma_f32_16x16x32_bf16 v[76:79], v[80:83], v[176:179], v[76:79]
ds_read_b64_tr_b16 v[100:101], v11 offset:32768
ds_read_b64_tr_b16 v[102:103], v11 offset:49152
v_mfma_f32_16x16x32_bf16 v[76:79], v[84:87], v[180:183], v[76:79]
ds_read_b64_tr_b16 v[104:105], v12 offset:32768
ds_read_b64_tr_b16 v[106:107], v12 offset:49152
v_mfma_f32_16x16x32_bf16 v[76:79], v[88:91], v[184:187], v[76:79]
ds_read_b64_tr_b16 v[108:109], v13 offset:32768
ds_read_b64_tr_b16 v[110:111], v13 offset:49152
v_mfma_f32_16x16x32_bf16 v[76:79], v[92:95], v[188:191], v[76:79]
ds_read_b64_tr_b16 v[112:113], v10 offset:33792
ds_read_b64_tr_b16 v[114:115], v10 offset:50176
S_V:
s_waitcnt lgkmcnt(8)
v_mfma_f32_16x16x32_bf16 v[160:163], a[0:3], v[96:99], 0
ds_read_b64_tr_b16 v[116:117], v11 offset:33792
ds_read_b64_tr_b16 v[118:119], v11 offset:50176
v_mfma_f32_16x16x32_bf16 v[176:179], a[4:7], v[96:99], 0
ds_read_b64_tr_b16 v[120:121], v12 offset:33792
s_waitcnt lgkmcnt(9)
v_mfma_f32_16x16x32_bf16 v[164:167], a[0:3], v[100:103], 0
ds_read_b64_tr_b16 v[122:123], v12 offset:50176
ds_read_b64_tr_b16 v[124:125], v13 offset:33792
v_mfma_f32_16x16x32_bf16 v[180:183], a[4:7], v[100:103], 0
ds_read_b64_tr_b16 v[126:127], v13 offset:50176
s_waitcnt lgkmcnt(10)
v_mfma_f32_16x16x32_bf16 v[168:171], a[0:3], v[104:107], 0
ds_read_b64_tr_b16 v[80:81], v10 offset:34816
ds_read_b64_tr_b16 v[82:83], v10 offset:51200
v_mfma_f32_16x16x32_bf16 v[184:187], a[4:7], v[104:107], 0
ds_read_b64_tr_b16 v[84:85], v11 offset:34816
s_waitcnt lgkmcnt(11)
v_mfma_f32_16x16x32_bf16 v[172:175], a[0:3], v[108:111], 0
ds_read_b64_tr_b16 v[86:87], v11 offset:51200
ds_read_b64_tr_b16 v[88:89], v12 offset:34816
v_mfma_f32_16x16x32_bf16 v[188:191], a[4:7], v[108:111], 0
ds_read_b64_tr_b16 v[90:91], v12 offset:51200
s_waitcnt lgkmcnt(10)
v_mfma_f32_16x16x32_bf16 v[160:163], a[8:11], v[112:115], v[160:163]
ds_read_b64_tr_b16 v[92:93], v13 offset:34816
ds_read_b64_tr_b16 v[94:95], v13 offset:51200
v_mfma_f32_16x16x32_bf16 v[176:179], a[12:15], v[112:115], v[176:179]
buffer_load_dwordx4 v23, s[32:35], s77 offen offset:1024 lds
v_mfma_f32_16x16x32_bf16 v[164:167], a[8:11], v[116:119], v[164:167]
ds_read_b64_tr_b16 v[96:97], v10 offset:35840
ds_read_b64_tr_b16 v[98:99], v10 offset:52224
v_mfma_f32_16x16x32_bf16 v[180:183], a[12:15], v[116:119], v[180:183]
ds_read_b64_tr_b16 v[100:101], v11 offset:35840
s_waitcnt lgkmcnt(9)
v_mfma_f32_16x16x32_bf16 v[168:171], a[8:11], v[120:123], v[168:171]
s_add_u32 s70, s0, S_Q - K_pc + 0
s_addc_u32 s71, s1, 0
global_load_dword v57, v9, s[70:71]
v_mfma_f32_16x16x32_bf16 v[184:187], a[12:15], v[120:123], v[184:187]
ds_read_b64_tr_b16 v[102:103], v11 offset:52224
s_mov_b32 s3, 0x200000
v_mfma_f32_16x16x32_bf16 v[172:175], a[8:11], v[124:127], v[172:175]
ds_read_b64_tr_b16 v[104:105], v12 offset:35840
ds_read_b64_tr_b16 v[106:107], v12 offset:52224
v_mfma_f32_16x16x32_bf16 v[188:191], a[12:15], v[124:127], v[188:191]
buffer_load_dwordx4 v24, s[32:35], s77 offen offset:2048 lds
v_mfma_f32_16x16x32_bf16 v[160:163], a[16:19], v[80:83], v[160:163]
ds_read_b64_tr_b16 v[108:109], v13 offset:35840
ds_read_b64_tr_b16 v[110:111], v13 offset:52224
v_mfma_f32_16x16x32_bf16 v[176:179], a[20:23], v[80:83], v[176:179]
ds_read_b64_tr_b16 v[112:113], v10 offset:36864
s_waitcnt lgkmcnt(7)
v_mfma_f32_16x16x32_bf16 v[164:167], a[16:19], v[84:87], v[164:167]
buffer_load_dword v57, v8, s[40:43], s3 offen
v_mfma_f32_16x16x32_bf16 v[180:183], a[20:23], v[84:87], v[180:183]
ds_read_b64_tr_b16 v[114:115], v10 offset:53248
ds_read_b64_tr_b16 v[116:117], v11 offset:36864
v_mfma_f32_16x16x32_bf16 v[168:171], a[16:19], v[88:91], v[168:171]
buffer_load_dwordx4 v25, s[32:35], s77 offen offset:3072 lds
v_mfma_f32_16x16x32_bf16 v[184:187], a[20:23], v[88:91], v[184:187]
ds_read_b64_tr_b16 v[118:119], v11 offset:53248
ds_read_b64_tr_b16 v[120:121], v12 offset:36864
v_mfma_f32_16x16x32_bf16 v[172:175], a[16:19], v[92:95], v[172:175]
s_lshr_b32 s78, s2, 6
s_lshl_b32 s78, s78, 14
s_and_b32 s79, s2, 63
s_lshl_b32 s79, s79, 8
s_add_u32 s78, s78, s79
s_lshl_b32 s79, s72, 6
s_add_u32 s78, s78, s79
s_add_u32 s78, s78, 589824
v_add_u32 v55, s78, v1
v_mfma_f32_16x16x32_bf16 v[188:191], a[20:23], v[92:95], v[188:191]
ds_read_b64_tr_b16 v[122:123], v12 offset:53248
ds_read_b64_tr_b16 v[124:125], v13 offset:36864
v_mfma_f32_16x16x32_bf16 v[160:163], a[24:27], v[96:99], v[160:163]
v_and_b32 v56, 15, v1
v_cmp_eq_u32 vcc, 0, v56
v_mov_b32 v56, s96
s_nop 0
v_cndmask_b32 v55, v56, v55, vcc
v_mfma_f32_16x16x32_bf16 v[176:179], a[28:31], v[96:99], v[176:179]
ds_read_b64_tr_b16 v[126:127], v13 offset:53248
s_waitcnt lgkmcnt(7)
v_mfma_f32_16x16x32_bf16 v[164:167], a[24:27], v[100:103], v[164:167]
ds_read_b64_tr_b16 v[80:81], v10 offset:37888
s_add_u32 m0, s76, 0
v_mfma_f32_16x16x32_bf16 v[180:183], a[28:31], v[100:103], v[180:183]
ds_read_b64_tr_b16 v[82:83], v10 offset:54272
s_add_u32 s77, s82, 0x481000
v_mfma_f32_16x16x32_bf16 v[168:171], a[24:27], v[104:107], v[168:171]
ds_read_b64_tr_b16 v[84:85], v11 offset:37888
ds_read_b64_tr_b16 v[86:87], v11 offset:54272
v_mfma_f32_16x16x32_bf16 v[184:187], a[28:31], v[104:107], v[184:187]
buffer_load_dwordx4 v22, s[32:35], s77 offen offset:0 lds
v_mfma_f32_16x16x32_bf16 v[172:175], a[24:27], v[108:111], v[172:175]
ds_read_b64_tr_b16 v[88:89], v12 offset:37888
ds_read_b64_tr_b16 v[90:91], v12 offset:54272
v_mfma_f32_16x16x32_bf16 v[188:191], a[28:31], v[108:111], v[188:191]
ds_read_b64_tr_b16 v[92:93], v13 offset:37888
s_waitcnt lgkmcnt(8)
v_mfma_f32_16x16x32_bf16 v[160:163], a[32:35], v[112:115], v[160:163]
buffer_store_dwordx4 v[76:79], v55, s[60:63], 0 offen sc1
v_mfma_f32_16x16x32_bf16 v[176:179], a[36:39], v[112:115], v[176:179]
ds_read_b64_tr_b16 v[94:95], v13 offset:54272
ds_read_b64_tr_b16 v[96:97], v10 offset:38912
v_mfma_f32_16x16x32_bf16 v[164:167], a[32:35], v[116:119], v[164:167]
buffer_load_dwordx4 v23, s[32:35], s77 offen offset:1024 lds
v_mfma_f32_16x16x32_bf16 v[180:183], a[36:39], v[116:119], v[180:183]
ds_read_b64_tr_b16 v[98:99], v10 offset:55296
ds_read_b64_tr_b16 v[100:101], v11 offset:38912
v_mfma_f32_16x16x32_bf16 v[168:171], a[32:35], v[120:123], v[168:171]
s_and_b32 s78, s2, 7
s_lshl_b32 s78, s78, 11
s_add_u32 s78, s78, 16384
v_lshl_add_u32 v55, v1, 7, s78
v_cmp_gt_u32 vcc, 16, v0
s_nop 1
v_cndmask_b32 v55, v56, v55, vcc
v_mfma_f32_16x16x32_bf16 v[184:187], a[36:39], v[120:123], v[184:187]
ds_read_b64_tr_b16 v[102:103], v11 offset:55296
s_waitcnt lgkmcnt(6)
v_mfma_f32_16x16x32_bf16 v[172:175], a[32:35], v[124:127], v[172:175]
ds_read_b64_tr_b16 v[104:105], v12 offset:38912
ds_read_b64_tr_b16 v[106:107], v12 offset:55296
v_mfma_f32_16x16x32_bf16 v[188:191], a[36:39], v[124:127], v[188:191]
buffer_load_dwordx4 v24, s[32:35], s77 offen offset:2048 lds
v_mfma_f32_16x16x32_bf16 v[160:163], a[40:43], v[80:83], v[160:163]
ds_read_b64_tr_b16 v[108:109], v13 offset:38912
ds_read_b64_tr_b16 v[110:111], v13 offset:55296
v_mfma_f32_16x16x32_bf16 v[176:179], a[44:47], v[80:83], v[176:179]
s_lshl_b32 s78, s72, 12
s_add_u32 s78, s78, 151552
v_add_u32 v53, s78, v46
v_mfma_f32_16x16x32_bf16 v[164:167], a[40:43], v[84:87], v[164:167]
ds_read_b64_tr_b16 v[112:113], v10 offset:39936
ds_read_b64_tr_b16 v[114:115], v10 offset:56320
v_mfma_f32_16x16x32_bf16 v[180:183], a[44:47], v[84:87], v[180:183]
s_lshl_b32 s78, s73, 4
s_add_u32 s78, s78, s74
s_lshl_b32 s78, s78, 12
s_add_u32 s78, s78, 0x100000
s_cmp_eq_u32 s72, 3
s_cselect_b32 s78, s78, s96
v_add_u32 v54, s78, v46
v_mfma_f32_16x16x32_bf16 v[168:171], a[40:43], v[88:91], v[168:171]
ds_read_b64_tr_b16 v[116:117], v11 offset:39936
v_mul_f32 v144, v59, v144
v_mfma_f32_16x16x32_bf16 v[184:187], a[44:47], v[88:91], v[184:187]
ds_read_b64_tr_b16 v[118:119], v11 offset:56320
s_waitcnt lgkmcnt(6)
v_mfma_f32_16x16x32_bf16 v[172:175], a[40:43], v[92:95], v[172:175]
ds_read_b64_tr_b16 v[120:121], v12 offset:39936
v_mul_f32 v145, v59, v145
v_mfma_f32_16x16x32_bf16 v[188:191], a[44:47], v[92:95], v[188:191]
ds_read_b64_tr_b16 v[122:123], v12 offset:56320
v_mul_f32 v146, v59, v146
v_mfma_f32_16x16x32_bf16 v[160:163], a[48:51], v[96:99], v[160:163]
ds_read_b64_tr_b16 v[124:125], v13 offset:39936
v_mul_f32 v147, v59, v147
v_mfma_f32_16x16x32_bf16 v[176:179], a[52:55], v[96:99], v[176:179]
ds_read_b64_tr_b16 v[126:127], v13 offset:56320
v_mul_f32 v148, v59, v148
v_mfma_f32_16x16x32_bf16 v[164:167], a[48:51], v[100:103], v[164:167]
buffer_load_dwordx4 v25, s[32:35], s77 offen offset:3072 lds
v_mfma_f32_16x16x32_bf16 v[180:183], a[52:55], v[100:103], v[180:183]
s_add_u32 m0, s76, 4096
s_add_u32 s77, s82, 0x541000
v_mfma_f32_16x16x32_bf16 v[168:171], a[48:51], v[104:107], v[168:171]
buffer_load_dwordx4 v22, s[32:35], s77 offen offset:0 lds
v_mfma_f32_16x16x32_bf16 v[184:187], a[52:55], v[104:107], v[184:187]
v_mul_f32 v149, v59, v149
s_waitcnt lgkmcnt(3)
v_mfma_f32_16x16x32_bf16 v[172:175], a[48:51], v[108:111], v[172:175]
s_waitcnt vmcnt(16) lgkmcnt(0)
s_barrier
v_mfma_f32_16x16x32_bf16 v[188:191], a[52:55], v[108:111], v[188:191]
ds_read_b64_tr_b16 v[80:81], v14 offset:0
ds_read_b64_tr_b16 v[82:83], v14 offset:16384
v_mfma_f32_16x16x32_bf16 v[160:163], a[56:59], v[112:115], v[160:163]
ds_read_b64_tr_b16 v[84:85], v15 offset:0
ds_read_b64_tr_b16 v[86:87], v15 offset:16384
v_mfma_f32_16x16x32_bf16 v[176:179], a[60:63], v[112:115], v[176:179]
ds_read_b64_tr_b16 v[88:89], v16 offset:0
ds_read_b64_tr_b16 v[90:91], v16 offset:16384
v_mfma_f32_16x16x32_bf16 v[164:167], a[56:59], v[116:119], v[164:167]
ds_read_b64_tr_b16 v[92:93], v17 offset:0
ds_read_b64_tr_b16 v[94:95], v17 offset:16384
v_mfma_f32_16x16x32_bf16 v[180:183], a[60:63], v[116:119], v[180:183]
ds_read_b64_tr_b16 v[96:97], v14 offset:1024
ds_read_b64_tr_b16 v[98:99], v14 offset:17408
v_mfma_f32_16x16x32_bf16 v[168:171], a[56:59], v[120:123], v[168:171]
ds_read_b64_tr_b16 v[100:101], v15 offset:1024
v_mul_f32 v150, v59, v150
v_mfma_f32_16x16x32_bf16 v[184:187], a[60:63], v[120:123], v[184:187]
ds_read_b64_tr_b16 v[102:103], v15 offset:17408
v_mul_f32 v151, v59, v151
v_mfma_f32_16x16x32_bf16 v[172:175], a[56:59], v[124:127], v[172:175]
ds_read_b64_tr_b16 v[104:105], v16 offset:1024
v_cvt_pk_bf16_f32 v200, v144, v145
v_mfma_f32_16x16x32_bf16 v[188:191], a[60:63], v[124:127], v[188:191]
ds_read_b64_tr_b16 v[106:107], v16 offset:17408
s_waitcnt lgkmcnt(10)
v_mfma_f32_16x16x32_bf16 v[160:163], a[64:67], v[80:83], v[160:163]
ds_read_b64_tr_b16 v[108:109], v17 offset:1024
v_cvt_pk_bf16_f32 v201, v146, v147
v_mfma_f32_16x16x32_bf16 v[176:179], a[68:71], v[80:83], v[176:179]
ds_read_b64_tr_b16 v[110:111], v17 offset:17408
v_cvt_pk_bf16_f32 v202, v148, v149
v_mfma_f32_16x16x32_bf16 v[164:167], a[64:67], v[84:87], v[164:167]
ds_read_b64_tr_b16 v[112:113], v14 offset:2048
v_cvt_pk_bf16_f32 v203, v150, v151
v_mfma_f32_16x16x32_bf16 v[180:183], a[68:71], v[84:87], v[180:183]
ds_read_b64_tr_b16 v[114:115], v14 offset:18432
s_waitcnt lgkmcnt(7)
v_mfma_f32_16x16x32_bf16 v[168:171], a[64:67], v[88:91], v[168:171]
ds_read_b64_tr_b16 v[116:117], v15 offset:2048
v_mul_f32 v152, v59, v152
v_mfma_f32_16x16x32_bf16 v[184:187], a[68:71], v[88:91], v[184:187]
ds_read_b64_tr_b16 v[118:119], v15 offset:18432
v_mul_f32 v153, v59, v153
v_mfma_f32_16x16x32_bf16 v[172:175], a[64:67], v[92:95], v[172:175]
ds_read_b64_tr_b16 v[120:121], v16 offset:2048
v_mul_f32 v154, v59, v154
v_mfma_f32_16x16x32_bf16 v[188:191], a[68:71], v[92:95], v[188:191]
ds_read_b64_tr_b16 v[122:123], v16 offset:18432
v_mul_f32 v155, v59, v155
v_mfma_f32_16x16x32_bf16 v[160:163], a[72:75], v[96:99], v[160:163]
ds_read_b64_tr_b16 v[124:125], v17 offset:2048
v_mul_f32 v156, v59, v156
v_mfma_f32_16x16x32_bf16 v[176:179], a[76:79], v[96:99], v[176:179]
ds_read_b64_tr_b16 v[126:127], v17 offset:18432
s_waitcnt lgkmcnt(7)
v_mfma_f32_16x16x32_bf16 v[164:167], a[72:75], v[100:103], v[164:167]
ds_read_b64_tr_b16 v[80:81], v14 offset:3072
v_mul_f32 v157, v59, v157
v_mfma_f32_16x16x32_bf16 v[180:183], a[76:79], v[100:103], v[180:183]
ds_read_b64_tr_b16 v[82:83], v14 offset:19456
v_mul_f32 v158, v59, v158
v_mfma_f32_16x16x32_bf16 v[168:171], a[72:75], v[104:107], v[168:171]
ds_read_b64_tr_b16 v[84:85], v15 offset:3072
v_mul_f32 v159, v59, v159
v_mfma_f32_16x16x32_bf16 v[184:187], a[76:79], v[104:107], v[184:187]
ds_read_b64_tr_b16 v[86:87], v15 offset:19456
v_cvt_pk_bf16_f32 v204, v152, v153
v_mfma_f32_16x16x32_bf16 v[172:175], a[72:75], v[108:111], v[172:175]
ds_read_b64_tr_b16 v[88:89], v16 offset:3072
v_cvt_pk_bf16_f32 v205, v154, v155
v_mfma_f32_16x16x32_bf16 v[188:191], a[76:79], v[108:111], v[188:191]
ds_read_b64_tr_b16 v[90:91], v16 offset:19456
s_waitcnt lgkmcnt(7)
v_mfma_f32_16x16x32_bf16 v[160:163], a[80:83], v[112:115], v[160:163]
ds_read_b64_tr_b16 v[92:93], v17 offset:3072
v_cvt_pk_bf16_f32 v206, v156, v157
v_mfma_f32_16x16x32_bf16 v[176:179], a[84:87], v[112:115], v[176:179]
ds_read_b64_tr_b16 v[94:95], v17 offset:19456
v_cvt_pk_bf16_f32 v207, v158, v159
v_mfma_f32_16x16x32_bf16 v[164:167], a[80:83], v[116:119], v[164:167]
ds_read_b64_tr_b16 v[96:97], v14 offset:4096
ds_read_b64_tr_b16 v[98:99], v14 offset:20480
v_mfma_f32_16x16x32_bf16 v[180:183], a[84:87], v[116:119], v[180:183]
buffer_load_dwordx4 v23, s[32:35], s77 offen offset:1024 lds
v_mfma_f32_16x16x32_bf16 v[168:171], a[80:83], v[120:123], v[168:171]
ds_read_b64_tr_b16 v[100:101], v15 offset:4096
ds_read_b64_tr_b16 v[102:103], v15 offset:20480
v_mfma_f32_16x16x32_bf16 v[184:187], a[84:87], v[120:123], v[184:187]
ds_read_b64_tr_b16 v[104:105], v16 offset:4096
s_waitcnt lgkmcnt(8)
v_mfma_f32_16x16x32_bf16 v[172:175], a[80:83], v[124:127], v[172:175]
buffer_store_dwordx4 v[200:203], v54, s[60:63], 0 offen offset:0 sc1
v_mfma_f32_16x16x32_bf16 v[188:191], a[84:87], v[124:127], v[188:191]
ds_read_b64_tr_b16 v[106:107], v16 offset:20480
ds_read_b64_tr_b16 v[108:109], v17 offset:4096
v_mfma_f32_16x16x32_bf16 v[160:163], a[88:91], v[80:83], v[160:163]
buffer_load_dwordx4 v24, s[32:35], s77 offen offset:2048 lds
v_mfma_f32_16x16x32_bf16 v[176:179], a[92:95], v[80:83], v[176:179]
ds_read_b64_tr_b16 v[110:111], v17 offset:20480
ds_read_b64_tr_b16 v[112:113], v14 offset:5120
v_mfma_f32_16x16x32_bf16 v[164:167], a[88:91], v[84:87], v[164:167]
ds_write_b128 v53, v[200:203] offset:0
v_mfma_f32_16x16x32_bf16 v[180:183], a[92:95], v[84:87], v[180:183]
ds_read_b64_tr_b16 v[114:115], v14 offset:21504
s_waitcnt lgkmcnt(7)
v_mfma_f32_16x16x32_bf16 v[168:171], a[88:91], v[88:91], v[168:171]
ds_read_b64_tr_b16 v[116:117], v15 offset:5120
s_mov_b32 s3, 0x200000
v_mfma_f32_16x16x32_bf16 v[184:187], a[92:95], v[88:91], v[184:187]
ds_read_b64_tr_b16 v[118:119], v15 offset:21504
ds_read_b64_tr_b16 v[120:121], v16 offset:5120
v_mfma_f32_16x16x32_bf16 v[172:175], a[88:91], v[92:95], v[172:175]
buffer_load_dwordx4 v25, s[32:35], s77 offen offset:3072 lds
v_mfma_f32_16x16x32_bf16 v[188:191], a[92:95], v[92:95], v[188:191]
ds_read_b64_tr_b16 v[122:123], v16 offset:21504
ds_read_b64_tr_b16 v[124:125], v17 offset:5120
v_mfma_f32_16x16x32_bf16 v[160:163], a[96:99], v[96:99], v[160:163]
buffer_load_dword v57, v8, s[44:47], s3 offen
v_mfma_f32_16x16x32_bf16 v[176:179], a[100:103], v[96:99], v[176:179]
ds_read_b64_tr_b16 v[126:127], v17 offset:21504
ds_read_b64_tr_b16 v[80:81], v14 offset:6144
v_mfma_f32_16x16x32_bf16 v[164:167], a[96:99], v[100:103], v[164:167]
buffer_store_dwordx4 v[204:207], v54, s[60:63], 0 offen offset:1024 sc1
v_mfma_f32_16x16x32_bf16 v[180:183], a[100:103], v[100:103], v[180:183]
ds_read_b64_tr_b16 v[82:83], v14 offset:22528
s_waitcnt lgkmcnt(7)
v_mfma_f32_16x16x32_bf16 v[168:171], a[96:99], v[104:107], v[168:171]
ds_read_b64_tr_b16 v[84:85], v15 offset:6144
s_add_u32 m0, s76, 32768
v_mfma_f32_16x16x32_bf16 v[184:187], a[100:103], v[104:107], v[184:187]
ds_read_b64_tr_b16 v[86:87], v15 offset:22528
s_add_u32 s77, s82, 0x0
v_mfma_f32_16x16x32_bf16 v[172:175], a[96:99], v[108:111], v[172:175]
ds_read_b64_tr_b16 v[88:89], v16 offset:6144
ds_read_b64_tr_b16 v[90:91], v16 offset:22528
v_mfma_f32_16x16x32_bf16 v[188:191], a[100:103], v[108:111], v[188:191]
buffer_load_dwordx4 v22, s[32:35], s77 offen offset:0 lds
v_mfma_f32_16x16x32_bf16 v[160:163], a[104:107], v[112:115], v[160:163]
ds_read_b64_tr_b16 v[92:93], v17 offset:6144
ds_read_b64_tr_b16 v[94:95], v17 offset:22528
v_mfma_f32_16x16x32_bf16 v[176:179], a[108:111], v[112:115], v[176:179]
ds_read_b64_tr_b16 v[96:97], v14 offset:7168
s_waitcnt lgkmcnt(8)
v_mfma_f32_16x16x32_bf16 v[164:167], a[104:107], v[116:119], v[164:167]
ds_write_b128 v53, v[204:207] offset:1024
v_mfma_f32_16x16x32_bf16 v[180:183], a[108:111], v[116:119], v[180:183]
ds_read_b64_tr_b16 v[98:99], v14 offset:23552
v_mul_f32 v128, v58, v128
v_mfma_f32_16x16x32_bf16 v[168:171], a[104:107], v[120:123], v[168:171]
ds_read_b64_tr_b16 v[100:101], v15 offset:7168
v_mul_f32 v129, v58, v129
v_mfma_f32_16x16x32_bf16 v[184:187], a[108:111], v[120:123], v[184:187]
ds_read_b64_tr_b16 v[102:103], v15 offset:23552
v_mul_f32 v130, v58, v130
v_mfma_f32_16x16x32_bf16 v[172:175], a[104:107], v[124:127], v[172:175]
ds_read_b64_tr_b16 v[104:105], v16 offset:7168
v_mul_f32 v131, v58, v131
v_mfma_f32_16x16x32_bf16 v[188:191], a[108:111], v[124:127], v[188:191]
ds_read_b64_tr_b16 v[106:107], v16 offset:23552
s_waitcnt lgkmcnt(7)
v_mfma_f32_16x16x32_bf16 v[160:163], a[112:115], v[80:83], v[160:163]
ds_read_b64_tr_b16 v[108:109], v17 offset:7168
v_mul_f32 v132, v58, v132
v_mfma_f32_16x16x32_bf16 v[176:179], a[116:119], v[80:83], v[176:179]
ds_read_b64_tr_b16 v[110:111], v17 offset:23552
v_mul_f32 v133, v58, v133
v_mfma_f32_16x16x32_bf16 v[164:167], a[112:115], v[84:87], v[164:167]
buffer_load_dwordx4 v23, s[32:35], s77 offen offset:1024 lds
v_mfma_f32_16x16x32_bf16 v[180:183], a[116:119], v[84:87], v[180:183]
buffer_load_dwordx4 v24, s[32:35], s77 offen offset:2048 lds
v_mfma_f32_16x16x32_bf16 v[168:171], a[112:115], v[88:91], v[168:171]
buffer_load_dwordx4 v25, s[32:35], s77 offen offset:3072 lds
v_mfma_f32_16x16x32_bf16 v[184:187], a[116:119], v[88:91], v[184:187]
s_add_u32 m0, s76, 36864
s_add_u32 s77, s82, 0xc0000
v_mfma_f32_16x16x32_bf16 v[172:175], a[112:115], v[92:95], v[172:175]
s_waitcnt vmcnt(16) lgkmcnt(0)
s_barrier
v_mfma_f32_16x16x32_bf16 v[188:191], a[116:119], v[92:95], v[188:191]
ds_read_b64_tr_b16 v[112:113], v14 offset:32768
ds_read_b64_tr_b16 v[114:115], v14 offset:49152
v_mfma_f32_16x16x32_bf16 v[160:163], a[120:123], v[96:99], v[160:163]
ds_read_b64_tr_b16 v[116:117], v15 offset:32768
ds_read_b64_tr_b16 v[118:119], v15 offset:49152
v_mfma_f32_16x16x32_bf16 v[176:179], a[124:127], v[96:99], v[176:179]
ds_read_b64_tr_b16 v[120:121], v16 offset:32768
ds_read_b64_tr_b16 v[122:123], v16 offset:49152
v_mfma_f32_16x16x32_bf16 v[164:167], a[120:123], v[100:103], v[164:167]
ds_read_b64_tr_b16 v[124:125], v17 offset:32768
ds_read_b64_tr_b16 v[126:127], v17 offset:49152
v_mfma_f32_16x16x32_bf16 v[180:183], a[124:127], v[100:103], v[180:183]
ds_read_b64_tr_b16 v[80:81], v14 offset:33792
ds_read_b64_tr_b16 v[82:83], v14 offset:50176
v_mfma_f32_16x16x32_bf16 v[168:171], a[120:123], v[104:107], v[168:171]
ds_read_b64_tr_b16 v[84:85], v15 offset:33792
s_waitcnt vmcnt(14)
v_mfma_f32_16x16x32_bf16 v[184:187], a[124:127], v[104:107], v[184:187]
ds_read_b64_tr_b16 v[86:87], v15 offset:50176
v_mul_f32 v134, v58, v134
v_mfma_f32_16x16x32_bf16 v[172:175], a[120:123], v[108:111], v[172:175]
ds_read_b64_tr_b16 v[88:89], v16 offset:33792
v_mul_f32 v135, v58, v135
v_mfma_f32_16x16x32_bf16 v[188:191], a[124:127], v[108:111], v[188:191]
ds_read_b64_tr_b16 v[90:91], v16 offset:50176
s_waitcnt lgkmcnt(10)
v_mfma_f32_16x16x32_bf16 v[160:163], a[128:131], v[112:115], v[160:163]
ds_read_b64_tr_b16 v[92:93], v17 offset:33792
v_cvt_pk_bf16_f32 v192, v128, v129
v_mfma_f32_16x16x32_bf16 v[176:179], a[132:135], v[112:115], v[176:179]
ds_read_b64_tr_b16 v[94:95], v17 offset:50176
v_cvt_pk_bf16_f32 v193, v130, v131
v_mfma_f32_16x16x32_bf16 v[164:167], a[128:131], v[116:119], v[164:167]
ds_read_b64_tr_b16 v[96:97], v14 offset:34816
v_cvt_pk_bf16_f32 v194, v132, v133
v_mfma_f32_16x16x32_bf16 v[180:183], a[132:135], v[116:119], v[180:183]
ds_read_b64_tr_b16 v[98:99], v14 offset:51200
s_waitcnt lgkmcnt(7)
v_mfma_f32_16x16x32_bf16 v[168:171], a[128:131], v[120:123], v[168:171]
ds_read_b64_tr_b16 v[100:101], v15 offset:34816
v_cvt_pk_bf16_f32 v195, v134, v135
v_mfma_f32_16x16x32_bf16 v[184:187], a[132:135], v[120:123], v[184:187]
ds_read_b64_tr_b16 v[102:103], v15 offset:51200
v_mul_f32 v136, v58, v136
v_mfma_f32_16x16x32_bf16 v[172:175], a[128:131], v[124:127], v[172:175]
ds_read_b64_tr_b16 v[104:105], v16 offset:34816
v_mul_f32 v137, v58, v137
v_mfma_f32_16x16x32_bf16 v[188:191], a[132:135], v[124:127], v[188:191]
ds_read_b64_tr_b16 v[106:107], v16 offset:51200
v_mul_f32 v138, v58, v138
v_mfma_f32_16x16x32_bf16 v[160:163], a[136:139], v[80:83], v[160:163]
ds_read_b64_tr_b16 v[108:109], v17 offset:34816
v_mul_f32 v139, v58, v139
v_mfma_f32_16x16x32_bf16 v[176:179], a[140:143], v[80:83], v[176:179]
ds_read_b64_tr_b16 v[110:111], v17 offset:51200
s_waitcnt lgkmcnt(7)
v_mfma_f32_16x16x32_bf16 v[164:167], a[136:139], v[84:87], v[164:167]
ds_read_b64_tr_b16 v[112:113], v14 offset:35840
v_mul_f32 v140, v58, v140
v_mfma_f32_16x16x32_bf16 v[180:183], a[140:143], v[84:87], v[180:183]
ds_read_b64_tr_b16 v[114:115], v14 offset:52224
v_mul_f32 v141, v58, v141
v_mfma_f32_16x16x32_bf16 v[168:171], a[136:139], v[88:91], v[168:171]
ds_read_b64_tr_b16 v[116:117], v15 offset:35840
v_mul_f32 v142, v58, v142
v_mfma_f32_16x16x32_bf16 v[184:187], a[140:143], v[88:91], v[184:187]
ds_read_b64_tr_b16 v[118:119], v15 offset:52224
v_mul_f32 v143, v58, v143
v_mfma_f32_16x16x32_bf16 v[172:175], a[136:139], v[92:95], v[172:175]
ds_read_b64_tr_b16 v[120:121], v16 offset:35840
v_cvt_pk_bf16_f32 v196, v136, v137
v_mfma_f32_16x16x32_bf16 v[188:191], a[140:143], v[92:95], v[188:191]
ds_read_b64_tr_b16 v[122:123], v16 offset:52224
s_waitcnt lgkmcnt(7)
v_mfma_f32_16x16x32_bf16 v[160:163], a[144:147], v[96:99], v[160:163]
ds_read_b64_tr_b16 v[124:125], v17 offset:35840
v_cvt_pk_bf16_f32 v197, v138, v139
v_mfma_f32_16x16x32_bf16 v[176:179], a[148:151], v[96:99], v[176:179]
ds_read_b64_tr_b16 v[126:127], v17 offset:52224
v_cvt_pk_bf16_f32 v198, v140, v141
v_mfma_f32_16x16x32_bf16 v[164:167], a[144:147], v[100:103], v[164:167]
ds_read_b64_tr_b16 v[80:81], v14 offset:36864
v_cvt_pk_bf16_f32 v199, v142, v143
v_mfma_f32_16x16x32_bf16 v[180:183], a[148:151], v[100:103], v[180:183]
ds_read_b64_tr_b16 v[82:83], v14 offset:53248
ds_read_b64_tr_b16 v[84:85], v15 offset:36864
v_mfma_f32_16x16x32_bf16 v[168:171], a[144:147], v[104:107], v[168:171]
buffer_load_dwordx4 v22, s[32:35], s77 offen offset:0 lds
v_mfma_f32_16x16x32_bf16 v[184:187], a[148:151], v[104:107], v[184:187]
ds_read_b64_tr_b16 v[86:87], v15 offset:53248
s_waitcnt lgkmcnt(7)
v_mfma_f32_16x16x32_bf16 v[172:175], a[144:147], v[108:111], v[172:175]
ds_read_b64_tr_b16 v[88:89], v16 offset:36864
ds_read_b64_tr_b16 v[90:91], v16 offset:53248
v_mfma_f32_16x16x32_bf16 v[188:191], a[148:151], v[108:111], v[188:191]
ds_read_b64_tr_b16 v[92:93], v17 offset:36864
v_mfma_f32_16x16x32_bf16 v[160:163], a[152:155], v[112:115], v[160:163]
ds_read_b64_tr_b16 v[94:95], v17 offset:53248
ds_read_b64_tr_b16 v[96:97], v14 offset:37888
v_mfma_f32_16x16x32_bf16 v[176:179], a[156:159], v[112:115], v[176:179]
buffer_load_dwordx4 v23, s[32:35], s77 offen offset:1024 lds
v_mfma_f32_16x16x32_bf16 v[164:167], a[152:155], v[116:119], v[164:167]
ds_read_b64_tr_b16 v[98:99], v14 offset:54272
ds_read_b64_tr_b16 v[100:101], v15 offset:37888
v_mfma_f32_16x16x32_bf16 v[180:183], a[156:159], v[116:119], v[180:183]
ds_read_b64_tr_b16 v[102:103], v15 offset:54272
s_waitcnt lgkmcnt(9)
v_mfma_f32_16x16x32_bf16 v[168:171], a[152:155], v[120:123], v[168:171]
ds_read_b64_tr_b16 v[104:105], v16 offset:37888
ds_read_b64_tr_b16 v[106:107], v16 offset:54272
v_mfma_f32_16x16x32_bf16 v[184:187], a[156:159], v[120:123], v[184:187]
ds_read_b64_tr_b16 v[108:109], v17 offset:37888
v_mfma_f32_16x16x32_bf16 v[172:175], a[152:155], v[124:127], v[172:175]
buffer_load_dwordx4 v24, s[32:35], s77 offen offset:2048 lds
v_mfma_f32_16x16x32_bf16 v[188:191], a[156:159], v[124:127], v[188:191]
ds_read_b64_tr_b16 v[110:111], v17 offset:54272
ds_read_b64_tr_b16 v[112:113], v14 offset:38912
v_mfma_f32_16x16x32_bf16 v[160:163], a[160:163], v[80:83], v[160:163]
ds_read_b64_tr_b16 v[114:115], v14 offset:55296
v_mfma_f32_16x16x32_bf16 v[176:179], a[164:167], v[80:83], v[176:179]
ds_read_b64_tr_b16 v[116:117], v15 offset:38912
s_waitcnt lgkmcnt(8)
v_mfma_f32_16x16x32_bf16 v[164:167], a[160:163], v[84:87], v[164:167]
ds_read_b64_tr_b16 v[118:119], v15 offset:55296
ds_read_b64_tr_b16 v[120:121], v16 offset:38912
v_mfma_f32_16x16x32_bf16 v[180:183], a[164:167], v[84:87], v[180:183]
buffer_load_dwordx4 v25, s[32:35], s77 offen offset:3072 lds
v_mfma_f32_16x16x32_bf16 v[168:171], a[160:163], v[88:91], v[168:171]
ds_read_b64_tr_b16 v[122:123], v16 offset:55296
ds_read_b64_tr_b16 v[124:125], v17 offset:38912
v_mfma_f32_16x16x32_bf16 v[184:187], a[164:167], v[88:91], v[184:187]
ds_read_b64_tr_b16 v[126:127], v17 offset:55296
v_mfma_f32_16x16x32_bf16 v[172:175], a[160:163], v[92:95], v[172:175]
ds_read_b64_tr_b16 v[80:81], v14 offset:39936
ds_read_b64_tr_b16 v[82:83], v14 offset:56320
v_mfma_f32_16x16x32_bf16 v[188:191], a[164:167], v[92:95], v[188:191]
ds_read_b64_tr_b16 v[84:85], v15 offset:39936
v_mfma_f32_16x16x32_bf16 v[160:163], a[168:171], v[96:99], v[160:163]
s_add_u32 m0, s76, 65536
s_add_u32 s77, s82, 0x180000
v_mfma_f32_16x16x32_bf16 v[176:179], a[172:175], v[96:99], v[176:179]
ds_read_b64_tr_b16 v[86:87], v15 offset:56320
s_waitcnt lgkmcnt(7)
v_mfma_f32_16x16x32_bf16 v[164:167], a[168:171], v[100:103], v[164:167]
buffer_load_dwordx4 v22, s[32:35], s77 offen offset:0 lds
v_mfma_f32_16x16x32_bf16 v[180:183], a[172:175], v[100:103], v[180:183]
s_mov_b32 s3, 0x400000
ds_read_b64_tr_b16 v[88:89], v16 offset:39936
v_mfma_f32_16x16x32_bf16 v[168:171], a[168:171], v[104:107], v[168:171]
buffer_load_dword v57, v8, s[40:43], s3 offen
v_mfma_f32_16x16x32_bf16 v[184:187], a[172:175], v[104:107], v[184:187]
ds_read_b64_tr_b16 v[90:91], v16 offset:56320
ds_read_b64_tr_b16 v[92:93], v17 offset:39936
v_mfma_f32_16x16x32_bf16 v[172:175], a[168:171], v[108:111], v[172:175]
ds_read_b64_tr_b16 v[94:95], v17 offset:56320
v_mfma_f32_16x16x32_bf16 v[188:191], a[172:175], v[108:111], v[188:191]
buffer_load_dwordx4 v23, s[32:35], s77 offen offset:1024 lds
v_mfma_f32_16x16x32_bf16 v[160:163], a[176:179], v[112:115], v[160:163]
buffer_load_dwordx4 v24, s[32:35], s77 offen offset:2048 lds
v_mfma_f32_16x16x32_bf16 v[176:179], a[180:183], v[112:115], v[176:179]
buffer_load_dwordx4 v25, s[32:35], s77 offen offset:3072 lds
v_mfma_f32_16x16x32_bf16 v[164:167], a[176:179], v[116:119], v[164:167]
s_add_u32 m0, s76, 69632
s_add_u32 s77, s82, 0x240000
v_mfma_f32_16x16x32_bf16 v[180:183], a[180:183], v[116:119], v[180:183]
s_waitcnt vmcnt(15) lgkmcnt(0)
s_barrier
v_mfma_f32_16x16x32_bf16 v[168:171], a[176:179], v[120:123], v[168:171]
ds_read_b64_tr_b16 v[96:97], v10 offset:0
ds_read_b64_tr_b16 v[98:99], v10 offset:16384
v_mfma_f32_16x16x32_bf16 v[184:187], a[180:183], v[120:123], v[184:187]
ds_read_b64_tr_b16 v[100:101], v11 offset:0
ds_read_b64_tr_b16 v[102:103], v11 offset:16384
v_mfma_f32_16x16x32_bf16 v[172:175], a[176:179], v[124:127], v[172:175]
ds_read_b64_tr_b16 v[104:105], v12 offset:0
v_mfma_f32_16x16x32_bf16 v[188:191], a[180:183], v[124:127], v[188:191]
ds_read_b64_tr_b16 v[106:107], v12 offset:16384
ds_read_b64_tr_b16 v[108:109], v13 offset:0
v_mfma_f32_16x16x32_bf16 v[160:163], a[184:187], v[80:83], v[160:163]
buffer_load_dwordx4 v22, s[32:35], s77 offen offset:0 lds
v_mfma_f32_16x16x32_bf16 v[176:179], a[188:191], v[80:83], v[176:179]
ds_read_b64_tr_b16 v[110:111], v13 offset:16384
ds_read_b64_tr_b16 v[112:113], v10 offset:1024
v_mfma_f32_16x16x32_bf16 v[164:167], a[184:187], v[84:87], v[164:167]
buffer_atomic_add v52, v55, s[60:63], 0 offen sc1
v_mfma_f32_16x16x32_bf16 v[180:183], a[188:191], v[84:87], v[180:183]
ds_read_b64_tr_b16 v[114:115], v10 offset:17408
ds_read_b64_tr_b16 v[116:117], v11 offset:1024
v_mfma_f32_16x16x32_bf16 v[168:171], a[184:187], v[88:91], v[168:171]
ds_read_b64_tr_b16 v[118:119], v11 offset:17408
v_mfma_f32_16x16x32_bf16 v[184:187], a[188:191], v[88:91], v[184:187]
buffer_load_dwordx4 v23, s[32:35], s77 offen offset:1024 lds
v_mfma_f32_16x16x32_bf16 v[172:175], a[184:187], v[92:95], v[172:175]
ds_read_b64_tr_b16 v[120:121], v12 offset:1024
ds_read_b64_tr_b16 v[122:123], v12 offset:17408
v_mfma_f32_16x16x32_bf16 v[188:191], a[188:191], v[92:95], v[188:191]
ds_read_b64_tr_b16 v[124:125], v13 offset:1024
s_waitcnt lgkmcnt(8)
v_mfma_f32_16x16x32_bf16 v[160:163], a[192:195], v[96:99], v[160:163]
ds_read_b64_tr_b16 v[126:127], v13 offset:17408
ds_read_b64_tr_b16 v[80:81], v10 offset:2048
v_mfma_f32_16x16x32_bf16 v[176:179], a[196:199], v[96:99], v[176:179]
ds_read_b64_tr_b16 v[82:83], v10 offset:18432
v_mfma_f32_16x16x32_bf16 v[164:167], a[192:195], v[100:103], v[164:167]
buffer_load_dwordx4 v24, s[32:35], s77 offen offset:2048 lds
v_mfma_f32_16x16x32_bf16 v[180:183], a[196:199], v[100:103], v[180:183]
ds_read_b64_tr_b16 v[84:85], v11 offset:2048
ds_read_b64_tr_b16 v[86:87], v11 offset:18432
v_mfma_f32_16x16x32_bf16 v[168:171], a[192:195], v[104:107], v[168:171]
ds_read_b64_tr_b16 v[88:89], v12 offset:2048
v_mfma_f32_16x16x32_bf16 v[184:187], a[196:199], v[104:107], v[184:187]
ds_read_b64_tr_b16 v[90:91], v12 offset:18432
s_waitcnt lgkmcnt(8)
v_mfma_f32_16x16x32_bf16 v[172:175], a[192:195], v[108:111], v[172:175]
ds_read_b64_tr_b16 v[92:93], v13 offset:2048
ds_read_b64_tr_b16 v[94:95], v13 offset:18432
v_mfma_f32_16x16x32_bf16 v[188:191], a[196:199], v[108:111], v[188:191]
buffer_load_dwordx4 v25, s[32:35], s77 offen offset:3072 lds
v_mfma_f32_16x16x32_bf16 v[160:163], a[200:203], v[112:115], v[160:163]
ds_read_b64_tr_b16 v[96:97], v10 offset:3072
ds_read_b64_tr_b16 v[98:99], v10 offset:19456
v_mfma_f32_16x16x32_bf16 v[176:179], a[204:207], v[112:115], v[176:179]
ds_read_b64_tr_b16 v[100:101], v11 offset:3072
v_mfma_f32_16x16x32_bf16 v[164:167], a[200:203], v[116:119], v[164:167]
ds_read_b64_tr_b16 v[102:103], v11 offset:19456
ds_read_b64_tr_b16 v[104:105], v12 offset:3072
v_mfma_f32_16x16x32_bf16 v[180:183], a[204:207], v[116:119], v[180:183]
ds_read_b64_tr_b16 v[106:107], v12 offset:19456
v_mfma_f32_16x16x32_bf16 v[168:171], a[200:203], v[120:123], v[168:171]
s_add_u32 m0, s76, 98304
s_add_u32 s77, s82, 0x300000
v_mfma_f32_16x16x32_bf16 v[184:187], a[204:207], v[120:123], v[184:187]
ds_read_b64_tr_b16 v[108:109], v13 offset:3072
s_waitcnt lgkmcnt(7)
v_mfma_f32_16x16x32_bf16 v[172:175], a[200:203], v[124:127], v[172:175]
buffer_load_dwordx4 v22, s[32:35], s77 offen offset:0 lds
v_mfma_f32_16x16x32_bf16 v[188:191], a[204:207], v[124:127], v[188:191]
ds_read_b64_tr_b16 v[110:111], v13 offset:19456
ds_read_b64_tr_b16 v[112:113], v10 offset:4096
v_mfma_f32_16x16x32_bf16 v[160:163], a[208:211], v[80:83], v[160:163]
ds_read_b64_tr_b16 v[114:115], v10 offset:20480
v_mfma_f32_16x16x32_bf16 v[176:179], a[212:215], v[80:83], v[176:179]
ds_read_b64_tr_b16 v[116:117], v11 offset:4096
ds_read_b64_tr_b16 v[118:119], v11 offset:20480
v_mfma_f32_16x16x32_bf16 v[164:167], a[208:211], v[84:87], v[164:167]
ds_read_b64_tr_b16 v[120:121], v12 offset:4096
v_mfma_f32_16x16x32_bf16 v[180:183], a[212:215], v[84:87], v[180:183]
buffer_load_dwordx4 v23, s[32:35], s77 offen offset:1024 lds
v_mfma_f32_16x16x32_bf16 v[168:171], a[208:211], v[88:91], v[168:171]
ds_read_b64_tr_b16 v[122:123], v12 offset:20480
ds_read_b64_tr_b16 v[124:125], v13 offset:4096
v_mfma_f32_16x16x32_bf16 v[184:187], a[212:215], v[88:91], v[184:187]
ds_read_b64_tr_b16 v[126:127], v13 offset:20480
v_mfma_f32_16x16x32_bf16 v[172:175], a[208:211], v[92:95], v[172:175]
ds_read_b64_tr_b16 v[80:81], v10 offset:5120
ds_read_b64_tr_b16 v[82:83], v10 offset:21504
v_mfma_f32_16x16x32_bf16 v[188:191], a[212:215], v[92:95], v[188:191]
ds_read_b64_tr_b16 v[84:85], v11 offset:5120
s_waitcnt lgkmcnt(9)
v_mfma_f32_16x16x32_bf16 v[160:163], a[216:219], v[96:99], v[160:163]
buffer_load_dwordx4 v24, s[32:35], s77 offen offset:2048 lds
v_mfma_f32_16x16x32_bf16 v[176:179], a[220:223], v[96:99], v[176:179]
s_lshl_b32 s78, s73, 4
s_add_u32 s78, s78, s74
s_lshl_b32 s78, s78, 10
s_add_u32 s78, s78, 49152
s_cmp_eq_u32 s72, 3
s_cselect_b32 s78, s78, s96
s_cmp_lt_u32 s73, 15
s_cselect_b32 s78, s78, s96
v_mov_b32 v2, s96
v_writelane_b32 v2, s78, 0
v_mfma_f32_16x16x32_bf16 v[164:167], a[216:219], v[100:103], v[164:167]
s_waitcnt vmcnt(21)
ds_read_b64_tr_b16 v[86:87], v11 offset:21504
v_mfma_f32_16x16x32_bf16 v[180:183], a[220:223], v[100:103], v[180:183]
buffer_atomic_add v52, v2, s[60:63], 0 offen sc1
v_mfma_f32_16x16x32_bf16 v[168:171], a[216:219], v[104:107], v[168:171]
ds_read_b64_tr_b16 v[88:89], v12 offset:5120
ds_read_b64_tr_b16 v[90:91], v12 offset:21504
v_mfma_f32_16x16x32_bf16 v[184:187], a[220:223], v[104:107], v[184:187]
buffer_load_dwordx4 v25, s[32:35], s77 offen offset:3072 lds
v_mfma_f32_16x16x32_bf16 v[172:175], a[216:219], v[108:111], v[172:175]
ds_read_b64_tr_b16 v[92:93], v13 offset:5120
ds_read_b64_tr_b16 v[94:95], v13 offset:21504
v_mfma_f32_16x16x32_bf16 v[188:191], a[220:223], v[108:111], v[188:191]
ds_read_b64_tr_b16 v[96:97], v10 offset:6144
v_mfma_f32_16x16x32_bf16 v[160:163], a[224:227], v[112:115], v[160:163]
ds_read_b64_tr_b16 v[98:99], v10 offset:22528
ds_read_b64_tr_b16 v[100:101], v11 offset:6144
v_mfma_f32_16x16x32_bf16 v[176:179], a[228:231], v[112:115], v[176:179]
ds_read_b64_tr_b16 v[102:103], v11 offset:22528
s_waitcnt lgkmcnt(8)
v_mfma_f32_16x16x32_bf16 v[164:167], a[224:227], v[116:119], v[164:167]
s_add_u32 m0, s76, 102400
s_add_u32 s77, s82, 0x3c0000
v_mfma_f32_16x16x32_bf16 v[180:183], a[228:231], v[116:119], v[180:183]
buffer_load_dwordx4 v22, s[32:35], s77 offen offset:0 lds
v_mfma_f32_16x16x32_bf16 v[168:171], a[224:227], v[120:123], v[168:171]
ds_read_b64_tr_b16 v[104:105], v12 offset:6144
ds_read_b64_tr_b16 v[106:107], v12 offset:22528
v_mfma_f32_16x16x32_bf16 v[184:187], a[228:231], v[120:123], v[184:187]
ds_read_b64_tr_b16 v[108:109], v13 offset:6144
v_mfma_f32_16x16x32_bf16 v[172:175], a[224:227], v[124:127], v[172:175]
ds_read_b64_tr_b16 v[110:111], v13 offset:22528
ds_read_b64_tr_b16 v[112:113], v10 offset:7168
v_mfma_f32_16x16x32_bf16 v[188:191], a[228:231], v[124:127], v[188:191]
ds_read_b64_tr_b16 v[114:115], v10 offset:23552
v_mfma_f32_16x16x32_bf16 v[160:163], a[232:235], v[80:83], v[160:163]
buffer_load_dwordx4 v23, s[32:35], s77 offen offset:1024 lds
v_mfma_f32_16x16x32_bf16 v[176:179], a[236:239], v[80:83], v[176:179]
ds_read_b64_tr_b16 v[116:117], v11 offset:7168
ds_read_b64_tr_b16 v[118:119], v11 offset:23552
v_mfma_f32_16x16x32_bf16 v[164:167], a[232:235], v[84:87], v[164:167]
ds_read_b64_tr_b16 v[120:121], v12 offset:7168
v_mfma_f32_16x16x32_bf16 v[180:183], a[236:239], v[84:87], v[180:183]
ds_read_b64_tr_b16 v[122:123], v12 offset:23552
s_waitcnt lgkmcnt(8)
v_mfma_f32_16x16x32_bf16 v[168:171], a[232:235], v[88:91], v[168:171]
ds_read_b64_tr_b16 v[124:125], v13 offset:7168
ds_read_b64_tr_b16 v[126:127], v13 offset:23552
v_mfma_f32_16x16x32_bf16 v[184:187], a[236:239], v[88:91], v[184:187]
buffer_load_dwordx4 v24, s[32:35], s77 offen offset:2048 lds
v_mfma_f32_16x16x32_bf16 v[172:175], a[232:235], v[92:95], v[172:175]
buffer_load_dwordx4 v25, s[32:35], s77 offen offset:3072 lds
v_mfma_f32_16x16x32_bf16 v[188:191], a[236:239], v[92:95], v[188:191]
v_mfma_f32_16x16x32_bf16 v[160:163], a[240:243], v[96:99], v[160:163]
v_mfma_f32_16x16x32_bf16 v[176:179], a[244:247], v[96:99], v[176:179]
s_waitcnt vmcnt(19) lgkmcnt(0)
s_barrier
v_mfma_f32_16x16x32_bf16 v[164:167], a[240:243], v[100:103], v[164:167]
ds_read_b64_tr_b16 v[80:81], v10 offset:32768
s_add_u32 m0, s76, 0
v_mfma_f32_16x16x32_bf16 v[180:183], a[244:247], v[100:103], v[180:183]
ds_read_b64_tr_b16 v[82:83], v10 offset:49152
s_add_u32 s77, s82, 0x480000
v_mfma_f32_16x16x32_bf16 v[168:171], a[240:243], v[104:107], v[168:171]
ds_read_b64_tr_b16 v[84:85], v11 offset:32768
ds_read_b64_tr_b16 v[86:87], v11 offset:49152
v_mfma_f32_16x16x32_bf16 v[184:187], a[244:247], v[104:107], v[184:187]
buffer_load_dwordx4 v22, s[32:35], s77 offen offset:0 lds
v_mfma_f32_16x16x32_bf16 v[172:175], a[240:243], v[108:111], v[172:175]
ds_read_b64_tr_b16 v[88:89], v12 offset:32768
ds_read_b64_tr_b16 v[90:91], v12 offset:49152
v_mfma_f32_16x16x32_bf16 v[188:191], a[244:247], v[108:111], v[188:191]
ds_read_b64_tr_b16 v[92:93], v13 offset:32768
v_mfma_f32_16x16x32_bf16 v[160:163], a[248:251], v[112:115], v[160:163]
ds_read_b64_tr_b16 v[94:95], v13 offset:49152
ds_read_b64_tr_b16 v[96:97], v10 offset:33792
v_mfma_f32_16x16x32_bf16 v[176:179], a[252:255], v[112:115], v[176:179]
ds_read_b64_tr_b16 v[98:99], v10 offset:50176
v_mfma_f32_16x16x32_bf16 v[164:167], a[248:251], v[116:119], v[164:167]
buffer_load_dwordx4 v23, s[32:35], s77 offen offset:1024 lds
v_mfma_f32_16x16x32_bf16 v[180:183], a[252:255], v[116:119], v[180:183]
ds_read_b64_tr_b16 v[100:101], v11 offset:33792
ds_read_b64_tr_b16 v[102:103], v11 offset:50176
v_mfma_f32_16x16x32_bf16 v[168:171], a[248:251], v[120:123], v[168:171]
ds_read_b64_tr_b16 v[104:105], v12 offset:33792
v_mfma_f32_16x16x32_bf16 v[184:187], a[252:255], v[120:123], v[184:187]
ds_read_b64_tr_b16 v[106:107], v12 offset:50176
ds_read_b64_tr_b16 v[108:109], v13 offset:33792
v_mfma_f32_16x16x32_bf16 v[172:175], a[248:251], v[124:127], v[172:175]
ds_read_b64_tr_b16 v[110:111], v13 offset:50176
v_mfma_f32_16x16x32_bf16 v[188:191], a[252:255], v[124:127], v[188:191]
buffer_load_dwordx4 v24, s[32:35], s77 offen offset:2048 lds
S_Q:
s_waitcnt lgkmcnt(7)
v_mfma_f32_16x16x32_bf16 v[128:131], v[80:83], a[0:3], 0
ds_read_b64_tr_b16 v[112:113], v10 offset:34816
ds_read_b64_tr_b16 v[114:115], v10 offset:51200
v_mfma_f32_16x16x32_bf16 v[144:147], v[80:83], a[4:7], 0
ds_read_b64_tr_b16 v[116:117], v11 offset:34816
v_mfma_f32_16x16x32_bf16 v[132:135], v[84:87], a[0:3], 0
ds_read_b64_tr_b16 v[118:119], v11 offset:51200
ds_read_b64_tr_b16 v[120:121], v12 offset:34816
v_mfma_f32_16x16x32_bf16 v[148:151], v[84:87], a[4:7], 0
s_add_u32 s70, s0, T_attn - K_pc + 0
s_addc_u32 s71, s1, 0
global_load_dword v57, v9, s[70:71]
v_mfma_f32_16x16x32_bf16 v[136:139], v[88:91], a[0:3], 0
buffer_load_dwordx4 v25, s[32:35], s77 offen offset:3072 lds
v_mfma_f32_16x16x32_bf16 v[152:155], v[88:91], a[4:7], 0
s_add_u32 s70, s0, T_attn - K_pc + 8192
s_addc_u32 s71, s1, 0
global_load_dword v57, v9, s[70:71]
v_mfma_f32_16x16x32_bf16 v[140:143], v[92:95], a[0:3], 0
v_lshrrev_b32 v3, 1, v46
v_sub_u32 v53, v53, v3
v_mfma_f32_16x16x32_bf16 v[156:159], v[92:95], a[4:7], 0
ds_read_b64_tr_b16 v[122:123], v12 offset:51200
s_waitcnt lgkmcnt(4)
v_mfma_f32_16x16x32_bf16 v[128:131], v[96:99], a[8:11], v[128:131]
ds_read_b64_tr_b16 v[124:125], v13 offset:34816
v_sub_u32 v54, v54, v3
v_mfma_f32_16x16x32_bf16 v[144:147], v[96:99], a[12:15], v[144:147]
ds_read_b64_tr_b16 v[126:127], v13 offset:51200
s_add_u32 m0, s76, 4096
v_mfma_f32_16x16x32_bf16 v[132:135], v[100:103], a[8:11], v[132:135]
ds_read_b64_tr_b16 v[80:81], v10 offset:35840
s_add_u32 s77, s82, 0x540000
v_mfma_f32_16x16x32_bf16 v[148:151], v[100:103], a[12:15], v[148:151]
ds_read_b64_tr_b16 v[82:83], v10 offset:52224
s_mov_b32 s3, 0x400000
v_mfma_f32_16x16x32_bf16 v[136:139], v[104:107], a[8:11], v[136:139]
ds_read_b64_tr_b16 v[84:85], v11 offset:35840
v_mul_f32 v176, v64, v176
v_mfma_f32_16x16x32_bf16 v[152:155], v[104:107], a[12:15], v[152:155]
ds_read_b64_tr_b16 v[86:87], v11 offset:52224
v_mul_f32 v177, v65, v177
v_mfma_f32_16x16x32_bf16 v[140:143], v[108:111], a[8:11], v[140:143]
ds_read_b64_tr_b16 v[88:89], v12 offset:35840
v_mul_f32 v178, v66, v178
v_mfma_f32_16x16x32_bf16 v[156:159], v[108:111], a[12:15], v[156:159]
ds_read_b64_tr_b16 v[90:91], v12 offset:52224
v_mul_f32 v179, v67, v179
v_mfma_f32_16x16x32_bf16 v[128:131], v[112:115], a[16:19], v[128:131]
ds_read_b64_tr_b16 v[92:93], v13 offset:35840
v_cvt_pk_bf16_f32 v228, v176, v177
v_mfma_f32_16x16x32_bf16 v[144:147], v[112:115], a[20:23], v[144:147]
ds_read_b64_tr_b16 v[94:95], v13 offset:52224
s_waitcnt lgkmcnt(7)
v_mfma_f32_16x16x32_bf16 v[132:135], v[116:119], a[16:19], v[132:135]
ds_read_b64_tr_b16 v[96:97], v10 offset:36864
v_cvt_pk_bf16_f32 v229, v178, v179
v_mfma_f32_16x16x32_bf16 v[148:151], v[116:119], a[20:23], v[148:151]
ds_read_b64_tr_b16 v[98:99], v10 offset:53248
v_mul_f32 v180, v64, v180
v_mfma_f32_16x16x32_bf16 v[136:139], v[120:123], a[16:19], v[136:139]
ds_read_b64_tr_b16 v[100:101], v11 offset:36864
v_mul_f32 v181, v65, v181
v_mfma_f32_16x16x32_bf16 v[152:155], v[120:123], a[20:23], v[152:155]
ds_read_b64_tr_b16 v[102:103], v11 offset:53248
v_mul_f32 v182, v66, v182
v_mfma_f32_16x16x32_bf16 v[140:143], v[124:127], a[16:19], v[140:143]
ds_read_b64_tr_b16 v[104:105], v12 offset:36864
v_mul_f32 v183, v67, v183
v_mfma_f32_16x16x32_bf16 v[156:159], v[124:127], a[20:23], v[156:159]
ds_read_b64_tr_b16 v[106:107], v12 offset:53248
s_waitcnt lgkmcnt(7)
v_mfma_f32_16x16x32_bf16 v[128:131], v[80:83], a[24:27], v[128:131]
ds_read_b64_tr_b16 v[108:109], v13 offset:36864
v_cvt_pk_bf16_f32 v234, v180, v181
v_mfma_f32_16x16x32_bf16 v[144:147], v[80:83], a[28:31], v[144:147]
ds_read_b64_tr_b16 v[110:111], v13 offset:53248
v_cvt_pk_bf16_f32 v235, v182, v183
v_mfma_f32_16x16x32_bf16 v[132:135], v[84:87], a[24:27], v[132:135]
ds_read_b64_tr_b16 v[112:113], v10 offset:37888
v_mul_f32 v184, v64, v184
v_mfma_f32_16x16x32_bf16 v[148:151], v[84:87], a[28:31], v[148:151]
ds_read_b64_tr_b16 v[114:115], v10 offset:54272
v_mul_f32 v185, v65, v185
v_mfma_f32_16x16x32_bf16 v[136:139], v[88:91], a[24:27], v[136:139]
ds_read_b64_tr_b16 v[116:117], v11 offset:37888
v_mul_f32 v186, v66, v186
v_mfma_f32_16x16x32_bf16 v[152:155], v[88:91], a[28:31], v[152:155]
ds_read_b64_tr_b16 v[118:119], v11 offset:54272
s_waitcnt lgkmcnt(7)
v_mfma_f32_16x16x32_bf16 v[140:143], v[92:95], a[24:27], v[140:143]
ds_read_b64_tr_b16 v[120:121], v12 offset:37888
v_mul_f32 v187, v67, v187
v_mfma_f32_16x16x32_bf16 v[156:159], v[92:95], a[28:31], v[156:159]
ds_read_b64_tr_b16 v[122:123], v12 offset:54272
v_cvt_pk_bf16_f32 v240, v184, v185
v_mfma_f32_16x16x32_bf16 v[128:131], v[96:99], a[32:35], v[128:131]
ds_read_b64_tr_b16 v[124:125], v13 offset:37888
v_cvt_pk_bf16_f32 v241, v186, v187
v_mfma_f32_16x16x32_bf16 v[144:147], v[96:99], a[36:39], v[144:147]
ds_read_b64_tr_b16 v[126:127], v13 offset:54272
v_mul_f32 v188, v64, v188
v_mfma_f32_16x16x32_bf16 v[132:135], v[100:103], a[32:35], v[132:135]
ds_read_b64_tr_b16 v[80:81], v10 offset:38912
v_mul_f32 v189, v65, v189
v_mfma_f32_16x16x32_bf16 v[148:151], v[100:103], a[36:39], v[148:151]
ds_read_b64_tr_b16 v[82:83], v10 offset:55296
s_waitcnt lgkmcnt(7)
v_mfma_f32_16x16x32_bf16 v[136:139], v[104:107], a[32:35], v[136:139]
ds_read_b64_tr_b16 v[84:85], v11 offset:38912
v_mul_f32 v190, v66, v190
v_mfma_f32_16x16x32_bf16 v[152:155], v[104:107], a[36:39], v[152:155]
ds_read_b64_tr_b16 v[86:87], v11 offset:55296
v_mul_f32 v191, v67, v191
v_mfma_f32_16x16x32_bf16 v[140:143], v[108:111], a[32:35], v[140:143]
ds_read_b64_tr_b16 v[88:89], v12 offset:38912
v_cvt_pk_bf16_f32 v246, v188, v189
v_mfma_f32_16x16x32_bf16 v[156:159], v[108:111], a[36:39], v[156:159]
ds_read_b64_tr_b16 v[90:91], v12 offset:55296
v_cvt_pk_bf16_f32 v247, v190, v191
v_mfma_f32_16x16x32_bf16 v[128:131], v[112:115], a[40:43], v[128:131]
ds_read_b64_tr_b16 v[92:93], v13 offset:38912
ds_read_b64_tr_b16 v[94:95], v13 offset:55296
v_mfma_f32_16x16x32_bf16 v[144:147], v[112:115], a[44:47], v[144:147]
ds_read_b64_tr_b16 v[96:97], v10 offset:39936
s_waitcnt lgkmcnt(8)
v_mfma_f32_16x16x32_bf16 v[132:135], v[116:119], a[40:43], v[132:135]
buffer_load_dwordx4 v22, s[32:35], s77 offen offset:0 lds
v_mfma_f32_16x16x32_bf16 v[148:151], v[116:119], a[44:47], v[148:151]
ds_read_b64_tr_b16 v[98:99], v10 offset:56320
ds_read_b64_tr_b16 v[100:101], v11 offset:39936
v_mfma_f32_16x16x32_bf16 v[136:139], v[120:123], a[40:43], v[136:139]
buffer_load_dword v57, v8, s[44:47], s3 offen
v_mfma_f32_16x16x32_bf16 v[152:155], v[120:123], a[44:47], v[152:155]
ds_read_b64_tr_b16 v[102:103], v11 offset:56320
ds_read_b64_tr_b16 v[104:105], v12 offset:39936
v_mfma_f32_16x16x32_bf16 v[140:143], v[124:127], a[40:43], v[140:143]
s_lshl_b32 s78, s73, 4
s_add_u32 s78, s78, s74
s_lshl_b32 s78, s78, 10
s_add_u32 s78, s78, 32768
s_cmp_eq_u32 s72, 0
s_cselect_b32 s79, s73, 0
s_cmp_lg_u32 s79, 0
s_cselect_b32 s78, s78, s96
s_cselect_b32 s79, 1, 0
v_mov_b32 v49, s96
v_writelane_b32 v49, s78, 0
v_mov_b32 v50, 0
v_writelane_b32 v50, s79, 0
v_mfma_f32_16x16x32_bf16 v[156:159], v[124:127], a[44:47], v[156:159]
ds_read_b64_tr_b16 v[106:107], v12 offset:56320
s_waitcnt lgkmcnt(6)
v_mfma_f32_16x16x32_bf16 v[128:131], v[80:83], a[48:51], v[128:131]
ds_read_b64_tr_b16 v[108:109], v13 offset:39936
ds_read_b64_tr_b16 v[110:111], v13 offset:56320
v_mfma_f32_16x16x32_bf16 v[144:147], v[80:83], a[52:55], v[144:147]
buffer_load_dwordx4 v23, s[32:35], s77 offen offset:1024 lds
v_mfma_f32_16x16x32_bf16 v[132:135], v[84:87], a[48:51], v[132:135]
buffer_load_dwordx4 v24, s[32:35], s77 offen offset:2048 lds
v_mfma_f32_16x16x32_bf16 v[148:151], v[84:87], a[52:55], v[148:151]
buffer_load_dwordx4 v25, s[32:35], s77 offen offset:3072 lds
v_mfma_f32_16x16x32_bf16 v[136:139], v[88:91], a[48:51], v[136:139]
v_mov_b32 v51, 0
buffer_atomic_add v51, v49, s[60:63], 0 offen sc0 sc1
v_mfma_f32_16x16x32_bf16 v[152:155], v[88:91], a[52:55], v[152:155]
s_waitcnt vmcnt(21) lgkmcnt(0)
s_barrier
v_mfma_f32_16x16x32_bf16 v[140:143], v[92:95], a[48:51], v[140:143]
ds_read_b64_tr_b16 v[112:113], v14 offset:0
ds_read_b64_tr_b16 v[114:115], v14 offset:16384
v_mfma_f32_16x16x32_bf16 v[156:159], v[92:95], a[52:55], v[156:159]
ds_read_b64_tr_b16 v[116:117], v15 offset:0
ds_read_b64_tr_b16 v[118:119], v15 offset:16384
v_mfma_f32_16x16x32_bf16 v[128:131], v[96:99], a[56:59], v[128:131]
ds_read_b64_tr_b16 v[120:121], v16 offset:0
ds_read_b64_tr_b16 v[122:123], v16 offset:16384
v_mfma_f32_16x16x32_bf16 v[144:147], v[96:99], a[60:63], v[144:147]
ds_read_b64_tr_b16 v[124:125], v17 offset:0
ds_read_b64_tr_b16 v[126:127], v17 offset:16384
v_mfma_f32_16x16x32_bf16 v[132:135], v[100:103], a[56:59], v[132:135]
ds_read_b64_tr_b16 v[80:81], v14 offset:1024
s_add_u32 m0, s76, 32768
v_mfma_f32_16x16x32_bf16 v[148:151], v[100:103], a[60:63], v[148:151]
ds_read_b64_tr_b16 v[82:83], v14 offset:17408
s_add_u32 s77, s83, 0x0
v_mfma_f32_16x16x32_bf16 v[136:139], v[104:107], a[56:59], v[136:139]
ds_read_b64_tr_b16 v[84:85], v15 offset:1024
ds_read_b64_tr_b16 v[86:87], v15 offset:17408
v_mfma_f32_16x16x32_bf16 v[152:155], v[104:107], a[60:63], v[152:155]
buffer_load_dwordx4 v26, s[36:39], s77 offen offset:0 lds
v_mfma_f32_16x16x32_bf16 v[140:143], v[108:111], a[56:59], v[140:143]
ds_read_b64_tr_b16 v[88:89], v16 offset:1024
ds_read_b64_tr_b16 v[90:91], v16 offset:17408
v_mfma_f32_16x16x32_bf16 v[156:159], v[108:111], a[60:63], v[156:159]
s_mov_b32 s3, 0x500000
s_waitcnt lgkmcnt(8)
v_mfma_f32_16x16x32_bf16 v[128:131], v[112:115], a[64:67], v[128:131]
ds_read_b64_tr_b16 v[92:93], v17 offset:1024
ds_read_b64_tr_b16 v[94:95], v17 offset:17408
v_mfma_f32_16x16x32_bf16 v[144:147], v[112:115], a[68:71], v[144:147]
buffer_load_dword v57, v8, s[40:43], s3 offen
v_mfma_f32_16x16x32_bf16 v[132:135], v[116:119], a[64:67], v[132:135]
ds_read_b64_tr_b16 v[96:97], v14 offset:2048
ds_read_b64_tr_b16 v[98:99], v14 offset:18432
v_mfma_f32_16x16x32_bf16 v[148:151], v[116:119], a[68:71], v[148:151]
buffer_load_dwordx4 v27, s[36:39], s77 offen offset:1024 lds
v_mfma_f32_16x16x32_bf16 v[136:139], v[120:123], a[64:67], v[136:139]
ds_read_b64_tr_b16 v[100:101], v15 offset:2048
ds_read_b64_tr_b16 v[102:103], v15 offset:18432
v_mfma_f32_16x16x32_bf16 v[152:155], v[120:123], a[68:71], v[152:155]
ds_read_b64_tr_b16 v[104:105], v16 offset:2048
s_waitcnt lgkmcnt(7)
v_mfma_f32_16x16x32_bf16 v[140:143], v[124:127], a[64:67], v[140:143]
buffer_store_dwordx2 v[228:229], v54, s[60:63], 0 offen offset:2048 sc1
v_mfma_f32_16x16x32_bf16 v[156:159], v[124:127], a[68:71], v[156:159]
ds_read_b64_tr_b16 v[106:107], v16 offset:18432
ds_read_b64_tr_b16 v[108:109], v17 offset:2048
v_mfma_f32_16x16x32_bf16 v[128:131], v[80:83], a[72:75], v[128:131]
buffer_load_dwordx4 v28, s[36:39], s77 offen offset:2048 lds
v_mfma_f32_16x16x32_bf16 v[144:147], v[80:83], a[76:79], v[144:147]
ds_read_b64_tr_b16 v[110:111], v17 offset:18432
ds_read_b64_tr_b16 v[112:113], v14 offset:3072
v_mfma_f32_16x16x32_bf16 v[132:135], v[84:87], a[72:75], v[132:135]
buffer_store_dwordx2 v[234:235], v54, s[60:63], 0 offen offset:2560 sc1
v_mfma_f32_16x16x32_bf16 v[148:151], v[84:87], a[76:79], v[148:151]
ds_read_b64_tr_b16 v[114:115], v14 offset:19456
ds_read_b64_tr_b16 v[116:117], v15 offset:3072
v_mfma_f32_16x16x32_bf16 v[136:139], v[88:91], a[72:75], v[136:139]
buffer_store_dwordx2 v[240:241], v54, s[60:63], 0 offen offset:3072 sc1
v_mfma_f32_16x16x32_bf16 v[152:155], v[88:91], a[76:79], v[152:155]
ds_read_b64_tr_b16 v[118:119], v15 offset:19456
s_waitcnt lgkmcnt(7)
v_mfma_f32_16x16x32_bf16 v[140:143], v[92:95], a[72:75], v[140:143]
ds_read_b64_tr_b16 v[120:121], v16 offset:3072
ds_read_b64_tr_b16 v[122:123], v16 offset:19456
v_mfma_f32_16x16x32_bf16 v[156:159], v[92:95], a[76:79], v[156:159]
buffer_load_dwordx4 v29, s[36:39], s77 offen offset:3072 lds
v_mfma_f32_16x16x32_bf16 v[128:131], v[96:99], a[80:83], v[128:131]
ds_read_b64_tr_b16 v[124:125], v17 offset:3072
ds_read_b64_tr_b16 v[126:127], v17 offset:19456
v_mfma_f32_16x16x32_bf16 v[144:147], v[96:99], a[84:87], v[144:147]
buffer_store_dwordx2 v[246:247], v54, s[60:63], 0 offen offset:3584 sc1
v_mfma_f32_16x16x32_bf16 v[132:135], v[100:103], a[80:83], v[132:135]
ds_read_b64_tr_b16 v[80:81], v14 offset:4096
ds_read_b64_tr_b16 v[82:83], v14 offset:20480
v_mfma_f32_16x16x32_bf16 v[148:151], v[100:103], a[84:87], v[148:151]
ds_read_b64_tr_b16 v[84:85], v15 offset:4096
s_waitcnt lgkmcnt(8)
v_mfma_f32_16x16x32_bf16 v[136:139], v[104:107], a[80:83], v[136:139]
s_add_u32 m0, s76, 36864
s_add_u32 s77, s83, 0x40000
v_mfma_f32_16x16x32_bf16 v[152:155], v[104:107], a[84:87], v[152:155]
ds_read_b64_tr_b16 v[86:87], v15 offset:20480
ds_read_b64_tr_b16 v[88:89], v16 offset:4096
v_mfma_f32_16x16x32_bf16 v[140:143], v[108:111], a[80:83], v[140:143]
buffer_load_dwordx4 v26, s[36:39], s77 offen offset:0 lds
v_mfma_f32_16x16x32_bf16 v[156:159], v[108:111], a[84:87], v[156:159]
ds_read_b64_tr_b16 v[90:91], v16 offset:20480
ds_read_b64_tr_b16 v[92:93], v17 offset:4096
v_mfma_f32_16x16x32_bf16 v[128:131], v[112:115], a[88:91], v[128:131]
ds_write_b64 v53, v[228:229] offset:2048
v_mfma_f32_16x16x32_bf16 v[144:147], v[112:115], a[92:95], v[144:147]
ds_read_b64_tr_b16 v[94:95], v17 offset:20480
s_waitcnt lgkmcnt(7)
v_mfma_f32_16x16x32_bf16 v[132:135], v[116:119], a[88:91], v[132:135]
ds_read_b64_tr_b16 v[96:97], v14 offset:5120
ds_read_b64_tr_b16 v[98:99], v14 offset:21504
v_mfma_f32_16x16x32_bf16 v[148:151], v[116:119], a[92:95], v[148:151]
buffer_load_dwordx4 v27, s[36:39], s77 offen offset:1024 lds
v_mfma_f32_16x16x32_bf16 v[136:139], v[120:123], a[88:91], v[136:139]
ds_read_b64_tr_b16 v[100:101], v15 offset:5120
ds_read_b64_tr_b16 v[102:103], v15 offset:21504
v_mfma_f32_16x16x32_bf16 v[152:155], v[120:123], a[92:95], v[152:155]
ds_write_b64 v53, v[234:235] offset:2560
v_mfma_f32_16x16x32_bf16 v[140:143], v[124:127], a[88:91], v[140:143]
ds_read_b64_tr_b16 v[104:105], v16 offset:5120
ds_read_b64_tr_b16 v[106:107], v16 offset:21504
v_mfma_f32_16x16x32_bf16 v[156:159], v[124:127], a[92:95], v[156:159]
ds_write_b64 v53, v[240:241] offset:3072
v_mfma_f32_16x16x32_bf16 v[128:131], v[80:83], a[96:99], v[128:131]
ds_read_b64_tr_b16 v[108:109], v17 offset:5120
ds_read_b64_tr_b16 v[110:111], v17 offset:21504
v_mfma_f32_16x16x32_bf16 v[144:147], v[80:83], a[100:103], v[144:147]
ds_read_b64_tr_b16 v[112:113], v14 offset:6144
s_waitcnt lgkmcnt(9)
v_mfma_f32_16x16x32_bf16 v[132:135], v[84:87], a[96:99], v[132:135]
buffer_load_dwordx4 v28, s[36:39], s77 offen offset:2048 lds
v_mfma_f32_16x16x32_bf16 v[148:151], v[84:87], a[100:103], v[148:151]
ds_read_b64_tr_b16 v[114:115], v14 offset:22528
ds_read_b64_tr_b16 v[116:117], v15 offset:6144
v_mfma_f32_16x16x32_bf16 v[136:139], v[88:91], a[96:99], v[136:139]
s_waitcnt vmcnt(12)
v_cmp_lt_u32 vcc, v51, v50
s_cbranch_vccnz pl_2_slow
pl_2_ok:
v_mfma_f32_16x16x32_bf16 v[152:155], v[88:91], a[100:103], v[152:155]
ds_read_b64_tr_b16 v[118:119], v15 offset:22528
ds_read_b64_tr_b16 v[120:121], v16 offset:6144
v_mfma_f32_16x16x32_bf16 v[140:143], v[92:95], a[96:99], v[140:143]
ds_write_b64 v53, v[246:247] offset:3584
v_mfma_f32_16x16x32_bf16 v[156:159], v[92:95], a[100:103], v[156:159]
ds_read_b64_tr_b16 v[122:123], v16 offset:22528
v_mul_f32 v160, v60, v160
v_mfma_f32_16x16x32_bf16 v[128:131], v[96:99], a[104:107], v[128:131]
ds_read_b64_tr_b16 v[124:125], v17 offset:6144
v_mul_f32 v161, v61, v161
v_mfma_f32_16x16x32_bf16 v[144:147], v[96:99], a[108:111], v[144:147]
ds_read_b64_tr_b16 v[126:127], v17 offset:22528
s_waitcnt lgkmcnt(8)
v_mfma_f32_16x16x32_bf16 v[132:135], v[100:103], a[104:107], v[132:135]
ds_read_b64_tr_b16 v[80:81], v14 offset:7168
v_mul_f32 v162, v62, v162
v_mfma_f32_16x16x32_bf16 v[148:151], v[100:103], a[108:111], v[148:151]
ds_read_b64_tr_b16 v[82:83], v14 offset:23552
v_mul_f32 v163, v63, v163
v_mfma_f32_16x16x32_bf16 v[136:139], v[104:107], a[104:107], v[136:139]
ds_read_b64_tr_b16 v[84:85], v15 offset:7168
v_cvt_pk_bf16_f32 v226, v160, v161
v_mfma_f32_16x16x32_bf16 v[152:155], v[104:107], a[108:111], v[152:155]
ds_read_b64_tr_b16 v[86:87], v15 offset:23552
v_cvt_pk_bf16_f32 v227, v162, v163
v_mfma_f32_16x16x32_bf16 v[140:143], v[108:111], a[104:107], v[140:143]
ds_read_b64_tr_b16 v[88:89], v16 offset:7168
v_mul_f32 v164, v60, v164
v_mfma_f32_16x16x32_bf16 v[156:159], v[108:111], a[108:111], v[156:159]
ds_read_b64_tr_b16 v[90:91], v16 offset:23552
s_waitcnt lgkmcnt(7)
v_mfma_f32_16x16x32_bf16 v[128:131], v[112:115], a[112:115], v[128:131]
ds_read_b64_tr_b16 v[92:93], v17 offset:7168
v_mul_f32 v165, v61, v165
v_mfma_f32_16x16x32_bf16 v[144:147], v[112:115], a[116:119], v[144:147]
ds_read_b64_tr_b16 v[94:95], v17 offset:23552
v_mul_f32 v166, v62, v166
v_mfma_f32_16x16x32_bf16 v[132:135], v[116:119], a[112:115], v[132:135]
buffer_load_dwordx4 v29, s[36:39], s77 offen offset:3072 lds
v_mfma_f32_16x16x32_bf16 v[148:151], v[116:119], a[116:119], v[148:151]
s_lshl_b32 s78, s73, 4
s_add_u32 s78, s78, s74
s_lshl_b32 s78, s78, 12
s_add_u32 s78, s78, 0xf0000
s_cmp_lg_u32 s73, 0
s_cselect_b32 s78, s78, s96
s_cmp_eq_u32 s72, 0
s_cselect_b32 s78, s78, s96
s_cselect_b32 s79, 0, 16384
s_add_u32 m0, s79, 147456
v_add_u32 v56, s78, v46
buffer_load_dwordx4 v56, s[60:63], 0 offen offset:0 sc1 lds
buffer_load_dwordx4 v56, s[60:63], 0 offen offset:1024 sc1 lds
v_mfma_f32_16x16x32_bf16 v[136:139], v[120:123], a[112:115], v[136:139]
s_lshr_b32 s78, s2, 4
s_lshl_b32 s78, s78, 7
s_add_u32 s78, s78, 16384
v_lshl_add_u32 v4, v1, 11, s78
v_cmp_gt_u32 vcc, 8, v0
v_mov_b32 v5, s96
s_nop 0
v_cndmask_b32 v49, v5, v4, vcc
v_mov_b32 v4, 32
v_cndmask_b32 v50, 0, v4, vcc
v_mfma_f32_16x16x32_bf16 v[152:155], v[120:123], a[116:119], v[152:155]
s_mov_b32 s3, 0x500000
s_waitcnt lgkmcnt(3)
v_mfma_f32_16x16x32_bf16 v[140:143], v[124:127], a[112:115], v[140:143]
s_waitcnt lgkmcnt(0)
s_barrier
v_mfma_f32_16x16x32_bf16 v[156:159], v[124:127], a[116:119], v[156:159]
ds_read_b64_tr_b16 v[96:97], v14 offset:32768
ds_read_b64_tr_b16 v[98:99], v14 offset:49152
v_mfma_f32_16x16x32_bf16 v[128:131], v[80:83], a[120:123], v[128:131]
ds_read_b64_tr_b16 v[100:101], v15 offset:32768
ds_read_b64_tr_b16 v[102:103], v15 offset:49152
v_mfma_f32_16x16x32_bf16 v[144:147], v[80:83], a[124:127], v[144:147]
ds_read_b64_tr_b16 v[104:105], v16 offset:32768
ds_read_b64_tr_b16 v[106:107], v16 offset:49152
v_mfma_f32_16x16x32_bf16 v[132:135], v[84:87], a[120:123], v[132:135]
ds_read_b64_tr_b16 v[108:109], v17 offset:32768
ds_read_b64_tr_b16 v[110:111], v17 offset:49152
v_mfma_f32_16x16x32_bf16 v[148:151], v[84:87], a[124:127], v[148:151]
ds_read_b64_tr_b16 v[112:113], v14 offset:33792
ds_read_b64_tr_b16 v[114:115], v14 offset:50176
v_mfma_f32_16x16x32_bf16 v[136:139], v[88:91], a[120:123], v[136:139]
ds_read_b64_tr_b16 v[116:117], v15 offset:33792
s_add_u32 m0, s76, 65536
v_mfma_f32_16x16x32_bf16 v[152:155], v[88:91], a[124:127], v[152:155]
ds_read_b64_tr_b16 v[118:119], v15 offset:50176
s_add_u32 s77, s83, 0x80000
v_mfma_f32_16x16x32_bf16 v[140:143], v[92:95], a[120:123], v[140:143]
ds_read_b64_tr_b16 v[120:121], v16 offset:33792
v_mul_f32 v167, v63, v167
v_mfma_f32_16x16x32_bf16 v[156:159], v[92:95], a[124:127], v[156:159]
ds_read_b64_tr_b16 v[122:123], v16 offset:50176
s_waitcnt lgkmcnt(10)
v_mfma_f32_16x16x32_bf16 v[128:131], v[96:99], a[128:131], v[128:131]
ds_read_b64_tr_b16 v[124:125], v17 offset:33792
v_cvt_pk_bf16_f32 v232, v164, v165
v_mfma_f32_16x16x32_bf16 v[144:147], v[96:99], a[132:135], v[144:147]
ds_read_b64_tr_b16 v[126:127], v17 offset:50176
v_cvt_pk_bf16_f32 v233, v166, v167
v_mfma_f32_16x16x32_bf16 v[132:135], v[100:103], a[128:131], v[132:135]
ds_read_b64_tr_b16 v[80:81], v14 offset:34816
v_mul_f32 v168, v60, v168
v_mfma_f32_16x16x32_bf16 v[148:151], v[100:103], a[132:135], v[148:151]
ds_read_b64_tr_b16 v[82:83], v14 offset:51200
s_waitcnt lgkmcnt(7)
v_mfma_f32_16x16x32_bf16 v[136:139], v[104:107], a[128:131], v[136:139]
ds_read_b64_tr_b16 v[84:85], v15 offset:34816
v_mul_f32 v169, v61, v169
v_mfma_f32_16x16x32_bf16 v[152:155], v[104:107], a[132:135], v[152:155]
ds_read_b64_tr_b16 v[86:87], v15 offset:51200
v_mul_f32 v170, v62, v170
v_mfma_f32_16x16x32_bf16 v[140:143], v[108:111], a[128:131], v[140:143]
ds_read_b64_tr_b16 v[88:89], v16 offset:34816
v_mul_f32 v171, v63, v171
v_mfma_f32_16x16x32_bf16 v[156:159], v[108:111], a[132:135], v[156:159]
ds_read_b64_tr_b16 v[90:91], v16 offset:51200
v_cvt_pk_bf16_f32 v238, v168, v169
v_mfma_f32_16x16x32_bf16 v[128:131], v[112:115], a[136:139], v[128:131]
ds_read_b64_tr_b16 v[92:93], v17 offset:34816
v_cvt_pk_bf16_f32 v239, v170, v171
v_mfma_f32_16x16x32_bf16 v[144:147], v[112:115], a[140:143], v[144:147]
ds_read_b64_tr_b16 v[94:95], v17 offset:51200
s_waitcnt lgkmcnt(7)
v_mfma_f32_16x16x32_bf16 v[132:135], v[116:119], a[136:139], v[132:135]
ds_read_b64_tr_b16 v[96:97], v14 offset:35840
v_mul_f32 v172, v60, v172
v_mfma_f32_16x16x32_bf16 v[148:151], v[116:119], a[140:143], v[148:151]
ds_read_b64_tr_b16 v[98:99], v14 offset:52224
v_mul_f32 v173, v61, v173
v_mfma_f32_16x16x32_bf16 v[136:139], v[120:123], a[136:139], v[136:139]
ds_read_b64_tr_b16 v[100:101], v15 offset:35840
v_mul_f32 v174, v62, v174
v_mfma_f32_16x16x32_bf16 v[152:155], v[120:123], a[140:143], v[152:155]
ds_read_b64_tr_b16 v[102:103], v15 offset:52224
v_mul_f32 v175, v63, v175
v_mfma_f32_16x16x32_bf16 v[140:143], v[124:127], a[136:139], v[140:143]
ds_read_b64_tr_b16 v[104:105], v16 offset:35840
v_cvt_pk_bf16_f32 v244, v172, v173
v_mfma_f32_16x16x32_bf16 v[156:159], v[124:127], a[140:143], v[156:159]
ds_read_b64_tr_b16 v[106:107], v16 offset:52224
s_waitcnt lgkmcnt(7)
v_mfma_f32_16x16x32_bf16 v[128:131], v[80:83], a[144:147], v[128:131]
ds_read_b64_tr_b16 v[108:109], v17 offset:35840
v_cvt_pk_bf16_f32 v245, v174, v175
v_mfma_f32_16x16x32_bf16 v[144:147], v[80:83], a[148:151], v[144:147]
ds_read_b64_tr_b16 v[110:111], v17 offset:52224
ds_read_b64_tr_b16 v[112:113], v14 offset:36864
v_mfma_f32_16x16x32_bf16 v[132:135], v[84:87], a[144:147], v[132:135]
buffer_load_dwordx4 v26, s[36:39], s77 offen offset:0 lds
v_mfma_f32_16x16x32_bf16 v[148:151], v[84:87], a[148:151], v[148:151]
ds_read_b64_tr_b16 v[114:115], v14 offset:53248
ds_read_b64_tr_b16 v[116:117], v15 offset:36864
v_mfma_f32_16x16x32_bf16 v[136:139], v[88:91], a[144:147], v[136:139]
buffer_load_dword v57, v8, s[44:47], s3 offen
v_mfma_f32_16x16x32_bf16 v[152:155], v[88:91], a[148:151], v[152:155]
ds_read_b64_tr_b16 v[118:119], v15 offset:53248
s_waitcnt lgkmcnt(7)
v_mfma_f32_16x16x32_bf16 v[140:143], v[92:95], a[144:147], v[140:143]
ds_read_b64_tr_b16 v[120:121], v16 offset:36864
ds_read_b64_tr_b16 v[122:123], v16 offset:53248
v_mfma_f32_16x16x32_bf16 v[156:159], v[92:95], a[148:151], v[156:159]
buffer_load_dwordx4 v27, s[36:39], s77 offen offset:1024 lds
v_mfma_f32_16x16x32_bf16 v[128:131], v[96:99], a[152:155], v[128:131]
ds_read_b64_tr_b16 v[124:125], v17 offset:36864
ds_read_b64_tr_b16 v[126:127], v17 offset:53248
v_mfma_f32_16x16x32_bf16 v[144:147], v[96:99], a[156:159], v[144:147]
v_mov_b32 v51, 0
buffer_atomic_add v51, v49, s[60:63], 0 offen sc0 sc1
v_mfma_f32_16x16x32_bf16 v[132:135], v[100:103], a[152:155], v[132:135]
ds_read_b64_tr_b16 v[80:81], v14 offset:37888
ds_read_b64_tr_b16 v[82:83], v14 offset:54272
v_mfma_f32_16x16x32_bf16 v[148:151], v[100:103], a[156:159], v[148:151]
ds_read_b64_tr_b16 v[84:85], v15 offset:37888
s_waitcnt lgkmcnt(8)
v_mfma_f32_16x16x32_bf16 v[136:139], v[104:107], a[152:155], v[136:139]
buffer_load_dwordx4 v28, s[36:39], s77 offen offset:2048 lds
v_mfma_f32_16x16x32_bf16 v[152:155], v[104:107], a[156:159], v[152:155]
ds_read_b64_tr_b16 v[86:87], v15 offset:54272
ds_read_b64_tr_b16 v[88:89], v16 offset:37888
v_mfma_f32_16x16x32_bf16 v[140:143], v[108:111], a[152:155], v[140:143]
ds_read_b64_tr_b16 v[90:91], v16 offset:54272
v_mfma_f32_16x16x32_bf16 v[156:159], v[108:111], a[156:159], v[156:159]
ds_read_b64_tr_b16 v[92:93], v17 offset:37888
ds_read_b64_tr_b16 v[94:95], v17 offset:54272
v_mfma_f32_16x16x32_bf16 v[128:131], v[112:115], a[160:163], v[128:131]
ds_read_b64_tr_b16 v[96:97], v14 offset:38912
v_mfma_f32_16x16x32_bf16 v[144:147], v[112:115], a[164:167], v[144:147]
ds_read_b64_tr_b16 v[98:99], v14 offset:55296
s_waitcnt lgkmcnt(8)
v_mfma_f32_16x16x32_bf16 v[132:135], v[116:119], a[160:163], v[132:135]
buffer_load_dwordx4 v29, s[36:39], s77 offen offset:3072 lds
v_mfma_f32_16x16x32_bf16 v[148:151], v[116:119], a[164:167], v[148:151]
ds_read_b64_tr_b16 v[100:101], v15 offset:38912
ds_read_b64_tr_b16 v[102:103], v15 offset:55296
v_mfma_f32_16x16x32_bf16 v[136:139], v[120:123], a[160:163], v[136:139]
ds_read_b64_tr_b16 v[104:105], v16 offset:38912
v_mfma_f32_16x16x32_bf16 v[152:155], v[120:123], a[164:167], v[152:155]
ds_read_b64_tr_b16 v[106:107], v16 offset:55296
ds_read_b64_tr_b16 v[108:109], v17 offset:38912
v_mfma_f32_16x16x32_bf16 v[140:143], v[124:127], a[160:163], v[140:143]
ds_read_b64_tr_b16 v[110:111], v17 offset:55296
v_mfma_f32_16x16x32_bf16 v[156:159], v[124:127], a[164:167], v[156:159]
s_add_u32 m0, s76, 69632
s_add_u32 s77, s83, 0xc0000
v_mfma_f32_16x16x32_bf16 v[128:131], v[80:83], a[168:171], v[128:131]
buffer_load_dwordx4 v26, s[36:39], s77 offen offset:0 lds
v_mfma_f32_16x16x32_bf16 v[144:147], v[80:83], a[172:175], v[144:147]
ds_read_b64_tr_b16 v[112:113], v14 offset:39936
s_waitcnt lgkmcnt(7)
v_mfma_f32_16x16x32_bf16 v[132:135], v[84:87], a[168:171], v[132:135]
ds_read_b64_tr_b16 v[114:115], v14 offset:56320
ds_read_b64_tr_b16 v[116:117], v15 offset:39936
v_mfma_f32_16x16x32_bf16 v[148:151], v[84:87], a[172:175], v[148:151]
ds_read_b64_tr_b16 v[118:119], v15 offset:56320
v_mfma_f32_16x16x32_bf16 v[136:139], v[88:91], a[168:171], v[136:139]
ds_read_b64_tr_b16 v[120:121], v16 offset:39936
ds_read_b64_tr_b16 v[122:123], v16 offset:56320
v_mfma_f32_16x16x32_bf16 v[152:155], v[88:91], a[172:175], v[152:155]
buffer_load_dwordx4 v27, s[36:39], s77 offen offset:1024 lds
v_mfma_f32_16x16x32_bf16 v[140:143], v[92:95], a[168:171], v[140:143]
ds_read_b64_tr_b16 v[124:125], v17 offset:39936
ds_read_b64_tr_b16 v[126:127], v17 offset:56320
v_mfma_f32_16x16x32_bf16 v[156:159], v[92:95], a[172:175], v[156:159]
buffer_load_dwordx4 v28, s[36:39], s77 offen offset:2048 lds
v_mfma_f32_16x16x32_bf16 v[128:131], v[96:99], a[176:179], v[128:131]
buffer_load_dwordx4 v29, s[36:39], s77 offen offset:3072 lds
v_mfma_f32_16x16x32_bf16 v[144:147], v[96:99], a[180:183], v[144:147]
s_waitcnt lgkmcnt(5)
v_mfma_f32_16x16x32_bf16 v[132:135], v[100:103], a[176:179], v[132:135]
v_mfma_f32_16x16x32_bf16 v[148:151], v[100:103], a[180:183], v[148:151]
s_waitcnt lgkmcnt(0)
s_barrier
v_mfma_f32_16x16x32_bf16 v[136:139], v[104:107], a[176:179], v[136:139]
ds_read_b64_tr_b16 v[80:81], v10 offset:0
ds_read_b64_tr_b16 v[82:83], v10 offset:16384
v_mfma_f32_16x16x32_bf16 v[152:155], v[104:107], a[180:183], v[152:155]
ds_read_b64_tr_b16 v[84:85], v11 offset:0
ds_read_b64_tr_b16 v[86:87], v11 offset:16384
v_mfma_f32_16x16x32_bf16 v[140:143], v[108:111], a[176:179], v[140:143]
ds_read_b64_tr_b16 v[88:89], v12 offset:0
s_add_u32 m0, s76, 98304
v_mfma_f32_16x16x32_bf16 v[156:159], v[108:111], a[180:183], v[156:159]
ds_read_b64_tr_b16 v[90:91], v12 offset:16384
s_add_u32 s77, s83, 0x100000
v_mfma_f32_16x16x32_bf16 v[128:131], v[112:115], a[184:187], v[128:131]
ds_read_b64_tr_b16 v[92:93], v13 offset:0
ds_read_b64_tr_b16 v[94:95], v13 offset:16384
v_mfma_f32_16x16x32_bf16 v[144:147], v[112:115], a[188:191], v[144:147]
buffer_load_dwordx4 v26, s[36:39], s77 offen offset:0 lds
v_mfma_f32_16x16x32_bf16 v[132:135], v[116:119], a[184:187], v[132:135]
ds_read_b64_tr_b16 v[96:97], v10 offset:1024
ds_read_b64_tr_b16 v[98:99], v10 offset:17408
v_mfma_f32_16x16x32_bf16 v[148:151], v[116:119], a[188:191], v[148:151]
s_lshl_b32 s78, s73, 4
s_add_u32 s78, s78, s74
s_lshl_b32 s78, s78, 10
s_add_u32 s78, s78, 49152
s_cmp_eq_u32 s72, 3
s_cselect_b32 s78, s78, s96
s_cmp_lt_u32 s73, 15
s_cselect_b32 s78, s78, s96
v_mov_b32 v2, s96
v_writelane_b32 v2, s78, 0
v_mfma_f32_16x16x32_bf16 v[136:139], v[120:123], a[184:187], v[136:139]
ds_read_b64_tr_b16 v[100:101], v11 offset:1024
s_waitcnt vmcnt(17)
v_mfma_f32_16x16x32_bf16 v[152:155], v[120:123], a[188:191], v[152:155]
ds_read_b64_tr_b16 v[102:103], v11 offset:17408
ds_read_b64_tr_b16 v[104:105], v12 offset:1024
v_mfma_f32_16x16x32_bf16 v[140:143], v[124:127], a[184:187], v[140:143]
buffer_load_dwordx4 v27, s[36:39], s77 offen offset:1024 lds
v_mfma_f32_16x16x32_bf16 v[156:159], v[124:127], a[188:191], v[156:159]
ds_read_b64_tr_b16 v[106:107], v12 offset:17408
s_waitcnt lgkmcnt(6)
v_mfma_f32_16x16x32_bf16 v[128:131], v[80:83], a[192:195], v[128:131]
ds_read_b64_tr_b16 v[108:109], v13 offset:1024
ds_read_b64_tr_b16 v[110:111], v13 offset:17408
v_mfma_f32_16x16x32_bf16 v[144:147], v[80:83], a[196:199], v[144:147]
buffer_atomic_add v52, v2, s[60:63], 0 offen sc1
v_mfma_f32_16x16x32_bf16 v[132:135], v[84:87], a[192:195], v[132:135]
ds_read_b64_tr_b16 v[112:113], v10 offset:2048
ds_read_b64_tr_b16 v[114:115], v10 offset:18432
v_mfma_f32_16x16x32_bf16 v[148:151], v[84:87], a[196:199], v[148:151]
buffer_load_dwordx4 v28, s[36:39], s77 offen offset:2048 lds
v_mfma_f32_16x16x32_bf16 v[136:139], v[88:91], a[192:195], v[136:139]
ds_read_b64_tr_b16 v[116:117], v11 offset:2048
ds_read_b64_tr_b16 v[118:119], v11 offset:18432
v_mfma_f32_16x16x32_bf16 v[152:155], v[88:91], a[196:199], v[152:155]
s_waitcnt vmcnt(10)
v_cmp_lt_u32 vcc, v51, v50
s_cbranch_vccnz pl_3_slow
pl_3_ok:
v_mfma_f32_16x16x32_bf16 v[140:143], v[92:95], a[192:195], v[140:143]
ds_read_b64_tr_b16 v[120:121], v12 offset:2048
ds_read_b64_tr_b16 v[122:123], v12 offset:18432
v_mfma_f32_16x16x32_bf16 v[156:159], v[92:95], a[196:199], v[156:159]
ds_read_b64_tr_b16 v[124:125], v13 offset:2048
s_waitcnt lgkmcnt(7)
v_mfma_f32_16x16x32_bf16 v[128:131], v[96:99], a[200:203], v[128:131]
buffer_load_dwordx4 v29, s[36:39], s77 offen offset:3072 lds
v_mfma_f32_16x16x32_bf16 v[144:147], v[96:99], a[204:207], v[144:147]
ds_read_b64_tr_b16 v[126:127], v13 offset:18432
ds_read_b64_tr_b16 v[80:81], v10 offset:3072
v_mfma_f32_16x16x32_bf16 v[132:135], v[100:103], a[200:203], v[132:135]
ds_read_b64_tr_b16 v[82:83], v10 offset:19456
v_mfma_f32_16x16x32_bf16 v[148:151], v[100:103], a[204:207], v[148:151]
ds_read_b64_tr_b16 v[84:85], v11 offset:3072
ds_read_b64_tr_b16 v[86:87], v11 offset:19456
v_mfma_f32_16x16x32_bf16 v[136:139], v[104:107], a[200:203], v[136:139]
ds_read_b64_tr_b16 v[88:89], v12 offset:3072
v_mfma_f32_16x16x32_bf16 v[152:155], v[104:107], a[204:207], v[152:155]
s_add_u32 m0, s76, 102400
s_add_u32 s77, s83, 0x140000
v_mfma_f32_16x16x32_bf16 v[140:143], v[108:111], a[200:203], v[140:143]
buffer_load_dwordx4 v26, s[36:39], s77 offen offset:0 lds
v_mfma_f32_16x16x32_bf16 v[156:159], v[108:111], a[204:207], v[156:159]
ds_read_b64_tr_b16 v[90:91], v12 offset:19456
s_waitcnt lgkmcnt(7)
v_mfma_f32_16x16x32_bf16 v[128:131], v[112:115], a[208:211], v[128:131]
ds_read_b64_tr_b16 v[92:93], v13 offset:3072
ds_read_b64_tr_b16 v[94:95], v13 offset:19456
v_mfma_f32_16x16x32_bf16 v[144:147], v[112:115], a[212:215], v[144:147]
ds_read_b64_tr_b16 v[96:97], v10 offset:4096
v_mfma_f32_16x16x32_bf16 v[132:135], v[116:119], a[208:211], v[132:135]
ds_read_b64_tr_b16 v[98:99], v10 offset:20480
ds_read_b64_tr_b16 v[100:101], v11 offset:4096
v_mfma_f32_16x16x32_bf16 v[148:151], v[116:119], a[212:215], v[148:151]
buffer_load_dwordx4 v27, s[36:39], s77 offen offset:1024 lds
v_mfma_f32_16x16x32_bf16 v[136:139], v[120:123], a[208:211], v[136:139]
ds_read_b64_tr_b16 v[102:103], v11 offset:20480
ds_read_b64_tr_b16 v[104:105], v12 offset:4096
v_mfma_f32_16x16x32_bf16 v[152:155], v[120:123], a[212:215], v[152:155]
ds_read_b64_tr_b16 v[106:107], v12 offset:20480
s_waitcnt lgkmcnt(9)
v_mfma_f32_16x16x32_bf16 v[140:143], v[124:127], a[208:211], v[140:143]
ds_read_b64_tr_b16 v[108:109], v13 offset:4096
ds_read_b64_tr_b16 v[110:111], v13 offset:20480
v_mfma_f32_16x16x32_bf16 v[156:159], v[124:127], a[212:215], v[156:159]
ds_read_b64_tr_b16 v[112:113], v10 offset:5120
v_mfma_f32_16x16x32_bf16 v[128:131], v[80:83], a[216:219], v[128:131]
buffer_load_dwordx4 v28, s[36:39], s77 offen offset:2048 lds
v_mfma_f32_16x16x32_bf16 v[144:147], v[80:83], a[220:223], v[144:147]
ds_read_b64_tr_b16 v[114:115], v10 offset:21504
ds_read_b64_tr_b16 v[116:117], v11 offset:5120
v_mfma_f32_16x16x32_bf16 v[132:135], v[84:87], a[216:219], v[132:135]
ds_read_b64_tr_b16 v[118:119], v11 offset:21504
v_mfma_f32_16x16x32_bf16 v[148:151], v[84:87], a[220:223], v[148:151]
ds_read_b64_tr_b16 v[120:121], v12 offset:5120
s_waitcnt lgkmcnt(8)
v_mfma_f32_16x16x32_bf16 v[136:139], v[88:91], a[216:219], v[136:139]
ds_read_b64_tr_b16 v[122:123], v12 offset:21504
ds_read_b64_tr_b16 v[124:125], v13 offset:5120
v_mfma_f32_16x16x32_bf16 v[152:155], v[88:91], a[220:223], v[152:155]
buffer_load_dwordx4 v29, s[36:39], s77 offen offset:3072 lds
v_mfma_f32_16x16x32_bf16 v[140:143], v[92:95], a[216:219], v[140:143]
ds_read_b64_tr_b16 v[126:127], v13 offset:21504
ds_read_b64_tr_b16 v[80:81], v10 offset:6144
v_mfma_f32_16x16x32_bf16 v[156:159], v[92:95], a[220:223], v[156:159]
ds_read_b64_tr_b16 v[82:83], v10 offset:22528
v_mfma_f32_16x16x32_bf16 v[128:131], v[96:99], a[224:227], v[128:131]
ds_read_b64_tr_b16 v[84:85], v11 offset:6144
ds_read_b64_tr_b16 v[86:87], v11 offset:22528
v_mfma_f32_16x16x32_bf16 v[144:147], v[96:99], a[228:231], v[144:147]
ds_read_b64_tr_b16 v[88:89], v12 offset:6144
v_mfma_f32_16x16x32_bf16 v[132:135], v[100:103], a[224:227], v[132:135]
ds_read_b64_tr_b16 v[90:91], v12 offset:22528
ds_read_b64_tr_b16 v[92:93], v13 offset:6144
v_mfma_f32_16x16x32_bf16 v[148:151], v[100:103], a[228:231], v[148:151]
ds_read_b64_tr_b16 v[94:95], v13 offset:22528
s_waitcnt lgkmcnt(9)
v_mfma_f32_16x16x32_bf16 v[136:139], v[104:107], a[224:227], v[136:139]
ds_read_b64_tr_b16 v[96:97], v10 offset:7168
ds_read_b64_tr_b16 v[98:99], v10 offset:23552
v_mfma_f32_16x16x32_bf16 v[152:155], v[104:107], a[228:231], v[152:155]
ds_read_b64_tr_b16 v[100:101], v11 offset:7168
v_mfma_f32_16x16x32_bf16 v[140:143], v[108:111], a[224:227], v[140:143]
ds_read_b64_tr_b16 v[102:103], v11 offset:23552
ds_read_b64_tr_b16 v[104:105], v12 offset:7168
v_mfma_f32_16x16x32_bf16 v[156:159], v[108:111], a[228:231], v[156:159]
ds_read_b64_tr_b16 v[106:107], v12 offset:23552
v_mfma_f32_16x16x32_bf16 v[128:131], v[112:115], a[232:235], v[128:131]
ds_read_b64_tr_b16 v[108:109], v13 offset:7168
v_mfma_f32_16x16x32_bf16 v[144:147], v[112:115], a[236:239], v[144:147]
ds_read_b64_tr_b16 v[110:111], v13 offset:23552
v_mfma_f32_16x16x32_bf16 v[132:135], v[116:119], a[232:235], v[132:135]
v_mfma_f32_16x16x32_bf16 v[148:151], v[116:119], a[236:239], v[148:151]
v_mfma_f32_16x16x32_bf16 v[136:139], v[120:123], a[232:235], v[136:139]
v_mfma_f32_16x16x32_bf16 v[152:155], v[120:123], a[236:239], v[152:155]
s_waitcnt lgkmcnt(3)
v_mfma_f32_16x16x32_bf16 v[140:143], v[124:127], a[232:235], v[140:143]
s_waitcnt lgkmcnt(0)
s_barrier
v_mfma_f32_16x16x32_bf16 v[156:159], v[124:127], a[236:239], v[156:159]
s_add_u32 m0, s76, 0
s_add_u32 s77, s83, 0x180000
v_mfma_f32_16x16x32_bf16 v[128:131], v[80:83], a[240:243], v[128:131]
buffer_load_dwordx4 v26, s[36:39], s77 offen offset:0 lds
v_mfma_f32_16x16x32_bf16 v[144:147], v[80:83], a[244:247], v[144:147]
v_mfma_f32_16x16x32_bf16 v[132:135], v[84:87], a[240:243], v[132:135]
v_mfma_f32_16x16x32_bf16 v[148:151], v[84:87], a[244:247], v[148:151]
v_mfma_f32_16x16x32_bf16 v[136:139], v[88:91], a[240:243], v[136:139]
v_mfma_f32_16x16x32_bf16 v[152:155], v[88:91], a[244:247], v[152:155]
buffer_load_dwordx4 v27, s[36:39], s77 offen offset:1024 lds
v_mfma_f32_16x16x32_bf16 v[140:143], v[92:95], a[240:243], v[140:143]
v_mfma_f32_16x16x32_bf16 v[156:159], v[92:95], a[244:247], v[156:159]
v_mfma_f32_16x16x32_bf16 v[128:131], v[96:99], a[248:251], v[128:131]
v_mfma_f32_16x16x32_bf16 v[144:147], v[96:99], a[252:255], v[144:147]
v_mfma_f32_16x16x32_bf16 v[132:135], v[100:103], a[248:251], v[132:135]
buffer_load_dwordx4 v28, s[36:39], s77 offen offset:2048 lds
v_mfma_f32_16x16x32_bf16 v[148:151], v[100:103], a[252:255], v[148:151]
v_mfma_f32_16x16x32_bf16 v[136:139], v[104:107], a[248:251], v[136:139]
v_mfma_f32_16x16x32_bf16 v[152:155], v[104:107], a[252:255], v[152:155]
v_mfma_f32_16x16x32_bf16 v[140:143], v[108:111], a[248:251], v[140:143]
v_mfma_f32_16x16x32_bf16 v[156:159], v[108:111], a[252:255], v[156:159]
buffer_load_dwordx4 v29, s[36:39], s77 offen offset:3072 lds
s_add_u32 m0, s76, 4096
s_add_u32 s77, s83, 0x1c0000
buffer_load_dwordx4 v26, s[36:39], s77 offen offset:0 lds
buffer_load_dwordx4 v27, s[36:39], s77 offen offset:1024 lds
buffer_load_dwordx4 v28, s[36:39], s77 offen offset:2048 lds
buffer_load_dwordx4 v29, s[36:39], s77 offen offset:3072 lds
T_attn:
s_lshl_b32 s78, s72, 12
s_add_u32 s78, s78, 147456
v_add_u32 v53, s78, v46
v_lshl_add_u32 v54, v1, 3, s78
ds_read_b128 v[208:211], v53 offset:0
ds_read_b128 v[212:215], v53 offset:1024
s_lshl_b32 s78, s73, 4
s_add_u32 s78, s78, s74
s_lshl_b32 s78, s78, 10
s_add_u32 s78, s78, 32768
s_cmp_eq_u32 s72, 0
s_cselect_b32 s79, s73, 0
s_cmp_lg_u32 s79, 0
s_cselect_b32 s78, s78, s96
s_cselect_b32 s79, 2, 0
v_mov_b32 v49, s96
v_writelane_b32 v49, s78, 0
v_mov_b32 v50, 0
v_writelane_b32 v50, s79, 0
v_mov_b32 v51, 0
buffer_atomic_add v51, v49, s[60:63], 0 offen sc0 sc1
v_mov_b32 v4, v58
v_mov_b32 v5, v58
v_mov_b32 v6, v59
v_mov_b32 v7, v59
v_pk_mul_f32 v[128:129], v[128:129], v[4:5]
v_pk_mul_f32 v[130:131], v[130:131], v[4:5]
v_pk_mul_f32 v[132:133], v[132:133], v[4:5]
v_pk_mul_f32 v[134:135], v[134:135], v[4:5]
v_pk_mul_f32 v[136:137], v[136:137], v[4:5]
v_pk_mul_f32 v[138:139], v[138:139], v[4:5]
v_pk_mul_f32 v[140:141], v[140:141], v[4:5]
v_pk_mul_f32 v[142:143], v[142:143], v[4:5]
v_pk_mul_f32 v[144:145], v[144:145], v[6:7]
v_pk_mul_f32 v[146:147], v[146:147], v[6:7]
v_pk_mul_f32 v[148:149], v[148:149], v[6:7]
v_pk_mul_f32 v[150:151], v[150:151], v[6:7]
v_pk_mul_f32 v[152:153], v[152:153], v[6:7]
v_pk_mul_f32 v[154:155], v[154:155], v[6:7]
v_pk_mul_f32 v[156:157], v[156:157], v[6:7]
v_pk_mul_f32 v[158:159], v[158:159], v[6:7]
v_cvt_pk_bf16_f32 v80, v128, v129
v_cvt_pk_bf16_f32 v81, v130, v131
v_cvt_pk_bf16_f32 v82, v132, v133
v_cvt_pk_bf16_f32 v83, v134, v135
v_cvt_pk_bf16_f32 v84, v136, v137
v_cvt_pk_bf16_f32 v85, v138, v139
v_cvt_pk_bf16_f32 v86, v140, v141
v_cvt_pk_bf16_f32 v87, v142, v143
v_cvt_pk_bf16_f32 v88, v144, v145
v_cvt_pk_bf16_f32 v89, v146, v147
v_cvt_pk_bf16_f32 v90, v148, v149
v_cvt_pk_bf16_f32 v91, v150, v151
v_cvt_pk_bf16_f32 v92, v152, v153
v_cvt_pk_bf16_f32 v93, v154, v155
v_cvt_pk_bf16_f32 v94, v156, v157
v_cvt_pk_bf16_f32 v95, v158, v159
v_mfma_f32_16x16x32_bf16 v[164:167], v[192:195], v[80:83], 0
s_waitcnt lgkmcnt(1)
v_mfma_f32_16x16x32_bf16 v[160:163], v[208:211], v[80:83], 0
v_mfma_f32_16x16x32_bf16 v[172:175], v[196:199], v[84:87], 0
s_waitcnt lgkmcnt(0)
v_mfma_f32_16x16x32_bf16 v[168:171], v[212:215], v[84:87], 0
v_mfma_f32_16x16x32_bf16 v[180:183], v[200:203], v[88:91], 0
v_mfma_f32_16x16x32_bf16 v[176:179], v[192:195], v[88:91], 0
v_mfma_f32_16x16x32_bf16 v[188:191], v[204:207], v[92:95], 0
v_mfma_f32_16x16x32_bf16 v[184:187], v[196:199], v[92:95], 0
s_waitcnt vmcnt(0)
v_cmp_lt_u32 vcc, v51, v50
s_cbranch_vccnz pl_4_slow
pl_4_ok:
s_lshl_b32 s78, s73, 4
s_add_u32 s78, s78, s74
s_lshl_b32 s78, s78, 12
s_add_u32 s78, s78, 0xf0000
s_cmp_lg_u32 s73, 0
s_cselect_b32 s78, s78, s96
s_cmp_eq_u32 s72, 0
s_cselect_b32 s78, s78, s96
s_cselect_b32 s79, 0, 16384
s_add_u32 m0, s79, 147456
v_add_u32 v56, s78, v46
buffer_load_dwordx4 v56, s[60:63], 0 offen offset:2048 sc1 lds
buffer_load_dwordx4 v56, s[60:63], 0 offen offset:3072 sc1 lds
s_mov_b32 s78, 0x3e8293ee
s_mov_b32 s79, 0x3e8293ee
v_mov_b32 v2, 0xf149f2ca
v_pk_mul_f32 v[160:161], v[160:161], s[78:79]
v_pk_mul_f32 v[162:163], v[162:163], s[78:79]
v_pk_mul_f32 v[164:165], v[164:165], s[78:79]
v_pk_mul_f32 v[166:167], v[166:167], s[78:79]
v_pk_mul_f32 v[168:169], v[168:169], s[78:79]
v_pk_mul_f32 v[170:171], v[170:171], s[78:79]
v_pk_mul_f32 v[172:173], v[172:173], s[78:79]
v_pk_mul_f32 v[174:175], v[174:175], s[78:79]
v_pk_mul_f32 v[176:177], v[176:177], s[78:79]
v_pk_mul_f32 v[178:179], v[178:179], s[78:79]
v_pk_mul_f32 v[180:181], v[180:181], s[78:79]
v_pk_mul_f32 v[182:183], v[182:183], s[78:79]
v_pk_mul_f32 v[184:185], v[184:185], s[78:79]
v_pk_mul_f32 v[186:187], v[186:187], s[78:79]
v_pk_mul_f32 v[188:189], v[188:189], s[78:79]
v_pk_mul_f32 v[190:191], v[190:191], s[78:79]
v_cndmask_b32 v160, v2, v160, s[20:21]
v_cndmask_b32 v164, v2, v164, s[12:13]
v_cndmask_b32 v161, v2, v161, s[22:23]
v_cndmask_b32 v165, v2, v165, s[14:15]
v_cndmask_b32 v162, v2, v162, s[24:25]
v_cndmask_b32 v166, v2, v166, s[16:17]
v_cndmask_b32 v163, v2, v163, s[26:27]
v_cndmask_b32 v167, v2, v167, s[18:19]
v_cndmask_b32 v168, v2, v168, s[20:21]
v_cndmask_b32 v172, v2, v172, s[12:13]
v_cndmask_b32 v169, v2, v169, s[22:23]
v_cndmask_b32 v173, v2, v173, s[14:15]
v_cndmask_b32 v170, v2, v170, s[24:25]
v_cndmask_b32 v174, v2, v174, s[16:17]
v_cndmask_b32 v171, v2, v171, s[26:27]
v_cndmask_b32 v175, v2, v175, s[18:19]
v_cndmask_b32 v176, v2, v176, s[4:5]
v_cndmask_b32 v180, v2, v180, s[12:13]
v_cndmask_b32 v177, v2, v177, s[6:7]
v_cndmask_b32 v181, v2, v181, s[14:15]
v_cndmask_b32 v178, v2, v178, s[8:9]
v_cndmask_b32 v182, v2, v182, s[16:17]
v_cndmask_b32 v179, v2, v179, s[10:11]
v_cndmask_b32 v183, v2, v183, s[18:19]
v_cndmask_b32 v184, v2, v184, s[4:5]
v_cndmask_b32 v188, v2, v188, s[12:13]
v_cndmask_b32 v185, v2, v185, s[6:7]
v_cndmask_b32 v189, v2, v189, s[14:15]
v_cndmask_b32 v186, v2, v186, s[8:9]
v_cndmask_b32 v190, v2, v190, s[16:17]
v_cndmask_b32 v187, v2, v187, s[10:11]
v_cndmask_b32 v191, v2, v191, s[18:19]
v_max3_f32 v112, v160, v161, v162
v_max3_f32 v116, v163, v164, v165
v_max3_f32 v113, v168, v169, v170
v_max3_f32 v117, v171, v172, v173
v_max3_f32 v114, v176, v177, v178
v_max3_f32 v118, v179, v180, v181
v_max3_f32 v115, v184, v185, v186
v_max3_f32 v119, v187, v188, v189
v_max3_f32 v112, v112, v166, v167
v_max3_f32 v113, v113, v174, v175
v_max3_f32 v114, v114, v182, v183
v_max3_f32 v115, v115, v190, v191
v_max_f32 v112, v112, v116
v_max_f32 v113, v113, v117
v_max_f32 v114, v114, v118
v_max_f32 v115, v115, v119
v_mov_b32 v116, v112
v_mov_b32 v117, v113
v_mov_b32 v118, v114
v_mov_b32 v119, v115
v_permlane32_swap_b32 v112, v116
v_permlane32_swap_b32 v113, v117
v_permlane32_swap_b32 v114, v118
v_permlane32_swap_b32 v115, v119
v_max_f32 v112, v112, v116
v_max_f32 v113, v113, v117
v_max_f32 v114, v114, v118
v_max_f32 v115, v115, v119
v_mov_b32 v116, v112
v_mov_b32 v117, v113
v_mov_b32 v118, v114
v_mov_b32 v119, v115
v_permlane16_swap_b32 v112, v116
v_permlane16_swap_b32 v113, v117
v_permlane16_swap_b32 v114, v118
v_permlane16_swap_b32 v115, v119
v_max_f32 v112, v112, v116
v_max_f32 v113, v113, v117
v_max_f32 v114, v114, v118
v_max_f32 v115, v115, v119
v_sub_f32 v160, v160, v112
v_sub_f32 v161, v161, v112
v_sub_f32 v162, v162, v112
v_sub_f32 v163, v163, v112
v_sub_f32 v164, v164, v112
v_sub_f32 v165, v165, v112
v_sub_f32 v166, v166, v112
v_sub_f32 v167, v167, v112
v_sub_f32 v168, v168, v113
v_sub_f32 v169, v169, v113
v_sub_f32 v170, v170, v113
v_sub_f32 v171, v171, v113
v_sub_f32 v172, v172, v113
v_sub_f32 v173, v173, v113
v_sub_f32 v174, v174, v113
v_sub_f32 v175, v175, v113
v_sub_f32 v176, v176, v114
v_sub_f32 v177, v177, v114
v_sub_f32 v178, v178, v114
v_sub_f32 v179, v179, v114
v_sub_f32 v180, v180, v114
v_sub_f32 v181, v181, v114
v_sub_f32 v182, v182, v114
v_sub_f32 v183, v183, v114
v_sub_f32 v184, v184, v115
v_sub_f32 v185, v185, v115
v_sub_f32 v186, v186, v115
v_sub_f32 v187, v187, v115
v_sub_f32 v188, v188, v115
v_sub_f32 v189, v189, v115
v_sub_f32 v190, v190, v115
v_sub_f32 v191, v191, v115
v_exp_f32 v160, v160
v_exp_f32 v161, v161
v_exp_f32 v162, v162
v_exp_f32 v163, v163
v_exp_f32 v164, v164
v_exp_f32 v165, v165
v_exp_f32 v166, v166
v_exp_f32 v167, v167
v_exp_f32 v168, v168
v_exp_f32 v169, v169
v_exp_f32 v170, v170
v_exp_f32 v171, v171
v_exp_f32 v172, v172
v_exp_f32 v173, v173
v_exp_f32 v174, v174
v_exp_f32 v175, v175
v_exp_f32 v176, v176
v_exp_f32 v177, v177
v_exp_f32 v178, v178
v_exp_f32 v179, v179
v_exp_f32 v180, v180
v_exp_f32 v181, v181
v_exp_f32 v182, v182
v_exp_f32 v183, v183
v_exp_f32 v184, v184
v_exp_f32 v185, v185
v_exp_f32 v186, v186
v_exp_f32 v187, v187
v_exp_f32 v188, v188
v_exp_f32 v189, v189
v_exp_f32 v190, v190
v_exp_f32 v191, v191
s_waitcnt vmcnt(0)
ds_read_b64 v[224:225], v54 offset:2048
ds_read_b64 v[230:231], v54 offset:2560
ds_read_b64 v[236:237], v54 offset:3072
ds_read_b64 v[242:243], v54 offset:3584
v_pk_add_f32 v[120:121], v[160:161], v[162:163]
v_pk_add_f32 v[122:123], v[168:169], v[170:171]
v_pk_add_f32 v[124:125], v[176:177], v[178:179]
v_pk_add_f32 v[126:127], v[184:185], v[186:187]
v_pk_add_f32 v[120:121], v[120:121], v[164:165]
v_pk_add_f32 v[122:123], v[122:123], v[172:173]
v_pk_add_f32 v[124:125], v[124:125], v[180:181]
v_pk_add_f32 v[126:127], v[126:127], v[188:189]
v_pk_add_f32 v[120:121], v[120:121], v[166:167]
v_pk_add_f32 v[122:123], v[122:123], v[174:175]
v_pk_add_f32 v[124:125], v[124:125], v[182:183]
v_pk_add_f32 v[126:127], v[126:127], v[190:191]
v_add_f32 v120, v120, v121
v_add_f32 v122, v122, v123
v_add_f32 v124, v124, v125
v_add_f32 v126, v126, v127
v_mov_b32 v116, v120
v_mov_b32 v117, v122
v_mov_b32 v118, v124
v_mov_b32 v119, v126
v_permlane32_swap_b32 v120, v116
v_permlane32_swap_b32 v122, v117
v_permlane32_swap_b32 v124, v118
v_permlane32_swap_b32 v126, v119
v_add_f32 v120, v120, v116
v_add_f32 v122, v122, v117
v_add_f32 v124, v124, v118
v_add_f32 v126, v126, v119
v_mov_b32 v116, v120
v_mov_b32 v117, v122
v_mov_b32 v118, v124
v_mov_b32 v119, v126
v_permlane16_swap_b32 v120, v116
v_permlane16_swap_b32 v122, v117
v_permlane16_swap_b32 v124, v118
v_permlane16_swap_b32 v126, v119
v_add_f32 v120, v120, v116
v_add_f32 v122, v122, v117
v_add_f32 v124, v124, v118
v_add_f32 v126, v126, v119
v_rcp_f32 v120, v120
v_rcp_f32 v122, v122
v_rcp_f32 v124, v124
v_rcp_f32 v126, v126
v_mov_b32 v121, v120
v_mov_b32 v123, v122
v_mov_b32 v125, v124
v_mov_b32 v127, v126
v_pk_mul_f32 v[160:161], v[160:161], v[120:121]
v_pk_mul_f32 v[162:163], v[162:163], v[120:121]
v_pk_mul_f32 v[164:165], v[164:165], v[120:121]
v_pk_mul_f32 v[166:167], v[166:167], v[120:121]
v_pk_mul_f32 v[168:169], v[168:169], v[122:123]
v_pk_mul_f32 v[170:171], v[170:171], v[122:123]
v_pk_mul_f32 v[172:173], v[172:173], v[122:123]
v_pk_mul_f32 v[174:175], v[174:175], v[122:123]
v_pk_mul_f32 v[176:177], v[176:177], v[124:125]
v_pk_mul_f32 v[178:179], v[178:179], v[124:125]
v_pk_mul_f32 v[180:181], v[180:181], v[124:125]
v_pk_mul_f32 v[182:183], v[182:183], v[124:125]
v_pk_mul_f32 v[184:185], v[184:185], v[126:127]
v_pk_mul_f32 v[186:187], v[186:187], v[126:127]
v_pk_mul_f32 v[188:189], v[188:189], v[126:127]
v_pk_mul_f32 v[190:191], v[190:191], v[126:127]
v_cvt_pk_bf16_f32 v96, v160, v161
v_cvt_pk_bf16_f32 v97, v162, v163
v_cvt_pk_bf16_f32 v98, v164, v165
v_cvt_pk_bf16_f32 v99, v166, v167
v_cvt_pk_bf16_f32 v100, v168, v169
v_cvt_pk_bf16_f32 v101, v170, v171
v_cvt_pk_bf16_f32 v102, v172, v173
v_cvt_pk_bf16_f32 v103, v174, v175
v_cvt_pk_bf16_f32 v104, v176, v177
v_cvt_pk_bf16_f32 v105, v178, v179
v_cvt_pk_bf16_f32 v106, v180, v181
v_cvt_pk_bf16_f32 v107, v182, v183
v_cvt_pk_bf16_f32 v108, v184, v185
v_cvt_pk_bf16_f32 v109, v186, v187
v_cvt_pk_bf16_f32 v110, v188, v189
v_cvt_pk_bf16_f32 v111, v190, v191
s_waitcnt lgkmcnt(3)
v_mfma_f32_16x16x32_bf16 v[128:131], v[224:227], v[96:99], 0
s_waitcnt lgkmcnt(2)
v_mfma_f32_16x16x32_bf16 v[132:135], v[230:233], v[96:99], 0
s_waitcnt lgkmcnt(1)
v_mfma_f32_16x16x32_bf16 v[136:139], v[236:239], v[100:103], 0
s_waitcnt lgkmcnt(0)
v_mfma_f32_16x16x32_bf16 v[140:143], v[242:245], v[100:103], 0
v_mfma_f32_16x16x32_bf16 v[144:147], v[226:229], v[104:107], 0
v_mfma_f32_16x16x32_bf16 v[148:151], v[232:235], v[104:107], 0
v_mfma_f32_16x16x32_bf16 v[152:155], v[238:241], v[108:111], 0
v_mfma_f32_16x16x32_bf16 v[156:159], v[244:247], v[108:111], 0
s_lshl_b32 s78, s74, 12
s_add_u32 s78, s78, s88
s_add_u32 s91, s78, 0x200000
v_cvt_pk_bf16_f32 v80, v128, v129
v_cvt_pk_bf16_f32 v81, v130, v131
v_cvt_pk_bf16_f32 v82, v132, v133
v_cvt_pk_bf16_f32 v83, v134, v135
buffer_store_dwordx4 v[80:83], v46, s[60:63], s91 offen offset:0 sc1
v_cvt_pk_bf16_f32 v84, v136, v137
v_cvt_pk_bf16_f32 v85, v138, v139
v_cvt_pk_bf16_f32 v86, v140, v141
v_cvt_pk_bf16_f32 v87, v142, v143
buffer_store_dwordx4 v[84:87], v46, s[60:63], s91 offen offset:2048 sc1
v_cvt_pk_bf16_f32 v88, v144, v145
v_cvt_pk_bf16_f32 v89, v146, v147
v_cvt_pk_bf16_f32 v90, v148, v149
v_cvt_pk_bf16_f32 v91, v150, v151
buffer_store_dwordx4 v[88:91], v46, s[60:63], s91 offen offset:1024 sc1
v_cvt_pk_bf16_f32 v92, v152, v153
v_cvt_pk_bf16_f32 v93, v154, v155
v_cvt_pk_bf16_f32 v94, v156, v157
v_cvt_pk_bf16_f32 v95, v158, v159
buffer_store_dwordx4 v[92:95], v46, s[60:63], s91 offen offset:3072 sc1
s_add_u32 s79, s72, 0
s_lshl_b32 s78, s73, 4
s_add_u32 s78, s78, s79
s_lshl_b32 s78, s78, 10
s_add_u32 s78, s78, 33408
v_mov_b32 v49, s96
v_writelane_b32 v49, s78, 0
v_mov_b32 v50, 0
v_writelane_b32 v50, 16, 0
s_waitcnt vmcnt(0)
buffer_atomic_add v52, v49, s[60:63], 0 offen sc1
v_lshlrev_b32 v2, 4, v0
s_mov_b32 s78, 0x91000
buffer_load_dwordx4 v[80:83], v2, s[60:63], s78 offen sc1
s_mov_b32 s78, 0x95000
buffer_load_dwordx4 v[84:87], v2, s[60:63], s78 offen sc1
s_mov_b32 s78, 0x99000
buffer_load_dwordx4 v[88:91], v2, s[60:63], s78 offen sc1
s_mov_b32 s78, 0x9d000
buffer_load_dwordx4 v[92:95], v2, s[60:63], s78 offen sc1
s_mov_b32 s78, 0x92000
buffer_load_dwordx4 v[96:99], v2, s[60:63], s78 offen sc1
s_mov_b32 s78, 0x96000
buffer_load_dwordx4 v[100:103], v2, s[60:63], s78 offen sc1
s_mov_b32 s78, 0x9a000
buffer_load_dwordx4 v[104:107], v2, s[60:63], s78 offen sc1
s_mov_b32 s78, 0x9e000
buffer_load_dwordx4 v[108:111], v2, s[60:63], s78 offen sc1
s_lshl_b32 s78, s75, 8
v_and_b32 v7, 15, v1
v_lshl_add_u32 v7, v7, 4, s78
v_bfe_u32 v6, v1, 4, 1
v_mul_u32_u24 v6, 12288, v6
v_add_u32 v7, v7, v6
s_mov_b32 s78, 0x90000
buffer_load_dwordx4 v[192:195], v7, s[60:63], s78 offen sc1
s_mov_b32 s78, 0x94000
buffer_load_dwordx4 v[196:199], v7, s[60:63], s78 offen sc1
s_mov_b32 s78, 0x98000
buffer_load_dwordx4 v[200:203], v7, s[60:63], s78 offen sc1
s_mov_b32 s78, 0x9c000
buffer_load_dwordx4 v[204:207], v7, s[60:63], s78 offen sc1
v_mov_b32 v51, 0
buffer_atomic_add v51, v49, s[60:63], 0 offen sc0 sc1
v_lshlrev_b32 v160, 16, v216
v_and_b32 v161, 0xffff0000, v216
v_lshlrev_b32 v162, 16, v217
v_and_b32 v163, 0xffff0000, v217
v_lshlrev_b32 v164, 16, v218
v_and_b32 v165, 0xffff0000, v218
v_lshlrev_b32 v166, 16, v219
v_and_b32 v167, 0xffff0000, v219
v_lshlrev_b32 v168, 16, v220
v_and_b32 v169, 0xffff0000, v220
v_lshlrev_b32 v170, 16, v221
v_and_b32 v171, 0xffff0000, v221
v_lshlrev_b32 v172, 16, v222
v_and_b32 v173, 0xffff0000, v222
v_lshlrev_b32 v174, 16, v223
v_and_b32 v175, 0xffff0000, v223
v_lshlrev_b32 v176, 16, v248
v_and_b32 v177, 0xffff0000, v248
v_lshlrev_b32 v178, 16, v249
v_and_b32 v179, 0xffff0000, v249
v_lshlrev_b32 v180, 16, v250
v_and_b32 v181, 0xffff0000, v250
v_lshlrev_b32 v182, 16, v251
v_and_b32 v183, 0xffff0000, v251
v_lshlrev_b32 v184, 16, v252
v_and_b32 v185, 0xffff0000, v252
v_lshlrev_b32 v186, 16, v253
v_and_b32 v187, 0xffff0000, v253
v_lshlrev_b32 v188, 16, v254
v_and_b32 v189, 0xffff0000, v254
v_lshlrev_b32 v190, 16, v255
v_and_b32 v191, 0xffff0000, v255
v_lshrrev_b32 v2, 3, v0
v_and_b32 v3, 3, v0
v_bfe_u32 v4, v0, 2, 1
v_mul_u32_u24 v5, 272, v2
v_lshl_add_u32 v5, v3, 6, v5
v_lshl_add_u32 v5, v4, 3, v5
v_add_u32 v5, 131072, v5
v_lshlrev_b32 v6, 7, v2
v_lshl_add_u32 v6, v3, 5, v6
v_lshl_add_u32 v6, v4, 2, v6
v_add_u32 v6, 139776, v6
v_mov_b32 v113, 0
v_mov_b32 v115, 0
v_mov_b32 v116, 0
v_mov_b32 v118, 0
s_waitcnt vmcnt(11)
v_pk_add_f32 v[80:81], v[80:81], v[84:85]
s_waitcnt vmcnt(9)
v_pk_add_f32 v[88:89], v[88:89], v[92:93]
v_pk_add_f32 v[82:83], v[82:83], v[86:87]
v_pk_add_f32 v[90:91], v[90:91], v[94:95]
v_pk_add_f32 v[80:81], v[80:81], v[88:89]
v_pk_add_f32 v[82:83], v[82:83], v[90:91]
s_waitcnt vmcnt(7)
v_pk_add_f32 v[96:97], v[96:97], v[100:101]
s_waitcnt vmcnt(5)
v_pk_add_f32 v[104:105], v[104:105], v[108:109]
v_pk_add_f32 v[98:99], v[98:99], v[102:103]
v_pk_add_f32 v[106:107], v[106:107], v[110:111]
v_pk_add_f32 v[96:97], v[96:97], v[104:105]
v_pk_add_f32 v[98:99], v[98:99], v[106:107]
v_cvt_pk_bf16_f32 v100, v96, v97
v_cvt_pk_bf16_f32 v102, v98, v99
v_lshlrev_b32 v96, 16, v100
v_and_b32 v97, 0xffff0000, v100
v_lshlrev_b32 v98, 16, v102
v_and_b32 v99, 0xffff0000, v102
v_add_f32 v96, 1.0, v96
v_add_f32 v97, 1.0, v97
v_add_f32 v98, 1.0, v98
v_add_f32 v99, 1.0, v99
v_cvt_pk_bf16_f32 v120, v80, v96
v_cvt_pk_bf16_f32 v121, v81, v97
v_cvt_pk_bf16_f32 v122, v82, v98
v_cvt_pk_bf16_f32 v123, v83, v99
v_lshrrev_b32 v112, 16, v120
v_and_b32 v114, 0xffff0000, v121
v_lshrrev_b32 v117, 16, v122
v_and_b32 v119, 0xffff0000, v123
ds_write_b64 v5, v[112:113] offset:0
ds_write_b64 v5, v[114:115] offset:16
ds_write_b64 v5, v[116:117] offset:32
ds_write_b64 v5, v[118:119] offset:48
ds_write2_b32 v6, v120, v121 offset0:0 offset1:2
ds_write2_b32 v6, v122, v123 offset0:4 offset1:6
s_waitcnt vmcnt(3)
v_pk_add_f32 v[192:193], v[192:193], v[196:197]
s_waitcnt vmcnt(1)
v_pk_add_f32 v[200:201], v[200:201], v[204:205]
v_pk_add_f32 v[194:195], v[194:195], v[198:199]
v_pk_add_f32 v[202:203], v[202:203], v[206:207]
v_pk_add_f32 v[192:193], v[192:193], v[200:201]
v_pk_add_f32 v[194:195], v[194:195], v[202:203]
v_cvt_pk_bf16_f32 v196, v192, v193
v_cvt_pk_bf16_f32 v198, v194, v195
v_lshlrev_b32 v192, 16, v196
v_and_b32 v193, 0xffff0000, v196
v_lshlrev_b32 v194, 16, v198
v_and_b32 v195, 0xffff0000, v198
v_and_b32 v7, 0x1f0, v46
v_add_u32 v7, 144384, v7
ds_write_b128 v7, v[192:195]
v_and_b32 v56, 48, v1
v_add_u32 v56, 144384, v56
s_waitcnt lgkmcnt(0)
ds_read_b128 v[192:195], v56 offset:0
ds_read_b128 v[196:199], v56 offset:64
ds_read_b128 v[200:203], v56 offset:128
ds_read_b128 v[204:207], v56 offset:192
ds_read_b64_tr_b16 v[112:113], v10 offset:32768
ds_read_b64_tr_b16 v[114:115], v10 offset:49152
ds_read_b64_tr_b16 v[116:117], v11 offset:32768
ds_read_b64_tr_b16 v[118:119], v11 offset:49152
ds_read_b64_tr_b16 v[120:121], v12 offset:32768
ds_read_b64_tr_b16 v[122:123], v12 offset:49152
ds_read_b64_tr_b16 v[124:125], v13 offset:32768
ds_read_b64_tr_b16 v[126:127], v13 offset:49152
ds_read_b64_tr_b16 v[80:81], v10 offset:33792
ds_read_b64_tr_b16 v[82:83], v10 offset:50176
ds_read_b64_tr_b16 v[84:85], v11 offset:33792
ds_read_b64_tr_b16 v[86:87], v11 offset:50176
ds_read_b64_tr_b16 v[88:89], v12 offset:33792
ds_read_b64_tr_b16 v[90:91], v12 offset:50176
ds_read_b64_tr_b16 v[92:93], v13 offset:33792
ds_read_b64_tr_b16 v[94:95], v13 offset:50176
s_waitcnt vmcnt(0)
v_cmp_lt_u32 vcc, v51, v50
s_cbranch_vccnz pl_5_slow
pl_5_ok:
s_add_u32 s91, s88, 0x200000
buffer_load_dwordx4 a[0:3], v46, s[60:63], s91 offen offset:0 sc1
buffer_load_dwordx4 a[4:7], v46, s[60:63], s91 offen offset:1024 sc1
buffer_load_dwordx4 a[8:11], v46, s[60:63], s91 offen offset:2048 sc1
buffer_load_dwordx4 a[12:15], v46, s[60:63], s91 offen offset:3072 sc1
s_add_u32 s91, s88, 0x201000
buffer_load_dwordx4 a[16:19], v46, s[60:63], s91 offen offset:0 sc1
buffer_load_dwordx4 a[20:23], v46, s[60:63], s91 offen offset:1024 sc1
buffer_load_dwordx4 a[24:27], v46, s[60:63], s91 offen offset:2048 sc1
buffer_load_dwordx4 a[28:31], v46, s[60:63], s91 offen offset:3072 sc1
s_add_u32 s91, s88, 0x202000
buffer_load_dwordx4 a[32:35], v46, s[60:63], s91 offen offset:0 sc1
buffer_load_dwordx4 a[36:39], v46, s[60:63], s91 offen offset:1024 sc1
buffer_load_dwordx4 a[40:43], v46, s[60:63], s91 offen offset:2048 sc1
buffer_load_dwordx4 a[44:47], v46, s[60:63], s91 offen offset:3072 sc1
s_add_u32 s91, s88, 0x203000
buffer_load_dwordx4 a[48:51], v46, s[60:63], s91 offen offset:0 sc1
buffer_load_dwordx4 a[52:55], v46, s[60:63], s91 offen offset:1024 sc1
buffer_load_dwordx4 a[56:59], v46, s[60:63], s91 offen offset:2048 sc1
buffer_load_dwordx4 a[60:63], v46, s[60:63], s91 offen offset:3072 sc1
S_O:
s_waitcnt vmcnt(15) lgkmcnt(14)
v_mfma_f32_16x16x32_bf16 v[128:131], v[112:115], a[0:3], 0
ds_read_b64_tr_b16 v[96:97], v10 offset:34816
ds_read_b64_tr_b16 v[98:99], v10 offset:51200
s_waitcnt vmcnt(14)
v_mfma_f32_16x16x32_bf16 v[144:147], v[112:115], a[4:7], 0
ds_read_b64_tr_b16 v[100:101], v11 offset:34816
s_waitcnt lgkmcnt(15)
v_mfma_f32_16x16x32_bf16 v[132:135], v[116:119], a[0:3], 0
s_add_u32 s91, s88, 0x204000
buffer_load_dwordx4 a[64:67], v46, s[60:63], s91 offen offset:0 sc1
v_mfma_f32_16x16x32_bf16 v[148:151], v[116:119], a[4:7], 0
ds_read_b64_tr_b16 v[102:103], v11 offset:51200
s_waitcnt lgkmcnt(14)
v_mfma_f32_16x16x32_bf16 v[136:139], v[120:123], a[0:3], 0
ds_read_b64_tr_b16 v[104:105], v12 offset:34816
ds_read_b64_tr_b16 v[106:107], v12 offset:51200
v_mfma_f32_16x16x32_bf16 v[152:155], v[120:123], a[4:7], 0
ds_read_b64_tr_b16 v[108:109], v13 offset:34816
s_waitcnt lgkmcnt(15)
v_mfma_f32_16x16x32_bf16 v[140:143], v[124:127], a[0:3], 0
buffer_load_dwordx4 a[68:71], v46, s[60:63], s91 offen offset:1024 sc1
v_mfma_f32_16x16x32_bf16 v[156:159], v[124:127], a[4:7], 0
ds_read_b64_tr_b16 v[110:111], v13 offset:51200
s_waitcnt vmcnt(15) lgkmcnt(6)
v_mfma_f32_16x16x32_bf16 v[128:131], v[80:83], a[8:11], v[128:131]
ds_read_b64_tr_b16 v[112:113], v10 offset:35840
ds_read_b64_tr_b16 v[114:115], v10 offset:52224
s_waitcnt vmcnt(14)
v_mfma_f32_16x16x32_bf16 v[144:147], v[80:83], a[12:15], v[144:147]
buffer_load_dwordx4 a[72:75], v46, s[60:63], s91 offen offset:2048 sc1
v_mfma_f32_16x16x32_bf16 v[132:135], v[84:87], a[8:11], v[132:135]
ds_read_b64_tr_b16 v[116:117], v11 offset:35840
ds_read_b64_tr_b16 v[118:119], v11 offset:52224
v_mfma_f32_16x16x32_bf16 v[148:151], v[84:87], a[12:15], v[148:151]
ds_read_b64_tr_b16 v[120:121], v12 offset:35840
v_mfma_f32_16x16x32_bf16 v[136:139], v[88:91], a[8:11], v[136:139]
ds_read_b64_tr_b16 v[122:123], v12 offset:52224
ds_read_b64_tr_b16 v[124:125], v13 offset:35840
v_mfma_f32_16x16x32_bf16 v[152:155], v[88:91], a[12:15], v[152:155]
buffer_load_dwordx4 a[76:79], v46, s[60:63], s91 offen offset:3072 sc1
v_mfma_f32_16x16x32_bf16 v[140:143], v[92:95], a[8:11], v[140:143]
ds_read_b64_tr_b16 v[126:127], v13 offset:52224
ds_read_b64_tr_b16 v[80:81], v10 offset:36864
v_mfma_f32_16x16x32_bf16 v[156:159], v[92:95], a[12:15], v[156:159]
ds_read_b64_tr_b16 v[82:83], v10 offset:53248
s_waitcnt vmcnt(15)
v_mfma_f32_16x16x32_bf16 v[128:131], v[96:99], a[16:19], v[128:131]
ds_read_b64_tr_b16 v[84:85], v11 offset:36864
ds_read_b64_tr_b16 v[86:87], v11 offset:53248
s_waitcnt vmcnt(14)
v_mfma_f32_16x16x32_bf16 v[144:147], v[96:99], a[20:23], v[144:147]
ds_read_b64_tr_b16 v[88:89], v12 offset:36864
s_waitcnt lgkmcnt(9)
v_mfma_f32_16x16x32_bf16 v[132:135], v[100:103], a[16:19], v[132:135]
s_add_u32 s91, s88, 0x205000
buffer_load_dwordx4 a[80:83], v46, s[60:63], s91 offen offset:0 sc1
v_mfma_f32_16x16x32_bf16 v[148:151], v[100:103], a[20:23], v[148:151]
ds_read_b64_tr_b16 v[90:91], v12 offset:53248
ds_read_b64_tr_b16 v[92:93], v13 offset:36864
v_mfma_f32_16x16x32_bf16 v[136:139], v[104:107], a[16:19], v[136:139]
ds_read_b64_tr_b16 v[94:95], v13 offset:53248
v_mfma_f32_16x16x32_bf16 v[152:155], v[104:107], a[20:23], v[152:155]
buffer_load_dwordx4 a[84:87], v46, s[60:63], s91 offen offset:1024 sc1
v_mfma_f32_16x16x32_bf16 v[140:143], v[108:111], a[16:19], v[140:143]
ds_read_b64_tr_b16 v[96:97], v10 offset:37888
ds_read_b64_tr_b16 v[98:99], v10 offset:54272
v_mfma_f32_16x16x32_bf16 v[156:159], v[108:111], a[20:23], v[156:159]
ds_read_b64_tr_b16 v[100:101], v11 offset:37888
s_waitcnt vmcnt(15)
v_mfma_f32_16x16x32_bf16 v[128:131], v[112:115], a[24:27], v[128:131]
ds_read_b64_tr_b16 v[102:103], v11 offset:54272
ds_read_b64_tr_b16 v[104:105], v12 offset:37888
s_waitcnt vmcnt(14)
v_mfma_f32_16x16x32_bf16 v[144:147], v[112:115], a[28:31], v[144:147]
buffer_load_dwordx4 a[88:91], v46, s[60:63], s91 offen offset:2048 sc1
v_mfma_f32_16x16x32_bf16 v[132:135], v[116:119], a[24:27], v[132:135]
ds_read_b64_tr_b16 v[106:107], v12 offset:54272
ds_read_b64_tr_b16 v[108:109], v13 offset:37888
v_mfma_f32_16x16x32_bf16 v[148:151], v[116:119], a[28:31], v[148:151]
ds_read_b64_tr_b16 v[110:111], v13 offset:54272
s_waitcnt lgkmcnt(8)
v_mfma_f32_16x16x32_bf16 v[136:139], v[120:123], a[24:27], v[136:139]
ds_read_b64_tr_b16 v[112:113], v10 offset:38912
ds_read_b64_tr_b16 v[114:115], v10 offset:55296
v_mfma_f32_16x16x32_bf16 v[152:155], v[120:123], a[28:31], v[152:155]
buffer_load_dwordx4 a[92:95], v46, s[60:63], s91 offen offset:3072 sc1
v_mfma_f32_16x16x32_bf16 v[140:143], v[124:127], a[24:27], v[140:143]
ds_read_b64_tr_b16 v[116:117], v11 offset:38912
ds_read_b64_tr_b16 v[118:119], v11 offset:55296
v_mfma_f32_16x16x32_bf16 v[156:159], v[124:127], a[28:31], v[156:159]
ds_read_b64_tr_b16 v[120:121], v12 offset:38912
s_waitcnt vmcnt(15)
v_mfma_f32_16x16x32_bf16 v[128:131], v[80:83], a[32:35], v[128:131]
ds_read_b64_tr_b16 v[122:123], v12 offset:55296
ds_read_b64_tr_b16 v[124:125], v13 offset:38912
s_waitcnt vmcnt(14)
v_mfma_f32_16x16x32_bf16 v[144:147], v[80:83], a[36:39], v[144:147]
s_add_u32 s91, s88, 0x206000
buffer_load_dwordx4 a[96:99], v46, s[60:63], s91 offen offset:0 sc1
v_mfma_f32_16x16x32_bf16 v[132:135], v[84:87], a[32:35], v[132:135]
ds_read_b64_tr_b16 v[126:127], v13 offset:55296
ds_read_b64_tr_b16 v[80:81], v10 offset:39936
v_mfma_f32_16x16x32_bf16 v[148:151], v[84:87], a[36:39], v[148:151]
ds_read_b64_tr_b16 v[82:83], v10 offset:56320
v_mfma_f32_16x16x32_bf16 v[136:139], v[88:91], a[32:35], v[136:139]
ds_read_b64_tr_b16 v[84:85], v11 offset:39936
v_mfma_f32_16x16x32_bf16 v[152:155], v[88:91], a[36:39], v[152:155]
buffer_load_dwordx4 a[100:103], v46, s[60:63], s91 offen offset:1024 sc1
v_mfma_f32_16x16x32_bf16 v[140:143], v[92:95], a[32:35], v[140:143]
ds_read_b64_tr_b16 v[86:87], v11 offset:56320
ds_read_b64_tr_b16 v[88:89], v12 offset:39936
v_mfma_f32_16x16x32_bf16 v[156:159], v[92:95], a[36:39], v[156:159]
ds_read_b64_tr_b16 v[90:91], v12 offset:56320
s_waitcnt vmcnt(15) lgkmcnt(7)
v_mfma_f32_16x16x32_bf16 v[128:131], v[96:99], a[40:43], v[128:131]
ds_read_b64_tr_b16 v[92:93], v13 offset:39936
s_waitcnt vmcnt(14)
v_mfma_f32_16x16x32_bf16 v[144:147], v[96:99], a[44:47], v[144:147]
buffer_load_dwordx4 a[104:107], v46, s[60:63], s91 offen offset:2048 sc1
v_mfma_f32_16x16x32_bf16 v[132:135], v[100:103], a[40:43], v[132:135]
ds_read_b64_tr_b16 v[94:95], v13 offset:56320
v_mfma_f32_16x16x32_bf16 v[148:151], v[100:103], a[44:47], v[148:151]
v_mfma_f32_16x16x32_bf16 v[136:139], v[104:107], a[40:43], v[136:139]
v_mfma_f32_16x16x32_bf16 v[152:155], v[104:107], a[44:47], v[152:155]
buffer_load_dwordx4 a[108:111], v46, s[60:63], s91 offen offset:3072 sc1
v_mfma_f32_16x16x32_bf16 v[140:143], v[108:111], a[40:43], v[140:143]
v_mfma_f32_16x16x32_bf16 v[156:159], v[108:111], a[44:47], v[156:159]
s_waitcnt lgkmcnt(0)
s_barrier
s_waitcnt vmcnt(15)
v_mfma_f32_16x16x32_bf16 v[128:131], v[112:115], a[48:51], v[128:131]
ds_read_b64_tr_b16 v[96:97], v14 offset:0
ds_read_b64_tr_b16 v[98:99], v14 offset:16384
s_waitcnt vmcnt(14)
v_mfma_f32_16x16x32_bf16 v[144:147], v[112:115], a[52:55], v[144:147]
s_add_u32 s91, s88, 0x207000
buffer_load_dwordx4 a[112:115], v46, s[60:63], s91 offen offset:0 sc1
v_mfma_f32_16x16x32_bf16 v[132:135], v[116:119], a[48:51], v[132:135]
ds_read_b64_tr_b16 v[100:101], v15 offset:0
ds_read_b64_tr_b16 v[102:103], v15 offset:16384
v_mfma_f32_16x16x32_bf16 v[148:151], v[116:119], a[52:55], v[148:151]
ds_read_b64_tr_b16 v[104:105], v16 offset:0
v_mfma_f32_16x16x32_bf16 v[136:139], v[120:123], a[48:51], v[136:139]
ds_read_b64_tr_b16 v[106:107], v16 offset:16384
ds_read_b64_tr_b16 v[108:109], v17 offset:0
v_mfma_f32_16x16x32_bf16 v[152:155], v[120:123], a[52:55], v[152:155]
buffer_load_dwordx4 a[116:119], v46, s[60:63], s91 offen offset:1024 sc1
v_mfma_f32_16x16x32_bf16 v[140:143], v[124:127], a[48:51], v[140:143]
ds_read_b64_tr_b16 v[110:111], v17 offset:16384
ds_read_b64_tr_b16 v[112:113], v14 offset:1024
v_mfma_f32_16x16x32_bf16 v[156:159], v[124:127], a[52:55], v[156:159]
ds_read_b64_tr_b16 v[114:115], v14 offset:17408
s_waitcnt vmcnt(15)
v_mfma_f32_16x16x32_bf16 v[128:131], v[80:83], a[56:59], v[128:131]
ds_read_b64_tr_b16 v[116:117], v15 offset:1024
ds_read_b64_tr_b16 v[118:119], v15 offset:17408
s_waitcnt vmcnt(14)
v_mfma_f32_16x16x32_bf16 v[144:147], v[80:83], a[60:63], v[144:147]
buffer_load_dwordx4 a[120:123], v46, s[60:63], s91 offen offset:2048 sc1
v_mfma_f32_16x16x32_bf16 v[132:135], v[84:87], a[56:59], v[132:135]
ds_read_b64_tr_b16 v[120:121], v16 offset:1024
ds_read_b64_tr_b16 v[122:123], v16 offset:17408
v_mfma_f32_16x16x32_bf16 v[148:151], v[84:87], a[60:63], v[148:151]
ds_read_b64_tr_b16 v[124:125], v17 offset:1024
v_mfma_f32_16x16x32_bf16 v[136:139], v[88:91], a[56:59], v[136:139]
ds_read_b64_tr_b16 v[126:127], v17 offset:17408
ds_read_b64_tr_b16 v[80:81], v14 offset:2048
v_mfma_f32_16x16x32_bf16 v[152:155], v[88:91], a[60:63], v[152:155]
buffer_load_dwordx4 a[124:127], v46, s[60:63], s91 offen offset:3072 sc1
v_mfma_f32_16x16x32_bf16 v[140:143], v[92:95], a[56:59], v[140:143]
ds_read_b64_tr_b16 v[82:83], v14 offset:18432
ds_read_b64_tr_b16 v[84:85], v15 offset:2048
v_mfma_f32_16x16x32_bf16 v[156:159], v[92:95], a[60:63], v[156:159]
ds_read_b64_tr_b16 v[86:87], v15 offset:18432
s_waitcnt vmcnt(15) lgkmcnt(8)
v_mfma_f32_16x16x32_bf16 v[128:131], v[96:99], a[64:67], v[128:131]
ds_read_b64_tr_b16 v[88:89], v16 offset:2048
ds_read_b64_tr_b16 v[90:91], v16 offset:18432
s_waitcnt vmcnt(14)
v_mfma_f32_16x16x32_bf16 v[144:147], v[96:99], a[68:71], v[144:147]
s_add_u32 s91, s88, 0x208000
buffer_load_dwordx4 a[128:131], v46, s[60:63], s91 offen offset:0 sc1
v_mfma_f32_16x16x32_bf16 v[132:135], v[100:103], a[64:67], v[132:135]
ds_read_b64_tr_b16 v[92:93], v17 offset:2048
ds_read_b64_tr_b16 v[94:95], v17 offset:18432
v_mfma_f32_16x16x32_bf16 v[148:151], v[100:103], a[68:71], v[148:151]
ds_read_b64_tr_b16 v[96:97], v14 offset:3072
v_mfma_f32_16x16x32_bf16 v[136:139], v[104:107], a[64:67], v[136:139]
ds_read_b64_tr_b16 v[98:99], v14 offset:19456
ds_read_b64_tr_b16 v[100:101], v15 offset:3072
v_mfma_f32_16x16x32_bf16 v[152:155], v[104:107], a[68:71], v[152:155]
buffer_load_dwordx4 a[132:135], v46, s[60:63], s91 offen offset:1024 sc1
v_mfma_f32_16x16x32_bf16 v[140:143], v[108:111], a[64:67], v[140:143]
ds_read_b64_tr_b16 v[102:103], v15 offset:19456
ds_read_b64_tr_b16 v[104:105], v16 offset:3072
v_mfma_f32_16x16x32_bf16 v[156:159], v[108:111], a[68:71], v[156:159]
ds_read_b64_tr_b16 v[106:107], v16 offset:19456
s_waitcnt vmcnt(15)
v_mfma_f32_16x16x32_bf16 v[128:131], v[112:115], a[72:75], v[128:131]
ds_read_b64_tr_b16 v[108:109], v17 offset:3072
s_waitcnt vmcnt(14)
v_mfma_f32_16x16x32_bf16 v[144:147], v[112:115], a[76:79], v[144:147]
buffer_load_dwordx4 a[136:139], v46, s[60:63], s91 offen offset:2048 sc1
v_mfma_f32_16x16x32_bf16 v[132:135], v[116:119], a[72:75], v[132:135]
ds_read_b64_tr_b16 v[110:111], v17 offset:19456
ds_read_b64_tr_b16 v[112:113], v14 offset:4096
v_mfma_f32_16x16x32_bf16 v[148:151], v[116:119], a[76:79], v[148:151]
ds_read_b64_tr_b16 v[114:115], v14 offset:20480
s_waitcnt lgkmcnt(7)
v_mfma_f32_16x16x32_bf16 v[136:139], v[120:123], a[72:75], v[136:139]
ds_read_b64_tr_b16 v[116:117], v15 offset:4096
v_mfma_f32_16x16x32_bf16 v[152:155], v[120:123], a[76:79], v[152:155]
buffer_load_dwordx4 a[140:143], v46, s[60:63], s91 offen offset:3072 sc1
v_mfma_f32_16x16x32_bf16 v[140:143], v[124:127], a[72:75], v[140:143]
ds_read_b64_tr_b16 v[118:119], v15 offset:20480
ds_read_b64_tr_b16 v[120:121], v16 offset:4096
v_mfma_f32_16x16x32_bf16 v[156:159], v[124:127], a[76:79], v[156:159]
ds_read_b64_tr_b16 v[122:123], v16 offset:20480
s_waitcnt vmcnt(15)
v_mfma_f32_16x16x32_bf16 v[128:131], v[80:83], a[80:83], v[128:131]
ds_read_b64_tr_b16 v[124:125], v17 offset:4096
s_waitcnt vmcnt(14)
v_mfma_f32_16x16x32_bf16 v[144:147], v[80:83], a[84:87], v[144:147]
s_add_u32 s91, s88, 0x209000
buffer_load_dwordx4 a[144:147], v46, s[60:63], s91 offen offset:0 sc1
v_mfma_f32_16x16x32_bf16 v[132:135], v[84:87], a[80:83], v[132:135]
ds_read_b64_tr_b16 v[126:127], v17 offset:20480
ds_read_b64_tr_b16 v[80:81], v14 offset:5120
v_mfma_f32_16x16x32_bf16 v[148:151], v[84:87], a[84:87], v[148:151]
ds_read_b64_tr_b16 v[82:83], v14 offset:21504
v_mfma_f32_16x16x32_bf16 v[136:139], v[88:91], a[80:83], v[136:139]
ds_read_b64_tr_b16 v[84:85], v15 offset:5120
v_mfma_f32_16x16x32_bf16 v[152:155], v[88:91], a[84:87], v[152:155]
buffer_load_dwordx4 a[148:151], v46, s[60:63], s91 offen offset:1024 sc1
v_mfma_f32_16x16x32_bf16 v[140:143], v[92:95], a[80:83], v[140:143]
ds_read_b64_tr_b16 v[86:87], v15 offset:21504
ds_read_b64_tr_b16 v[88:89], v16 offset:5120
v_mfma_f32_16x16x32_bf16 v[156:159], v[92:95], a[84:87], v[156:159]
ds_read_b64_tr_b16 v[90:91], v16 offset:21504
s_waitcnt vmcnt(15)
v_mfma_f32_16x16x32_bf16 v[128:131], v[96:99], a[88:91], v[128:131]
ds_read_b64_tr_b16 v[92:93], v17 offset:5120
s_waitcnt vmcnt(14)
v_mfma_f32_16x16x32_bf16 v[144:147], v[96:99], a[92:95], v[144:147]
ds_read_b64_tr_b16 v[94:95], v17 offset:21504
s_waitcnt lgkmcnt(7)
v_mfma_f32_16x16x32_bf16 v[132:135], v[100:103], a[88:91], v[132:135]
buffer_load_dwordx4 a[152:155], v46, s[60:63], s91 offen offset:2048 sc1
v_mfma_f32_16x16x32_bf16 v[148:151], v[100:103], a[92:95], v[148:151]
ds_read_b64_tr_b16 v[96:97], v14 offset:6144
ds_read_b64_tr_b16 v[98:99], v14 offset:22528
v_mfma_f32_16x16x32_bf16 v[136:139], v[104:107], a[88:91], v[136:139]
ds_read_b64_tr_b16 v[100:101], v15 offset:6144
v_mfma_f32_16x16x32_bf16 v[152:155], v[104:107], a[92:95], v[152:155]
buffer_load_dwordx4 a[156:159], v46, s[60:63], s91 offen offset:3072 sc1
v_mfma_f32_16x16x32_bf16 v[140:143], v[108:111], a[88:91], v[140:143]
ds_read_b64_tr_b16 v[102:103], v15 offset:22528
ds_read_b64_tr_b16 v[104:105], v16 offset:6144
v_mfma_f32_16x16x32_bf16 v[156:159], v[108:111], a[92:95], v[156:159]
ds_read_b64_tr_b16 v[106:107], v16 offset:22528
s_waitcnt vmcnt(15)
v_mfma_f32_16x16x32_bf16 v[128:131], v[112:115], a[96:99], v[128:131]
ds_read_b64_tr_b16 v[108:109], v17 offset:6144
s_waitcnt vmcnt(14)
v_mfma_f32_16x16x32_bf16 v[144:147], v[112:115], a[100:103], v[144:147]
s_add_u32 s91, s88, 0x20a000
buffer_load_dwordx4 a[160:163], v46, s[60:63], s91 offen offset:0 sc1
v_mfma_f32_16x16x32_bf16 v[132:135], v[116:119], a[96:99], v[132:135]
ds_read_b64_tr_b16 v[110:111], v17 offset:22528
ds_read_b64_tr_b16 v[112:113], v14 offset:7168
v_mfma_f32_16x16x32_bf16 v[148:151], v[116:119], a[100:103], v[148:151]
ds_read_b64_tr_b16 v[114:115], v14 offset:23552
v_mfma_f32_16x16x32_bf16 v[136:139], v[120:123], a[96:99], v[136:139]
ds_read_b64_tr_b16 v[116:117], v15 offset:7168
v_mfma_f32_16x16x32_bf16 v[152:155], v[120:123], a[100:103], v[152:155]
buffer_load_dwordx4 a[164:167], v46, s[60:63], s91 offen offset:1024 sc1
v_mfma_f32_16x16x32_bf16 v[140:143], v[124:127], a[96:99], v[140:143]
ds_read_b64_tr_b16 v[118:119], v15 offset:23552
ds_read_b64_tr_b16 v[120:121], v16 offset:7168
v_mfma_f32_16x16x32_bf16 v[156:159], v[124:127], a[100:103], v[156:159]
ds_read_b64_tr_b16 v[122:123], v16 offset:23552
s_waitcnt vmcnt(15) lgkmcnt(7)
v_mfma_f32_16x16x32_bf16 v[128:131], v[80:83], a[104:107], v[128:131]
ds_read_b64_tr_b16 v[124:125], v17 offset:7168
s_waitcnt vmcnt(14)
v_mfma_f32_16x16x32_bf16 v[144:147], v[80:83], a[108:111], v[144:147]
buffer_load_dwordx4 a[168:171], v46, s[60:63], s91 offen offset:2048 sc1
v_mfma_f32_16x16x32_bf16 v[132:135], v[84:87], a[104:107], v[132:135]
ds_read_b64_tr_b16 v[126:127], v17 offset:23552
v_mfma_f32_16x16x32_bf16 v[148:151], v[84:87], a[108:111], v[148:151]
v_mfma_f32_16x16x32_bf16 v[136:139], v[88:91], a[104:107], v[136:139]
v_mfma_f32_16x16x32_bf16 v[152:155], v[88:91], a[108:111], v[152:155]
buffer_load_dwordx4 a[172:175], v46, s[60:63], s91 offen offset:3072 sc1
v_mfma_f32_16x16x32_bf16 v[140:143], v[92:95], a[104:107], v[140:143]
v_mfma_f32_16x16x32_bf16 v[156:159], v[92:95], a[108:111], v[156:159]
s_waitcnt lgkmcnt(0)
s_barrier
s_waitcnt vmcnt(15)
v_mfma_f32_16x16x32_bf16 v[128:131], v[96:99], a[112:115], v[128:131]
ds_read_b64_tr_b16 v[80:81], v14 offset:32768
ds_read_b64_tr_b16 v[82:83], v14 offset:49152
s_waitcnt vmcnt(14)
v_mfma_f32_16x16x32_bf16 v[144:147], v[96:99], a[116:119], v[144:147]
s_add_u32 s91, s88, 0x20b000
buffer_load_dwordx4 a[176:179], v46, s[60:63], s91 offen offset:0 sc1
v_mfma_f32_16x16x32_bf16 v[132:135], v[100:103], a[112:115], v[132:135]
ds_read_b64_tr_b16 v[84:85], v15 offset:32768
ds_read_b64_tr_b16 v[86:87], v15 offset:49152
v_mfma_f32_16x16x32_bf16 v[148:151], v[100:103], a[116:119], v[148:151]
ds_read_b64_tr_b16 v[88:89], v16 offset:32768
v_mfma_f32_16x16x32_bf16 v[136:139], v[104:107], a[112:115], v[136:139]
ds_read_b64_tr_b16 v[90:91], v16 offset:49152
ds_read_b64_tr_b16 v[92:93], v17 offset:32768
v_mfma_f32_16x16x32_bf16 v[152:155], v[104:107], a[116:119], v[152:155]
buffer_load_dwordx4 a[180:183], v46, s[60:63], s91 offen offset:1024 sc1
v_mfma_f32_16x16x32_bf16 v[140:143], v[108:111], a[112:115], v[140:143]
ds_read_b64_tr_b16 v[94:95], v17 offset:49152
ds_read_b64_tr_b16 v[96:97], v14 offset:33792
v_mfma_f32_16x16x32_bf16 v[156:159], v[108:111], a[116:119], v[156:159]
ds_read_b64_tr_b16 v[98:99], v14 offset:50176
s_waitcnt vmcnt(15)
v_mfma_f32_16x16x32_bf16 v[128:131], v[112:115], a[120:123], v[128:131]
ds_read_b64_tr_b16 v[100:101], v15 offset:33792
ds_read_b64_tr_b16 v[102:103], v15 offset:50176
s_waitcnt vmcnt(14)
v_mfma_f32_16x16x32_bf16 v[144:147], v[112:115], a[124:127], v[144:147]
buffer_load_dwordx4 a[184:187], v46, s[60:63], s91 offen offset:2048 sc1
v_mfma_f32_16x16x32_bf16 v[132:135], v[116:119], a[120:123], v[132:135]
ds_read_b64_tr_b16 v[104:105], v16 offset:33792
ds_read_b64_tr_b16 v[106:107], v16 offset:50176
v_mfma_f32_16x16x32_bf16 v[148:151], v[116:119], a[124:127], v[148:151]
ds_read_b64_tr_b16 v[108:109], v17 offset:33792
v_mfma_f32_16x16x32_bf16 v[136:139], v[120:123], a[120:123], v[136:139]
ds_read_b64_tr_b16 v[110:111], v17 offset:50176
ds_read_b64_tr_b16 v[112:113], v14 offset:34816
v_mfma_f32_16x16x32_bf16 v[152:155], v[120:123], a[124:127], v[152:155]
buffer_load_dwordx4 a[188:191], v46, s[60:63], s91 offen offset:3072 sc1
v_mfma_f32_16x16x32_bf16 v[140:143], v[124:127], a[120:123], v[140:143]
ds_read_b64_tr_b16 v[114:115], v14 offset:51200
ds_read_b64_tr_b16 v[116:117], v15 offset:34816
v_mfma_f32_16x16x32_bf16 v[156:159], v[124:127], a[124:127], v[156:159]
ds_read_b64_tr_b16 v[118:119], v15 offset:51200
s_waitcnt vmcnt(15) lgkmcnt(8)
v_mfma_f32_16x16x32_bf16 v[128:131], v[80:83], a[128:131], v[128:131]
ds_read_b64_tr_b16 v[120:121], v16 offset:34816
ds_read_b64_tr_b16 v[122:123], v16 offset:51200
s_waitcnt vmcnt(14)
v_mfma_f32_16x16x32_bf16 v[144:147], v[80:83], a[132:135], v[144:147]
s_add_u32 s91, s88, 0x20c000
buffer_load_dwordx4 a[192:195], v46, s[60:63], s91 offen offset:0 sc1
v_mfma_f32_16x16x32_bf16 v[132:135], v[84:87], a[128:131], v[132:135]
ds_read_b64_tr_b16 v[124:125], v17 offset:34816
ds_read_b64_tr_b16 v[126:127], v17 offset:51200
v_mfma_f32_16x16x32_bf16 v[148:151], v[84:87], a[132:135], v[148:151]
ds_read_b64_tr_b16 v[80:81], v14 offset:35840
v_mfma_f32_16x16x32_bf16 v[136:139], v[88:91], a[128:131], v[136:139]
ds_read_b64_tr_b16 v[82:83], v14 offset:52224
ds_read_b64_tr_b16 v[84:85], v15 offset:35840
v_mfma_f32_16x16x32_bf16 v[152:155], v[88:91], a[132:135], v[152:155]
buffer_load_dwordx4 a[196:199], v46, s[60:63], s91 offen offset:1024 sc1
v_mfma_f32_16x16x32_bf16 v[140:143], v[92:95], a[128:131], v[140:143]
ds_read_b64_tr_b16 v[86:87], v15 offset:52224
ds_read_b64_tr_b16 v[88:89], v16 offset:35840
v_mfma_f32_16x16x32_bf16 v[156:159], v[92:95], a[132:135], v[156:159]
ds_read_b64_tr_b16 v[90:91], v16 offset:52224
s_waitcnt vmcnt(15)
v_mfma_f32_16x16x32_bf16 v[128:131], v[96:99], a[136:139], v[128:131]
ds_read_b64_tr_b16 v[92:93], v17 offset:35840
s_waitcnt vmcnt(14)
v_mfma_f32_16x16x32_bf16 v[144:147], v[96:99], a[140:143], v[144:147]
buffer_load_dwordx4 a[200:203], v46, s[60:63], s91 offen offset:2048 sc1
v_mfma_f32_16x16x32_bf16 v[132:135], v[100:103], a[136:139], v[132:135]
ds_read_b64_tr_b16 v[94:95], v17 offset:52224
ds_read_b64_tr_b16 v[96:97], v14 offset:36864
v_mfma_f32_16x16x32_bf16 v[148:151], v[100:103], a[140:143], v[148:151]
ds_read_b64_tr_b16 v[98:99], v14 offset:53248
s_waitcnt lgkmcnt(7)
v_mfma_f32_16x16x32_bf16 v[136:139], v[104:107], a[136:139], v[136:139]
ds_read_b64_tr_b16 v[100:101], v15 offset:36864
v_mfma_f32_16x16x32_bf16 v[152:155], v[104:107], a[140:143], v[152:155]
buffer_load_dwordx4 a[204:207], v46, s[60:63], s91 offen offset:3072 sc1
v_mfma_f32_16x16x32_bf16 v[140:143], v[108:111], a[136:139], v[140:143]
ds_read_b64_tr_b16 v[102:103], v15 offset:53248
ds_read_b64_tr_b16 v[104:105], v16 offset:36864
v_mfma_f32_16x16x32_bf16 v[156:159], v[108:111], a[140:143], v[156:159]
ds_read_b64_tr_b16 v[106:107], v16 offset:53248
s_waitcnt vmcnt(15)
v_mfma_f32_16x16x32_bf16 v[128:131], v[112:115], a[144:147], v[128:131]
ds_read_b64_tr_b16 v[108:109], v17 offset:36864
s_waitcnt vmcnt(14)
v_mfma_f32_16x16x32_bf16 v[144:147], v[112:115], a[148:151], v[144:147]
s_add_u32 s91, s88, 0x20d000
buffer_load_dwordx4 a[208:211], v46, s[60:63], s91 offen offset:0 sc1
v_mfma_f32_16x16x32_bf16 v[132:135], v[116:119], a[144:147], v[132:135]
ds_read_b64_tr_b16 v[110:111], v17 offset:53248
ds_read_b64_tr_b16 v[112:113], v14 offset:37888
v_mfma_f32_16x16x32_bf16 v[148:151], v[116:119], a[148:151], v[148:151]
ds_read_b64_tr_b16 v[114:115], v14 offset:54272
v_mfma_f32_16x16x32_bf16 v[136:139], v[120:123], a[144:147], v[136:139]
ds_read_b64_tr_b16 v[116:117], v15 offset:37888
v_mfma_f32_16x16x32_bf16 v[152:155], v[120:123], a[148:151], v[152:155]
buffer_load_dwordx4 a[212:215], v46, s[60:63], s91 offen offset:1024 sc1
v_mfma_f32_16x16x32_bf16 v[140:143], v[124:127], a[144:147], v[140:143]
ds_read_b64_tr_b16 v[118:119], v15 offset:54272
ds_read_b64_tr_b16 v[120:121], v16 offset:37888
v_mfma_f32_16x16x32_bf16 v[156:159], v[124:127], a[148:151], v[156:159]
ds_read_b64_tr_b16 v[122:123], v16 offset:54272
s_waitcnt vmcnt(15)
v_mfma_f32_16x16x32_bf16 v[128:131], v[80:83], a[152:155], v[128:131]
ds_read_b64_tr_b16 v[124:125], v17 offset:37888
s_waitcnt vmcnt(14)
v_mfma_f32_16x16x32_bf16 v[144:147], v[80:83], a[156:159], v[144:147]
ds_read_b64_tr_b16 v[126:127], v17 offset:54272
s_waitcnt lgkmcnt(7)
v_mfma_f32_16x16x32_bf16 v[132:135], v[84:87], a[152:155], v[132:135]
buffer_load_dwordx4 a[216:219], v46, s[60:63], s91 offen offset:2048 sc1
v_mfma_f32_16x16x32_bf16 v[148:151], v[84:87], a[156:159], v[148:151]
ds_read_b64_tr_b16 v[80:81], v14 offset:38912
ds_read_b64_tr_b16 v[82:83], v14 offset:55296
v_mfma_f32_16x16x32_bf16 v[136:139], v[88:91], a[152:155], v[136:139]
ds_read_b64_tr_b16 v[84:85], v15 offset:38912
v_mfma_f32_16x16x32_bf16 v[152:155], v[88:91], a[156:159], v[152:155]
buffer_load_dwordx4 a[220:223], v46, s[60:63], s91 offen offset:3072 sc1
v_mfma_f32_16x16x32_bf16 v[140:143], v[92:95], a[152:155], v[140:143]
ds_read_b64_tr_b16 v[86:87], v15 offset:55296
ds_read_b64_tr_b16 v[88:89], v16 offset:38912
v_mfma_f32_16x16x32_bf16 v[156:159], v[92:95], a[156:159], v[156:159]
ds_read_b64_tr_b16 v[90:91], v16 offset:55296
s_waitcnt vmcnt(15)
v_mfma_f32_16x16x32_bf16 v[128:131], v[96:99], a[160:163], v[128:131]
ds_read_b64_tr_b16 v[92:93], v17 offset:38912
s_waitcnt vmcnt(14)
v_mfma_f32_16x16x32_bf16 v[144:147], v[96:99], a[164:167], v[144:147]
s_add_u32 s91, s88, 0x20e000
buffer_load_dwordx4 a[224:227], v46, s[60:63], s91 offen offset:0 sc1
v_mfma_f32_16x16x32_bf16 v[132:135], v[100:103], a[160:163], v[132:135]
ds_read_b64_tr_b16 v[94:95], v17 offset:55296
ds_read_b64_tr_b16 v[96:97], v14 offset:39936
v_mfma_f32_16x16x32_bf16 v[148:151], v[100:103], a[164:167], v[148:151]
ds_read_b64_tr_b16 v[98:99], v14 offset:56320
v_mfma_f32_16x16x32_bf16 v[136:139], v[104:107], a[160:163], v[136:139]
ds_read_b64_tr_b16 v[100:101], v15 offset:39936
v_mfma_f32_16x16x32_bf16 v[152:155], v[104:107], a[164:167], v[152:155]
buffer_load_dwordx4 a[228:231], v46, s[60:63], s91 offen offset:1024 sc1
v_mfma_f32_16x16x32_bf16 v[140:143], v[108:111], a[160:163], v[140:143]
ds_read_b64_tr_b16 v[102:103], v15 offset:56320
ds_read_b64_tr_b16 v[104:105], v16 offset:39936
v_mfma_f32_16x16x32_bf16 v[156:159], v[108:111], a[164:167], v[156:159]
ds_read_b64_tr_b16 v[106:107], v16 offset:56320
s_waitcnt vmcnt(15) lgkmcnt(7)
v_mfma_f32_16x16x32_bf16 v[128:131], v[112:115], a[168:171], v[128:131]
ds_read_b64_tr_b16 v[108:109], v17 offset:39936
s_waitcnt vmcnt(14)
v_mfma_f32_16x16x32_bf16 v[144:147], v[112:115], a[172:175], v[144:147]
buffer_load_dwordx4 a[232:235], v46, s[60:63], s91 offen offset:2048 sc1
v_mfma_f32_16x16x32_bf16 v[132:135], v[116:119], a[168:171], v[132:135]
ds_read_b64_tr_b16 v[110:111], v17 offset:56320
v_mfma_f32_16x16x32_bf16 v[148:151], v[116:119], a[172:175], v[148:151]
v_mfma_f32_16x16x32_bf16 v[136:139], v[120:123], a[168:171], v[136:139]
v_mfma_f32_16x16x32_bf16 v[152:155], v[120:123], a[172:175], v[152:155]
buffer_load_dwordx4 a[236:239], v46, s[60:63], s91 offen offset:3072 sc1
v_mfma_f32_16x16x32_bf16 v[140:143], v[124:127], a[168:171], v[140:143]
v_mfma_f32_16x16x32_bf16 v[156:159], v[124:127], a[172:175], v[156:159]
s_waitcnt lgkmcnt(0)
s_barrier
s_waitcnt vmcnt(15)
v_mfma_f32_16x16x32_bf16 v[128:131], v[80:83], a[176:179], v[128:131]
ds_read_b64_tr_b16 v[112:113], v10 offset:0
ds_read_b64_tr_b16 v[114:115], v10 offset:16384
s_waitcnt vmcnt(14)
v_mfma_f32_16x16x32_bf16 v[144:147], v[80:83], a[180:183], v[144:147]
s_add_u32 s91, s88, 0x20f000
buffer_load_dwordx4 a[240:243], v46, s[60:63], s91 offen offset:0 sc1
v_mfma_f32_16x16x32_bf16 v[132:135], v[84:87], a[176:179], v[132:135]
ds_read_b64_tr_b16 v[116:117], v11 offset:0
ds_read_b64_tr_b16 v[118:119], v11 offset:16384
v_mfma_f32_16x16x32_bf16 v[148:151], v[84:87], a[180:183], v[148:151]
ds_read_b64_tr_b16 v[120:121], v12 offset:0
v_mfma_f32_16x16x32_bf16 v[136:139], v[88:91], a[176:179], v[136:139]
ds_read_b64_tr_b16 v[122:123], v12 offset:16384
ds_read_b64_tr_b16 v[124:125], v13 offset:0
v_mfma_f32_16x16x32_bf16 v[152:155], v[88:91], a[180:183], v[152:155]
buffer_load_dwordx4 a[244:247], v46, s[60:63], s91 offen offset:1024 sc1
v_mfma_f32_16x16x32_bf16 v[140:143], v[92:95], a[176:179], v[140:143]
ds_read_b64_tr_b16 v[126:127], v13 offset:16384
ds_read_b64_tr_b16 v[80:81], v10 offset:1024
v_mfma_f32_16x16x32_bf16 v[156:159], v[92:95], a[180:183], v[156:159]
ds_read_b64_tr_b16 v[82:83], v10 offset:17408
s_waitcnt vmcnt(15)
v_mfma_f32_16x16x32_bf16 v[128:131], v[96:99], a[184:187], v[128:131]
ds_read_b64_tr_b16 v[84:85], v11 offset:1024
ds_read_b64_tr_b16 v[86:87], v11 offset:17408
s_waitcnt vmcnt(14)
v_mfma_f32_16x16x32_bf16 v[144:147], v[96:99], a[188:191], v[144:147]
buffer_load_dwordx4 a[248:251], v46, s[60:63], s91 offen offset:2048 sc1
v_mfma_f32_16x16x32_bf16 v[132:135], v[100:103], a[184:187], v[132:135]
ds_read_b64_tr_b16 v[88:89], v12 offset:1024
ds_read_b64_tr_b16 v[90:91], v12 offset:17408
v_mfma_f32_16x16x32_bf16 v[148:151], v[100:103], a[188:191], v[148:151]
ds_read_b64_tr_b16 v[92:93], v13 offset:1024
v_mfma_f32_16x16x32_bf16 v[136:139], v[104:107], a[184:187], v[136:139]
ds_read_b64_tr_b16 v[94:95], v13 offset:17408
ds_read_b64_tr_b16 v[96:97], v10 offset:2048
v_mfma_f32_16x16x32_bf16 v[152:155], v[104:107], a[188:191], v[152:155]
buffer_load_dwordx4 a[252:255], v46, s[60:63], s91 offen offset:3072 sc1
v_mfma_f32_16x16x32_bf16 v[140:143], v[108:111], a[184:187], v[140:143]
s_add_u32 s70, s0, T_wo - K_pc + 0
s_addc_u32 s71, s1, 0
global_load_dword v57, v9, s[70:71]
v_mfma_f32_16x16x32_bf16 v[156:159], v[108:111], a[188:191], v[156:159]
ds_read_b64_tr_b16 v[98:99], v10 offset:18432
s_waitcnt vmcnt(16) lgkmcnt(6)
v_mfma_f32_16x16x32_bf16 v[128:131], v[112:115], a[192:195], v[128:131]
s_add_u32 s70, s0, T_wo - K_pc + 8192
s_addc_u32 s71, s1, 0
global_load_dword v57, v9, s[70:71]
s_waitcnt vmcnt(16)
v_mfma_f32_16x16x32_bf16 v[144:147], v[112:115], a[196:199], v[144:147]
ds_read_b64_tr_b16 v[100:101], v11 offset:2048
ds_read_b64_tr_b16 v[102:103], v11 offset:18432
v_mfma_f32_16x16x32_bf16 v[132:135], v[116:119], a[192:195], v[132:135]
ds_read_b64_tr_b16 v[104:105], v12 offset:2048
v_mfma_f32_16x16x32_bf16 v[148:151], v[116:119], a[196:199], v[148:151]
ds_read_b64_tr_b16 v[106:107], v12 offset:18432
ds_read_b64_tr_b16 v[108:109], v13 offset:2048
v_mfma_f32_16x16x32_bf16 v[136:139], v[120:123], a[192:195], v[136:139]
ds_read_b64_tr_b16 v[110:111], v13 offset:18432
v_mfma_f32_16x16x32_bf16 v[152:155], v[120:123], a[196:199], v[152:155]
ds_read_b64_tr_b16 v[112:113], v10 offset:3072
ds_read_b64_tr_b16 v[114:115], v10 offset:19456
v_mfma_f32_16x16x32_bf16 v[140:143], v[124:127], a[192:195], v[140:143]
ds_read_b64_tr_b16 v[116:117], v11 offset:3072
v_mfma_f32_16x16x32_bf16 v[156:159], v[124:127], a[196:199], v[156:159]
ds_read_b64_tr_b16 v[118:119], v11 offset:19456
s_waitcnt vmcnt(15)
v_mfma_f32_16x16x32_bf16 v[128:131], v[80:83], a[200:203], v[128:131]
ds_read_b64_tr_b16 v[120:121], v12 offset:3072
ds_read_b64_tr_b16 v[122:123], v12 offset:19456
s_waitcnt vmcnt(14)
v_mfma_f32_16x16x32_bf16 v[144:147], v[80:83], a[204:207], v[144:147]
ds_read_b64_tr_b16 v[124:125], v13 offset:3072
v_mfma_f32_16x16x32_bf16 v[132:135], v[84:87], a[200:203], v[132:135]
ds_read_b64_tr_b16 v[126:127], v13 offset:19456
ds_read_b64_tr_b16 v[80:81], v10 offset:4096
v_mfma_f32_16x16x32_bf16 v[148:151], v[84:87], a[204:207], v[148:151]
ds_read_b64_tr_b16 v[82:83], v10 offset:20480
s_waitcnt lgkmcnt(10)
v_mfma_f32_16x16x32_bf16 v[136:139], v[88:91], a[200:203], v[136:139]
ds_read_b64_tr_b16 v[84:85], v11 offset:4096
v_mfma_f32_16x16x32_bf16 v[152:155], v[88:91], a[204:207], v[152:155]
ds_read_b64_tr_b16 v[86:87], v11 offset:20480
v_mfma_f32_16x16x32_bf16 v[140:143], v[92:95], a[200:203], v[140:143]
ds_read_b64_tr_b16 v[88:89], v12 offset:4096
v_mfma_f32_16x16x32_bf16 v[156:159], v[92:95], a[204:207], v[156:159]
ds_read_b64_tr_b16 v[90:91], v12 offset:20480
s_waitcnt vmcnt(13)
v_mfma_f32_16x16x32_bf16 v[128:131], v[96:99], a[208:211], v[128:131]
ds_read_b64_tr_b16 v[92:93], v13 offset:4096
s_waitcnt vmcnt(12)
v_mfma_f32_16x16x32_bf16 v[144:147], v[96:99], a[212:215], v[144:147]
ds_read_b64_tr_b16 v[94:95], v13 offset:20480
v_mfma_f32_16x16x32_bf16 v[132:135], v[100:103], a[208:211], v[132:135]
ds_read_b64_tr_b16 v[96:97], v10 offset:5120
v_mfma_f32_16x16x32_bf16 v[148:151], v[100:103], a[212:215], v[148:151]
ds_read_b64_tr_b16 v[98:99], v10 offset:21504
v_mfma_f32_16x16x32_bf16 v[136:139], v[104:107], a[208:211], v[136:139]
ds_read_b64_tr_b16 v[100:101], v11 offset:5120
v_mfma_f32_16x16x32_bf16 v[152:155], v[104:107], a[212:215], v[152:155]
ds_read_b64_tr_b16 v[102:103], v11 offset:21504
v_mfma_f32_16x16x32_bf16 v[140:143], v[108:111], a[208:211], v[140:143]
ds_read_b64_tr_b16 v[104:105], v12 offset:5120
v_mfma_f32_16x16x32_bf16 v[156:159], v[108:111], a[212:215], v[156:159]
ds_read_b64_tr_b16 v[106:107], v12 offset:21504
s_waitcnt vmcnt(11) lgkmcnt(7)
v_mfma_f32_16x16x32_bf16 v[128:131], v[112:115], a[216:219], v[128:131]
ds_read_b64_tr_b16 v[108:109], v13 offset:5120
s_waitcnt vmcnt(10)
v_mfma_f32_16x16x32_bf16 v[144:147], v[112:115], a[220:223], v[144:147]
ds_read_b64_tr_b16 v[110:111], v13 offset:21504
v_mfma_f32_16x16x32_bf16 v[132:135], v[116:119], a[216:219], v[132:135]
ds_read_b64_tr_b16 v[112:113], v10 offset:6144
v_mfma_f32_16x16x32_bf16 v[148:151], v[116:119], a[220:223], v[148:151]
ds_read_b64_tr_b16 v[114:115], v10 offset:22528
v_mfma_f32_16x16x32_bf16 v[136:139], v[120:123], a[216:219], v[136:139]
ds_read_b64_tr_b16 v[116:117], v11 offset:6144
v_mfma_f32_16x16x32_bf16 v[152:155], v[120:123], a[220:223], v[152:155]
ds_read_b64_tr_b16 v[118:119], v11 offset:22528
v_mfma_f32_16x16x32_bf16 v[140:143], v[124:127], a[216:219], v[140:143]
ds_read_b64_tr_b16 v[120:121], v12 offset:6144
v_mfma_f32_16x16x32_bf16 v[156:159], v[124:127], a[220:223], v[156:159]
ds_read_b64_tr_b16 v[122:123], v12 offset:22528
s_waitcnt vmcnt(9)
v_mfma_f32_16x16x32_bf16 v[128:131], v[80:83], a[224:227], v[128:131]
ds_read_b64_tr_b16 v[124:125], v13 offset:6144
s_waitcnt vmcnt(8)
v_mfma_f32_16x16x32_bf16 v[144:147], v[80:83], a[228:231], v[144:147]
ds_read_b64_tr_b16 v[126:127], v13 offset:22528
v_mfma_f32_16x16x32_bf16 v[132:135], v[84:87], a[224:227], v[132:135]
ds_read_b64_tr_b16 v[80:81], v10 offset:7168
v_mfma_f32_16x16x32_bf16 v[148:151], v[84:87], a[228:231], v[148:151]
ds_read_b64_tr_b16 v[82:83], v10 offset:23552
v_mfma_f32_16x16x32_bf16 v[136:139], v[88:91], a[224:227], v[136:139]
ds_read_b64_tr_b16 v[84:85], v11 offset:7168
v_mfma_f32_16x16x32_bf16 v[152:155], v[88:91], a[228:231], v[152:155]
ds_read_b64_tr_b16 v[86:87], v11 offset:23552
s_waitcnt lgkmcnt(7)
v_mfma_f32_16x16x32_bf16 v[140:143], v[92:95], a[224:227], v[140:143]
ds_read_b64_tr_b16 v[88:89], v12 offset:7168
v_mfma_f32_16x16x32_bf16 v[156:159], v[92:95], a[228:231], v[156:159]
ds_read_b64_tr_b16 v[90:91], v12 offset:23552
s_waitcnt vmcnt(7)
v_mfma_f32_16x16x32_bf16 v[128:131], v[96:99], a[232:235], v[128:131]
ds_read_b64_tr_b16 v[92:93], v13 offset:7168
s_waitcnt vmcnt(6)
v_mfma_f32_16x16x32_bf16 v[144:147], v[96:99], a[236:239], v[144:147]
ds_read_b64_tr_b16 v[94:95], v13 offset:23552
v_mfma_f32_16x16x32_bf16 v[132:135], v[100:103], a[232:235], v[132:135]
v_mfma_f32_16x16x32_bf16 v[148:151], v[100:103], a[236:239], v[148:151]
v_mfma_f32_16x16x32_bf16 v[136:139], v[104:107], a[232:235], v[136:139]
v_mfma_f32_16x16x32_bf16 v[152:155], v[104:107], a[236:239], v[152:155]
v_mfma_f32_16x16x32_bf16 v[140:143], v[108:111], a[232:235], v[140:143]
v_mfma_f32_16x16x32_bf16 v[156:159], v[108:111], a[236:239], v[156:159]
s_waitcnt vmcnt(5)
v_mfma_f32_16x16x32_bf16 v[128:131], v[112:115], a[240:243], v[128:131]
s_waitcnt vmcnt(4)
v_mfma_f32_16x16x32_bf16 v[144:147], v[112:115], a[244:247], v[144:147]
v_mfma_f32_16x16x32_bf16 v[132:135], v[116:119], a[240:243], v[132:135]
v_mfma_f32_16x16x32_bf16 v[148:151], v[116:119], a[244:247], v[148:151]
s_waitcnt lgkmcnt(0)
v_mfma_f32_16x16x32_bf16 v[136:139], v[120:123], a[240:243], v[136:139]
v_mfma_f32_16x16x32_bf16 v[152:155], v[120:123], a[244:247], v[152:155]
v_mfma_f32_16x16x32_bf16 v[140:143], v[124:127], a[240:243], v[140:143]
v_mfma_f32_16x16x32_bf16 v[156:159], v[124:127], a[244:247], v[156:159]
s_waitcnt vmcnt(3)
v_mfma_f32_16x16x32_bf16 v[128:131], v[80:83], a[248:251], v[128:131]
s_waitcnt vmcnt(2)
v_mfma_f32_16x16x32_bf16 v[144:147], v[80:83], a[252:255], v[144:147]
v_mfma_f32_16x16x32_bf16 v[132:135], v[84:87], a[248:251], v[132:135]
v_mfma_f32_16x16x32_bf16 v[148:151], v[84:87], a[252:255], v[148:151]
v_mfma_f32_16x16x32_bf16 v[136:139], v[88:91], a[248:251], v[136:139]
v_mfma_f32_16x16x32_bf16 v[152:155], v[88:91], a[252:255], v[152:155]
v_mfma_f32_16x16x32_bf16 v[140:143], v[92:95], a[248:251], v[140:143]
v_mfma_f32_16x16x32_bf16 v[156:159], v[92:95], a[252:255], v[156:159]
T_wo:
s_lshl_b32 s78, s75, 12
s_add_u32 s78, s78, s88
s_add_u32 s91, s78, 0x600000
v_pk_fma_f32 v[160:161], v[128:129], v[192:193], v[160:161]
v_pk_fma_f32 v[162:163], v[130:131], v[194:195], v[162:163]
v_pk_fma_f32 v[164:165], v[132:133], v[196:197], v[164:165]
v_pk_fma_f32 v[166:167], v[134:135], v[198:199], v[166:167]
v_cvt_pk_bf16_f32 v224, v160, v161
v_cvt_pk_bf16_f32 v225, v162, v163
v_cvt_pk_bf16_f32 v226, v164, v165
v_cvt_pk_bf16_f32 v227, v166, v167
buffer_store_dwordx4 v[224:227], v46, s[60:63], s91 offen offset:0 sc1
v_pk_fma_f32 v[168:169], v[136:137], v[200:201], v[168:169]
v_pk_fma_f32 v[170:171], v[138:139], v[202:203], v[170:171]
v_pk_fma_f32 v[172:173], v[140:141], v[204:205], v[172:173]
v_pk_fma_f32 v[174:175], v[142:143], v[206:207], v[174:175]
v_cvt_pk_bf16_f32 v228, v168, v169
v_cvt_pk_bf16_f32 v229, v170, v171
v_cvt_pk_bf16_f32 v230, v172, v173
v_cvt_pk_bf16_f32 v231, v174, v175
buffer_store_dwordx4 v[228:231], v46, s[60:63], s91 offen offset:2048 sc1
v_pk_fma_f32 v[176:177], v[144:145], v[192:193], v[176:177]
v_pk_fma_f32 v[178:179], v[146:147], v[194:195], v[178:179]
v_pk_fma_f32 v[180:181], v[148:149], v[196:197], v[180:181]
v_pk_fma_f32 v[182:183], v[150:151], v[198:199], v[182:183]
v_cvt_pk_bf16_f32 v232, v176, v177
v_cvt_pk_bf16_f32 v233, v178, v179
v_cvt_pk_bf16_f32 v234, v180, v181
v_cvt_pk_bf16_f32 v235, v182, v183
buffer_store_dwordx4 v[232:235], v46, s[60:63], s91 offen offset:1024 sc1
v_pk_fma_f32 v[184:185], v[152:153], v[200:201], v[184:185]
v_pk_fma_f32 v[186:187], v[154:155], v[202:203], v[186:187]
v_pk_fma_f32 v[188:189], v[156:157], v[204:205], v[188:189]
v_pk_fma_f32 v[190:191], v[158:159], v[206:207], v[190:191]
v_cvt_pk_bf16_f32 v236, v184, v185
v_cvt_pk_bf16_f32 v237, v186, v187
v_cvt_pk_bf16_f32 v238, v188, v189
v_cvt_pk_bf16_f32 v239, v190, v191
buffer_store_dwordx4 v[236:239], v46, s[60:63], s91 offen offset:3072 sc1
s_add_u32 s79, s72, 4
s_lshl_b32 s78, s73, 4
s_add_u32 s78, s78, s79
s_lshl_b32 s78, s78, 10
s_add_u32 s78, s78, 33408
v_mov_b32 v49, s96
v_writelane_b32 v49, s78, 0
v_mov_b32 v50, 0
v_writelane_b32 v50, 16, 0
s_waitcnt vmcnt(0)
buffer_atomic_add v52, v49, s[60:63], 0 offen sc1
s_add_u32 m0, s76, 32768
s_add_u32 s77, s84, 0x0
buffer_load_dwordx4 v30, s[40:43], s77 offen offset:0 lds
buffer_load_dwordx4 v31, s[40:43], s77 offen offset:1024 lds
buffer_load_dwordx4 v32, s[40:43], s77 offen offset:2048 lds
buffer_load_dwordx4 v33, s[40:43], s77 offen offset:3072 lds
s_add_u32 m0, s76, 36864
s_add_u32 s77, s84, 0xe0000
buffer_load_dwordx4 v30, s[40:43], s77 offen offset:0 lds
buffer_load_dwordx4 v31, s[40:43], s77 offen offset:1024 lds
buffer_load_dwordx4 v32, s[40:43], s77 offen offset:2048 lds
buffer_load_dwordx4 v33, s[40:43], s77 offen offset:3072 lds
s_add_u32 m0, s76, 65536
s_add_u32 s77, s84, 0x1c0000
buffer_load_dwordx4 v30, s[40:43], s77 offen offset:0 lds
buffer_load_dwordx4 v31, s[40:43], s77 offen offset:1024 lds
buffer_load_dwordx4 v32, s[40:43], s77 offen offset:2048 lds
buffer_load_dwordx4 v33, s[40:43], s77 offen offset:3072 lds
s_add_u32 m0, s76, 69632
s_add_u32 s77, s84, 0x2a0000
buffer_load_dwordx4 v30, s[40:43], s77 offen offset:0 lds
buffer_load_dwordx4 v31, s[40:43], s77 offen offset:1024 lds
buffer_load_dwordx4 v32, s[40:43], s77 offen offset:2048 lds
buffer_load_dwordx4 v33, s[40:43], s77 offen offset:3072 lds
v_mov_b32 v51, 0
buffer_atomic_add v51, v49, s[60:63], 0 offen sc0 sc1
v_add_u32 v38, 0, v26
v_add_u32 v42, 393216, v26
v_add_u32 v39, 523264, v26
v_add_u32 v43, 457728, v26
v_add_u32 v40, 915456, v26
v_add_u32 v44, 1308672, v26
v_add_u32 v41, 1438720, v26
v_add_u32 v45, 1373184, v26
s_lshr_b32 s12, s74, 2
s_and_b32 s13, s74, 3
s_mul_i32 s78, s74, 14336
s_add_u32 s78, s78, s89
s_add_u32 s78, s78, 0xa00000
s_bitcmp1_b32 s74, 0
s_cselect_b32 s79, 2048, 0
s_cselect_b32 s80, 0, 12288
s_add_u32 s4, s78, s79
s_add_u32 s5, s78, s80
s_mul_i32 s6, s12, 57344
s_add_u32 s6, s6, s89
s_add_u32 s6, s6, 0xa00000
s_mul_i32 s14, s12, 1835008
s_lshl_b32 s78, s13, 9
s_add_u32 s14, s14, s78
s_lshr_b32 s15, s88, 12
s_add_u32 s79, s12, 1
s_and_b32 s79, s79, 3
s_lshl_b32 s78, s79, 7
s_add_u32 s97, s14, s78
s_lshl_b32 s79, s79, 2
s_add_u32 s16, s79, s13
s_add_u32 s78, s15, s16
s_mul_i32 s78, s78, 12288
s_add_u32 s8, s78, 0x1900000
s_add_u32 s79, s12, 2
s_and_b32 s79, s79, 3
s_lshl_b32 s78, s79, 7
s_add_u32 s98, s14, s78
s_lshl_b32 s79, s79, 2
s_add_u32 s17, s79, s13
s_add_u32 s78, s15, s17
s_mul_i32 s78, s78, 12288
s_add_u32 s9, s78, 0x1901000
s_add_u32 s79, s12, 3
s_and_b32 s79, s79, 3
s_lshl_b32 s78, s79, 7
s_add_u32 s99, s14, s78
s_lshl_b32 s79, s79, 2
s_add_u32 s18, s79, s13
s_add_u32 s78, s15, s18
s_mul_i32 s78, s78, 12288
s_add_u32 s10, s78, 0x1902000
s_add_u32 s79, s12, 4
s_and_b32 s79, s79, 3
s_lshl_b32 s78, s79, 7
s_add_u32 s100, s14, s78
s_lshl_b32 s79, s79, 2
s_add_u32 s19, s79, s13
s_add_u32 s78, s15, s19
s_mul_i32 s78, s78, 12288
s_add_u32 s11, s78, 0x1900000
v_mov_b32 v200, 0x3f803f80
v_mov_b32 v201, 0x3f803f80
v_mov_b32 v202, 0x3f803f80
v_mov_b32 v203, 0x3f803f80
s_waitcnt vmcnt(0)
v_cmp_lt_u32 vcc, v51, v50
s_cbranch_vccnz pl_6_slow
pl_6_ok:
s_add_u32 s91, s88, 0x600000
buffer_load_dwordx4 a[0:3], v46, s[60:63], s91 offen offset:0 sc1
buffer_load_dwordx4 a[4:7], v46, s[60:63], s91 offen offset:1024 sc1
buffer_load_dwordx4 a[8:11], v46, s[60:63], s91 offen offset:2048 sc1
buffer_load_dwordx4 a[12:15], v46, s[60:63], s91 offen offset:3072 sc1
s_add_u32 s91, s88, 0x601000
buffer_load_dwordx4 a[16:19], v46, s[60:63], s91 offen offset:0 sc1
buffer_load_dwordx4 a[20:23], v46, s[60:63], s91 offen offset:1024 sc1
buffer_load_dwordx4 a[24:27], v46, s[60:63], s91 offen offset:2048 sc1
buffer_load_dwordx4 a[28:31], v46, s[60:63], s91 offen offset:3072 sc1
s_add_u32 s91, s88, 0x602000
buffer_load_dwordx4 a[32:35], v46, s[60:63], s91 offen offset:0 sc1
buffer_load_dwordx4 a[36:39], v46, s[60:63], s91 offen offset:1024 sc1
buffer_load_dwordx4 a[40:43], v46, s[60:63], s91 offen offset:2048 sc1
buffer_load_dwordx4 a[44:47], v46, s[60:63], s91 offen offset:3072 sc1
s_add_u32 s91, s88, 0x603000
buffer_load_dwordx4 a[48:51], v46, s[60:63], s91 offen offset:0 sc1
buffer_load_dwordx4 a[52:55], v46, s[60:63], s91 offen offset:1024 sc1
buffer_load_dwordx4 a[56:59], v46, s[60:63], s91 offen offset:2048 sc1
buffer_load_dwordx4 a[60:63], v46, s[60:63], s91 offen offset:3072 sc1
s_add_u32 s91, s88, 0x604000
buffer_load_dwordx4 a[64:67], v46, s[60:63], s91 offen offset:0 sc1
s_waitcnt vmcnt(16)
v_mfma_f32_16x16x32_bf16 v[204:207], v[200:203], a[0:3], 0
v_mfma_f32_16x16x32_bf16 v[212:215], a[0:3], a[0:3], 0
buffer_load_dwordx4 a[68:71], v46, s[60:63], s91 offen offset:1024 sc1
s_waitcnt vmcnt(16)
v_mfma_f32_16x16x32_bf16 v[208:211], v[200:203], a[4:7], 0
v_mfma_f32_16x16x32_bf16 v[216:219], a[4:7], a[4:7], 0
buffer_load_dwordx4 a[72:75], v46, s[60:63], s91 offen offset:2048 sc1
s_waitcnt vmcnt(16)
v_mfma_f32_16x16x32_bf16 v[204:207], v[200:203], a[8:11], v[204:207]
v_mfma_f32_16x16x32_bf16 v[212:215], a[8:11], a[8:11], v[212:215]
buffer_load_dwordx4 a[76:79], v46, s[60:63], s91 offen offset:3072 sc1
s_waitcnt vmcnt(16)
v_mfma_f32_16x16x32_bf16 v[208:211], v[200:203], a[12:15], v[208:211]
v_mfma_f32_16x16x32_bf16 v[216:219], a[12:15], a[12:15], v[216:219]
s_add_u32 s91, s88, 0x605000
buffer_load_dwordx4 a[80:83], v46, s[60:63], s91 offen offset:0 sc1
s_waitcnt vmcnt(16)
v_mfma_f32_16x16x32_bf16 v[204:207], v[200:203], a[16:19], v[204:207]
v_mfma_f32_16x16x32_bf16 v[212:215], a[16:19], a[16:19], v[212:215]
buffer_load_dwordx4 a[84:87], v46, s[60:63], s91 offen offset:1024 sc1
s_waitcnt vmcnt(16)
v_mfma_f32_16x16x32_bf16 v[208:211], v[200:203], a[20:23], v[208:211]
v_mfma_f32_16x16x32_bf16 v[216:219], a[20:23], a[20:23], v[216:219]
buffer_load_dwordx4 a[88:91], v46, s[60:63], s91 offen offset:2048 sc1
s_waitcnt vmcnt(16)
v_mfma_f32_16x16x32_bf16 v[204:207], v[200:203], a[24:27], v[204:207]
v_mfma_f32_16x16x32_bf16 v[212:215], a[24:27], a[24:27], v[212:215]
buffer_load_dwordx4 a[92:95], v46, s[60:63], s91 offen offset:3072 sc1
s_waitcnt vmcnt(16)
v_mfma_f32_16x16x32_bf16 v[208:211], v[200:203], a[28:31], v[208:211]
v_mfma_f32_16x16x32_bf16 v[216:219], a[28:31], a[28:31], v[216:219]
s_add_u32 s91, s88, 0x606000
buffer_load_dwordx4 a[96:99], v46, s[60:63], s91 offen offset:0 sc1
s_waitcnt vmcnt(16)
v_mfma_f32_16x16x32_bf16 v[204:207], v[200:203], a[32:35], v[204:207]
v_mfma_f32_16x16x32_bf16 v[212:215], a[32:35], a[32:35], v[212:215]
buffer_load_dwordx4 a[100:103], v46, s[60:63], s91 offen offset:1024 sc1
s_waitcnt vmcnt(16)
v_mfma_f32_16x16x32_bf16 v[208:211], v[200:203], a[36:39], v[208:211]
v_mfma_f32_16x16x32_bf16 v[216:219], a[36:39], a[36:39], v[216:219]
buffer_load_dwordx4 a[104:107], v46, s[60:63], s91 offen offset:2048 sc1
s_waitcnt vmcnt(16)
v_mfma_f32_16x16x32_bf16 v[204:207], v[200:203], a[40:43], v[204:207]
v_mfma_f32_16x16x32_bf16 v[212:215], a[40:43], a[40:43], v[212:215]
buffer_load_dwordx4 a[108:111], v46, s[60:63], s91 offen offset:3072 sc1
s_waitcnt vmcnt(16)
v_mfma_f32_16x16x32_bf16 v[208:211], v[200:203], a[44:47], v[208:211]
v_mfma_f32_16x16x32_bf16 v[216:219], a[44:47], a[44:47], v[216:219]
s_add_u32 s91, s88, 0x607000
buffer_load_dwordx4 a[112:115], v46, s[60:63], s91 offen offset:0 sc1
s_waitcnt vmcnt(16)
v_mfma_f32_16x16x32_bf16 v[204:207], v[200:203], a[48:51], v[204:207]
v_mfma_f32_16x16x32_bf16 v[212:215], a[48:51], a[48:51], v[212:215]
buffer_load_dwordx4 a[116:119], v46, s[60:63], s91 offen offset:1024 sc1
s_waitcnt vmcnt(16)
v_mfma_f32_16x16x32_bf16 v[208:211], v[200:203], a[52:55], v[208:211]
v_mfma_f32_16x16x32_bf16 v[216:219], a[52:55], a[52:55], v[216:219]
buffer_load_dwordx4 a[120:123], v46, s[60:63], s91 offen offset:2048 sc1
s_waitcnt vmcnt(16)
v_mfma_f32_16x16x32_bf16 v[204:207], v[200:203], a[56:59], v[204:207]
v_mfma_f32_16x16x32_bf16 v[212:215], a[56:59], a[56:59], v[212:215]
buffer_load_dwordx4 a[124:127], v46, s[60:63], s91 offen offset:3072 sc1
s_waitcnt vmcnt(16)
v_mfma_f32_16x16x32_bf16 v[208:211], v[200:203], a[60:63], v[208:211]
v_mfma_f32_16x16x32_bf16 v[216:219], a[60:63], a[60:63], v[216:219]
s_add_u32 s91, s88, 0x608000
buffer_load_dwordx4 a[128:131], v46, s[60:63], s91 offen offset:0 sc1
s_waitcnt vmcnt(16)
v_mfma_f32_16x16x32_bf16 v[204:207], v[200:203], a[64:67], v[204:207]
v_mfma_f32_16x16x32_bf16 v[212:215], a[64:67], a[64:67], v[212:215]
buffer_load_dwordx4 a[132:135], v46, s[60:63], s91 offen offset:1024 sc1
s_waitcnt vmcnt(16)
v_mfma_f32_16x16x32_bf16 v[208:211], v[200:203], a[68:71], v[208:211]
v_mfma_f32_16x16x32_bf16 v[216:219], a[68:71], a[68:71], v[216:219]
buffer_load_dwordx4 a[136:139], v46, s[60:63], s91 offen offset:2048 sc1
s_waitcnt vmcnt(16)
v_mfma_f32_16x16x32_bf16 v[204:207], v[200:203], a[72:75], v[204:207]
v_mfma_f32_16x16x32_bf16 v[212:215], a[72:75], a[72:75], v[212:215]
buffer_load_dwordx4 a[140:143], v46, s[60:63], s91 offen offset:3072 sc1
s_waitcnt vmcnt(16)
v_mfma_f32_16x16x32_bf16 v[208:211], v[200:203], a[76:79], v[208:211]
v_mfma_f32_16x16x32_bf16 v[216:219], a[76:79], a[76:79], v[216:219]
s_add_u32 s91, s88, 0x609000
buffer_load_dwordx4 a[144:147], v46, s[60:63], s91 offen offset:0 sc1
s_waitcnt vmcnt(16)
v_mfma_f32_16x16x32_bf16 v[204:207], v[200:203], a[80:83], v[204:207]
v_mfma_f32_16x16x32_bf16 v[212:215], a[80:83], a[80:83], v[212:215]
buffer_load_dwordx4 a[148:151], v46, s[60:63], s91 offen offset:1024 sc1
s_waitcnt vmcnt(16)
v_mfma_f32_16x16x32_bf16 v[208:211], v[200:203], a[84:87], v[208:211]
v_mfma_f32_16x16x32_bf16 v[216:219], a[84:87], a[84:87], v[216:219]
buffer_load_dwordx4 a[152:155], v46, s[60:63], s91 offen offset:2048 sc1
s_waitcnt vmcnt(16)
v_mfma_f32_16x16x32_bf16 v[204:207], v[200:203], a[88:91], v[204:207]
v_mfma_f32_16x16x32_bf16 v[212:215], a[88:91], a[88:91], v[212:215]
buffer_load_dwordx4 a[156:159], v46, s[60:63], s91 offen offset:3072 sc1
s_waitcnt vmcnt(16)
v_mfma_f32_16x16x32_bf16 v[208:211], v[200:203], a[92:95], v[208:211]
v_mfma_f32_16x16x32_bf16 v[216:219], a[92:95], a[92:95], v[216:219]
s_add_u32 s91, s88, 0x60a000
buffer_load_dwordx4 a[160:163], v46, s[60:63], s91 offen offset:0 sc1
s_waitcnt vmcnt(16)
v_mfma_f32_16x16x32_bf16 v[204:207], v[200:203], a[96:99], v[204:207]
v_mfma_f32_16x16x32_bf16 v[212:215], a[96:99], a[96:99], v[212:215]
buffer_load_dwordx4 a[164:167], v46, s[60:63], s91 offen offset:1024 sc1
s_waitcnt vmcnt(16)
v_mfma_f32_16x16x32_bf16 v[208:211], v[200:203], a[100:103], v[208:211]
v_mfma_f32_16x16x32_bf16 v[216:219], a[100:103], a[100:103], v[216:219]
buffer_load_dwordx4 a[168:171], v46, s[60:63], s91 offen offset:2048 sc1
s_waitcnt vmcnt(16)
v_mfma_f32_16x16x32_bf16 v[204:207], v[200:203], a[104:107], v[204:207]
v_mfma_f32_16x16x32_bf16 v[212:215], a[104:107], a[104:107], v[212:215]
buffer_load_dwordx4 a[172:175], v46, s[60:63], s91 offen offset:3072 sc1
s_waitcnt vmcnt(16)
v_mfma_f32_16x16x32_bf16 v[208:211], v[200:203], a[108:111], v[208:211]
v_mfma_f32_16x16x32_bf16 v[216:219], a[108:111], a[108:111], v[216:219]
s_add_u32 s91, s88, 0x60b000
buffer_load_dwordx4 a[176:179], v46, s[60:63], s91 offen offset:0 sc1
s_waitcnt vmcnt(16)
v_mfma_f32_16x16x32_bf16 v[204:207], v[200:203], a[112:115], v[204:207]
v_mfma_f32_16x16x32_bf16 v[212:215], a[112:115], a[112:115], v[212:215]
buffer_load_dwordx4 a[180:183], v46, s[60:63], s91 offen offset:1024 sc1
s_waitcnt vmcnt(16)
v_mfma_f32_16x16x32_bf16 v[208:211], v[200:203], a[116:119], v[208:211]
v_mfma_f32_16x16x32_bf16 v[216:219], a[116:119], a[116:119], v[216:219]
buffer_load_dwordx4 a[184:187], v46, s[60:63], s91 offen offset:2048 sc1
s_waitcnt vmcnt(16)
v_mfma_f32_16x16x32_bf16 v[204:207], v[200:203], a[120:123], v[204:207]
v_mfma_f32_16x16x32_bf16 v[212:215], a[120:123], a[120:123], v[212:215]
buffer_load_dwordx4 a[188:191], v46, s[60:63], s91 offen offset:3072 sc1
s_waitcnt vmcnt(16)
v_mfma_f32_16x16x32_bf16 v[208:211], v[200:203], a[124:127], v[208:211]
v_mfma_f32_16x16x32_bf16 v[216:219], a[124:127], a[124:127], v[216:219]
s_add_u32 s91, s88, 0x60c000
buffer_load_dwordx4 a[192:195], v46, s[60:63], s91 offen offset:0 sc1
s_waitcnt vmcnt(16)
v_mfma_f32_16x16x32_bf16 v[204:207], v[200:203], a[128:131], v[204:207]
v_mfma_f32_16x16x32_bf16 v[212:215], a[128:131], a[128:131], v[212:215]
buffer_load_dwordx4 a[196:199], v46, s[60:63], s91 offen offset:1024 sc1
s_waitcnt vmcnt(16)
v_mfma_f32_16x16x32_bf16 v[208:211], v[200:203], a[132:135], v[208:211]
v_mfma_f32_16x16x32_bf16 v[216:219], a[132:135], a[132:135], v[216:219]
buffer_load_dwordx4 a[200:203], v46, s[60:63], s91 offen offset:2048 sc1
s_waitcnt vmcnt(16)
v_mfma_f32_16x16x32_bf16 v[204:207], v[200:203], a[136:139], v[204:207]
v_mfma_f32_16x16x32_bf16 v[212:215], a[136:139], a[136:139], v[212:215]
buffer_load_dwordx4 a[204:207], v46, s[60:63], s91 offen offset:3072 sc1
s_waitcnt vmcnt(16)
v_mfma_f32_16x16x32_bf16 v[208:211], v[200:203], a[140:143], v[208:211]
v_mfma_f32_16x16x32_bf16 v[216:219], a[140:143], a[140:143], v[216:219]
s_add_u32 s91, s88, 0x60d000
buffer_load_dwordx4 a[208:211], v46, s[60:63], s91 offen offset:0 sc1
s_waitcnt vmcnt(16)
v_mfma_f32_16x16x32_bf16 v[204:207], v[200:203], a[144:147], v[204:207]
v_mfma_f32_16x16x32_bf16 v[212:215], a[144:147], a[144:147], v[212:215]
buffer_load_dwordx4 a[212:215], v46, s[60:63], s91 offen offset:1024 sc1
s_waitcnt vmcnt(16)
v_mfma_f32_16x16x32_bf16 v[208:211], v[200:203], a[148:151], v[208:211]
v_mfma_f32_16x16x32_bf16 v[216:219], a[148:151], a[148:151], v[216:219]
buffer_load_dwordx4 a[216:219], v46, s[60:63], s91 offen offset:2048 sc1
s_waitcnt vmcnt(16)
v_mfma_f32_16x16x32_bf16 v[204:207], v[200:203], a[152:155], v[204:207]
v_mfma_f32_16x16x32_bf16 v[212:215], a[152:155], a[152:155], v[212:215]
buffer_load_dwordx4 a[220:223], v46, s[60:63], s91 offen offset:3072 sc1
s_waitcnt vmcnt(16)
v_mfma_f32_16x16x32_bf16 v[208:211], v[200:203], a[156:159], v[208:211]
v_mfma_f32_16x16x32_bf16 v[216:219], a[156:159], a[156:159], v[216:219]
s_add_u32 s91, s88, 0x60e000
buffer_load_dwordx4 a[224:227], v46, s[60:63], s91 offen offset:0 sc1
s_waitcnt vmcnt(16)
v_mfma_f32_16x16x32_bf16 v[204:207], v[200:203], a[160:163], v[204:207]
v_mfma_f32_16x16x32_bf16 v[212:215], a[160:163], a[160:163], v[212:215]
buffer_load_dwordx4 a[228:231], v46, s[60:63], s91 offen offset:1024 sc1
s_waitcnt vmcnt(16)
v_mfma_f32_16x16x32_bf16 v[208:211], v[200:203], a[164:167], v[208:211]
v_mfma_f32_16x16x32_bf16 v[216:219], a[164:167], a[164:167], v[216:219]
buffer_load_dwordx4 a[232:235], v46, s[60:63], s91 offen offset:2048 sc1
s_waitcnt vmcnt(16)
v_mfma_f32_16x16x32_bf16 v[204:207], v[200:203], a[168:171], v[204:207]
v_mfma_f32_16x16x32_bf16 v[212:215], a[168:171], a[168:171], v[212:215]
buffer_load_dwordx4 a[236:239], v46, s[60:63], s91 offen offset:3072 sc1
s_waitcnt vmcnt(16)
v_mfma_f32_16x16x32_bf16 v[208:211], v[200:203], a[172:175], v[208:211]
v_mfma_f32_16x16x32_bf16 v[216:219], a[172:175], a[172:175], v[216:219]
s_add_u32 s91, s88, 0x60f000
buffer_load_dwordx4 a[240:243], v46, s[60:63], s91 offen offset:0 sc1
s_waitcnt vmcnt(16)
v_mfma_f32_16x16x32_bf16 v[204:207], v[200:203], a[176:179], v[204:207]
v_mfma_f32_16x16x32_bf16 v[212:215], a[176:179], a[176:179], v[212:215]
buffer_load_dwordx4 a[244:247], v46, s[60:63], s91 offen offset:1024 sc1
s_waitcnt vmcnt(16)
v_mfma_f32_16x16x32_bf16 v[208:211], v[200:203], a[180:183], v[208:211]
v_mfma_f32_16x16x32_bf16 v[216:219], a[180:183], a[180:183], v[216:219]
buffer_load_dwordx4 a[248:251], v46, s[60:63], s91 offen offset:2048 sc1
s_waitcnt vmcnt(16)
v_mfma_f32_16x16x32_bf16 v[204:207], v[200:203], a[184:187], v[204:207]
v_mfma_f32_16x16x32_bf16 v[212:215], a[184:187], a[184:187], v[212:215]
buffer_load_dwordx4 a[252:255], v46, s[60:63], s91 offen offset:3072 sc1
s_waitcnt vmcnt(16)
v_mfma_f32_16x16x32_bf16 v[208:211], v[200:203], a[188:191], v[208:211]
v_mfma_f32_16x16x32_bf16 v[216:219], a[188:191], a[188:191], v[216:219]
s_add_u32 m0, s76, 98304
s_add_u32 s77, s84, 0x380000
buffer_load_dwordx4 v30, s[40:43], s77 offen offset:0 lds
buffer_load_dwordx4 v31, s[40:43], s77 offen offset:1024 lds
buffer_load_dwordx4 v32, s[40:43], s77 offen offset:2048 lds
buffer_load_dwordx4 v33, s[40:43], s77 offen offset:3072 lds
s_add_u32 m0, s76, 102400
s_add_u32 s77, s84, 0x460000
buffer_load_dwordx4 v30, s[40:43], s77 offen offset:0 lds
buffer_load_dwordx4 v31, s[40:43], s77 offen offset:1024 lds
buffer_load_dwordx4 v32, s[40:43], s77 offen offset:2048 lds
buffer_load_dwordx4 v33, s[40:43], s77 offen offset:3072 lds
s_waitcnt vmcnt(23)
v_mfma_f32_16x16x32_bf16 v[204:207], v[200:203], a[192:195], v[204:207]
v_mfma_f32_16x16x32_bf16 v[212:215], a[192:195], a[192:195], v[212:215]
s_waitcnt vmcnt(22)
v_mfma_f32_16x16x32_bf16 v[208:211], v[200:203], a[196:199], v[208:211]
v_mfma_f32_16x16x32_bf16 v[216:219], a[196:199], a[196:199], v[216:219]
s_waitcnt vmcnt(21)
v_mfma_f32_16x16x32_bf16 v[204:207], v[200:203], a[200:203], v[204:207]
v_mfma_f32_16x16x32_bf16 v[212:215], a[200:203], a[200:203], v[212:215]
s_waitcnt vmcnt(20)
v_mfma_f32_16x16x32_bf16 v[208:211], v[200:203], a[204:207], v[208:211]
v_mfma_f32_16x16x32_bf16 v[216:219], a[204:207], a[204:207], v[216:219]
s_waitcnt vmcnt(19)
v_mfma_f32_16x16x32_bf16 v[204:207], v[200:203], a[208:211], v[204:207]
v_mfma_f32_16x16x32_bf16 v[212:215], a[208:211], a[208:211], v[212:215]
s_waitcnt vmcnt(18)
v_mfma_f32_16x16x32_bf16 v[208:211], v[200:203], a[212:215], v[208:211]
v_mfma_f32_16x16x32_bf16 v[216:219], a[212:215], a[212:215], v[216:219]
s_waitcnt vmcnt(17)
v_mfma_f32_16x16x32_bf16 v[204:207], v[200:203], a[216:219], v[204:207]
v_mfma_f32_16x16x32_bf16 v[212:215], a[216:219], a[216:219], v[212:215]
s_waitcnt vmcnt(16)
v_mfma_f32_16x16x32_bf16 v[208:211], v[200:203], a[220:223], v[208:211]
v_mfma_f32_16x16x32_bf16 v[216:219], a[220:223], a[220:223], v[216:219]
s_waitcnt vmcnt(15)
v_mfma_f32_16x16x32_bf16 v[204:207], v[200:203], a[224:227], v[204:207]
v_mfma_f32_16x16x32_bf16 v[212:215], a[224:227], a[224:227], v[212:215]
s_waitcnt vmcnt(14)
v_mfma_f32_16x16x32_bf16 v[208:211], v[200:203], a[228:231], v[208:211]
v_mfma_f32_16x16x32_bf16 v[216:219], a[228:231], a[228:231], v[216:219]
s_waitcnt vmcnt(13)
v_mfma_f32_16x16x32_bf16 v[204:207], v[200:203], a[232:235], v[204:207]
v_mfma_f32_16x16x32_bf16 v[212:215], a[232:235], a[232:235], v[212:215]
s_waitcnt vmcnt(12)
v_mfma_f32_16x16x32_bf16 v[208:211], v[200:203], a[236:239], v[208:211]
v_mfma_f32_16x16x32_bf16 v[216:219], a[236:239], a[236:239], v[216:219]
s_waitcnt vmcnt(11)
v_mfma_f32_16x16x32_bf16 v[204:207], v[200:203], a[240:243], v[204:207]
v_mfma_f32_16x16x32_bf16 v[212:215], a[240:243], a[240:243], v[212:215]
s_waitcnt vmcnt(10)
v_mfma_f32_16x16x32_bf16 v[208:211], v[200:203], a[244:247], v[208:211]
v_mfma_f32_16x16x32_bf16 v[216:219], a[244:247], a[244:247], v[216:219]
s_waitcnt vmcnt(9)
v_mfma_f32_16x16x32_bf16 v[204:207], v[200:203], a[248:251], v[204:207]
v_mfma_f32_16x16x32_bf16 v[212:215], a[248:251], a[248:251], v[212:215]
s_waitcnt vmcnt(8)
v_mfma_f32_16x16x32_bf16 v[208:211], v[200:203], a[252:255], v[208:211]
v_mfma_f32_16x16x32_bf16 v[216:219], a[252:255], a[252:255], v[216:219]
v_and_b32 v2, 3, v1
v_cmp_eq_u32 vcc, 1, v2
s_nop 2
v_cndmask_b32 v212, v212, v213, vcc
s_nop 1
v_cndmask_b32 v216, v216, v217, vcc
v_cmp_eq_u32 vcc, 2, v2
s_nop 1
v_cndmask_b32 v212, v212, v214, vcc
v_cndmask_b32 v216, v216, v218, vcc
v_cmp_eq_u32 vcc, 3, v2
s_nop 1
v_cndmask_b32 v212, v212, v215, vcc
v_cndmask_b32 v216, v216, v219, vcc
v_and_b32 v2, 15, v1
v_lshrrev_b32 v3, 2, v2
v_lshl_add_u32 v2, v3, 4, v2
v_lshlrev_b32 v2, 2, v2
ds_bpermute_b32 v213, v2, v212
ds_bpermute_b32 v217, v2, v216
v_mul_f32 v204, 0x3a800000, v204
v_mul_f32 v208, 0x3a800000, v208
v_mul_f32 v205, v204, v204
v_mul_f32 v209, v208, v208
s_waitcnt lgkmcnt(1)
v_mul_f32 v213, 0x3a800000, v213
s_waitcnt lgkmcnt(0)
v_mul_f32 v217, 0x3a800000, v217
v_sub_f32 v213, v213, v205
v_sub_f32 v217, v217, v209
v_max_f32 v213, 0, v213
v_max_f32 v217, 0, v217
v_cvt_pk_bf16_f32 v206, v213, v213
v_lshlrev_b32 v213, 16, v206
v_cvt_pk_bf16_f32 v210, v217, v217
v_lshlrev_b32 v217, 16, v210
v_add_f32 v213, 0x3727c5ac, v213
v_add_f32 v217, 0x3727c5ac, v217
v_cvt_pk_bf16_f32 v206, v213, v213
v_lshlrev_b32 v213, 16, v206
v_cvt_pk_bf16_f32 v210, v217, v217
v_lshlrev_b32 v217, 16, v210
v_sqrt_f32 v213, v213
v_sqrt_f32 v217, v217
v_sub_f32 v204, 0, v204
v_sub_f32 v208, 0, v208
v_cmp_gt_u32 vcc, 16, v1
v_cvt_pk_bf16_f32 v206, v213, v204
v_cvt_pk_bf16_f32 v210, v217, v208
v_lshlrev_b32 v76, 16, v206
v_lshlrev_b32 v77, 16, v210
v_cndmask_b32 v68, 0, v206, vcc
v_mov_b32 v69, 0
v_mov_b32 v70, 0
v_mov_b32 v71, v68
v_cndmask_b32 v72, 0, v210, vcc
v_mov_b32 v73, 0
v_mov_b32 v74, 0
v_mov_b32 v75, v72
v_rcp_f32 v58, v76
v_rcp_f32 v59, v77
v_mul_f32 v60, 0xbfb8aa3b, v58
v_mul_f32 v62, v76, v76
v_mul_f32 v61, 0xbfb8aa3b, v59
v_mul_f32 v63, v77, v77
v_and_b32 v2, 15, v1
v_lshrrev_b32 v3, 2, v2
v_lshrrev_b32 v4, 4, v1
v_cmp_eq_u32 vcc, v3, v4
v_lshlrev_b32 v3, 4, v2
v_mov_b32 v4, 256
v_cndmask_b32 v3, v4, v3, vcc
v_add_u32 v53, 131072, v3
v_lshlrev_b32 v2, 3, v2
v_add_u32 v54, 139776, v2
ds_read_b128 v[128:131], v53 offset:0
ds_read_b64 v[132:133], v54 offset:0
ds_read_b128 v[136:139], v53 offset:272
ds_read_b64 v[140:141], v54 offset:128
ds_read_b128 v[144:147], v53 offset:544
ds_read_b64 v[148:149], v54 offset:256
s_waitcnt lgkmcnt(4)
v_mfma_f32_16x16x16_bf16 v[160:163], v[132:133], v[68:69], 0
v_mfma_f32_16x16x16_bf16 v[164:167], v[132:133], v[70:71], 0
ds_read_b128 v[152:155], v53 offset:816
v_mfma_f32_16x16x16_bf16 v[160:163], v[128:129], a[0:1], v[160:163]
v_mfma_f32_16x16x16_bf16 v[164:167], v[130:131], a[2:3], v[164:167]
s_add_u32 s70, s0, S_G0 - K_pc + 0
s_addc_u32 s71, s1, 0
global_load_dword v57, v9, s[70:71]
v_mfma_f32_16x16x16_bf16 v[168:171], v[132:133], v[72:73], 0
v_mfma_f32_16x16x16_bf16 v[172:175], v[132:133], v[74:75], 0
ds_read_b64 v[156:157], v54 offset:384
v_mfma_f32_16x16x16_bf16 v[168:171], v[128:129], a[4:5], v[168:171]
v_mfma_f32_16x16x16_bf16 v[172:175], v[130:131], a[6:7], v[172:175]
s_waitcnt lgkmcnt(4)
v_mfma_f32_16x16x16_bf16 v[176:179], v[140:141], v[68:69], 0
v_cvt_pk_bf16_f32 v160, v160, v161
v_cvt_pk_bf16_f32 v161, v162, v163
v_mfma_f32_16x16x16_bf16 v[180:183], v[140:141], v[70:71], 0
v_cvt_pk_bf16_f32 v164, v164, v165
v_cvt_pk_bf16_f32 v165, v166, v167
ds_read_b128 v[128:131], v53 offset:1088
v_mfma_f32_16x16x16_bf16 v[176:179], v[136:137], a[8:9], v[176:179]
v_accvgpr_write_b32 a0, v160
v_accvgpr_write_b32 a1, v161
v_mfma_f32_16x16x16_bf16 v[180:183], v[138:139], a[10:11], v[180:183]
v_accvgpr_write_b32 a2, v164
v_accvgpr_write_b32 a3, v165
v_mfma_f32_16x16x16_bf16 v[184:187], v[140:141], v[72:73], 0
v_cvt_pk_bf16_f32 v168, v168, v169
v_cvt_pk_bf16_f32 v169, v170, v171
v_mfma_f32_16x16x16_bf16 v[188:191], v[140:141], v[74:75], 0
v_cvt_pk_bf16_f32 v172, v172, v173
v_cvt_pk_bf16_f32 v173, v174, v175
ds_read_b64 v[132:133], v54 offset:512
v_mfma_f32_16x16x16_bf16 v[184:187], v[136:137], a[12:13], v[184:187]
v_accvgpr_write_b32 a4, v168
v_accvgpr_write_b32 a5, v169
v_mfma_f32_16x16x16_bf16 v[188:191], v[138:139], a[14:15], v[188:191]
v_accvgpr_write_b32 a6, v172
v_accvgpr_write_b32 a7, v173
s_waitcnt lgkmcnt(4)
v_mfma_f32_16x16x16_bf16 v[160:163], v[148:149], v[68:69], 0
v_cvt_pk_bf16_f32 v176, v176, v177
v_cvt_pk_bf16_f32 v177, v178, v179
v_mfma_f32_16x16x16_bf16 v[164:167], v[148:149], v[70:71], 0
v_cvt_pk_bf16_f32 v180, v180, v181
v_cvt_pk_bf16_f32 v181, v182, v183
ds_read_b128 v[136:139], v53 offset:1360
v_mfma_f32_16x16x16_bf16 v[160:163], v[144:145], a[16:17], v[160:163]
v_accvgpr_write_b32 a8, v176
v_accvgpr_write_b32 a9, v177
v_mfma_f32_16x16x16_bf16 v[164:167], v[146:147], a[18:19], v[164:167]
v_accvgpr_write_b32 a10, v180
v_accvgpr_write_b32 a11, v181
v_mfma_f32_16x16x16_bf16 v[168:171], v[148:149], v[72:73], 0
v_cvt_pk_bf16_f32 v184, v184, v185
v_cvt_pk_bf16_f32 v185, v186, v187
v_mfma_f32_16x16x16_bf16 v[172:175], v[148:149], v[74:75], 0
v_cvt_pk_bf16_f32 v188, v188, v189
v_cvt_pk_bf16_f32 v189, v190, v191
ds_read_b64 v[140:141], v54 offset:640
v_mfma_f32_16x16x16_bf16 v[168:171], v[144:145], a[20:21], v[168:171]
v_accvgpr_write_b32 a12, v184
v_accvgpr_write_b32 a13, v185
v_mfma_f32_16x16x16_bf16 v[172:175], v[146:147], a[22:23], v[172:175]
v_accvgpr_write_b32 a14, v188
v_accvgpr_write_b32 a15, v189
s_waitcnt lgkmcnt(4)
v_mfma_f32_16x16x16_bf16 v[176:179], v[156:157], v[68:69], 0
v_cvt_pk_bf16_f32 v160, v160, v161
v_cvt_pk_bf16_f32 v161, v162, v163
v_mfma_f32_16x16x16_bf16 v[180:183], v[156:157], v[70:71], 0
v_cvt_pk_bf16_f32 v164, v164, v165
v_cvt_pk_bf16_f32 v165, v166, v167
ds_read_b128 v[144:147], v53 offset:1632
v_mfma_f32_16x16x16_bf16 v[176:179], v[152:153], a[24:25], v[176:179]
v_accvgpr_write_b32 a16, v160
v_accvgpr_write_b32 a17, v161
v_mfma_f32_16x16x16_bf16 v[180:183], v[154:155], a[26:27], v[180:183]
v_accvgpr_write_b32 a18, v164
v_accvgpr_write_b32 a19, v165
v_mfma_f32_16x16x16_bf16 v[184:187], v[156:157], v[72:73], 0
v_cvt_pk_bf16_f32 v168, v168, v169
v_cvt_pk_bf16_f32 v169, v170, v171
v_mfma_f32_16x16x16_bf16 v[188:191], v[156:157], v[74:75], 0
v_cvt_pk_bf16_f32 v172, v172, v173
v_cvt_pk_bf16_f32 v173, v174, v175
ds_read_b64 v[148:149], v54 offset:768
v_mfma_f32_16x16x16_bf16 v[184:187], v[152:153], a[28:29], v[184:187]
v_accvgpr_write_b32 a20, v168
v_accvgpr_write_b32 a21, v169
v_mfma_f32_16x16x16_bf16 v[188:191], v[154:155], a[30:31], v[188:191]
v_accvgpr_write_b32 a22, v172
v_accvgpr_write_b32 a23, v173
s_waitcnt lgkmcnt(4)
v_mfma_f32_16x16x16_bf16 v[160:163], v[132:133], v[68:69], 0
v_cvt_pk_bf16_f32 v176, v176, v177
v_cvt_pk_bf16_f32 v177, v178, v179
v_mfma_f32_16x16x16_bf16 v[164:167], v[132:133], v[70:71], 0
v_cvt_pk_bf16_f32 v180, v180, v181
v_cvt_pk_bf16_f32 v181, v182, v183
ds_read_b128 v[152:155], v53 offset:1904
v_mfma_f32_16x16x16_bf16 v[160:163], v[128:129], a[32:33], v[160:163]
v_accvgpr_write_b32 a24, v176
v_accvgpr_write_b32 a25, v177
v_mfma_f32_16x16x16_bf16 v[164:167], v[130:131], a[34:35], v[164:167]
v_accvgpr_write_b32 a26, v180
v_accvgpr_write_b32 a27, v181
v_mfma_f32_16x16x16_bf16 v[168:171], v[132:133], v[72:73], 0
v_cvt_pk_bf16_f32 v184, v184, v185
v_cvt_pk_bf16_f32 v185, v186, v187
v_mfma_f32_16x16x16_bf16 v[172:175], v[132:133], v[74:75], 0
v_cvt_pk_bf16_f32 v188, v188, v189
v_cvt_pk_bf16_f32 v189, v190, v191
ds_read_b64 v[156:157], v54 offset:896
v_mfma_f32_16x16x16_bf16 v[168:171], v[128:129], a[36:37], v[168:171]
v_accvgpr_write_b32 a28, v184
v_accvgpr_write_b32 a29, v185
v_mfma_f32_16x16x16_bf16 v[172:175], v[130:131], a[38:39], v[172:175]
v_accvgpr_write_b32 a30, v188
v_accvgpr_write_b32 a31, v189
s_waitcnt lgkmcnt(4)
v_mfma_f32_16x16x16_bf16 v[176:179], v[140:141], v[68:69], 0
v_cvt_pk_bf16_f32 v160, v160, v161
v_cvt_pk_bf16_f32 v161, v162, v163
v_mfma_f32_16x16x16_bf16 v[180:183], v[140:141], v[70:71], 0
v_cvt_pk_bf16_f32 v164, v164, v165
v_cvt_pk_bf16_f32 v165, v166, v167
ds_read_b128 v[128:131], v53 offset:2176
v_mfma_f32_16x16x16_bf16 v[176:179], v[136:137], a[40:41], v[176:179]
v_accvgpr_write_b32 a32, v160
v_accvgpr_write_b32 a33, v161
v_mfma_f32_16x16x16_bf16 v[180:183], v[138:139], a[42:43], v[180:183]
v_accvgpr_write_b32 a34, v164
v_accvgpr_write_b32 a35, v165
v_mfma_f32_16x16x16_bf16 v[184:187], v[140:141], v[72:73], 0
v_cvt_pk_bf16_f32 v168, v168, v169
v_cvt_pk_bf16_f32 v169, v170, v171
v_mfma_f32_16x16x16_bf16 v[188:191], v[140:141], v[74:75], 0
v_cvt_pk_bf16_f32 v172, v172, v173
v_cvt_pk_bf16_f32 v173, v174, v175
ds_read_b64 v[132:133], v54 offset:1024
v_mfma_f32_16x16x16_bf16 v[184:187], v[136:137], a[44:45], v[184:187]
v_accvgpr_write_b32 a36, v168
v_accvgpr_write_b32 a37, v169
v_mfma_f32_16x16x16_bf16 v[188:191], v[138:139], a[46:47], v[188:191]
v_accvgpr_write_b32 a38, v172
v_accvgpr_write_b32 a39, v173
s_waitcnt lgkmcnt(4)
v_mfma_f32_16x16x16_bf16 v[160:163], v[148:149], v[68:69], 0
v_cvt_pk_bf16_f32 v176, v176, v177
v_cvt_pk_bf16_f32 v177, v178, v179
v_mfma_f32_16x16x16_bf16 v[164:167], v[148:149], v[70:71], 0
v_cvt_pk_bf16_f32 v180, v180, v181
v_cvt_pk_bf16_f32 v181, v182, v183
ds_read_b128 v[136:139], v53 offset:2448
v_mfma_f32_16x16x16_bf16 v[160:163], v[144:145], a[48:49], v[160:163]
v_accvgpr_write_b32 a40, v176
v_accvgpr_write_b32 a41, v177
v_mfma_f32_16x16x16_bf16 v[164:167], v[146:147], a[50:51], v[164:167]
v_accvgpr_write_b32 a42, v180
v_accvgpr_write_b32 a43, v181
v_mfma_f32_16x16x16_bf16 v[168:171], v[148:149], v[72:73], 0
v_cvt_pk_bf16_f32 v184, v184, v185
v_cvt_pk_bf16_f32 v185, v186, v187
v_mfma_f32_16x16x16_bf16 v[172:175], v[148:149], v[74:75], 0
v_cvt_pk_bf16_f32 v188, v188, v189
v_cvt_pk_bf16_f32 v189, v190, v191
ds_read_b64 v[140:141], v54 offset:1152
v_mfma_f32_16x16x16_bf16 v[168:171], v[144:145], a[52:53], v[168:171]
v_accvgpr_write_b32 a44, v184
v_accvgpr_write_b32 a45, v185
v_mfma_f32_16x16x16_bf16 v[172:175], v[146:147], a[54:55], v[172:175]
v_accvgpr_write_b32 a46, v188
v_accvgpr_write_b32 a47, v189
s_waitcnt lgkmcnt(4)
v_mfma_f32_16x16x16_bf16 v[176:179], v[156:157], v[68:69], 0
v_cvt_pk_bf16_f32 v160, v160, v161
v_cvt_pk_bf16_f32 v161, v162, v163
v_mfma_f32_16x16x16_bf16 v[180:183], v[156:157], v[70:71], 0
v_cvt_pk_bf16_f32 v164, v164, v165
v_cvt_pk_bf16_f32 v165, v166, v167
ds_read_b128 v[144:147], v53 offset:2720
v_mfma_f32_16x16x16_bf16 v[176:179], v[152:153], a[56:57], v[176:179]
v_accvgpr_write_b32 a48, v160
v_accvgpr_write_b32 a49, v161
v_mfma_f32_16x16x16_bf16 v[180:183], v[154:155], a[58:59], v[180:183]
v_accvgpr_write_b32 a50, v164
v_accvgpr_write_b32 a51, v165
v_mfma_f32_16x16x16_bf16 v[184:187], v[156:157], v[72:73], 0
v_cvt_pk_bf16_f32 v168, v168, v169
v_cvt_pk_bf16_f32 v169, v170, v171
v_mfma_f32_16x16x16_bf16 v[188:191], v[156:157], v[74:75], 0
v_cvt_pk_bf16_f32 v172, v172, v173
v_cvt_pk_bf16_f32 v173, v174, v175
ds_read_b64 v[148:149], v54 offset:1280
v_mfma_f32_16x16x16_bf16 v[184:187], v[152:153], a[60:61], v[184:187]
v_accvgpr_write_b32 a52, v168
v_accvgpr_write_b32 a53, v169
v_mfma_f32_16x16x16_bf16 v[188:191], v[154:155], a[62:63], v[188:191]
v_accvgpr_write_b32 a54, v172
v_accvgpr_write_b32 a55, v173
s_waitcnt lgkmcnt(4)
v_mfma_f32_16x16x16_bf16 v[160:163], v[132:133], v[68:69], 0
v_cvt_pk_bf16_f32 v176, v176, v177
v_cvt_pk_bf16_f32 v177, v178, v179
v_mfma_f32_16x16x16_bf16 v[164:167], v[132:133], v[70:71], 0
v_cvt_pk_bf16_f32 v180, v180, v181
v_cvt_pk_bf16_f32 v181, v182, v183
ds_read_b128 v[152:155], v53 offset:2992
v_mfma_f32_16x16x16_bf16 v[160:163], v[128:129], a[64:65], v[160:163]
v_accvgpr_write_b32 a56, v176
v_accvgpr_write_b32 a57, v177
v_mfma_f32_16x16x16_bf16 v[164:167], v[130:131], a[66:67], v[164:167]
v_accvgpr_write_b32 a58, v180
v_accvgpr_write_b32 a59, v181
v_mfma_f32_16x16x16_bf16 v[168:171], v[132:133], v[72:73], 0
v_cvt_pk_bf16_f32 v184, v184, v185
v_cvt_pk_bf16_f32 v185, v186, v187
v_mfma_f32_16x16x16_bf16 v[172:175], v[132:133], v[74:75], 0
v_cvt_pk_bf16_f32 v188, v188, v189
v_cvt_pk_bf16_f32 v189, v190, v191
ds_read_b64 v[156:157], v54 offset:1408
v_mfma_f32_16x16x16_bf16 v[168:171], v[128:129], a[68:69], v[168:171]
v_accvgpr_write_b32 a60, v184
v_accvgpr_write_b32 a61, v185
v_mfma_f32_16x16x16_bf16 v[172:175], v[130:131], a[70:71], v[172:175]
v_accvgpr_write_b32 a62, v188
v_accvgpr_write_b32 a63, v189
s_waitcnt lgkmcnt(4)
v_mfma_f32_16x16x16_bf16 v[176:179], v[140:141], v[68:69], 0
v_cvt_pk_bf16_f32 v160, v160, v161
v_cvt_pk_bf16_f32 v161, v162, v163
v_mfma_f32_16x16x16_bf16 v[180:183], v[140:141], v[70:71], 0
v_cvt_pk_bf16_f32 v164, v164, v165
v_cvt_pk_bf16_f32 v165, v166, v167
ds_read_b128 v[128:131], v53 offset:3264
v_mfma_f32_16x16x16_bf16 v[176:179], v[136:137], a[72:73], v[176:179]
v_accvgpr_write_b32 a64, v160
v_accvgpr_write_b32 a65, v161
v_mfma_f32_16x16x16_bf16 v[180:183], v[138:139], a[74:75], v[180:183]
v_accvgpr_write_b32 a66, v164
v_accvgpr_write_b32 a67, v165
v_mfma_f32_16x16x16_bf16 v[184:187], v[140:141], v[72:73], 0
v_cvt_pk_bf16_f32 v168, v168, v169
v_cvt_pk_bf16_f32 v169, v170, v171
v_mfma_f32_16x16x16_bf16 v[188:191], v[140:141], v[74:75], 0
v_cvt_pk_bf16_f32 v172, v172, v173
v_cvt_pk_bf16_f32 v173, v174, v175
ds_read_b64 v[132:133], v54 offset:1536
v_mfma_f32_16x16x16_bf16 v[184:187], v[136:137], a[76:77], v[184:187]
v_accvgpr_write_b32 a68, v168
v_accvgpr_write_b32 a69, v169
v_mfma_f32_16x16x16_bf16 v[188:191], v[138:139], a[78:79], v[188:191]
v_accvgpr_write_b32 a70, v172
v_accvgpr_write_b32 a71, v173
s_waitcnt lgkmcnt(4)
v_mfma_f32_16x16x16_bf16 v[160:163], v[148:149], v[68:69], 0
v_cvt_pk_bf16_f32 v176, v176, v177
v_cvt_pk_bf16_f32 v177, v178, v179
v_mfma_f32_16x16x16_bf16 v[164:167], v[148:149], v[70:71], 0
v_cvt_pk_bf16_f32 v180, v180, v181
v_cvt_pk_bf16_f32 v181, v182, v183
ds_read_b128 v[136:139], v53 offset:3536
v_mfma_f32_16x16x16_bf16 v[160:163], v[144:145], a[80:81], v[160:163]
v_accvgpr_write_b32 a72, v176
v_accvgpr_write_b32 a73, v177
v_mfma_f32_16x16x16_bf16 v[164:167], v[146:147], a[82:83], v[164:167]
v_accvgpr_write_b32 a74, v180
v_accvgpr_write_b32 a75, v181
v_mfma_f32_16x16x16_bf16 v[168:171], v[148:149], v[72:73], 0
v_cvt_pk_bf16_f32 v184, v184, v185
v_cvt_pk_bf16_f32 v185, v186, v187
v_mfma_f32_16x16x16_bf16 v[172:175], v[148:149], v[74:75], 0
v_cvt_pk_bf16_f32 v188, v188, v189
v_cvt_pk_bf16_f32 v189, v190, v191
ds_read_b64 v[140:141], v54 offset:1664
v_mfma_f32_16x16x16_bf16 v[168:171], v[144:145], a[84:85], v[168:171]
v_accvgpr_write_b32 a76, v184
v_accvgpr_write_b32 a77, v185
v_mfma_f32_16x16x16_bf16 v[172:175], v[146:147], a[86:87], v[172:175]
v_accvgpr_write_b32 a78, v188
v_accvgpr_write_b32 a79, v189
s_waitcnt lgkmcnt(4)
v_mfma_f32_16x16x16_bf16 v[176:179], v[156:157], v[68:69], 0
v_cvt_pk_bf16_f32 v160, v160, v161
v_cvt_pk_bf16_f32 v161, v162, v163
v_mfma_f32_16x16x16_bf16 v[180:183], v[156:157], v[70:71], 0
v_cvt_pk_bf16_f32 v164, v164, v165
v_cvt_pk_bf16_f32 v165, v166, v167
ds_read_b128 v[144:147], v53 offset:3808
v_mfma_f32_16x16x16_bf16 v[176:179], v[152:153], a[88:89], v[176:179]
v_accvgpr_write_b32 a80, v160
v_accvgpr_write_b32 a81, v161
v_mfma_f32_16x16x16_bf16 v[180:183], v[154:155], a[90:91], v[180:183]
v_accvgpr_write_b32 a82, v164
v_accvgpr_write_b32 a83, v165
v_mfma_f32_16x16x16_bf16 v[184:187], v[156:157], v[72:73], 0
v_cvt_pk_bf16_f32 v168, v168, v169
v_cvt_pk_bf16_f32 v169, v170, v171
v_mfma_f32_16x16x16_bf16 v[188:191], v[156:157], v[74:75], 0
v_cvt_pk_bf16_f32 v172, v172, v173
v_cvt_pk_bf16_f32 v173, v174, v175
ds_read_b64 v[148:149], v54 offset:1792
v_mfma_f32_16x16x16_bf16 v[184:187], v[152:153], a[92:93], v[184:187]
v_accvgpr_write_b32 a84, v168
v_accvgpr_write_b32 a85, v169
v_mfma_f32_16x16x16_bf16 v[188:191], v[154:155], a[94:95], v[188:191]
v_accvgpr_write_b32 a86, v172
v_accvgpr_write_b32 a87, v173
s_waitcnt lgkmcnt(4)
v_mfma_f32_16x16x16_bf16 v[160:163], v[132:133], v[68:69], 0
v_cvt_pk_bf16_f32 v176, v176, v177
v_cvt_pk_bf16_f32 v177, v178, v179
v_mfma_f32_16x16x16_bf16 v[164:167], v[132:133], v[70:71], 0
v_cvt_pk_bf16_f32 v180, v180, v181
v_cvt_pk_bf16_f32 v181, v182, v183
ds_read_b128 v[152:155], v53 offset:4080
v_mfma_f32_16x16x16_bf16 v[160:163], v[128:129], a[96:97], v[160:163]
v_accvgpr_write_b32 a88, v176
v_accvgpr_write_b32 a89, v177
v_mfma_f32_16x16x16_bf16 v[164:167], v[130:131], a[98:99], v[164:167]
v_accvgpr_write_b32 a90, v180
v_accvgpr_write_b32 a91, v181
v_mfma_f32_16x16x16_bf16 v[168:171], v[132:133], v[72:73], 0
v_cvt_pk_bf16_f32 v184, v184, v185
v_cvt_pk_bf16_f32 v185, v186, v187
v_mfma_f32_16x16x16_bf16 v[172:175], v[132:133], v[74:75], 0
v_cvt_pk_bf16_f32 v188, v188, v189
v_cvt_pk_bf16_f32 v189, v190, v191
ds_read_b64 v[156:157], v54 offset:1920
v_mfma_f32_16x16x16_bf16 v[168:171], v[128:129], a[100:101], v[168:171]
v_accvgpr_write_b32 a92, v184
v_accvgpr_write_b32 a93, v185
v_mfma_f32_16x16x16_bf16 v[172:175], v[130:131], a[102:103], v[172:175]
v_accvgpr_write_b32 a94, v188
v_accvgpr_write_b32 a95, v189
s_waitcnt lgkmcnt(4)
v_mfma_f32_16x16x16_bf16 v[176:179], v[140:141], v[68:69], 0
v_cvt_pk_bf16_f32 v160, v160, v161
v_cvt_pk_bf16_f32 v161, v162, v163
v_mfma_f32_16x16x16_bf16 v[180:183], v[140:141], v[70:71], 0
v_cvt_pk_bf16_f32 v164, v164, v165
v_cvt_pk_bf16_f32 v165, v166, v167
ds_read_b128 v[128:131], v53 offset:4352
v_mfma_f32_16x16x16_bf16 v[176:179], v[136:137], a[104:105], v[176:179]
v_accvgpr_write_b32 a96, v160
v_accvgpr_write_b32 a97, v161
v_mfma_f32_16x16x16_bf16 v[180:183], v[138:139], a[106:107], v[180:183]
v_accvgpr_write_b32 a98, v164
v_accvgpr_write_b32 a99, v165
v_mfma_f32_16x16x16_bf16 v[184:187], v[140:141], v[72:73], 0
v_cvt_pk_bf16_f32 v168, v168, v169
v_cvt_pk_bf16_f32 v169, v170, v171
v_mfma_f32_16x16x16_bf16 v[188:191], v[140:141], v[74:75], 0
v_cvt_pk_bf16_f32 v172, v172, v173
v_cvt_pk_bf16_f32 v173, v174, v175
ds_read_b64 v[132:133], v54 offset:2048
v_mfma_f32_16x16x16_bf16 v[184:187], v[136:137], a[108:109], v[184:187]
v_accvgpr_write_b32 a100, v168
v_accvgpr_write_b32 a101, v169
v_mfma_f32_16x16x16_bf16 v[188:191], v[138:139], a[110:111], v[188:191]
v_accvgpr_write_b32 a102, v172
v_accvgpr_write_b32 a103, v173
s_waitcnt lgkmcnt(4)
v_mfma_f32_16x16x16_bf16 v[160:163], v[148:149], v[68:69], 0
v_cvt_pk_bf16_f32 v176, v176, v177
v_cvt_pk_bf16_f32 v177, v178, v179
v_mfma_f32_16x16x16_bf16 v[164:167], v[148:149], v[70:71], 0
v_cvt_pk_bf16_f32 v180, v180, v181
v_cvt_pk_bf16_f32 v181, v182, v183
ds_read_b128 v[136:139], v53 offset:4624
v_mfma_f32_16x16x16_bf16 v[160:163], v[144:145], a[112:113], v[160:163]
v_accvgpr_write_b32 a104, v176
v_accvgpr_write_b32 a105, v177
v_mfma_f32_16x16x16_bf16 v[164:167], v[146:147], a[114:115], v[164:167]
v_accvgpr_write_b32 a106, v180
v_accvgpr_write_b32 a107, v181
v_mfma_f32_16x16x16_bf16 v[168:171], v[148:149], v[72:73], 0
v_cvt_pk_bf16_f32 v184, v184, v185
v_cvt_pk_bf16_f32 v185, v186, v187
v_mfma_f32_16x16x16_bf16 v[172:175], v[148:149], v[74:75], 0
v_cvt_pk_bf16_f32 v188, v188, v189
v_cvt_pk_bf16_f32 v189, v190, v191
ds_read_b64 v[140:141], v54 offset:2176
v_mfma_f32_16x16x16_bf16 v[168:171], v[144:145], a[116:117], v[168:171]
v_accvgpr_write_b32 a108, v184
v_accvgpr_write_b32 a109, v185
v_mfma_f32_16x16x16_bf16 v[172:175], v[146:147], a[118:119], v[172:175]
v_accvgpr_write_b32 a110, v188
v_accvgpr_write_b32 a111, v189
s_waitcnt lgkmcnt(4)
v_mfma_f32_16x16x16_bf16 v[176:179], v[156:157], v[68:69], 0
v_cvt_pk_bf16_f32 v160, v160, v161
v_cvt_pk_bf16_f32 v161, v162, v163
v_mfma_f32_16x16x16_bf16 v[180:183], v[156:157], v[70:71], 0
v_cvt_pk_bf16_f32 v164, v164, v165
v_cvt_pk_bf16_f32 v165, v166, v167
ds_read_b128 v[144:147], v53 offset:4896
v_mfma_f32_16x16x16_bf16 v[176:179], v[152:153], a[120:121], v[176:179]
v_accvgpr_write_b32 a112, v160
v_accvgpr_write_b32 a113, v161
v_mfma_f32_16x16x16_bf16 v[180:183], v[154:155], a[122:123], v[180:183]
v_accvgpr_write_b32 a114, v164
v_accvgpr_write_b32 a115, v165
v_mfma_f32_16x16x16_bf16 v[184:187], v[156:157], v[72:73], 0
v_cvt_pk_bf16_f32 v168, v168, v169
v_cvt_pk_bf16_f32 v169, v170, v171
v_mfma_f32_16x16x16_bf16 v[188:191], v[156:157], v[74:75], 0
v_cvt_pk_bf16_f32 v172, v172, v173
v_cvt_pk_bf16_f32 v173, v174, v175
ds_read_b64 v[148:149], v54 offset:2304
v_mfma_f32_16x16x16_bf16 v[184:187], v[152:153], a[124:125], v[184:187]
v_accvgpr_write_b32 a116, v168
v_accvgpr_write_b32 a117, v169
v_mfma_f32_16x16x16_bf16 v[188:191], v[154:155], a[126:127], v[188:191]
v_accvgpr_write_b32 a118, v172
v_accvgpr_write_b32 a119, v173
s_waitcnt lgkmcnt(4)
v_mfma_f32_16x16x16_bf16 v[160:163], v[132:133], v[68:69], 0
v_cvt_pk_bf16_f32 v176, v176, v177
v_cvt_pk_bf16_f32 v177, v178, v179
v_mfma_f32_16x16x16_bf16 v[164:167], v[132:133], v[70:71], 0
v_cvt_pk_bf16_f32 v180, v180, v181
v_cvt_pk_bf16_f32 v181, v182, v183
ds_read_b128 v[152:155], v53 offset:5168
v_mfma_f32_16x16x16_bf16 v[160:163], v[128:129], a[128:129], v[160:163]
v_accvgpr_write_b32 a120, v176
v_accvgpr_write_b32 a121, v177
v_mfma_f32_16x16x16_bf16 v[164:167], v[130:131], a[130:131], v[164:167]
v_accvgpr_write_b32 a122, v180
v_accvgpr_write_b32 a123, v181
v_mfma_f32_16x16x16_bf16 v[168:171], v[132:133], v[72:73], 0
v_cvt_pk_bf16_f32 v184, v184, v185
v_cvt_pk_bf16_f32 v185, v186, v187
v_mfma_f32_16x16x16_bf16 v[172:175], v[132:133], v[74:75], 0
v_cvt_pk_bf16_f32 v188, v188, v189
v_cvt_pk_bf16_f32 v189, v190, v191
ds_read_b64 v[156:157], v54 offset:2432
v_mfma_f32_16x16x16_bf16 v[168:171], v[128:129], a[132:133], v[168:171]
v_accvgpr_write_b32 a124, v184
v_accvgpr_write_b32 a125, v185
v_mfma_f32_16x16x16_bf16 v[172:175], v[130:131], a[134:135], v[172:175]
v_accvgpr_write_b32 a126, v188
v_accvgpr_write_b32 a127, v189
s_waitcnt lgkmcnt(4)
v_mfma_f32_16x16x16_bf16 v[176:179], v[140:141], v[68:69], 0
v_cvt_pk_bf16_f32 v160, v160, v161
v_cvt_pk_bf16_f32 v161, v162, v163
v_mfma_f32_16x16x16_bf16 v[180:183], v[140:141], v[70:71], 0
v_cvt_pk_bf16_f32 v164, v164, v165
v_cvt_pk_bf16_f32 v165, v166, v167
ds_read_b128 v[128:131], v53 offset:5440
v_mfma_f32_16x16x16_bf16 v[176:179], v[136:137], a[136:137], v[176:179]
v_accvgpr_write_b32 a128, v160
v_accvgpr_write_b32 a129, v161
v_mfma_f32_16x16x16_bf16 v[180:183], v[138:139], a[138:139], v[180:183]
v_accvgpr_write_b32 a130, v164
v_accvgpr_write_b32 a131, v165
v_mfma_f32_16x16x16_bf16 v[184:187], v[140:141], v[72:73], 0
v_cvt_pk_bf16_f32 v168, v168, v169
v_cvt_pk_bf16_f32 v169, v170, v171
v_mfma_f32_16x16x16_bf16 v[188:191], v[140:141], v[74:75], 0
v_cvt_pk_bf16_f32 v172, v172, v173
v_cvt_pk_bf16_f32 v173, v174, v175
ds_read_b64 v[132:133], v54 offset:2560
v_mfma_f32_16x16x16_bf16 v[184:187], v[136:137], a[140:141], v[184:187]
v_accvgpr_write_b32 a132, v168
v_accvgpr_write_b32 a133, v169
v_mfma_f32_16x16x16_bf16 v[188:191], v[138:139], a[142:143], v[188:191]
v_accvgpr_write_b32 a134, v172
v_accvgpr_write_b32 a135, v173
s_waitcnt lgkmcnt(4)
v_mfma_f32_16x16x16_bf16 v[160:163], v[148:149], v[68:69], 0
v_cvt_pk_bf16_f32 v176, v176, v177
v_cvt_pk_bf16_f32 v177, v178, v179
v_mfma_f32_16x16x16_bf16 v[164:167], v[148:149], v[70:71], 0
v_cvt_pk_bf16_f32 v180, v180, v181
v_cvt_pk_bf16_f32 v181, v182, v183
ds_read_b128 v[136:139], v53 offset:5712
v_mfma_f32_16x16x16_bf16 v[160:163], v[144:145], a[144:145], v[160:163]
v_accvgpr_write_b32 a136, v176
v_accvgpr_write_b32 a137, v177
v_mfma_f32_16x16x16_bf16 v[164:167], v[146:147], a[146:147], v[164:167]
v_accvgpr_write_b32 a138, v180
v_accvgpr_write_b32 a139, v181
v_mfma_f32_16x16x16_bf16 v[168:171], v[148:149], v[72:73], 0
v_cvt_pk_bf16_f32 v184, v184, v185
v_cvt_pk_bf16_f32 v185, v186, v187
v_mfma_f32_16x16x16_bf16 v[172:175], v[148:149], v[74:75], 0
v_cvt_pk_bf16_f32 v188, v188, v189
v_cvt_pk_bf16_f32 v189, v190, v191
ds_read_b64 v[140:141], v54 offset:2688
v_mfma_f32_16x16x16_bf16 v[168:171], v[144:145], a[148:149], v[168:171]
v_accvgpr_write_b32 a140, v184
v_accvgpr_write_b32 a141, v185
v_mfma_f32_16x16x16_bf16 v[172:175], v[146:147], a[150:151], v[172:175]
v_accvgpr_write_b32 a142, v188
v_accvgpr_write_b32 a143, v189
s_waitcnt lgkmcnt(4)
v_mfma_f32_16x16x16_bf16 v[176:179], v[156:157], v[68:69], 0
v_cvt_pk_bf16_f32 v160, v160, v161
v_cvt_pk_bf16_f32 v161, v162, v163
v_mfma_f32_16x16x16_bf16 v[180:183], v[156:157], v[70:71], 0
v_cvt_pk_bf16_f32 v164, v164, v165
v_cvt_pk_bf16_f32 v165, v166, v167
ds_read_b128 v[144:147], v53 offset:5984
v_mfma_f32_16x16x16_bf16 v[176:179], v[152:153], a[152:153], v[176:179]
v_accvgpr_write_b32 a144, v160
v_accvgpr_write_b32 a145, v161
v_mfma_f32_16x16x16_bf16 v[180:183], v[154:155], a[154:155], v[180:183]
v_accvgpr_write_b32 a146, v164
v_accvgpr_write_b32 a147, v165
v_mfma_f32_16x16x16_bf16 v[184:187], v[156:157], v[72:73], 0
v_cvt_pk_bf16_f32 v168, v168, v169
v_cvt_pk_bf16_f32 v169, v170, v171
v_mfma_f32_16x16x16_bf16 v[188:191], v[156:157], v[74:75], 0
v_cvt_pk_bf16_f32 v172, v172, v173
v_cvt_pk_bf16_f32 v173, v174, v175
ds_read_b64 v[148:149], v54 offset:2816
v_mfma_f32_16x16x16_bf16 v[184:187], v[152:153], a[156:157], v[184:187]
v_accvgpr_write_b32 a148, v168
v_accvgpr_write_b32 a149, v169
v_mfma_f32_16x16x16_bf16 v[188:191], v[154:155], a[158:159], v[188:191]
v_accvgpr_write_b32 a150, v172
v_accvgpr_write_b32 a151, v173
s_waitcnt lgkmcnt(4)
v_mfma_f32_16x16x16_bf16 v[160:163], v[132:133], v[68:69], 0
v_cvt_pk_bf16_f32 v176, v176, v177
v_cvt_pk_bf16_f32 v177, v178, v179
v_mfma_f32_16x16x16_bf16 v[164:167], v[132:133], v[70:71], 0
v_cvt_pk_bf16_f32 v180, v180, v181
v_cvt_pk_bf16_f32 v181, v182, v183
ds_read_b128 v[152:155], v53 offset:6256
v_mfma_f32_16x16x16_bf16 v[160:163], v[128:129], a[160:161], v[160:163]
v_accvgpr_write_b32 a152, v176
v_accvgpr_write_b32 a153, v177
v_mfma_f32_16x16x16_bf16 v[164:167], v[130:131], a[162:163], v[164:167]
v_accvgpr_write_b32 a154, v180
v_accvgpr_write_b32 a155, v181
v_mfma_f32_16x16x16_bf16 v[168:171], v[132:133], v[72:73], 0
v_cvt_pk_bf16_f32 v184, v184, v185
v_cvt_pk_bf16_f32 v185, v186, v187
v_mfma_f32_16x16x16_bf16 v[172:175], v[132:133], v[74:75], 0
v_cvt_pk_bf16_f32 v188, v188, v189
v_cvt_pk_bf16_f32 v189, v190, v191
ds_read_b64 v[156:157], v54 offset:2944
v_mfma_f32_16x16x16_bf16 v[168:171], v[128:129], a[164:165], v[168:171]
v_accvgpr_write_b32 a156, v184
v_accvgpr_write_b32 a157, v185
v_mfma_f32_16x16x16_bf16 v[172:175], v[130:131], a[166:167], v[172:175]
v_accvgpr_write_b32 a158, v188
v_accvgpr_write_b32 a159, v189
s_waitcnt lgkmcnt(4)
v_mfma_f32_16x16x16_bf16 v[176:179], v[140:141], v[68:69], 0
v_cvt_pk_bf16_f32 v160, v160, v161
v_cvt_pk_bf16_f32 v161, v162, v163
v_mfma_f32_16x16x16_bf16 v[180:183], v[140:141], v[70:71], 0
v_cvt_pk_bf16_f32 v164, v164, v165
v_cvt_pk_bf16_f32 v165, v166, v167
ds_read_b128 v[128:131], v53 offset:6528
v_mfma_f32_16x16x16_bf16 v[176:179], v[136:137], a[168:169], v[176:179]
v_accvgpr_write_b32 a160, v160
v_accvgpr_write_b32 a161, v161
v_mfma_f32_16x16x16_bf16 v[180:183], v[138:139], a[170:171], v[180:183]
v_accvgpr_write_b32 a162, v164
v_accvgpr_write_b32 a163, v165
v_mfma_f32_16x16x16_bf16 v[184:187], v[140:141], v[72:73], 0
v_cvt_pk_bf16_f32 v168, v168, v169
v_cvt_pk_bf16_f32 v169, v170, v171
v_mfma_f32_16x16x16_bf16 v[188:191], v[140:141], v[74:75], 0
v_cvt_pk_bf16_f32 v172, v172, v173
v_cvt_pk_bf16_f32 v173, v174, v175
ds_read_b64 v[132:133], v54 offset:3072
v_mfma_f32_16x16x16_bf16 v[184:187], v[136:137], a[172:173], v[184:187]
v_accvgpr_write_b32 a164, v168
v_accvgpr_write_b32 a165, v169
v_mfma_f32_16x16x16_bf16 v[188:191], v[138:139], a[174:175], v[188:191]
v_accvgpr_write_b32 a166, v172
v_accvgpr_write_b32 a167, v173
s_waitcnt lgkmcnt(4)
v_mfma_f32_16x16x16_bf16 v[160:163], v[148:149], v[68:69], 0
v_cvt_pk_bf16_f32 v176, v176, v177
v_cvt_pk_bf16_f32 v177, v178, v179
v_mfma_f32_16x16x16_bf16 v[164:167], v[148:149], v[70:71], 0
v_cvt_pk_bf16_f32 v180, v180, v181
v_cvt_pk_bf16_f32 v181, v182, v183
ds_read_b128 v[136:139], v53 offset:6800
v_mfma_f32_16x16x16_bf16 v[160:163], v[144:145], a[176:177], v[160:163]
v_accvgpr_write_b32 a168, v176
v_accvgpr_write_b32 a169, v177
v_mfma_f32_16x16x16_bf16 v[164:167], v[146:147], a[178:179], v[164:167]
v_accvgpr_write_b32 a170, v180
v_accvgpr_write_b32 a171, v181
v_mfma_f32_16x16x16_bf16 v[168:171], v[148:149], v[72:73], 0
v_cvt_pk_bf16_f32 v184, v184, v185
v_cvt_pk_bf16_f32 v185, v186, v187
v_mfma_f32_16x16x16_bf16 v[172:175], v[148:149], v[74:75], 0
v_cvt_pk_bf16_f32 v188, v188, v189
v_cvt_pk_bf16_f32 v189, v190, v191
ds_read_b64 v[140:141], v54 offset:3200
v_mfma_f32_16x16x16_bf16 v[168:171], v[144:145], a[180:181], v[168:171]
v_accvgpr_write_b32 a172, v184
v_accvgpr_write_b32 a173, v185
v_mfma_f32_16x16x16_bf16 v[172:175], v[146:147], a[182:183], v[172:175]
v_accvgpr_write_b32 a174, v188
v_accvgpr_write_b32 a175, v189
s_waitcnt lgkmcnt(4)
v_mfma_f32_16x16x16_bf16 v[176:179], v[156:157], v[68:69], 0
v_cvt_pk_bf16_f32 v160, v160, v161
v_cvt_pk_bf16_f32 v161, v162, v163
v_mfma_f32_16x16x16_bf16 v[180:183], v[156:157], v[70:71], 0
v_cvt_pk_bf16_f32 v164, v164, v165
v_cvt_pk_bf16_f32 v165, v166, v167
ds_read_b128 v[144:147], v53 offset:7072
v_mfma_f32_16x16x16_bf16 v[176:179], v[152:153], a[184:185], v[176:179]
v_accvgpr_write_b32 a176, v160
v_accvgpr_write_b32 a177, v161
v_mfma_f32_16x16x16_bf16 v[180:183], v[154:155], a[186:187], v[180:183]
v_accvgpr_write_b32 a178, v164
v_accvgpr_write_b32 a179, v165
v_mfma_f32_16x16x16_bf16 v[184:187], v[156:157], v[72:73], 0
v_cvt_pk_bf16_f32 v168, v168, v169
v_cvt_pk_bf16_f32 v169, v170, v171
v_mfma_f32_16x16x16_bf16 v[188:191], v[156:157], v[74:75], 0
v_cvt_pk_bf16_f32 v172, v172, v173
v_cvt_pk_bf16_f32 v173, v174, v175
ds_read_b64 v[148:149], v54 offset:3328
v_mfma_f32_16x16x16_bf16 v[184:187], v[152:153], a[188:189], v[184:187]
v_accvgpr_write_b32 a180, v168
v_accvgpr_write_b32 a181, v169
v_mfma_f32_16x16x16_bf16 v[188:191], v[154:155], a[190:191], v[188:191]
v_accvgpr_write_b32 a182, v172
v_accvgpr_write_b32 a183, v173
s_waitcnt lgkmcnt(4)
v_mfma_f32_16x16x16_bf16 v[160:163], v[132:133], v[68:69], 0
v_cvt_pk_bf16_f32 v176, v176, v177
v_cvt_pk_bf16_f32 v177, v178, v179
v_mfma_f32_16x16x16_bf16 v[164:167], v[132:133], v[70:71], 0
v_cvt_pk_bf16_f32 v180, v180, v181
v_cvt_pk_bf16_f32 v181, v182, v183
ds_read_b128 v[152:155], v53 offset:7344
v_mfma_f32_16x16x16_bf16 v[160:163], v[128:129], a[192:193], v[160:163]
v_accvgpr_write_b32 a184, v176
v_accvgpr_write_b32 a185, v177
v_mfma_f32_16x16x16_bf16 v[164:167], v[130:131], a[194:195], v[164:167]
v_accvgpr_write_b32 a186, v180
v_accvgpr_write_b32 a187, v181
v_mfma_f32_16x16x16_bf16 v[168:171], v[132:133], v[72:73], 0
v_cvt_pk_bf16_f32 v184, v184, v185
v_cvt_pk_bf16_f32 v185, v186, v187
v_mfma_f32_16x16x16_bf16 v[172:175], v[132:133], v[74:75], 0
v_cvt_pk_bf16_f32 v188, v188, v189
v_cvt_pk_bf16_f32 v189, v190, v191
ds_read_b64 v[156:157], v54 offset:3456
v_mfma_f32_16x16x16_bf16 v[168:171], v[128:129], a[196:197], v[168:171]
v_accvgpr_write_b32 a188, v184
v_accvgpr_write_b32 a189, v185
v_mfma_f32_16x16x16_bf16 v[172:175], v[130:131], a[198:199], v[172:175]
v_accvgpr_write_b32 a190, v188
v_accvgpr_write_b32 a191, v189
s_waitcnt lgkmcnt(4)
v_mfma_f32_16x16x16_bf16 v[176:179], v[140:141], v[68:69], 0
v_cvt_pk_bf16_f32 v160, v160, v161
v_cvt_pk_bf16_f32 v161, v162, v163
v_mfma_f32_16x16x16_bf16 v[180:183], v[140:141], v[70:71], 0
v_cvt_pk_bf16_f32 v164, v164, v165
v_cvt_pk_bf16_f32 v165, v166, v167
ds_read_b128 v[128:131], v53 offset:7616
v_mfma_f32_16x16x16_bf16 v[176:179], v[136:137], a[200:201], v[176:179]
v_accvgpr_write_b32 a192, v160
v_accvgpr_write_b32 a193, v161
v_mfma_f32_16x16x16_bf16 v[180:183], v[138:139], a[202:203], v[180:183]
v_accvgpr_write_b32 a194, v164
v_accvgpr_write_b32 a195, v165
v_mfma_f32_16x16x16_bf16 v[184:187], v[140:141], v[72:73], 0
v_cvt_pk_bf16_f32 v168, v168, v169
v_cvt_pk_bf16_f32 v169, v170, v171
v_mfma_f32_16x16x16_bf16 v[188:191], v[140:141], v[74:75], 0
v_cvt_pk_bf16_f32 v172, v172, v173
v_cvt_pk_bf16_f32 v173, v174, v175
ds_read_b64 v[132:133], v54 offset:3584
v_mfma_f32_16x16x16_bf16 v[184:187], v[136:137], a[204:205], v[184:187]
v_accvgpr_write_b32 a196, v168
v_accvgpr_write_b32 a197, v169
v_mfma_f32_16x16x16_bf16 v[188:191], v[138:139], a[206:207], v[188:191]
v_accvgpr_write_b32 a198, v172
v_accvgpr_write_b32 a199, v173
s_waitcnt lgkmcnt(4)
v_mfma_f32_16x16x16_bf16 v[160:163], v[148:149], v[68:69], 0
v_cvt_pk_bf16_f32 v176, v176, v177
v_cvt_pk_bf16_f32 v177, v178, v179
v_mfma_f32_16x16x16_bf16 v[164:167], v[148:149], v[70:71], 0
v_cvt_pk_bf16_f32 v180, v180, v181
v_cvt_pk_bf16_f32 v181, v182, v183
ds_read_b128 v[136:139], v53 offset:7888
v_mfma_f32_16x16x16_bf16 v[160:163], v[144:145], a[208:209], v[160:163]
v_accvgpr_write_b32 a200, v176
v_accvgpr_write_b32 a201, v177
v_mfma_f32_16x16x16_bf16 v[164:167], v[146:147], a[210:211], v[164:167]
v_accvgpr_write_b32 a202, v180
v_accvgpr_write_b32 a203, v181
v_mfma_f32_16x16x16_bf16 v[168:171], v[148:149], v[72:73], 0
v_cvt_pk_bf16_f32 v184, v184, v185
v_cvt_pk_bf16_f32 v185, v186, v187
v_mfma_f32_16x16x16_bf16 v[172:175], v[148:149], v[74:75], 0
v_cvt_pk_bf16_f32 v188, v188, v189
v_cvt_pk_bf16_f32 v189, v190, v191
ds_read_b64 v[140:141], v54 offset:3712
v_mfma_f32_16x16x16_bf16 v[168:171], v[144:145], a[212:213], v[168:171]
v_accvgpr_write_b32 a204, v184
v_accvgpr_write_b32 a205, v185
v_mfma_f32_16x16x16_bf16 v[172:175], v[146:147], a[214:215], v[172:175]
v_accvgpr_write_b32 a206, v188
v_accvgpr_write_b32 a207, v189
s_waitcnt lgkmcnt(4)
v_mfma_f32_16x16x16_bf16 v[176:179], v[156:157], v[68:69], 0
v_cvt_pk_bf16_f32 v160, v160, v161
v_cvt_pk_bf16_f32 v161, v162, v163
v_mfma_f32_16x16x16_bf16 v[180:183], v[156:157], v[70:71], 0
v_cvt_pk_bf16_f32 v164, v164, v165
v_cvt_pk_bf16_f32 v165, v166, v167
ds_read_b128 v[144:147], v53 offset:8160
v_mfma_f32_16x16x16_bf16 v[176:179], v[152:153], a[216:217], v[176:179]
v_accvgpr_write_b32 a208, v160
v_accvgpr_write_b32 a209, v161
v_mfma_f32_16x16x16_bf16 v[180:183], v[154:155], a[218:219], v[180:183]
v_accvgpr_write_b32 a210, v164
v_accvgpr_write_b32 a211, v165
v_mfma_f32_16x16x16_bf16 v[184:187], v[156:157], v[72:73], 0
v_cvt_pk_bf16_f32 v168, v168, v169
v_cvt_pk_bf16_f32 v169, v170, v171
v_mfma_f32_16x16x16_bf16 v[188:191], v[156:157], v[74:75], 0
v_cvt_pk_bf16_f32 v172, v172, v173
v_cvt_pk_bf16_f32 v173, v174, v175
ds_read_b64 v[148:149], v54 offset:3840
v_mfma_f32_16x16x16_bf16 v[184:187], v[152:153], a[220:221], v[184:187]
v_accvgpr_write_b32 a212, v168
v_accvgpr_write_b32 a213, v169
v_mfma_f32_16x16x16_bf16 v[188:191], v[154:155], a[222:223], v[188:191]
v_accvgpr_write_b32 a214, v172
v_accvgpr_write_b32 a215, v173
s_waitcnt lgkmcnt(4)
v_mfma_f32_16x16x16_bf16 v[160:163], v[132:133], v[68:69], 0
v_cvt_pk_bf16_f32 v176, v176, v177
v_cvt_pk_bf16_f32 v177, v178, v179
v_mfma_f32_16x16x16_bf16 v[164:167], v[132:133], v[70:71], 0
v_cvt_pk_bf16_f32 v180, v180, v181
v_cvt_pk_bf16_f32 v181, v182, v183
ds_read_b128 v[152:155], v53 offset:8432
v_mfma_f32_16x16x16_bf16 v[160:163], v[128:129], a[224:225], v[160:163]
v_accvgpr_write_b32 a216, v176
v_accvgpr_write_b32 a217, v177
v_mfma_f32_16x16x16_bf16 v[164:167], v[130:131], a[226:227], v[164:167]
v_accvgpr_write_b32 a218, v180
v_accvgpr_write_b32 a219, v181
v_mfma_f32_16x16x16_bf16 v[168:171], v[132:133], v[72:73], 0
v_cvt_pk_bf16_f32 v184, v184, v185
v_cvt_pk_bf16_f32 v185, v186, v187
v_mfma_f32_16x16x16_bf16 v[172:175], v[132:133], v[74:75], 0
v_cvt_pk_bf16_f32 v188, v188, v189
v_cvt_pk_bf16_f32 v189, v190, v191
ds_read_b64 v[156:157], v54 offset:3968
v_mfma_f32_16x16x16_bf16 v[168:171], v[128:129], a[228:229], v[168:171]
v_accvgpr_write_b32 a220, v184
v_accvgpr_write_b32 a221, v185
v_mfma_f32_16x16x16_bf16 v[172:175], v[130:131], a[230:231], v[172:175]
v_accvgpr_write_b32 a222, v188
v_accvgpr_write_b32 a223, v189
s_waitcnt lgkmcnt(4)
v_mfma_f32_16x16x16_bf16 v[176:179], v[140:141], v[68:69], 0
v_cvt_pk_bf16_f32 v160, v160, v161
v_cvt_pk_bf16_f32 v161, v162, v163
v_mfma_f32_16x16x16_bf16 v[180:183], v[140:141], v[70:71], 0
v_cvt_pk_bf16_f32 v164, v164, v165
v_cvt_pk_bf16_f32 v165, v166, v167
v_mfma_f32_16x16x16_bf16 v[176:179], v[136:137], a[232:233], v[176:179]
v_accvgpr_write_b32 a224, v160
v_accvgpr_write_b32 a225, v161
v_mfma_f32_16x16x16_bf16 v[180:183], v[138:139], a[234:235], v[180:183]
v_accvgpr_write_b32 a226, v164
v_accvgpr_write_b32 a227, v165
v_mfma_f32_16x16x16_bf16 v[184:187], v[140:141], v[72:73], 0
v_cvt_pk_bf16_f32 v168, v168, v169
v_cvt_pk_bf16_f32 v169, v170, v171
v_mfma_f32_16x16x16_bf16 v[188:191], v[140:141], v[74:75], 0
v_cvt_pk_bf16_f32 v172, v172, v173
v_cvt_pk_bf16_f32 v173, v174, v175
v_mfma_f32_16x16x16_bf16 v[184:187], v[136:137], a[236:237], v[184:187]
v_accvgpr_write_b32 a228, v168
v_accvgpr_write_b32 a229, v169
v_mfma_f32_16x16x16_bf16 v[188:191], v[138:139], a[238:239], v[188:191]
v_accvgpr_write_b32 a230, v172
v_accvgpr_write_b32 a231, v173
s_waitcnt lgkmcnt(2)
v_mfma_f32_16x16x16_bf16 v[160:163], v[148:149], v[68:69], 0
v_cvt_pk_bf16_f32 v176, v176, v177
v_cvt_pk_bf16_f32 v177, v178, v179
v_mfma_f32_16x16x16_bf16 v[164:167], v[148:149], v[70:71], 0
v_cvt_pk_bf16_f32 v180, v180, v181
v_cvt_pk_bf16_f32 v181, v182, v183
v_mfma_f32_16x16x16_bf16 v[160:163], v[144:145], a[240:241], v[160:163]
v_accvgpr_write_b32 a232, v176
v_accvgpr_write_b32 a233, v177
v_mfma_f32_16x16x16_bf16 v[164:167], v[146:147], a[242:243], v[164:167]
v_accvgpr_write_b32 a234, v180
v_accvgpr_write_b32 a235, v181
v_mfma_f32_16x16x16_bf16 v[168:171], v[148:149], v[72:73], 0
v_cvt_pk_bf16_f32 v184, v184, v185
v_cvt_pk_bf16_f32 v185, v186, v187
v_mfma_f32_16x16x16_bf16 v[172:175], v[148:149], v[74:75], 0
v_cvt_pk_bf16_f32 v188, v188, v189
v_cvt_pk_bf16_f32 v189, v190, v191
v_mfma_f32_16x16x16_bf16 v[168:171], v[144:145], a[244:245], v[168:171]
v_accvgpr_write_b32 a236, v184
v_accvgpr_write_b32 a237, v185
v_mfma_f32_16x16x16_bf16 v[172:175], v[146:147], a[246:247], v[172:175]
v_accvgpr_write_b32 a238, v188
v_accvgpr_write_b32 a239, v189
s_waitcnt lgkmcnt(0)
v_mfma_f32_16x16x16_bf16 v[176:179], v[156:157], v[68:69], 0
v_cvt_pk_bf16_f32 v160, v160, v161
v_cvt_pk_bf16_f32 v161, v162, v163
v_mfma_f32_16x16x16_bf16 v[180:183], v[156:157], v[70:71], 0
v_cvt_pk_bf16_f32 v164, v164, v165
v_cvt_pk_bf16_f32 v165, v166, v167
v_mfma_f32_16x16x16_bf16 v[176:179], v[152:153], a[248:249], v[176:179]
v_accvgpr_write_b32 a240, v160
v_accvgpr_write_b32 a241, v161
v_mfma_f32_16x16x16_bf16 v[180:183], v[154:155], a[250:251], v[180:183]
v_accvgpr_write_b32 a242, v164
v_accvgpr_write_b32 a243, v165
v_mfma_f32_16x16x16_bf16 v[184:187], v[156:157], v[72:73], 0
v_cvt_pk_bf16_f32 v168, v168, v169
v_cvt_pk_bf16_f32 v169, v170, v171
v_mfma_f32_16x16x16_bf16 v[188:191], v[156:157], v[74:75], 0
v_cvt_pk_bf16_f32 v172, v172, v173
v_cvt_pk_bf16_f32 v173, v174, v175
v_mfma_f32_16x16x16_bf16 v[184:187], v[152:153], a[252:253], v[184:187]
v_accvgpr_write_b32 a244, v168
v_accvgpr_write_b32 a245, v169
v_mfma_f32_16x16x16_bf16 v[188:191], v[154:155], a[254:255], v[188:191]
v_accvgpr_write_b32 a246, v172
v_accvgpr_write_b32 a247, v173
v_cvt_pk_bf16_f32 v176, v176, v177
v_cvt_pk_bf16_f32 v177, v178, v179
v_cvt_pk_bf16_f32 v180, v180, v181
v_cvt_pk_bf16_f32 v181, v182, v183
v_accvgpr_write_b32 a248, v176
v_accvgpr_write_b32 a249, v177
v_accvgpr_write_b32 a250, v180
v_accvgpr_write_b32 a251, v181
v_cvt_pk_bf16_f32 v184, v184, v185
v_cvt_pk_bf16_f32 v185, v186, v187
v_cvt_pk_bf16_f32 v188, v188, v189
v_cvt_pk_bf16_f32 v189, v190, v191
v_accvgpr_write_b32 a252, v184
v_accvgpr_write_b32 a253, v185
v_accvgpr_write_b32 a254, v188
v_accvgpr_write_b32 a255, v189
s_and_b32 s79, s74, 12
s_add_u32 s79, s79, s72
s_lshl_b32 s78, s73, 4
s_add_u32 s78, s78, s79
s_lshl_b32 s78, s78, 10
s_add_u32 s78, s78, 33536
v_mov_b32 v53, s96
v_writelane_b32 v53, s78, 0
s_add_u32 s78, s78, 128
v_mov_b32 v54, s96
v_writelane_b32 v54, s78, 0
v_writelane_b32 v50, 4, 0
s_barrier
ds_read_b64_tr_b16 v[96:97], v10 offset:32768
ds_read_b64_tr_b16 v[98:99], v10 offset:49152
ds_read_b64_tr_b16 v[100:101], v11 offset:32768
ds_read_b64_tr_b16 v[102:103], v11 offset:49152
ds_read_b64_tr_b16 v[104:105], v12 offset:32768
ds_read_b64_tr_b16 v[106:107], v12 offset:49152
ds_read_b64_tr_b16 v[108:109], v13 offset:32768
ds_read_b64_tr_b16 v[110:111], v13 offset:49152
ds_read_b64_tr_b16 v[112:113], v10 offset:33792
ds_read_b64_tr_b16 v[114:115], v10 offset:50176
ds_read_b64_tr_b16 v[116:117], v11 offset:33792
ds_read_b64_tr_b16 v[118:119], v11 offset:50176
ds_read_b64_tr_b16 v[120:121], v12 offset:33792
ds_read_b64_tr_b16 v[122:123], v12 offset:50176
ds_read_b64_tr_b16 v[124:125], v13 offset:33792
ds_read_b64_tr_b16 v[126:127], v13 offset:50176
S_G0:
s_waitcnt lgkmcnt(14)
v_mfma_f32_16x16x32_bf16 v[128:131], v[96:99], a[0:3], 0
s_add_u32 m0, s76, 0
s_add_u32 s77, s84, 0x540000
v_mfma_f32_16x16x32_bf16 v[144:147], v[96:99], a[4:7], 0
ds_read_b64_tr_b16 v[80:81], v10 offset:34816
s_waitcnt lgkmcnt(13)
v_mfma_f32_16x16x32_bf16 v[132:135], v[100:103], a[0:3], 0
buffer_load_dwordx4 v30, s[40:43], s77 offen offset:0 lds
v_mfma_f32_16x16x32_bf16 v[148:151], v[100:103], a[4:7], 0
ds_read_b64_tr_b16 v[82:83], v10 offset:51200
s_waitcnt lgkmcnt(12)
v_mfma_f32_16x16x32_bf16 v[136:139], v[104:107], a[0:3], 0
ds_read_b64_tr_b16 v[84:85], v11 offset:34816
ds_read_b64_tr_b16 v[86:87], v11 offset:51200
v_mfma_f32_16x16x32_bf16 v[152:155], v[104:107], a[4:7], 0
ds_read_b64_tr_b16 v[88:89], v12 offset:34816
s_waitcnt lgkmcnt(13)
v_mfma_f32_16x16x32_bf16 v[140:143], v[108:111], a[0:3], 0
s_add_u32 s70, s0, S_U0 - K_pc + 0
s_addc_u32 s71, s1, 0
global_load_dword v57, v9, s[70:71]
v_mfma_f32_16x16x32_bf16 v[156:159], v[108:111], a[4:7], 0
ds_read_b64_tr_b16 v[90:91], v12 offset:51200
s_waitcnt lgkmcnt(6)
v_mfma_f32_16x16x32_bf16 v[128:131], v[112:115], a[8:11], v[128:131]
ds_read_b64_tr_b16 v[92:93], v13 offset:34816
ds_read_b64_tr_b16 v[94:95], v13 offset:51200
v_mfma_f32_16x16x32_bf16 v[144:147], v[112:115], a[12:15], v[144:147]
buffer_load_dwordx4 v31, s[40:43], s77 offen offset:1024 lds
v_mfma_f32_16x16x32_bf16 v[132:135], v[116:119], a[8:11], v[132:135]
ds_read_b64_tr_b16 v[96:97], v10 offset:35840
ds_read_b64_tr_b16 v[98:99], v10 offset:52224
v_mfma_f32_16x16x32_bf16 v[148:151], v[116:119], a[12:15], v[148:151]
s_mov_b32 s3, 0x0
ds_read_b64_tr_b16 v[100:101], v11 offset:35840
v_mfma_f32_16x16x32_bf16 v[136:139], v[120:123], a[8:11], v[136:139]
buffer_load_dword v57, v8, s[48:51], s3 offen
v_mfma_f32_16x16x32_bf16 v[152:155], v[120:123], a[12:15], v[152:155]
ds_read_b64_tr_b16 v[102:103], v11 offset:52224
ds_read_b64_tr_b16 v[104:105], v12 offset:35840
v_mfma_f32_16x16x32_bf16 v[140:143], v[124:127], a[8:11], v[140:143]
buffer_load_dwordx4 v32, s[40:43], s77 offen offset:2048 lds
v_mfma_f32_16x16x32_bf16 v[156:159], v[124:127], a[12:15], v[156:159]
ds_read_b64_tr_b16 v[106:107], v12 offset:52224
s_waitcnt lgkmcnt(6)
v_mfma_f32_16x16x32_bf16 v[128:131], v[80:83], a[16:19], v[128:131]
ds_read_b64_tr_b16 v[108:109], v13 offset:35840
ds_read_b64_tr_b16 v[110:111], v13 offset:52224
v_mfma_f32_16x16x32_bf16 v[144:147], v[80:83], a[20:23], v[144:147]
ds_read_b64_tr_b16 v[112:113], v10 offset:36864
v_mfma_f32_16x16x32_bf16 v[132:135], v[84:87], a[16:19], v[132:135]
ds_read_b64_tr_b16 v[114:115], v10 offset:53248
ds_read_b64_tr_b16 v[116:117], v11 offset:36864
v_mfma_f32_16x16x32_bf16 v[148:151], v[84:87], a[20:23], v[148:151]
buffer_load_dwordx4 v33, s[40:43], s77 offen offset:3072 lds
v_mfma_f32_16x16x32_bf16 v[136:139], v[88:91], a[16:19], v[136:139]
ds_read_b64_tr_b16 v[118:119], v11 offset:53248
ds_read_b64_tr_b16 v[120:121], v12 offset:36864
v_mfma_f32_16x16x32_bf16 v[152:155], v[88:91], a[20:23], v[152:155]
ds_read_b64_tr_b16 v[122:123], v12 offset:53248
v_mfma_f32_16x16x32_bf16 v[140:143], v[92:95], a[16:19], v[140:143]
ds_read_b64_tr_b16 v[124:125], v13 offset:36864
ds_read_b64_tr_b16 v[126:127], v13 offset:53248
v_mfma_f32_16x16x32_bf16 v[156:159], v[92:95], a[20:23], v[156:159]
ds_read_b64_tr_b16 v[80:81], v10 offset:37888
s_waitcnt lgkmcnt(9)
v_mfma_f32_16x16x32_bf16 v[128:131], v[96:99], a[24:27], v[128:131]
s_add_u32 m0, s76, 4096
s_add_u32 s77, s84, 0x620000
v_mfma_f32_16x16x32_bf16 v[144:147], v[96:99], a[28:31], v[144:147]
buffer_load_dwordx4 v30, s[40:43], s77 offen offset:0 lds
v_mfma_f32_16x16x32_bf16 v[132:135], v[100:103], a[24:27], v[132:135]
ds_read_b64_tr_b16 v[82:83], v10 offset:54272
ds_read_b64_tr_b16 v[84:85], v11 offset:37888
v_mfma_f32_16x16x32_bf16 v[148:151], v[100:103], a[28:31], v[148:151]
ds_read_b64_tr_b16 v[86:87], v11 offset:54272
v_mfma_f32_16x16x32_bf16 v[136:139], v[104:107], a[24:27], v[136:139]
ds_read_b64_tr_b16 v[88:89], v12 offset:37888
ds_read_b64_tr_b16 v[90:91], v12 offset:54272
v_mfma_f32_16x16x32_bf16 v[152:155], v[104:107], a[28:31], v[152:155]
ds_read_b64_tr_b16 v[92:93], v13 offset:37888
v_mfma_f32_16x16x32_bf16 v[140:143], v[108:111], a[24:27], v[140:143]
buffer_load_dwordx4 v31, s[40:43], s77 offen offset:1024 lds
v_mfma_f32_16x16x32_bf16 v[156:159], v[108:111], a[28:31], v[156:159]
ds_read_b64_tr_b16 v[94:95], v13 offset:54272
s_waitcnt lgkmcnt(7)
v_mfma_f32_16x16x32_bf16 v[128:131], v[112:115], a[32:35], v[128:131]
ds_read_b64_tr_b16 v[96:97], v10 offset:38912
ds_read_b64_tr_b16 v[98:99], v10 offset:55296
v_mfma_f32_16x16x32_bf16 v[144:147], v[112:115], a[36:39], v[144:147]
ds_read_b64_tr_b16 v[100:101], v11 offset:38912
v_mfma_f32_16x16x32_bf16 v[132:135], v[116:119], a[32:35], v[132:135]
ds_read_b64_tr_b16 v[102:103], v11 offset:55296
ds_read_b64_tr_b16 v[104:105], v12 offset:38912
v_mfma_f32_16x16x32_bf16 v[148:151], v[116:119], a[36:39], v[148:151]
buffer_load_dwordx4 v32, s[40:43], s77 offen offset:2048 lds
v_mfma_f32_16x16x32_bf16 v[136:139], v[120:123], a[32:35], v[136:139]
ds_read_b64_tr_b16 v[106:107], v12 offset:55296
ds_read_b64_tr_b16 v[108:109], v13 offset:38912
v_mfma_f32_16x16x32_bf16 v[152:155], v[120:123], a[36:39], v[152:155]
ds_read_b64_tr_b16 v[110:111], v13 offset:55296
v_mfma_f32_16x16x32_bf16 v[140:143], v[124:127], a[32:35], v[140:143]
ds_read_b64_tr_b16 v[112:113], v10 offset:39936
ds_read_b64_tr_b16 v[114:115], v10 offset:56320
v_mfma_f32_16x16x32_bf16 v[156:159], v[124:127], a[36:39], v[156:159]
ds_read_b64_tr_b16 v[116:117], v11 offset:39936
s_waitcnt lgkmcnt(9)
v_mfma_f32_16x16x32_bf16 v[128:131], v[80:83], a[40:43], v[128:131]
buffer_load_dwordx4 v33, s[40:43], s77 offen offset:3072 lds
v_mfma_f32_16x16x32_bf16 v[144:147], v[80:83], a[44:47], v[144:147]
ds_read_b64_tr_b16 v[118:119], v11 offset:56320
ds_read_b64_tr_b16 v[120:121], v12 offset:39936
v_mfma_f32_16x16x32_bf16 v[132:135], v[84:87], a[40:43], v[132:135]
ds_read_b64_tr_b16 v[122:123], v12 offset:56320
v_mfma_f32_16x16x32_bf16 v[148:151], v[84:87], a[44:47], v[148:151]
ds_read_b64_tr_b16 v[124:125], v13 offset:39936
ds_read_b64_tr_b16 v[126:127], v13 offset:56320
v_mfma_f32_16x16x32_bf16 v[136:139], v[88:91], a[40:43], v[136:139]
v_mfma_f32_16x16x32_bf16 v[152:155], v[88:91], a[44:47], v[152:155]
v_mfma_f32_16x16x32_bf16 v[140:143], v[92:95], a[40:43], v[140:143]
v_mfma_f32_16x16x32_bf16 v[156:159], v[92:95], a[44:47], v[156:159]
v_mfma_f32_16x16x32_bf16 v[128:131], v[96:99], a[48:51], v[128:131]
s_waitcnt lgkmcnt(0)
s_barrier
v_mfma_f32_16x16x32_bf16 v[144:147], v[96:99], a[52:55], v[144:147]
s_add_u32 m0, s76, 32768
s_add_u32 s77, s84, 0x0
v_mfma_f32_16x16x32_bf16 v[132:135], v[100:103], a[48:51], v[132:135]
ds_read_b64_tr_b16 v[80:81], v14 offset:0
ds_read_b64_tr_b16 v[82:83], v14 offset:16384
v_mfma_f32_16x16x32_bf16 v[148:151], v[100:103], a[52:55], v[148:151]
buffer_load_dwordx4 v30, s[44:47], s77 offen offset:0 lds
v_mfma_f32_16x16x32_bf16 v[136:139], v[104:107], a[48:51], v[136:139]
ds_read_b64_tr_b16 v[84:85], v15 offset:0
ds_read_b64_tr_b16 v[86:87], v15 offset:16384
v_mfma_f32_16x16x32_bf16 v[152:155], v[104:107], a[52:55], v[152:155]
ds_read_b64_tr_b16 v[88:89], v16 offset:0
v_mfma_f32_16x16x32_bf16 v[140:143], v[108:111], a[48:51], v[140:143]
ds_read_b64_tr_b16 v[90:91], v16 offset:16384
ds_read_b64_tr_b16 v[92:93], v17 offset:0
v_mfma_f32_16x16x32_bf16 v[156:159], v[108:111], a[52:55], v[156:159]
ds_read_b64_tr_b16 v[94:95], v17 offset:16384
v_mfma_f32_16x16x32_bf16 v[128:131], v[112:115], a[56:59], v[128:131]
buffer_load_dwordx4 v31, s[44:47], s77 offen offset:1024 lds
v_mfma_f32_16x16x32_bf16 v[144:147], v[112:115], a[60:63], v[144:147]
ds_read_b64_tr_b16 v[96:97], v14 offset:1024
ds_read_b64_tr_b16 v[98:99], v14 offset:17408
v_mfma_f32_16x16x32_bf16 v[132:135], v[116:119], a[56:59], v[132:135]
ds_read_b64_tr_b16 v[100:101], v15 offset:1024
v_mfma_f32_16x16x32_bf16 v[148:151], v[116:119], a[60:63], v[148:151]
ds_read_b64_tr_b16 v[102:103], v15 offset:17408
ds_read_b64_tr_b16 v[104:105], v16 offset:1024
v_mfma_f32_16x16x32_bf16 v[136:139], v[120:123], a[56:59], v[136:139]
ds_read_b64_tr_b16 v[106:107], v16 offset:17408
v_mfma_f32_16x16x32_bf16 v[152:155], v[120:123], a[60:63], v[152:155]
buffer_load_dwordx4 v32, s[44:47], s77 offen offset:2048 lds
v_mfma_f32_16x16x32_bf16 v[140:143], v[124:127], a[56:59], v[140:143]
ds_read_b64_tr_b16 v[108:109], v17 offset:1024
ds_read_b64_tr_b16 v[110:111], v17 offset:17408
v_mfma_f32_16x16x32_bf16 v[156:159], v[124:127], a[60:63], v[156:159]
ds_read_b64_tr_b16 v[112:113], v14 offset:2048
s_waitcnt lgkmcnt(9)
v_mfma_f32_16x16x32_bf16 v[128:131], v[80:83], a[64:67], v[128:131]
ds_read_b64_tr_b16 v[114:115], v14 offset:18432
ds_read_b64_tr_b16 v[116:117], v15 offset:2048
v_mfma_f32_16x16x32_bf16 v[144:147], v[80:83], a[68:71], v[144:147]
ds_read_b64_tr_b16 v[118:119], v15 offset:18432
v_mfma_f32_16x16x32_bf16 v[132:135], v[84:87], a[64:67], v[132:135]
buffer_load_dwordx4 v33, s[44:47], s77 offen offset:3072 lds
v_mfma_f32_16x16x32_bf16 v[148:151], v[84:87], a[68:71], v[148:151]
ds_read_b64_tr_b16 v[120:121], v16 offset:2048
ds_read_b64_tr_b16 v[122:123], v16 offset:18432
v_mfma_f32_16x16x32_bf16 v[136:139], v[88:91], a[64:67], v[136:139]
ds_read_b64_tr_b16 v[124:125], v17 offset:2048
v_mfma_f32_16x16x32_bf16 v[152:155], v[88:91], a[68:71], v[152:155]
ds_read_b64_tr_b16 v[126:127], v17 offset:18432
ds_read_b64_tr_b16 v[80:81], v14 offset:3072
v_mfma_f32_16x16x32_bf16 v[140:143], v[92:95], a[64:67], v[140:143]
ds_read_b64_tr_b16 v[82:83], v14 offset:19456
v_mfma_f32_16x16x32_bf16 v[156:159], v[92:95], a[68:71], v[156:159]
s_add_u32 m0, s76, 36864
s_waitcnt lgkmcnt(7)
v_mfma_f32_16x16x32_bf16 v[128:131], v[96:99], a[72:75], v[128:131]
s_add_u32 s77, s84, 0xe0000
ds_read_b64_tr_b16 v[84:85], v15 offset:3072
v_mfma_f32_16x16x32_bf16 v[144:147], v[96:99], a[76:79], v[144:147]
buffer_load_dwordx4 v30, s[44:47], s77 offen offset:0 lds
v_mfma_f32_16x16x32_bf16 v[132:135], v[100:103], a[72:75], v[132:135]
ds_read_b64_tr_b16 v[86:87], v15 offset:19456
ds_read_b64_tr_b16 v[88:89], v16 offset:3072
v_mfma_f32_16x16x32_bf16 v[148:151], v[100:103], a[76:79], v[148:151]
ds_read_b64_tr_b16 v[90:91], v16 offset:19456
v_mfma_f32_16x16x32_bf16 v[136:139], v[104:107], a[72:75], v[136:139]
ds_read_b64_tr_b16 v[92:93], v17 offset:3072
ds_read_b64_tr_b16 v[94:95], v17 offset:19456
v_mfma_f32_16x16x32_bf16 v[152:155], v[104:107], a[76:79], v[152:155]
ds_read_b64_tr_b16 v[96:97], v14 offset:4096
v_mfma_f32_16x16x32_bf16 v[140:143], v[108:111], a[72:75], v[140:143]
buffer_load_dwordx4 v31, s[44:47], s77 offen offset:1024 lds
v_mfma_f32_16x16x32_bf16 v[156:159], v[108:111], a[76:79], v[156:159]
ds_read_b64_tr_b16 v[98:99], v14 offset:20480
ds_read_b64_tr_b16 v[100:101], v15 offset:4096
v_mfma_f32_16x16x32_bf16 v[128:131], v[112:115], a[80:83], v[128:131]
ds_read_b64_tr_b16 v[102:103], v15 offset:20480
v_mfma_f32_16x16x32_bf16 v[144:147], v[112:115], a[84:87], v[144:147]
ds_read_b64_tr_b16 v[104:105], v16 offset:4096
s_waitcnt lgkmcnt(8)
v_mfma_f32_16x16x32_bf16 v[132:135], v[116:119], a[80:83], v[132:135]
ds_read_b64_tr_b16 v[106:107], v16 offset:20480
ds_read_b64_tr_b16 v[108:109], v17 offset:4096
v_mfma_f32_16x16x32_bf16 v[148:151], v[116:119], a[84:87], v[148:151]
buffer_load_dwordx4 v32, s[44:47], s77 offen offset:2048 lds
v_mfma_f32_16x16x32_bf16 v[136:139], v[120:123], a[80:83], v[136:139]
ds_read_b64_tr_b16 v[110:111], v17 offset:20480
ds_read_b64_tr_b16 v[112:113], v14 offset:5120
v_mfma_f32_16x16x32_bf16 v[152:155], v[120:123], a[84:87], v[152:155]
ds_read_b64_tr_b16 v[114:115], v14 offset:21504
v_mfma_f32_16x16x32_bf16 v[140:143], v[124:127], a[80:83], v[140:143]
ds_read_b64_tr_b16 v[116:117], v15 offset:5120
ds_read_b64_tr_b16 v[118:119], v15 offset:21504
v_mfma_f32_16x16x32_bf16 v[156:159], v[124:127], a[84:87], v[156:159]
ds_read_b64_tr_b16 v[120:121], v16 offset:5120
v_mfma_f32_16x16x32_bf16 v[128:131], v[80:83], a[88:91], v[128:131]
buffer_load_dwordx4 v33, s[44:47], s77 offen offset:3072 lds
v_mfma_f32_16x16x32_bf16 v[144:147], v[80:83], a[92:95], v[144:147]
ds_read_b64_tr_b16 v[122:123], v16 offset:21504
ds_read_b64_tr_b16 v[124:125], v17 offset:5120
v_mfma_f32_16x16x32_bf16 v[132:135], v[84:87], a[88:91], v[132:135]
ds_read_b64_tr_b16 v[126:127], v17 offset:21504
v_mfma_f32_16x16x32_bf16 v[148:151], v[84:87], a[92:95], v[148:151]
ds_read_b64_tr_b16 v[80:81], v14 offset:6144
s_waitcnt lgkmcnt(8)
v_mfma_f32_16x16x32_bf16 v[136:139], v[88:91], a[88:91], v[136:139]
ds_read_b64_tr_b16 v[82:83], v14 offset:22528
ds_read_b64_tr_b16 v[84:85], v15 offset:6144
v_mfma_f32_16x16x32_bf16 v[152:155], v[88:91], a[92:95], v[152:155]
ds_read_b64_tr_b16 v[86:87], v15 offset:22528
v_mfma_f32_16x16x32_bf16 v[140:143], v[92:95], a[88:91], v[140:143]
ds_read_b64_tr_b16 v[88:89], v16 offset:6144
v_mfma_f32_16x16x32_bf16 v[156:159], v[92:95], a[92:95], v[156:159]
ds_read_b64_tr_b16 v[90:91], v16 offset:22528
v_mfma_f32_16x16x32_bf16 v[128:131], v[96:99], a[96:99], v[128:131]
ds_read_b64_tr_b16 v[92:93], v17 offset:6144
v_mfma_f32_16x16x32_bf16 v[144:147], v[96:99], a[100:103], v[144:147]
ds_read_b64_tr_b16 v[94:95], v17 offset:22528
v_mfma_f32_16x16x32_bf16 v[132:135], v[100:103], a[96:99], v[132:135]
ds_read_b64_tr_b16 v[96:97], v14 offset:7168
v_mfma_f32_16x16x32_bf16 v[148:151], v[100:103], a[100:103], v[148:151]
ds_read_b64_tr_b16 v[98:99], v14 offset:23552
v_mfma_f32_16x16x32_bf16 v[136:139], v[104:107], a[96:99], v[136:139]
ds_read_b64_tr_b16 v[100:101], v15 offset:7168
v_mfma_f32_16x16x32_bf16 v[152:155], v[104:107], a[100:103], v[152:155]
ds_read_b64_tr_b16 v[102:103], v15 offset:23552
v_mfma_f32_16x16x32_bf16 v[140:143], v[108:111], a[96:99], v[140:143]
ds_read_b64_tr_b16 v[104:105], v16 offset:7168
v_mfma_f32_16x16x32_bf16 v[156:159], v[108:111], a[100:103], v[156:159]
ds_read_b64_tr_b16 v[106:107], v16 offset:23552
s_waitcnt lgkmcnt(7)
v_mfma_f32_16x16x32_bf16 v[128:131], v[112:115], a[104:107], v[128:131]
ds_read_b64_tr_b16 v[108:109], v17 offset:7168
v_mfma_f32_16x16x32_bf16 v[144:147], v[112:115], a[108:111], v[144:147]
ds_read_b64_tr_b16 v[110:111], v17 offset:23552
v_mfma_f32_16x16x32_bf16 v[132:135], v[116:119], a[104:107], v[132:135]
v_mfma_f32_16x16x32_bf16 v[148:151], v[116:119], a[108:111], v[148:151]
v_mfma_f32_16x16x32_bf16 v[136:139], v[120:123], a[104:107], v[136:139]
v_mfma_f32_16x16x32_bf16 v[152:155], v[120:123], a[108:111], v[152:155]
v_mfma_f32_16x16x32_bf16 v[140:143], v[124:127], a[104:107], v[140:143]
s_waitcnt vmcnt(19) lgkmcnt(0)
s_barrier
v_mfma_f32_16x16x32_bf16 v[156:159], v[124:127], a[108:111], v[156:159]
s_add_u32 m0, s76, 65536
s_add_u32 s77, s84, 0x1c0000
v_mfma_f32_16x16x32_bf16 v[128:131], v[80:83], a[112:115], v[128:131]
buffer_load_dwordx4 v30, s[44:47], s77 offen offset:0 lds
v_mfma_f32_16x16x32_bf16 v[144:147], v[80:83], a[116:119], v[144:147]
ds_read_b64_tr_b16 v[112:113], v14 offset:32768
ds_read_b64_tr_b16 v[114:115], v14 offset:49152
v_mfma_f32_16x16x32_bf16 v[132:135], v[84:87], a[112:115], v[132:135]
ds_read_b64_tr_b16 v[116:117], v15 offset:32768
v_mfma_f32_16x16x32_bf16 v[148:151], v[84:87], a[116:119], v[148:151]
ds_read_b64_tr_b16 v[118:119], v15 offset:49152
ds_read_b64_tr_b16 v[120:121], v16 offset:32768
v_mfma_f32_16x16x32_bf16 v[136:139], v[88:91], a[112:115], v[136:139]
ds_read_b64_tr_b16 v[122:123], v16 offset:49152
v_mfma_f32_16x16x32_bf16 v[152:155], v[88:91], a[116:119], v[152:155]
buffer_load_dwordx4 v31, s[44:47], s77 offen offset:1024 lds
v_mfma_f32_16x16x32_bf16 v[140:143], v[92:95], a[112:115], v[140:143]
ds_read_b64_tr_b16 v[124:125], v17 offset:32768
ds_read_b64_tr_b16 v[126:127], v17 offset:49152
v_mfma_f32_16x16x32_bf16 v[156:159], v[92:95], a[116:119], v[156:159]
ds_read_b64_tr_b16 v[80:81], v14 offset:33792
v_mfma_f32_16x16x32_bf16 v[128:131], v[96:99], a[120:123], v[128:131]
ds_read_b64_tr_b16 v[82:83], v14 offset:50176
ds_read_b64_tr_b16 v[84:85], v15 offset:33792
v_mfma_f32_16x16x32_bf16 v[144:147], v[96:99], a[124:127], v[144:147]
ds_read_b64_tr_b16 v[86:87], v15 offset:50176
v_mfma_f32_16x16x32_bf16 v[132:135], v[100:103], a[120:123], v[132:135]
buffer_load_dwordx4 v32, s[44:47], s77 offen offset:2048 lds
v_mfma_f32_16x16x32_bf16 v[148:151], v[100:103], a[124:127], v[148:151]
ds_read_b64_tr_b16 v[88:89], v16 offset:33792
ds_read_b64_tr_b16 v[90:91], v16 offset:50176
v_mfma_f32_16x16x32_bf16 v[136:139], v[104:107], a[120:123], v[136:139]
ds_read_b64_tr_b16 v[92:93], v17 offset:33792
v_mfma_f32_16x16x32_bf16 v[152:155], v[104:107], a[124:127], v[152:155]
ds_read_b64_tr_b16 v[94:95], v17 offset:50176
ds_read_b64_tr_b16 v[96:97], v14 offset:34816
v_mfma_f32_16x16x32_bf16 v[140:143], v[108:111], a[120:123], v[140:143]
ds_read_b64_tr_b16 v[98:99], v14 offset:51200
v_mfma_f32_16x16x32_bf16 v[156:159], v[108:111], a[124:127], v[156:159]
ds_read_b64_tr_b16 v[100:101], v15 offset:34816
s_waitcnt lgkmcnt(8)
v_mfma_f32_16x16x32_bf16 v[128:131], v[112:115], a[128:131], v[128:131]
buffer_load_dwordx4 v33, s[44:47], s77 offen offset:3072 lds
v_mfma_f32_16x16x32_bf16 v[144:147], v[112:115], a[132:135], v[144:147]
ds_read_b64_tr_b16 v[102:103], v15 offset:51200
ds_read_b64_tr_b16 v[104:105], v16 offset:34816
v_mfma_f32_16x16x32_bf16 v[132:135], v[116:119], a[128:131], v[132:135]
ds_read_b64_tr_b16 v[106:107], v16 offset:51200
v_mfma_f32_16x16x32_bf16 v[148:151], v[116:119], a[132:135], v[148:151]
s_mov_b32 s3, 0x200000
ds_read_b64_tr_b16 v[108:109], v17 offset:34816
v_mfma_f32_16x16x32_bf16 v[136:139], v[120:123], a[128:131], v[136:139]
buffer_load_dword v57, v8, s[48:51], s3 offen
v_mfma_f32_16x16x32_bf16 v[152:155], v[120:123], a[132:135], v[152:155]
s_add_u32 m0, s76, 69632
s_add_u32 s77, s84, 0x2a0000
v_mfma_f32_16x16x32_bf16 v[140:143], v[124:127], a[128:131], v[140:143]
buffer_load_dwordx4 v30, s[44:47], s77 offen offset:0 lds
v_mfma_f32_16x16x32_bf16 v[156:159], v[124:127], a[132:135], v[156:159]
ds_read_b64_tr_b16 v[110:111], v17 offset:51200
ds_read_b64_tr_b16 v[112:113], v14 offset:35840
v_mfma_f32_16x16x32_bf16 v[128:131], v[80:83], a[136:139], v[128:131]
ds_read_b64_tr_b16 v[114:115], v14 offset:52224
v_mfma_f32_16x16x32_bf16 v[144:147], v[80:83], a[140:143], v[144:147]
ds_read_b64_tr_b16 v[116:117], v15 offset:35840
s_waitcnt lgkmcnt(5)
v_mfma_f32_16x16x32_bf16 v[132:135], v[84:87], a[136:139], v[132:135]
ds_read_b64_tr_b16 v[118:119], v15 offset:52224
ds_read_b64_tr_b16 v[120:121], v16 offset:35840
v_mfma_f32_16x16x32_bf16 v[148:151], v[84:87], a[140:143], v[148:151]
buffer_load_dwordx4 v31, s[44:47], s77 offen offset:1024 lds
v_mfma_f32_16x16x32_bf16 v[136:139], v[88:91], a[136:139], v[136:139]
ds_read_b64_tr_b16 v[122:123], v16 offset:52224
ds_read_b64_tr_b16 v[124:125], v17 offset:35840
v_mfma_f32_16x16x32_bf16 v[152:155], v[88:91], a[140:143], v[152:155]
ds_read_b64_tr_b16 v[126:127], v17 offset:52224
v_mfma_f32_16x16x32_bf16 v[140:143], v[92:95], a[136:139], v[140:143]
ds_read_b64_tr_b16 v[80:81], v14 offset:36864
ds_read_b64_tr_b16 v[82:83], v14 offset:53248
v_mfma_f32_16x16x32_bf16 v[156:159], v[92:95], a[140:143], v[156:159]
ds_read_b64_tr_b16 v[84:85], v15 offset:36864
v_mfma_f32_16x16x32_bf16 v[128:131], v[96:99], a[144:147], v[128:131]
buffer_load_dwordx4 v32, s[44:47], s77 offen offset:2048 lds
v_mfma_f32_16x16x32_bf16 v[144:147], v[96:99], a[148:151], v[144:147]
ds_read_b64_tr_b16 v[86:87], v15 offset:53248
ds_read_b64_tr_b16 v[88:89], v16 offset:36864
v_mfma_f32_16x16x32_bf16 v[132:135], v[100:103], a[144:147], v[132:135]
ds_read_b64_tr_b16 v[90:91], v16 offset:53248
v_mfma_f32_16x16x32_bf16 v[148:151], v[100:103], a[148:151], v[148:151]
ds_read_b64_tr_b16 v[92:93], v17 offset:36864
ds_read_b64_tr_b16 v[94:95], v17 offset:53248
v_mfma_f32_16x16x32_bf16 v[136:139], v[104:107], a[144:147], v[136:139]
ds_read_b64_tr_b16 v[96:97], v14 offset:37888
v_mfma_f32_16x16x32_bf16 v[152:155], v[104:107], a[148:151], v[152:155]
ds_read_b64_tr_b16 v[98:99], v14 offset:54272
s_waitcnt lgkmcnt(8)
v_mfma_f32_16x16x32_bf16 v[140:143], v[108:111], a[144:147], v[140:143]
buffer_load_dwordx4 v33, s[44:47], s77 offen offset:3072 lds
v_mfma_f32_16x16x32_bf16 v[156:159], v[108:111], a[148:151], v[156:159]
ds_read_b64_tr_b16 v[100:101], v15 offset:37888
ds_read_b64_tr_b16 v[102:103], v15 offset:54272
v_mfma_f32_16x16x32_bf16 v[128:131], v[112:115], a[152:155], v[128:131]
ds_read_b64_tr_b16 v[104:105], v16 offset:37888
v_mfma_f32_16x16x32_bf16 v[144:147], v[112:115], a[156:159], v[144:147]
ds_read_b64_tr_b16 v[106:107], v16 offset:54272
ds_read_b64_tr_b16 v[108:109], v17 offset:37888
v_mfma_f32_16x16x32_bf16 v[132:135], v[116:119], a[152:155], v[132:135]
ds_read_b64_tr_b16 v[110:111], v17 offset:54272
v_mfma_f32_16x16x32_bf16 v[148:151], v[116:119], a[156:159], v[148:151]
ds_read_b64_tr_b16 v[112:113], v14 offset:38912
ds_read_b64_tr_b16 v[114:115], v14 offset:55296
v_mfma_f32_16x16x32_bf16 v[136:139], v[120:123], a[152:155], v[136:139]
ds_read_b64_tr_b16 v[116:117], v15 offset:38912
v_mfma_f32_16x16x32_bf16 v[152:155], v[120:123], a[156:159], v[152:155]
ds_read_b64_tr_b16 v[118:119], v15 offset:55296
v_mfma_f32_16x16x32_bf16 v[140:143], v[124:127], a[152:155], v[140:143]
ds_read_b64_tr_b16 v[120:121], v16 offset:38912
v_mfma_f32_16x16x32_bf16 v[156:159], v[124:127], a[156:159], v[156:159]
ds_read_b64_tr_b16 v[122:123], v16 offset:55296
v_mfma_f32_16x16x32_bf16 v[128:131], v[80:83], a[160:163], v[128:131]
ds_read_b64_tr_b16 v[124:125], v17 offset:38912
v_mfma_f32_16x16x32_bf16 v[144:147], v[80:83], a[164:167], v[144:147]
ds_read_b64_tr_b16 v[126:127], v17 offset:55296
s_waitcnt lgkmcnt(8)
v_mfma_f32_16x16x32_bf16 v[132:135], v[84:87], a[160:163], v[132:135]
ds_read_b64_tr_b16 v[80:81], v14 offset:39936
v_mfma_f32_16x16x32_bf16 v[148:151], v[84:87], a[164:167], v[148:151]
ds_read_b64_tr_b16 v[82:83], v14 offset:56320
v_mfma_f32_16x16x32_bf16 v[136:139], v[88:91], a[160:163], v[136:139]
ds_read_b64_tr_b16 v[84:85], v15 offset:39936
v_mfma_f32_16x16x32_bf16 v[152:155], v[88:91], a[164:167], v[152:155]
ds_read_b64_tr_b16 v[86:87], v15 offset:56320
v_mfma_f32_16x16x32_bf16 v[140:143], v[92:95], a[160:163], v[140:143]
ds_read_b64_tr_b16 v[88:89], v16 offset:39936
v_mfma_f32_16x16x32_bf16 v[156:159], v[92:95], a[164:167], v[156:159]
ds_read_b64_tr_b16 v[90:91], v16 offset:56320
v_mfma_f32_16x16x32_bf16 v[128:131], v[96:99], a[168:171], v[128:131]
ds_read_b64_tr_b16 v[92:93], v17 offset:39936
v_mfma_f32_16x16x32_bf16 v[144:147], v[96:99], a[172:175], v[144:147]
ds_read_b64_tr_b16 v[94:95], v17 offset:56320
v_mfma_f32_16x16x32_bf16 v[132:135], v[100:103], a[168:171], v[132:135]
v_mfma_f32_16x16x32_bf16 v[148:151], v[100:103], a[172:175], v[148:151]
v_mfma_f32_16x16x32_bf16 v[136:139], v[104:107], a[168:171], v[136:139]
v_mfma_f32_16x16x32_bf16 v[152:155], v[104:107], a[172:175], v[152:155]
v_mfma_f32_16x16x32_bf16 v[140:143], v[108:111], a[168:171], v[140:143]
s_waitcnt vmcnt(17) lgkmcnt(0)
s_barrier
v_mfma_f32_16x16x32_bf16 v[156:159], v[108:111], a[172:175], v[156:159]
s_add_u32 m0, s76, 98304
s_add_u32 s77, s84, 0x380000
v_mfma_f32_16x16x32_bf16 v[128:131], v[112:115], a[176:179], v[128:131]
buffer_load_dwordx4 v30, s[44:47], s77 offen offset:0 lds
v_mfma_f32_16x16x32_bf16 v[144:147], v[112:115], a[180:183], v[144:147]
ds_read_b64_tr_b16 v[96:97], v10 offset:0
ds_read_b64_tr_b16 v[98:99], v10 offset:16384
v_mfma_f32_16x16x32_bf16 v[132:135], v[116:119], a[176:179], v[132:135]
ds_read_b64_tr_b16 v[100:101], v11 offset:0
v_mfma_f32_16x16x32_bf16 v[148:151], v[116:119], a[180:183], v[148:151]
ds_read_b64_tr_b16 v[102:103], v11 offset:16384
ds_read_b64_tr_b16 v[104:105], v12 offset:0
v_mfma_f32_16x16x32_bf16 v[136:139], v[120:123], a[176:179], v[136:139]
ds_read_b64_tr_b16 v[106:107], v12 offset:16384
v_mfma_f32_16x16x32_bf16 v[152:155], v[120:123], a[180:183], v[152:155]
buffer_load_dwordx4 v31, s[44:47], s77 offen offset:1024 lds
v_mfma_f32_16x16x32_bf16 v[140:143], v[124:127], a[176:179], v[140:143]
ds_read_b64_tr_b16 v[108:109], v13 offset:0
ds_read_b64_tr_b16 v[110:111], v13 offset:16384
v_mfma_f32_16x16x32_bf16 v[156:159], v[124:127], a[180:183], v[156:159]
ds_read_b64_tr_b16 v[112:113], v10 offset:1024
v_mfma_f32_16x16x32_bf16 v[128:131], v[80:83], a[184:187], v[128:131]
ds_read_b64_tr_b16 v[114:115], v10 offset:17408
ds_read_b64_tr_b16 v[116:117], v11 offset:1024
v_mfma_f32_16x16x32_bf16 v[144:147], v[80:83], a[188:191], v[144:147]
ds_read_b64_tr_b16 v[118:119], v11 offset:17408
v_mfma_f32_16x16x32_bf16 v[132:135], v[84:87], a[184:187], v[132:135]
buffer_load_dwordx4 v32, s[44:47], s77 offen offset:2048 lds
v_mfma_f32_16x16x32_bf16 v[148:151], v[84:87], a[188:191], v[148:151]
ds_read_b64_tr_b16 v[120:121], v12 offset:1024
ds_read_b64_tr_b16 v[122:123], v12 offset:17408
v_mfma_f32_16x16x32_bf16 v[136:139], v[88:91], a[184:187], v[136:139]
ds_read_b64_tr_b16 v[124:125], v13 offset:1024
v_mfma_f32_16x16x32_bf16 v[152:155], v[88:91], a[188:191], v[152:155]
ds_read_b64_tr_b16 v[126:127], v13 offset:17408
ds_read_b64_tr_b16 v[80:81], v10 offset:2048
v_mfma_f32_16x16x32_bf16 v[140:143], v[92:95], a[184:187], v[140:143]
ds_read_b64_tr_b16 v[82:83], v10 offset:18432
v_mfma_f32_16x16x32_bf16 v[156:159], v[92:95], a[188:191], v[156:159]
ds_read_b64_tr_b16 v[84:85], v11 offset:2048
s_waitcnt lgkmcnt(8)
v_mfma_f32_16x16x32_bf16 v[128:131], v[96:99], a[192:195], v[128:131]
buffer_load_dwordx4 v33, s[44:47], s77 offen offset:3072 lds
v_mfma_f32_16x16x32_bf16 v[144:147], v[96:99], a[196:199], v[144:147]
ds_read_b64_tr_b16 v[86:87], v11 offset:18432
ds_read_b64_tr_b16 v[88:89], v12 offset:2048
v_mfma_f32_16x16x32_bf16 v[132:135], v[100:103], a[192:195], v[132:135]
ds_read_b64_tr_b16 v[90:91], v12 offset:18432
v_mfma_f32_16x16x32_bf16 v[148:151], v[100:103], a[196:199], v[148:151]
ds_read_b64_tr_b16 v[92:93], v13 offset:2048
ds_read_b64_tr_b16 v[94:95], v13 offset:18432
v_mfma_f32_16x16x32_bf16 v[136:139], v[104:107], a[192:195], v[136:139]
ds_read_b64_tr_b16 v[96:97], v10 offset:3072
v_mfma_f32_16x16x32_bf16 v[152:155], v[104:107], a[196:199], v[152:155]
s_add_u32 m0, s76, 102400
s_add_u32 s77, s84, 0x460000
v_mfma_f32_16x16x32_bf16 v[140:143], v[108:111], a[192:195], v[140:143]
buffer_load_dwordx4 v30, s[44:47], s77 offen offset:0 lds
v_mfma_f32_16x16x32_bf16 v[156:159], v[108:111], a[196:199], v[156:159]
ds_read_b64_tr_b16 v[98:99], v10 offset:19456
ds_read_b64_tr_b16 v[100:101], v11 offset:3072
v_mfma_f32_16x16x32_bf16 v[128:131], v[112:115], a[200:203], v[128:131]
ds_read_b64_tr_b16 v[102:103], v11 offset:19456
v_mfma_f32_16x16x32_bf16 v[144:147], v[112:115], a[204:207], v[144:147]
ds_read_b64_tr_b16 v[104:105], v12 offset:3072
s_waitcnt lgkmcnt(7)
v_mfma_f32_16x16x32_bf16 v[132:135], v[116:119], a[200:203], v[132:135]
ds_read_b64_tr_b16 v[106:107], v12 offset:19456
ds_read_b64_tr_b16 v[108:109], v13 offset:3072
v_mfma_f32_16x16x32_bf16 v[148:151], v[116:119], a[204:207], v[148:151]
buffer_load_dwordx4 v31, s[44:47], s77 offen offset:1024 lds
v_mfma_f32_16x16x32_bf16 v[136:139], v[120:123], a[200:203], v[136:139]
ds_read_b64_tr_b16 v[110:111], v13 offset:19456
ds_read_b64_tr_b16 v[112:113], v10 offset:4096
v_mfma_f32_16x16x32_bf16 v[152:155], v[120:123], a[204:207], v[152:155]
ds_read_b64_tr_b16 v[114:115], v10 offset:20480
v_mfma_f32_16x16x32_bf16 v[140:143], v[124:127], a[200:203], v[140:143]
ds_read_b64_tr_b16 v[116:117], v11 offset:4096
ds_read_b64_tr_b16 v[118:119], v11 offset:20480
v_mfma_f32_16x16x32_bf16 v[156:159], v[124:127], a[204:207], v[156:159]
ds_read_b64_tr_b16 v[120:121], v12 offset:4096
v_mfma_f32_16x16x32_bf16 v[128:131], v[80:83], a[208:211], v[128:131]
buffer_load_dwordx4 v32, s[44:47], s77 offen offset:2048 lds
v_mfma_f32_16x16x32_bf16 v[144:147], v[80:83], a[212:215], v[144:147]
ds_read_b64_tr_b16 v[122:123], v12 offset:20480
ds_read_b64_tr_b16 v[124:125], v13 offset:4096
v_mfma_f32_16x16x32_bf16 v[132:135], v[84:87], a[208:211], v[132:135]
ds_read_b64_tr_b16 v[126:127], v13 offset:20480
v_mfma_f32_16x16x32_bf16 v[148:151], v[84:87], a[212:215], v[148:151]
ds_read_b64_tr_b16 v[80:81], v10 offset:5120
ds_read_b64_tr_b16 v[82:83], v10 offset:21504
v_mfma_f32_16x16x32_bf16 v[136:139], v[88:91], a[208:211], v[136:139]
ds_read_b64_tr_b16 v[84:85], v11 offset:5120
v_mfma_f32_16x16x32_bf16 v[152:155], v[88:91], a[212:215], v[152:155]
ds_read_b64_tr_b16 v[86:87], v11 offset:21504
s_waitcnt lgkmcnt(8)
v_mfma_f32_16x16x32_bf16 v[140:143], v[92:95], a[208:211], v[140:143]
buffer_load_dwordx4 v33, s[44:47], s77 offen offset:3072 lds
v_mfma_f32_16x16x32_bf16 v[156:159], v[92:95], a[212:215], v[156:159]
ds_read_b64_tr_b16 v[88:89], v12 offset:5120
ds_read_b64_tr_b16 v[90:91], v12 offset:21504
v_mfma_f32_16x16x32_bf16 v[128:131], v[96:99], a[216:219], v[128:131]
ds_read_b64_tr_b16 v[92:93], v13 offset:5120
v_mfma_f32_16x16x32_bf16 v[144:147], v[96:99], a[220:223], v[144:147]
ds_read_b64_tr_b16 v[94:95], v13 offset:21504
v_mfma_f32_16x16x32_bf16 v[132:135], v[100:103], a[216:219], v[132:135]
ds_read_b64_tr_b16 v[96:97], v10 offset:6144
v_mfma_f32_16x16x32_bf16 v[148:151], v[100:103], a[220:223], v[148:151]
ds_read_b64_tr_b16 v[98:99], v10 offset:22528
v_mfma_f32_16x16x32_bf16 v[136:139], v[104:107], a[216:219], v[136:139]
ds_read_b64_tr_b16 v[100:101], v11 offset:6144
v_mfma_f32_16x16x32_bf16 v[152:155], v[104:107], a[220:223], v[152:155]
ds_read_b64_tr_b16 v[102:103], v11 offset:22528
v_mfma_f32_16x16x32_bf16 v[140:143], v[108:111], a[216:219], v[140:143]
ds_read_b64_tr_b16 v[104:105], v12 offset:6144
v_mfma_f32_16x16x32_bf16 v[156:159], v[108:111], a[220:223], v[156:159]
ds_read_b64_tr_b16 v[106:107], v12 offset:22528
v_mfma_f32_16x16x32_bf16 v[128:131], v[112:115], a[224:227], v[128:131]
ds_read_b64_tr_b16 v[108:109], v13 offset:6144
v_mfma_f32_16x16x32_bf16 v[144:147], v[112:115], a[228:231], v[144:147]
ds_read_b64_tr_b16 v[110:111], v13 offset:22528
v_mfma_f32_16x16x32_bf16 v[132:135], v[116:119], a[224:227], v[132:135]
ds_read_b64_tr_b16 v[112:113], v10 offset:7168
v_mfma_f32_16x16x32_bf16 v[148:151], v[116:119], a[228:231], v[148:151]
ds_read_b64_tr_b16 v[114:115], v10 offset:23552
s_waitcnt lgkmcnt(7)
v_mfma_f32_16x16x32_bf16 v[136:139], v[120:123], a[224:227], v[136:139]
ds_read_b64_tr_b16 v[116:117], v11 offset:7168
v_mfma_f32_16x16x32_bf16 v[152:155], v[120:123], a[228:231], v[152:155]
ds_read_b64_tr_b16 v[118:119], v11 offset:23552
v_mfma_f32_16x16x32_bf16 v[140:143], v[124:127], a[224:227], v[140:143]
ds_read_b64_tr_b16 v[120:121], v12 offset:7168
v_mfma_f32_16x16x32_bf16 v[156:159], v[124:127], a[228:231], v[156:159]
ds_read_b64_tr_b16 v[122:123], v12 offset:23552
v_mfma_f32_16x16x32_bf16 v[128:131], v[80:83], a[232:235], v[128:131]
ds_read_b64_tr_b16 v[124:125], v13 offset:7168
v_mfma_f32_16x16x32_bf16 v[144:147], v[80:83], a[236:239], v[144:147]
ds_read_b64_tr_b16 v[126:127], v13 offset:23552
v_mfma_f32_16x16x32_bf16 v[132:135], v[84:87], a[232:235], v[132:135]
v_mfma_f32_16x16x32_bf16 v[148:151], v[84:87], a[236:239], v[148:151]
v_mfma_f32_16x16x32_bf16 v[136:139], v[88:91], a[232:235], v[136:139]
v_mfma_f32_16x16x32_bf16 v[152:155], v[88:91], a[236:239], v[152:155]
v_mfma_f32_16x16x32_bf16 v[140:143], v[92:95], a[232:235], v[140:143]
s_waitcnt vmcnt(17) lgkmcnt(0)
s_barrier
v_mfma_f32_16x16x32_bf16 v[156:159], v[92:95], a[236:239], v[156:159]
s_add_u32 m0, s76, 0
s_add_u32 s77, s84, 0x540000
v_mfma_f32_16x16x32_bf16 v[128:131], v[96:99], a[240:243], v[128:131]
buffer_load_dwordx4 v30, s[44:47], s77 offen offset:0 lds
v_mfma_f32_16x16x32_bf16 v[144:147], v[96:99], a[244:247], v[144:147]
ds_read_b64_tr_b16 v[80:81], v10 offset:32768
ds_read_b64_tr_b16 v[82:83], v10 offset:49152
v_mfma_f32_16x16x32_bf16 v[132:135], v[100:103], a[240:243], v[132:135]
ds_read_b64_tr_b16 v[84:85], v11 offset:32768
v_mfma_f32_16x16x32_bf16 v[148:151], v[100:103], a[244:247], v[148:151]
ds_read_b64_tr_b16 v[86:87], v11 offset:49152
ds_read_b64_tr_b16 v[88:89], v12 offset:32768
v_mfma_f32_16x16x32_bf16 v[136:139], v[104:107], a[240:243], v[136:139]
ds_read_b64_tr_b16 v[90:91], v12 offset:49152
v_mfma_f32_16x16x32_bf16 v[152:155], v[104:107], a[244:247], v[152:155]
buffer_load_dwordx4 v31, s[44:47], s77 offen offset:1024 lds
v_mfma_f32_16x16x32_bf16 v[140:143], v[108:111], a[240:243], v[140:143]
ds_read_b64_tr_b16 v[92:93], v13 offset:32768
ds_read_b64_tr_b16 v[94:95], v13 offset:49152
v_mfma_f32_16x16x32_bf16 v[156:159], v[108:111], a[244:247], v[156:159]
ds_read_b64_tr_b16 v[96:97], v10 offset:33792
v_mfma_f32_16x16x32_bf16 v[128:131], v[112:115], a[248:251], v[128:131]
ds_read_b64_tr_b16 v[98:99], v10 offset:50176
ds_read_b64_tr_b16 v[100:101], v11 offset:33792
v_mfma_f32_16x16x32_bf16 v[144:147], v[112:115], a[252:255], v[144:147]
ds_read_b64_tr_b16 v[102:103], v11 offset:50176
v_mfma_f32_16x16x32_bf16 v[132:135], v[116:119], a[248:251], v[132:135]
buffer_load_dwordx4 v32, s[44:47], s77 offen offset:2048 lds
v_mfma_f32_16x16x32_bf16 v[148:151], v[116:119], a[252:255], v[148:151]
ds_read_b64_tr_b16 v[104:105], v12 offset:33792
ds_read_b64_tr_b16 v[106:107], v12 offset:50176
v_mfma_f32_16x16x32_bf16 v[136:139], v[120:123], a[248:251], v[136:139]
ds_read_b64_tr_b16 v[108:109], v13 offset:33792
v_mfma_f32_16x16x32_bf16 v[152:155], v[120:123], a[252:255], v[152:155]
ds_read_b64_tr_b16 v[110:111], v13 offset:50176
ds_read_b64_tr_b16 v[112:113], v10 offset:34816
v_mfma_f32_16x16x32_bf16 v[140:143], v[124:127], a[248:251], v[140:143]
ds_read_b64_tr_b16 v[114:115], v10 offset:51200
v_mfma_f32_16x16x32_bf16 v[156:159], v[124:127], a[252:255], v[156:159]
buffer_load_dwordx4 v33, s[44:47], s77 offen offset:3072 lds
S_U0:
s_waitcnt lgkmcnt(7)
v_mfma_f32_16x16x32_bf16 v[192:195], v[80:83], a[0:3], 0
ds_read_b64_tr_b16 v[116:117], v11 offset:34816
ds_read_b64_tr_b16 v[118:119], v11 offset:51200
v_mfma_f32_16x16x32_bf16 v[208:211], v[80:83], a[4:7], 0
ds_read_b64_tr_b16 v[120:121], v12 offset:34816
v_mfma_f32_16x16x32_bf16 v[196:199], v[84:87], a[0:3], 0
ds_read_b64_tr_b16 v[122:123], v12 offset:51200
ds_read_b64_tr_b16 v[124:125], v13 offset:34816
v_mfma_f32_16x16x32_bf16 v[212:215], v[84:87], a[4:7], 0
s_add_u32 s70, s0, S_G1 - K_pc + 0
s_addc_u32 s71, s1, 0
global_load_dword v57, v9, s[70:71]
v_mfma_f32_16x16x32_bf16 v[200:203], v[88:91], a[0:3], 0
s_add_u32 m0, s76, 4096
s_add_u32 s77, s84, 0x620000
v_mfma_f32_16x16x32_bf16 v[216:219], v[88:91], a[4:7], 0
buffer_load_dwordx4 v30, s[44:47], s77 offen offset:0 lds
v_mfma_f32_16x16x32_bf16 v[204:207], v[92:95], a[0:3], 0
v_mul_f32 v240, v60, v128
v_mul_f32 v241, v60, v129
v_mfma_f32_16x16x32_bf16 v[220:223], v[92:95], a[4:7], 0
v_mul_f32 v242, v60, v130
v_mul_f32 v243, v60, v131
v_mfma_f32_16x16x32_bf16 v[192:195], v[96:99], a[8:11], v[192:195]
v_exp_f32 v240, v240
v_mfma_f32_16x16x32_bf16 v[208:211], v[96:99], a[12:15], v[208:211]
ds_read_b64_tr_b16 v[126:127], v13 offset:51200
s_waitcnt lgkmcnt(1)
v_mfma_f32_16x16x32_bf16 v[196:199], v[100:103], a[8:11], v[196:199]
ds_read_b64_tr_b16 v[80:81], v10 offset:35840
ds_read_b64_tr_b16 v[82:83], v10 offset:52224
v_mfma_f32_16x16x32_bf16 v[212:215], v[100:103], a[12:15], v[212:215]
buffer_load_dwordx4 v31, s[44:47], s77 offen offset:1024 lds
v_mfma_f32_16x16x32_bf16 v[200:203], v[104:107], a[8:11], v[200:203]
ds_read_b64_tr_b16 v[84:85], v11 offset:35840
ds_read_b64_tr_b16 v[86:87], v11 offset:52224
v_mfma_f32_16x16x32_bf16 v[216:219], v[104:107], a[12:15], v[216:219]
v_exp_f32 v241, v241
v_mfma_f32_16x16x32_bf16 v[204:207], v[108:111], a[8:11], v[204:207]
ds_read_b64_tr_b16 v[88:89], v12 offset:35840
ds_read_b64_tr_b16 v[90:91], v12 offset:52224
v_mfma_f32_16x16x32_bf16 v[220:223], v[108:111], a[12:15], v[220:223]
v_exp_f32 v242, v242
v_mfma_f32_16x16x32_bf16 v[192:195], v[112:115], a[16:19], v[192:195]
ds_read_b64_tr_b16 v[92:93], v13 offset:35840
ds_read_b64_tr_b16 v[94:95], v13 offset:52224
v_mfma_f32_16x16x32_bf16 v[208:211], v[112:115], a[20:23], v[208:211]
buffer_load_dwordx4 v32, s[44:47], s77 offen offset:2048 lds
v_mfma_f32_16x16x32_bf16 v[196:199], v[116:119], a[16:19], v[196:199]
ds_read_b64_tr_b16 v[96:97], v10 offset:36864
ds_read_b64_tr_b16 v[98:99], v10 offset:53248
v_mfma_f32_16x16x32_bf16 v[212:215], v[116:119], a[20:23], v[212:215]
v_exp_f32 v243, v243
v_mfma_f32_16x16x32_bf16 v[200:203], v[120:123], a[16:19], v[200:203]
ds_read_b64_tr_b16 v[100:101], v11 offset:36864
v_fma_f32 v240, v240, v62, v62
v_mfma_f32_16x16x32_bf16 v[216:219], v[120:123], a[20:23], v[216:219]
ds_read_b64_tr_b16 v[102:103], v11 offset:53248
s_waitcnt lgkmcnt(6)
v_mfma_f32_16x16x32_bf16 v[204:207], v[124:127], a[16:19], v[204:207]
ds_read_b64_tr_b16 v[104:105], v12 offset:36864
v_fma_f32 v241, v241, v62, v62
v_mfma_f32_16x16x32_bf16 v[220:223], v[124:127], a[20:23], v[220:223]
ds_read_b64_tr_b16 v[106:107], v12 offset:53248
v_fma_f32 v242, v242, v62, v62
v_mfma_f32_16x16x32_bf16 v[192:195], v[80:83], a[24:27], v[192:195]
ds_read_b64_tr_b16 v[108:109], v13 offset:36864
v_fma_f32 v243, v243, v62, v62
v_mfma_f32_16x16x32_bf16 v[208:211], v[80:83], a[28:31], v[208:211]
ds_read_b64_tr_b16 v[110:111], v13 offset:53248
ds_read_b64_tr_b16 v[112:113], v10 offset:37888
v_mfma_f32_16x16x32_bf16 v[196:199], v[84:87], a[24:27], v[196:199]
buffer_load_dwordx4 v33, s[44:47], s77 offen offset:3072 lds
v_mfma_f32_16x16x32_bf16 v[212:215], v[84:87], a[28:31], v[212:215]
ds_read_b64_tr_b16 v[114:115], v10 offset:54272
ds_read_b64_tr_b16 v[116:117], v11 offset:37888
v_mfma_f32_16x16x32_bf16 v[200:203], v[88:91], a[24:27], v[200:203]
v_rcp_f32 v240, v240
v_mfma_f32_16x16x32_bf16 v[216:219], v[88:91], a[28:31], v[216:219]
ds_read_b64_tr_b16 v[118:119], v11 offset:54272
s_waitcnt lgkmcnt(7)
v_mfma_f32_16x16x32_bf16 v[204:207], v[92:95], a[24:27], v[204:207]
ds_read_b64_tr_b16 v[120:121], v12 offset:37888
ds_read_b64_tr_b16 v[122:123], v12 offset:54272
v_mfma_f32_16x16x32_bf16 v[220:223], v[92:95], a[28:31], v[220:223]
v_rcp_f32 v241, v241
v_mfma_f32_16x16x32_bf16 v[192:195], v[96:99], a[32:35], v[192:195]
ds_read_b64_tr_b16 v[124:125], v13 offset:37888
ds_read_b64_tr_b16 v[126:127], v13 offset:54272
v_mfma_f32_16x16x32_bf16 v[208:211], v[96:99], a[36:39], v[208:211]
v_rcp_f32 v242, v242
v_mfma_f32_16x16x32_bf16 v[196:199], v[100:103], a[32:35], v[196:199]
ds_read_b64_tr_b16 v[80:81], v10 offset:38912
ds_read_b64_tr_b16 v[82:83], v10 offset:55296
v_mfma_f32_16x16x32_bf16 v[212:215], v[100:103], a[36:39], v[212:215]
ds_read_b64_tr_b16 v[84:85], v11 offset:38912
s_waitcnt lgkmcnt(8)
v_mfma_f32_16x16x32_bf16 v[200:203], v[104:107], a[32:35], v[200:203]
v_rcp_f32 v243, v243
v_mfma_f32_16x16x32_bf16 v[216:219], v[104:107], a[36:39], v[216:219]
ds_read_b64_tr_b16 v[86:87], v11 offset:55296
v_mul_f32 v128, v128, v240
v_mfma_f32_16x16x32_bf16 v[204:207], v[108:111], a[32:35], v[204:207]
ds_read_b64_tr_b16 v[88:89], v12 offset:38912
v_mul_f32 v129, v129, v241
v_mfma_f32_16x16x32_bf16 v[220:223], v[108:111], a[36:39], v[220:223]
ds_read_b64_tr_b16 v[90:91], v12 offset:55296
v_mul_f32 v130, v130, v242
v_mfma_f32_16x16x32_bf16 v[192:195], v[112:115], a[40:43], v[192:195]
ds_read_b64_tr_b16 v[92:93], v13 offset:38912
v_mul_f32 v131, v131, v243
v_mfma_f32_16x16x32_bf16 v[208:211], v[112:115], a[44:47], v[208:211]
ds_read_b64_tr_b16 v[94:95], v13 offset:55296
s_waitcnt lgkmcnt(6)
v_mfma_f32_16x16x32_bf16 v[196:199], v[116:119], a[40:43], v[196:199]
ds_read_b64_tr_b16 v[96:97], v10 offset:39936
v_mul_f32 v244, v60, v132
v_mfma_f32_16x16x32_bf16 v[212:215], v[116:119], a[44:47], v[212:215]
ds_read_b64_tr_b16 v[98:99], v10 offset:56320
v_mul_f32 v245, v60, v133
v_mfma_f32_16x16x32_bf16 v[200:203], v[120:123], a[40:43], v[200:203]
ds_read_b64_tr_b16 v[100:101], v11 offset:39936
v_mul_f32 v246, v60, v134
v_mfma_f32_16x16x32_bf16 v[216:219], v[120:123], a[44:47], v[216:219]
ds_read_b64_tr_b16 v[102:103], v11 offset:56320
v_mul_f32 v247, v60, v135
v_mfma_f32_16x16x32_bf16 v[204:207], v[124:127], a[40:43], v[204:207]
ds_read_b64_tr_b16 v[104:105], v12 offset:39936
ds_read_b64_tr_b16 v[106:107], v12 offset:56320
v_mfma_f32_16x16x32_bf16 v[220:223], v[124:127], a[44:47], v[220:223]
v_exp_f32 v244, v244
v_mfma_f32_16x16x32_bf16 v[192:195], v[80:83], a[48:51], v[192:195]
ds_read_b64_tr_b16 v[108:109], v13 offset:39936
ds_read_b64_tr_b16 v[110:111], v13 offset:56320
v_mfma_f32_16x16x32_bf16 v[208:211], v[80:83], a[52:55], v[208:211]
s_waitcnt lgkmcnt(7)
v_mfma_f32_16x16x32_bf16 v[196:199], v[84:87], a[48:51], v[196:199]
v_exp_f32 v245, v245
v_mfma_f32_16x16x32_bf16 v[212:215], v[84:87], a[52:55], v[212:215]
v_exp_f32 v246, v246
v_mfma_f32_16x16x32_bf16 v[200:203], v[88:91], a[48:51], v[200:203]
v_exp_f32 v247, v247
v_mfma_f32_16x16x32_bf16 v[216:219], v[88:91], a[52:55], v[216:219]
s_waitcnt vmcnt(17) lgkmcnt(0)
s_barrier
v_mfma_f32_16x16x32_bf16 v[204:207], v[92:95], a[48:51], v[204:207]
ds_read_b64_tr_b16 v[112:113], v14 offset:0
ds_read_b64_tr_b16 v[114:115], v14 offset:16384
v_mfma_f32_16x16x32_bf16 v[220:223], v[92:95], a[52:55], v[220:223]
ds_read_b64_tr_b16 v[116:117], v15 offset:0
ds_read_b64_tr_b16 v[118:119], v15 offset:16384
v_mfma_f32_16x16x32_bf16 v[192:195], v[96:99], a[56:59], v[192:195]
ds_read_b64_tr_b16 v[120:121], v16 offset:0
ds_read_b64_tr_b16 v[122:123], v16 offset:16384
v_mfma_f32_16x16x32_bf16 v[208:211], v[96:99], a[60:63], v[208:211]
ds_read_b64_tr_b16 v[124:125], v17 offset:0
ds_read_b64_tr_b16 v[126:127], v17 offset:16384
v_mfma_f32_16x16x32_bf16 v[196:199], v[100:103], a[56:59], v[196:199]
ds_read_b64_tr_b16 v[80:81], v14 offset:1024
s_add_u32 m0, s76, 32768
v_mfma_f32_16x16x32_bf16 v[212:215], v[100:103], a[60:63], v[212:215]
ds_read_b64_tr_b16 v[82:83], v14 offset:17408
s_add_u32 s77, s84, 0x80
v_mfma_f32_16x16x32_bf16 v[200:203], v[104:107], a[56:59], v[200:203]
ds_read_b64_tr_b16 v[84:85], v15 offset:1024
v_fma_f32 v244, v244, v62, v62
v_mfma_f32_16x16x32_bf16 v[216:219], v[104:107], a[60:63], v[216:219]
ds_read_b64_tr_b16 v[86:87], v15 offset:17408
v_fma_f32 v245, v245, v62, v62
v_mfma_f32_16x16x32_bf16 v[204:207], v[108:111], a[56:59], v[204:207]
ds_read_b64_tr_b16 v[88:89], v16 offset:1024
v_fma_f32 v246, v246, v62, v62
v_mfma_f32_16x16x32_bf16 v[220:223], v[108:111], a[60:63], v[220:223]
ds_read_b64_tr_b16 v[90:91], v16 offset:17408
s_waitcnt lgkmcnt(8)
v_mfma_f32_16x16x32_bf16 v[192:195], v[112:115], a[64:67], v[192:195]
ds_read_b64_tr_b16 v[92:93], v17 offset:1024
v_fma_f32 v247, v247, v62, v62
v_mfma_f32_16x16x32_bf16 v[208:211], v[112:115], a[68:71], v[208:211]
ds_read_b64_tr_b16 v[94:95], v17 offset:17408
ds_read_b64_tr_b16 v[96:97], v14 offset:2048
v_mfma_f32_16x16x32_bf16 v[196:199], v[116:119], a[64:67], v[196:199]
buffer_load_dwordx4 v30, s[40:43], s77 offen offset:0 lds
v_mfma_f32_16x16x32_bf16 v[212:215], v[116:119], a[68:71], v[212:215]
ds_read_b64_tr_b16 v[98:99], v14 offset:18432
ds_read_b64_tr_b16 v[100:101], v15 offset:2048
v_mfma_f32_16x16x32_bf16 v[200:203], v[120:123], a[64:67], v[200:203]
v_rcp_f32 v244, v244
v_mfma_f32_16x16x32_bf16 v[216:219], v[120:123], a[68:71], v[216:219]
ds_read_b64_tr_b16 v[102:103], v15 offset:18432
s_waitcnt lgkmcnt(7)
v_mfma_f32_16x16x32_bf16 v[204:207], v[124:127], a[64:67], v[204:207]
ds_read_b64_tr_b16 v[104:105], v16 offset:2048
ds_read_b64_tr_b16 v[106:107], v16 offset:18432
v_mfma_f32_16x16x32_bf16 v[220:223], v[124:127], a[68:71], v[220:223]
buffer_load_dwordx4 v31, s[40:43], s77 offen offset:1024 lds
v_mfma_f32_16x16x32_bf16 v[192:195], v[80:83], a[72:75], v[192:195]
ds_read_b64_tr_b16 v[108:109], v17 offset:2048
ds_read_b64_tr_b16 v[110:111], v17 offset:18432
v_mfma_f32_16x16x32_bf16 v[208:211], v[80:83], a[76:79], v[208:211]
v_rcp_f32 v245, v245
v_mfma_f32_16x16x32_bf16 v[196:199], v[84:87], a[72:75], v[196:199]
ds_read_b64_tr_b16 v[112:113], v14 offset:3072
ds_read_b64_tr_b16 v[114:115], v14 offset:19456
v_mfma_f32_16x16x32_bf16 v[212:215], v[84:87], a[76:79], v[212:215]
ds_read_b64_tr_b16 v[116:117], v15 offset:3072
s_waitcnt lgkmcnt(8)
v_mfma_f32_16x16x32_bf16 v[200:203], v[88:91], a[72:75], v[200:203]
buffer_load_dwordx4 v32, s[40:43], s77 offen offset:2048 lds
v_mfma_f32_16x16x32_bf16 v[216:219], v[88:91], a[76:79], v[216:219]
ds_read_b64_tr_b16 v[118:119], v15 offset:19456
ds_read_b64_tr_b16 v[120:121], v16 offset:3072
v_mfma_f32_16x16x32_bf16 v[204:207], v[92:95], a[72:75], v[204:207]
v_rcp_f32 v246, v246
v_mfma_f32_16x16x32_bf16 v[220:223], v[92:95], a[76:79], v[220:223]
ds_read_b64_tr_b16 v[122:123], v16 offset:19456
ds_read_b64_tr_b16 v[124:125], v17 offset:3072
v_mfma_f32_16x16x32_bf16 v[192:195], v[96:99], a[80:83], v[192:195]
v_rcp_f32 v247, v247
v_mfma_f32_16x16x32_bf16 v[208:211], v[96:99], a[84:87], v[208:211]
ds_read_b64_tr_b16 v[126:127], v17 offset:19456
s_waitcnt lgkmcnt(6)
v_mfma_f32_16x16x32_bf16 v[196:199], v[100:103], a[80:83], v[196:199]
ds_read_b64_tr_b16 v[80:81], v14 offset:4096
v_mul_f32 v132, v132, v244
v_mfma_f32_16x16x32_bf16 v[212:215], v[100:103], a[84:87], v[212:215]
ds_read_b64_tr_b16 v[82:83], v14 offset:20480
v_mul_f32 v133, v133, v245
v_mfma_f32_16x16x32_bf16 v[200:203], v[104:107], a[80:83], v[200:203]
ds_read_b64_tr_b16 v[84:85], v15 offset:4096
v_mul_f32 v134, v134, v246
v_mfma_f32_16x16x32_bf16 v[216:219], v[104:107], a[84:87], v[216:219]
ds_read_b64_tr_b16 v[86:87], v15 offset:20480
v_mul_f32 v135, v135, v247
v_mfma_f32_16x16x32_bf16 v[204:207], v[108:111], a[80:83], v[204:207]
ds_read_b64_tr_b16 v[88:89], v16 offset:4096
v_mul_f32 v240, v60, v136
v_mfma_f32_16x16x32_bf16 v[220:223], v[108:111], a[84:87], v[220:223]
ds_read_b64_tr_b16 v[90:91], v16 offset:20480
v_mul_f32 v241, v60, v137
v_mfma_f32_16x16x32_bf16 v[192:195], v[112:115], a[88:91], v[192:195]
ds_read_b64_tr_b16 v[92:93], v17 offset:4096
v_mul_f32 v242, v60, v138
v_mfma_f32_16x16x32_bf16 v[208:211], v[112:115], a[92:95], v[208:211]
ds_read_b64_tr_b16 v[94:95], v17 offset:20480
s_waitcnt lgkmcnt(7)
v_mfma_f32_16x16x32_bf16 v[196:199], v[116:119], a[88:91], v[196:199]
ds_read_b64_tr_b16 v[96:97], v14 offset:5120
v_mul_f32 v243, v60, v139
v_mfma_f32_16x16x32_bf16 v[212:215], v[116:119], a[92:95], v[212:215]
ds_read_b64_tr_b16 v[98:99], v14 offset:21504
ds_read_b64_tr_b16 v[100:101], v15 offset:5120
v_mfma_f32_16x16x32_bf16 v[200:203], v[120:123], a[88:91], v[200:203]
buffer_load_dwordx4 v33, s[40:43], s77 offen offset:3072 lds
v_mfma_f32_16x16x32_bf16 v[216:219], v[120:123], a[92:95], v[216:219]
ds_read_b64_tr_b16 v[102:103], v15 offset:21504
ds_read_b64_tr_b16 v[104:105], v16 offset:5120
v_mfma_f32_16x16x32_bf16 v[204:207], v[124:127], a[88:91], v[204:207]
v_exp_f32 v240, v240
v_mfma_f32_16x16x32_bf16 v[220:223], v[124:127], a[92:95], v[220:223]
ds_read_b64_tr_b16 v[106:107], v16 offset:21504
s_waitcnt lgkmcnt(7)
v_mfma_f32_16x16x32_bf16 v[192:195], v[80:83], a[96:99], v[192:195]
ds_read_b64_tr_b16 v[108:109], v17 offset:5120
ds_read_b64_tr_b16 v[110:111], v17 offset:21504
v_mfma_f32_16x16x32_bf16 v[208:211], v[80:83], a[100:103], v[208:211]
s_add_u32 m0, s76, 36864
s_add_u32 s77, s84, 0xe0080
v_mfma_f32_16x16x32_bf16 v[196:199], v[84:87], a[96:99], v[196:199]
ds_read_b64_tr_b16 v[112:113], v14 offset:6144
ds_read_b64_tr_b16 v[114:115], v14 offset:22528
v_mfma_f32_16x16x32_bf16 v[212:215], v[84:87], a[100:103], v[212:215]
buffer_load_dwordx4 v30, s[40:43], s77 offen offset:0 lds
v_mfma_f32_16x16x32_bf16 v[200:203], v[88:91], a[96:99], v[200:203]
ds_read_b64_tr_b16 v[116:117], v15 offset:6144
ds_read_b64_tr_b16 v[118:119], v15 offset:22528
v_mfma_f32_16x16x32_bf16 v[216:219], v[88:91], a[100:103], v[216:219]
ds_read_b64_tr_b16 v[120:121], v16 offset:6144
s_waitcnt lgkmcnt(8)
v_mfma_f32_16x16x32_bf16 v[204:207], v[92:95], a[96:99], v[204:207]
v_exp_f32 v241, v241
v_mfma_f32_16x16x32_bf16 v[220:223], v[92:95], a[100:103], v[220:223]
ds_read_b64_tr_b16 v[122:123], v16 offset:22528
ds_read_b64_tr_b16 v[124:125], v17 offset:6144
v_mfma_f32_16x16x32_bf16 v[192:195], v[96:99], a[104:107], v[192:195]
buffer_load_dwordx4 v31, s[40:43], s77 offen offset:1024 lds
v_mfma_f32_16x16x32_bf16 v[208:211], v[96:99], a[108:111], v[208:211]
ds_read_b64_tr_b16 v[126:127], v17 offset:22528
ds_read_b64_tr_b16 v[80:81], v14 offset:7168
v_mfma_f32_16x16x32_bf16 v[196:199], v[100:103], a[104:107], v[196:199]
v_exp_f32 v242, v242
v_mfma_f32_16x16x32_bf16 v[212:215], v[100:103], a[108:111], v[212:215]
ds_read_b64_tr_b16 v[82:83], v14 offset:23552
s_waitcnt lgkmcnt(6)
v_mfma_f32_16x16x32_bf16 v[200:203], v[104:107], a[104:107], v[200:203]
ds_read_b64_tr_b16 v[84:85], v15 offset:7168
ds_read_b64_tr_b16 v[86:87], v15 offset:23552
v_mfma_f32_16x16x32_bf16 v[216:219], v[104:107], a[108:111], v[216:219]
buffer_load_dwordx4 v32, s[40:43], s77 offen offset:2048 lds
v_mfma_f32_16x16x32_bf16 v[204:207], v[108:111], a[104:107], v[204:207]
ds_read_b64_tr_b16 v[88:89], v16 offset:7168
ds_read_b64_tr_b16 v[90:91], v16 offset:23552
v_mfma_f32_16x16x32_bf16 v[220:223], v[108:111], a[108:111], v[220:223]
v_exp_f32 v243, v243
v_mfma_f32_16x16x32_bf16 v[192:195], v[112:115], a[112:115], v[192:195]
ds_read_b64_tr_b16 v[92:93], v17 offset:7168
v_fma_f32 v240, v240, v62, v62
v_mfma_f32_16x16x32_bf16 v[208:211], v[112:115], a[116:119], v[208:211]
ds_read_b64_tr_b16 v[94:95], v17 offset:23552
v_fma_f32 v241, v241, v62, v62
v_mfma_f32_16x16x32_bf16 v[196:199], v[116:119], a[112:115], v[196:199]
buffer_load_dwordx4 v33, s[40:43], s77 offen offset:3072 lds
v_mfma_f32_16x16x32_bf16 v[212:215], v[116:119], a[116:119], v[212:215]
v_fma_f32 v242, v242, v62, v62
s_waitcnt lgkmcnt(4)
v_mfma_f32_16x16x32_bf16 v[200:203], v[120:123], a[112:115], v[200:203]
v_fma_f32 v243, v243, v62, v62
v_mfma_f32_16x16x32_bf16 v[216:219], v[120:123], a[116:119], v[216:219]
v_rcp_f32 v240, v240
v_mfma_f32_16x16x32_bf16 v[204:207], v[124:127], a[112:115], v[204:207]
s_waitcnt vmcnt(17) lgkmcnt(0)
s_barrier
v_mfma_f32_16x16x32_bf16 v[220:223], v[124:127], a[116:119], v[220:223]
ds_read_b64_tr_b16 v[96:97], v14 offset:32768
ds_read_b64_tr_b16 v[98:99], v14 offset:49152
v_mfma_f32_16x16x32_bf16 v[192:195], v[80:83], a[120:123], v[192:195]
ds_read_b64_tr_b16 v[100:101], v15 offset:32768
ds_read_b64_tr_b16 v[102:103], v15 offset:49152
v_mfma_f32_16x16x32_bf16 v[208:211], v[80:83], a[124:127], v[208:211]
ds_read_b64_tr_b16 v[104:105], v16 offset:32768
ds_read_b64_tr_b16 v[106:107], v16 offset:49152
v_mfma_f32_16x16x32_bf16 v[196:199], v[84:87], a[120:123], v[196:199]
ds_read_b64_tr_b16 v[108:109], v17 offset:32768
ds_read_b64_tr_b16 v[110:111], v17 offset:49152
v_mfma_f32_16x16x32_bf16 v[212:215], v[84:87], a[124:127], v[212:215]
ds_read_b64_tr_b16 v[112:113], v14 offset:33792
ds_read_b64_tr_b16 v[114:115], v14 offset:50176
v_mfma_f32_16x16x32_bf16 v[200:203], v[88:91], a[120:123], v[200:203]
ds_read_b64_tr_b16 v[116:117], v15 offset:33792
s_add_u32 m0, s76, 65536
v_mfma_f32_16x16x32_bf16 v[216:219], v[88:91], a[124:127], v[216:219]
ds_read_b64_tr_b16 v[118:119], v15 offset:50176
s_add_u32 s77, s84, 0x1c0080
v_mfma_f32_16x16x32_bf16 v[204:207], v[92:95], a[120:123], v[204:207]
ds_read_b64_tr_b16 v[120:121], v16 offset:33792
ds_read_b64_tr_b16 v[122:123], v16 offset:50176
v_mfma_f32_16x16x32_bf16 v[220:223], v[92:95], a[124:127], v[220:223]
ds_read_b64_tr_b16 v[124:125], v17 offset:33792
s_waitcnt lgkmcnt(11)
v_mfma_f32_16x16x32_bf16 v[192:195], v[96:99], a[128:131], v[192:195]
buffer_load_dwordx4 v30, s[40:43], s77 offen offset:0 lds
v_mfma_f32_16x16x32_bf16 v[208:211], v[96:99], a[132:135], v[208:211]
ds_read_b64_tr_b16 v[126:127], v17 offset:50176
ds_read_b64_tr_b16 v[80:81], v14 offset:34816
v_mfma_f32_16x16x32_bf16 v[196:199], v[100:103], a[128:131], v[196:199]
v_rcp_f32 v241, v241
v_mfma_f32_16x16x32_bf16 v[212:215], v[100:103], a[132:135], v[212:215]
ds_read_b64_tr_b16 v[82:83], v14 offset:51200
s_waitcnt lgkmcnt(7)
v_mfma_f32_16x16x32_bf16 v[200:203], v[104:107], a[128:131], v[200:203]
ds_read_b64_tr_b16 v[84:85], v15 offset:34816
ds_read_b64_tr_b16 v[86:87], v15 offset:51200
v_mfma_f32_16x16x32_bf16 v[216:219], v[104:107], a[132:135], v[216:219]
buffer_load_dwordx4 v31, s[40:43], s77 offen offset:1024 lds
v_mfma_f32_16x16x32_bf16 v[204:207], v[108:111], a[128:131], v[204:207]
ds_read_b64_tr_b16 v[88:89], v16 offset:34816
ds_read_b64_tr_b16 v[90:91], v16 offset:51200
v_mfma_f32_16x16x32_bf16 v[220:223], v[108:111], a[132:135], v[220:223]
v_rcp_f32 v242, v242
v_mfma_f32_16x16x32_bf16 v[192:195], v[112:115], a[136:139], v[192:195]
ds_read_b64_tr_b16 v[92:93], v17 offset:34816
ds_read_b64_tr_b16 v[94:95], v17 offset:51200
v_mfma_f32_16x16x32_bf16 v[208:211], v[112:115], a[140:143], v[208:211]
ds_read_b64_tr_b16 v[96:97], v14 offset:35840
s_waitcnt lgkmcnt(8)
v_mfma_f32_16x16x32_bf16 v[196:199], v[116:119], a[136:139], v[196:199]
buffer_load_dwordx4 v32, s[40:43], s77 offen offset:2048 lds
v_mfma_f32_16x16x32_bf16 v[212:215], v[116:119], a[140:143], v[212:215]
ds_read_b64_tr_b16 v[98:99], v14 offset:52224
ds_read_b64_tr_b16 v[100:101], v15 offset:35840
v_mfma_f32_16x16x32_bf16 v[200:203], v[120:123], a[136:139], v[200:203]
v_rcp_f32 v243, v243
v_mfma_f32_16x16x32_bf16 v[216:219], v[120:123], a[140:143], v[216:219]
ds_read_b64_tr_b16 v[102:103], v15 offset:52224
v_mul_f32 v136, v136, v240
v_mfma_f32_16x16x32_bf16 v[204:207], v[124:127], a[136:139], v[204:207]
ds_read_b64_tr_b16 v[104:105], v16 offset:35840
v_mul_f32 v137, v137, v241
v_mfma_f32_16x16x32_bf16 v[220:223], v[124:127], a[140:143], v[220:223]
ds_read_b64_tr_b16 v[106:107], v16 offset:52224
s_waitcnt lgkmcnt(6)
v_mfma_f32_16x16x32_bf16 v[192:195], v[80:83], a[144:147], v[192:195]
ds_read_b64_tr_b16 v[108:109], v17 offset:35840
v_mul_f32 v138, v138, v242
v_mfma_f32_16x16x32_bf16 v[208:211], v[80:83], a[148:151], v[208:211]
ds_read_b64_tr_b16 v[110:111], v17 offset:52224
v_mul_f32 v139, v139, v243
v_mfma_f32_16x16x32_bf16 v[196:199], v[84:87], a[144:147], v[196:199]
ds_read_b64_tr_b16 v[112:113], v14 offset:36864
v_mul_f32 v244, v60, v140
v_mfma_f32_16x16x32_bf16 v[212:215], v[84:87], a[148:151], v[212:215]
ds_read_b64_tr_b16 v[114:115], v14 offset:53248
v_mul_f32 v245, v60, v141
v_mfma_f32_16x16x32_bf16 v[200:203], v[88:91], a[144:147], v[200:203]
ds_read_b64_tr_b16 v[116:117], v15 offset:36864
v_mul_f32 v246, v60, v142
v_mfma_f32_16x16x32_bf16 v[216:219], v[88:91], a[148:151], v[216:219]
ds_read_b64_tr_b16 v[118:119], v15 offset:53248
v_mul_f32 v247, v60, v143
v_mfma_f32_16x16x32_bf16 v[204:207], v[92:95], a[144:147], v[204:207]
ds_read_b64_tr_b16 v[120:121], v16 offset:36864
ds_read_b64_tr_b16 v[122:123], v16 offset:53248
v_mfma_f32_16x16x32_bf16 v[220:223], v[92:95], a[148:151], v[220:223]
ds_read_b64_tr_b16 v[124:125], v17 offset:36864
s_waitcnt lgkmcnt(8)
v_mfma_f32_16x16x32_bf16 v[192:195], v[96:99], a[152:155], v[192:195]
buffer_load_dwordx4 v33, s[40:43], s77 offen offset:3072 lds
v_mfma_f32_16x16x32_bf16 v[208:211], v[96:99], a[156:159], v[208:211]
ds_read_b64_tr_b16 v[126:127], v17 offset:53248
ds_read_b64_tr_b16 v[80:81], v14 offset:37888
v_mfma_f32_16x16x32_bf16 v[196:199], v[100:103], a[152:155], v[196:199]
v_exp_f32 v244, v244
v_mfma_f32_16x16x32_bf16 v[212:215], v[100:103], a[156:159], v[212:215]
ds_read_b64_tr_b16 v[82:83], v14 offset:54272
ds_read_b64_tr_b16 v[84:85], v15 offset:37888
v_mfma_f32_16x16x32_bf16 v[200:203], v[104:107], a[152:155], v[200:203]
v_exp_f32 v245, v245
v_mfma_f32_16x16x32_bf16 v[216:219], v[104:107], a[156:159], v[216:219]
ds_read_b64_tr_b16 v[86:87], v15 offset:54272
s_waitcnt lgkmcnt(6)
v_mfma_f32_16x16x32_bf16 v[204:207], v[108:111], a[152:155], v[204:207]
ds_read_b64_tr_b16 v[88:89], v16 offset:37888
s_add_u32 m0, s76, 69632
v_mfma_f32_16x16x32_bf16 v[220:223], v[108:111], a[156:159], v[220:223]
ds_read_b64_tr_b16 v[90:91], v16 offset:54272
s_add_u32 s77, s84, 0x2a0080
v_mfma_f32_16x16x32_bf16 v[192:195], v[112:115], a[160:163], v[192:195]
ds_read_b64_tr_b16 v[92:93], v17 offset:37888
ds_read_b64_tr_b16 v[94:95], v17 offset:54272
v_mfma_f32_16x16x32_bf16 v[208:211], v[112:115], a[164:167], v[208:211]
buffer_load_dwordx4 v30, s[40:43], s77 offen offset:0 lds
v_mfma_f32_16x16x32_bf16 v[196:199], v[116:119], a[160:163], v[196:199]
ds_read_b64_tr_b16 v[96:97], v14 offset:38912
ds_read_b64_tr_b16 v[98:99], v14 offset:55296
v_mfma_f32_16x16x32_bf16 v[212:215], v[116:119], a[164:167], v[212:215]
v_exp_f32 v246, v246
v_mfma_f32_16x16x32_bf16 v[200:203], v[120:123], a[160:163], v[200:203]
ds_read_b64_tr_b16 v[100:101], v15 offset:38912
ds_read_b64_tr_b16 v[102:103], v15 offset:55296
v_mfma_f32_16x16x32_bf16 v[216:219], v[120:123], a[164:167], v[216:219]
ds_read_b64_tr_b16 v[104:105], v16 offset:38912
s_waitcnt lgkmcnt(8)
v_mfma_f32_16x16x32_bf16 v[204:207], v[124:127], a[160:163], v[204:207]
buffer_load_dwordx4 v31, s[40:43], s77 offen offset:1024 lds
v_mfma_f32_16x16x32_bf16 v[220:223], v[124:127], a[164:167], v[220:223]
ds_read_b64_tr_b16 v[106:107], v16 offset:55296
ds_read_b64_tr_b16 v[108:109], v17 offset:38912
v_mfma_f32_16x16x32_bf16 v[192:195], v[80:83], a[168:171], v[192:195]
v_exp_f32 v247, v247
v_mfma_f32_16x16x32_bf16 v[208:211], v[80:83], a[172:175], v[208:211]
ds_read_b64_tr_b16 v[110:111], v17 offset:55296
v_fma_f32 v244, v244, v62, v62
v_mfma_f32_16x16x32_bf16 v[196:199], v[84:87], a[168:171], v[196:199]
ds_read_b64_tr_b16 v[112:113], v14 offset:39936
v_fma_f32 v245, v245, v62, v62
v_mfma_f32_16x16x32_bf16 v[212:215], v[84:87], a[172:175], v[212:215]
ds_read_b64_tr_b16 v[114:115], v14 offset:56320
s_waitcnt lgkmcnt(6)
v_mfma_f32_16x16x32_bf16 v[200:203], v[88:91], a[168:171], v[200:203]
ds_read_b64_tr_b16 v[116:117], v15 offset:39936
v_fma_f32 v246, v246, v62, v62
v_mfma_f32_16x16x32_bf16 v[216:219], v[88:91], a[172:175], v[216:219]
ds_read_b64_tr_b16 v[118:119], v15 offset:56320
v_fma_f32 v247, v247, v62, v62
v_mfma_f32_16x16x32_bf16 v[204:207], v[92:95], a[168:171], v[204:207]
ds_read_b64_tr_b16 v[120:121], v16 offset:39936
ds_read_b64_tr_b16 v[122:123], v16 offset:56320
v_mfma_f32_16x16x32_bf16 v[220:223], v[92:95], a[172:175], v[220:223]
buffer_load_dwordx4 v32, s[40:43], s77 offen offset:2048 lds
v_mfma_f32_16x16x32_bf16 v[192:195], v[96:99], a[176:179], v[192:195]
ds_read_b64_tr_b16 v[124:125], v17 offset:39936
ds_read_b64_tr_b16 v[126:127], v17 offset:56320
v_mfma_f32_16x16x32_bf16 v[208:211], v[96:99], a[180:183], v[208:211]
buffer_load_dwordx4 v33, s[40:43], s77 offen offset:3072 lds
v_mfma_f32_16x16x32_bf16 v[196:199], v[100:103], a[176:179], v[196:199]
v_rcp_f32 v244, v244
v_mfma_f32_16x16x32_bf16 v[212:215], v[100:103], a[180:183], v[212:215]
s_waitcnt lgkmcnt(5)
v_mfma_f32_16x16x32_bf16 v[200:203], v[104:107], a[176:179], v[200:203]
v_rcp_f32 v245, v245
v_mfma_f32_16x16x32_bf16 v[216:219], v[104:107], a[180:183], v[216:219]
s_waitcnt vmcnt(16) lgkmcnt(0)
s_barrier
v_mfma_f32_16x16x32_bf16 v[204:207], v[108:111], a[176:179], v[204:207]
ds_read_b64_tr_b16 v[80:81], v10 offset:0
ds_read_b64_tr_b16 v[82:83], v10 offset:16384
v_mfma_f32_16x16x32_bf16 v[220:223], v[108:111], a[180:183], v[220:223]
ds_read_b64_tr_b16 v[84:85], v11 offset:0
ds_read_b64_tr_b16 v[86:87], v11 offset:16384
v_mfma_f32_16x16x32_bf16 v[192:195], v[112:115], a[184:187], v[192:195]
ds_read_b64_tr_b16 v[88:89], v12 offset:0
ds_read_b64_tr_b16 v[90:91], v12 offset:16384
v_mfma_f32_16x16x32_bf16 v[208:211], v[112:115], a[188:191], v[208:211]
ds_read_b64_tr_b16 v[92:93], v13 offset:0
ds_read_b64_tr_b16 v[94:95], v13 offset:16384
v_mfma_f32_16x16x32_bf16 v[196:199], v[116:119], a[184:187], v[196:199]
ds_read_b64_tr_b16 v[96:97], v10 offset:1024
s_add_u32 m0, s76, 98304
v_mfma_f32_16x16x32_bf16 v[212:215], v[116:119], a[188:191], v[212:215]
ds_read_b64_tr_b16 v[98:99], v10 offset:17408
s_add_u32 s77, s84, 0x380080
v_mfma_f32_16x16x32_bf16 v[200:203], v[120:123], a[184:187], v[200:203]
ds_read_b64_tr_b16 v[100:101], v11 offset:1024
ds_read_b64_tr_b16 v[102:103], v11 offset:17408
v_mfma_f32_16x16x32_bf16 v[216:219], v[120:123], a[188:191], v[216:219]
buffer_load_dwordx4 v30, s[40:43], s77 offen offset:0 lds
v_mfma_f32_16x16x32_bf16 v[204:207], v[124:127], a[184:187], v[204:207]
ds_read_b64_tr_b16 v[104:105], v12 offset:1024
ds_read_b64_tr_b16 v[106:107], v12 offset:17408
v_mfma_f32_16x16x32_bf16 v[220:223], v[124:127], a[188:191], v[220:223]
ds_read_b64_tr_b16 v[108:109], v13 offset:1024
s_waitcnt lgkmcnt(9)
v_mfma_f32_16x16x32_bf16 v[192:195], v[80:83], a[192:195], v[192:195]
v_rcp_f32 v246, v246
v_mfma_f32_16x16x32_bf16 v[208:211], v[80:83], a[196:199], v[208:211]
ds_read_b64_tr_b16 v[110:111], v13 offset:17408
ds_read_b64_tr_b16 v[112:113], v10 offset:2048
v_mfma_f32_16x16x32_bf16 v[196:199], v[84:87], a[192:195], v[196:199]
buffer_load_dwordx4 v31, s[40:43], s77 offen offset:1024 lds
v_mfma_f32_16x16x32_bf16 v[212:215], v[84:87], a[196:199], v[212:215]
ds_read_b64_tr_b16 v[114:115], v10 offset:18432
ds_read_b64_tr_b16 v[116:117], v11 offset:2048
v_mfma_f32_16x16x32_bf16 v[200:203], v[88:91], a[192:195], v[200:203]
v_rcp_f32 v247, v247
v_mfma_f32_16x16x32_bf16 v[216:219], v[88:91], a[196:199], v[216:219]
ds_read_b64_tr_b16 v[118:119], v11 offset:18432
s_waitcnt lgkmcnt(6)
v_mfma_f32_16x16x32_bf16 v[204:207], v[92:95], a[192:195], v[204:207]
ds_read_b64_tr_b16 v[120:121], v12 offset:2048
v_mul_f32 v140, v140, v244
v_mfma_f32_16x16x32_bf16 v[220:223], v[92:95], a[196:199], v[220:223]
ds_read_b64_tr_b16 v[122:123], v12 offset:18432
v_mul_f32 v141, v141, v245
v_mfma_f32_16x16x32_bf16 v[192:195], v[96:99], a[200:203], v[192:195]
ds_read_b64_tr_b16 v[124:125], v13 offset:2048
v_mul_f32 v142, v142, v246
v_mfma_f32_16x16x32_bf16 v[208:211], v[96:99], a[204:207], v[208:211]
ds_read_b64_tr_b16 v[126:127], v13 offset:18432
v_mul_f32 v143, v143, v247
v_mfma_f32_16x16x32_bf16 v[196:199], v[100:103], a[200:203], v[196:199]
ds_read_b64_tr_b16 v[80:81], v10 offset:3072
v_mul_f32 v240, v61, v144
v_mfma_f32_16x16x32_bf16 v[212:215], v[100:103], a[204:207], v[212:215]
ds_read_b64_tr_b16 v[82:83], v10 offset:19456
v_mul_f32 v241, v61, v145
v_mfma_f32_16x16x32_bf16 v[200:203], v[104:107], a[200:203], v[200:203]
ds_read_b64_tr_b16 v[84:85], v11 offset:3072
v_mul_f32 v242, v61, v146
v_mfma_f32_16x16x32_bf16 v[216:219], v[104:107], a[204:207], v[216:219]
ds_read_b64_tr_b16 v[86:87], v11 offset:19456
s_waitcnt lgkmcnt(7)
v_mfma_f32_16x16x32_bf16 v[204:207], v[108:111], a[200:203], v[204:207]
ds_read_b64_tr_b16 v[88:89], v12 offset:3072
v_mul_f32 v243, v61, v147
v_mfma_f32_16x16x32_bf16 v[220:223], v[108:111], a[204:207], v[220:223]
ds_read_b64_tr_b16 v[90:91], v12 offset:19456
ds_read_b64_tr_b16 v[92:93], v13 offset:3072
v_mfma_f32_16x16x32_bf16 v[192:195], v[112:115], a[208:211], v[192:195]
buffer_load_dwordx4 v32, s[40:43], s77 offen offset:2048 lds
v_mfma_f32_16x16x32_bf16 v[208:211], v[112:115], a[212:215], v[208:211]
ds_read_b64_tr_b16 v[94:95], v13 offset:19456
ds_read_b64_tr_b16 v[96:97], v10 offset:4096
v_mfma_f32_16x16x32_bf16 v[196:199], v[116:119], a[208:211], v[196:199]
v_exp_f32 v240, v240
v_mfma_f32_16x16x32_bf16 v[212:215], v[116:119], a[212:215], v[212:215]
ds_read_b64_tr_b16 v[98:99], v10 offset:20480
s_waitcnt lgkmcnt(7)
v_mfma_f32_16x16x32_bf16 v[200:203], v[120:123], a[208:211], v[200:203]
ds_read_b64_tr_b16 v[100:101], v11 offset:4096
ds_read_b64_tr_b16 v[102:103], v11 offset:20480
v_mfma_f32_16x16x32_bf16 v[216:219], v[120:123], a[212:215], v[216:219]
buffer_load_dwordx4 v33, s[40:43], s77 offen offset:3072 lds
v_mfma_f32_16x16x32_bf16 v[204:207], v[124:127], a[208:211], v[204:207]
ds_read_b64_tr_b16 v[104:105], v12 offset:4096
ds_read_b64_tr_b16 v[106:107], v12 offset:20480
v_mfma_f32_16x16x32_bf16 v[220:223], v[124:127], a[212:215], v[220:223]
v_exp_f32 v241, v241
v_mfma_f32_16x16x32_bf16 v[192:195], v[80:83], a[216:219], v[192:195]
ds_read_b64_tr_b16 v[108:109], v13 offset:4096
ds_read_b64_tr_b16 v[110:111], v13 offset:20480
v_mfma_f32_16x16x32_bf16 v[208:211], v[80:83], a[220:223], v[208:211]
ds_read_b64_tr_b16 v[112:113], v10 offset:5120
s_waitcnt lgkmcnt(8)
v_mfma_f32_16x16x32_bf16 v[196:199], v[84:87], a[216:219], v[196:199]
s_add_u32 m0, s76, 102400
s_add_u32 s77, s84, 0x460080
v_mfma_f32_16x16x32_bf16 v[212:215], v[84:87], a[220:223], v[212:215]
ds_read_b64_tr_b16 v[114:115], v10 offset:21504
ds_read_b64_tr_b16 v[116:117], v11 offset:5120
v_mfma_f32_16x16x32_bf16 v[200:203], v[88:91], a[216:219], v[200:203]
buffer_load_dwordx4 v30, s[40:43], s77 offen offset:0 lds
v_mfma_f32_16x16x32_bf16 v[216:219], v[88:91], a[220:223], v[216:219]
ds_read_b64_tr_b16 v[118:119], v11 offset:21504
ds_read_b64_tr_b16 v[120:121], v12 offset:5120
v_mfma_f32_16x16x32_bf16 v[204:207], v[92:95], a[216:219], v[204:207]
v_exp_f32 v242, v242
v_mfma_f32_16x16x32_bf16 v[220:223], v[92:95], a[220:223], v[220:223]
ds_read_b64_tr_b16 v[122:123], v12 offset:21504
s_waitcnt lgkmcnt(6)
v_mfma_f32_16x16x32_bf16 v[192:195], v[96:99], a[224:227], v[192:195]
ds_read_b64_tr_b16 v[124:125], v13 offset:5120
ds_read_b64_tr_b16 v[126:127], v13 offset:21504
v_mfma_f32_16x16x32_bf16 v[208:211], v[96:99], a[228:231], v[208:211]
buffer_load_dwordx4 v31, s[40:43], s77 offen offset:1024 lds
v_mfma_f32_16x16x32_bf16 v[196:199], v[100:103], a[224:227], v[196:199]
ds_read_b64_tr_b16 v[80:81], v10 offset:6144
ds_read_b64_tr_b16 v[82:83], v10 offset:22528
v_mfma_f32_16x16x32_bf16 v[212:215], v[100:103], a[228:231], v[212:215]
v_exp_f32 v243, v243
v_mfma_f32_16x16x32_bf16 v[200:203], v[104:107], a[224:227], v[200:203]
ds_read_b64_tr_b16 v[84:85], v11 offset:6144
v_fma_f32 v240, v240, v63, v63
v_mfma_f32_16x16x32_bf16 v[216:219], v[104:107], a[228:231], v[216:219]
ds_read_b64_tr_b16 v[86:87], v11 offset:22528
v_fma_f32 v241, v241, v63, v63
v_mfma_f32_16x16x32_bf16 v[204:207], v[108:111], a[224:227], v[204:207]
ds_read_b64_tr_b16 v[88:89], v12 offset:6144
v_fma_f32 v242, v242, v63, v63
v_mfma_f32_16x16x32_bf16 v[220:223], v[108:111], a[228:231], v[220:223]
ds_read_b64_tr_b16 v[90:91], v12 offset:22528
s_waitcnt lgkmcnt(6)
v_mfma_f32_16x16x32_bf16 v[192:195], v[112:115], a[232:235], v[192:195]
ds_read_b64_tr_b16 v[92:93], v13 offset:6144
v_fma_f32 v243, v243, v63, v63
v_mfma_f32_16x16x32_bf16 v[208:211], v[112:115], a[236:239], v[208:211]
ds_read_b64_tr_b16 v[94:95], v13 offset:22528
ds_read_b64_tr_b16 v[96:97], v10 offset:7168
v_mfma_f32_16x16x32_bf16 v[196:199], v[116:119], a[232:235], v[196:199]
buffer_load_dwordx4 v32, s[40:43], s77 offen offset:2048 lds
v_mfma_f32_16x16x32_bf16 v[212:215], v[116:119], a[236:239], v[212:215]
ds_read_b64_tr_b16 v[98:99], v10 offset:23552
ds_read_b64_tr_b16 v[100:101], v11 offset:7168
v_mfma_f32_16x16x32_bf16 v[200:203], v[120:123], a[232:235], v[200:203]
v_rcp_f32 v240, v240
v_mfma_f32_16x16x32_bf16 v[216:219], v[120:123], a[236:239], v[216:219]
ds_read_b64_tr_b16 v[102:103], v11 offset:23552
ds_read_b64_tr_b16 v[104:105], v12 offset:7168
v_mfma_f32_16x16x32_bf16 v[204:207], v[124:127], a[232:235], v[204:207]
v_rcp_f32 v241, v241
v_mfma_f32_16x16x32_bf16 v[220:223], v[124:127], a[236:239], v[220:223]
ds_read_b64_tr_b16 v[106:107], v12 offset:23552
s_waitcnt lgkmcnt(7)
v_mfma_f32_16x16x32_bf16 v[192:195], v[80:83], a[240:243], v[192:195]
ds_read_b64_tr_b16 v[108:109], v13 offset:7168
ds_read_b64_tr_b16 v[110:111], v13 offset:23552
v_mfma_f32_16x16x32_bf16 v[208:211], v[80:83], a[244:247], v[208:211]
buffer_load_dwordx4 v33, s[40:43], s77 offen offset:3072 lds
v_mfma_f32_16x16x32_bf16 v[196:199], v[84:87], a[240:243], v[196:199]
v_rcp_f32 v242, v242
v_mfma_f32_16x16x32_bf16 v[212:215], v[84:87], a[244:247], v[212:215]
v_rcp_f32 v243, v243
v_mfma_f32_16x16x32_bf16 v[200:203], v[88:91], a[240:243], v[200:203]
v_mul_f32 v144, v144, v240
v_mul_f32 v145, v145, v241
v_mfma_f32_16x16x32_bf16 v[216:219], v[88:91], a[244:247], v[216:219]
s_waitcnt vmcnt(16) lgkmcnt(0)
s_barrier
v_mfma_f32_16x16x32_bf16 v[204:207], v[92:95], a[240:243], v[204:207]
ds_read_b64_tr_b16 v[112:113], v10 offset:32768
ds_read_b64_tr_b16 v[114:115], v10 offset:49152
v_mfma_f32_16x16x32_bf16 v[220:223], v[92:95], a[244:247], v[220:223]
ds_read_b64_tr_b16 v[116:117], v11 offset:32768
ds_read_b64_tr_b16 v[118:119], v11 offset:49152
v_mfma_f32_16x16x32_bf16 v[192:195], v[96:99], a[248:251], v[192:195]
ds_read_b64_tr_b16 v[120:121], v12 offset:32768
ds_read_b64_tr_b16 v[122:123], v12 offset:49152
v_mfma_f32_16x16x32_bf16 v[208:211], v[96:99], a[252:255], v[208:211]
ds_read_b64_tr_b16 v[124:125], v13 offset:32768
ds_read_b64_tr_b16 v[126:127], v13 offset:49152
v_mfma_f32_16x16x32_bf16 v[196:199], v[100:103], a[248:251], v[196:199]
ds_read_b64_tr_b16 v[80:81], v10 offset:33792
s_add_u32 m0, s76, 0
v_mfma_f32_16x16x32_bf16 v[212:215], v[100:103], a[252:255], v[212:215]
ds_read_b64_tr_b16 v[82:83], v10 offset:50176
s_add_u32 s77, s84, 0x540080
v_mfma_f32_16x16x32_bf16 v[200:203], v[104:107], a[248:251], v[200:203]
ds_read_b64_tr_b16 v[84:85], v11 offset:33792
v_mul_f32 v146, v146, v242
v_mfma_f32_16x16x32_bf16 v[216:219], v[104:107], a[252:255], v[216:219]
ds_read_b64_tr_b16 v[86:87], v11 offset:50176
v_mul_f32 v147, v147, v243
v_mfma_f32_16x16x32_bf16 v[204:207], v[108:111], a[248:251], v[204:207]
ds_read_b64_tr_b16 v[88:89], v12 offset:33792
v_mul_f32 v244, v61, v148
v_mfma_f32_16x16x32_bf16 v[220:223], v[108:111], a[252:255], v[220:223]
ds_read_b64_tr_b16 v[90:91], v12 offset:50176
v_mul_f32 v245, v61, v149
S_G1:
s_waitcnt lgkmcnt(8)
v_mfma_f32_16x16x32_bf16 v[160:163], v[112:115], a[0:3], 0
ds_read_b64_tr_b16 v[92:93], v13 offset:33792
v_mul_f32 v246, v61, v150
v_mfma_f32_16x16x32_bf16 v[176:179], v[112:115], a[4:7], 0
ds_read_b64_tr_b16 v[94:95], v13 offset:50176
v_mul_f32 v247, v61, v151
v_mfma_f32_16x16x32_bf16 v[164:167], v[116:119], a[0:3], 0
ds_read_b64_tr_b16 v[96:97], v10 offset:34816
ds_read_b64_tr_b16 v[98:99], v10 offset:51200
v_mfma_f32_16x16x32_bf16 v[180:183], v[116:119], a[4:7], 0
buffer_load_dwordx4 v30, s[40:43], s77 offen offset:0 lds
v_mfma_f32_16x16x32_bf16 v[168:171], v[120:123], a[0:3], 0
ds_read_b64_tr_b16 v[100:101], v11 offset:34816
ds_read_b64_tr_b16 v[102:103], v11 offset:51200
v_mfma_f32_16x16x32_bf16 v[184:187], v[120:123], a[4:7], 0
ds_read_b64_tr_b16 v[104:105], v12 offset:34816
s_waitcnt lgkmcnt(8)
v_mfma_f32_16x16x32_bf16 v[172:175], v[124:127], a[0:3], 0
s_add_u32 s70, s0, S_U1 - K_pc + 0
s_addc_u32 s71, s1, 0
global_load_dword v57, v9, s[70:71]
v_mfma_f32_16x16x32_bf16 v[188:191], v[124:127], a[4:7], 0
ds_read_b64_tr_b16 v[106:107], v12 offset:51200
ds_read_b64_tr_b16 v[108:109], v13 offset:34816
v_mfma_f32_16x16x32_bf16 v[160:163], v[80:83], a[8:11], v[160:163]
buffer_load_dwordx4 v31, s[40:43], s77 offen offset:1024 lds
v_mfma_f32_16x16x32_bf16 v[176:179], v[80:83], a[12:15], v[176:179]
ds_read_b64_tr_b16 v[110:111], v13 offset:51200
ds_read_b64_tr_b16 v[112:113], v10 offset:35840
v_mfma_f32_16x16x32_bf16 v[164:167], v[84:87], a[8:11], v[164:167]
v_exp_f32 v244, v244
v_mfma_f32_16x16x32_bf16 v[180:183], v[84:87], a[12:15], v[180:183]
ds_read_b64_tr_b16 v[114:115], v10 offset:52224
s_waitcnt lgkmcnt(6)
v_mfma_f32_16x16x32_bf16 v[168:171], v[88:91], a[8:11], v[168:171]
ds_read_b64_tr_b16 v[116:117], v11 offset:35840
s_mov_b32 s3, 0x400000
v_mfma_f32_16x16x32_bf16 v[184:187], v[88:91], a[12:15], v[184:187]
ds_read_b64_tr_b16 v[118:119], v11 offset:52224
ds_read_b64_tr_b16 v[120:121], v12 offset:35840
v_mfma_f32_16x16x32_bf16 v[172:175], v[92:95], a[8:11], v[172:175]
buffer_load_dwordx4 v32, s[40:43], s77 offen offset:2048 lds
v_mfma_f32_16x16x32_bf16 v[188:191], v[92:95], a[12:15], v[188:191]
ds_read_b64_tr_b16 v[122:123], v12 offset:52224
ds_read_b64_tr_b16 v[124:125], v13 offset:35840
v_mfma_f32_16x16x32_bf16 v[160:163], v[96:99], a[16:19], v[160:163]
buffer_load_dword v57, v8, s[48:51], s3 offen
v_mfma_f32_16x16x32_bf16 v[176:179], v[96:99], a[20:23], v[176:179]
ds_read_b64_tr_b16 v[126:127], v13 offset:52224
ds_read_b64_tr_b16 v[80:81], v10 offset:36864
v_mfma_f32_16x16x32_bf16 v[164:167], v[100:103], a[16:19], v[164:167]
v_exp_f32 v245, v245
v_mfma_f32_16x16x32_bf16 v[180:183], v[100:103], a[20:23], v[180:183]
ds_read_b64_tr_b16 v[82:83], v10 offset:53248
s_waitcnt lgkmcnt(7)
v_mfma_f32_16x16x32_bf16 v[168:171], v[104:107], a[16:19], v[168:171]
ds_read_b64_tr_b16 v[84:85], v11 offset:36864
ds_read_b64_tr_b16 v[86:87], v11 offset:53248
v_mfma_f32_16x16x32_bf16 v[184:187], v[104:107], a[20:23], v[184:187]
buffer_load_dwordx4 v33, s[40:43], s77 offen offset:3072 lds
v_mfma_f32_16x16x32_bf16 v[172:175], v[108:111], a[16:19], v[172:175]
ds_read_b64_tr_b16 v[88:89], v12 offset:36864
ds_read_b64_tr_b16 v[90:91], v12 offset:53248
v_mfma_f32_16x16x32_bf16 v[188:191], v[108:111], a[20:23], v[188:191]
v_exp_f32 v246, v246
v_mfma_f32_16x16x32_bf16 v[160:163], v[112:115], a[24:27], v[160:163]
ds_read_b64_tr_b16 v[92:93], v13 offset:36864
ds_read_b64_tr_b16 v[94:95], v13 offset:53248
v_mfma_f32_16x16x32_bf16 v[176:179], v[112:115], a[28:31], v[176:179]
ds_read_b64_tr_b16 v[96:97], v10 offset:37888
s_waitcnt lgkmcnt(8)
v_mfma_f32_16x16x32_bf16 v[164:167], v[116:119], a[24:27], v[164:167]
s_add_u32 m0, s76, 4096
s_add_u32 s77, s84, 0x620080
v_mfma_f32_16x16x32_bf16 v[180:183], v[116:119], a[28:31], v[180:183]
ds_read_b64_tr_b16 v[98:99], v10 offset:54272
ds_read_b64_tr_b16 v[100:101], v11 offset:37888
v_mfma_f32_16x16x32_bf16 v[168:171], v[120:123], a[24:27], v[168:171]
buffer_load_dwordx4 v30, s[40:43], s77 offen offset:0 lds
v_mfma_f32_16x16x32_bf16 v[184:187], v[120:123], a[28:31], v[184:187]
ds_read_b64_tr_b16 v[102:103], v11 offset:54272
ds_read_b64_tr_b16 v[104:105], v12 offset:37888
v_mfma_f32_16x16x32_bf16 v[172:175], v[124:127], a[24:27], v[172:175]
v_exp_f32 v247, v247
v_mfma_f32_16x16x32_bf16 v[188:191], v[124:127], a[28:31], v[188:191]
ds_read_b64_tr_b16 v[106:107], v12 offset:54272
s_waitcnt lgkmcnt(6)
v_mfma_f32_16x16x32_bf16 v[160:163], v[80:83], a[32:35], v[160:163]
ds_read_b64_tr_b16 v[108:109], v13 offset:37888
v_fma_f32 v244, v244, v63, v63
v_mfma_f32_16x16x32_bf16 v[176:179], v[80:83], a[36:39], v[176:179]
ds_read_b64_tr_b16 v[110:111], v13 offset:54272
v_fma_f32 v245, v245, v63, v63
v_mfma_f32_16x16x32_bf16 v[164:167], v[84:87], a[32:35], v[164:167]
ds_read_b64_tr_b16 v[112:113], v10 offset:38912
v_fma_f32 v246, v246, v63, v63
v_mfma_f32_16x16x32_bf16 v[180:183], v[84:87], a[36:39], v[180:183]
ds_read_b64_tr_b16 v[114:115], v10 offset:55296
v_fma_f32 v247, v247, v63, v63
v_mfma_f32_16x16x32_bf16 v[168:171], v[88:91], a[32:35], v[168:171]
ds_read_b64_tr_b16 v[116:117], v11 offset:38912
ds_read_b64_tr_b16 v[118:119], v11 offset:55296
v_mfma_f32_16x16x32_bf16 v[184:187], v[88:91], a[36:39], v[184:187]
buffer_load_dwordx4 v31, s[40:43], s77 offen offset:1024 lds
v_mfma_f32_16x16x32_bf16 v[172:175], v[92:95], a[32:35], v[172:175]
ds_read_b64_tr_b16 v[120:121], v12 offset:38912
ds_read_b64_tr_b16 v[122:123], v12 offset:55296
v_mfma_f32_16x16x32_bf16 v[188:191], v[92:95], a[36:39], v[188:191]
ds_read_b64_tr_b16 v[124:125], v13 offset:38912
s_waitcnt lgkmcnt(8)
v_mfma_f32_16x16x32_bf16 v[160:163], v[96:99], a[40:43], v[160:163]
v_rcp_f32 v244, v244
v_mfma_f32_16x16x32_bf16 v[176:179], v[96:99], a[44:47], v[176:179]
ds_read_b64_tr_b16 v[126:127], v13 offset:55296
ds_read_b64_tr_b16 v[80:81], v10 offset:39936
v_mfma_f32_16x16x32_bf16 v[164:167], v[100:103], a[40:43], v[164:167]
buffer_load_dwordx4 v32, s[40:43], s77 offen offset:2048 lds
v_mfma_f32_16x16x32_bf16 v[180:183], v[100:103], a[44:47], v[180:183]
ds_read_b64_tr_b16 v[82:83], v10 offset:56320
ds_read_b64_tr_b16 v[84:85], v11 offset:39936
v_mfma_f32_16x16x32_bf16 v[168:171], v[104:107], a[40:43], v[168:171]
v_rcp_f32 v245, v245
v_mfma_f32_16x16x32_bf16 v[184:187], v[104:107], a[44:47], v[184:187]
ds_read_b64_tr_b16 v[86:87], v11 offset:56320
s_waitcnt lgkmcnt(6)
v_mfma_f32_16x16x32_bf16 v[172:175], v[108:111], a[40:43], v[172:175]
ds_read_b64_tr_b16 v[88:89], v12 offset:39936
ds_read_b64_tr_b16 v[90:91], v12 offset:56320
v_mfma_f32_16x16x32_bf16 v[188:191], v[108:111], a[44:47], v[188:191]
buffer_load_dwordx4 v33, s[40:43], s77 offen offset:3072 lds
v_mfma_f32_16x16x32_bf16 v[160:163], v[112:115], a[48:51], v[160:163]
ds_read_b64_tr_b16 v[92:93], v13 offset:39936
ds_read_b64_tr_b16 v[94:95], v13 offset:56320
v_mfma_f32_16x16x32_bf16 v[176:179], v[112:115], a[52:55], v[176:179]
v_rcp_f32 v246, v246
v_mfma_f32_16x16x32_bf16 v[164:167], v[116:119], a[48:51], v[164:167]
v_rcp_f32 v247, v247
v_mfma_f32_16x16x32_bf16 v[180:183], v[116:119], a[52:55], v[180:183]
v_mul_f32 v148, v148, v244
v_mul_f32 v149, v149, v245
v_mfma_f32_16x16x32_bf16 v[168:171], v[120:123], a[48:51], v[168:171]
v_mul_f32 v150, v150, v246
v_mul_f32 v151, v151, v247
v_mfma_f32_16x16x32_bf16 v[184:187], v[120:123], a[52:55], v[184:187]
s_waitcnt vmcnt(18) lgkmcnt(0)
s_barrier
v_mfma_f32_16x16x32_bf16 v[172:175], v[124:127], a[48:51], v[172:175]
ds_read_b64_tr_b16 v[96:97], v14 offset:0
ds_read_b64_tr_b16 v[98:99], v14 offset:16384
v_mfma_f32_16x16x32_bf16 v[188:191], v[124:127], a[52:55], v[188:191]
ds_read_b64_tr_b16 v[100:101], v15 offset:0
ds_read_b64_tr_b16 v[102:103], v15 offset:16384
v_mfma_f32_16x16x32_bf16 v[160:163], v[80:83], a[56:59], v[160:163]
ds_read_b64_tr_b16 v[104:105], v16 offset:0
ds_read_b64_tr_b16 v[106:107], v16 offset:16384
v_mfma_f32_16x16x32_bf16 v[176:179], v[80:83], a[60:63], v[176:179]
ds_read_b64_tr_b16 v[108:109], v17 offset:0
ds_read_b64_tr_b16 v[110:111], v17 offset:16384
v_mfma_f32_16x16x32_bf16 v[164:167], v[84:87], a[56:59], v[164:167]
ds_read_b64_tr_b16 v[112:113], v14 offset:1024
s_add_u32 m0, s76, 32768
v_mfma_f32_16x16x32_bf16 v[180:183], v[84:87], a[60:63], v[180:183]
ds_read_b64_tr_b16 v[114:115], v14 offset:17408
s_add_u32 s77, s84, 0x80
v_mfma_f32_16x16x32_bf16 v[168:171], v[88:91], a[56:59], v[168:171]
ds_read_b64_tr_b16 v[116:117], v15 offset:1024
v_mul_f32 v240, v61, v152
v_mfma_f32_16x16x32_bf16 v[184:187], v[88:91], a[60:63], v[184:187]
ds_read_b64_tr_b16 v[118:119], v15 offset:17408
v_mul_f32 v241, v61, v153
v_mfma_f32_16x16x32_bf16 v[172:175], v[92:95], a[56:59], v[172:175]
ds_read_b64_tr_b16 v[120:121], v16 offset:1024
v_mul_f32 v242, v61, v154
v_mfma_f32_16x16x32_bf16 v[188:191], v[92:95], a[60:63], v[188:191]
ds_read_b64_tr_b16 v[122:123], v16 offset:17408
s_waitcnt lgkmcnt(8)
v_mfma_f32_16x16x32_bf16 v[160:163], v[96:99], a[64:67], v[160:163]
ds_read_b64_tr_b16 v[124:125], v17 offset:1024
v_mul_f32 v243, v61, v155
v_mfma_f32_16x16x32_bf16 v[176:179], v[96:99], a[68:71], v[176:179]
ds_read_b64_tr_b16 v[126:127], v17 offset:17408
ds_read_b64_tr_b16 v[80:81], v14 offset:2048
v_mfma_f32_16x16x32_bf16 v[164:167], v[100:103], a[64:67], v[164:167]
buffer_load_dwordx4 v30, s[44:47], s77 offen offset:0 lds
v_mfma_f32_16x16x32_bf16 v[180:183], v[100:103], a[68:71], v[180:183]
ds_read_b64_tr_b16 v[82:83], v14 offset:18432
ds_read_b64_tr_b16 v[84:85], v15 offset:2048
v_mfma_f32_16x16x32_bf16 v[168:171], v[104:107], a[64:67], v[168:171]
v_exp_f32 v240, v240
v_mfma_f32_16x16x32_bf16 v[184:187], v[104:107], a[68:71], v[184:187]
ds_read_b64_tr_b16 v[86:87], v15 offset:18432
s_waitcnt lgkmcnt(7)
v_mfma_f32_16x16x32_bf16 v[172:175], v[108:111], a[64:67], v[172:175]
ds_read_b64_tr_b16 v[88:89], v16 offset:2048
ds_read_b64_tr_b16 v[90:91], v16 offset:18432
v_mfma_f32_16x16x32_bf16 v[188:191], v[108:111], a[68:71], v[188:191]
buffer_load_dwordx4 v31, s[44:47], s77 offen offset:1024 lds
v_mfma_f32_16x16x32_bf16 v[160:163], v[112:115], a[72:75], v[160:163]
ds_read_b64_tr_b16 v[92:93], v17 offset:2048
ds_read_b64_tr_b16 v[94:95], v17 offset:18432
v_mfma_f32_16x16x32_bf16 v[176:179], v[112:115], a[76:79], v[176:179]
v_exp_f32 v241, v241
v_mfma_f32_16x16x32_bf16 v[164:167], v[116:119], a[72:75], v[164:167]
ds_read_b64_tr_b16 v[96:97], v14 offset:3072
ds_read_b64_tr_b16 v[98:99], v14 offset:19456
v_mfma_f32_16x16x32_bf16 v[180:183], v[116:119], a[76:79], v[180:183]
ds_read_b64_tr_b16 v[100:101], v15 offset:3072
s_waitcnt lgkmcnt(8)
v_mfma_f32_16x16x32_bf16 v[168:171], v[120:123], a[72:75], v[168:171]
buffer_load_dwordx4 v32, s[44:47], s77 offen offset:2048 lds
v_mfma_f32_16x16x32_bf16 v[184:187], v[120:123], a[76:79], v[184:187]
ds_read_b64_tr_b16 v[102:103], v15 offset:19456
ds_read_b64_tr_b16 v[104:105], v16 offset:3072
v_mfma_f32_16x16x32_bf16 v[172:175], v[124:127], a[72:75], v[172:175]
v_exp_f32 v242, v242
v_mfma_f32_16x16x32_bf16 v[188:191], v[124:127], a[76:79], v[188:191]
ds_read_b64_tr_b16 v[106:107], v16 offset:19456
ds_read_b64_tr_b16 v[108:109], v17 offset:3072
v_mfma_f32_16x16x32_bf16 v[160:163], v[80:83], a[80:83], v[160:163]
v_exp_f32 v243, v243
v_mfma_f32_16x16x32_bf16 v[176:179], v[80:83], a[84:87], v[176:179]
ds_read_b64_tr_b16 v[110:111], v17 offset:19456
s_waitcnt lgkmcnt(6)
v_mfma_f32_16x16x32_bf16 v[164:167], v[84:87], a[80:83], v[164:167]
ds_read_b64_tr_b16 v[112:113], v14 offset:4096
v_fma_f32 v240, v240, v63, v63
v_mfma_f32_16x16x32_bf16 v[180:183], v[84:87], a[84:87], v[180:183]
ds_read_b64_tr_b16 v[114:115], v14 offset:20480
v_fma_f32 v241, v241, v63, v63
v_mfma_f32_16x16x32_bf16 v[168:171], v[88:91], a[80:83], v[168:171]
ds_read_b64_tr_b16 v[116:117], v15 offset:4096
v_fma_f32 v242, v242, v63, v63
v_mfma_f32_16x16x32_bf16 v[184:187], v[88:91], a[84:87], v[184:187]
ds_read_b64_tr_b16 v[118:119], v15 offset:20480
v_fma_f32 v243, v243, v63, v63
v_mfma_f32_16x16x32_bf16 v[172:175], v[92:95], a[80:83], v[172:175]
ds_read_b64_tr_b16 v[120:121], v16 offset:4096
ds_read_b64_tr_b16 v[122:123], v16 offset:20480
v_mfma_f32_16x16x32_bf16 v[188:191], v[92:95], a[84:87], v[188:191]
buffer_load_dwordx4 v33, s[44:47], s77 offen offset:3072 lds
v_mfma_f32_16x16x32_bf16 v[160:163], v[96:99], a[88:91], v[160:163]
ds_read_b64_tr_b16 v[124:125], v17 offset:4096
ds_read_b64_tr_b16 v[126:127], v17 offset:20480
v_mfma_f32_16x16x32_bf16 v[176:179], v[96:99], a[92:95], v[176:179]
ds_read_b64_tr_b16 v[80:81], v14 offset:5120
s_waitcnt lgkmcnt(8)
v_mfma_f32_16x16x32_bf16 v[164:167], v[100:103], a[88:91], v[164:167]
v_rcp_f32 v240, v240
v_mfma_f32_16x16x32_bf16 v[180:183], v[100:103], a[92:95], v[180:183]
ds_read_b64_tr_b16 v[82:83], v14 offset:21504
ds_read_b64_tr_b16 v[84:85], v15 offset:5120
v_mfma_f32_16x16x32_bf16 v[168:171], v[104:107], a[88:91], v[168:171]
s_add_u32 m0, s76, 36864
s_add_u32 s77, s84, 0xe0080
v_mfma_f32_16x16x32_bf16 v[184:187], v[104:107], a[92:95], v[184:187]
ds_read_b64_tr_b16 v[86:87], v15 offset:21504
ds_read_b64_tr_b16 v[88:89], v16 offset:5120
v_mfma_f32_16x16x32_bf16 v[172:175], v[108:111], a[88:91], v[172:175]
buffer_load_dwordx4 v30, s[44:47], s77 offen offset:0 lds
v_mfma_f32_16x16x32_bf16 v[188:191], v[108:111], a[92:95], v[188:191]
ds_read_b64_tr_b16 v[90:91], v16 offset:21504
s_waitcnt lgkmcnt(6)
v_mfma_f32_16x16x32_bf16 v[160:163], v[112:115], a[96:99], v[160:163]
ds_read_b64_tr_b16 v[92:93], v17 offset:5120
ds_read_b64_tr_b16 v[94:95], v17 offset:21504
v_mfma_f32_16x16x32_bf16 v[176:179], v[112:115], a[100:103], v[176:179]
v_rcp_f32 v241, v241
v_mfma_f32_16x16x32_bf16 v[164:167], v[116:119], a[96:99], v[164:167]
ds_read_b64_tr_b16 v[96:97], v14 offset:6144
ds_read_b64_tr_b16 v[98:99], v14 offset:22528
v_mfma_f32_16x16x32_bf16 v[180:183], v[116:119], a[100:103], v[180:183]
buffer_load_dwordx4 v31, s[44:47], s77 offen offset:1024 lds
v_mfma_f32_16x16x32_bf16 v[168:171], v[120:123], a[96:99], v[168:171]
ds_read_b64_tr_b16 v[100:101], v15 offset:6144
ds_read_b64_tr_b16 v[102:103], v15 offset:22528
v_mfma_f32_16x16x32_bf16 v[184:187], v[120:123], a[100:103], v[184:187]
v_rcp_f32 v242, v242
v_mfma_f32_16x16x32_bf16 v[172:175], v[124:127], a[96:99], v[172:175]
ds_read_b64_tr_b16 v[104:105], v16 offset:6144
ds_read_b64_tr_b16 v[106:107], v16 offset:22528
v_mfma_f32_16x16x32_bf16 v[188:191], v[124:127], a[100:103], v[188:191]
ds_read_b64_tr_b16 v[108:109], v17 offset:6144
s_waitcnt lgkmcnt(7)
v_mfma_f32_16x16x32_bf16 v[160:163], v[80:83], a[104:107], v[160:163]
buffer_load_dwordx4 v32, s[44:47], s77 offen offset:2048 lds
v_mfma_f32_16x16x32_bf16 v[176:179], v[80:83], a[108:111], v[176:179]
ds_read_b64_tr_b16 v[110:111], v17 offset:22528
ds_read_b64_tr_b16 v[112:113], v14 offset:7168
v_mfma_f32_16x16x32_bf16 v[164:167], v[84:87], a[104:107], v[164:167]
v_rcp_f32 v243, v243
v_mfma_f32_16x16x32_bf16 v[180:183], v[84:87], a[108:111], v[180:183]
ds_read_b64_tr_b16 v[114:115], v14 offset:23552
v_mul_f32 v152, v152, v240
v_mfma_f32_16x16x32_bf16 v[168:171], v[88:91], a[104:107], v[168:171]
ds_read_b64_tr_b16 v[116:117], v15 offset:7168
v_mul_f32 v153, v153, v241
v_mfma_f32_16x16x32_bf16 v[184:187], v[88:91], a[108:111], v[184:187]
ds_read_b64_tr_b16 v[118:119], v15 offset:23552
v_mul_f32 v154, v154, v242
v_mfma_f32_16x16x32_bf16 v[172:175], v[92:95], a[104:107], v[172:175]
ds_read_b64_tr_b16 v[120:121], v16 offset:7168
v_mul_f32 v155, v155, v243
v_mfma_f32_16x16x32_bf16 v[188:191], v[92:95], a[108:111], v[188:191]
ds_read_b64_tr_b16 v[122:123], v16 offset:23552
s_waitcnt lgkmcnt(7)
v_mfma_f32_16x16x32_bf16 v[160:163], v[96:99], a[112:115], v[160:163]
ds_read_b64_tr_b16 v[124:125], v17 offset:7168
v_mul_f32 v244, v61, v156
v_mfma_f32_16x16x32_bf16 v[176:179], v[96:99], a[116:119], v[176:179]
ds_read_b64_tr_b16 v[126:127], v17 offset:23552
v_mul_f32 v245, v61, v157
v_mfma_f32_16x16x32_bf16 v[164:167], v[100:103], a[112:115], v[164:167]
buffer_load_dwordx4 v33, s[44:47], s77 offen offset:3072 lds
v_mfma_f32_16x16x32_bf16 v[180:183], v[100:103], a[116:119], v[180:183]
v_mul_f32 v246, v61, v158
v_mul_f32 v247, v61, v159
v_mfma_f32_16x16x32_bf16 v[168:171], v[104:107], a[112:115], v[168:171]
v_exp_f32 v244, v244
v_mfma_f32_16x16x32_bf16 v[184:187], v[104:107], a[116:119], v[184:187]
s_waitcnt lgkmcnt(3)
v_mfma_f32_16x16x32_bf16 v[172:175], v[108:111], a[112:115], v[172:175]
s_waitcnt vmcnt(18) lgkmcnt(0)
s_barrier
v_mfma_f32_16x16x32_bf16 v[188:191], v[108:111], a[116:119], v[188:191]
ds_read_b64_tr_b16 v[80:81], v14 offset:32768
ds_read_b64_tr_b16 v[82:83], v14 offset:49152
ds_read_b64_tr_b16 v[84:85], v15 offset:32768
v_mfma_f32_16x16x32_bf16 v[160:163], v[112:115], a[120:123], v[160:163]
ds_read_b64_tr_b16 v[86:87], v15 offset:49152
ds_read_b64_tr_b16 v[88:89], v16 offset:32768
ds_read_b64_tr_b16 v[90:91], v16 offset:49152
v_mfma_f32_16x16x32_bf16 v[176:179], v[112:115], a[124:127], v[176:179]
ds_read_b64_tr_b16 v[92:93], v17 offset:32768
ds_read_b64_tr_b16 v[94:95], v17 offset:49152
s_add_u32 m0, s76, 65536
v_mfma_f32_16x16x32_bf16 v[164:167], v[116:119], a[120:123], v[164:167]
ds_read_b64_tr_b16 v[96:97], v14 offset:33792
s_add_u32 s77, s84, 0x1c0080
v_mfma_f32_16x16x32_bf16 v[180:183], v[116:119], a[124:127], v[180:183]
ds_read_b64_tr_b16 v[98:99], v14 offset:50176
buffer_load_dwordx4 v30, s[44:47], s77 offen offset:0 lds
v_mfma_f32_16x16x32_bf16 v[168:171], v[120:123], a[120:123], v[168:171]
ds_read_b64_tr_b16 v[100:101], v15 offset:33792
ds_read_b64_tr_b16 v[102:103], v15 offset:50176
v_mfma_f32_16x16x32_bf16 v[184:187], v[120:123], a[124:127], v[184:187]
v_exp_f32 v245, v245
ds_read_b64_tr_b16 v[104:105], v16 offset:33792
v_mfma_f32_16x16x32_bf16 v[172:175], v[124:127], a[120:123], v[172:175]
v_exp_f32 v246, v246
v_mfma_f32_16x16x32_bf16 v[188:191], v[124:127], a[124:127], v[188:191]
ds_read_b64_tr_b16 v[106:107], v16 offset:50176
s_waitcnt lgkmcnt(8)
v_mfma_f32_16x16x32_bf16 v[160:163], v[80:83], a[128:131], v[160:163]
ds_read_b64_tr_b16 v[108:109], v17 offset:33792
ds_read_b64_tr_b16 v[110:111], v17 offset:50176
v_mfma_f32_16x16x32_bf16 v[176:179], v[80:83], a[132:135], v[176:179]
buffer_load_dwordx4 v31, s[44:47], s77 offen offset:1024 lds
ds_read_b64_tr_b16 v[112:113], v14 offset:34816
v_mfma_f32_16x16x32_bf16 v[164:167], v[84:87], a[128:131], v[164:167]
v_exp_f32 v247, v247
v_mfma_f32_16x16x32_bf16 v[180:183], v[84:87], a[132:135], v[180:183]
ds_read_b64_tr_b16 v[114:115], v14 offset:51200
s_mov_b32 s3, 0x500000
v_mfma_f32_16x16x32_bf16 v[168:171], v[88:91], a[128:131], v[168:171]
ds_read_b64_tr_b16 v[116:117], v15 offset:34816
v_fma_f32 v244, v244, v63, v63
v_mfma_f32_16x16x32_bf16 v[184:187], v[88:91], a[132:135], v[184:187]
ds_read_b64_tr_b16 v[118:119], v15 offset:51200
s_waitcnt lgkmcnt(7)
v_mfma_f32_16x16x32_bf16 v[172:175], v[92:95], a[128:131], v[172:175]
ds_read_b64_tr_b16 v[120:121], v16 offset:34816
v_fma_f32 v245, v245, v63, v63
v_mfma_f32_16x16x32_bf16 v[188:191], v[92:95], a[132:135], v[188:191]
ds_read_b64_tr_b16 v[122:123], v16 offset:51200
v_fma_f32 v246, v246, v63, v63
v_mfma_f32_16x16x32_bf16 v[160:163], v[96:99], a[136:139], v[160:163]
ds_read_b64_tr_b16 v[124:125], v17 offset:34816
v_fma_f32 v247, v247, v63, v63
v_mfma_f32_16x16x32_bf16 v[176:179], v[96:99], a[140:143], v[176:179]
ds_read_b64_tr_b16 v[126:127], v17 offset:51200
ds_read_b64_tr_b16 v[80:81], v14 offset:35840
v_mfma_f32_16x16x32_bf16 v[164:167], v[100:103], a[136:139], v[164:167]
buffer_load_dwordx4 v32, s[44:47], s77 offen offset:2048 lds
v_mfma_f32_16x16x32_bf16 v[180:183], v[100:103], a[140:143], v[180:183]
ds_read_b64_tr_b16 v[82:83], v14 offset:52224
s_waitcnt lgkmcnt(7)
v_mfma_f32_16x16x32_bf16 v[168:171], v[104:107], a[136:139], v[168:171]
ds_read_b64_tr_b16 v[84:85], v15 offset:35840
ds_read_b64_tr_b16 v[86:87], v15 offset:52224
v_mfma_f32_16x16x32_bf16 v[184:187], v[104:107], a[140:143], v[184:187]
buffer_load_dword v57, v8, s[48:51], s3 offen
v_mfma_f32_16x16x32_bf16 v[172:175], v[108:111], a[136:139], v[172:175]
ds_read_b64_tr_b16 v[88:89], v16 offset:35840
ds_read_b64_tr_b16 v[90:91], v16 offset:52224
v_mfma_f32_16x16x32_bf16 v[188:191], v[108:111], a[140:143], v[188:191]
buffer_load_dwordx4 v33, s[44:47], s77 offen offset:3072 lds
ds_read_b64_tr_b16 v[92:93], v17 offset:35840
v_mfma_f32_16x16x32_bf16 v[160:163], v[112:115], a[144:147], v[160:163]
v_rcp_f32 v244, v244
v_mfma_f32_16x16x32_bf16 v[176:179], v[112:115], a[148:151], v[176:179]
ds_read_b64_tr_b16 v[94:95], v17 offset:52224
s_waitcnt lgkmcnt(7)
v_mfma_f32_16x16x32_bf16 v[164:167], v[116:119], a[144:147], v[164:167]
ds_read_b64_tr_b16 v[96:97], v14 offset:36864
ds_read_b64_tr_b16 v[98:99], v14 offset:53248
v_mfma_f32_16x16x32_bf16 v[180:183], v[116:119], a[148:151], v[180:183]
v_rcp_f32 v245, v245
v_mfma_f32_16x16x32_bf16 v[168:171], v[120:123], a[144:147], v[168:171]
ds_read_b64_tr_b16 v[100:101], v15 offset:36864
s_add_u32 m0, s76, 69632
v_mfma_f32_16x16x32_bf16 v[184:187], v[120:123], a[148:151], v[184:187]
ds_read_b64_tr_b16 v[102:103], v15 offset:53248
s_add_u32 s77, s84, 0x2a0080
v_mfma_f32_16x16x32_bf16 v[172:175], v[124:127], a[144:147], v[172:175]
ds_read_b64_tr_b16 v[104:105], v16 offset:36864
ds_read_b64_tr_b16 v[106:107], v16 offset:53248
v_mfma_f32_16x16x32_bf16 v[188:191], v[124:127], a[148:151], v[188:191]
ds_read_b64_tr_b16 v[108:109], v17 offset:36864
s_waitcnt lgkmcnt(8)
v_mfma_f32_16x16x32_bf16 v[160:163], v[80:83], a[152:155], v[160:163]
buffer_load_dwordx4 v30, s[44:47], s77 offen offset:0 lds
v_mfma_f32_16x16x32_bf16 v[176:179], v[80:83], a[156:159], v[176:179]
ds_read_b64_tr_b16 v[110:111], v17 offset:53248
ds_read_b64_tr_b16 v[112:113], v14 offset:37888
v_mfma_f32_16x16x32_bf16 v[164:167], v[84:87], a[152:155], v[164:167]
v_rcp_f32 v246, v246
v_mfma_f32_16x16x32_bf16 v[180:183], v[84:87], a[156:159], v[180:183]
ds_read_b64_tr_b16 v[114:115], v14 offset:54272
ds_read_b64_tr_b16 v[116:117], v15 offset:37888
v_mfma_f32_16x16x32_bf16 v[168:171], v[88:91], a[152:155], v[168:171]
v_rcp_f32 v247, v247
v_mfma_f32_16x16x32_bf16 v[184:187], v[88:91], a[156:159], v[184:187]
ds_read_b64_tr_b16 v[118:119], v15 offset:54272
s_waitcnt lgkmcnt(6)
v_mfma_f32_16x16x32_bf16 v[172:175], v[92:95], a[152:155], v[172:175]
ds_read_b64_tr_b16 v[120:121], v16 offset:37888
v_mul_f32 v156, v156, v244
v_mfma_f32_16x16x32_bf16 v[188:191], v[92:95], a[156:159], v[188:191]
ds_read_b64_tr_b16 v[122:123], v16 offset:54272
v_mul_f32 v157, v157, v245
v_mfma_f32_16x16x32_bf16 v[160:163], v[96:99], a[160:163], v[160:163]
ds_read_b64_tr_b16 v[124:125], v17 offset:37888
v_mul_f32 v158, v158, v246
v_mfma_f32_16x16x32_bf16 v[176:179], v[96:99], a[164:167], v[176:179]
ds_read_b64_tr_b16 v[126:127], v17 offset:54272
v_mul_f32 v159, v159, v247
v_mfma_f32_16x16x32_bf16 v[164:167], v[100:103], a[160:163], v[164:167]
ds_read_b64_tr_b16 v[80:81], v14 offset:38912
ds_read_b64_tr_b16 v[82:83], v14 offset:55296
v_mfma_f32_16x16x32_bf16 v[180:183], v[100:103], a[164:167], v[180:183]
buffer_load_dwordx4 v31, s[44:47], s77 offen offset:1024 lds
v_mfma_f32_16x16x32_bf16 v[168:171], v[104:107], a[160:163], v[168:171]
ds_read_b64_tr_b16 v[84:85], v15 offset:38912
ds_read_b64_tr_b16 v[86:87], v15 offset:55296
v_mfma_f32_16x16x32_bf16 v[184:187], v[104:107], a[164:167], v[184:187]
s_add_u32 s7, s4, 0
s_waitcnt lgkmcnt(7)
v_mfma_f32_16x16x32_bf16 v[172:175], v[108:111], a[160:163], v[172:175]
ds_read_b64_tr_b16 v[88:89], v16 offset:38912
v_mul_f32 v192, v192, v128
v_mfma_f32_16x16x32_bf16 v[188:191], v[108:111], a[164:167], v[188:191]
ds_read_b64_tr_b16 v[90:91], v16 offset:55296
v_mul_f32 v193, v193, v129
v_mfma_f32_16x16x32_bf16 v[160:163], v[112:115], a[168:171], v[160:163]
ds_read_b64_tr_b16 v[92:93], v17 offset:38912
v_mul_f32 v194, v194, v130
v_mfma_f32_16x16x32_bf16 v[176:179], v[112:115], a[172:175], v[176:179]
ds_read_b64_tr_b16 v[94:95], v17 offset:55296
v_mul_f32 v195, v195, v131
v_mfma_f32_16x16x32_bf16 v[164:167], v[116:119], a[168:171], v[164:167]
ds_read_b64_tr_b16 v[96:97], v14 offset:39936
v_mul_f32 v196, v196, v132
v_mfma_f32_16x16x32_bf16 v[180:183], v[116:119], a[172:175], v[180:183]
ds_read_b64_tr_b16 v[98:99], v14 offset:56320
s_waitcnt lgkmcnt(6)
v_mfma_f32_16x16x32_bf16 v[168:171], v[120:123], a[168:171], v[168:171]
ds_read_b64_tr_b16 v[100:101], v15 offset:39936
v_mul_f32 v197, v197, v133
v_mfma_f32_16x16x32_bf16 v[184:187], v[120:123], a[172:175], v[184:187]
ds_read_b64_tr_b16 v[102:103], v15 offset:56320
v_mul_f32 v198, v198, v134
v_mfma_f32_16x16x32_bf16 v[172:175], v[124:127], a[168:171], v[172:175]
ds_read_b64_tr_b16 v[104:105], v16 offset:39936
v_mul_f32 v199, v199, v135
v_mfma_f32_16x16x32_bf16 v[188:191], v[124:127], a[172:175], v[188:191]
ds_read_b64_tr_b16 v[106:107], v16 offset:56320
v_cvt_pk_bf16_f32 v192, v192, v193
v_mfma_f32_16x16x32_bf16 v[160:163], v[80:83], a[176:179], v[160:163]
ds_read_b64_tr_b16 v[108:109], v17 offset:39936
v_cvt_pk_bf16_f32 v193, v194, v195
v_mfma_f32_16x16x32_bf16 v[176:179], v[80:83], a[180:183], v[176:179]
ds_read_b64_tr_b16 v[110:111], v17 offset:56320
v_cvt_pk_bf16_f32 v194, v196, v197
v_mfma_f32_16x16x32_bf16 v[164:167], v[84:87], a[176:179], v[164:167]
buffer_load_dwordx4 v32, s[44:47], s77 offen offset:2048 lds
v_mfma_f32_16x16x32_bf16 v[180:183], v[84:87], a[180:183], v[180:183]
v_cvt_pk_bf16_f32 v195, v198, v199
s_waitcnt lgkmcnt(5)
v_mfma_f32_16x16x32_bf16 v[168:171], v[88:91], a[176:179], v[168:171]
buffer_load_dwordx4 v33, s[44:47], s77 offen offset:3072 lds
v_mfma_f32_16x16x32_bf16 v[184:187], v[88:91], a[180:183], v[184:187]
buffer_store_dwordx4 v[192:195], v46, s[60:63], s7 offen offset:0 sc1
v_mfma_f32_16x16x32_bf16 v[172:175], v[92:95], a[176:179], v[172:175]
s_waitcnt vmcnt(18) lgkmcnt(0)
s_barrier
v_mfma_f32_16x16x32_bf16 v[188:191], v[92:95], a[180:183], v[188:191]
ds_read_b64_tr_b16 v[112:113], v10 offset:0
ds_read_b64_tr_b16 v[114:115], v10 offset:16384
ds_read_b64_tr_b16 v[116:117], v11 offset:0
v_mfma_f32_16x16x32_bf16 v[160:163], v[96:99], a[184:187], v[160:163]
ds_read_b64_tr_b16 v[118:119], v11 offset:16384
ds_read_b64_tr_b16 v[120:121], v12 offset:0
ds_read_b64_tr_b16 v[122:123], v12 offset:16384
v_mfma_f32_16x16x32_bf16 v[176:179], v[96:99], a[188:191], v[176:179]
ds_read_b64_tr_b16 v[124:125], v13 offset:0
ds_read_b64_tr_b16 v[126:127], v13 offset:16384
s_add_u32 m0, s76, 98304
v_mfma_f32_16x16x32_bf16 v[164:167], v[100:103], a[184:187], v[164:167]
ds_read_b64_tr_b16 v[80:81], v10 offset:1024
s_add_u32 s77, s84, 0x380080
v_mul_f32 v200, v200, v136
v_mfma_f32_16x16x32_bf16 v[180:183], v[100:103], a[188:191], v[180:183]
ds_read_b64_tr_b16 v[82:83], v10 offset:17408
buffer_load_dwordx4 v30, s[44:47], s77 offen offset:0 lds
v_mfma_f32_16x16x32_bf16 v[168:171], v[104:107], a[184:187], v[168:171]
ds_read_b64_tr_b16 v[84:85], v11 offset:1024
v_mul_f32 v201, v201, v137
v_mul_f32 v202, v202, v138
v_mfma_f32_16x16x32_bf16 v[184:187], v[104:107], a[188:191], v[184:187]
ds_read_b64_tr_b16 v[86:87], v11 offset:17408
v_mul_f32 v203, v203, v139
v_mul_f32 v204, v204, v140
v_mfma_f32_16x16x32_bf16 v[172:175], v[108:111], a[184:187], v[172:175]
ds_read_b64_tr_b16 v[88:89], v12 offset:1024
v_mul_f32 v205, v205, v141
v_mul_f32 v206, v206, v142
v_mfma_f32_16x16x32_bf16 v[188:191], v[108:111], a[188:191], v[188:191]
ds_read_b64_tr_b16 v[90:91], v12 offset:17408
v_mul_f32 v207, v207, v143
s_waitcnt lgkmcnt(8)
v_mfma_f32_16x16x32_bf16 v[160:163], v[112:115], a[192:195], v[160:163]
ds_read_b64_tr_b16 v[92:93], v13 offset:1024
buffer_load_dwordx4 v31, s[44:47], s77 offen offset:1024 lds
v_mfma_f32_16x16x32_bf16 v[176:179], v[112:115], a[196:199], v[176:179]
ds_read_b64_tr_b16 v[94:95], v13 offset:17408
v_cvt_pk_bf16_f32 v200, v200, v201
v_cvt_pk_bf16_f32 v201, v202, v203
v_mfma_f32_16x16x32_bf16 v[164:167], v[116:119], a[192:195], v[164:167]
ds_read_b64_tr_b16 v[96:97], v10 offset:2048
v_cvt_pk_bf16_f32 v202, v204, v205
v_cvt_pk_bf16_f32 v203, v206, v207
v_mfma_f32_16x16x32_bf16 v[180:183], v[116:119], a[196:199], v[180:183]
ds_read_b64_tr_b16 v[98:99], v10 offset:18432
buffer_store_dwordx4 v[200:203], v46, s[60:63], s7 offen offset:2048 sc1
v_mfma_f32_16x16x32_bf16 v[168:171], v[120:123], a[192:195], v[168:171]
ds_read_b64_tr_b16 v[100:101], v11 offset:2048
v_mul_f32 v208, v208, v144
v_mfma_f32_16x16x32_bf16 v[184:187], v[120:123], a[196:199], v[184:187]
ds_read_b64_tr_b16 v[102:103], v11 offset:18432
s_waitcnt lgkmcnt(7)
v_mfma_f32_16x16x32_bf16 v[172:175], v[124:127], a[192:195], v[172:175]
ds_read_b64_tr_b16 v[104:105], v12 offset:2048
v_mul_f32 v209, v209, v145
v_mfma_f32_16x16x32_bf16 v[188:191], v[124:127], a[196:199], v[188:191]
ds_read_b64_tr_b16 v[106:107], v12 offset:18432
v_mul_f32 v210, v210, v146
v_mfma_f32_16x16x32_bf16 v[160:163], v[80:83], a[200:203], v[160:163]
ds_read_b64_tr_b16 v[108:109], v13 offset:2048
v_mul_f32 v211, v211, v147
v_mfma_f32_16x16x32_bf16 v[176:179], v[80:83], a[204:207], v[176:179]
ds_read_b64_tr_b16 v[110:111], v13 offset:18432
v_mul_f32 v212, v212, v148
v_mfma_f32_16x16x32_bf16 v[164:167], v[84:87], a[200:203], v[164:167]
ds_read_b64_tr_b16 v[112:113], v10 offset:3072
v_mul_f32 v213, v213, v149
v_mfma_f32_16x16x32_bf16 v[180:183], v[84:87], a[204:207], v[180:183]
ds_read_b64_tr_b16 v[114:115], v10 offset:19456
s_waitcnt lgkmcnt(7)
v_mfma_f32_16x16x32_bf16 v[168:171], v[88:91], a[200:203], v[168:171]
ds_read_b64_tr_b16 v[116:117], v11 offset:3072
v_mul_f32 v214, v214, v150
v_mfma_f32_16x16x32_bf16 v[184:187], v[88:91], a[204:207], v[184:187]
ds_read_b64_tr_b16 v[118:119], v11 offset:19456
v_mul_f32 v215, v215, v151
v_mfma_f32_16x16x32_bf16 v[172:175], v[92:95], a[200:203], v[172:175]
ds_read_b64_tr_b16 v[120:121], v12 offset:3072
v_cvt_pk_bf16_f32 v208, v208, v209
v_mfma_f32_16x16x32_bf16 v[188:191], v[92:95], a[204:207], v[188:191]
ds_read_b64_tr_b16 v[122:123], v12 offset:19456
v_cvt_pk_bf16_f32 v209, v210, v211
v_mfma_f32_16x16x32_bf16 v[160:163], v[96:99], a[208:211], v[160:163]
ds_read_b64_tr_b16 v[124:125], v13 offset:3072
v_cvt_pk_bf16_f32 v210, v212, v213
v_mfma_f32_16x16x32_bf16 v[176:179], v[96:99], a[212:215], v[176:179]
ds_read_b64_tr_b16 v[126:127], v13 offset:19456
s_waitcnt lgkmcnt(7)
v_mfma_f32_16x16x32_bf16 v[164:167], v[100:103], a[208:211], v[164:167]
ds_read_b64_tr_b16 v[80:81], v10 offset:4096
v_cvt_pk_bf16_f32 v211, v214, v215
v_mfma_f32_16x16x32_bf16 v[180:183], v[100:103], a[212:215], v[180:183]
ds_read_b64_tr_b16 v[82:83], v10 offset:20480
ds_read_b64_tr_b16 v[84:85], v11 offset:4096
v_mfma_f32_16x16x32_bf16 v[168:171], v[104:107], a[208:211], v[168:171]
buffer_load_dwordx4 v32, s[44:47], s77 offen offset:2048 lds
v_mfma_f32_16x16x32_bf16 v[184:187], v[104:107], a[212:215], v[184:187]
ds_read_b64_tr_b16 v[86:87], v11 offset:20480
ds_read_b64_tr_b16 v[88:89], v12 offset:4096
v_mfma_f32_16x16x32_bf16 v[172:175], v[108:111], a[208:211], v[172:175]
buffer_store_dwordx4 v[208:211], v46, s[60:63], s7 offen offset:1024 sc1
v_mfma_f32_16x16x32_bf16 v[188:191], v[108:111], a[212:215], v[188:191]
ds_read_b64_tr_b16 v[90:91], v12 offset:20480
s_waitcnt lgkmcnt(7)
v_mfma_f32_16x16x32_bf16 v[160:163], v[112:115], a[216:219], v[160:163]
ds_read_b64_tr_b16 v[92:93], v13 offset:4096
v_mul_f32 v216, v216, v152
v_mfma_f32_16x16x32_bf16 v[176:179], v[112:115], a[220:223], v[176:179]
ds_read_b64_tr_b16 v[94:95], v13 offset:20480
v_mul_f32 v217, v217, v153
v_mfma_f32_16x16x32_bf16 v[164:167], v[116:119], a[216:219], v[164:167]
ds_read_b64_tr_b16 v[96:97], v10 offset:5120
v_mul_f32 v218, v218, v154
v_mfma_f32_16x16x32_bf16 v[180:183], v[116:119], a[220:223], v[180:183]
ds_read_b64_tr_b16 v[98:99], v10 offset:21504
v_mul_f32 v219, v219, v155
v_mfma_f32_16x16x32_bf16 v[168:171], v[120:123], a[216:219], v[168:171]
ds_read_b64_tr_b16 v[100:101], v11 offset:5120
v_mul_f32 v220, v220, v156
v_mfma_f32_16x16x32_bf16 v[184:187], v[120:123], a[220:223], v[184:187]
ds_read_b64_tr_b16 v[102:103], v11 offset:21504
s_waitcnt lgkmcnt(7)
v_mfma_f32_16x16x32_bf16 v[172:175], v[124:127], a[216:219], v[172:175]
ds_read_b64_tr_b16 v[104:105], v12 offset:5120
v_mul_f32 v221, v221, v157
v_mfma_f32_16x16x32_bf16 v[188:191], v[124:127], a[220:223], v[188:191]
ds_read_b64_tr_b16 v[106:107], v12 offset:21504
v_mul_f32 v222, v222, v158
v_mfma_f32_16x16x32_bf16 v[160:163], v[80:83], a[224:227], v[160:163]
ds_read_b64_tr_b16 v[108:109], v13 offset:5120
v_mul_f32 v223, v223, v159
v_mfma_f32_16x16x32_bf16 v[176:179], v[80:83], a[228:231], v[176:179]
ds_read_b64_tr_b16 v[110:111], v13 offset:21504
v_cvt_pk_bf16_f32 v216, v216, v217
v_mfma_f32_16x16x32_bf16 v[164:167], v[84:87], a[224:227], v[164:167]
ds_read_b64_tr_b16 v[112:113], v10 offset:6144
v_cvt_pk_bf16_f32 v217, v218, v219
v_mfma_f32_16x16x32_bf16 v[180:183], v[84:87], a[228:231], v[180:183]
ds_read_b64_tr_b16 v[114:115], v10 offset:22528
s_waitcnt lgkmcnt(7)
v_mfma_f32_16x16x32_bf16 v[168:171], v[88:91], a[224:227], v[168:171]
ds_read_b64_tr_b16 v[116:117], v11 offset:6144
v_cvt_pk_bf16_f32 v218, v220, v221
v_mfma_f32_16x16x32_bf16 v[184:187], v[88:91], a[228:231], v[184:187]
ds_read_b64_tr_b16 v[118:119], v11 offset:22528
v_cvt_pk_bf16_f32 v219, v222, v223
v_mfma_f32_16x16x32_bf16 v[172:175], v[92:95], a[224:227], v[172:175]
ds_read_b64_tr_b16 v[120:121], v12 offset:6144
ds_read_b64_tr_b16 v[122:123], v12 offset:22528
v_mfma_f32_16x16x32_bf16 v[188:191], v[92:95], a[228:231], v[188:191]
buffer_load_dwordx4 v33, s[44:47], s77 offen offset:3072 lds
v_mfma_f32_16x16x32_bf16 v[160:163], v[96:99], a[232:235], v[160:163]
ds_read_b64_tr_b16 v[124:125], v13 offset:6144
ds_read_b64_tr_b16 v[126:127], v13 offset:22528
v_mfma_f32_16x16x32_bf16 v[176:179], v[96:99], a[236:239], v[176:179]
ds_read_b64_tr_b16 v[80:81], v10 offset:7168
s_waitcnt lgkmcnt(8)
v_mfma_f32_16x16x32_bf16 v[164:167], v[100:103], a[232:235], v[164:167]
buffer_store_dwordx4 v[216:219], v46, s[60:63], s7 offen offset:3072 sc1
v_mfma_f32_16x16x32_bf16 v[180:183], v[100:103], a[236:239], v[180:183]
ds_read_b64_tr_b16 v[82:83], v10 offset:23552
ds_read_b64_tr_b16 v[84:85], v11 offset:7168
v_mfma_f32_16x16x32_bf16 v[168:171], v[104:107], a[232:235], v[168:171]
s_add_u32 m0, s76, 102400
s_add_u32 s77, s84, 0x460080
v_mfma_f32_16x16x32_bf16 v[184:187], v[104:107], a[236:239], v[184:187]
ds_read_b64_tr_b16 v[86:87], v11 offset:23552
ds_read_b64_tr_b16 v[88:89], v12 offset:7168
v_mfma_f32_16x16x32_bf16 v[172:175], v[108:111], a[232:235], v[172:175]
buffer_load_dwordx4 v30, s[44:47], s77 offen offset:0 lds
v_mfma_f32_16x16x32_bf16 v[188:191], v[108:111], a[236:239], v[188:191]
ds_read_b64_tr_b16 v[90:91], v12 offset:23552
s_waitcnt lgkmcnt(6)
v_mfma_f32_16x16x32_bf16 v[160:163], v[112:115], a[240:243], v[160:163]
ds_read_b64_tr_b16 v[92:93], v13 offset:7168
ds_read_b64_tr_b16 v[94:95], v13 offset:23552
v_mfma_f32_16x16x32_bf16 v[176:179], v[112:115], a[244:247], v[176:179]
buffer_load_dwordx4 v31, s[44:47], s77 offen offset:1024 lds
v_mfma_f32_16x16x32_bf16 v[164:167], v[116:119], a[240:243], v[164:167]
buffer_load_dwordx4 v32, s[44:47], s77 offen offset:2048 lds
v_mfma_f32_16x16x32_bf16 v[180:183], v[116:119], a[244:247], v[180:183]
buffer_load_dwordx4 v33, s[44:47], s77 offen offset:3072 lds
v_mfma_f32_16x16x32_bf16 v[168:171], v[120:123], a[240:243], v[168:171]
v_mfma_f32_16x16x32_bf16 v[184:187], v[120:123], a[244:247], v[184:187]
s_waitcnt vmcnt(21) lgkmcnt(0)
s_barrier
v_mfma_f32_16x16x32_bf16 v[172:175], v[124:127], a[240:243], v[172:175]
ds_read_b64_tr_b16 v[96:97], v10 offset:32768
ds_read_b64_tr_b16 v[98:99], v10 offset:49152
v_mfma_f32_16x16x32_bf16 v[188:191], v[124:127], a[244:247], v[188:191]
ds_read_b64_tr_b16 v[100:101], v11 offset:32768
ds_read_b64_tr_b16 v[102:103], v11 offset:49152
v_mfma_f32_16x16x32_bf16 v[160:163], v[80:83], a[248:251], v[160:163]
ds_read_b64_tr_b16 v[104:105], v12 offset:32768
ds_read_b64_tr_b16 v[106:107], v12 offset:49152
v_mfma_f32_16x16x32_bf16 v[176:179], v[80:83], a[252:255], v[176:179]
ds_read_b64_tr_b16 v[108:109], v13 offset:32768
ds_read_b64_tr_b16 v[110:111], v13 offset:49152
v_mfma_f32_16x16x32_bf16 v[164:167], v[84:87], a[248:251], v[164:167]
ds_read_b64_tr_b16 v[112:113], v10 offset:33792
s_add_u32 m0, s76, 0
v_mfma_f32_16x16x32_bf16 v[180:183], v[84:87], a[252:255], v[180:183]
ds_read_b64_tr_b16 v[114:115], v10 offset:50176
s_add_u32 s77, s84, 0x540080
v_mfma_f32_16x16x32_bf16 v[168:171], v[88:91], a[248:251], v[168:171]
ds_read_b64_tr_b16 v[116:117], v11 offset:33792
ds_read_b64_tr_b16 v[118:119], v11 offset:50176
v_mfma_f32_16x16x32_bf16 v[184:187], v[88:91], a[252:255], v[184:187]
buffer_load_dwordx4 v30, s[44:47], s77 offen offset:0 lds
v_mfma_f32_16x16x32_bf16 v[172:175], v[92:95], a[248:251], v[172:175]
ds_read_b64_tr_b16 v[120:121], v12 offset:33792
ds_read_b64_tr_b16 v[122:123], v12 offset:50176
v_mfma_f32_16x16x32_bf16 v[188:191], v[92:95], a[252:255], v[188:191]
ds_read_b64_tr_b16 v[124:125], v13 offset:33792
S_U1:
s_waitcnt lgkmcnt(9)
v_mfma_f32_16x16x32_bf16 v[192:195], v[96:99], a[0:3], 0
ds_read_b64_tr_b16 v[126:127], v13 offset:50176
ds_read_b64_tr_b16 v[80:81], v10 offset:34816
v_mfma_f32_16x16x32_bf16 v[208:211], v[96:99], a[4:7], 0
ds_read_b64_tr_b16 v[82:83], v10 offset:51200
v_mfma_f32_16x16x32_bf16 v[196:199], v[100:103], a[0:3], 0
buffer_load_dwordx4 v31, s[44:47], s77 offen offset:1024 lds
v_mfma_f32_16x16x32_bf16 v[212:215], v[100:103], a[4:7], 0
s_add_u32 s70, s0, S_H - K_pc + 0
s_addc_u32 s71, s1, 0
global_load_dword v57, v9, s[70:71]
v_mfma_f32_16x16x32_bf16 v[200:203], v[104:107], a[0:3], 0
ds_read_b64_tr_b16 v[84:85], v11 offset:34816
v_mul_f32 v240, v60, v160
v_mfma_f32_16x16x32_bf16 v[216:219], v[104:107], a[4:7], 0
ds_read_b64_tr_b16 v[86:87], v11 offset:51200
s_waitcnt lgkmcnt(6)
v_mfma_f32_16x16x32_bf16 v[204:207], v[108:111], a[0:3], 0
ds_read_b64_tr_b16 v[88:89], v12 offset:34816
v_mul_f32 v241, v60, v161
v_mfma_f32_16x16x32_bf16 v[220:223], v[108:111], a[4:7], 0
ds_read_b64_tr_b16 v[90:91], v12 offset:51200
v_mul_f32 v242, v60, v162
v_mfma_f32_16x16x32_bf16 v[192:195], v[112:115], a[8:11], v[192:195]
ds_read_b64_tr_b16 v[92:93], v13 offset:34816
v_mul_f32 v243, v60, v163
v_mfma_f32_16x16x32_bf16 v[208:211], v[112:115], a[12:15], v[208:211]
ds_read_b64_tr_b16 v[94:95], v13 offset:51200
ds_read_b64_tr_b16 v[96:97], v10 offset:35840
v_mfma_f32_16x16x32_bf16 v[196:199], v[116:119], a[8:11], v[196:199]
buffer_load_dwordx4 v32, s[44:47], s77 offen offset:2048 lds
v_mfma_f32_16x16x32_bf16 v[212:215], v[116:119], a[12:15], v[212:215]
ds_read_b64_tr_b16 v[98:99], v10 offset:52224
ds_read_b64_tr_b16 v[100:101], v11 offset:35840
v_mfma_f32_16x16x32_bf16 v[200:203], v[120:123], a[8:11], v[200:203]
v_exp_f32 v240, v240
v_mfma_f32_16x16x32_bf16 v[216:219], v[120:123], a[12:15], v[216:219]
ds_read_b64_tr_b16 v[102:103], v11 offset:52224
s_waitcnt lgkmcnt(7)
v_mfma_f32_16x16x32_bf16 v[204:207], v[124:127], a[8:11], v[204:207]
ds_read_b64_tr_b16 v[104:105], v12 offset:35840
ds_read_b64_tr_b16 v[106:107], v12 offset:52224
v_mfma_f32_16x16x32_bf16 v[220:223], v[124:127], a[12:15], v[220:223]
buffer_load_dwordx4 v33, s[44:47], s77 offen offset:3072 lds
v_mfma_f32_16x16x32_bf16 v[192:195], v[80:83], a[16:19], v[192:195]
ds_read_b64_tr_b16 v[108:109], v13 offset:35840
ds_read_b64_tr_b16 v[110:111], v13 offset:52224
v_mfma_f32_16x16x32_bf16 v[208:211], v[80:83], a[20:23], v[208:211]
v_exp_f32 v241, v241
v_mfma_f32_16x16x32_bf16 v[196:199], v[84:87], a[16:19], v[196:199]
ds_read_b64_tr_b16 v[112:113], v10 offset:36864
ds_read_b64_tr_b16 v[114:115], v10 offset:53248
v_mfma_f32_16x16x32_bf16 v[212:215], v[84:87], a[20:23], v[212:215]
ds_read_b64_tr_b16 v[116:117], v11 offset:36864
s_waitcnt lgkmcnt(8)
v_mfma_f32_16x16x32_bf16 v[200:203], v[88:91], a[16:19], v[200:203]
s_add_u32 m0, s76, 4096
s_add_u32 s77, s84, 0x620080
v_mfma_f32_16x16x32_bf16 v[216:219], v[88:91], a[20:23], v[216:219]
ds_read_b64_tr_b16 v[118:119], v11 offset:53248
ds_read_b64_tr_b16 v[120:121], v12 offset:36864
v_mfma_f32_16x16x32_bf16 v[204:207], v[92:95], a[16:19], v[204:207]
buffer_load_dwordx4 v30, s[44:47], s77 offen offset:0 lds
v_mfma_f32_16x16x32_bf16 v[220:223], v[92:95], a[20:23], v[220:223]
ds_read_b64_tr_b16 v[122:123], v12 offset:53248
ds_read_b64_tr_b16 v[124:125], v13 offset:36864
v_mfma_f32_16x16x32_bf16 v[192:195], v[96:99], a[24:27], v[192:195]
v_exp_f32 v242, v242
v_mfma_f32_16x16x32_bf16 v[208:211], v[96:99], a[28:31], v[208:211]
ds_read_b64_tr_b16 v[126:127], v13 offset:53248
s_waitcnt lgkmcnt(6)
v_mfma_f32_16x16x32_bf16 v[196:199], v[100:103], a[24:27], v[196:199]
ds_read_b64_tr_b16 v[80:81], v10 offset:37888
ds_read_b64_tr_b16 v[82:83], v10 offset:54272
v_mfma_f32_16x16x32_bf16 v[212:215], v[100:103], a[28:31], v[212:215]
buffer_load_dwordx4 v31, s[44:47], s77 offen offset:1024 lds
v_mfma_f32_16x16x32_bf16 v[200:203], v[104:107], a[24:27], v[200:203]
ds_read_b64_tr_b16 v[84:85], v11 offset:37888
ds_read_b64_tr_b16 v[86:87], v11 offset:54272
v_mfma_f32_16x16x32_bf16 v[216:219], v[104:107], a[28:31], v[216:219]
v_exp_f32 v243, v243
v_mfma_f32_16x16x32_bf16 v[204:207], v[108:111], a[24:27], v[204:207]
ds_read_b64_tr_b16 v[88:89], v12 offset:37888
v_fma_f32 v240, v240, v62, v62
v_mfma_f32_16x16x32_bf16 v[220:223], v[108:111], a[28:31], v[220:223]
ds_read_b64_tr_b16 v[90:91], v12 offset:54272
v_fma_f32 v241, v241, v62, v62
v_mfma_f32_16x16x32_bf16 v[192:195], v[112:115], a[32:35], v[192:195]
ds_read_b64_tr_b16 v[92:93], v13 offset:37888
v_fma_f32 v242, v242, v62, v62
v_mfma_f32_16x16x32_bf16 v[208:211], v[112:115], a[36:39], v[208:211]
ds_read_b64_tr_b16 v[94:95], v13 offset:54272
s_waitcnt lgkmcnt(6)
v_mfma_f32_16x16x32_bf16 v[196:199], v[116:119], a[32:35], v[196:199]
ds_read_b64_tr_b16 v[96:97], v10 offset:38912
v_fma_f32 v243, v243, v62, v62
v_mfma_f32_16x16x32_bf16 v[212:215], v[116:119], a[36:39], v[212:215]
ds_read_b64_tr_b16 v[98:99], v10 offset:55296
ds_read_b64_tr_b16 v[100:101], v11 offset:38912
v_mfma_f32_16x16x32_bf16 v[200:203], v[120:123], a[32:35], v[200:203]
buffer_load_dwordx4 v32, s[44:47], s77 offen offset:2048 lds
v_mfma_f32_16x16x32_bf16 v[216:219], v[120:123], a[36:39], v[216:219]
ds_read_b64_tr_b16 v[102:103], v11 offset:55296
ds_read_b64_tr_b16 v[104:105], v12 offset:38912
v_mfma_f32_16x16x32_bf16 v[204:207], v[124:127], a[32:35], v[204:207]
v_rcp_f32 v240, v240
v_mfma_f32_16x16x32_bf16 v[220:223], v[124:127], a[36:39], v[220:223]
ds_read_b64_tr_b16 v[106:107], v12 offset:55296
ds_read_b64_tr_b16 v[108:109], v13 offset:38912
v_mfma_f32_16x16x32_bf16 v[192:195], v[80:83], a[40:43], v[192:195]
v_rcp_f32 v241, v241
v_mfma_f32_16x16x32_bf16 v[208:211], v[80:83], a[44:47], v[208:211]
ds_read_b64_tr_b16 v[110:111], v13 offset:55296
s_waitcnt lgkmcnt(7)
v_mfma_f32_16x16x32_bf16 v[196:199], v[84:87], a[40:43], v[196:199]
ds_read_b64_tr_b16 v[112:113], v10 offset:39936
ds_read_b64_tr_b16 v[114:115], v10 offset:56320
v_mfma_f32_16x16x32_bf16 v[212:215], v[84:87], a[44:47], v[212:215]
buffer_load_dwordx4 v33, s[44:47], s77 offen offset:3072 lds
v_mfma_f32_16x16x32_bf16 v[200:203], v[88:91], a[40:43], v[200:203]
ds_read_b64_tr_b16 v[116:117], v11 offset:39936
ds_read_b64_tr_b16 v[118:119], v11 offset:56320
v_mfma_f32_16x16x32_bf16 v[216:219], v[88:91], a[44:47], v[216:219]
v_rcp_f32 v242, v242
v_mfma_f32_16x16x32_bf16 v[204:207], v[92:95], a[40:43], v[204:207]
ds_read_b64_tr_b16 v[120:121], v12 offset:39936
ds_read_b64_tr_b16 v[122:123], v12 offset:56320
v_mfma_f32_16x16x32_bf16 v[220:223], v[92:95], a[44:47], v[220:223]
ds_read_b64_tr_b16 v[124:125], v13 offset:39936
s_waitcnt lgkmcnt(8)
v_mfma_f32_16x16x32_bf16 v[192:195], v[96:99], a[48:51], v[192:195]
v_rcp_f32 v243, v243
v_mfma_f32_16x16x32_bf16 v[208:211], v[96:99], a[52:55], v[208:211]
ds_read_b64_tr_b16 v[126:127], v13 offset:56320
v_mul_f32 v160, v160, v240
v_mfma_f32_16x16x32_bf16 v[196:199], v[100:103], a[48:51], v[196:199]
v_mul_f32 v161, v161, v241
v_mul_f32 v162, v162, v242
v_mfma_f32_16x16x32_bf16 v[212:215], v[100:103], a[52:55], v[212:215]
v_mul_f32 v163, v163, v243
v_mul_f32 v244, v60, v164
v_mfma_f32_16x16x32_bf16 v[200:203], v[104:107], a[48:51], v[200:203]
v_mul_f32 v245, v60, v165
v_mul_f32 v246, v60, v166
v_mfma_f32_16x16x32_bf16 v[216:219], v[104:107], a[52:55], v[216:219]
v_mul_f32 v247, v60, v167
s_waitcnt lgkmcnt(2)
v_mfma_f32_16x16x32_bf16 v[204:207], v[108:111], a[48:51], v[204:207]
s_waitcnt vmcnt(21) lgkmcnt(0)
s_barrier
v_mfma_f32_16x16x32_bf16 v[220:223], v[108:111], a[52:55], v[220:223]
ds_read_b64_tr_b16 v[80:81], v14 offset:0
ds_read_b64_tr_b16 v[82:83], v14 offset:16384
v_mfma_f32_16x16x32_bf16 v[192:195], v[112:115], a[56:59], v[192:195]
ds_read_b64_tr_b16 v[84:85], v15 offset:0
ds_read_b64_tr_b16 v[86:87], v15 offset:16384
v_mfma_f32_16x16x32_bf16 v[208:211], v[112:115], a[60:63], v[208:211]
ds_read_b64_tr_b16 v[88:89], v16 offset:0
ds_read_b64_tr_b16 v[90:91], v16 offset:16384
v_mfma_f32_16x16x32_bf16 v[196:199], v[116:119], a[56:59], v[196:199]
ds_read_b64_tr_b16 v[92:93], v17 offset:0
ds_read_b64_tr_b16 v[94:95], v17 offset:16384
v_mfma_f32_16x16x32_bf16 v[212:215], v[116:119], a[60:63], v[212:215]
ds_read_b64_tr_b16 v[96:97], v14 offset:1024
ds_read_b64_tr_b16 v[98:99], v14 offset:17408
v_mfma_f32_16x16x32_bf16 v[200:203], v[120:123], a[56:59], v[200:203]
ds_read_b64_tr_b16 v[100:101], v15 offset:1024
s_add_u32 m0, s76, 32768
v_mfma_f32_16x16x32_bf16 v[216:219], v[120:123], a[60:63], v[216:219]
ds_read_b64_tr_b16 v[102:103], v15 offset:17408
s_add_u32 s77, s85, 0x0
v_mfma_f32_16x16x32_bf16 v[204:207], v[124:127], a[56:59], v[204:207]
ds_read_b64_tr_b16 v[104:105], v16 offset:1024
ds_read_b64_tr_b16 v[106:107], v16 offset:17408
v_mfma_f32_16x16x32_bf16 v[220:223], v[124:127], a[60:63], v[220:223]
ds_read_b64_tr_b16 v[108:109], v17 offset:1024
s_waitcnt lgkmcnt(11)
v_mfma_f32_16x16x32_bf16 v[192:195], v[80:83], a[64:67], v[192:195]
buffer_load_dwordx4 v34, s[52:55], s77 offen offset:0 lds
v_mfma_f32_16x16x32_bf16 v[208:211], v[80:83], a[68:71], v[208:211]
ds_read_b64_tr_b16 v[110:111], v17 offset:17408
ds_read_b64_tr_b16 v[112:113], v14 offset:2048
v_mfma_f32_16x16x32_bf16 v[196:199], v[84:87], a[64:67], v[196:199]
v_exp_f32 v244, v244
v_mfma_f32_16x16x32_bf16 v[212:215], v[84:87], a[68:71], v[212:215]
ds_read_b64_tr_b16 v[114:115], v14 offset:18432
s_waitcnt lgkmcnt(7)
v_mfma_f32_16x16x32_bf16 v[200:203], v[88:91], a[64:67], v[200:203]
ds_read_b64_tr_b16 v[116:117], v15 offset:2048
ds_read_b64_tr_b16 v[118:119], v15 offset:18432
v_mfma_f32_16x16x32_bf16 v[216:219], v[88:91], a[68:71], v[216:219]
buffer_load_dwordx4 v35, s[52:55], s77 offen offset:1024 lds
v_mfma_f32_16x16x32_bf16 v[204:207], v[92:95], a[64:67], v[204:207]
ds_read_b64_tr_b16 v[120:121], v16 offset:2048
ds_read_b64_tr_b16 v[122:123], v16 offset:18432
v_mfma_f32_16x16x32_bf16 v[220:223], v[92:95], a[68:71], v[220:223]
v_exp_f32 v245, v245
v_mfma_f32_16x16x32_bf16 v[192:195], v[96:99], a[72:75], v[192:195]
ds_read_b64_tr_b16 v[124:125], v17 offset:2048
ds_read_b64_tr_b16 v[126:127], v17 offset:18432
v_mfma_f32_16x16x32_bf16 v[208:211], v[96:99], a[76:79], v[208:211]
ds_read_b64_tr_b16 v[80:81], v14 offset:3072
s_waitcnt lgkmcnt(8)
v_mfma_f32_16x16x32_bf16 v[196:199], v[100:103], a[72:75], v[196:199]
buffer_load_dwordx4 v36, s[52:55], s77 offen offset:2048 lds
v_mfma_f32_16x16x32_bf16 v[212:215], v[100:103], a[76:79], v[212:215]
ds_read_b64_tr_b16 v[82:83], v14 offset:19456
ds_read_b64_tr_b16 v[84:85], v15 offset:3072
v_mfma_f32_16x16x32_bf16 v[200:203], v[104:107], a[72:75], v[200:203]
v_exp_f32 v246, v246
v_mfma_f32_16x16x32_bf16 v[216:219], v[104:107], a[76:79], v[216:219]
ds_read_b64_tr_b16 v[86:87], v15 offset:19456
ds_read_b64_tr_b16 v[88:89], v16 offset:3072
v_mfma_f32_16x16x32_bf16 v[204:207], v[108:111], a[72:75], v[204:207]
v_exp_f32 v247, v247
v_mfma_f32_16x16x32_bf16 v[220:223], v[108:111], a[76:79], v[220:223]
ds_read_b64_tr_b16 v[90:91], v16 offset:19456
s_waitcnt lgkmcnt(6)
v_mfma_f32_16x16x32_bf16 v[192:195], v[112:115], a[80:83], v[192:195]
ds_read_b64_tr_b16 v[92:93], v17 offset:3072
v_fma_f32 v244, v244, v62, v62
v_mfma_f32_16x16x32_bf16 v[208:211], v[112:115], a[84:87], v[208:211]
ds_read_b64_tr_b16 v[94:95], v17 offset:19456
v_fma_f32 v245, v245, v62, v62
v_mfma_f32_16x16x32_bf16 v[196:199], v[116:119], a[80:83], v[196:199]
ds_read_b64_tr_b16 v[96:97], v14 offset:4096
v_fma_f32 v246, v246, v62, v62
v_mfma_f32_16x16x32_bf16 v[212:215], v[116:119], a[84:87], v[212:215]
ds_read_b64_tr_b16 v[98:99], v14 offset:20480
v_fma_f32 v247, v247, v62, v62
v_mfma_f32_16x16x32_bf16 v[200:203], v[120:123], a[80:83], v[200:203]
ds_read_b64_tr_b16 v[100:101], v15 offset:4096
ds_read_b64_tr_b16 v[102:103], v15 offset:20480
v_mfma_f32_16x16x32_bf16 v[216:219], v[120:123], a[84:87], v[216:219]
buffer_load_dwordx4 v37, s[52:55], s77 offen offset:3072 lds
v_mfma_f32_16x16x32_bf16 v[204:207], v[124:127], a[80:83], v[204:207]
ds_read_b64_tr_b16 v[104:105], v16 offset:4096
ds_read_b64_tr_b16 v[106:107], v16 offset:20480
v_mfma_f32_16x16x32_bf16 v[220:223], v[124:127], a[84:87], v[220:223]
ds_read_b64_tr_b16 v[108:109], v17 offset:4096
s_waitcnt lgkmcnt(8)
v_mfma_f32_16x16x32_bf16 v[192:195], v[80:83], a[88:91], v[192:195]
v_rcp_f32 v244, v244
v_mfma_f32_16x16x32_bf16 v[208:211], v[80:83], a[92:95], v[208:211]
ds_read_b64_tr_b16 v[110:111], v17 offset:20480
ds_read_b64_tr_b16 v[112:113], v14 offset:5120
v_mfma_f32_16x16x32_bf16 v[196:199], v[84:87], a[88:91], v[196:199]
s_add_u32 m0, s76, 36864
s_add_u32 s77, s85, 0xe0000
v_mfma_f32_16x16x32_bf16 v[212:215], v[84:87], a[92:95], v[212:215]
ds_read_b64_tr_b16 v[114:115], v14 offset:21504
ds_read_b64_tr_b16 v[116:117], v15 offset:5120
v_mfma_f32_16x16x32_bf16 v[200:203], v[88:91], a[88:91], v[200:203]
buffer_load_dwordx4 v34, s[52:55], s77 offen offset:0 lds
v_mfma_f32_16x16x32_bf16 v[216:219], v[88:91], a[92:95], v[216:219]
ds_read_b64_tr_b16 v[118:119], v15 offset:21504
s_waitcnt lgkmcnt(6)
v_mfma_f32_16x16x32_bf16 v[204:207], v[92:95], a[88:91], v[204:207]
ds_read_b64_tr_b16 v[120:121], v16 offset:5120
ds_read_b64_tr_b16 v[122:123], v16 offset:21504
v_mfma_f32_16x16x32_bf16 v[220:223], v[92:95], a[92:95], v[220:223]
v_rcp_f32 v245, v245
v_mfma_f32_16x16x32_bf16 v[192:195], v[96:99], a[96:99], v[192:195]
ds_read_b64_tr_b16 v[124:125], v17 offset:5120
ds_read_b64_tr_b16 v[126:127], v17 offset:21504
v_mfma_f32_16x16x32_bf16 v[208:211], v[96:99], a[100:103], v[208:211]
buffer_load_dwordx4 v35, s[52:55], s77 offen offset:1024 lds
v_mfma_f32_16x16x32_bf16 v[196:199], v[100:103], a[96:99], v[196:199]
ds_read_b64_tr_b16 v[80:81], v14 offset:6144
ds_read_b64_tr_b16 v[82:83], v14 offset:22528
v_mfma_f32_16x16x32_bf16 v[212:215], v[100:103], a[100:103], v[212:215]
v_rcp_f32 v246, v246
v_mfma_f32_16x16x32_bf16 v[200:203], v[104:107], a[96:99], v[200:203]
ds_read_b64_tr_b16 v[84:85], v15 offset:6144
ds_read_b64_tr_b16 v[86:87], v15 offset:22528
v_mfma_f32_16x16x32_bf16 v[216:219], v[104:107], a[100:103], v[216:219]
ds_read_b64_tr_b16 v[88:89], v16 offset:6144
s_waitcnt lgkmcnt(7)
v_mfma_f32_16x16x32_bf16 v[204:207], v[108:111], a[96:99], v[204:207]
buffer_load_dwordx4 v36, s[52:55], s77 offen offset:2048 lds
v_mfma_f32_16x16x32_bf16 v[220:223], v[108:111], a[100:103], v[220:223]
ds_read_b64_tr_b16 v[90:91], v16 offset:22528
ds_read_b64_tr_b16 v[92:93], v17 offset:6144
v_mfma_f32_16x16x32_bf16 v[192:195], v[112:115], a[104:107], v[192:195]
v_rcp_f32 v247, v247
v_mfma_f32_16x16x32_bf16 v[208:211], v[112:115], a[108:111], v[208:211]
ds_read_b64_tr_b16 v[94:95], v17 offset:22528
v_mul_f32 v164, v164, v244
v_mfma_f32_16x16x32_bf16 v[196:199], v[116:119], a[104:107], v[196:199]
ds_read_b64_tr_b16 v[96:97], v14 offset:7168
v_mul_f32 v165, v165, v245
v_mfma_f32_16x16x32_bf16 v[212:215], v[116:119], a[108:111], v[212:215]
ds_read_b64_tr_b16 v[98:99], v14 offset:23552
v_mul_f32 v166, v166, v246
v_mfma_f32_16x16x32_bf16 v[200:203], v[120:123], a[104:107], v[200:203]
ds_read_b64_tr_b16 v[100:101], v15 offset:7168
v_mul_f32 v167, v167, v247
v_mfma_f32_16x16x32_bf16 v[216:219], v[120:123], a[108:111], v[216:219]
ds_read_b64_tr_b16 v[102:103], v15 offset:23552
s_waitcnt lgkmcnt(7)
v_mfma_f32_16x16x32_bf16 v[204:207], v[124:127], a[104:107], v[204:207]
ds_read_b64_tr_b16 v[104:105], v16 offset:7168
v_mul_f32 v240, v60, v168
v_mfma_f32_16x16x32_bf16 v[220:223], v[124:127], a[108:111], v[220:223]
ds_read_b64_tr_b16 v[106:107], v16 offset:23552
v_mul_f32 v241, v60, v169
v_mfma_f32_16x16x32_bf16 v[192:195], v[80:83], a[112:115], v[192:195]
ds_read_b64_tr_b16 v[108:109], v17 offset:7168
v_mul_f32 v242, v60, v170
v_mfma_f32_16x16x32_bf16 v[208:211], v[80:83], a[116:119], v[208:211]
ds_read_b64_tr_b16 v[110:111], v17 offset:23552
v_mul_f32 v243, v60, v171
v_mfma_f32_16x16x32_bf16 v[196:199], v[84:87], a[112:115], v[196:199]
buffer_load_dwordx4 v37, s[52:55], s77 offen offset:3072 lds
v_mfma_f32_16x16x32_bf16 v[212:215], v[84:87], a[116:119], v[212:215]
s_waitcnt lgkmcnt(5)
v_mfma_f32_16x16x32_bf16 v[200:203], v[88:91], a[112:115], v[200:203]
v_exp_f32 v240, v240
v_mfma_f32_16x16x32_bf16 v[216:219], v[88:91], a[116:119], v[216:219]
v_exp_f32 v241, v241
v_mfma_f32_16x16x32_bf16 v[204:207], v[92:95], a[112:115], v[204:207]
s_waitcnt vmcnt(17) lgkmcnt(0)
s_barrier
v_mfma_f32_16x16x32_bf16 v[220:223], v[92:95], a[116:119], v[220:223]
ds_read_b64_tr_b16 v[112:113], v14 offset:32768
ds_read_b64_tr_b16 v[114:115], v14 offset:49152
v_mfma_f32_16x16x32_bf16 v[192:195], v[96:99], a[120:123], v[192:195]
ds_read_b64_tr_b16 v[116:117], v15 offset:32768
ds_read_b64_tr_b16 v[118:119], v15 offset:49152
v_mfma_f32_16x16x32_bf16 v[208:211], v[96:99], a[124:127], v[208:211]
ds_read_b64_tr_b16 v[120:121], v16 offset:32768
ds_read_b64_tr_b16 v[122:123], v16 offset:49152
v_mfma_f32_16x16x32_bf16 v[196:199], v[100:103], a[120:123], v[196:199]
ds_read_b64_tr_b16 v[124:125], v17 offset:32768
ds_read_b64_tr_b16 v[126:127], v17 offset:49152
v_mfma_f32_16x16x32_bf16 v[212:215], v[100:103], a[124:127], v[212:215]
ds_read_b64_tr_b16 v[80:81], v14 offset:33792
ds_read_b64_tr_b16 v[82:83], v14 offset:50176
v_mfma_f32_16x16x32_bf16 v[200:203], v[104:107], a[120:123], v[200:203]
ds_read_b64_tr_b16 v[84:85], v15 offset:33792
s_add_u32 m0, s76, 65536
v_mfma_f32_16x16x32_bf16 v[216:219], v[104:107], a[124:127], v[216:219]
ds_read_b64_tr_b16 v[86:87], v15 offset:50176
s_add_u32 s77, s85, 0x1c0000
v_mfma_f32_16x16x32_bf16 v[204:207], v[108:111], a[120:123], v[204:207]
ds_read_b64_tr_b16 v[88:89], v16 offset:33792
ds_read_b64_tr_b16 v[90:91], v16 offset:50176
v_mfma_f32_16x16x32_bf16 v[220:223], v[108:111], a[124:127], v[220:223]
ds_read_b64_tr_b16 v[92:93], v17 offset:33792
s_waitcnt lgkmcnt(11)
v_mfma_f32_16x16x32_bf16 v[192:195], v[112:115], a[128:131], v[192:195]
buffer_load_dwordx4 v34, s[52:55], s77 offen offset:0 lds
v_mfma_f32_16x16x32_bf16 v[208:211], v[112:115], a[132:135], v[208:211]
ds_read_b64_tr_b16 v[94:95], v17 offset:50176
ds_read_b64_tr_b16 v[96:97], v14 offset:34816
v_mfma_f32_16x16x32_bf16 v[196:199], v[116:119], a[128:131], v[196:199]
v_exp_f32 v242, v242
v_mfma_f32_16x16x32_bf16 v[212:215], v[116:119], a[132:135], v[212:215]
ds_read_b64_tr_b16 v[98:99], v14 offset:51200
s_waitcnt lgkmcnt(7)
v_mfma_f32_16x16x32_bf16 v[200:203], v[120:123], a[128:131], v[200:203]
ds_read_b64_tr_b16 v[100:101], v15 offset:34816
ds_read_b64_tr_b16 v[102:103], v15 offset:51200
v_mfma_f32_16x16x32_bf16 v[216:219], v[120:123], a[132:135], v[216:219]
buffer_load_dwordx4 v35, s[52:55], s77 offen offset:1024 lds
v_mfma_f32_16x16x32_bf16 v[204:207], v[124:127], a[128:131], v[204:207]
ds_read_b64_tr_b16 v[104:105], v16 offset:34816
ds_read_b64_tr_b16 v[106:107], v16 offset:51200
v_mfma_f32_16x16x32_bf16 v[220:223], v[124:127], a[132:135], v[220:223]
v_exp_f32 v243, v243
v_mfma_f32_16x16x32_bf16 v[192:195], v[80:83], a[136:139], v[192:195]
ds_read_b64_tr_b16 v[108:109], v17 offset:34816
v_fma_f32 v240, v240, v62, v62
v_mfma_f32_16x16x32_bf16 v[208:211], v[80:83], a[140:143], v[208:211]
ds_read_b64_tr_b16 v[110:111], v17 offset:51200
s_waitcnt lgkmcnt(7)
v_mfma_f32_16x16x32_bf16 v[196:199], v[84:87], a[136:139], v[196:199]
ds_read_b64_tr_b16 v[112:113], v14 offset:35840
v_fma_f32 v241, v241, v62, v62
v_mfma_f32_16x16x32_bf16 v[212:215], v[84:87], a[140:143], v[212:215]
ds_read_b64_tr_b16 v[114:115], v14 offset:52224
v_fma_f32 v242, v242, v62, v62
v_mfma_f32_16x16x32_bf16 v[200:203], v[88:91], a[136:139], v[200:203]
ds_read_b64_tr_b16 v[116:117], v15 offset:35840
v_fma_f32 v243, v243, v62, v62
v_mfma_f32_16x16x32_bf16 v[216:219], v[88:91], a[140:143], v[216:219]
ds_read_b64_tr_b16 v[118:119], v15 offset:52224
ds_read_b64_tr_b16 v[120:121], v16 offset:35840
v_mfma_f32_16x16x32_bf16 v[204:207], v[92:95], a[136:139], v[204:207]
buffer_load_dwordx4 v36, s[52:55], s77 offen offset:2048 lds
v_mfma_f32_16x16x32_bf16 v[220:223], v[92:95], a[140:143], v[220:223]
ds_read_b64_tr_b16 v[122:123], v16 offset:52224
s_waitcnt lgkmcnt(7)
v_mfma_f32_16x16x32_bf16 v[192:195], v[96:99], a[144:147], v[192:195]
ds_read_b64_tr_b16 v[124:125], v17 offset:35840
ds_read_b64_tr_b16 v[126:127], v17 offset:52224
v_mfma_f32_16x16x32_bf16 v[208:211], v[96:99], a[148:151], v[208:211]
v_rcp_f32 v240, v240
v_mfma_f32_16x16x32_bf16 v[196:199], v[100:103], a[144:147], v[196:199]
ds_read_b64_tr_b16 v[80:81], v14 offset:36864
ds_read_b64_tr_b16 v[82:83], v14 offset:53248
v_mfma_f32_16x16x32_bf16 v[212:215], v[100:103], a[148:151], v[212:215]
buffer_load_dwordx4 v37, s[52:55], s77 offen offset:3072 lds
v_mfma_f32_16x16x32_bf16 v[200:203], v[104:107], a[144:147], v[200:203]
ds_read_b64_tr_b16 v[84:85], v15 offset:36864
ds_read_b64_tr_b16 v[86:87], v15 offset:53248
v_mfma_f32_16x16x32_bf16 v[216:219], v[104:107], a[148:151], v[216:219]
ds_read_b64_tr_b16 v[88:89], v16 offset:36864
s_waitcnt lgkmcnt(8)
v_mfma_f32_16x16x32_bf16 v[204:207], v[108:111], a[144:147], v[204:207]
v_rcp_f32 v241, v241
v_mfma_f32_16x16x32_bf16 v[220:223], v[108:111], a[148:151], v[220:223]
ds_read_b64_tr_b16 v[90:91], v16 offset:53248
ds_read_b64_tr_b16 v[92:93], v17 offset:36864
v_mfma_f32_16x16x32_bf16 v[192:195], v[112:115], a[152:155], v[192:195]
s_add_u32 m0, s76, 69632
s_add_u32 s77, s85, 0x2a0000
v_mfma_f32_16x16x32_bf16 v[208:211], v[112:115], a[156:159], v[208:211]
ds_read_b64_tr_b16 v[94:95], v17 offset:53248
ds_read_b64_tr_b16 v[96:97], v14 offset:37888
v_mfma_f32_16x16x32_bf16 v[196:199], v[116:119], a[152:155], v[196:199]
buffer_load_dwordx4 v34, s[52:55], s77 offen offset:0 lds
v_mfma_f32_16x16x32_bf16 v[212:215], v[116:119], a[156:159], v[212:215]
ds_read_b64_tr_b16 v[98:99], v14 offset:54272
s_waitcnt lgkmcnt(6)
v_mfma_f32_16x16x32_bf16 v[200:203], v[120:123], a[152:155], v[200:203]
ds_read_b64_tr_b16 v[100:101], v15 offset:37888
ds_read_b64_tr_b16 v[102:103], v15 offset:54272
v_mfma_f32_16x16x32_bf16 v[216:219], v[120:123], a[156:159], v[216:219]
v_rcp_f32 v242, v242
v_mfma_f32_16x16x32_bf16 v[204:207], v[124:127], a[152:155], v[204:207]
ds_read_b64_tr_b16 v[104:105], v16 offset:37888
ds_read_b64_tr_b16 v[106:107], v16 offset:54272
v_mfma_f32_16x16x32_bf16 v[220:223], v[124:127], a[156:159], v[220:223]
buffer_load_dwordx4 v35, s[52:55], s77 offen offset:1024 lds
v_mfma_f32_16x16x32_bf16 v[192:195], v[80:83], a[160:163], v[192:195]
ds_read_b64_tr_b16 v[108:109], v17 offset:37888
ds_read_b64_tr_b16 v[110:111], v17 offset:54272
v_mfma_f32_16x16x32_bf16 v[208:211], v[80:83], a[164:167], v[208:211]
v_rcp_f32 v243, v243
v_mfma_f32_16x16x32_bf16 v[196:199], v[84:87], a[160:163], v[196:199]
ds_read_b64_tr_b16 v[112:113], v14 offset:38912
v_mul_f32 v168, v168, v240
v_mfma_f32_16x16x32_bf16 v[212:215], v[84:87], a[164:167], v[212:215]
ds_read_b64_tr_b16 v[114:115], v14 offset:55296
s_waitcnt lgkmcnt(6)
v_mfma_f32_16x16x32_bf16 v[200:203], v[88:91], a[160:163], v[200:203]
ds_read_b64_tr_b16 v[116:117], v15 offset:38912
v_mul_f32 v169, v169, v241
v_mfma_f32_16x16x32_bf16 v[216:219], v[88:91], a[164:167], v[216:219]
ds_read_b64_tr_b16 v[118:119], v15 offset:55296
v_mul_f32 v170, v170, v242
v_mfma_f32_16x16x32_bf16 v[204:207], v[92:95], a[160:163], v[204:207]
ds_read_b64_tr_b16 v[120:121], v16 offset:38912
v_mul_f32 v171, v171, v243
v_mfma_f32_16x16x32_bf16 v[220:223], v[92:95], a[164:167], v[220:223]
ds_read_b64_tr_b16 v[122:123], v16 offset:55296
v_mul_f32 v244, v60, v172
v_mfma_f32_16x16x32_bf16 v[192:195], v[96:99], a[168:171], v[192:195]
ds_read_b64_tr_b16 v[124:125], v17 offset:38912
v_mul_f32 v245, v60, v173
v_mfma_f32_16x16x32_bf16 v[208:211], v[96:99], a[172:175], v[208:211]
ds_read_b64_tr_b16 v[126:127], v17 offset:55296
v_mul_f32 v246, v60, v174
v_mfma_f32_16x16x32_bf16 v[196:199], v[100:103], a[168:171], v[196:199]
ds_read_b64_tr_b16 v[80:81], v14 offset:39936
v_mul_f32 v247, v60, v175
v_mfma_f32_16x16x32_bf16 v[212:215], v[100:103], a[172:175], v[212:215]
ds_read_b64_tr_b16 v[82:83], v14 offset:56320
s_waitcnt lgkmcnt(7)
v_mfma_f32_16x16x32_bf16 v[200:203], v[104:107], a[168:171], v[200:203]
ds_read_b64_tr_b16 v[84:85], v15 offset:39936
ds_read_b64_tr_b16 v[86:87], v15 offset:56320
v_mfma_f32_16x16x32_bf16 v[216:219], v[104:107], a[172:175], v[216:219]
buffer_load_dwordx4 v36, s[52:55], s77 offen offset:2048 lds
v_mfma_f32_16x16x32_bf16 v[204:207], v[108:111], a[168:171], v[204:207]
ds_read_b64_tr_b16 v[88:89], v16 offset:39936
ds_read_b64_tr_b16 v[90:91], v16 offset:56320
v_mfma_f32_16x16x32_bf16 v[220:223], v[108:111], a[172:175], v[220:223]
v_exp_f32 v244, v244
v_mfma_f32_16x16x32_bf16 v[192:195], v[112:115], a[176:179], v[192:195]
ds_read_b64_tr_b16 v[92:93], v17 offset:39936
ds_read_b64_tr_b16 v[94:95], v17 offset:56320
v_mfma_f32_16x16x32_bf16 v[208:211], v[112:115], a[180:183], v[208:211]
s_waitcnt lgkmcnt(7)
v_mfma_f32_16x16x32_bf16 v[196:199], v[116:119], a[176:179], v[196:199]
buffer_load_dwordx4 v37, s[52:55], s77 offen offset:3072 lds
v_mfma_f32_16x16x32_bf16 v[212:215], v[116:119], a[180:183], v[212:215]
v_exp_f32 v245, v245
v_mfma_f32_16x16x32_bf16 v[200:203], v[120:123], a[176:179], v[200:203]
v_exp_f32 v246, v246
v_mfma_f32_16x16x32_bf16 v[216:219], v[120:123], a[180:183], v[216:219]
s_waitcnt vmcnt(16) lgkmcnt(0)
s_barrier
v_mfma_f32_16x16x32_bf16 v[204:207], v[124:127], a[176:179], v[204:207]
ds_read_b64_tr_b16 v[96:97], v10 offset:0
ds_read_b64_tr_b16 v[98:99], v10 offset:16384
v_mfma_f32_16x16x32_bf16 v[220:223], v[124:127], a[180:183], v[220:223]
ds_read_b64_tr_b16 v[100:101], v11 offset:0
ds_read_b64_tr_b16 v[102:103], v11 offset:16384
v_mfma_f32_16x16x32_bf16 v[192:195], v[80:83], a[184:187], v[192:195]
ds_read_b64_tr_b16 v[104:105], v12 offset:0
ds_read_b64_tr_b16 v[106:107], v12 offset:16384
v_mfma_f32_16x16x32_bf16 v[208:211], v[80:83], a[188:191], v[208:211]
ds_read_b64_tr_b16 v[108:109], v13 offset:0
ds_read_b64_tr_b16 v[110:111], v13 offset:16384
v_mfma_f32_16x16x32_bf16 v[196:199], v[84:87], a[184:187], v[196:199]
ds_read_b64_tr_b16 v[112:113], v10 offset:1024
s_add_u32 m0, s76, 98304
v_mfma_f32_16x16x32_bf16 v[212:215], v[84:87], a[188:191], v[212:215]
ds_read_b64_tr_b16 v[114:115], v10 offset:17408
s_add_u32 s77, s85, 0x380000
v_mfma_f32_16x16x32_bf16 v[200:203], v[88:91], a[184:187], v[200:203]
ds_read_b64_tr_b16 v[116:117], v11 offset:1024
ds_read_b64_tr_b16 v[118:119], v11 offset:17408
v_mfma_f32_16x16x32_bf16 v[216:219], v[88:91], a[188:191], v[216:219]
buffer_load_dwordx4 v34, s[52:55], s77 offen offset:0 lds
v_mfma_f32_16x16x32_bf16 v[204:207], v[92:95], a[184:187], v[204:207]
ds_read_b64_tr_b16 v[120:121], v12 offset:1024
ds_read_b64_tr_b16 v[122:123], v12 offset:17408
v_mfma_f32_16x16x32_bf16 v[220:223], v[92:95], a[188:191], v[220:223]
ds_read_b64_tr_b16 v[124:125], v13 offset:1024
s_waitcnt lgkmcnt(9)
v_mfma_f32_16x16x32_bf16 v[192:195], v[96:99], a[192:195], v[192:195]
v_exp_f32 v247, v247
v_mfma_f32_16x16x32_bf16 v[208:211], v[96:99], a[196:199], v[208:211]
ds_read_b64_tr_b16 v[126:127], v13 offset:17408
v_fma_f32 v244, v244, v62, v62
v_mfma_f32_16x16x32_bf16 v[196:199], v[100:103], a[192:195], v[196:199]
ds_read_b64_tr_b16 v[80:81], v10 offset:2048
v_fma_f32 v245, v245, v62, v62
v_mfma_f32_16x16x32_bf16 v[212:215], v[100:103], a[196:199], v[212:215]
ds_read_b64_tr_b16 v[82:83], v10 offset:18432
v_fma_f32 v246, v246, v62, v62
v_mfma_f32_16x16x32_bf16 v[200:203], v[104:107], a[192:195], v[200:203]
ds_read_b64_tr_b16 v[84:85], v11 offset:2048
v_fma_f32 v247, v247, v62, v62
v_mfma_f32_16x16x32_bf16 v[216:219], v[104:107], a[196:199], v[216:219]
ds_read_b64_tr_b16 v[86:87], v11 offset:18432
s_waitcnt lgkmcnt(6)
v_mfma_f32_16x16x32_bf16 v[204:207], v[108:111], a[192:195], v[204:207]
ds_read_b64_tr_b16 v[88:89], v12 offset:2048
ds_read_b64_tr_b16 v[90:91], v12 offset:18432
v_mfma_f32_16x16x32_bf16 v[220:223], v[108:111], a[196:199], v[220:223]
buffer_load_dwordx4 v35, s[52:55], s77 offen offset:1024 lds
v_mfma_f32_16x16x32_bf16 v[192:195], v[112:115], a[200:203], v[192:195]
ds_read_b64_tr_b16 v[92:93], v13 offset:2048
ds_read_b64_tr_b16 v[94:95], v13 offset:18432
v_mfma_f32_16x16x32_bf16 v[208:211], v[112:115], a[204:207], v[208:211]
v_rcp_f32 v244, v244
v_mfma_f32_16x16x32_bf16 v[196:199], v[116:119], a[200:203], v[196:199]
ds_read_b64_tr_b16 v[96:97], v10 offset:3072
ds_read_b64_tr_b16 v[98:99], v10 offset:19456
v_mfma_f32_16x16x32_bf16 v[212:215], v[116:119], a[204:207], v[212:215]
v_rcp_f32 v245, v245
v_mfma_f32_16x16x32_bf16 v[200:203], v[120:123], a[200:203], v[200:203]
ds_read_b64_tr_b16 v[100:101], v11 offset:3072
ds_read_b64_tr_b16 v[102:103], v11 offset:19456
v_mfma_f32_16x16x32_bf16 v[216:219], v[120:123], a[204:207], v[216:219]
ds_read_b64_tr_b16 v[104:105], v12 offset:3072
s_waitcnt lgkmcnt(7)
v_mfma_f32_16x16x32_bf16 v[204:207], v[124:127], a[200:203], v[204:207]
buffer_load_dwordx4 v36, s[52:55], s77 offen offset:2048 lds
v_mfma_f32_16x16x32_bf16 v[220:223], v[124:127], a[204:207], v[220:223]
ds_read_b64_tr_b16 v[106:107], v12 offset:19456
ds_read_b64_tr_b16 v[108:109], v13 offset:3072
v_mfma_f32_16x16x32_bf16 v[192:195], v[80:83], a[208:211], v[192:195]
v_rcp_f32 v246, v246
v_mfma_f32_16x16x32_bf16 v[208:211], v[80:83], a[212:215], v[208:211]
ds_read_b64_tr_b16 v[110:111], v13 offset:19456
ds_read_b64_tr_b16 v[112:113], v10 offset:4096
v_mfma_f32_16x16x32_bf16 v[196:199], v[84:87], a[208:211], v[196:199]
v_rcp_f32 v247, v247
v_mfma_f32_16x16x32_bf16 v[212:215], v[84:87], a[212:215], v[212:215]
ds_read_b64_tr_b16 v[114:115], v10 offset:20480
v_mul_f32 v172, v172, v244
v_mfma_f32_16x16x32_bf16 v[200:203], v[88:91], a[208:211], v[200:203]
ds_read_b64_tr_b16 v[116:117], v11 offset:4096
v_mul_f32 v173, v173, v245
v_mfma_f32_16x16x32_bf16 v[216:219], v[88:91], a[212:215], v[216:219]
ds_read_b64_tr_b16 v[118:119], v11 offset:20480
s_waitcnt lgkmcnt(7)
v_mfma_f32_16x16x32_bf16 v[204:207], v[92:95], a[208:211], v[204:207]
ds_read_b64_tr_b16 v[120:121], v12 offset:4096
v_mul_f32 v174, v174, v246
v_mfma_f32_16x16x32_bf16 v[220:223], v[92:95], a[212:215], v[220:223]
ds_read_b64_tr_b16 v[122:123], v12 offset:20480
v_mul_f32 v175, v175, v247
v_mfma_f32_16x16x32_bf16 v[192:195], v[96:99], a[216:219], v[192:195]
ds_read_b64_tr_b16 v[124:125], v13 offset:4096
v_mul_f32 v240, v61, v176
v_mfma_f32_16x16x32_bf16 v[208:211], v[96:99], a[220:223], v[208:211]
ds_read_b64_tr_b16 v[126:127], v13 offset:20480
v_mul_f32 v241, v61, v177
v_mfma_f32_16x16x32_bf16 v[196:199], v[100:103], a[216:219], v[196:199]
ds_read_b64_tr_b16 v[80:81], v10 offset:5120
v_mul_f32 v242, v61, v178
v_mfma_f32_16x16x32_bf16 v[212:215], v[100:103], a[220:223], v[212:215]
ds_read_b64_tr_b16 v[82:83], v10 offset:21504
s_waitcnt lgkmcnt(7)
v_mfma_f32_16x16x32_bf16 v[200:203], v[104:107], a[216:219], v[200:203]
ds_read_b64_tr_b16 v[84:85], v11 offset:5120
v_mul_f32 v243, v61, v179
v_mfma_f32_16x16x32_bf16 v[216:219], v[104:107], a[220:223], v[216:219]
ds_read_b64_tr_b16 v[86:87], v11 offset:21504
ds_read_b64_tr_b16 v[88:89], v12 offset:5120
v_mfma_f32_16x16x32_bf16 v[204:207], v[108:111], a[216:219], v[204:207]
buffer_load_dwordx4 v37, s[52:55], s77 offen offset:3072 lds
v_mfma_f32_16x16x32_bf16 v[220:223], v[108:111], a[220:223], v[220:223]
ds_read_b64_tr_b16 v[90:91], v12 offset:21504
ds_read_b64_tr_b16 v[92:93], v13 offset:5120
v_mfma_f32_16x16x32_bf16 v[192:195], v[112:115], a[224:227], v[192:195]
v_exp_f32 v240, v240
v_mfma_f32_16x16x32_bf16 v[208:211], v[112:115], a[228:231], v[208:211]
ds_read_b64_tr_b16 v[94:95], v13 offset:21504
s_waitcnt lgkmcnt(7)
v_mfma_f32_16x16x32_bf16 v[196:199], v[116:119], a[224:227], v[196:199]
ds_read_b64_tr_b16 v[96:97], v10 offset:6144
ds_read_b64_tr_b16 v[98:99], v10 offset:22528
v_mfma_f32_16x16x32_bf16 v[212:215], v[116:119], a[228:231], v[212:215]
s_add_u32 m0, s76, 102400
s_add_u32 s77, s85, 0x460000
v_mfma_f32_16x16x32_bf16 v[200:203], v[120:123], a[224:227], v[200:203]
ds_read_b64_tr_b16 v[100:101], v11 offset:6144
ds_read_b64_tr_b16 v[102:103], v11 offset:22528
v_mfma_f32_16x16x32_bf16 v[216:219], v[120:123], a[228:231], v[216:219]
buffer_load_dwordx4 v34, s[52:55], s77 offen offset:0 lds
v_mfma_f32_16x16x32_bf16 v[204:207], v[124:127], a[224:227], v[204:207]
ds_read_b64_tr_b16 v[104:105], v12 offset:6144
ds_read_b64_tr_b16 v[106:107], v12 offset:22528
v_mfma_f32_16x16x32_bf16 v[220:223], v[124:127], a[228:231], v[220:223]
ds_read_b64_tr_b16 v[108:109], v13 offset:6144
s_waitcnt lgkmcnt(8)
v_mfma_f32_16x16x32_bf16 v[192:195], v[80:83], a[232:235], v[192:195]
v_exp_f32 v241, v241
v_mfma_f32_16x16x32_bf16 v[208:211], v[80:83], a[236:239], v[208:211]
ds_read_b64_tr_b16 v[110:111], v13 offset:22528
ds_read_b64_tr_b16 v[112:113], v10 offset:7168
v_mfma_f32_16x16x32_bf16 v[196:199], v[84:87], a[232:235], v[196:199]
buffer_load_dwordx4 v35, s[52:55], s77 offen offset:1024 lds
v_mfma_f32_16x16x32_bf16 v[212:215], v[84:87], a[236:239], v[212:215]
ds_read_b64_tr_b16 v[114:115], v10 offset:23552
ds_read_b64_tr_b16 v[116:117], v11 offset:7168
v_mfma_f32_16x16x32_bf16 v[200:203], v[88:91], a[232:235], v[200:203]
v_exp_f32 v242, v242
v_mfma_f32_16x16x32_bf16 v[216:219], v[88:91], a[236:239], v[216:219]
ds_read_b64_tr_b16 v[118:119], v11 offset:23552
s_waitcnt lgkmcnt(6)
v_mfma_f32_16x16x32_bf16 v[204:207], v[92:95], a[232:235], v[204:207]
ds_read_b64_tr_b16 v[120:121], v12 offset:7168
ds_read_b64_tr_b16 v[122:123], v12 offset:23552
v_mfma_f32_16x16x32_bf16 v[220:223], v[92:95], a[236:239], v[220:223]
buffer_load_dwordx4 v36, s[52:55], s77 offen offset:2048 lds
v_mfma_f32_16x16x32_bf16 v[192:195], v[96:99], a[240:243], v[192:195]
ds_read_b64_tr_b16 v[124:125], v13 offset:7168
ds_read_b64_tr_b16 v[126:127], v13 offset:23552
v_mfma_f32_16x16x32_bf16 v[208:211], v[96:99], a[244:247], v[208:211]
buffer_load_dwordx4 v37, s[52:55], s77 offen offset:3072 lds
v_mfma_f32_16x16x32_bf16 v[196:199], v[100:103], a[240:243], v[196:199]
v_exp_f32 v243, v243
v_mfma_f32_16x16x32_bf16 v[212:215], v[100:103], a[244:247], v[212:215]
v_fma_f32 v240, v240, v63, v63
v_fma_f32 v241, v241, v63, v63
v_mfma_f32_16x16x32_bf16 v[200:203], v[104:107], a[240:243], v[200:203]
v_fma_f32 v242, v242, v63, v63
v_fma_f32 v243, v243, v63, v63
v_mfma_f32_16x16x32_bf16 v[216:219], v[104:107], a[244:247], v[216:219]
s_waitcnt vmcnt(16) lgkmcnt(0)
s_barrier
v_mfma_f32_16x16x32_bf16 v[204:207], v[108:111], a[240:243], v[204:207]
ds_read_b64_tr_b16 v[80:81], v18 offset:32768
ds_read_b64_tr_b16 v[82:83], v18 offset:40960
v_mfma_f32_16x16x32_bf16 v[220:223], v[108:111], a[244:247], v[220:223]
ds_read_b64_tr_b16 v[84:85], v19 offset:32768
ds_read_b64_tr_b16 v[86:87], v19 offset:40960
v_mfma_f32_16x16x32_bf16 v[192:195], v[112:115], a[248:251], v[192:195]
ds_read_b64_tr_b16 v[88:89], v18 offset:49152
ds_read_b64_tr_b16 v[90:91], v18 offset:57344
v_mfma_f32_16x16x32_bf16 v[208:211], v[112:115], a[252:255], v[208:211]
ds_read_b64_tr_b16 v[92:93], v19 offset:49152
ds_read_b64_tr_b16 v[94:95], v19 offset:57344
v_mfma_f32_16x16x32_bf16 v[196:199], v[116:119], a[248:251], v[196:199]
ds_read_b64_tr_b16 v[96:97], v18 offset:33792
s_add_u32 m0, s76, 0
v_mfma_f32_16x16x32_bf16 v[212:215], v[116:119], a[252:255], v[212:215]
ds_read_b64_tr_b16 v[98:99], v18 offset:41984
s_add_u32 s77, s85, 0x540000
v_mfma_f32_16x16x32_bf16 v[200:203], v[120:123], a[248:251], v[200:203]
ds_read_b64_tr_b16 v[100:101], v19 offset:33792
ds_read_b64_tr_b16 v[102:103], v19 offset:41984
v_mfma_f32_16x16x32_bf16 v[216:219], v[120:123], a[252:255], v[216:219]
buffer_load_dwordx4 v34, s[52:55], s77 offen offset:0 lds
v_mfma_f32_16x16x32_bf16 v[204:207], v[124:127], a[248:251], v[204:207]
ds_read_b64_tr_b16 v[104:105], v18 offset:50176
ds_read_b64_tr_b16 v[106:107], v18 offset:58368
v_mfma_f32_16x16x32_bf16 v[220:223], v[124:127], a[252:255], v[220:223]
v_rcp_f32 v240, v240
S_H:
s_waitcnt lgkmcnt(8)
v_mfma_f32_16x16x32_bf16 v[128:131], v[80:83], a[0:3], 0
ds_read_b64_tr_b16 v[108:109], v19 offset:50176
ds_read_b64_tr_b16 v[110:111], v19 offset:58368
v_mfma_f32_16x16x32_bf16 v[144:147], v[80:83], a[4:7], 0
v_rcp_f32 v241, v241
v_mfma_f32_16x16x32_bf16 v[132:135], v[84:87], a[0:3], 0
ds_read_b64_tr_b16 v[112:113], v18 offset:34816
ds_read_b64_tr_b16 v[114:115], v18 offset:43008
v_mfma_f32_16x16x32_bf16 v[148:151], v[84:87], a[4:7], 0
buffer_load_dwordx4 v35, s[52:55], s77 offen offset:1024 lds
v_mfma_f32_16x16x32_bf16 v[136:139], v[88:91], a[0:3], 0
ds_read_b64_tr_b16 v[116:117], v19 offset:34816
ds_read_b64_tr_b16 v[118:119], v19 offset:43008
v_mfma_f32_16x16x32_bf16 v[152:155], v[88:91], a[4:7], 0
ds_read_b64_tr_b16 v[120:121], v18 offset:51200
s_waitcnt lgkmcnt(7)
v_mfma_f32_16x16x32_bf16 v[140:143], v[92:95], a[0:3], 0
s_add_u32 s70, s0, S_G2 - K_pc + 0
s_addc_u32 s71, s1, 0
global_load_dword v57, v9, s[70:71]
v_mfma_f32_16x16x32_bf16 v[156:159], v[92:95], a[4:7], 0
ds_read_b64_tr_b16 v[122:123], v18 offset:59392
ds_read_b64_tr_b16 v[124:125], v19 offset:51200
v_mfma_f32_16x16x32_bf16 v[128:131], v[96:99], a[8:11], v[128:131]
buffer_load_dwordx4 v36, s[52:55], s77 offen offset:2048 lds
v_mfma_f32_16x16x32_bf16 v[144:147], v[96:99], a[12:15], v[144:147]
ds_read_b64_tr_b16 v[126:127], v19 offset:59392
ds_read_b64_tr_b16 v[80:81], v18 offset:35840
v_mfma_f32_16x16x32_bf16 v[132:135], v[100:103], a[8:11], v[132:135]
v_rcp_f32 v242, v242
v_mfma_f32_16x16x32_bf16 v[148:151], v[100:103], a[12:15], v[148:151]
ds_read_b64_tr_b16 v[82:83], v18 offset:44032
ds_read_b64_tr_b16 v[84:85], v19 offset:35840
v_mfma_f32_16x16x32_bf16 v[136:139], v[104:107], a[8:11], v[136:139]
v_rcp_f32 v243, v243
v_mfma_f32_16x16x32_bf16 v[152:155], v[104:107], a[12:15], v[152:155]
ds_read_b64_tr_b16 v[86:87], v19 offset:44032
s_waitcnt lgkmcnt(7)
v_mfma_f32_16x16x32_bf16 v[140:143], v[108:111], a[8:11], v[140:143]
ds_read_b64_tr_b16 v[88:89], v18 offset:52224
v_mul_f32 v176, v176, v240
v_mfma_f32_16x16x32_bf16 v[156:159], v[108:111], a[12:15], v[156:159]
ds_read_b64_tr_b16 v[90:91], v18 offset:60416
v_mul_f32 v177, v177, v241
v_mfma_f32_16x16x32_bf16 v[128:131], v[112:115], a[16:19], v[128:131]
ds_read_b64_tr_b16 v[92:93], v19 offset:52224
v_mul_f32 v178, v178, v242
v_mfma_f32_16x16x32_bf16 v[144:147], v[112:115], a[20:23], v[144:147]
ds_read_b64_tr_b16 v[94:95], v19 offset:60416
v_mul_f32 v179, v179, v243
v_mfma_f32_16x16x32_bf16 v[132:135], v[116:119], a[16:19], v[132:135]
ds_read_b64_tr_b16 v[96:97], v18 offset:36864
v_mul_f32 v244, v61, v180
v_mfma_f32_16x16x32_bf16 v[148:151], v[116:119], a[20:23], v[148:151]
ds_read_b64_tr_b16 v[98:99], v18 offset:45056
s_waitcnt lgkmcnt(7)
v_mfma_f32_16x16x32_bf16 v[136:139], v[120:123], a[16:19], v[136:139]
ds_read_b64_tr_b16 v[100:101], v19 offset:36864
v_mul_f32 v245, v61, v181
v_mfma_f32_16x16x32_bf16 v[152:155], v[120:123], a[20:23], v[152:155]
ds_read_b64_tr_b16 v[102:103], v19 offset:45056
v_mul_f32 v246, v61, v182
v_mfma_f32_16x16x32_bf16 v[140:143], v[124:127], a[16:19], v[140:143]
ds_read_b64_tr_b16 v[104:105], v18 offset:53248
v_mul_f32 v247, v61, v183
v_mfma_f32_16x16x32_bf16 v[156:159], v[124:127], a[20:23], v[156:159]
ds_read_b64_tr_b16 v[106:107], v18 offset:61440
ds_read_b64_tr_b16 v[108:109], v19 offset:53248
v_mfma_f32_16x16x32_bf16 v[128:131], v[80:83], a[24:27], v[128:131]
buffer_load_dwordx4 v37, s[52:55], s77 offen offset:3072 lds
v_mfma_f32_16x16x32_bf16 v[144:147], v[80:83], a[28:31], v[144:147]
ds_read_b64_tr_b16 v[110:111], v19 offset:61440
s_waitcnt lgkmcnt(7)
v_mfma_f32_16x16x32_bf16 v[132:135], v[84:87], a[24:27], v[132:135]
ds_read_b64_tr_b16 v[112:113], v18 offset:37888
ds_read_b64_tr_b16 v[114:115], v18 offset:46080
v_mfma_f32_16x16x32_bf16 v[148:151], v[84:87], a[28:31], v[148:151]
v_exp_f32 v244, v244
v_mfma_f32_16x16x32_bf16 v[136:139], v[88:91], a[24:27], v[136:139]
ds_read_b64_tr_b16 v[116:117], v19 offset:37888
ds_read_b64_tr_b16 v[118:119], v19 offset:46080
v_mfma_f32_16x16x32_bf16 v[152:155], v[88:91], a[28:31], v[152:155]
s_add_u32 m0, s76, 4096
s_add_u32 s77, s85, 0x620000
v_mfma_f32_16x16x32_bf16 v[140:143], v[92:95], a[24:27], v[140:143]
ds_read_b64_tr_b16 v[120:121], v18 offset:54272
ds_read_b64_tr_b16 v[122:123], v18 offset:62464
v_mfma_f32_16x16x32_bf16 v[156:159], v[92:95], a[28:31], v[156:159]
ds_read_b64_tr_b16 v[124:125], v19 offset:54272
s_waitcnt lgkmcnt(8)
v_mfma_f32_16x16x32_bf16 v[128:131], v[96:99], a[32:35], v[128:131]
buffer_load_dwordx4 v34, s[52:55], s77 offen offset:0 lds
v_mfma_f32_16x16x32_bf16 v[144:147], v[96:99], a[36:39], v[144:147]
ds_read_b64_tr_b16 v[126:127], v19 offset:62464
ds_read_b64_tr_b16 v[80:81], v18 offset:38912
v_mfma_f32_16x16x32_bf16 v[132:135], v[100:103], a[32:35], v[132:135]
v_exp_f32 v245, v245
v_mfma_f32_16x16x32_bf16 v[148:151], v[100:103], a[36:39], v[148:151]
ds_read_b64_tr_b16 v[82:83], v18 offset:47104
ds_read_b64_tr_b16 v[84:85], v19 offset:38912
v_mfma_f32_16x16x32_bf16 v[136:139], v[104:107], a[32:35], v[136:139]
v_exp_f32 v246, v246
v_mfma_f32_16x16x32_bf16 v[152:155], v[104:107], a[36:39], v[152:155]
ds_read_b64_tr_b16 v[86:87], v19 offset:47104
s_waitcnt lgkmcnt(6)
v_mfma_f32_16x16x32_bf16 v[140:143], v[108:111], a[32:35], v[140:143]
ds_read_b64_tr_b16 v[88:89], v18 offset:55296
ds_read_b64_tr_b16 v[90:91], v18 offset:63488
v_mfma_f32_16x16x32_bf16 v[156:159], v[108:111], a[36:39], v[156:159]
buffer_load_dwordx4 v35, s[52:55], s77 offen offset:1024 lds
v_mfma_f32_16x16x32_bf16 v[128:131], v[112:115], a[40:43], v[128:131]
ds_read_b64_tr_b16 v[92:93], v19 offset:55296
ds_read_b64_tr_b16 v[94:95], v19 offset:63488
v_mfma_f32_16x16x32_bf16 v[144:147], v[112:115], a[44:47], v[144:147]
v_exp_f32 v247, v247
v_mfma_f32_16x16x32_bf16 v[132:135], v[116:119], a[40:43], v[132:135]
ds_read_b64_tr_b16 v[96:97], v18 offset:39936
v_fma_f32 v244, v244, v63, v63
v_mfma_f32_16x16x32_bf16 v[148:151], v[116:119], a[44:47], v[148:151]
ds_read_b64_tr_b16 v[98:99], v18 offset:48128
v_fma_f32 v245, v245, v63, v63
v_mfma_f32_16x16x32_bf16 v[136:139], v[120:123], a[40:43], v[136:139]
ds_read_b64_tr_b16 v[100:101], v19 offset:39936
v_fma_f32 v246, v246, v63, v63
v_mfma_f32_16x16x32_bf16 v[152:155], v[120:123], a[44:47], v[152:155]
ds_read_b64_tr_b16 v[102:103], v19 offset:48128
s_waitcnt lgkmcnt(6)
v_mfma_f32_16x16x32_bf16 v[140:143], v[124:127], a[40:43], v[140:143]
ds_read_b64_tr_b16 v[104:105], v18 offset:56320
v_fma_f32 v247, v247, v63, v63
v_mfma_f32_16x16x32_bf16 v[156:159], v[124:127], a[44:47], v[156:159]
ds_read_b64_tr_b16 v[106:107], v18 offset:64512
ds_read_b64_tr_b16 v[108:109], v19 offset:56320
v_mfma_f32_16x16x32_bf16 v[128:131], v[80:83], a[48:51], v[128:131]
buffer_load_dwordx4 v36, s[52:55], s77 offen offset:2048 lds
v_mfma_f32_16x16x32_bf16 v[144:147], v[80:83], a[52:55], v[144:147]
ds_read_b64_tr_b16 v[110:111], v19 offset:64512
v_mfma_f32_16x16x32_bf16 v[132:135], v[84:87], a[48:51], v[132:135]
buffer_load_dwordx4 v37, s[52:55], s77 offen offset:3072 lds
v_mfma_f32_16x16x32_bf16 v[148:151], v[84:87], a[52:55], v[148:151]
v_rcp_f32 v244, v244
v_mfma_f32_16x16x32_bf16 v[136:139], v[88:91], a[48:51], v[136:139]
v_rcp_f32 v245, v245
v_mfma_f32_16x16x32_bf16 v[152:155], v[88:91], a[52:55], v[152:155]
s_waitcnt lgkmcnt(3)
v_mfma_f32_16x16x32_bf16 v[140:143], v[92:95], a[48:51], v[140:143]
s_waitcnt vmcnt(17) lgkmcnt(0)
s_barrier
v_mfma_f32_16x16x32_bf16 v[156:159], v[92:95], a[52:55], v[156:159]
ds_read_b64_tr_b16 v[112:113], v20 offset:0
ds_read_b64_tr_b16 v[114:115], v20 offset:8192
v_mfma_f32_16x16x32_bf16 v[128:131], v[96:99], a[56:59], v[128:131]
ds_read_b64_tr_b16 v[116:117], v21 offset:0
ds_read_b64_tr_b16 v[118:119], v21 offset:8192
v_mfma_f32_16x16x32_bf16 v[144:147], v[96:99], a[60:63], v[144:147]
ds_read_b64_tr_b16 v[120:121], v20 offset:16384
ds_read_b64_tr_b16 v[122:123], v20 offset:24576
v_mfma_f32_16x16x32_bf16 v[132:135], v[100:103], a[56:59], v[132:135]
ds_read_b64_tr_b16 v[124:125], v21 offset:16384
ds_read_b64_tr_b16 v[126:127], v21 offset:24576
v_mfma_f32_16x16x32_bf16 v[148:151], v[100:103], a[60:63], v[148:151]
ds_read_b64_tr_b16 v[80:81], v20 offset:1024
ds_read_b64_tr_b16 v[82:83], v20 offset:9216
v_mfma_f32_16x16x32_bf16 v[136:139], v[104:107], a[56:59], v[136:139]
ds_read_b64_tr_b16 v[84:85], v21 offset:1024
s_add_u32 m0, s76, 32768
v_mfma_f32_16x16x32_bf16 v[152:155], v[104:107], a[60:63], v[152:155]
ds_read_b64_tr_b16 v[86:87], v21 offset:9216
s_add_u32 s77, s84, 0x100
ds_read_b64_tr_b16 v[88:89], v20 offset:17408
v_mfma_f32_16x16x32_bf16 v[140:143], v[108:111], a[56:59], v[140:143]
buffer_load_dwordx4 v30, s[40:43], s77 offen offset:0 lds
v_mfma_f32_16x16x32_bf16 v[156:159], v[108:111], a[60:63], v[156:159]
ds_read_b64_tr_b16 v[90:91], v20 offset:25600
s_waitcnt lgkmcnt(10)
v_mfma_f32_16x16x32_bf16 v[128:131], v[112:115], a[64:67], v[128:131]
ds_read_b64_tr_b16 v[92:93], v21 offset:17408
ds_read_b64_tr_b16 v[94:95], v21 offset:25600
v_mfma_f32_16x16x32_bf16 v[144:147], v[112:115], a[68:71], v[144:147]
v_rcp_f32 v246, v246
ds_read_b64_tr_b16 v[96:97], v20 offset:2048
v_mfma_f32_16x16x32_bf16 v[132:135], v[116:119], a[64:67], v[132:135]
v_rcp_f32 v247, v247
v_mfma_f32_16x16x32_bf16 v[148:151], v[116:119], a[68:71], v[148:151]
ds_read_b64_tr_b16 v[98:99], v20 offset:10240
s_waitcnt lgkmcnt(7)
v_mfma_f32_16x16x32_bf16 v[136:139], v[120:123], a[64:67], v[136:139]
ds_read_b64_tr_b16 v[100:101], v21 offset:2048
v_mul_f32 v180, v180, v244
v_mfma_f32_16x16x32_bf16 v[152:155], v[120:123], a[68:71], v[152:155]
ds_read_b64_tr_b16 v[102:103], v21 offset:10240
v_mul_f32 v181, v181, v245
v_mfma_f32_16x16x32_bf16 v[140:143], v[124:127], a[64:67], v[140:143]
ds_read_b64_tr_b16 v[104:105], v20 offset:18432
v_mul_f32 v182, v182, v246
v_mfma_f32_16x16x32_bf16 v[156:159], v[124:127], a[68:71], v[156:159]
ds_read_b64_tr_b16 v[106:107], v20 offset:26624
v_mul_f32 v183, v183, v247
v_mfma_f32_16x16x32_bf16 v[128:131], v[80:83], a[72:75], v[128:131]
ds_read_b64_tr_b16 v[108:109], v21 offset:18432
v_mul_f32 v240, v61, v184
v_mfma_f32_16x16x32_bf16 v[144:147], v[80:83], a[76:79], v[144:147]
ds_read_b64_tr_b16 v[110:111], v21 offset:26624
s_waitcnt lgkmcnt(7)
v_mfma_f32_16x16x32_bf16 v[132:135], v[84:87], a[72:75], v[132:135]
ds_read_b64_tr_b16 v[112:113], v20 offset:3072
v_mul_f32 v241, v61, v185
v_mfma_f32_16x16x32_bf16 v[148:151], v[84:87], a[76:79], v[148:151]
ds_read_b64_tr_b16 v[114:115], v20 offset:11264
v_mul_f32 v242, v61, v186
v_mfma_f32_16x16x32_bf16 v[136:139], v[88:91], a[72:75], v[136:139]
ds_read_b64_tr_b16 v[116:117], v21 offset:3072
v_mul_f32 v243, v61, v187
v_mfma_f32_16x16x32_bf16 v[152:155], v[88:91], a[76:79], v[152:155]
ds_read_b64_tr_b16 v[118:119], v21 offset:11264
ds_read_b64_tr_b16 v[120:121], v20 offset:19456
v_mfma_f32_16x16x32_bf16 v[140:143], v[92:95], a[72:75], v[140:143]
buffer_load_dwordx4 v31, s[40:43], s77 offen offset:1024 lds
v_mfma_f32_16x16x32_bf16 v[156:159], v[92:95], a[76:79], v[156:159]
ds_read_b64_tr_b16 v[122:123], v20 offset:27648
s_waitcnt lgkmcnt(7)
v_mfma_f32_16x16x32_bf16 v[128:131], v[96:99], a[80:83], v[128:131]
ds_read_b64_tr_b16 v[124:125], v21 offset:19456
ds_read_b64_tr_b16 v[126:127], v21 offset:27648
v_mfma_f32_16x16x32_bf16 v[144:147], v[96:99], a[84:87], v[144:147]
v_exp_f32 v240, v240
v_mfma_f32_16x16x32_bf16 v[132:135], v[100:103], a[80:83], v[132:135]
ds_read_b64_tr_b16 v[80:81], v20 offset:4096
ds_read_b64_tr_b16 v[82:83], v20 offset:12288
v_mfma_f32_16x16x32_bf16 v[148:151], v[100:103], a[84:87], v[148:151]
buffer_load_dwordx4 v32, s[40:43], s77 offen offset:2048 lds
v_mfma_f32_16x16x32_bf16 v[136:139], v[104:107], a[80:83], v[136:139]
ds_read_b64_tr_b16 v[84:85], v21 offset:4096
ds_read_b64_tr_b16 v[86:87], v21 offset:12288
v_mfma_f32_16x16x32_bf16 v[152:155], v[104:107], a[84:87], v[152:155]
ds_read_b64_tr_b16 v[88:89], v20 offset:20480
s_waitcnt lgkmcnt(8)
v_mfma_f32_16x16x32_bf16 v[140:143], v[108:111], a[80:83], v[140:143]
v_exp_f32 v241, v241
v_mfma_f32_16x16x32_bf16 v[156:159], v[108:111], a[84:87], v[156:159]
ds_read_b64_tr_b16 v[90:91], v20 offset:28672
ds_read_b64_tr_b16 v[92:93], v21 offset:20480
v_mfma_f32_16x16x32_bf16 v[128:131], v[112:115], a[88:91], v[128:131]
buffer_load_dwordx4 v33, s[40:43], s77 offen offset:3072 lds
v_mfma_f32_16x16x32_bf16 v[144:147], v[112:115], a[92:95], v[144:147]
ds_read_b64_tr_b16 v[94:95], v21 offset:28672
ds_read_b64_tr_b16 v[96:97], v20 offset:5120
v_mfma_f32_16x16x32_bf16 v[132:135], v[116:119], a[88:91], v[132:135]
v_exp_f32 v242, v242
v_mfma_f32_16x16x32_bf16 v[148:151], v[116:119], a[92:95], v[148:151]
ds_read_b64_tr_b16 v[98:99], v20 offset:13312
s_waitcnt lgkmcnt(6)
v_mfma_f32_16x16x32_bf16 v[136:139], v[120:123], a[88:91], v[136:139]
ds_read_b64_tr_b16 v[100:101], v21 offset:5120
ds_read_b64_tr_b16 v[102:103], v21 offset:13312
v_mfma_f32_16x16x32_bf16 v[152:155], v[120:123], a[92:95], v[152:155]
s_add_u32 m0, s76, 36864
s_add_u32 s77, s84, 0xe0100
v_mfma_f32_16x16x32_bf16 v[140:143], v[124:127], a[88:91], v[140:143]
ds_read_b64_tr_b16 v[104:105], v20 offset:21504
ds_read_b64_tr_b16 v[106:107], v20 offset:29696
v_mfma_f32_16x16x32_bf16 v[156:159], v[124:127], a[92:95], v[156:159]
buffer_load_dwordx4 v30, s[40:43], s77 offen offset:0 lds
v_mfma_f32_16x16x32_bf16 v[128:131], v[80:83], a[96:99], v[128:131]
ds_read_b64_tr_b16 v[108:109], v21 offset:21504
ds_read_b64_tr_b16 v[110:111], v21 offset:29696
v_mfma_f32_16x16x32_bf16 v[144:147], v[80:83], a[100:103], v[144:147]
v_exp_f32 v243, v243
v_mfma_f32_16x16x32_bf16 v[132:135], v[84:87], a[96:99], v[132:135]
ds_read_b64_tr_b16 v[112:113], v20 offset:6144
v_fma_f32 v240, v240, v63, v63
v_mfma_f32_16x16x32_bf16 v[148:151], v[84:87], a[100:103], v[148:151]
ds_read_b64_tr_b16 v[114:115], v20 offset:14336
s_waitcnt lgkmcnt(6)
v_mfma_f32_16x16x32_bf16 v[136:139], v[88:91], a[96:99], v[136:139]
ds_read_b64_tr_b16 v[116:117], v21 offset:6144
v_fma_f32 v241, v241, v63, v63
v_mfma_f32_16x16x32_bf16 v[152:155], v[88:91], a[100:103], v[152:155]
ds_read_b64_tr_b16 v[118:119], v21 offset:14336
v_fma_f32 v242, v242, v63, v63
v_mfma_f32_16x16x32_bf16 v[140:143], v[92:95], a[96:99], v[140:143]
ds_read_b64_tr_b16 v[120:121], v20 offset:22528
v_fma_f32 v243, v243, v63, v63
v_mfma_f32_16x16x32_bf16 v[156:159], v[92:95], a[100:103], v[156:159]
ds_read_b64_tr_b16 v[122:123], v20 offset:30720
ds_read_b64_tr_b16 v[124:125], v21 offset:22528
v_mfma_f32_16x16x32_bf16 v[128:131], v[96:99], a[104:107], v[128:131]
buffer_load_dwordx4 v31, s[40:43], s77 offen offset:1024 lds
v_mfma_f32_16x16x32_bf16 v[144:147], v[96:99], a[108:111], v[144:147]
ds_read_b64_tr_b16 v[126:127], v21 offset:30720
ds_read_b64_tr_b16 v[80:81], v20 offset:7168
v_mfma_f32_16x16x32_bf16 v[132:135], v[100:103], a[104:107], v[132:135]
v_rcp_f32 v240, v240
v_mfma_f32_16x16x32_bf16 v[148:151], v[100:103], a[108:111], v[148:151]
ds_read_b64_tr_b16 v[82:83], v20 offset:15360
s_waitcnt lgkmcnt(7)
v_mfma_f32_16x16x32_bf16 v[136:139], v[104:107], a[104:107], v[136:139]
ds_read_b64_tr_b16 v[84:85], v21 offset:7168
ds_read_b64_tr_b16 v[86:87], v21 offset:15360
v_mfma_f32_16x16x32_bf16 v[152:155], v[104:107], a[108:111], v[152:155]
buffer_load_dwordx4 v32, s[40:43], s77 offen offset:2048 lds
v_mfma_f32_16x16x32_bf16 v[140:143], v[108:111], a[104:107], v[140:143]
ds_read_b64_tr_b16 v[88:89], v20 offset:23552
ds_read_b64_tr_b16 v[90:91], v20 offset:31744
v_mfma_f32_16x16x32_bf16 v[156:159], v[108:111], a[108:111], v[156:159]
v_rcp_f32 v241, v241
v_mfma_f32_16x16x32_bf16 v[128:131], v[112:115], a[112:115], v[128:131]
ds_read_b64_tr_b16 v[92:93], v21 offset:23552
ds_read_b64_tr_b16 v[94:95], v21 offset:31744
v_mfma_f32_16x16x32_bf16 v[144:147], v[112:115], a[116:119], v[144:147]
s_waitcnt lgkmcnt(7)
v_mfma_f32_16x16x32_bf16 v[132:135], v[116:119], a[112:115], v[132:135]
buffer_load_dwordx4 v33, s[40:43], s77 offen offset:3072 lds
v_mfma_f32_16x16x32_bf16 v[148:151], v[116:119], a[116:119], v[148:151]
v_rcp_f32 v242, v242
v_mfma_f32_16x16x32_bf16 v[136:139], v[120:123], a[112:115], v[136:139]
v_rcp_f32 v243, v243
v_mfma_f32_16x16x32_bf16 v[152:155], v[120:123], a[116:119], v[152:155]
s_waitcnt vmcnt(17) lgkmcnt(0)
s_barrier
v_mfma_f32_16x16x32_bf16 v[140:143], v[124:127], a[112:115], v[140:143]
ds_read_b64_tr_b16 v[96:97], v20 offset:32768
ds_read_b64_tr_b16 v[98:99], v20 offset:40960
ds_read_b64_tr_b16 v[100:101], v21 offset:32768
v_mfma_f32_16x16x32_bf16 v[156:159], v[124:127], a[116:119], v[156:159]
ds_read_b64_tr_b16 v[102:103], v21 offset:40960
ds_read_b64_tr_b16 v[104:105], v20 offset:49152
ds_read_b64_tr_b16 v[106:107], v20 offset:57344
v_mfma_f32_16x16x32_bf16 v[128:131], v[80:83], a[120:123], v[128:131]
ds_read_b64_tr_b16 v[108:109], v21 offset:49152
s_add_u32 m0, s76, 65536
s_add_u32 s77, s84, 0x1c0100
v_mfma_f32_16x16x32_bf16 v[144:147], v[80:83], a[124:127], v[144:147]
ds_read_b64_tr_b16 v[110:111], v21 offset:57344
buffer_load_dwordx4 v30, s[40:43], s77 offen offset:0 lds
v_mfma_f32_16x16x32_bf16 v[132:135], v[84:87], a[120:123], v[132:135]
ds_read_b64_tr_b16 v[112:113], v20 offset:33792
v_mul_f32 v184, v184, v240
v_mul_f32 v185, v185, v241
v_mfma_f32_16x16x32_bf16 v[148:151], v[84:87], a[124:127], v[148:151]
ds_read_b64_tr_b16 v[114:115], v20 offset:41984
v_mul_f32 v186, v186, v242
v_mul_f32 v187, v187, v243
v_mfma_f32_16x16x32_bf16 v[136:139], v[88:91], a[120:123], v[136:139]
ds_read_b64_tr_b16 v[116:117], v21 offset:33792
v_mul_f32 v244, v61, v188
v_mul_f32 v245, v61, v189
v_mfma_f32_16x16x32_bf16 v[152:155], v[88:91], a[124:127], v[152:155]
ds_read_b64_tr_b16 v[118:119], v21 offset:41984
v_mul_f32 v246, v61, v190
v_mul_f32 v247, v61, v191
v_mfma_f32_16x16x32_bf16 v[140:143], v[92:95], a[120:123], v[140:143]
ds_read_b64_tr_b16 v[120:121], v20 offset:50176
buffer_load_dwordx4 v31, s[40:43], s77 offen offset:1024 lds
v_mfma_f32_16x16x32_bf16 v[156:159], v[92:95], a[124:127], v[156:159]
ds_read_b64_tr_b16 v[122:123], v20 offset:58368
ds_read_b64_tr_b16 v[124:125], v21 offset:50176
s_waitcnt lgkmcnt(8)
v_mfma_f32_16x16x32_bf16 v[128:131], v[96:99], a[128:131], v[128:131]
v_exp_f32 v244, v244
ds_read_b64_tr_b16 v[126:127], v21 offset:58368
v_mfma_f32_16x16x32_bf16 v[144:147], v[96:99], a[132:135], v[144:147]
v_exp_f32 v245, v245
ds_read_b64_tr_b16 v[80:81], v20 offset:34816
v_mfma_f32_16x16x32_bf16 v[132:135], v[100:103], a[128:131], v[132:135]
v_exp_f32 v246, v246
ds_read_b64_tr_b16 v[82:83], v20 offset:43008
v_mfma_f32_16x16x32_bf16 v[148:151], v[100:103], a[132:135], v[148:151]
buffer_load_dwordx4 v32, s[40:43], s77 offen offset:2048 lds
v_mfma_f32_16x16x32_bf16 v[136:139], v[104:107], a[128:131], v[136:139]
ds_read_b64_tr_b16 v[84:85], v21 offset:34816
ds_read_b64_tr_b16 v[86:87], v21 offset:43008
v_mfma_f32_16x16x32_bf16 v[152:155], v[104:107], a[132:135], v[152:155]
ds_read_b64_tr_b16 v[88:89], v20 offset:51200
s_waitcnt lgkmcnt(8)
v_mfma_f32_16x16x32_bf16 v[140:143], v[108:111], a[128:131], v[140:143]
v_exp_f32 v247, v247
v_mfma_f32_16x16x32_bf16 v[156:159], v[108:111], a[132:135], v[156:159]
ds_read_b64_tr_b16 v[90:91], v20 offset:59392
v_fma_f32 v244, v244, v63, v63
v_mfma_f32_16x16x32_bf16 v[128:131], v[112:115], a[136:139], v[128:131]
ds_read_b64_tr_b16 v[92:93], v21 offset:51200
v_fma_f32 v245, v245, v63, v63
v_mfma_f32_16x16x32_bf16 v[144:147], v[112:115], a[140:143], v[144:147]
ds_read_b64_tr_b16 v[94:95], v21 offset:59392
v_fma_f32 v246, v246, v63, v63
v_mfma_f32_16x16x32_bf16 v[132:135], v[116:119], a[136:139], v[132:135]
ds_read_b64_tr_b16 v[96:97], v20 offset:35840
v_fma_f32 v247, v247, v63, v63
v_mfma_f32_16x16x32_bf16 v[148:151], v[116:119], a[140:143], v[148:151]
ds_read_b64_tr_b16 v[98:99], v20 offset:44032
s_waitcnt lgkmcnt(6)
v_mfma_f32_16x16x32_bf16 v[136:139], v[120:123], a[136:139], v[136:139]
ds_read_b64_tr_b16 v[100:101], v21 offset:35840
ds_read_b64_tr_b16 v[102:103], v21 offset:44032
v_mfma_f32_16x16x32_bf16 v[152:155], v[120:123], a[140:143], v[152:155]
buffer_load_dwordx4 v33, s[40:43], s77 offen offset:3072 lds
v_mfma_f32_16x16x32_bf16 v[140:143], v[124:127], a[136:139], v[140:143]
ds_read_b64_tr_b16 v[104:105], v20 offset:52224
ds_read_b64_tr_b16 v[106:107], v20 offset:60416
v_mfma_f32_16x16x32_bf16 v[156:159], v[124:127], a[140:143], v[156:159]
v_rcp_f32 v244, v244
v_mfma_f32_16x16x32_bf16 v[128:131], v[80:83], a[144:147], v[128:131]
ds_read_b64_tr_b16 v[108:109], v21 offset:52224
ds_read_b64_tr_b16 v[110:111], v21 offset:60416
v_mfma_f32_16x16x32_bf16 v[144:147], v[80:83], a[148:151], v[144:147]
v_rcp_f32 v245, v245
v_mfma_f32_16x16x32_bf16 v[132:135], v[84:87], a[144:147], v[132:135]
ds_read_b64_tr_b16 v[112:113], v20 offset:36864
s_add_u32 m0, s76, 69632
v_mfma_f32_16x16x32_bf16 v[148:151], v[84:87], a[148:151], v[148:151]
ds_read_b64_tr_b16 v[114:115], v20 offset:45056
s_waitcnt lgkmcnt(6)
v_mfma_f32_16x16x32_bf16 v[136:139], v[88:91], a[144:147], v[136:139]
ds_read_b64_tr_b16 v[116:117], v21 offset:36864
s_add_u32 s77, s84, 0x2a0100
v_mfma_f32_16x16x32_bf16 v[152:155], v[88:91], a[148:151], v[152:155]
ds_read_b64_tr_b16 v[118:119], v21 offset:45056
ds_read_b64_tr_b16 v[120:121], v20 offset:53248
v_mfma_f32_16x16x32_bf16 v[140:143], v[92:95], a[144:147], v[140:143]
buffer_load_dwordx4 v30, s[40:43], s77 offen offset:0 lds
v_mfma_f32_16x16x32_bf16 v[156:159], v[92:95], a[148:151], v[156:159]
ds_read_b64_tr_b16 v[122:123], v20 offset:61440
ds_read_b64_tr_b16 v[124:125], v21 offset:53248
v_mfma_f32_16x16x32_bf16 v[128:131], v[96:99], a[152:155], v[128:131]
v_rcp_f32 v246, v246
v_mfma_f32_16x16x32_bf16 v[144:147], v[96:99], a[156:159], v[144:147]
ds_read_b64_tr_b16 v[126:127], v21 offset:61440
ds_read_b64_tr_b16 v[80:81], v20 offset:37888
v_mfma_f32_16x16x32_bf16 v[132:135], v[100:103], a[152:155], v[132:135]
v_rcp_f32 v247, v247
v_mfma_f32_16x16x32_bf16 v[148:151], v[100:103], a[156:159], v[148:151]
ds_read_b64_tr_b16 v[82:83], v20 offset:46080
s_waitcnt lgkmcnt(7)
v_mfma_f32_16x16x32_bf16 v[136:139], v[104:107], a[152:155], v[136:139]
ds_read_b64_tr_b16 v[84:85], v21 offset:37888
v_mul_f32 v188, v188, v244
v_mfma_f32_16x16x32_bf16 v[152:155], v[104:107], a[156:159], v[152:155]
ds_read_b64_tr_b16 v[86:87], v21 offset:46080
v_mul_f32 v189, v189, v245
v_mfma_f32_16x16x32_bf16 v[140:143], v[108:111], a[152:155], v[140:143]
ds_read_b64_tr_b16 v[88:89], v20 offset:54272
v_mul_f32 v190, v190, v246
v_mfma_f32_16x16x32_bf16 v[156:159], v[108:111], a[156:159], v[156:159]
ds_read_b64_tr_b16 v[90:91], v20 offset:62464
v_mul_f32 v191, v191, v247
v_mfma_f32_16x16x32_bf16 v[128:131], v[112:115], a[160:163], v[128:131]
ds_read_b64_tr_b16 v[92:93], v21 offset:54272
ds_read_b64_tr_b16 v[94:95], v21 offset:62464
v_mfma_f32_16x16x32_bf16 v[144:147], v[112:115], a[164:167], v[144:147]
ds_read_b64_tr_b16 v[96:97], v20 offset:38912
s_waitcnt lgkmcnt(8)
v_mfma_f32_16x16x32_bf16 v[132:135], v[116:119], a[160:163], v[132:135]
buffer_load_dwordx4 v31, s[40:43], s77 offen offset:1024 lds
v_mfma_f32_16x16x32_bf16 v[148:151], v[116:119], a[164:167], v[148:151]
ds_read_b64_tr_b16 v[98:99], v20 offset:47104
s_add_u32 s7, s4, 4096
v_mfma_f32_16x16x32_bf16 v[136:139], v[120:123], a[160:163], v[136:139]
ds_read_b64_tr_b16 v[100:101], v21 offset:38912
v_mul_f32 v192, v192, v160
v_mfma_f32_16x16x32_bf16 v[152:155], v[120:123], a[164:167], v[152:155]
ds_read_b64_tr_b16 v[102:103], v21 offset:47104
v_mul_f32 v193, v193, v161
v_mfma_f32_16x16x32_bf16 v[140:143], v[124:127], a[160:163], v[140:143]
ds_read_b64_tr_b16 v[104:105], v20 offset:55296
v_mul_f32 v194, v194, v162
v_mfma_f32_16x16x32_bf16 v[156:159], v[124:127], a[164:167], v[156:159]
ds_read_b64_tr_b16 v[106:107], v20 offset:63488
s_waitcnt lgkmcnt(6)
v_mfma_f32_16x16x32_bf16 v[128:131], v[80:83], a[168:171], v[128:131]
ds_read_b64_tr_b16 v[108:109], v21 offset:55296
v_mul_f32 v195, v195, v163
v_mfma_f32_16x16x32_bf16 v[144:147], v[80:83], a[172:175], v[144:147]
ds_read_b64_tr_b16 v[110:111], v21 offset:63488
v_mul_f32 v196, v196, v164
v_mfma_f32_16x16x32_bf16 v[132:135], v[84:87], a[168:171], v[132:135]
ds_read_b64_tr_b16 v[112:113], v20 offset:39936
v_mul_f32 v197, v197, v165
v_mfma_f32_16x16x32_bf16 v[148:151], v[84:87], a[172:175], v[148:151]
ds_read_b64_tr_b16 v[114:115], v20 offset:48128
v_mul_f32 v198, v198, v166
v_mfma_f32_16x16x32_bf16 v[136:139], v[88:91], a[168:171], v[136:139]
ds_read_b64_tr_b16 v[116:117], v21 offset:39936
v_mul_f32 v199, v199, v167
v_mfma_f32_16x16x32_bf16 v[152:155], v[88:91], a[172:175], v[152:155]
ds_read_b64_tr_b16 v[118:119], v21 offset:48128
v_cvt_pk_bf16_f32 v192, v192, v193
v_mfma_f32_16x16x32_bf16 v[140:143], v[92:95], a[168:171], v[140:143]
ds_read_b64_tr_b16 v[120:121], v20 offset:56320
v_cvt_pk_bf16_f32 v193, v194, v195
v_mfma_f32_16x16x32_bf16 v[156:159], v[92:95], a[172:175], v[156:159]
ds_read_b64_tr_b16 v[122:123], v20 offset:64512
s_waitcnt lgkmcnt(7)
v_mfma_f32_16x16x32_bf16 v[128:131], v[96:99], a[176:179], v[128:131]
ds_read_b64_tr_b16 v[124:125], v21 offset:56320
v_cvt_pk_bf16_f32 v194, v196, v197
v_mfma_f32_16x16x32_bf16 v[144:147], v[96:99], a[180:183], v[144:147]
ds_read_b64_tr_b16 v[126:127], v21 offset:64512
v_cvt_pk_bf16_f32 v195, v198, v199
v_mfma_f32_16x16x32_bf16 v[132:135], v[100:103], a[176:179], v[132:135]
buffer_load_dwordx4 v32, s[40:43], s77 offen offset:2048 lds
v_mfma_f32_16x16x32_bf16 v[148:151], v[100:103], a[180:183], v[148:151]
buffer_load_dwordx4 v33, s[40:43], s77 offen offset:3072 lds
v_mfma_f32_16x16x32_bf16 v[136:139], v[104:107], a[176:179], v[136:139]
buffer_store_dwordx4 v[192:195], v46, s[60:63], s7 offen offset:0 sc1
v_mfma_f32_16x16x32_bf16 v[152:155], v[104:107], a[180:183], v[152:155]
v_mul_f32 v200, v200, v168
s_waitcnt lgkmcnt(3)
v_mfma_f32_16x16x32_bf16 v[140:143], v[108:111], a[176:179], v[140:143]
s_waitcnt vmcnt(17) lgkmcnt(0)
s_barrier
v_mfma_f32_16x16x32_bf16 v[156:159], v[108:111], a[180:183], v[156:159]
ds_read_b64_tr_b16 v[80:81], v18 offset:0
ds_read_b64_tr_b16 v[82:83], v18 offset:8192
ds_read_b64_tr_b16 v[84:85], v19 offset:0
v_mfma_f32_16x16x32_bf16 v[128:131], v[112:115], a[184:187], v[128:131]
ds_read_b64_tr_b16 v[86:87], v19 offset:8192
ds_read_b64_tr_b16 v[88:89], v18 offset:16384
ds_read_b64_tr_b16 v[90:91], v18 offset:24576
v_mfma_f32_16x16x32_bf16 v[144:147], v[112:115], a[188:191], v[144:147]
ds_read_b64_tr_b16 v[92:93], v19 offset:16384
ds_read_b64_tr_b16 v[94:95], v19 offset:24576
s_add_u32 m0, s76, 98304
v_mfma_f32_16x16x32_bf16 v[132:135], v[116:119], a[184:187], v[132:135]
ds_read_b64_tr_b16 v[96:97], v18 offset:1024
s_add_u32 s77, s84, 0x380100
v_mul_f32 v201, v201, v169
v_mfma_f32_16x16x32_bf16 v[148:151], v[116:119], a[188:191], v[148:151]
ds_read_b64_tr_b16 v[98:99], v18 offset:9216
buffer_load_dwordx4 v30, s[40:43], s77 offen offset:0 lds
v_mfma_f32_16x16x32_bf16 v[136:139], v[120:123], a[184:187], v[136:139]
ds_read_b64_tr_b16 v[100:101], v19 offset:1024
v_mul_f32 v202, v202, v170
v_mul_f32 v203, v203, v171
v_mfma_f32_16x16x32_bf16 v[152:155], v[120:123], a[188:191], v[152:155]
ds_read_b64_tr_b16 v[102:103], v19 offset:9216
v_mul_f32 v204, v204, v172
v_mul_f32 v205, v205, v173
v_mfma_f32_16x16x32_bf16 v[140:143], v[124:127], a[184:187], v[140:143]
ds_read_b64_tr_b16 v[104:105], v18 offset:17408
v_mul_f32 v206, v206, v174
v_mul_f32 v207, v207, v175
v_mfma_f32_16x16x32_bf16 v[156:159], v[124:127], a[188:191], v[156:159]
ds_read_b64_tr_b16 v[106:107], v18 offset:25600
v_cvt_pk_bf16_f32 v200, v200, v201
s_waitcnt lgkmcnt(8)
v_mfma_f32_16x16x32_bf16 v[128:131], v[80:83], a[192:195], v[128:131]
ds_read_b64_tr_b16 v[108:109], v19 offset:17408
buffer_load_dwordx4 v31, s[40:43], s77 offen offset:1024 lds
v_mfma_f32_16x16x32_bf16 v[144:147], v[80:83], a[196:199], v[144:147]
ds_read_b64_tr_b16 v[110:111], v19 offset:25600
v_cvt_pk_bf16_f32 v201, v202, v203
v_cvt_pk_bf16_f32 v202, v204, v205
v_mfma_f32_16x16x32_bf16 v[132:135], v[84:87], a[192:195], v[132:135]
ds_read_b64_tr_b16 v[112:113], v18 offset:2048
v_cvt_pk_bf16_f32 v203, v206, v207
ds_read_b64_tr_b16 v[114:115], v18 offset:10240
v_mfma_f32_16x16x32_bf16 v[148:151], v[84:87], a[196:199], v[148:151]
buffer_store_dwordx4 v[200:203], v46, s[60:63], s7 offen offset:2048 sc1
v_mul_f32 v208, v208, v176
v_mfma_f32_16x16x32_bf16 v[136:139], v[88:91], a[192:195], v[136:139]
ds_read_b64_tr_b16 v[116:117], v19 offset:2048
v_mul_f32 v209, v209, v177
v_mfma_f32_16x16x32_bf16 v[152:155], v[88:91], a[196:199], v[152:155]
ds_read_b64_tr_b16 v[118:119], v19 offset:10240
s_waitcnt lgkmcnt(7)
v_mfma_f32_16x16x32_bf16 v[140:143], v[92:95], a[192:195], v[140:143]
ds_read_b64_tr_b16 v[120:121], v18 offset:18432
v_mul_f32 v210, v210, v178
v_mfma_f32_16x16x32_bf16 v[156:159], v[92:95], a[196:199], v[156:159]
ds_read_b64_tr_b16 v[122:123], v18 offset:26624
v_mul_f32 v211, v211, v179
v_mfma_f32_16x16x32_bf16 v[128:131], v[96:99], a[200:203], v[128:131]
ds_read_b64_tr_b16 v[124:125], v19 offset:18432
v_mul_f32 v212, v212, v180
v_mfma_f32_16x16x32_bf16 v[144:147], v[96:99], a[204:207], v[144:147]
ds_read_b64_tr_b16 v[126:127], v19 offset:26624
v_mul_f32 v213, v213, v181
v_mfma_f32_16x16x32_bf16 v[132:135], v[100:103], a[200:203], v[132:135]
ds_read_b64_tr_b16 v[80:81], v18 offset:3072
v_mul_f32 v214, v214, v182
v_mfma_f32_16x16x32_bf16 v[148:151], v[100:103], a[204:207], v[148:151]
ds_read_b64_tr_b16 v[82:83], v18 offset:11264
s_waitcnt lgkmcnt(7)
v_mfma_f32_16x16x32_bf16 v[136:139], v[104:107], a[200:203], v[136:139]
ds_read_b64_tr_b16 v[84:85], v19 offset:3072
v_mul_f32 v215, v215, v183
v_mfma_f32_16x16x32_bf16 v[152:155], v[104:107], a[204:207], v[152:155]
ds_read_b64_tr_b16 v[86:87], v19 offset:11264
v_cvt_pk_bf16_f32 v208, v208, v209
v_mfma_f32_16x16x32_bf16 v[140:143], v[108:111], a[200:203], v[140:143]
ds_read_b64_tr_b16 v[88:89], v18 offset:19456
v_cvt_pk_bf16_f32 v209, v210, v211
v_mfma_f32_16x16x32_bf16 v[156:159], v[108:111], a[204:207], v[156:159]
ds_read_b64_tr_b16 v[90:91], v18 offset:27648
v_cvt_pk_bf16_f32 v210, v212, v213
v_mfma_f32_16x16x32_bf16 v[128:131], v[112:115], a[208:211], v[128:131]
ds_read_b64_tr_b16 v[92:93], v19 offset:19456
v_cvt_pk_bf16_f32 v211, v214, v215
v_mfma_f32_16x16x32_bf16 v[144:147], v[112:115], a[212:215], v[144:147]
ds_read_b64_tr_b16 v[94:95], v19 offset:27648
s_waitcnt lgkmcnt(7)
v_mfma_f32_16x16x32_bf16 v[132:135], v[116:119], a[208:211], v[132:135]
ds_read_b64_tr_b16 v[96:97], v18 offset:4096
ds_read_b64_tr_b16 v[98:99], v18 offset:12288
v_mfma_f32_16x16x32_bf16 v[148:151], v[116:119], a[212:215], v[148:151]
buffer_load_dwordx4 v32, s[40:43], s77 offen offset:2048 lds
v_mfma_f32_16x16x32_bf16 v[136:139], v[120:123], a[208:211], v[136:139]
ds_read_b64_tr_b16 v[100:101], v19 offset:4096
ds_read_b64_tr_b16 v[102:103], v19 offset:12288
v_mfma_f32_16x16x32_bf16 v[152:155], v[120:123], a[212:215], v[152:155]
buffer_store_dwordx4 v[208:211], v46, s[60:63], s7 offen offset:1024 sc1
v_mfma_f32_16x16x32_bf16 v[140:143], v[124:127], a[208:211], v[140:143]
ds_read_b64_tr_b16 v[104:105], v18 offset:20480
v_mul_f32 v216, v216, v184
v_mfma_f32_16x16x32_bf16 v[156:159], v[124:127], a[212:215], v[156:159]
ds_read_b64_tr_b16 v[106:107], v18 offset:28672
s_waitcnt lgkmcnt(7)
v_mfma_f32_16x16x32_bf16 v[128:131], v[80:83], a[216:219], v[128:131]
ds_read_b64_tr_b16 v[108:109], v19 offset:20480
v_mul_f32 v217, v217, v185
v_mfma_f32_16x16x32_bf16 v[144:147], v[80:83], a[220:223], v[144:147]
ds_read_b64_tr_b16 v[110:111], v19 offset:28672
v_mul_f32 v218, v218, v186
v_mfma_f32_16x16x32_bf16 v[132:135], v[84:87], a[216:219], v[132:135]
ds_read_b64_tr_b16 v[112:113], v18 offset:5120
v_mul_f32 v219, v219, v187
v_mfma_f32_16x16x32_bf16 v[148:151], v[84:87], a[220:223], v[148:151]
ds_read_b64_tr_b16 v[114:115], v18 offset:13312
v_mul_f32 v220, v220, v188
v_mfma_f32_16x16x32_bf16 v[136:139], v[88:91], a[216:219], v[136:139]
ds_read_b64_tr_b16 v[116:117], v19 offset:5120
v_mul_f32 v221, v221, v189
v_mfma_f32_16x16x32_bf16 v[152:155], v[88:91], a[220:223], v[152:155]
ds_read_b64_tr_b16 v[118:119], v19 offset:13312
s_waitcnt lgkmcnt(7)
v_mfma_f32_16x16x32_bf16 v[140:143], v[92:95], a[216:219], v[140:143]
ds_read_b64_tr_b16 v[120:121], v18 offset:21504
v_mul_f32 v222, v222, v190
v_mfma_f32_16x16x32_bf16 v[156:159], v[92:95], a[220:223], v[156:159]
ds_read_b64_tr_b16 v[122:123], v18 offset:29696
v_mul_f32 v223, v223, v191
v_mfma_f32_16x16x32_bf16 v[128:131], v[96:99], a[224:227], v[128:131]
ds_read_b64_tr_b16 v[124:125], v19 offset:21504
v_cvt_pk_bf16_f32 v216, v216, v217
v_mfma_f32_16x16x32_bf16 v[144:147], v[96:99], a[228:231], v[144:147]
ds_read_b64_tr_b16 v[126:127], v19 offset:29696
v_cvt_pk_bf16_f32 v217, v218, v219
v_mfma_f32_16x16x32_bf16 v[132:135], v[100:103], a[224:227], v[132:135]
ds_read_b64_tr_b16 v[80:81], v18 offset:6144
v_cvt_pk_bf16_f32 v218, v220, v221
v_mfma_f32_16x16x32_bf16 v[148:151], v[100:103], a[228:231], v[148:151]
ds_read_b64_tr_b16 v[82:83], v18 offset:14336
s_waitcnt lgkmcnt(7)
v_mfma_f32_16x16x32_bf16 v[136:139], v[104:107], a[224:227], v[136:139]
ds_read_b64_tr_b16 v[84:85], v19 offset:6144
v_cvt_pk_bf16_f32 v219, v222, v223
v_mfma_f32_16x16x32_bf16 v[152:155], v[104:107], a[228:231], v[152:155]
ds_read_b64_tr_b16 v[86:87], v19 offset:14336
ds_read_b64_tr_b16 v[88:89], v18 offset:22528
v_mfma_f32_16x16x32_bf16 v[140:143], v[108:111], a[224:227], v[140:143]
buffer_load_dwordx4 v33, s[40:43], s77 offen offset:3072 lds
v_mfma_f32_16x16x32_bf16 v[156:159], v[108:111], a[228:231], v[156:159]
ds_read_b64_tr_b16 v[90:91], v18 offset:30720
ds_read_b64_tr_b16 v[92:93], v19 offset:22528
v_mfma_f32_16x16x32_bf16 v[128:131], v[112:115], a[232:235], v[128:131]
buffer_store_dwordx4 v[216:219], v46, s[60:63], s7 offen offset:3072 sc1
v_mfma_f32_16x16x32_bf16 v[144:147], v[112:115], a[236:239], v[144:147]
ds_read_b64_tr_b16 v[94:95], v19 offset:30720
s_waitcnt lgkmcnt(7)
v_mfma_f32_16x16x32_bf16 v[132:135], v[116:119], a[232:235], v[132:135]
ds_read_b64_tr_b16 v[96:97], v18 offset:7168
ds_read_b64_tr_b16 v[98:99], v18 offset:15360
v_mfma_f32_16x16x32_bf16 v[148:151], v[116:119], a[236:239], v[148:151]
s_add_u32 m0, s76, 102400
s_add_u32 s77, s84, 0x460100
v_mfma_f32_16x16x32_bf16 v[136:139], v[120:123], a[232:235], v[136:139]
ds_read_b64_tr_b16 v[100:101], v19 offset:7168
ds_read_b64_tr_b16 v[102:103], v19 offset:15360
v_mfma_f32_16x16x32_bf16 v[152:155], v[120:123], a[236:239], v[152:155]
buffer_load_dwordx4 v30, s[40:43], s77 offen offset:0 lds
v_mfma_f32_16x16x32_bf16 v[140:143], v[124:127], a[232:235], v[140:143]
ds_read_b64_tr_b16 v[104:105], v18 offset:23552
ds_read_b64_tr_b16 v[106:107], v18 offset:31744
v_mfma_f32_16x16x32_bf16 v[156:159], v[124:127], a[236:239], v[156:159]
ds_read_b64_tr_b16 v[108:109], v19 offset:23552
s_waitcnt lgkmcnt(8)
v_mfma_f32_16x16x32_bf16 v[128:131], v[80:83], a[240:243], v[128:131]
ds_read_b64_tr_b16 v[110:111], v19 offset:31744
v_mfma_f32_16x16x32_bf16 v[144:147], v[80:83], a[244:247], v[144:147]
buffer_load_dwordx4 v31, s[40:43], s77 offen offset:1024 lds
v_mfma_f32_16x16x32_bf16 v[132:135], v[84:87], a[240:243], v[132:135]
buffer_load_dwordx4 v32, s[40:43], s77 offen offset:2048 lds
v_mfma_f32_16x16x32_bf16 v[148:151], v[84:87], a[244:247], v[148:151]
buffer_load_dwordx4 v33, s[40:43], s77 offen offset:3072 lds
v_mfma_f32_16x16x32_bf16 v[136:139], v[88:91], a[240:243], v[136:139]
v_mfma_f32_16x16x32_bf16 v[152:155], v[88:91], a[244:247], v[152:155]
s_waitcnt vmcnt(20) lgkmcnt(0)
s_barrier
v_mfma_f32_16x16x32_bf16 v[140:143], v[92:95], a[240:243], v[140:143]
ds_read_b64_tr_b16 v[112:113], v10 offset:32768
ds_read_b64_tr_b16 v[114:115], v10 offset:49152
v_mfma_f32_16x16x32_bf16 v[156:159], v[92:95], a[244:247], v[156:159]
ds_read_b64_tr_b16 v[116:117], v11 offset:32768
ds_read_b64_tr_b16 v[118:119], v11 offset:49152
v_mfma_f32_16x16x32_bf16 v[128:131], v[96:99], a[248:251], v[128:131]
ds_read_b64_tr_b16 v[120:121], v12 offset:32768
ds_read_b64_tr_b16 v[122:123], v12 offset:49152
v_mfma_f32_16x16x32_bf16 v[144:147], v[96:99], a[252:255], v[144:147]
ds_read_b64_tr_b16 v[124:125], v13 offset:32768
ds_read_b64_tr_b16 v[126:127], v13 offset:49152
v_mfma_f32_16x16x32_bf16 v[132:135], v[100:103], a[248:251], v[132:135]
ds_read_b64_tr_b16 v[80:81], v10 offset:33792
s_add_u32 m0, s76, 0
v_mfma_f32_16x16x32_bf16 v[148:151], v[100:103], a[252:255], v[148:151]
ds_read_b64_tr_b16 v[82:83], v10 offset:50176
s_add_u32 s77, s84, 0x540100
v_mfma_f32_16x16x32_bf16 v[136:139], v[104:107], a[248:251], v[136:139]
ds_read_b64_tr_b16 v[84:85], v11 offset:33792
ds_read_b64_tr_b16 v[86:87], v11 offset:50176
v_mfma_f32_16x16x32_bf16 v[152:155], v[104:107], a[252:255], v[152:155]
buffer_load_dwordx4 v30, s[40:43], s77 offen offset:0 lds
v_mfma_f32_16x16x32_bf16 v[140:143], v[108:111], a[248:251], v[140:143]
ds_read_b64_tr_b16 v[88:89], v12 offset:33792
ds_read_b64_tr_b16 v[90:91], v12 offset:50176
v_mfma_f32_16x16x32_bf16 v[156:159], v[108:111], a[252:255], v[156:159]
ds_read_b64_tr_b16 v[92:93], v13 offset:33792
S_G2:
s_waitcnt lgkmcnt(9)
v_mfma_f32_16x16x32_bf16 v[160:163], v[112:115], a[0:3], 0
ds_read_b64_tr_b16 v[94:95], v13 offset:50176
ds_read_b64_tr_b16 v[96:97], v10 offset:34816
v_mfma_f32_16x16x32_bf16 v[176:179], v[112:115], a[4:7], 0
ds_read_b64_tr_b16 v[98:99], v10 offset:51200
v_mfma_f32_16x16x32_bf16 v[164:167], v[116:119], a[0:3], 0
buffer_load_dwordx4 v31, s[40:43], s77 offen offset:1024 lds
v_mfma_f32_16x16x32_bf16 v[180:183], v[116:119], a[4:7], 0
s_add_u32 s70, s0, S_U2 - K_pc + 0
s_addc_u32 s71, s1, 0
global_load_dword v57, v9, s[70:71]
v_mfma_f32_16x16x32_bf16 v[168:171], v[120:123], a[0:3], 0
ds_read_b64_tr_b16 v[100:101], v11 offset:34816
v_mul_f32 v240, v60, v128
v_mfma_f32_16x16x32_bf16 v[184:187], v[120:123], a[4:7], 0
ds_read_b64_tr_b16 v[102:103], v11 offset:51200
s_waitcnt lgkmcnt(6)
v_mfma_f32_16x16x32_bf16 v[172:175], v[124:127], a[0:3], 0
ds_read_b64_tr_b16 v[104:105], v12 offset:34816
v_mul_f32 v241, v60, v129
v_mfma_f32_16x16x32_bf16 v[188:191], v[124:127], a[4:7], 0
ds_read_b64_tr_b16 v[106:107], v12 offset:51200
v_mul_f32 v242, v60, v130
v_mfma_f32_16x16x32_bf16 v[160:163], v[80:83], a[8:11], v[160:163]
ds_read_b64_tr_b16 v[108:109], v13 offset:34816
v_mul_f32 v243, v60, v131
v_mfma_f32_16x16x32_bf16 v[176:179], v[80:83], a[12:15], v[176:179]
ds_read_b64_tr_b16 v[110:111], v13 offset:51200
ds_read_b64_tr_b16 v[112:113], v10 offset:35840
v_mfma_f32_16x16x32_bf16 v[164:167], v[84:87], a[8:11], v[164:167]
buffer_load_dwordx4 v32, s[40:43], s77 offen offset:2048 lds
v_mfma_f32_16x16x32_bf16 v[180:183], v[84:87], a[12:15], v[180:183]
ds_read_b64_tr_b16 v[114:115], v10 offset:52224
ds_read_b64_tr_b16 v[116:117], v11 offset:35840
v_mfma_f32_16x16x32_bf16 v[168:171], v[88:91], a[8:11], v[168:171]
v_exp_f32 v240, v240
v_mfma_f32_16x16x32_bf16 v[184:187], v[88:91], a[12:15], v[184:187]
ds_read_b64_tr_b16 v[118:119], v11 offset:52224
s_waitcnt lgkmcnt(7)
v_mfma_f32_16x16x32_bf16 v[172:175], v[92:95], a[8:11], v[172:175]
ds_read_b64_tr_b16 v[120:121], v12 offset:35840
ds_read_b64_tr_b16 v[122:123], v12 offset:52224
v_mfma_f32_16x16x32_bf16 v[188:191], v[92:95], a[12:15], v[188:191]
buffer_load_dwordx4 v33, s[40:43], s77 offen offset:3072 lds
v_mfma_f32_16x16x32_bf16 v[160:163], v[96:99], a[16:19], v[160:163]
ds_read_b64_tr_b16 v[124:125], v13 offset:35840
ds_read_b64_tr_b16 v[126:127], v13 offset:52224
v_mfma_f32_16x16x32_bf16 v[176:179], v[96:99], a[20:23], v[176:179]
v_exp_f32 v241, v241
v_mfma_f32_16x16x32_bf16 v[164:167], v[100:103], a[16:19], v[164:167]
ds_read_b64_tr_b16 v[80:81], v10 offset:36864
ds_read_b64_tr_b16 v[82:83], v10 offset:53248
v_mfma_f32_16x16x32_bf16 v[180:183], v[100:103], a[20:23], v[180:183]
ds_read_b64_tr_b16 v[84:85], v11 offset:36864
s_waitcnt lgkmcnt(8)
v_mfma_f32_16x16x32_bf16 v[168:171], v[104:107], a[16:19], v[168:171]
s_add_u32 m0, s76, 4096
s_add_u32 s77, s84, 0x620100
v_mfma_f32_16x16x32_bf16 v[184:187], v[104:107], a[20:23], v[184:187]
ds_read_b64_tr_b16 v[86:87], v11 offset:53248
ds_read_b64_tr_b16 v[88:89], v12 offset:36864
v_mfma_f32_16x16x32_bf16 v[172:175], v[108:111], a[16:19], v[172:175]
buffer_load_dwordx4 v30, s[40:43], s77 offen offset:0 lds
v_mfma_f32_16x16x32_bf16 v[188:191], v[108:111], a[20:23], v[188:191]
ds_read_b64_tr_b16 v[90:91], v12 offset:53248
ds_read_b64_tr_b16 v[92:93], v13 offset:36864
v_mfma_f32_16x16x32_bf16 v[160:163], v[112:115], a[24:27], v[160:163]
v_exp_f32 v242, v242
v_mfma_f32_16x16x32_bf16 v[176:179], v[112:115], a[28:31], v[176:179]
ds_read_b64_tr_b16 v[94:95], v13 offset:53248
s_waitcnt lgkmcnt(6)
v_mfma_f32_16x16x32_bf16 v[164:167], v[116:119], a[24:27], v[164:167]
ds_read_b64_tr_b16 v[96:97], v10 offset:37888
ds_read_b64_tr_b16 v[98:99], v10 offset:54272
v_mfma_f32_16x16x32_bf16 v[180:183], v[116:119], a[28:31], v[180:183]
buffer_load_dwordx4 v31, s[40:43], s77 offen offset:1024 lds
v_mfma_f32_16x16x32_bf16 v[168:171], v[120:123], a[24:27], v[168:171]
ds_read_b64_tr_b16 v[100:101], v11 offset:37888
ds_read_b64_tr_b16 v[102:103], v11 offset:54272
v_mfma_f32_16x16x32_bf16 v[184:187], v[120:123], a[28:31], v[184:187]
v_exp_f32 v243, v243
v_mfma_f32_16x16x32_bf16 v[172:175], v[124:127], a[24:27], v[172:175]
ds_read_b64_tr_b16 v[104:105], v12 offset:37888
v_fma_f32 v240, v240, v62, v62
v_mfma_f32_16x16x32_bf16 v[188:191], v[124:127], a[28:31], v[188:191]
ds_read_b64_tr_b16 v[106:107], v12 offset:54272
v_fma_f32 v241, v241, v62, v62
v_mfma_f32_16x16x32_bf16 v[160:163], v[80:83], a[32:35], v[160:163]
ds_read_b64_tr_b16 v[108:109], v13 offset:37888
v_fma_f32 v242, v242, v62, v62
v_mfma_f32_16x16x32_bf16 v[176:179], v[80:83], a[36:39], v[176:179]
ds_read_b64_tr_b16 v[110:111], v13 offset:54272
s_waitcnt lgkmcnt(6)
v_mfma_f32_16x16x32_bf16 v[164:167], v[84:87], a[32:35], v[164:167]
ds_read_b64_tr_b16 v[112:113], v10 offset:38912
v_fma_f32 v243, v243, v62, v62
v_mfma_f32_16x16x32_bf16 v[180:183], v[84:87], a[36:39], v[180:183]
ds_read_b64_tr_b16 v[114:115], v10 offset:55296
ds_read_b64_tr_b16 v[116:117], v11 offset:38912
v_mfma_f32_16x16x32_bf16 v[168:171], v[88:91], a[32:35], v[168:171]
buffer_load_dwordx4 v32, s[40:43], s77 offen offset:2048 lds
v_mfma_f32_16x16x32_bf16 v[184:187], v[88:91], a[36:39], v[184:187]
ds_read_b64_tr_b16 v[118:119], v11 offset:55296
ds_read_b64_tr_b16 v[120:121], v12 offset:38912
v_mfma_f32_16x16x32_bf16 v[172:175], v[92:95], a[32:35], v[172:175]
v_rcp_f32 v240, v240
v_mfma_f32_16x16x32_bf16 v[188:191], v[92:95], a[36:39], v[188:191]
ds_read_b64_tr_b16 v[122:123], v12 offset:55296
ds_read_b64_tr_b16 v[124:125], v13 offset:38912
v_mfma_f32_16x16x32_bf16 v[160:163], v[96:99], a[40:43], v[160:163]
v_rcp_f32 v241, v241
v_mfma_f32_16x16x32_bf16 v[176:179], v[96:99], a[44:47], v[176:179]
ds_read_b64_tr_b16 v[126:127], v13 offset:55296
s_waitcnt lgkmcnt(7)
v_mfma_f32_16x16x32_bf16 v[164:167], v[100:103], a[40:43], v[164:167]
ds_read_b64_tr_b16 v[80:81], v10 offset:39936
ds_read_b64_tr_b16 v[82:83], v10 offset:56320
v_mfma_f32_16x16x32_bf16 v[180:183], v[100:103], a[44:47], v[180:183]
buffer_load_dwordx4 v33, s[40:43], s77 offen offset:3072 lds
v_mfma_f32_16x16x32_bf16 v[168:171], v[104:107], a[40:43], v[168:171]
ds_read_b64_tr_b16 v[84:85], v11 offset:39936
ds_read_b64_tr_b16 v[86:87], v11 offset:56320
v_mfma_f32_16x16x32_bf16 v[184:187], v[104:107], a[44:47], v[184:187]
v_rcp_f32 v242, v242
v_mfma_f32_16x16x32_bf16 v[172:175], v[108:111], a[40:43], v[172:175]
ds_read_b64_tr_b16 v[88:89], v12 offset:39936
ds_read_b64_tr_b16 v[90:91], v12 offset:56320
v_mfma_f32_16x16x32_bf16 v[188:191], v[108:111], a[44:47], v[188:191]
ds_read_b64_tr_b16 v[92:93], v13 offset:39936
s_waitcnt lgkmcnt(8)
v_mfma_f32_16x16x32_bf16 v[160:163], v[112:115], a[48:51], v[160:163]
v_rcp_f32 v243, v243
v_mfma_f32_16x16x32_bf16 v[176:179], v[112:115], a[52:55], v[176:179]
ds_read_b64_tr_b16 v[94:95], v13 offset:56320
v_mul_f32 v128, v128, v240
v_mfma_f32_16x16x32_bf16 v[164:167], v[116:119], a[48:51], v[164:167]
v_mul_f32 v129, v129, v241
v_mul_f32 v130, v130, v242
v_mfma_f32_16x16x32_bf16 v[180:183], v[116:119], a[52:55], v[180:183]
v_mul_f32 v131, v131, v243
v_mul_f32 v244, v60, v132
v_mfma_f32_16x16x32_bf16 v[168:171], v[120:123], a[48:51], v[168:171]
v_mul_f32 v245, v60, v133
v_mul_f32 v246, v60, v134
v_mfma_f32_16x16x32_bf16 v[184:187], v[120:123], a[52:55], v[184:187]
v_mul_f32 v247, v60, v135
s_waitcnt lgkmcnt(2)
v_mfma_f32_16x16x32_bf16 v[172:175], v[124:127], a[48:51], v[172:175]
s_waitcnt vmcnt(21) lgkmcnt(0)
s_barrier
v_mfma_f32_16x16x32_bf16 v[188:191], v[124:127], a[52:55], v[188:191]
ds_read_b64_tr_b16 v[96:97], v14 offset:0
ds_read_b64_tr_b16 v[98:99], v14 offset:16384
v_mfma_f32_16x16x32_bf16 v[160:163], v[80:83], a[56:59], v[160:163]
ds_read_b64_tr_b16 v[100:101], v15 offset:0
ds_read_b64_tr_b16 v[102:103], v15 offset:16384
v_mfma_f32_16x16x32_bf16 v[176:179], v[80:83], a[60:63], v[176:179]
ds_read_b64_tr_b16 v[104:105], v16 offset:0
ds_read_b64_tr_b16 v[106:107], v16 offset:16384
v_mfma_f32_16x16x32_bf16 v[164:167], v[84:87], a[56:59], v[164:167]
ds_read_b64_tr_b16 v[108:109], v17 offset:0
ds_read_b64_tr_b16 v[110:111], v17 offset:16384
v_mfma_f32_16x16x32_bf16 v[180:183], v[84:87], a[60:63], v[180:183]
ds_read_b64_tr_b16 v[112:113], v14 offset:1024
ds_read_b64_tr_b16 v[114:115], v14 offset:17408
v_mfma_f32_16x16x32_bf16 v[168:171], v[88:91], a[56:59], v[168:171]
ds_read_b64_tr_b16 v[116:117], v15 offset:1024
s_add_u32 m0, s76, 32768
v_mfma_f32_16x16x32_bf16 v[184:187], v[88:91], a[60:63], v[184:187]
ds_read_b64_tr_b16 v[118:119], v15 offset:17408
s_add_u32 s77, s84, 0x100
v_mfma_f32_16x16x32_bf16 v[172:175], v[92:95], a[56:59], v[172:175]
ds_read_b64_tr_b16 v[120:121], v16 offset:1024
ds_read_b64_tr_b16 v[122:123], v16 offset:17408
v_mfma_f32_16x16x32_bf16 v[188:191], v[92:95], a[60:63], v[188:191]
ds_read_b64_tr_b16 v[124:125], v17 offset:1024
s_waitcnt lgkmcnt(11)
v_mfma_f32_16x16x32_bf16 v[160:163], v[96:99], a[64:67], v[160:163]
buffer_load_dwordx4 v30, s[44:47], s77 offen offset:0 lds
v_mfma_f32_16x16x32_bf16 v[176:179], v[96:99], a[68:71], v[176:179]
ds_read_b64_tr_b16 v[126:127], v17 offset:17408
ds_read_b64_tr_b16 v[80:81], v14 offset:2048
v_mfma_f32_16x16x32_bf16 v[164:167], v[100:103], a[64:67], v[164:167]
v_exp_f32 v244, v244
v_mfma_f32_16x16x32_bf16 v[180:183], v[100:103], a[68:71], v[180:183]
ds_read_b64_tr_b16 v[82:83], v14 offset:18432
s_waitcnt lgkmcnt(7)
v_mfma_f32_16x16x32_bf16 v[168:171], v[104:107], a[64:67], v[168:171]
ds_read_b64_tr_b16 v[84:85], v15 offset:2048
ds_read_b64_tr_b16 v[86:87], v15 offset:18432
v_mfma_f32_16x16x32_bf16 v[184:187], v[104:107], a[68:71], v[184:187]
buffer_load_dwordx4 v31, s[44:47], s77 offen offset:1024 lds
v_mfma_f32_16x16x32_bf16 v[172:175], v[108:111], a[64:67], v[172:175]
ds_read_b64_tr_b16 v[88:89], v16 offset:2048
ds_read_b64_tr_b16 v[90:91], v16 offset:18432
v_mfma_f32_16x16x32_bf16 v[188:191], v[108:111], a[68:71], v[188:191]
v_exp_f32 v245, v245
v_mfma_f32_16x16x32_bf16 v[160:163], v[112:115], a[72:75], v[160:163]
ds_read_b64_tr_b16 v[92:93], v17 offset:2048
ds_read_b64_tr_b16 v[94:95], v17 offset:18432
v_mfma_f32_16x16x32_bf16 v[176:179], v[112:115], a[76:79], v[176:179]
ds_read_b64_tr_b16 v[96:97], v14 offset:3072
s_waitcnt lgkmcnt(8)
v_mfma_f32_16x16x32_bf16 v[164:167], v[116:119], a[72:75], v[164:167]
buffer_load_dwordx4 v32, s[44:47], s77 offen offset:2048 lds
v_mfma_f32_16x16x32_bf16 v[180:183], v[116:119], a[76:79], v[180:183]
ds_read_b64_tr_b16 v[98:99], v14 offset:19456
ds_read_b64_tr_b16 v[100:101], v15 offset:3072
v_mfma_f32_16x16x32_bf16 v[168:171], v[120:123], a[72:75], v[168:171]
v_exp_f32 v246, v246
v_mfma_f32_16x16x32_bf16 v[184:187], v[120:123], a[76:79], v[184:187]
ds_read_b64_tr_b16 v[102:103], v15 offset:19456
ds_read_b64_tr_b16 v[104:105], v16 offset:3072
v_mfma_f32_16x16x32_bf16 v[172:175], v[124:127], a[72:75], v[172:175]
v_exp_f32 v247, v247
v_mfma_f32_16x16x32_bf16 v[188:191], v[124:127], a[76:79], v[188:191]
ds_read_b64_tr_b16 v[106:107], v16 offset:19456
s_waitcnt lgkmcnt(6)
v_mfma_f32_16x16x32_bf16 v[160:163], v[80:83], a[80:83], v[160:163]
ds_read_b64_tr_b16 v[108:109], v17 offset:3072
v_fma_f32 v244, v244, v62, v62
v_mfma_f32_16x16x32_bf16 v[176:179], v[80:83], a[84:87], v[176:179]
ds_read_b64_tr_b16 v[110:111], v17 offset:19456
v_fma_f32 v245, v245, v62, v62
v_mfma_f32_16x16x32_bf16 v[164:167], v[84:87], a[80:83], v[164:167]
ds_read_b64_tr_b16 v[112:113], v14 offset:4096
v_fma_f32 v246, v246, v62, v62
v_mfma_f32_16x16x32_bf16 v[180:183], v[84:87], a[84:87], v[180:183]
ds_read_b64_tr_b16 v[114:115], v14 offset:20480
v_fma_f32 v247, v247, v62, v62
v_mfma_f32_16x16x32_bf16 v[168:171], v[88:91], a[80:83], v[168:171]
ds_read_b64_tr_b16 v[116:117], v15 offset:4096
ds_read_b64_tr_b16 v[118:119], v15 offset:20480
v_mfma_f32_16x16x32_bf16 v[184:187], v[88:91], a[84:87], v[184:187]
buffer_load_dwordx4 v33, s[44:47], s77 offen offset:3072 lds
v_mfma_f32_16x16x32_bf16 v[172:175], v[92:95], a[80:83], v[172:175]
ds_read_b64_tr_b16 v[120:121], v16 offset:4096
ds_read_b64_tr_b16 v[122:123], v16 offset:20480
v_mfma_f32_16x16x32_bf16 v[188:191], v[92:95], a[84:87], v[188:191]
ds_read_b64_tr_b16 v[124:125], v17 offset:4096
s_waitcnt lgkmcnt(8)
v_mfma_f32_16x16x32_bf16 v[160:163], v[96:99], a[88:91], v[160:163]
v_rcp_f32 v244, v244
v_mfma_f32_16x16x32_bf16 v[176:179], v[96:99], a[92:95], v[176:179]
ds_read_b64_tr_b16 v[126:127], v17 offset:20480
ds_read_b64_tr_b16 v[80:81], v14 offset:5120
v_mfma_f32_16x16x32_bf16 v[164:167], v[100:103], a[88:91], v[164:167]
s_add_u32 m0, s76, 36864
s_add_u32 s77, s84, 0xe0100
v_mfma_f32_16x16x32_bf16 v[180:183], v[100:103], a[92:95], v[180:183]
ds_read_b64_tr_b16 v[82:83], v14 offset:21504
ds_read_b64_tr_b16 v[84:85], v15 offset:5120
v_mfma_f32_16x16x32_bf16 v[168:171], v[104:107], a[88:91], v[168:171]
buffer_load_dwordx4 v30, s[44:47], s77 offen offset:0 lds
v_mfma_f32_16x16x32_bf16 v[184:187], v[104:107], a[92:95], v[184:187]
ds_read_b64_tr_b16 v[86:87], v15 offset:21504
s_waitcnt lgkmcnt(6)
v_mfma_f32_16x16x32_bf16 v[172:175], v[108:111], a[88:91], v[172:175]
ds_read_b64_tr_b16 v[88:89], v16 offset:5120
ds_read_b64_tr_b16 v[90:91], v16 offset:21504
v_mfma_f32_16x16x32_bf16 v[188:191], v[108:111], a[92:95], v[188:191]
v_rcp_f32 v245, v245
v_mfma_f32_16x16x32_bf16 v[160:163], v[112:115], a[96:99], v[160:163]
ds_read_b64_tr_b16 v[92:93], v17 offset:5120
ds_read_b64_tr_b16 v[94:95], v17 offset:21504
v_mfma_f32_16x16x32_bf16 v[176:179], v[112:115], a[100:103], v[176:179]
buffer_load_dwordx4 v31, s[44:47], s77 offen offset:1024 lds
v_mfma_f32_16x16x32_bf16 v[164:167], v[116:119], a[96:99], v[164:167]
ds_read_b64_tr_b16 v[96:97], v14 offset:6144
ds_read_b64_tr_b16 v[98:99], v14 offset:22528
v_mfma_f32_16x16x32_bf16 v[180:183], v[116:119], a[100:103], v[180:183]
v_rcp_f32 v246, v246
v_mfma_f32_16x16x32_bf16 v[168:171], v[120:123], a[96:99], v[168:171]
ds_read_b64_tr_b16 v[100:101], v15 offset:6144
ds_read_b64_tr_b16 v[102:103], v15 offset:22528
v_mfma_f32_16x16x32_bf16 v[184:187], v[120:123], a[100:103], v[184:187]
ds_read_b64_tr_b16 v[104:105], v16 offset:6144
s_waitcnt lgkmcnt(7)
v_mfma_f32_16x16x32_bf16 v[172:175], v[124:127], a[96:99], v[172:175]
buffer_load_dwordx4 v32, s[44:47], s77 offen offset:2048 lds
v_mfma_f32_16x16x32_bf16 v[188:191], v[124:127], a[100:103], v[188:191]
ds_read_b64_tr_b16 v[106:107], v16 offset:22528
ds_read_b64_tr_b16 v[108:109], v17 offset:6144
v_mfma_f32_16x16x32_bf16 v[160:163], v[80:83], a[104:107], v[160:163]
v_rcp_f32 v247, v247
v_mfma_f32_16x16x32_bf16 v[176:179], v[80:83], a[108:111], v[176:179]
ds_read_b64_tr_b16 v[110:111], v17 offset:22528
v_mul_f32 v132, v132, v244
v_mfma_f32_16x16x32_bf16 v[164:167], v[84:87], a[104:107], v[164:167]
ds_read_b64_tr_b16 v[112:113], v14 offset:7168
v_mul_f32 v133, v133, v245
v_mfma_f32_16x16x32_bf16 v[180:183], v[84:87], a[108:111], v[180:183]
ds_read_b64_tr_b16 v[114:115], v14 offset:23552
v_mul_f32 v134, v134, v246
v_mfma_f32_16x16x32_bf16 v[168:171], v[88:91], a[104:107], v[168:171]
ds_read_b64_tr_b16 v[116:117], v15 offset:7168
v_mul_f32 v135, v135, v247
v_mfma_f32_16x16x32_bf16 v[184:187], v[88:91], a[108:111], v[184:187]
ds_read_b64_tr_b16 v[118:119], v15 offset:23552
s_waitcnt lgkmcnt(7)
v_mfma_f32_16x16x32_bf16 v[172:175], v[92:95], a[104:107], v[172:175]
ds_read_b64_tr_b16 v[120:121], v16 offset:7168
v_mul_f32 v240, v61, v144
v_mfma_f32_16x16x32_bf16 v[188:191], v[92:95], a[108:111], v[188:191]
ds_read_b64_tr_b16 v[122:123], v16 offset:23552
v_mul_f32 v241, v61, v145
v_mfma_f32_16x16x32_bf16 v[160:163], v[96:99], a[112:115], v[160:163]
ds_read_b64_tr_b16 v[124:125], v17 offset:7168
v_mul_f32 v242, v61, v146
v_mfma_f32_16x16x32_bf16 v[176:179], v[96:99], a[116:119], v[176:179]
ds_read_b64_tr_b16 v[126:127], v17 offset:23552
v_mul_f32 v243, v61, v147
v_mfma_f32_16x16x32_bf16 v[164:167], v[100:103], a[112:115], v[164:167]
buffer_load_dwordx4 v33, s[44:47], s77 offen offset:3072 lds
v_mfma_f32_16x16x32_bf16 v[180:183], v[100:103], a[116:119], v[180:183]
s_waitcnt lgkmcnt(5)
v_mfma_f32_16x16x32_bf16 v[168:171], v[104:107], a[112:115], v[168:171]
v_exp_f32 v240, v240
v_mfma_f32_16x16x32_bf16 v[184:187], v[104:107], a[116:119], v[184:187]
v_exp_f32 v241, v241
v_mfma_f32_16x16x32_bf16 v[172:175], v[108:111], a[112:115], v[172:175]
s_waitcnt vmcnt(17) lgkmcnt(0)
s_barrier
v_mfma_f32_16x16x32_bf16 v[188:191], v[108:111], a[116:119], v[188:191]
ds_read_b64_tr_b16 v[80:81], v14 offset:32768
ds_read_b64_tr_b16 v[82:83], v14 offset:49152
ds_read_b64_tr_b16 v[84:85], v15 offset:32768
v_mfma_f32_16x16x32_bf16 v[160:163], v[112:115], a[120:123], v[160:163]
ds_read_b64_tr_b16 v[86:87], v15 offset:49152
ds_read_b64_tr_b16 v[88:89], v16 offset:32768
ds_read_b64_tr_b16 v[90:91], v16 offset:49152
v_mfma_f32_16x16x32_bf16 v[176:179], v[112:115], a[124:127], v[176:179]
ds_read_b64_tr_b16 v[92:93], v17 offset:32768
ds_read_b64_tr_b16 v[94:95], v17 offset:49152
s_add_u32 m0, s76, 65536
v_mfma_f32_16x16x32_bf16 v[164:167], v[116:119], a[120:123], v[164:167]
ds_read_b64_tr_b16 v[96:97], v14 offset:33792
s_add_u32 s77, s84, 0x1c0100
v_mfma_f32_16x16x32_bf16 v[180:183], v[116:119], a[124:127], v[180:183]
ds_read_b64_tr_b16 v[98:99], v14 offset:50176
buffer_load_dwordx4 v30, s[44:47], s77 offen offset:0 lds
v_mfma_f32_16x16x32_bf16 v[168:171], v[120:123], a[120:123], v[168:171]
ds_read_b64_tr_b16 v[100:101], v15 offset:33792
ds_read_b64_tr_b16 v[102:103], v15 offset:50176
v_mfma_f32_16x16x32_bf16 v[184:187], v[120:123], a[124:127], v[184:187]
v_exp_f32 v242, v242
ds_read_b64_tr_b16 v[104:105], v16 offset:33792
v_mfma_f32_16x16x32_bf16 v[172:175], v[124:127], a[120:123], v[172:175]
v_exp_f32 v243, v243
v_mfma_f32_16x16x32_bf16 v[188:191], v[124:127], a[124:127], v[188:191]
ds_read_b64_tr_b16 v[106:107], v16 offset:50176
s_waitcnt lgkmcnt(8)
v_mfma_f32_16x16x32_bf16 v[160:163], v[80:83], a[128:131], v[160:163]
ds_read_b64_tr_b16 v[108:109], v17 offset:33792
v_fma_f32 v240, v240, v63, v63
v_mfma_f32_16x16x32_bf16 v[176:179], v[80:83], a[132:135], v[176:179]
ds_read_b64_tr_b16 v[110:111], v17 offset:50176
v_fma_f32 v241, v241, v63, v63
v_mfma_f32_16x16x32_bf16 v[164:167], v[84:87], a[128:131], v[164:167]
ds_read_b64_tr_b16 v[112:113], v14 offset:34816
v_fma_f32 v242, v242, v63, v63
v_mfma_f32_16x16x32_bf16 v[180:183], v[84:87], a[132:135], v[180:183]
ds_read_b64_tr_b16 v[114:115], v14 offset:51200
v_fma_f32 v243, v243, v63, v63
v_mfma_f32_16x16x32_bf16 v[168:171], v[88:91], a[128:131], v[168:171]
ds_read_b64_tr_b16 v[116:117], v15 offset:34816
ds_read_b64_tr_b16 v[118:119], v15 offset:51200
v_mfma_f32_16x16x32_bf16 v[184:187], v[88:91], a[132:135], v[184:187]
ds_read_b64_tr_b16 v[120:121], v16 offset:34816
s_waitcnt lgkmcnt(8)
v_mfma_f32_16x16x32_bf16 v[172:175], v[92:95], a[128:131], v[172:175]
buffer_load_dwordx4 v31, s[44:47], s77 offen offset:1024 lds
v_mfma_f32_16x16x32_bf16 v[188:191], v[92:95], a[132:135], v[188:191]
ds_read_b64_tr_b16 v[122:123], v16 offset:51200
ds_read_b64_tr_b16 v[124:125], v17 offset:34816
v_mfma_f32_16x16x32_bf16 v[160:163], v[96:99], a[136:139], v[160:163]
v_rcp_f32 v240, v240
v_mfma_f32_16x16x32_bf16 v[176:179], v[96:99], a[140:143], v[176:179]
ds_read_b64_tr_b16 v[126:127], v17 offset:51200
ds_read_b64_tr_b16 v[80:81], v14 offset:35840
v_mfma_f32_16x16x32_bf16 v[164:167], v[100:103], a[136:139], v[164:167]
v_rcp_f32 v241, v241
v_mfma_f32_16x16x32_bf16 v[180:183], v[100:103], a[140:143], v[180:183]
ds_read_b64_tr_b16 v[82:83], v14 offset:52224
s_waitcnt lgkmcnt(6)
v_mfma_f32_16x16x32_bf16 v[168:171], v[104:107], a[136:139], v[168:171]
ds_read_b64_tr_b16 v[84:85], v15 offset:35840
ds_read_b64_tr_b16 v[86:87], v15 offset:52224
v_mfma_f32_16x16x32_bf16 v[184:187], v[104:107], a[140:143], v[184:187]
buffer_load_dwordx4 v32, s[44:47], s77 offen offset:2048 lds
v_mfma_f32_16x16x32_bf16 v[172:175], v[108:111], a[136:139], v[172:175]
ds_read_b64_tr_b16 v[88:89], v16 offset:35840
ds_read_b64_tr_b16 v[90:91], v16 offset:52224
v_mfma_f32_16x16x32_bf16 v[188:191], v[108:111], a[140:143], v[188:191]
v_rcp_f32 v242, v242
v_mfma_f32_16x16x32_bf16 v[160:163], v[112:115], a[144:147], v[160:163]
ds_read_b64_tr_b16 v[92:93], v17 offset:35840
ds_read_b64_tr_b16 v[94:95], v17 offset:52224
v_mfma_f32_16x16x32_bf16 v[176:179], v[112:115], a[148:151], v[176:179]
v_rcp_f32 v243, v243
v_mfma_f32_16x16x32_bf16 v[164:167], v[116:119], a[144:147], v[164:167]
ds_read_b64_tr_b16 v[96:97], v14 offset:36864
v_mul_f32 v144, v144, v240
v_mfma_f32_16x16x32_bf16 v[180:183], v[116:119], a[148:151], v[180:183]
ds_read_b64_tr_b16 v[98:99], v14 offset:53248
s_waitcnt lgkmcnt(6)
v_mfma_f32_16x16x32_bf16 v[168:171], v[120:123], a[144:147], v[168:171]
ds_read_b64_tr_b16 v[100:101], v15 offset:36864
v_mul_f32 v145, v145, v241
v_mfma_f32_16x16x32_bf16 v[184:187], v[120:123], a[148:151], v[184:187]
ds_read_b64_tr_b16 v[102:103], v15 offset:53248
v_mul_f32 v146, v146, v242
v_mfma_f32_16x16x32_bf16 v[172:175], v[124:127], a[144:147], v[172:175]
ds_read_b64_tr_b16 v[104:105], v16 offset:36864
v_mul_f32 v147, v147, v243
v_mfma_f32_16x16x32_bf16 v[188:191], v[124:127], a[148:151], v[188:191]
ds_read_b64_tr_b16 v[106:107], v16 offset:53248
v_mul_f32 v244, v61, v148
v_mfma_f32_16x16x32_bf16 v[160:163], v[80:83], a[152:155], v[160:163]
ds_read_b64_tr_b16 v[108:109], v17 offset:36864
v_mul_f32 v245, v61, v149
v_mfma_f32_16x16x32_bf16 v[176:179], v[80:83], a[156:159], v[176:179]
ds_read_b64_tr_b16 v[110:111], v17 offset:53248
v_mul_f32 v246, v61, v150
v_mfma_f32_16x16x32_bf16 v[164:167], v[84:87], a[152:155], v[164:167]
ds_read_b64_tr_b16 v[112:113], v14 offset:37888
v_mul_f32 v247, v61, v151
v_mfma_f32_16x16x32_bf16 v[180:183], v[84:87], a[156:159], v[180:183]
ds_read_b64_tr_b16 v[114:115], v14 offset:54272
s_waitcnt lgkmcnt(7)
v_mfma_f32_16x16x32_bf16 v[168:171], v[88:91], a[152:155], v[168:171]
ds_read_b64_tr_b16 v[116:117], v15 offset:37888
ds_read_b64_tr_b16 v[118:119], v15 offset:54272
v_mfma_f32_16x16x32_bf16 v[184:187], v[88:91], a[156:159], v[184:187]
buffer_load_dwordx4 v33, s[44:47], s77 offen offset:3072 lds
v_mfma_f32_16x16x32_bf16 v[172:175], v[92:95], a[152:155], v[172:175]
ds_read_b64_tr_b16 v[120:121], v16 offset:37888
ds_read_b64_tr_b16 v[122:123], v16 offset:54272
v_mfma_f32_16x16x32_bf16 v[188:191], v[92:95], a[156:159], v[188:191]
v_exp_f32 v244, v244
v_mfma_f32_16x16x32_bf16 v[160:163], v[96:99], a[160:163], v[160:163]
ds_read_b64_tr_b16 v[124:125], v17 offset:37888
ds_read_b64_tr_b16 v[126:127], v17 offset:54272
v_mfma_f32_16x16x32_bf16 v[176:179], v[96:99], a[164:167], v[176:179]
ds_read_b64_tr_b16 v[80:81], v14 offset:38912
s_waitcnt lgkmcnt(8)
v_mfma_f32_16x16x32_bf16 v[164:167], v[100:103], a[160:163], v[164:167]
s_add_u32 m0, s76, 69632
s_add_u32 s77, s84, 0x2a0100
v_mfma_f32_16x16x32_bf16 v[180:183], v[100:103], a[164:167], v[180:183]
ds_read_b64_tr_b16 v[82:83], v14 offset:55296
ds_read_b64_tr_b16 v[84:85], v15 offset:38912
v_mfma_f32_16x16x32_bf16 v[168:171], v[104:107], a[160:163], v[168:171]
buffer_load_dwordx4 v30, s[44:47], s77 offen offset:0 lds
v_mfma_f32_16x16x32_bf16 v[184:187], v[104:107], a[164:167], v[184:187]
ds_read_b64_tr_b16 v[86:87], v15 offset:55296
ds_read_b64_tr_b16 v[88:89], v16 offset:38912
v_mfma_f32_16x16x32_bf16 v[172:175], v[108:111], a[160:163], v[172:175]
v_exp_f32 v245, v245
v_mfma_f32_16x16x32_bf16 v[188:191], v[108:111], a[164:167], v[188:191]
ds_read_b64_tr_b16 v[90:91], v16 offset:55296
s_waitcnt lgkmcnt(6)
v_mfma_f32_16x16x32_bf16 v[160:163], v[112:115], a[168:171], v[160:163]
ds_read_b64_tr_b16 v[92:93], v17 offset:38912
ds_read_b64_tr_b16 v[94:95], v17 offset:55296
v_mfma_f32_16x16x32_bf16 v[176:179], v[112:115], a[172:175], v[176:179]
buffer_load_dwordx4 v31, s[44:47], s77 offen offset:1024 lds
v_mfma_f32_16x16x32_bf16 v[164:167], v[116:119], a[168:171], v[164:167]
ds_read_b64_tr_b16 v[96:97], v14 offset:39936
ds_read_b64_tr_b16 v[98:99], v14 offset:56320
v_mfma_f32_16x16x32_bf16 v[180:183], v[116:119], a[172:175], v[180:183]
v_exp_f32 v246, v246
v_mfma_f32_16x16x32_bf16 v[168:171], v[120:123], a[168:171], v[168:171]
ds_read_b64_tr_b16 v[100:101], v15 offset:39936
ds_read_b64_tr_b16 v[102:103], v15 offset:56320
v_mfma_f32_16x16x32_bf16 v[184:187], v[120:123], a[172:175], v[184:187]
v_exp_f32 v247, v247
v_mfma_f32_16x16x32_bf16 v[172:175], v[124:127], a[168:171], v[172:175]
ds_read_b64_tr_b16 v[104:105], v16 offset:39936
v_fma_f32 v244, v244, v63, v63
v_mfma_f32_16x16x32_bf16 v[188:191], v[124:127], a[172:175], v[188:191]
ds_read_b64_tr_b16 v[106:107], v16 offset:56320
s_waitcnt lgkmcnt(6)
v_mfma_f32_16x16x32_bf16 v[160:163], v[80:83], a[176:179], v[160:163]
ds_read_b64_tr_b16 v[108:109], v17 offset:39936
v_fma_f32 v245, v245, v63, v63
v_mfma_f32_16x16x32_bf16 v[176:179], v[80:83], a[180:183], v[176:179]
ds_read_b64_tr_b16 v[110:111], v17 offset:56320
v_fma_f32 v246, v246, v63, v63
v_mfma_f32_16x16x32_bf16 v[164:167], v[84:87], a[176:179], v[164:167]
buffer_load_dwordx4 v32, s[44:47], s77 offen offset:2048 lds
v_mfma_f32_16x16x32_bf16 v[180:183], v[84:87], a[180:183], v[180:183]
buffer_load_dwordx4 v33, s[44:47], s77 offen offset:3072 lds
v_mfma_f32_16x16x32_bf16 v[168:171], v[88:91], a[176:179], v[168:171]
v_fma_f32 v247, v247, v63, v63
v_mfma_f32_16x16x32_bf16 v[184:187], v[88:91], a[180:183], v[184:187]
v_rcp_f32 v244, v244
v_mfma_f32_16x16x32_bf16 v[172:175], v[92:95], a[176:179], v[172:175]
s_waitcnt vmcnt(16) lgkmcnt(0)
s_barrier
v_mfma_f32_16x16x32_bf16 v[188:191], v[92:95], a[180:183], v[188:191]
ds_read_b64_tr_b16 v[112:113], v10 offset:0
ds_read_b64_tr_b16 v[114:115], v10 offset:16384
ds_read_b64_tr_b16 v[116:117], v11 offset:0
v_mfma_f32_16x16x32_bf16 v[160:163], v[96:99], a[184:187], v[160:163]
ds_read_b64_tr_b16 v[118:119], v11 offset:16384
ds_read_b64_tr_b16 v[120:121], v12 offset:0
ds_read_b64_tr_b16 v[122:123], v12 offset:16384
v_mfma_f32_16x16x32_bf16 v[176:179], v[96:99], a[188:191], v[176:179]
ds_read_b64_tr_b16 v[124:125], v13 offset:0
ds_read_b64_tr_b16 v[126:127], v13 offset:16384
s_add_u32 m0, s76, 98304
v_mfma_f32_16x16x32_bf16 v[164:167], v[100:103], a[184:187], v[164:167]
ds_read_b64_tr_b16 v[80:81], v10 offset:1024
s_add_u32 s77, s84, 0x380100
v_mfma_f32_16x16x32_bf16 v[180:183], v[100:103], a[188:191], v[180:183]
ds_read_b64_tr_b16 v[82:83], v10 offset:17408
buffer_load_dwordx4 v30, s[44:47], s77 offen offset:0 lds
v_mfma_f32_16x16x32_bf16 v[168:171], v[104:107], a[184:187], v[168:171]
ds_read_b64_tr_b16 v[84:85], v11 offset:1024
v_rcp_f32 v245, v245
v_mfma_f32_16x16x32_bf16 v[184:187], v[104:107], a[188:191], v[184:187]
ds_read_b64_tr_b16 v[86:87], v11 offset:17408
v_rcp_f32 v246, v246
v_mfma_f32_16x16x32_bf16 v[172:175], v[108:111], a[184:187], v[172:175]
ds_read_b64_tr_b16 v[88:89], v12 offset:1024
v_rcp_f32 v247, v247
v_mfma_f32_16x16x32_bf16 v[188:191], v[108:111], a[188:191], v[188:191]
ds_read_b64_tr_b16 v[90:91], v12 offset:17408
v_mul_f32 v148, v148, v244
s_waitcnt lgkmcnt(8)
v_mfma_f32_16x16x32_bf16 v[160:163], v[112:115], a[192:195], v[160:163]
ds_read_b64_tr_b16 v[92:93], v13 offset:1024
buffer_load_dwordx4 v31, s[44:47], s77 offen offset:1024 lds
v_mfma_f32_16x16x32_bf16 v[176:179], v[112:115], a[196:199], v[176:179]
ds_read_b64_tr_b16 v[94:95], v13 offset:17408
v_mul_f32 v149, v149, v245
v_mul_f32 v150, v150, v246
v_mfma_f32_16x16x32_bf16 v[164:167], v[116:119], a[192:195], v[164:167]
ds_read_b64_tr_b16 v[96:97], v10 offset:2048
v_mul_f32 v151, v151, v247
v_mul_f32 v136, v136, v128
v_mfma_f32_16x16x32_bf16 v[180:183], v[116:119], a[196:199], v[180:183]
ds_read_b64_tr_b16 v[98:99], v10 offset:18432
v_mul_f32 v137, v137, v129
v_mul_f32 v138, v138, v130
v_mfma_f32_16x16x32_bf16 v[168:171], v[120:123], a[192:195], v[168:171]
ds_read_b64_tr_b16 v[100:101], v11 offset:2048
v_mul_f32 v139, v139, v131
v_mfma_f32_16x16x32_bf16 v[184:187], v[120:123], a[196:199], v[184:187]
ds_read_b64_tr_b16 v[102:103], v11 offset:18432
s_waitcnt lgkmcnt(7)
v_mfma_f32_16x16x32_bf16 v[172:175], v[124:127], a[192:195], v[172:175]
ds_read_b64_tr_b16 v[104:105], v12 offset:2048
v_mul_f32 v140, v140, v132
v_mfma_f32_16x16x32_bf16 v[188:191], v[124:127], a[196:199], v[188:191]
ds_read_b64_tr_b16 v[106:107], v12 offset:18432
v_mul_f32 v141, v141, v133
v_mfma_f32_16x16x32_bf16 v[160:163], v[80:83], a[200:203], v[160:163]
ds_read_b64_tr_b16 v[108:109], v13 offset:2048
v_mul_f32 v142, v142, v134
v_mfma_f32_16x16x32_bf16 v[176:179], v[80:83], a[204:207], v[176:179]
ds_read_b64_tr_b16 v[110:111], v13 offset:18432
v_mul_f32 v143, v143, v135
v_mfma_f32_16x16x32_bf16 v[164:167], v[84:87], a[200:203], v[164:167]
ds_read_b64_tr_b16 v[112:113], v10 offset:3072
v_cvt_pk_bf16_f32 v136, v136, v137
v_mfma_f32_16x16x32_bf16 v[180:183], v[84:87], a[204:207], v[180:183]
ds_read_b64_tr_b16 v[114:115], v10 offset:19456
s_waitcnt lgkmcnt(7)
v_mfma_f32_16x16x32_bf16 v[168:171], v[88:91], a[200:203], v[168:171]
ds_read_b64_tr_b16 v[116:117], v11 offset:3072
v_cvt_pk_bf16_f32 v137, v138, v139
v_mfma_f32_16x16x32_bf16 v[184:187], v[88:91], a[204:207], v[184:187]
ds_read_b64_tr_b16 v[118:119], v11 offset:19456
v_cvt_pk_bf16_f32 v138, v140, v141
v_mfma_f32_16x16x32_bf16 v[172:175], v[92:95], a[200:203], v[172:175]
ds_read_b64_tr_b16 v[120:121], v12 offset:3072
v_cvt_pk_bf16_f32 v139, v142, v143
v_mfma_f32_16x16x32_bf16 v[188:191], v[92:95], a[204:207], v[188:191]
ds_read_b64_tr_b16 v[122:123], v12 offset:19456
ds_read_b64_tr_b16 v[124:125], v13 offset:3072
v_mfma_f32_16x16x32_bf16 v[160:163], v[96:99], a[208:211], v[160:163]
buffer_load_dwordx4 v32, s[44:47], s77 offen offset:2048 lds
v_mfma_f32_16x16x32_bf16 v[176:179], v[96:99], a[212:215], v[176:179]
ds_read_b64_tr_b16 v[126:127], v13 offset:19456
s_waitcnt lgkmcnt(7)
v_mfma_f32_16x16x32_bf16 v[164:167], v[100:103], a[208:211], v[164:167]
ds_read_b64_tr_b16 v[80:81], v10 offset:4096
ds_read_b64_tr_b16 v[82:83], v10 offset:20480
v_mfma_f32_16x16x32_bf16 v[180:183], v[100:103], a[212:215], v[180:183]
buffer_store_dwordx4 v[136:139], v46, s[60:63], s5 offen offset:0 sc1
v_mfma_f32_16x16x32_bf16 v[168:171], v[104:107], a[208:211], v[168:171]
ds_read_b64_tr_b16 v[84:85], v11 offset:4096
v_mul_f32 v152, v152, v144
v_mfma_f32_16x16x32_bf16 v[184:187], v[104:107], a[212:215], v[184:187]
ds_read_b64_tr_b16 v[86:87], v11 offset:20480
v_mul_f32 v153, v153, v145
v_mfma_f32_16x16x32_bf16 v[172:175], v[108:111], a[208:211], v[172:175]
ds_read_b64_tr_b16 v[88:89], v12 offset:4096
v_mul_f32 v154, v154, v146
v_mfma_f32_16x16x32_bf16 v[188:191], v[108:111], a[212:215], v[188:191]
ds_read_b64_tr_b16 v[90:91], v12 offset:20480
s_waitcnt lgkmcnt(7)
v_mfma_f32_16x16x32_bf16 v[160:163], v[112:115], a[216:219], v[160:163]
ds_read_b64_tr_b16 v[92:93], v13 offset:4096
v_mul_f32 v155, v155, v147
v_mfma_f32_16x16x32_bf16 v[176:179], v[112:115], a[220:223], v[176:179]
ds_read_b64_tr_b16 v[94:95], v13 offset:20480
v_mul_f32 v156, v156, v148
v_mfma_f32_16x16x32_bf16 v[164:167], v[116:119], a[216:219], v[164:167]
ds_read_b64_tr_b16 v[96:97], v10 offset:5120
v_mul_f32 v157, v157, v149
v_mfma_f32_16x16x32_bf16 v[180:183], v[116:119], a[220:223], v[180:183]
ds_read_b64_tr_b16 v[98:99], v10 offset:21504
v_mul_f32 v158, v158, v150
v_mfma_f32_16x16x32_bf16 v[168:171], v[120:123], a[216:219], v[168:171]
ds_read_b64_tr_b16 v[100:101], v11 offset:5120
v_mul_f32 v159, v159, v151
v_mfma_f32_16x16x32_bf16 v[184:187], v[120:123], a[220:223], v[184:187]
ds_read_b64_tr_b16 v[102:103], v11 offset:21504
s_waitcnt lgkmcnt(7)
v_mfma_f32_16x16x32_bf16 v[172:175], v[124:127], a[216:219], v[172:175]
ds_read_b64_tr_b16 v[104:105], v12 offset:5120
v_cvt_pk_bf16_f32 v152, v152, v153
v_mfma_f32_16x16x32_bf16 v[188:191], v[124:127], a[220:223], v[188:191]
ds_read_b64_tr_b16 v[106:107], v12 offset:21504
v_cvt_pk_bf16_f32 v153, v154, v155
v_mfma_f32_16x16x32_bf16 v[160:163], v[80:83], a[224:227], v[160:163]
ds_read_b64_tr_b16 v[108:109], v13 offset:5120
v_cvt_pk_bf16_f32 v154, v156, v157
v_mfma_f32_16x16x32_bf16 v[176:179], v[80:83], a[228:231], v[176:179]
ds_read_b64_tr_b16 v[110:111], v13 offset:21504
v_cvt_pk_bf16_f32 v155, v158, v159
v_mfma_f32_16x16x32_bf16 v[164:167], v[84:87], a[224:227], v[164:167]
ds_read_b64_tr_b16 v[112:113], v10 offset:6144
ds_read_b64_tr_b16 v[114:115], v10 offset:22528
v_mfma_f32_16x16x32_bf16 v[180:183], v[84:87], a[228:231], v[180:183]
ds_read_b64_tr_b16 v[116:117], v11 offset:6144
s_waitcnt lgkmcnt(8)
v_mfma_f32_16x16x32_bf16 v[168:171], v[88:91], a[224:227], v[168:171]
buffer_load_dwordx4 v33, s[44:47], s77 offen offset:3072 lds
v_mfma_f32_16x16x32_bf16 v[184:187], v[88:91], a[228:231], v[184:187]
ds_read_b64_tr_b16 v[118:119], v11 offset:22528
ds_read_b64_tr_b16 v[120:121], v12 offset:6144
v_mfma_f32_16x16x32_bf16 v[172:175], v[92:95], a[224:227], v[172:175]
buffer_store_dwordx4 v[152:155], v46, s[60:63], s5 offen offset:1024 sc1
v_mfma_f32_16x16x32_bf16 v[188:191], v[92:95], a[228:231], v[188:191]
ds_read_b64_tr_b16 v[122:123], v12 offset:22528
ds_read_b64_tr_b16 v[124:125], v13 offset:6144
v_mfma_f32_16x16x32_bf16 v[160:163], v[96:99], a[232:235], v[160:163]
ds_read_b64_tr_b16 v[126:127], v13 offset:22528
v_mfma_f32_16x16x32_bf16 v[176:179], v[96:99], a[236:239], v[176:179]
s_add_u32 m0, s76, 102400
s_waitcnt lgkmcnt(6)
v_mfma_f32_16x16x32_bf16 v[164:167], v[100:103], a[232:235], v[164:167]
ds_read_b64_tr_b16 v[80:81], v10 offset:7168
s_add_u32 s77, s84, 0x460100
v_mfma_f32_16x16x32_bf16 v[180:183], v[100:103], a[236:239], v[180:183]
ds_read_b64_tr_b16 v[82:83], v10 offset:23552
ds_read_b64_tr_b16 v[84:85], v11 offset:7168
v_mfma_f32_16x16x32_bf16 v[168:171], v[104:107], a[232:235], v[168:171]
buffer_load_dwordx4 v30, s[44:47], s77 offen offset:0 lds
v_mfma_f32_16x16x32_bf16 v[184:187], v[104:107], a[236:239], v[184:187]
ds_read_b64_tr_b16 v[86:87], v11 offset:23552
ds_read_b64_tr_b16 v[88:89], v12 offset:7168
v_mfma_f32_16x16x32_bf16 v[172:175], v[108:111], a[232:235], v[172:175]
ds_read_b64_tr_b16 v[90:91], v12 offset:23552
v_mfma_f32_16x16x32_bf16 v[188:191], v[108:111], a[236:239], v[188:191]
ds_read_b64_tr_b16 v[92:93], v13 offset:7168
ds_read_b64_tr_b16 v[94:95], v13 offset:23552
v_mfma_f32_16x16x32_bf16 v[160:163], v[112:115], a[240:243], v[160:163]
buffer_load_dwordx4 v31, s[44:47], s77 offen offset:1024 lds
v_mfma_f32_16x16x32_bf16 v[176:179], v[112:115], a[244:247], v[176:179]
s_waitcnt lgkmcnt(7)
v_mfma_f32_16x16x32_bf16 v[164:167], v[116:119], a[240:243], v[164:167]
buffer_load_dwordx4 v32, s[44:47], s77 offen offset:2048 lds
v_mfma_f32_16x16x32_bf16 v[180:183], v[116:119], a[244:247], v[180:183]
buffer_load_dwordx4 v33, s[44:47], s77 offen offset:3072 lds
v_mfma_f32_16x16x32_bf16 v[168:171], v[120:123], a[240:243], v[168:171]
s_waitcnt vmcnt(18) lgkmcnt(0)
s_barrier
v_mfma_f32_16x16x32_bf16 v[184:187], v[120:123], a[244:247], v[184:187]
ds_read_b64_tr_b16 v[96:97], v10 offset:32768
ds_read_b64_tr_b16 v[98:99], v10 offset:49152
ds_read_b64_tr_b16 v[100:101], v11 offset:32768
ds_read_b64_tr_b16 v[102:103], v11 offset:49152
v_mfma_f32_16x16x32_bf16 v[172:175], v[124:127], a[240:243], v[172:175]
ds_read_b64_tr_b16 v[104:105], v12 offset:32768
s_add_u32 m0, s76, 0
s_add_u32 s77, s84, 0x540100
v_mfma_f32_16x16x32_bf16 v[188:191], v[124:127], a[244:247], v[188:191]
ds_read_b64_tr_b16 v[106:107], v12 offset:49152
buffer_load_dwordx4 v30, s[44:47], s77 offen offset:0 lds
ds_read_b64_tr_b16 v[108:109], v13 offset:32768
v_mfma_f32_16x16x32_bf16 v[160:163], v[80:83], a[248:251], v[160:163]
ds_read_b64_tr_b16 v[110:111], v13 offset:49152
v_mfma_f32_16x16x32_bf16 v[176:179], v[80:83], a[252:255], v[176:179]
ds_read_b64_tr_b16 v[112:113], v10 offset:33792
ds_read_b64_tr_b16 v[114:115], v10 offset:50176
ds_read_b64_tr_b16 v[116:117], v11 offset:33792
ds_read_b64_tr_b16 v[118:119], v11 offset:50176
v_mfma_f32_16x16x32_bf16 v[164:167], v[84:87], a[248:251], v[164:167]
ds_read_b64_tr_b16 v[120:121], v12 offset:33792
v_mfma_f32_16x16x32_bf16 v[180:183], v[84:87], a[252:255], v[180:183]
ds_read_b64_tr_b16 v[122:123], v12 offset:50176
ds_read_b64_tr_b16 v[124:125], v13 offset:33792
ds_read_b64_tr_b16 v[126:127], v13 offset:50176
ds_read_b64_tr_b16 v[80:81], v10 offset:34816
v_mfma_f32_16x16x32_bf16 v[168:171], v[88:91], a[248:251], v[168:171]
buffer_load_dwordx4 v31, s[44:47], s77 offen offset:1024 lds
ds_read_b64_tr_b16 v[82:83], v10 offset:51200
v_mfma_f32_16x16x32_bf16 v[184:187], v[88:91], a[252:255], v[184:187]
ds_read_b64_tr_b16 v[84:85], v11 offset:34816
ds_read_b64_tr_b16 v[86:87], v11 offset:51200
v_mfma_f32_16x16x32_bf16 v[172:175], v[92:95], a[248:251], v[172:175]
ds_read_b64_tr_b16 v[88:89], v12 offset:34816
v_mfma_f32_16x16x32_bf16 v[188:191], v[92:95], a[252:255], v[188:191]
ds_read_b64_tr_b16 v[90:91], v12 offset:51200
s_waitcnt vmcnt(6)
buffer_atomic_add v52, v53, s[60:63], 0 offen sc1
S_U2:
s_waitcnt lgkmcnt(14)
v_mfma_f32_16x16x32_bf16 v[192:195], v[96:99], a[0:3], 0
ds_read_b64_tr_b16 v[92:93], v13 offset:34816
v_mfma_f32_16x16x32_bf16 v[208:211], v[96:99], a[4:7], 0
buffer_load_dwordx4 v32, s[44:47], s77 offen offset:2048 lds
ds_read_b64_tr_b16 v[94:95], v13 offset:51200
v_mfma_f32_16x16x32_bf16 v[196:199], v[100:103], a[0:3], 0
ds_read_b64_tr_b16 v[96:97], v10 offset:35840
v_mfma_f32_16x16x32_bf16 v[212:215], v[100:103], a[4:7], 0
s_add_u32 s70, s0, S_D0 - K_pc + 0
s_addc_u32 s71, s1, 0
global_load_dword v57, v9, s[70:71]
v_mfma_f32_16x16x32_bf16 v[200:203], v[104:107], a[0:3], 0
v_mul_f32 v240, v60, v160
v_mul_f32 v241, v60, v161
v_mul_f32 v242, v60, v162
v_mfma_f32_16x16x32_bf16 v[216:219], v[104:107], a[4:7], 0
v_mul_f32 v243, v60, v163
v_exp_f32 v240, v240
v_mfma_f32_16x16x32_bf16 v[204:207], v[108:111], a[0:3], 0
buffer_load_dwordx4 v33, s[44:47], s77 offen offset:3072 lds
ds_read_b64_tr_b16 v[98:99], v10 offset:52224
v_mfma_f32_16x16x32_bf16 v[220:223], v[108:111], a[4:7], 0
v_exp_f32 v241, v241
s_waitcnt lgkmcnt(3)
v_mfma_f32_16x16x32_bf16 v[192:195], v[112:115], a[8:11], v[192:195]
v_exp_f32 v242, v242
ds_read_b64_tr_b16 v[100:101], v11 offset:35840
v_mfma_f32_16x16x32_bf16 v[208:211], v[112:115], a[12:15], v[208:211]
v_exp_f32 v243, v243
v_fma_f32 v240, v240, v62, v62
v_mfma_f32_16x16x32_bf16 v[196:199], v[116:119], a[8:11], v[196:199]
v_fma_f32 v241, v241, v62, v62
v_fma_f32 v242, v242, v62, v62
v_fma_f32 v243, v243, v62, v62
v_mfma_f32_16x16x32_bf16 v[212:215], v[116:119], a[12:15], v[212:215]
s_add_u32 m0, s76, 4096
s_add_u32 s77, s84, 0x620100
ds_read_b64_tr_b16 v[102:103], v11 offset:52224
v_mfma_f32_16x16x32_bf16 v[200:203], v[120:123], a[8:11], v[200:203]
buffer_load_dwordx4 v30, s[44:47], s77 offen offset:0 lds
ds_read_b64_tr_b16 v[104:105], v12 offset:35840
v_mfma_f32_16x16x32_bf16 v[216:219], v[120:123], a[12:15], v[216:219]
v_rcp_f32 v240, v240
ds_read_b64_tr_b16 v[106:107], v12 offset:52224
v_mfma_f32_16x16x32_bf16 v[204:207], v[124:127], a[8:11], v[204:207]
v_rcp_f32 v241, v241
ds_read_b64_tr_b16 v[108:109], v13 offset:35840
v_mfma_f32_16x16x32_bf16 v[220:223], v[124:127], a[12:15], v[220:223]
v_mov_b32 v51, 0
buffer_atomic_add v51, v53, s[60:63], 0 offen sc0 sc1
v_mfma_f32_16x16x32_bf16 v[192:195], v[80:83], a[16:19], v[192:195]
v_rcp_f32 v242, v242
ds_read_b64_tr_b16 v[110:111], v13 offset:52224
v_mfma_f32_16x16x32_bf16 v[208:211], v[80:83], a[20:23], v[208:211]
buffer_load_dwordx4 v31, s[44:47], s77 offen offset:1024 lds
ds_read_b64_tr_b16 v[112:113], v10 offset:36864
v_mfma_f32_16x16x32_bf16 v[196:199], v[84:87], a[16:19], v[196:199]
v_rcp_f32 v243, v243
v_mul_f32 v160, v160, v240
v_mfma_f32_16x16x32_bf16 v[212:215], v[84:87], a[20:23], v[212:215]
ds_read_b64_tr_b16 v[114:115], v10 offset:53248
v_mul_f32 v161, v161, v241
v_mul_f32 v162, v162, v242
v_mfma_f32_16x16x32_bf16 v[200:203], v[88:91], a[16:19], v[200:203]
ds_read_b64_tr_b16 v[116:117], v11 offset:36864
v_mul_f32 v163, v163, v243
v_mul_f32 v244, v60, v164
v_mfma_f32_16x16x32_bf16 v[216:219], v[88:91], a[20:23], v[216:219]
ds_read_b64_tr_b16 v[118:119], v11 offset:53248
v_mul_f32 v245, v60, v165
s_waitcnt lgkmcnt(5)
v_mfma_f32_16x16x32_bf16 v[204:207], v[92:95], a[16:19], v[204:207]
ds_read_b64_tr_b16 v[120:121], v12 offset:36864
buffer_load_dwordx4 v32, s[44:47], s77 offen offset:2048 lds
v_mfma_f32_16x16x32_bf16 v[220:223], v[92:95], a[20:23], v[220:223]
ds_read_b64_tr_b16 v[122:123], v12 offset:53248
v_mul_f32 v246, v60, v166
v_mul_f32 v247, v60, v167
v_mfma_f32_16x16x32_bf16 v[192:195], v[96:99], a[24:27], v[192:195]
ds_read_b64_tr_b16 v[124:125], v13 offset:36864
v_exp_f32 v244, v244
v_mfma_f32_16x16x32_bf16 v[208:211], v[96:99], a[28:31], v[208:211]
ds_read_b64_tr_b16 v[126:127], v13 offset:53248
v_exp_f32 v245, v245
v_mfma_f32_16x16x32_bf16 v[196:199], v[100:103], a[24:27], v[196:199]
ds_read_b64_tr_b16 v[80:81], v10 offset:37888
v_exp_f32 v246, v246
v_mfma_f32_16x16x32_bf16 v[212:215], v[100:103], a[28:31], v[212:215]
ds_read_b64_tr_b16 v[82:83], v10 offset:54272
buffer_load_dwordx4 v33, s[44:47], s77 offen offset:3072 lds
v_mfma_f32_16x16x32_bf16 v[200:203], v[104:107], a[24:27], v[200:203]
ds_read_b64_tr_b16 v[84:85], v11 offset:37888
v_exp_f32 v247, v247
v_mfma_f32_16x16x32_bf16 v[216:219], v[104:107], a[28:31], v[216:219]
ds_read_b64_tr_b16 v[86:87], v11 offset:54272
v_fma_f32 v244, v244, v62, v62
s_waitcnt lgkmcnt(7)
v_mfma_f32_16x16x32_bf16 v[204:207], v[108:111], a[24:27], v[204:207]
ds_read_b64_tr_b16 v[88:89], v12 offset:37888
v_fma_f32 v245, v245, v62, v62
v_fma_f32 v246, v246, v62, v62
v_mfma_f32_16x16x32_bf16 v[220:223], v[108:111], a[28:31], v[220:223]
ds_read_b64_tr_b16 v[90:91], v12 offset:54272
v_fma_f32 v247, v247, v62, v62
ds_read_b64_tr_b16 v[92:93], v13 offset:37888
v_mfma_f32_16x16x32_bf16 v[192:195], v[112:115], a[32:35], v[192:195]
v_rcp_f32 v244, v244
ds_read_b64_tr_b16 v[94:95], v13 offset:54272
v_mfma_f32_16x16x32_bf16 v[208:211], v[112:115], a[36:39], v[208:211]
v_rcp_f32 v245, v245
ds_read_b64_tr_b16 v[96:97], v10 offset:38912
v_mfma_f32_16x16x32_bf16 v[196:199], v[116:119], a[32:35], v[196:199]
v_rcp_f32 v246, v246
ds_read_b64_tr_b16 v[98:99], v10 offset:55296
v_mfma_f32_16x16x32_bf16 v[212:215], v[116:119], a[36:39], v[212:215]
v_rcp_f32 v247, v247
s_waitcnt lgkmcnt(7)
v_mfma_f32_16x16x32_bf16 v[200:203], v[120:123], a[32:35], v[200:203]
ds_read_b64_tr_b16 v[100:101], v11 offset:38912
v_mul_f32 v164, v164, v244
v_mul_f32 v165, v165, v245
v_mfma_f32_16x16x32_bf16 v[216:219], v[120:123], a[36:39], v[216:219]
ds_read_b64_tr_b16 v[102:103], v11 offset:55296
v_mul_f32 v166, v166, v246
v_mul_f32 v167, v167, v247
v_mfma_f32_16x16x32_bf16 v[204:207], v[124:127], a[32:35], v[204:207]
ds_read_b64_tr_b16 v[104:105], v12 offset:38912
v_mul_f32 v240, v60, v168
v_mul_f32 v241, v60, v169
v_mfma_f32_16x16x32_bf16 v[220:223], v[124:127], a[36:39], v[220:223]
ds_read_b64_tr_b16 v[106:107], v12 offset:55296
v_mul_f32 v242, v60, v170
v_mul_f32 v243, v60, v171
v_mfma_f32_16x16x32_bf16 v[192:195], v[80:83], a[40:43], v[192:195]
ds_read_b64_tr_b16 v[108:109], v13 offset:38912
v_exp_f32 v240, v240
v_mfma_f32_16x16x32_bf16 v[208:211], v[80:83], a[44:47], v[208:211]
ds_read_b64_tr_b16 v[110:111], v13 offset:55296
ds_read_b64_tr_b16 v[112:113], v10 offset:39936
s_waitcnt lgkmcnt(7)
v_mfma_f32_16x16x32_bf16 v[196:199], v[84:87], a[40:43], v[196:199]
v_exp_f32 v241, v241
ds_read_b64_tr_b16 v[114:115], v10 offset:56320
v_mfma_f32_16x16x32_bf16 v[212:215], v[84:87], a[44:47], v[212:215]
v_exp_f32 v242, v242
ds_read_b64_tr_b16 v[116:117], v11 offset:39936
v_mfma_f32_16x16x32_bf16 v[200:203], v[88:91], a[40:43], v[200:203]
v_exp_f32 v243, v243
v_fma_f32 v240, v240, v62, v62
v_mfma_f32_16x16x32_bf16 v[216:219], v[88:91], a[44:47], v[216:219]
ds_read_b64_tr_b16 v[118:119], v11 offset:56320
v_fma_f32 v241, v241, v62, v62
v_fma_f32 v242, v242, v62, v62
v_mfma_f32_16x16x32_bf16 v[204:207], v[92:95], a[40:43], v[204:207]
ds_read_b64_tr_b16 v[120:121], v12 offset:39936
v_fma_f32 v243, v243, v62, v62
ds_read_b64_tr_b16 v[122:123], v12 offset:56320
v_mfma_f32_16x16x32_bf16 v[220:223], v[92:95], a[44:47], v[220:223]
v_rcp_f32 v240, v240
ds_read_b64_tr_b16 v[124:125], v13 offset:39936
v_mfma_f32_16x16x32_bf16 v[192:195], v[96:99], a[48:51], v[192:195]
v_rcp_f32 v241, v241
ds_read_b64_tr_b16 v[126:127], v13 offset:56320
v_mfma_f32_16x16x32_bf16 v[208:211], v[96:99], a[52:55], v[208:211]
s_waitcnt lgkmcnt(6)
v_mfma_f32_16x16x32_bf16 v[196:199], v[100:103], a[48:51], v[196:199]
v_rcp_f32 v242, v242
v_mfma_f32_16x16x32_bf16 v[212:215], v[100:103], a[52:55], v[212:215]
v_rcp_f32 v243, v243
v_mfma_f32_16x16x32_bf16 v[200:203], v[104:107], a[48:51], v[200:203]
v_mul_f32 v168, v168, v240
v_mul_f32 v169, v169, v241
v_mfma_f32_16x16x32_bf16 v[216:219], v[104:107], a[52:55], v[216:219]
s_waitcnt lgkmcnt(0)
s_barrier
v_mfma_f32_16x16x32_bf16 v[204:207], v[108:111], a[48:51], v[204:207]
ds_read_b64_tr_b16 v[80:81], v14 offset:0
ds_read_b64_tr_b16 v[82:83], v14 offset:16384
ds_read_b64_tr_b16 v[84:85], v15 offset:0
v_mfma_f32_16x16x32_bf16 v[220:223], v[108:111], a[52:55], v[220:223]
ds_read_b64_tr_b16 v[86:87], v15 offset:16384
ds_read_b64_tr_b16 v[88:89], v16 offset:0
ds_read_b64_tr_b16 v[90:91], v16 offset:16384
v_mfma_f32_16x16x32_bf16 v[192:195], v[112:115], a[56:59], v[192:195]
ds_read_b64_tr_b16 v[92:93], v17 offset:0
s_add_u32 m0, s76, 32768
s_add_u32 s77, s97, 0x0
v_mfma_f32_16x16x32_bf16 v[208:211], v[112:115], a[60:63], v[208:211]
ds_read_b64_tr_b16 v[94:95], v17 offset:16384
buffer_load_dwordx4 v38, s[48:51], s77 offen offset:0 lds
v_mfma_f32_16x16x32_bf16 v[196:199], v[116:119], a[56:59], v[196:199]
ds_read_b64_tr_b16 v[96:97], v14 offset:1024
s_waitcnt vmcnt(4)
v_cmp_lt_u32 vcc, v51, v50
s_cbranch_vccnz pl_7_slow
pl_7_ok:
v_mfma_f32_16x16x32_bf16 v[212:215], v[116:119], a[60:63], v[212:215]
ds_read_b64_tr_b16 v[98:99], v14 offset:17408
s_add_u32 s91, s6, 0
v_mul_f32 v170, v170, v242
v_mfma_f32_16x16x32_bf16 v[200:203], v[120:123], a[56:59], v[200:203]
ds_read_b64_tr_b16 v[100:101], v15 offset:1024
buffer_load_dwordx4 a[0:3], v46, s[60:63], s91 offen offset:0 sc1
v_mfma_f32_16x16x32_bf16 v[216:219], v[120:123], a[60:63], v[216:219]
ds_read_b64_tr_b16 v[102:103], v15 offset:17408
buffer_load_dwordx4 a[4:7], v46, s[60:63], s91 offen offset:1024 sc1
v_mfma_f32_16x16x32_bf16 v[204:207], v[124:127], a[56:59], v[204:207]
ds_read_b64_tr_b16 v[104:105], v16 offset:1024
buffer_load_dwordx4 v39, s[48:51], s77 offen offset:1024 lds
v_mfma_f32_16x16x32_bf16 v[220:223], v[124:127], a[60:63], v[220:223]
ds_read_b64_tr_b16 v[106:107], v16 offset:17408
s_add_u32 s91, s6, 16384
s_waitcnt lgkmcnt(7)
v_mfma_f32_16x16x32_bf16 v[192:195], v[80:83], a[64:67], v[192:195]
ds_read_b64_tr_b16 v[108:109], v17 offset:1024
buffer_load_dwordx4 a[8:11], v46, s[60:63], s91 offen offset:0 sc1
v_mfma_f32_16x16x32_bf16 v[208:211], v[80:83], a[68:71], v[208:211]
ds_read_b64_tr_b16 v[110:111], v17 offset:17408
buffer_load_dwordx4 a[12:15], v46, s[60:63], s91 offen offset:1024 sc1
v_mfma_f32_16x16x32_bf16 v[196:199], v[84:87], a[64:67], v[196:199]
ds_read_b64_tr_b16 v[112:113], v14 offset:2048
s_add_u32 s91, s6, 28672
v_mul_f32 v171, v171, v243
v_mfma_f32_16x16x32_bf16 v[212:215], v[84:87], a[68:71], v[212:215]
ds_read_b64_tr_b16 v[114:115], v14 offset:18432
buffer_load_dwordx4 v40, s[48:51], s77 offen offset:2048 lds
v_mfma_f32_16x16x32_bf16 v[200:203], v[88:91], a[64:67], v[200:203]
ds_read_b64_tr_b16 v[116:117], v15 offset:2048
buffer_load_dwordx4 a[16:19], v46, s[60:63], s91 offen offset:0 sc1
v_mfma_f32_16x16x32_bf16 v[216:219], v[88:91], a[68:71], v[216:219]
ds_read_b64_tr_b16 v[118:119], v15 offset:18432
v_mul_f32 v244, v60, v172
s_waitcnt lgkmcnt(7)
v_mfma_f32_16x16x32_bf16 v[204:207], v[92:95], a[64:67], v[204:207]
ds_read_b64_tr_b16 v[120:121], v16 offset:2048
buffer_load_dwordx4 a[20:23], v46, s[60:63], s91 offen offset:1024 sc1
v_mfma_f32_16x16x32_bf16 v[220:223], v[92:95], a[68:71], v[220:223]
ds_read_b64_tr_b16 v[122:123], v16 offset:18432
s_add_u32 s91, s6, 45056
v_mul_f32 v245, v60, v173
v_mfma_f32_16x16x32_bf16 v[192:195], v[96:99], a[72:75], v[192:195]
ds_read_b64_tr_b16 v[124:125], v17 offset:2048
buffer_load_dwordx4 v41, s[48:51], s77 offen offset:3072 lds
v_mfma_f32_16x16x32_bf16 v[208:211], v[96:99], a[76:79], v[208:211]
ds_read_b64_tr_b16 v[126:127], v17 offset:18432
buffer_load_dwordx4 a[24:27], v46, s[60:63], s91 offen offset:0 sc1
v_mfma_f32_16x16x32_bf16 v[196:199], v[100:103], a[72:75], v[196:199]
ds_read_b64_tr_b16 v[80:81], v14 offset:3072
buffer_load_dwordx4 a[28:31], v46, s[60:63], s91 offen offset:1024 sc1
v_mfma_f32_16x16x32_bf16 v[212:215], v[100:103], a[76:79], v[212:215]
ds_read_b64_tr_b16 v[82:83], v14 offset:19456
s_add_u32 s91, s6, 2048
s_waitcnt lgkmcnt(7)
v_mfma_f32_16x16x32_bf16 v[200:203], v[104:107], a[72:75], v[200:203]
ds_read_b64_tr_b16 v[84:85], v15 offset:3072
buffer_load_dwordx4 a[32:35], v46, s[60:63], s91 offen offset:0 sc1
v_mfma_f32_16x16x32_bf16 v[216:219], v[104:107], a[76:79], v[216:219]
ds_read_b64_tr_b16 v[86:87], v15 offset:19456
s_add_u32 m0, s76, 36864
s_add_u32 s77, s97, 0x10000
v_mfma_f32_16x16x32_bf16 v[204:207], v[108:111], a[72:75], v[204:207]
ds_read_b64_tr_b16 v[88:89], v16 offset:3072
buffer_load_dwordx4 v38, s[48:51], s77 offen offset:0 lds
v_mfma_f32_16x16x32_bf16 v[220:223], v[108:111], a[76:79], v[220:223]
ds_read_b64_tr_b16 v[90:91], v16 offset:19456
buffer_load_dwordx4 a[36:39], v46, s[60:63], s91 offen offset:1024 sc1
v_mfma_f32_16x16x32_bf16 v[192:195], v[112:115], a[80:83], v[192:195]
ds_read_b64_tr_b16 v[92:93], v17 offset:3072
s_add_u32 s91, s6, 18432
v_mul_f32 v246, v60, v174
v_mfma_f32_16x16x32_bf16 v[208:211], v[112:115], a[84:87], v[208:211]
ds_read_b64_tr_b16 v[94:95], v17 offset:19456
v_mul_f32 v247, v60, v175
s_waitcnt lgkmcnt(7)
v_mfma_f32_16x16x32_bf16 v[196:199], v[116:119], a[80:83], v[196:199]
ds_read_b64_tr_b16 v[96:97], v14 offset:4096
buffer_load_dwordx4 a[40:43], v46, s[60:63], s91 offen offset:0 sc1
v_mfma_f32_16x16x32_bf16 v[212:215], v[116:119], a[84:87], v[212:215]
ds_read_b64_tr_b16 v[98:99], v14 offset:20480
buffer_load_dwordx4 v39, s[48:51], s77 offen offset:1024 lds
v_mfma_f32_16x16x32_bf16 v[200:203], v[120:123], a[80:83], v[200:203]
ds_read_b64_tr_b16 v[100:101], v15 offset:4096
buffer_load_dwordx4 a[44:47], v46, s[60:63], s91 offen offset:1024 sc1
v_mfma_f32_16x16x32_bf16 v[216:219], v[120:123], a[84:87], v[216:219]
ds_read_b64_tr_b16 v[102:103], v15 offset:20480
s_add_u32 s91, s6, 30720
ds_read_b64_tr_b16 v[104:105], v16 offset:4096
v_mfma_f32_16x16x32_bf16 v[204:207], v[124:127], a[80:83], v[204:207]
buffer_load_dwordx4 a[48:51], v46, s[60:63], s91 offen offset:0 sc1
ds_read_b64_tr_b16 v[106:107], v16 offset:20480
v_mfma_f32_16x16x32_bf16 v[220:223], v[124:127], a[84:87], v[220:223]
buffer_load_dwordx4 a[52:55], v46, s[60:63], s91 offen offset:1024 sc1
s_waitcnt lgkmcnt(7)
v_mfma_f32_16x16x32_bf16 v[192:195], v[80:83], a[88:91], v[192:195]
ds_read_b64_tr_b16 v[108:109], v17 offset:4096
buffer_load_dwordx4 v40, s[48:51], s77 offen offset:2048 lds
v_mfma_f32_16x16x32_bf16 v[208:211], v[80:83], a[92:95], v[208:211]
ds_read_b64_tr_b16 v[110:111], v17 offset:20480
s_add_u32 s91, s6, 47104
ds_read_b64_tr_b16 v[112:113], v14 offset:5120
v_mfma_f32_16x16x32_bf16 v[196:199], v[84:87], a[88:91], v[196:199]
buffer_load_dwordx4 a[56:59], v46, s[60:63], s91 offen offset:0 sc1
ds_read_b64_tr_b16 v[114:115], v14 offset:21504
v_mfma_f32_16x16x32_bf16 v[212:215], v[84:87], a[92:95], v[212:215]
buffer_load_dwordx4 a[60:63], v46, s[60:63], s91 offen offset:1024 sc1
s_add_u32 s91, s6, 4096
v_mfma_f32_16x16x32_bf16 v[200:203], v[88:91], a[88:91], v[200:203]
ds_read_b64_tr_b16 v[116:117], v15 offset:5120
buffer_load_dwordx4 a[64:67], v46, s[60:63], s91 offen offset:0 sc1
v_mfma_f32_16x16x32_bf16 v[216:219], v[88:91], a[92:95], v[216:219]
ds_read_b64_tr_b16 v[118:119], v15 offset:21504
ds_read_b64_tr_b16 v[120:121], v16 offset:5120
s_waitcnt lgkmcnt(7)
v_mfma_f32_16x16x32_bf16 v[204:207], v[92:95], a[88:91], v[204:207]
buffer_load_dwordx4 v41, s[48:51], s77 offen offset:3072 lds
ds_read_b64_tr_b16 v[122:123], v16 offset:21504
v_mfma_f32_16x16x32_bf16 v[220:223], v[92:95], a[92:95], v[220:223]
buffer_load_dwordx4 a[68:71], v46, s[60:63], s91 offen offset:1024 sc1
s_add_u32 s91, s6, 20480
v_mfma_f32_16x16x32_bf16 v[192:195], v[96:99], a[96:99], v[192:195]
ds_read_b64_tr_b16 v[124:125], v17 offset:5120
buffer_load_dwordx4 a[72:75], v46, s[60:63], s91 offen offset:0 sc1
v_mfma_f32_16x16x32_bf16 v[208:211], v[96:99], a[100:103], v[208:211]
ds_read_b64_tr_b16 v[126:127], v17 offset:21504
buffer_load_dwordx4 a[76:79], v46, s[60:63], s91 offen offset:1024 sc1
v_mfma_f32_16x16x32_bf16 v[196:199], v[100:103], a[96:99], v[196:199]
ds_read_b64_tr_b16 v[80:81], v14 offset:6144
s_add_u32 s91, s6, 32768
ds_read_b64_tr_b16 v[82:83], v14 offset:22528
v_mfma_f32_16x16x32_bf16 v[212:215], v[100:103], a[100:103], v[212:215]
buffer_load_dwordx4 a[80:83], v46, s[60:63], s91 offen offset:0 sc1
ds_read_b64_tr_b16 v[84:85], v15 offset:6144
v_mfma_f32_16x16x32_bf16 v[200:203], v[104:107], a[96:99], v[200:203]
buffer_load_dwordx4 a[84:87], v46, s[60:63], s91 offen offset:1024 sc1
s_add_u32 s91, s6, 49152
v_mfma_f32_16x16x32_bf16 v[216:219], v[104:107], a[100:103], v[216:219]
ds_read_b64_tr_b16 v[86:87], v15 offset:22528
ds_read_b64_tr_b16 v[88:89], v16 offset:6144
s_waitcnt lgkmcnt(7)
v_mfma_f32_16x16x32_bf16 v[204:207], v[108:111], a[96:99], v[204:207]
buffer_load_dwordx4 a[88:91], v46, s[60:63], s91 offen offset:0 sc1
ds_read_b64_tr_b16 v[90:91], v16 offset:22528
v_mfma_f32_16x16x32_bf16 v[220:223], v[108:111], a[100:103], v[220:223]
buffer_load_dwordx4 a[92:95], v46, s[60:63], s91 offen offset:1024 sc1
s_add_u32 s91, s6, 6144
v_mfma_f32_16x16x32_bf16 v[192:195], v[112:115], a[104:107], v[192:195]
ds_read_b64_tr_b16 v[92:93], v17 offset:6144
buffer_load_dwordx4 a[96:99], v46, s[60:63], s91 offen offset:0 sc1
v_mfma_f32_16x16x32_bf16 v[208:211], v[112:115], a[108:111], v[208:211]
ds_read_b64_tr_b16 v[94:95], v17 offset:22528
buffer_load_dwordx4 a[100:103], v46, s[60:63], s91 offen offset:1024 sc1
v_mfma_f32_16x16x32_bf16 v[196:199], v[116:119], a[104:107], v[196:199]
ds_read_b64_tr_b16 v[96:97], v14 offset:7168
v_exp_f32 v244, v244
v_mfma_f32_16x16x32_bf16 v[212:215], v[116:119], a[108:111], v[212:215]
ds_read_b64_tr_b16 v[98:99], v14 offset:23552
v_exp_f32 v245, v245
v_mfma_f32_16x16x32_bf16 v[200:203], v[120:123], a[104:107], v[200:203]
ds_read_b64_tr_b16 v[100:101], v15 offset:7168
v_exp_f32 v246, v246
v_mfma_f32_16x16x32_bf16 v[216:219], v[120:123], a[108:111], v[216:219]
ds_read_b64_tr_b16 v[102:103], v15 offset:23552
ds_read_b64_tr_b16 v[104:105], v16 offset:7168
s_waitcnt lgkmcnt(7)
v_mfma_f32_16x16x32_bf16 v[204:207], v[124:127], a[104:107], v[204:207]
v_exp_f32 v247, v247
v_fma_f32 v244, v244, v62, v62
v_mfma_f32_16x16x32_bf16 v[220:223], v[124:127], a[108:111], v[220:223]
ds_read_b64_tr_b16 v[106:107], v16 offset:23552
s_add_u32 s91, s6, 22528
v_fma_f32 v245, v245, v62, v62
v_mfma_f32_16x16x32_bf16 v[192:195], v[80:83], a[112:115], v[192:195]
ds_read_b64_tr_b16 v[108:109], v17 offset:7168
buffer_load_dwordx4 a[104:107], v46, s[60:63], s91 offen offset:0 sc1
v_mfma_f32_16x16x32_bf16 v[208:211], v[80:83], a[116:119], v[208:211]
ds_read_b64_tr_b16 v[110:111], v17 offset:23552
buffer_load_dwordx4 a[108:111], v46, s[60:63], s91 offen offset:1024 sc1
v_mfma_f32_16x16x32_bf16 v[196:199], v[84:87], a[112:115], v[196:199]
v_fma_f32 v246, v246, v62, v62
v_fma_f32 v247, v247, v62, v62
v_mfma_f32_16x16x32_bf16 v[212:215], v[84:87], a[116:119], v[212:215]
v_rcp_f32 v244, v244
v_mfma_f32_16x16x32_bf16 v[200:203], v[88:91], a[112:115], v[200:203]
v_rcp_f32 v245, v245
v_mfma_f32_16x16x32_bf16 v[216:219], v[88:91], a[116:119], v[216:219]
v_rcp_f32 v246, v246
s_waitcnt lgkmcnt(3)
v_mfma_f32_16x16x32_bf16 v[204:207], v[92:95], a[112:115], v[204:207]
s_waitcnt lgkmcnt(0)
s_barrier
ds_read_b64_tr_b16 v[112:113], v14 offset:32768
v_mfma_f32_16x16x32_bf16 v[220:223], v[92:95], a[116:119], v[220:223]
ds_read_b64_tr_b16 v[114:115], v14 offset:49152
ds_read_b64_tr_b16 v[116:117], v15 offset:32768
ds_read_b64_tr_b16 v[118:119], v15 offset:49152
v_mfma_f32_16x16x32_bf16 v[192:195], v[96:99], a[120:123], v[192:195]
ds_read_b64_tr_b16 v[120:121], v16 offset:32768
ds_read_b64_tr_b16 v[122:123], v16 offset:49152
ds_read_b64_tr_b16 v[124:125], v17 offset:32768
v_mfma_f32_16x16x32_bf16 v[208:211], v[96:99], a[124:127], v[208:211]
ds_read_b64_tr_b16 v[126:127], v17 offset:49152
s_add_u32 m0, s76, 65536
s_add_u32 s77, s97, 0x20000
v_mfma_f32_16x16x32_bf16 v[196:199], v[100:103], a[120:123], v[196:199]
ds_read_b64_tr_b16 v[80:81], v14 offset:33792
buffer_load_dwordx4 v38, s[48:51], s77 offen offset:0 lds
v_mfma_f32_16x16x32_bf16 v[212:215], v[100:103], a[124:127], v[212:215]
ds_read_b64_tr_b16 v[82:83], v14 offset:50176
s_add_u32 s91, s6, 34816
ds_read_b64_tr_b16 v[84:85], v15 offset:33792
v_mfma_f32_16x16x32_bf16 v[200:203], v[104:107], a[120:123], v[200:203]
buffer_load_dwordx4 a[112:115], v46, s[60:63], s91 offen offset:0 sc1
ds_read_b64_tr_b16 v[86:87], v15 offset:50176
v_mfma_f32_16x16x32_bf16 v[216:219], v[104:107], a[124:127], v[216:219]
buffer_load_dwordx4 a[116:119], v46, s[60:63], s91 offen offset:1024 sc1
ds_read_b64_tr_b16 v[88:89], v16 offset:33792
v_mfma_f32_16x16x32_bf16 v[204:207], v[108:111], a[120:123], v[204:207]
v_rcp_f32 v247, v247
v_mul_f32 v172, v172, v244
v_mfma_f32_16x16x32_bf16 v[220:223], v[108:111], a[124:127], v[220:223]
ds_read_b64_tr_b16 v[90:91], v16 offset:50176
s_add_u32 s91, s6, 51200
s_waitcnt lgkmcnt(7)
v_mfma_f32_16x16x32_bf16 v[192:195], v[112:115], a[128:131], v[192:195]
ds_read_b64_tr_b16 v[92:93], v17 offset:33792
buffer_load_dwordx4 v39, s[48:51], s77 offen offset:1024 lds
v_mfma_f32_16x16x32_bf16 v[208:211], v[112:115], a[132:135], v[208:211]
ds_read_b64_tr_b16 v[94:95], v17 offset:50176
buffer_load_dwordx4 a[120:123], v46, s[60:63], s91 offen offset:0 sc1
v_mfma_f32_16x16x32_bf16 v[196:199], v[116:119], a[128:131], v[196:199]
ds_read_b64_tr_b16 v[96:97], v14 offset:34816
buffer_load_dwordx4 a[124:127], v46, s[60:63], s91 offen offset:1024 sc1
v_mfma_f32_16x16x32_bf16 v[212:215], v[116:119], a[132:135], v[212:215]
ds_read_b64_tr_b16 v[98:99], v14 offset:51200
v_mul_f32 v173, v173, v245
v_mul_f32 v174, v174, v246
v_mfma_f32_16x16x32_bf16 v[200:203], v[120:123], a[128:131], v[200:203]
ds_read_b64_tr_b16 v[100:101], v15 offset:34816
v_mul_f32 v175, v175, v247
v_mul_f32 v240, v61, v176
v_mfma_f32_16x16x32_bf16 v[216:219], v[120:123], a[132:135], v[216:219]
ds_read_b64_tr_b16 v[102:103], v15 offset:51200
v_mul_f32 v241, v61, v177
s_waitcnt lgkmcnt(7)
v_mfma_f32_16x16x32_bf16 v[204:207], v[124:127], a[128:131], v[204:207]
ds_read_b64_tr_b16 v[104:105], v16 offset:34816
buffer_load_dwordx4 v40, s[48:51], s77 offen offset:2048 lds
v_mfma_f32_16x16x32_bf16 v[220:223], v[124:127], a[132:135], v[220:223]
ds_read_b64_tr_b16 v[106:107], v16 offset:51200
s_add_u32 s91, s6, 12288
v_mul_f32 v242, v61, v178
v_mfma_f32_16x16x32_bf16 v[192:195], v[80:83], a[136:139], v[192:195]
ds_read_b64_tr_b16 v[108:109], v17 offset:34816
buffer_load_dwordx4 a[128:131], v46, s[60:63], s91 offen offset:0 sc1
v_mfma_f32_16x16x32_bf16 v[208:211], v[80:83], a[140:143], v[208:211]
ds_read_b64_tr_b16 v[110:111], v17 offset:51200
buffer_load_dwordx4 a[132:135], v46, s[60:63], s91 offen offset:1024 sc1
v_mfma_f32_16x16x32_bf16 v[196:199], v[84:87], a[136:139], v[196:199]
ds_read_b64_tr_b16 v[112:113], v14 offset:35840
v_mul_f32 v243, v61, v179
ds_read_b64_tr_b16 v[114:115], v14 offset:52224
v_mfma_f32_16x16x32_bf16 v[212:215], v[84:87], a[140:143], v[212:215]
buffer_load_dwordx4 v41, s[48:51], s77 offen offset:3072 lds
s_waitcnt lgkmcnt(7)
v_mfma_f32_16x16x32_bf16 v[200:203], v[88:91], a[136:139], v[200:203]
ds_read_b64_tr_b16 v[116:117], v15 offset:35840
v_exp_f32 v240, v240
v_mfma_f32_16x16x32_bf16 v[216:219], v[88:91], a[140:143], v[216:219]
ds_read_b64_tr_b16 v[118:119], v15 offset:52224
v_exp_f32 v241, v241
v_mfma_f32_16x16x32_bf16 v[204:207], v[92:95], a[136:139], v[204:207]
ds_read_b64_tr_b16 v[120:121], v16 offset:35840
v_exp_f32 v242, v242
v_mfma_f32_16x16x32_bf16 v[220:223], v[92:95], a[140:143], v[220:223]
ds_read_b64_tr_b16 v[122:123], v16 offset:52224
s_add_u32 s91, s6, 14336
ds_read_b64_tr_b16 v[124:125], v17 offset:35840
v_mfma_f32_16x16x32_bf16 v[192:195], v[96:99], a[144:147], v[192:195]
s_add_u32 m0, s76, 69632
s_add_u32 s77, s97, 0x30000
ds_read_b64_tr_b16 v[126:127], v17 offset:52224
v_mfma_f32_16x16x32_bf16 v[208:211], v[96:99], a[148:151], v[208:211]
buffer_load_dwordx4 v38, s[48:51], s77 offen offset:0 lds
s_waitcnt lgkmcnt(6)
v_mfma_f32_16x16x32_bf16 v[196:199], v[100:103], a[144:147], v[196:199]
ds_read_b64_tr_b16 v[80:81], v14 offset:36864
buffer_load_dwordx4 a[136:139], v46, s[60:63], s91 offen offset:0 sc1
v_mfma_f32_16x16x32_bf16 v[212:215], v[100:103], a[148:151], v[212:215]
ds_read_b64_tr_b16 v[82:83], v14 offset:53248
buffer_load_dwordx4 a[140:143], v46, s[60:63], s91 offen offset:1024 sc1
v_mfma_f32_16x16x32_bf16 v[200:203], v[104:107], a[144:147], v[200:203]
ds_read_b64_tr_b16 v[84:85], v15 offset:36864
v_exp_f32 v243, v243
v_mfma_f32_16x16x32_bf16 v[216:219], v[104:107], a[148:151], v[216:219]
ds_read_b64_tr_b16 v[86:87], v15 offset:53248
v_fma_f32 v240, v240, v63, v63
v_fma_f32 v241, v241, v63, v63
v_mfma_f32_16x16x32_bf16 v[204:207], v[108:111], a[144:147], v[204:207]
ds_read_b64_tr_b16 v[88:89], v16 offset:36864
buffer_load_dwordx4 v39, s[48:51], s77 offen offset:1024 lds
v_mfma_f32_16x16x32_bf16 v[220:223], v[108:111], a[148:151], v[220:223]
ds_read_b64_tr_b16 v[90:91], v16 offset:53248
s_add_u32 s91, s6, 40960
v_fma_f32 v242, v242, v63, v63
v_mfma_f32_16x16x32_bf16 v[192:195], v[112:115], a[152:155], v[192:195]
ds_read_b64_tr_b16 v[92:93], v17 offset:36864
buffer_load_dwordx4 a[144:147], v46, s[60:63], s91 offen offset:0 sc1
v_mfma_f32_16x16x32_bf16 v[208:211], v[112:115], a[156:159], v[208:211]
ds_read_b64_tr_b16 v[94:95], v17 offset:53248
v_fma_f32 v243, v243, v63, v63
s_waitcnt lgkmcnt(7)
v_mfma_f32_16x16x32_bf16 v[196:199], v[116:119], a[152:155], v[196:199]
ds_read_b64_tr_b16 v[96:97], v14 offset:37888
buffer_load_dwordx4 a[148:151], v46, s[60:63], s91 offen offset:1024 sc1
v_mfma_f32_16x16x32_bf16 v[212:215], v[116:119], a[156:159], v[212:215]
ds_read_b64_tr_b16 v[98:99], v14 offset:54272
buffer_load_dwordx4 v40, s[48:51], s77 offen offset:2048 lds
v_mfma_f32_16x16x32_bf16 v[200:203], v[120:123], a[152:155], v[200:203]
ds_read_b64_tr_b16 v[100:101], v15 offset:37888
v_rcp_f32 v240, v240
v_mfma_f32_16x16x32_bf16 v[216:219], v[120:123], a[156:159], v[216:219]
ds_read_b64_tr_b16 v[102:103], v15 offset:54272
v_rcp_f32 v241, v241
v_mfma_f32_16x16x32_bf16 v[204:207], v[124:127], a[152:155], v[204:207]
ds_read_b64_tr_b16 v[104:105], v16 offset:37888
v_rcp_f32 v242, v242
v_mfma_f32_16x16x32_bf16 v[220:223], v[124:127], a[156:159], v[220:223]
ds_read_b64_tr_b16 v[106:107], v16 offset:54272
s_add_u32 s91, s6, 43008
s_waitcnt lgkmcnt(7)
v_mfma_f32_16x16x32_bf16 v[192:195], v[80:83], a[160:163], v[192:195]
ds_read_b64_tr_b16 v[108:109], v17 offset:37888
buffer_load_dwordx4 v41, s[48:51], s77 offen offset:3072 lds
v_mfma_f32_16x16x32_bf16 v[208:211], v[80:83], a[164:167], v[208:211]
ds_read_b64_tr_b16 v[110:111], v17 offset:54272
buffer_load_dwordx4 a[152:155], v46, s[60:63], s91 offen offset:0 sc1
v_mfma_f32_16x16x32_bf16 v[196:199], v[84:87], a[160:163], v[196:199]
ds_read_b64_tr_b16 v[112:113], v14 offset:38912
buffer_load_dwordx4 a[156:159], v46, s[60:63], s91 offen offset:1024 sc1
v_mfma_f32_16x16x32_bf16 v[212:215], v[84:87], a[164:167], v[212:215]
ds_read_b64_tr_b16 v[114:115], v14 offset:55296
v_rcp_f32 v243, v243
v_mfma_f32_16x16x32_bf16 v[200:203], v[88:91], a[160:163], v[200:203]
ds_read_b64_tr_b16 v[116:117], v15 offset:38912
v_mul_f32 v176, v176, v240
v_mul_f32 v177, v177, v241
v_mfma_f32_16x16x32_bf16 v[216:219], v[88:91], a[164:167], v[216:219]
ds_read_b64_tr_b16 v[118:119], v15 offset:55296
v_mul_f32 v178, v178, v242
s_waitcnt lgkmcnt(7)
v_mfma_f32_16x16x32_bf16 v[204:207], v[92:95], a[160:163], v[204:207]
ds_read_b64_tr_b16 v[120:121], v16 offset:38912
v_mul_f32 v179, v179, v243
v_mul_f32 v244, v61, v180
v_mfma_f32_16x16x32_bf16 v[220:223], v[92:95], a[164:167], v[220:223]
ds_read_b64_tr_b16 v[122:123], v16 offset:55296
v_mul_f32 v245, v61, v181
v_mul_f32 v246, v61, v182
v_mfma_f32_16x16x32_bf16 v[192:195], v[96:99], a[168:171], v[192:195]
ds_read_b64_tr_b16 v[124:125], v17 offset:38912
v_mul_f32 v247, v61, v183
ds_read_b64_tr_b16 v[126:127], v17 offset:55296
v_mfma_f32_16x16x32_bf16 v[208:211], v[96:99], a[172:175], v[208:211]
v_exp_f32 v244, v244
ds_read_b64_tr_b16 v[80:81], v14 offset:39936
v_mfma_f32_16x16x32_bf16 v[196:199], v[100:103], a[168:171], v[196:199]
v_exp_f32 v245, v245
ds_read_b64_tr_b16 v[82:83], v14 offset:56320
v_mfma_f32_16x16x32_bf16 v[212:215], v[100:103], a[172:175], v[212:215]
v_exp_f32 v246, v246
s_waitcnt lgkmcnt(7)
v_mfma_f32_16x16x32_bf16 v[200:203], v[104:107], a[168:171], v[200:203]
ds_read_b64_tr_b16 v[84:85], v15 offset:39936
v_exp_f32 v247, v247
v_mfma_f32_16x16x32_bf16 v[216:219], v[104:107], a[172:175], v[216:219]
ds_read_b64_tr_b16 v[86:87], v15 offset:56320
v_fma_f32 v244, v244, v63, v63
v_fma_f32 v245, v245, v63, v63
v_mfma_f32_16x16x32_bf16 v[204:207], v[108:111], a[168:171], v[204:207]
ds_read_b64_tr_b16 v[88:89], v16 offset:39936
v_fma_f32 v246, v246, v63, v63
v_fma_f32 v247, v247, v63, v63
v_mfma_f32_16x16x32_bf16 v[220:223], v[108:111], a[172:175], v[220:223]
ds_read_b64_tr_b16 v[90:91], v16 offset:56320
v_rcp_f32 v244, v244
v_mfma_f32_16x16x32_bf16 v[192:195], v[112:115], a[176:179], v[192:195]
ds_read_b64_tr_b16 v[92:93], v17 offset:39936
v_rcp_f32 v245, v245
v_mfma_f32_16x16x32_bf16 v[208:211], v[112:115], a[180:183], v[208:211]
ds_read_b64_tr_b16 v[94:95], v17 offset:56320
s_waitcnt lgkmcnt(6)
v_mfma_f32_16x16x32_bf16 v[196:199], v[116:119], a[176:179], v[196:199]
v_rcp_f32 v246, v246
v_mfma_f32_16x16x32_bf16 v[212:215], v[116:119], a[180:183], v[212:215]
v_rcp_f32 v247, v247
v_mul_f32 v180, v180, v244
v_mfma_f32_16x16x32_bf16 v[200:203], v[120:123], a[176:179], v[200:203]
v_mul_f32 v181, v181, v245
v_mul_f32 v182, v182, v246
v_mul_f32 v183, v183, v247
v_mfma_f32_16x16x32_bf16 v[216:219], v[120:123], a[180:183], v[216:219]
v_mul_f32 v240, v61, v184
v_mul_f32 v241, v61, v185
v_mul_f32 v242, v61, v186
v_mfma_f32_16x16x32_bf16 v[204:207], v[124:127], a[176:179], v[204:207]
s_waitcnt vmcnt(56) lgkmcnt(0)
s_barrier
v_mfma_f32_16x16x32_bf16 v[220:223], v[124:127], a[180:183], v[220:223]
ds_read_b64_tr_b16 v[96:97], v10 offset:0
ds_read_b64_tr_b16 v[98:99], v10 offset:16384
ds_read_b64_tr_b16 v[100:101], v11 offset:0
v_mfma_f32_16x16x32_bf16 v[192:195], v[80:83], a[184:187], v[192:195]
ds_read_b64_tr_b16 v[102:103], v11 offset:16384
ds_read_b64_tr_b16 v[104:105], v12 offset:0
ds_read_b64_tr_b16 v[106:107], v12 offset:16384
v_mfma_f32_16x16x32_bf16 v[208:211], v[80:83], a[188:191], v[208:211]
ds_read_b64_tr_b16 v[108:109], v13 offset:0
ds_read_b64_tr_b16 v[110:111], v13 offset:16384
s_add_u32 m0, s76, 98304
v_mfma_f32_16x16x32_bf16 v[196:199], v[84:87], a[184:187], v[196:199]
ds_read_b64_tr_b16 v[112:113], v10 offset:1024
s_add_u32 s77, s97, 0x0
v_mul_f32 v243, v61, v187
v_mfma_f32_16x16x32_bf16 v[212:215], v[84:87], a[188:191], v[212:215]
ds_read_b64_tr_b16 v[114:115], v10 offset:17408
buffer_load_dwordx4 v42, s[48:51], s77 offen offset:0 lds
v_mfma_f32_16x16x32_bf16 v[200:203], v[88:91], a[184:187], v[200:203]
ds_read_b64_tr_b16 v[116:117], v11 offset:1024
v_exp_f32 v240, v240
v_mfma_f32_16x16x32_bf16 v[216:219], v[88:91], a[188:191], v[216:219]
ds_read_b64_tr_b16 v[118:119], v11 offset:17408
v_exp_f32 v241, v241
v_mfma_f32_16x16x32_bf16 v[204:207], v[92:95], a[184:187], v[204:207]
ds_read_b64_tr_b16 v[120:121], v12 offset:1024
v_exp_f32 v242, v242
v_mfma_f32_16x16x32_bf16 v[220:223], v[92:95], a[188:191], v[220:223]
ds_read_b64_tr_b16 v[122:123], v12 offset:17408
ds_read_b64_tr_b16 v[124:125], v13 offset:1024
s_waitcnt lgkmcnt(9)
v_mfma_f32_16x16x32_bf16 v[192:195], v[96:99], a[192:195], v[192:195]
buffer_load_dwordx4 v43, s[48:51], s77 offen offset:1024 lds
ds_read_b64_tr_b16 v[126:127], v13 offset:17408
v_mfma_f32_16x16x32_bf16 v[208:211], v[96:99], a[196:199], v[208:211]
v_exp_f32 v243, v243
v_fma_f32 v240, v240, v63, v63
v_mfma_f32_16x16x32_bf16 v[196:199], v[100:103], a[192:195], v[196:199]
ds_read_b64_tr_b16 v[80:81], v10 offset:2048
v_fma_f32 v241, v241, v63, v63
v_fma_f32 v242, v242, v63, v63
v_mfma_f32_16x16x32_bf16 v[212:215], v[100:103], a[196:199], v[212:215]
ds_read_b64_tr_b16 v[82:83], v10 offset:18432
v_fma_f32 v243, v243, v63, v63
ds_read_b64_tr_b16 v[84:85], v11 offset:2048
v_mfma_f32_16x16x32_bf16 v[200:203], v[104:107], a[192:195], v[200:203]
v_rcp_f32 v240, v240
ds_read_b64_tr_b16 v[86:87], v11 offset:18432
v_mfma_f32_16x16x32_bf16 v[216:219], v[104:107], a[196:199], v[216:219]
buffer_load_dwordx4 v44, s[48:51], s77 offen offset:2048 lds
s_waitcnt lgkmcnt(7)
v_mfma_f32_16x16x32_bf16 v[204:207], v[108:111], a[192:195], v[204:207]
ds_read_b64_tr_b16 v[88:89], v12 offset:2048
v_rcp_f32 v241, v241
v_mfma_f32_16x16x32_bf16 v[220:223], v[108:111], a[196:199], v[220:223]
ds_read_b64_tr_b16 v[90:91], v12 offset:18432
v_rcp_f32 v242, v242
v_mfma_f32_16x16x32_bf16 v[192:195], v[112:115], a[200:203], v[192:195]
ds_read_b64_tr_b16 v[92:93], v13 offset:2048
v_rcp_f32 v243, v243
v_mfma_f32_16x16x32_bf16 v[208:211], v[112:115], a[204:207], v[208:211]
ds_read_b64_tr_b16 v[94:95], v13 offset:18432
v_mul_f32 v184, v184, v240
v_mul_f32 v185, v185, v241
v_mfma_f32_16x16x32_bf16 v[196:199], v[116:119], a[200:203], v[196:199]
ds_read_b64_tr_b16 v[96:97], v10 offset:3072
buffer_load_dwordx4 v45, s[48:51], s77 offen offset:3072 lds
v_mfma_f32_16x16x32_bf16 v[212:215], v[116:119], a[204:207], v[212:215]
ds_read_b64_tr_b16 v[98:99], v10 offset:19456
v_mul_f32 v186, v186, v242
s_waitcnt lgkmcnt(6)
v_mfma_f32_16x16x32_bf16 v[200:203], v[120:123], a[200:203], v[200:203]
ds_read_b64_tr_b16 v[100:101], v11 offset:3072
v_mul_f32 v187, v187, v243
v_mul_f32 v244, v61, v188
v_mfma_f32_16x16x32_bf16 v[216:219], v[120:123], a[204:207], v[216:219]
ds_read_b64_tr_b16 v[102:103], v11 offset:19456
v_mul_f32 v245, v61, v189
v_mul_f32 v246, v61, v190
v_mfma_f32_16x16x32_bf16 v[204:207], v[124:127], a[200:203], v[204:207]
ds_read_b64_tr_b16 v[104:105], v12 offset:3072
v_mul_f32 v247, v61, v191
v_mfma_f32_16x16x32_bf16 v[220:223], v[124:127], a[204:207], v[220:223]
ds_read_b64_tr_b16 v[106:107], v12 offset:19456
s_add_u32 m0, s76, 102400
v_mfma_f32_16x16x32_bf16 v[192:195], v[80:83], a[208:211], v[192:195]
ds_read_b64_tr_b16 v[108:109], v13 offset:3072
s_add_u32 s77, s97, 0x40000
v_mfma_f32_16x16x32_bf16 v[208:211], v[80:83], a[212:215], v[208:211]
ds_read_b64_tr_b16 v[110:111], v13 offset:19456
ds_read_b64_tr_b16 v[112:113], v10 offset:4096
v_mfma_f32_16x16x32_bf16 v[196:199], v[84:87], a[208:211], v[196:199]
buffer_load_dwordx4 v38, s[48:51], s77 offen offset:0 lds
v_mfma_f32_16x16x32_bf16 v[212:215], v[84:87], a[212:215], v[212:215]
ds_read_b64_tr_b16 v[114:115], v10 offset:20480
s_waitcnt lgkmcnt(7)
v_mfma_f32_16x16x32_bf16 v[200:203], v[88:91], a[208:211], v[200:203]
ds_read_b64_tr_b16 v[116:117], v11 offset:4096
ds_read_b64_tr_b16 v[118:119], v11 offset:20480
v_mfma_f32_16x16x32_bf16 v[216:219], v[88:91], a[212:215], v[216:219]
v_exp_f32 v244, v244
v_mfma_f32_16x16x32_bf16 v[204:207], v[92:95], a[208:211], v[204:207]
ds_read_b64_tr_b16 v[120:121], v12 offset:4096
ds_read_b64_tr_b16 v[122:123], v12 offset:20480
v_mfma_f32_16x16x32_bf16 v[220:223], v[92:95], a[212:215], v[220:223]
buffer_load_dwordx4 v39, s[48:51], s77 offen offset:1024 lds
v_mfma_f32_16x16x32_bf16 v[192:195], v[96:99], a[216:219], v[192:195]
ds_read_b64_tr_b16 v[124:125], v13 offset:4096
ds_read_b64_tr_b16 v[126:127], v13 offset:20480
v_mfma_f32_16x16x32_bf16 v[208:211], v[96:99], a[220:223], v[208:211]
ds_read_b64_tr_b16 v[80:81], v10 offset:5120
s_waitcnt lgkmcnt(8)
v_mfma_f32_16x16x32_bf16 v[196:199], v[100:103], a[216:219], v[196:199]
v_exp_f32 v245, v245
v_mfma_f32_16x16x32_bf16 v[212:215], v[100:103], a[220:223], v[212:215]
ds_read_b64_tr_b16 v[82:83], v10 offset:21504
ds_read_b64_tr_b16 v[84:85], v11 offset:5120
v_mfma_f32_16x16x32_bf16 v[200:203], v[104:107], a[216:219], v[200:203]
buffer_load_dwordx4 v40, s[48:51], s77 offen offset:2048 lds
v_mfma_f32_16x16x32_bf16 v[216:219], v[104:107], a[220:223], v[216:219]
ds_read_b64_tr_b16 v[86:87], v11 offset:21504
ds_read_b64_tr_b16 v[88:89], v12 offset:5120
v_mfma_f32_16x16x32_bf16 v[204:207], v[108:111], a[216:219], v[204:207]
v_exp_f32 v246, v246
v_mfma_f32_16x16x32_bf16 v[220:223], v[108:111], a[220:223], v[220:223]
ds_read_b64_tr_b16 v[90:91], v12 offset:21504
s_waitcnt lgkmcnt(6)
v_mfma_f32_16x16x32_bf16 v[192:195], v[112:115], a[224:227], v[192:195]
ds_read_b64_tr_b16 v[92:93], v13 offset:5120
ds_read_b64_tr_b16 v[94:95], v13 offset:21504
v_mfma_f32_16x16x32_bf16 v[208:211], v[112:115], a[228:231], v[208:211]
buffer_load_dwordx4 v41, s[48:51], s77 offen offset:3072 lds
v_mfma_f32_16x16x32_bf16 v[196:199], v[116:119], a[224:227], v[196:199]
ds_read_b64_tr_b16 v[96:97], v10 offset:6144
ds_read_b64_tr_b16 v[98:99], v10 offset:22528
v_mfma_f32_16x16x32_bf16 v[212:215], v[116:119], a[228:231], v[212:215]
v_exp_f32 v247, v247
v_mfma_f32_16x16x32_bf16 v[200:203], v[120:123], a[224:227], v[200:203]
ds_read_b64_tr_b16 v[100:101], v11 offset:6144
v_fma_f32 v244, v244, v63, v63
v_mfma_f32_16x16x32_bf16 v[216:219], v[120:123], a[228:231], v[216:219]
ds_read_b64_tr_b16 v[102:103], v11 offset:22528
v_fma_f32 v245, v245, v63, v63
v_mfma_f32_16x16x32_bf16 v[204:207], v[124:127], a[224:227], v[204:207]
ds_read_b64_tr_b16 v[104:105], v12 offset:6144
v_fma_f32 v246, v246, v63, v63
v_mfma_f32_16x16x32_bf16 v[220:223], v[124:127], a[228:231], v[220:223]
ds_read_b64_tr_b16 v[106:107], v12 offset:22528
s_waitcnt lgkmcnt(6)
v_mfma_f32_16x16x32_bf16 v[192:195], v[80:83], a[232:235], v[192:195]
ds_read_b64_tr_b16 v[108:109], v13 offset:6144
v_fma_f32 v247, v247, v63, v63
v_mfma_f32_16x16x32_bf16 v[208:211], v[80:83], a[236:239], v[208:211]
ds_read_b64_tr_b16 v[110:111], v13 offset:22528
ds_read_b64_tr_b16 v[112:113], v10 offset:7168
v_mfma_f32_16x16x32_bf16 v[196:199], v[84:87], a[232:235], v[196:199]
v_rcp_f32 v244, v244
v_mfma_f32_16x16x32_bf16 v[212:215], v[84:87], a[236:239], v[212:215]
ds_read_b64_tr_b16 v[114:115], v10 offset:23552
ds_read_b64_tr_b16 v[116:117], v11 offset:7168
v_mfma_f32_16x16x32_bf16 v[200:203], v[88:91], a[232:235], v[200:203]
v_rcp_f32 v245, v245
v_mfma_f32_16x16x32_bf16 v[216:219], v[88:91], a[236:239], v[216:219]
ds_read_b64_tr_b16 v[118:119], v11 offset:23552
ds_read_b64_tr_b16 v[120:121], v12 offset:7168
v_mfma_f32_16x16x32_bf16 v[204:207], v[92:95], a[232:235], v[204:207]
v_rcp_f32 v246, v246
v_mfma_f32_16x16x32_bf16 v[220:223], v[92:95], a[236:239], v[220:223]
ds_read_b64_tr_b16 v[122:123], v12 offset:23552
s_waitcnt lgkmcnt(7)
v_mfma_f32_16x16x32_bf16 v[192:195], v[96:99], a[240:243], v[192:195]
ds_read_b64_tr_b16 v[124:125], v13 offset:7168
ds_read_b64_tr_b16 v[126:127], v13 offset:23552
v_mfma_f32_16x16x32_bf16 v[208:211], v[96:99], a[244:247], v[208:211]
v_rcp_f32 v247, v247
v_mfma_f32_16x16x32_bf16 v[196:199], v[100:103], a[240:243], v[196:199]
v_mul_f32 v188, v188, v244
v_mul_f32 v189, v189, v245
v_mfma_f32_16x16x32_bf16 v[212:215], v[100:103], a[244:247], v[212:215]
v_mul_f32 v190, v190, v246
v_mul_f32 v191, v191, v247
v_mfma_f32_16x16x32_bf16 v[200:203], v[104:107], a[240:243], v[200:203]
v_mfma_f32_16x16x32_bf16 v[216:219], v[104:107], a[244:247], v[216:219]
s_waitcnt vmcnt(39) lgkmcnt(0)
s_barrier
v_mfma_f32_16x16x32_bf16 v[204:207], v[108:111], a[240:243], v[204:207]
ds_read_b64_tr_b16 v[80:81], v10 offset:32768
ds_read_b64_tr_b16 v[82:83], v10 offset:49152
v_mfma_f32_16x16x32_bf16 v[220:223], v[108:111], a[244:247], v[220:223]
ds_read_b64_tr_b16 v[84:85], v11 offset:32768
ds_read_b64_tr_b16 v[86:87], v11 offset:49152
v_mfma_f32_16x16x32_bf16 v[192:195], v[112:115], a[248:251], v[192:195]
ds_read_b64_tr_b16 v[88:89], v12 offset:32768
ds_read_b64_tr_b16 v[90:91], v12 offset:49152
v_mfma_f32_16x16x32_bf16 v[208:211], v[112:115], a[252:255], v[208:211]
ds_read_b64_tr_b16 v[92:93], v13 offset:32768
ds_read_b64_tr_b16 v[94:95], v13 offset:49152
v_mfma_f32_16x16x32_bf16 v[196:199], v[116:119], a[248:251], v[196:199]
ds_read_b64_tr_b16 v[96:97], v10 offset:33792
s_add_u32 m0, s76, 0
v_mfma_f32_16x16x32_bf16 v[212:215], v[116:119], a[252:255], v[212:215]
ds_read_b64_tr_b16 v[98:99], v10 offset:50176
s_add_u32 s77, s97, 0x50000
v_mfma_f32_16x16x32_bf16 v[200:203], v[120:123], a[248:251], v[200:203]
ds_read_b64_tr_b16 v[100:101], v11 offset:33792
ds_read_b64_tr_b16 v[102:103], v11 offset:50176
v_mfma_f32_16x16x32_bf16 v[216:219], v[120:123], a[252:255], v[216:219]
buffer_load_dwordx4 v38, s[48:51], s77 offen offset:0 lds
v_mfma_f32_16x16x32_bf16 v[204:207], v[124:127], a[248:251], v[204:207]
ds_read_b64_tr_b16 v[104:105], v12 offset:33792
ds_read_b64_tr_b16 v[106:107], v12 offset:50176
v_mfma_f32_16x16x32_bf16 v[220:223], v[124:127], a[252:255], v[220:223]
ds_read_b64_tr_b16 v[108:109], v13 offset:33792
S_D0:
s_waitcnt lgkmcnt(9)
v_mfma_f32_16x16x32_bf16 v[128:131], v[80:83], a[0:3], 0
ds_read_b64_tr_b16 v[110:111], v13 offset:50176
ds_read_b64_tr_b16 v[112:113], v10 offset:34816
ds_read_b64_tr_b16 v[114:115], v10 offset:51200
v_mfma_f32_16x16x32_bf16 v[144:147], v[80:83], a[4:7], 0
ds_read_b64_tr_b16 v[116:117], v11 offset:34816
v_mfma_f32_16x16x32_bf16 v[132:135], v[84:87], a[0:3], 0
buffer_load_dwordx4 v39, s[48:51], s77 offen offset:1024 lds
ds_read_b64_tr_b16 v[118:119], v11 offset:51200
v_mfma_f32_16x16x32_bf16 v[148:151], v[84:87], a[4:7], 0
s_add_u32 s70, s0, S_D1 - K_pc + 0
s_addc_u32 s71, s1, 0
global_load_dword v57, v9, s[70:71]
v_mfma_f32_16x16x32_bf16 v[136:139], v[88:91], a[0:3], 0
s_add_u32 s7, s4, 8192
v_mul_f32 v192, v192, v160
v_mul_f32 v193, v193, v161
v_mfma_f32_16x16x32_bf16 v[152:155], v[88:91], a[4:7], 0
v_mul_f32 v194, v194, v162
v_mul_f32 v195, v195, v163
s_waitcnt lgkmcnt(6)
v_mfma_f32_16x16x32_bf16 v[140:143], v[92:95], a[0:3], 0
ds_read_b64_tr_b16 v[120:121], v12 offset:34816
v_mul_f32 v196, v196, v164
v_mul_f32 v197, v197, v165
v_mfma_f32_16x16x32_bf16 v[156:159], v[92:95], a[4:7], 0
ds_read_b64_tr_b16 v[122:123], v12 offset:51200
buffer_load_dwordx4 v40, s[48:51], s77 offen offset:2048 lds
v_mfma_f32_16x16x32_bf16 v[128:131], v[96:99], a[8:11], v[128:131]
ds_read_b64_tr_b16 v[124:125], v13 offset:34816
v_mul_f32 v198, v198, v166
v_mul_f32 v199, v199, v167
v_mfma_f32_16x16x32_bf16 v[144:147], v[96:99], a[12:15], v[144:147]
ds_read_b64_tr_b16 v[126:127], v13 offset:51200
v_cvt_pk_bf16_f32 v192, v192, v193
v_cvt_pk_bf16_f32 v193, v194, v195
v_mfma_f32_16x16x32_bf16 v[132:135], v[100:103], a[8:11], v[132:135]
ds_read_b64_tr_b16 v[80:81], v10 offset:35840
v_cvt_pk_bf16_f32 v194, v196, v197
v_cvt_pk_bf16_f32 v195, v198, v199
v_mfma_f32_16x16x32_bf16 v[148:151], v[100:103], a[12:15], v[148:151]
ds_read_b64_tr_b16 v[82:83], v10 offset:52224
buffer_store_dwordx4 v[192:195], v46, s[60:63], s7 offen offset:0 sc1
v_mfma_f32_16x16x32_bf16 v[136:139], v[104:107], a[8:11], v[136:139]
ds_read_b64_tr_b16 v[84:85], v11 offset:35840
buffer_load_dwordx4 v41, s[48:51], s77 offen offset:3072 lds
v_mfma_f32_16x16x32_bf16 v[152:155], v[104:107], a[12:15], v[152:155]
ds_read_b64_tr_b16 v[86:87], v11 offset:52224
v_mul_f32 v200, v200, v168
s_waitcnt lgkmcnt(7)
v_mfma_f32_16x16x32_bf16 v[140:143], v[108:111], a[8:11], v[140:143]
ds_read_b64_tr_b16 v[88:89], v12 offset:35840
v_mul_f32 v201, v201, v169
v_mul_f32 v202, v202, v170
v_mfma_f32_16x16x32_bf16 v[156:159], v[108:111], a[12:15], v[156:159]
ds_read_b64_tr_b16 v[90:91], v12 offset:52224
v_mul_f32 v203, v203, v171
v_mul_f32 v204, v204, v172
v_mfma_f32_16x16x32_bf16 v[128:131], v[112:115], a[16:19], v[128:131]
ds_read_b64_tr_b16 v[92:93], v13 offset:35840
v_mul_f32 v205, v205, v173
v_mul_f32 v206, v206, v174
v_mfma_f32_16x16x32_bf16 v[144:147], v[112:115], a[20:23], v[144:147]
ds_read_b64_tr_b16 v[94:95], v13 offset:52224
v_mul_f32 v207, v207, v175
v_cvt_pk_bf16_f32 v200, v200, v201
v_mfma_f32_16x16x32_bf16 v[132:135], v[116:119], a[16:19], v[132:135]
ds_read_b64_tr_b16 v[96:97], v10 offset:36864
v_cvt_pk_bf16_f32 v201, v202, v203
v_cvt_pk_bf16_f32 v202, v204, v205
v_mfma_f32_16x16x32_bf16 v[148:151], v[116:119], a[20:23], v[148:151]
ds_read_b64_tr_b16 v[98:99], v10 offset:53248
v_cvt_pk_bf16_f32 v203, v206, v207
s_waitcnt lgkmcnt(7)
v_mfma_f32_16x16x32_bf16 v[136:139], v[120:123], a[16:19], v[136:139]
ds_read_b64_tr_b16 v[100:101], v11 offset:36864
buffer_store_dwordx4 v[200:203], v46, s[60:63], s7 offen offset:2048 sc1
v_mfma_f32_16x16x32_bf16 v[152:155], v[120:123], a[20:23], v[152:155]
ds_read_b64_tr_b16 v[102:103], v11 offset:53248
v_mul_f32 v208, v208, v176
v_mul_f32 v209, v209, v177
v_mfma_f32_16x16x32_bf16 v[140:143], v[124:127], a[16:19], v[140:143]
ds_read_b64_tr_b16 v[104:105], v12 offset:36864
v_mul_f32 v210, v210, v178
v_mul_f32 v211, v211, v179
v_mfma_f32_16x16x32_bf16 v[156:159], v[124:127], a[20:23], v[156:159]
ds_read_b64_tr_b16 v[106:107], v12 offset:53248
v_mul_f32 v212, v212, v180
v_mfma_f32_16x16x32_bf16 v[128:131], v[80:83], a[24:27], v[128:131]
ds_read_b64_tr_b16 v[108:109], v13 offset:36864
v_mul_f32 v213, v213, v181
v_mfma_f32_16x16x32_bf16 v[144:147], v[80:83], a[28:31], v[144:147]
ds_read_b64_tr_b16 v[110:111], v13 offset:53248
s_waitcnt lgkmcnt(7)
v_mfma_f32_16x16x32_bf16 v[132:135], v[84:87], a[24:27], v[132:135]
ds_read_b64_tr_b16 v[112:113], v10 offset:37888
v_mul_f32 v214, v214, v182
v_mfma_f32_16x16x32_bf16 v[148:151], v[84:87], a[28:31], v[148:151]
ds_read_b64_tr_b16 v[114:115], v10 offset:54272
v_mul_f32 v215, v215, v183
v_mfma_f32_16x16x32_bf16 v[136:139], v[88:91], a[24:27], v[136:139]
ds_read_b64_tr_b16 v[116:117], v11 offset:37888
v_cvt_pk_bf16_f32 v208, v208, v209
v_mfma_f32_16x16x32_bf16 v[152:155], v[88:91], a[28:31], v[152:155]
ds_read_b64_tr_b16 v[118:119], v11 offset:54272
v_cvt_pk_bf16_f32 v209, v210, v211
v_mfma_f32_16x16x32_bf16 v[140:143], v[92:95], a[24:27], v[140:143]
ds_read_b64_tr_b16 v[120:121], v12 offset:37888
v_cvt_pk_bf16_f32 v210, v212, v213
v_mfma_f32_16x16x32_bf16 v[156:159], v[92:95], a[28:31], v[156:159]
ds_read_b64_tr_b16 v[122:123], v12 offset:54272
s_waitcnt lgkmcnt(7)
v_mfma_f32_16x16x32_bf16 v[128:131], v[96:99], a[32:35], v[128:131]
ds_read_b64_tr_b16 v[124:125], v13 offset:37888
v_cvt_pk_bf16_f32 v211, v214, v215
v_mfma_f32_16x16x32_bf16 v[144:147], v[96:99], a[36:39], v[144:147]
ds_read_b64_tr_b16 v[126:127], v13 offset:54272
ds_read_b64_tr_b16 v[80:81], v10 offset:38912
v_mfma_f32_16x16x32_bf16 v[132:135], v[100:103], a[32:35], v[132:135]
buffer_store_dwordx4 v[208:211], v46, s[60:63], s7 offen offset:1024 sc1
v_mfma_f32_16x16x32_bf16 v[148:151], v[100:103], a[36:39], v[148:151]
ds_read_b64_tr_b16 v[82:83], v10 offset:55296
v_mul_f32 v216, v216, v184
v_mfma_f32_16x16x32_bf16 v[136:139], v[104:107], a[32:35], v[136:139]
ds_read_b64_tr_b16 v[84:85], v11 offset:38912
v_mul_f32 v217, v217, v185
v_mfma_f32_16x16x32_bf16 v[152:155], v[104:107], a[36:39], v[152:155]
ds_read_b64_tr_b16 v[86:87], v11 offset:55296
s_waitcnt lgkmcnt(7)
v_mfma_f32_16x16x32_bf16 v[140:143], v[108:111], a[32:35], v[140:143]
ds_read_b64_tr_b16 v[88:89], v12 offset:38912
v_mul_f32 v218, v218, v186
v_mfma_f32_16x16x32_bf16 v[156:159], v[108:111], a[36:39], v[156:159]
ds_read_b64_tr_b16 v[90:91], v12 offset:55296
v_mul_f32 v219, v219, v187
v_mfma_f32_16x16x32_bf16 v[128:131], v[112:115], a[40:43], v[128:131]
ds_read_b64_tr_b16 v[92:93], v13 offset:38912
v_mul_f32 v220, v220, v188
v_mfma_f32_16x16x32_bf16 v[144:147], v[112:115], a[44:47], v[144:147]
ds_read_b64_tr_b16 v[94:95], v13 offset:55296
v_mul_f32 v221, v221, v189
v_mfma_f32_16x16x32_bf16 v[132:135], v[116:119], a[40:43], v[132:135]
ds_read_b64_tr_b16 v[96:97], v10 offset:39936
v_mul_f32 v222, v222, v190
v_mfma_f32_16x16x32_bf16 v[148:151], v[116:119], a[44:47], v[148:151]
ds_read_b64_tr_b16 v[98:99], v10 offset:56320
s_waitcnt lgkmcnt(7)
v_mfma_f32_16x16x32_bf16 v[136:139], v[120:123], a[40:43], v[136:139]
ds_read_b64_tr_b16 v[100:101], v11 offset:39936
v_mul_f32 v223, v223, v191
v_mfma_f32_16x16x32_bf16 v[152:155], v[120:123], a[44:47], v[152:155]
ds_read_b64_tr_b16 v[102:103], v11 offset:56320
v_cvt_pk_bf16_f32 v216, v216, v217
v_mfma_f32_16x16x32_bf16 v[140:143], v[124:127], a[40:43], v[140:143]
ds_read_b64_tr_b16 v[104:105], v12 offset:39936
v_cvt_pk_bf16_f32 v217, v218, v219
v_mfma_f32_16x16x32_bf16 v[156:159], v[124:127], a[44:47], v[156:159]
ds_read_b64_tr_b16 v[106:107], v12 offset:56320
v_cvt_pk_bf16_f32 v218, v220, v221
v_mfma_f32_16x16x32_bf16 v[128:131], v[80:83], a[48:51], v[128:131]
ds_read_b64_tr_b16 v[108:109], v13 offset:39936
v_cvt_pk_bf16_f32 v219, v222, v223
v_mfma_f32_16x16x32_bf16 v[144:147], v[80:83], a[52:55], v[144:147]
ds_read_b64_tr_b16 v[110:111], v13 offset:56320
s_waitcnt lgkmcnt(7)
v_mfma_f32_16x16x32_bf16 v[132:135], v[84:87], a[48:51], v[132:135]
buffer_store_dwordx4 v[216:219], v46, s[60:63], s7 offen offset:3072 sc1
v_mfma_f32_16x16x32_bf16 v[148:151], v[84:87], a[52:55], v[148:151]
v_mfma_f32_16x16x32_bf16 v[136:139], v[88:91], a[48:51], v[136:139]
v_mfma_f32_16x16x32_bf16 v[152:155], v[88:91], a[52:55], v[152:155]
v_mfma_f32_16x16x32_bf16 v[140:143], v[92:95], a[48:51], v[140:143]
s_waitcnt vmcnt(19) lgkmcnt(0)
s_barrier
v_mfma_f32_16x16x32_bf16 v[156:159], v[92:95], a[52:55], v[156:159]
ds_read_b64_tr_b16 v[112:113], v14 offset:0
ds_read_b64_tr_b16 v[114:115], v14 offset:16384
ds_read_b64_tr_b16 v[116:117], v15 offset:0
v_mfma_f32_16x16x32_bf16 v[128:131], v[96:99], a[56:59], v[128:131]
ds_read_b64_tr_b16 v[118:119], v15 offset:16384
ds_read_b64_tr_b16 v[120:121], v16 offset:0
ds_read_b64_tr_b16 v[122:123], v16 offset:16384
v_mfma_f32_16x16x32_bf16 v[144:147], v[96:99], a[60:63], v[144:147]
ds_read_b64_tr_b16 v[124:125], v17 offset:0
ds_read_b64_tr_b16 v[126:127], v17 offset:16384
s_add_u32 m0, s76, 32768
v_mfma_f32_16x16x32_bf16 v[132:135], v[100:103], a[56:59], v[132:135]
ds_read_b64_tr_b16 v[80:81], v14 offset:1024
s_add_u32 s77, s98, 0x0
v_mfma_f32_16x16x32_bf16 v[148:151], v[100:103], a[60:63], v[148:151]
ds_read_b64_tr_b16 v[82:83], v14 offset:17408
buffer_load_dwordx4 v38, s[48:51], s77 offen offset:0 lds
v_mfma_f32_16x16x32_bf16 v[136:139], v[104:107], a[56:59], v[136:139]
ds_read_b64_tr_b16 v[84:85], v15 offset:1024
ds_read_b64_tr_b16 v[86:87], v15 offset:17408
ds_read_b64_tr_b16 v[88:89], v16 offset:1024
v_mfma_f32_16x16x32_bf16 v[152:155], v[104:107], a[60:63], v[152:155]
ds_read_b64_tr_b16 v[90:91], v16 offset:17408
v_mfma_f32_16x16x32_bf16 v[140:143], v[108:111], a[56:59], v[140:143]
ds_read_b64_tr_b16 v[92:93], v17 offset:1024
ds_read_b64_tr_b16 v[94:95], v17 offset:17408
ds_read_b64_tr_b16 v[96:97], v14 offset:2048
v_mfma_f32_16x16x32_bf16 v[156:159], v[108:111], a[60:63], v[156:159]
ds_read_b64_tr_b16 v[98:99], v14 offset:18432
s_waitcnt lgkmcnt(12)
v_mfma_f32_16x16x32_bf16 v[128:131], v[112:115], a[64:67], v[128:131]
buffer_load_dwordx4 v39, s[48:51], s77 offen offset:1024 lds
ds_read_b64_tr_b16 v[100:101], v15 offset:2048
v_mfma_f32_16x16x32_bf16 v[144:147], v[112:115], a[68:71], v[144:147]
ds_read_b64_tr_b16 v[102:103], v15 offset:18432
ds_read_b64_tr_b16 v[104:105], v16 offset:2048
ds_read_b64_tr_b16 v[106:107], v16 offset:18432
v_mfma_f32_16x16x32_bf16 v[132:135], v[116:119], a[64:67], v[132:135]
ds_read_b64_tr_b16 v[108:109], v17 offset:2048
v_mfma_f32_16x16x32_bf16 v[148:151], v[116:119], a[68:71], v[148:151]
ds_read_b64_tr_b16 v[110:111], v17 offset:18432
ds_read_b64_tr_b16 v[112:113], v14 offset:3072
ds_read_b64_tr_b16 v[114:115], v14 offset:19456
v_mfma_f32_16x16x32_bf16 v[136:139], v[120:123], a[64:67], v[136:139]
ds_read_b64_tr_b16 v[116:117], v15 offset:3072
v_mfma_f32_16x16x32_bf16 v[152:155], v[120:123], a[68:71], v[152:155]
buffer_load_dwordx4 v40, s[48:51], s77 offen offset:2048 lds
s_waitcnt lgkmcnt(10)
v_mfma_f32_16x16x32_bf16 v[140:143], v[124:127], a[64:67], v[140:143]
ds_read_b64_tr_b16 v[118:119], v15 offset:19456
ds_read_b64_tr_b16 v[120:121], v16 offset:3072
v_mfma_f32_16x16x32_bf16 v[156:159], v[124:127], a[68:71], v[156:159]
ds_read_b64_tr_b16 v[122:123], v16 offset:19456
v_mfma_f32_16x16x32_bf16 v[128:131], v[80:83], a[72:75], v[128:131]
ds_read_b64_tr_b16 v[124:125], v17 offset:3072
v_mfma_f32_16x16x32_bf16 v[144:147], v[80:83], a[76:79], v[144:147]
ds_read_b64_tr_b16 v[126:127], v17 offset:19456
v_mfma_f32_16x16x32_bf16 v[132:135], v[84:87], a[72:75], v[132:135]
buffer_load_dwordx4 v41, s[48:51], s77 offen offset:3072 lds
ds_read_b64_tr_b16 v[80:81], v14 offset:4096
v_mfma_f32_16x16x32_bf16 v[148:151], v[84:87], a[76:79], v[148:151]
ds_read_b64_tr_b16 v[82:83], v14 offset:20480
v_mfma_f32_16x16x32_bf16 v[136:139], v[88:91], a[72:75], v[136:139]
ds_read_b64_tr_b16 v[84:85], v15 offset:4096
v_mfma_f32_16x16x32_bf16 v[152:155], v[88:91], a[76:79], v[152:155]
ds_read_b64_tr_b16 v[86:87], v15 offset:20480
v_mfma_f32_16x16x32_bf16 v[140:143], v[92:95], a[72:75], v[140:143]
ds_read_b64_tr_b16 v[88:89], v16 offset:4096
v_mfma_f32_16x16x32_bf16 v[156:159], v[92:95], a[76:79], v[156:159]
s_add_u32 m0, s76, 36864
s_add_u32 s77, s98, 0x10000
s_waitcnt lgkmcnt(6)
v_mfma_f32_16x16x32_bf16 v[128:131], v[96:99], a[80:83], v[128:131]
buffer_load_dwordx4 v38, s[48:51], s77 offen offset:0 lds
ds_read_b64_tr_b16 v[90:91], v16 offset:20480
v_mfma_f32_16x16x32_bf16 v[144:147], v[96:99], a[84:87], v[144:147]
s_waitcnt vmcnt(5)
buffer_atomic_add v52, v54, s[60:63], 0 offen sc1
v_mfma_f32_16x16x32_bf16 v[132:135], v[100:103], a[80:83], v[132:135]
v_mov_b32 v51, 0
buffer_atomic_add v51, v54, s[60:63], 0 offen sc0 sc1
v_mfma_f32_16x16x32_bf16 v[148:151], v[100:103], a[84:87], v[148:151]
ds_read_b64_tr_b16 v[92:93], v17 offset:4096
ds_read_b64_tr_b16 v[94:95], v17 offset:20480
ds_read_b64_tr_b16 v[96:97], v14 offset:5120
v_mfma_f32_16x16x32_bf16 v[136:139], v[104:107], a[80:83], v[136:139]
ds_read_b64_tr_b16 v[98:99], v14 offset:21504
v_mfma_f32_16x16x32_bf16 v[152:155], v[104:107], a[84:87], v[152:155]
buffer_load_dwordx4 v39, s[48:51], s77 offen offset:1024 lds
ds_read_b64_tr_b16 v[100:101], v15 offset:5120
v_mfma_f32_16x16x32_bf16 v[140:143], v[108:111], a[80:83], v[140:143]
ds_read_b64_tr_b16 v[102:103], v15 offset:21504
ds_read_b64_tr_b16 v[104:105], v16 offset:5120
v_mfma_f32_16x16x32_bf16 v[156:159], v[108:111], a[84:87], v[156:159]
ds_read_b64_tr_b16 v[106:107], v16 offset:21504
v_mfma_f32_16x16x32_bf16 v[128:131], v[112:115], a[88:91], v[128:131]
ds_read_b64_tr_b16 v[108:109], v17 offset:5120
v_mfma_f32_16x16x32_bf16 v[144:147], v[112:115], a[92:95], v[144:147]
ds_read_b64_tr_b16 v[110:111], v17 offset:21504
v_mfma_f32_16x16x32_bf16 v[132:135], v[116:119], a[88:91], v[132:135]
buffer_load_dwordx4 v40, s[48:51], s77 offen offset:2048 lds
ds_read_b64_tr_b16 v[112:113], v14 offset:6144
v_mfma_f32_16x16x32_bf16 v[148:151], v[116:119], a[92:95], v[148:151]
ds_read_b64_tr_b16 v[114:115], v14 offset:22528
v_mfma_f32_16x16x32_bf16 v[136:139], v[120:123], a[88:91], v[136:139]
ds_read_b64_tr_b16 v[116:117], v15 offset:6144
v_mfma_f32_16x16x32_bf16 v[152:155], v[120:123], a[92:95], v[152:155]
ds_read_b64_tr_b16 v[118:119], v15 offset:22528
s_waitcnt lgkmcnt(7)
v_mfma_f32_16x16x32_bf16 v[140:143], v[124:127], a[88:91], v[140:143]
ds_read_b64_tr_b16 v[120:121], v16 offset:6144
v_mfma_f32_16x16x32_bf16 v[156:159], v[124:127], a[92:95], v[156:159]
buffer_load_dwordx4 v41, s[48:51], s77 offen offset:3072 lds
ds_read_b64_tr_b16 v[122:123], v16 offset:22528
v_mfma_f32_16x16x32_bf16 v[128:131], v[80:83], a[96:99], v[128:131]
ds_read_b64_tr_b16 v[124:125], v17 offset:6144
v_mfma_f32_16x16x32_bf16 v[144:147], v[80:83], a[100:103], v[144:147]
ds_read_b64_tr_b16 v[126:127], v17 offset:22528
v_mfma_f32_16x16x32_bf16 v[132:135], v[84:87], a[96:99], v[132:135]
ds_read_b64_tr_b16 v[80:81], v14 offset:7168
v_mfma_f32_16x16x32_bf16 v[148:151], v[84:87], a[100:103], v[148:151]
ds_read_b64_tr_b16 v[82:83], v14 offset:23552
v_mfma_f32_16x16x32_bf16 v[136:139], v[88:91], a[96:99], v[136:139]
ds_read_b64_tr_b16 v[84:85], v15 offset:7168
v_mfma_f32_16x16x32_bf16 v[152:155], v[88:91], a[100:103], v[152:155]
ds_read_b64_tr_b16 v[86:87], v15 offset:23552
v_mfma_f32_16x16x32_bf16 v[140:143], v[92:95], a[96:99], v[140:143]
ds_read_b64_tr_b16 v[88:89], v16 offset:7168
v_mfma_f32_16x16x32_bf16 v[156:159], v[92:95], a[100:103], v[156:159]
ds_read_b64_tr_b16 v[90:91], v16 offset:23552
v_mfma_f32_16x16x32_bf16 v[128:131], v[96:99], a[104:107], v[128:131]
ds_read_b64_tr_b16 v[92:93], v17 offset:7168
v_mfma_f32_16x16x32_bf16 v[144:147], v[96:99], a[108:111], v[144:147]
ds_read_b64_tr_b16 v[94:95], v17 offset:23552
v_mfma_f32_16x16x32_bf16 v[132:135], v[100:103], a[104:107], v[132:135]
v_mfma_f32_16x16x32_bf16 v[148:151], v[100:103], a[108:111], v[148:151]
s_waitcnt vmcnt(3)
v_cmp_lt_u32 vcc, v51, v50
s_cbranch_vccnz pl_8_slow
pl_8_ok:
s_waitcnt lgkmcnt(5)
v_mfma_f32_16x16x32_bf16 v[136:139], v[104:107], a[104:107], v[136:139]
s_add_u32 s91, s6, 8192
buffer_load_dwordx4 a[160:163], v46, s[60:63], s91 offen offset:0 sc1
v_mfma_f32_16x16x32_bf16 v[152:155], v[104:107], a[108:111], v[152:155]
buffer_load_dwordx4 a[164:167], v46, s[60:63], s91 offen offset:1024 sc1
s_add_u32 s91, s6, 24576
v_mfma_f32_16x16x32_bf16 v[140:143], v[108:111], a[104:107], v[140:143]
s_waitcnt lgkmcnt(0)
s_barrier
ds_read_b64_tr_b16 v[96:97], v14 offset:32768
v_mfma_f32_16x16x32_bf16 v[156:159], v[108:111], a[108:111], v[156:159]
s_add_u32 m0, s76, 65536
s_add_u32 s77, s98, 0x20000
buffer_load_dwordx4 v38, s[48:51], s77 offen offset:0 lds
v_mfma_f32_16x16x32_bf16 v[128:131], v[112:115], a[112:115], v[128:131]
buffer_load_dwordx4 a[168:171], v46, s[60:63], s91 offen offset:0 sc1
buffer_load_dwordx4 a[172:175], v46, s[60:63], s91 offen offset:1024 sc1
v_mfma_f32_16x16x32_bf16 v[144:147], v[112:115], a[116:119], v[144:147]
s_add_u32 s91, s6, 36864
buffer_load_dwordx4 a[176:179], v46, s[60:63], s91 offen offset:0 sc1
v_mfma_f32_16x16x32_bf16 v[132:135], v[116:119], a[112:115], v[132:135]
buffer_load_dwordx4 a[180:183], v46, s[60:63], s91 offen offset:1024 sc1
s_add_u32 s91, s6, 53248
v_mfma_f32_16x16x32_bf16 v[148:151], v[116:119], a[116:119], v[148:151]
ds_read_b64_tr_b16 v[98:99], v14 offset:49152
buffer_load_dwordx4 a[184:187], v46, s[60:63], s91 offen offset:0 sc1
v_mfma_f32_16x16x32_bf16 v[136:139], v[120:123], a[112:115], v[136:139]
ds_read_b64_tr_b16 v[100:101], v15 offset:32768
buffer_load_dwordx4 v39, s[48:51], s77 offen offset:1024 lds
v_mfma_f32_16x16x32_bf16 v[152:155], v[120:123], a[116:119], v[152:155]
ds_read_b64_tr_b16 v[102:103], v15 offset:49152
buffer_load_dwordx4 a[188:191], v46, s[60:63], s91 offen offset:1024 sc1
v_mfma_f32_16x16x32_bf16 v[140:143], v[124:127], a[112:115], v[140:143]
ds_read_b64_tr_b16 v[104:105], v16 offset:32768
s_add_u32 s91, s6, 10240
ds_read_b64_tr_b16 v[106:107], v16 offset:49152
v_mfma_f32_16x16x32_bf16 v[156:159], v[124:127], a[116:119], v[156:159]
buffer_load_dwordx4 a[192:195], v46, s[60:63], s91 offen offset:0 sc1
ds_read_b64_tr_b16 v[108:109], v17 offset:32768
v_mfma_f32_16x16x32_bf16 v[128:131], v[80:83], a[120:123], v[128:131]
buffer_load_dwordx4 a[196:199], v46, s[60:63], s91 offen offset:1024 sc1
s_add_u32 s91, s6, 26624
v_mfma_f32_16x16x32_bf16 v[144:147], v[80:83], a[124:127], v[144:147]
ds_read_b64_tr_b16 v[110:111], v17 offset:49152
buffer_load_dwordx4 v40, s[48:51], s77 offen offset:2048 lds
v_mfma_f32_16x16x32_bf16 v[132:135], v[84:87], a[120:123], v[132:135]
ds_read_b64_tr_b16 v[112:113], v14 offset:33792
buffer_load_dwordx4 a[200:203], v46, s[60:63], s91 offen offset:0 sc1
v_mfma_f32_16x16x32_bf16 v[148:151], v[84:87], a[124:127], v[148:151]
ds_read_b64_tr_b16 v[114:115], v14 offset:50176
buffer_load_dwordx4 a[204:207], v46, s[60:63], s91 offen offset:1024 sc1
v_mfma_f32_16x16x32_bf16 v[136:139], v[88:91], a[120:123], v[136:139]
ds_read_b64_tr_b16 v[116:117], v15 offset:33792
s_add_u32 s91, s6, 38912
ds_read_b64_tr_b16 v[118:119], v15 offset:50176
v_mfma_f32_16x16x32_bf16 v[152:155], v[88:91], a[124:127], v[152:155]
buffer_load_dwordx4 a[208:211], v46, s[60:63], s91 offen offset:0 sc1
ds_read_b64_tr_b16 v[120:121], v16 offset:33792
v_mfma_f32_16x16x32_bf16 v[140:143], v[92:95], a[120:123], v[140:143]
buffer_load_dwordx4 v41, s[48:51], s77 offen offset:3072 lds
ds_read_b64_tr_b16 v[122:123], v16 offset:50176
v_mfma_f32_16x16x32_bf16 v[156:159], v[92:95], a[124:127], v[156:159]
buffer_load_dwordx4 a[212:215], v46, s[60:63], s91 offen offset:1024 sc1
s_waitcnt lgkmcnt(7)
v_mfma_f32_16x16x32_bf16 v[128:131], v[96:99], a[128:131], v[128:131]
ds_read_b64_tr_b16 v[124:125], v17 offset:33792
s_add_u32 s91, s6, 55296
ds_read_b64_tr_b16 v[126:127], v17 offset:50176
v_mfma_f32_16x16x32_bf16 v[144:147], v[96:99], a[132:135], v[144:147]
buffer_load_dwordx4 a[216:219], v46, s[60:63], s91 offen offset:0 sc1
ds_read_b64_tr_b16 v[80:81], v14 offset:34816
v_mfma_f32_16x16x32_bf16 v[132:135], v[100:103], a[128:131], v[132:135]
buffer_load_dwordx4 a[220:223], v46, s[60:63], s91 offen offset:1024 sc1
ds_read_b64_tr_b16 v[82:83], v14 offset:51200
v_mfma_f32_16x16x32_bf16 v[148:151], v[100:103], a[132:135], v[148:151]
s_add_u32 m0, s76, 69632
s_add_u32 s77, s98, 0x30000
ds_read_b64_tr_b16 v[84:85], v15 offset:34816
v_mfma_f32_16x16x32_bf16 v[136:139], v[104:107], a[128:131], v[136:139]
buffer_load_dwordx4 v38, s[48:51], s77 offen offset:0 lds
ds_read_b64_tr_b16 v[86:87], v15 offset:51200
v_mfma_f32_16x16x32_bf16 v[152:155], v[104:107], a[132:135], v[152:155]
s_lshl_b32 s78, s73, 4
s_add_u32 s78, s78, s16
s_lshl_b32 s78, s78, 10
s_add_u32 s78, s78, 32896
s_lshl_b32 s79, s72, 7
s_add_u32 s78, s78, s79
v_mov_b32 v53, s96
v_writelane_b32 v53, s78, 0
s_waitcnt lgkmcnt(6)
v_mfma_f32_16x16x32_bf16 v[140:143], v[108:111], a[128:131], v[140:143]
ds_read_b64_tr_b16 v[88:89], v16 offset:34816
s_lshl_b32 s78, s73, 4
s_add_u32 s78, s78, s17
s_lshl_b32 s78, s78, 10
s_add_u32 s78, s78, 32896
s_lshl_b32 s79, s72, 7
s_add_u32 s78, s78, s79
v_mov_b32 v54, s96
v_writelane_b32 v54, s78, 0
v_mfma_f32_16x16x32_bf16 v[156:159], v[108:111], a[132:135], v[156:159]
ds_read_b64_tr_b16 v[90:91], v16 offset:51200
ds_read_b64_tr_b16 v[92:93], v17 offset:34816
v_mfma_f32_16x16x32_bf16 v[128:131], v[112:115], a[136:139], v[128:131]
s_lshl_b32 s78, s73, 4
s_add_u32 s78, s78, s18
s_lshl_b32 s78, s78, 10
s_add_u32 s78, s78, 32896
s_lshl_b32 s79, s72, 7
s_add_u32 s78, s78, s79
v_mov_b32 v55, s96
v_writelane_b32 v55, s78, 0
v_mfma_f32_16x16x32_bf16 v[144:147], v[112:115], a[140:143], v[144:147]
ds_read_b64_tr_b16 v[94:95], v17 offset:51200
ds_read_b64_tr_b16 v[96:97], v14 offset:35840
v_mfma_f32_16x16x32_bf16 v[132:135], v[116:119], a[136:139], v[132:135]
buffer_load_dwordx4 v39, s[48:51], s77 offen offset:1024 lds
v_mfma_f32_16x16x32_bf16 v[148:151], v[116:119], a[140:143], v[148:151]
ds_read_b64_tr_b16 v[98:99], v14 offset:52224
ds_read_b64_tr_b16 v[100:101], v15 offset:35840
v_mfma_f32_16x16x32_bf16 v[136:139], v[120:123], a[136:139], v[136:139]
ds_read_b64_tr_b16 v[102:103], v15 offset:52224
v_mfma_f32_16x16x32_bf16 v[152:155], v[120:123], a[140:143], v[152:155]
ds_read_b64_tr_b16 v[104:105], v16 offset:35840
s_waitcnt lgkmcnt(8)
v_mfma_f32_16x16x32_bf16 v[140:143], v[124:127], a[136:139], v[140:143]
ds_read_b64_tr_b16 v[106:107], v16 offset:52224
ds_read_b64_tr_b16 v[108:109], v17 offset:35840
v_mfma_f32_16x16x32_bf16 v[156:159], v[124:127], a[140:143], v[156:159]
buffer_load_dwordx4 v40, s[48:51], s77 offen offset:2048 lds
v_mfma_f32_16x16x32_bf16 v[128:131], v[80:83], a[144:147], v[128:131]
ds_read_b64_tr_b16 v[110:111], v17 offset:52224
ds_read_b64_tr_b16 v[112:113], v14 offset:36864
v_mfma_f32_16x16x32_bf16 v[144:147], v[80:83], a[148:151], v[144:147]
ds_read_b64_tr_b16 v[114:115], v14 offset:53248
v_mfma_f32_16x16x32_bf16 v[132:135], v[84:87], a[144:147], v[132:135]
ds_read_b64_tr_b16 v[116:117], v15 offset:36864
ds_read_b64_tr_b16 v[118:119], v15 offset:53248
v_mfma_f32_16x16x32_bf16 v[148:151], v[84:87], a[148:151], v[148:151]
ds_read_b64_tr_b16 v[120:121], v16 offset:36864
s_waitcnt lgkmcnt(9)
v_mfma_f32_16x16x32_bf16 v[136:139], v[88:91], a[144:147], v[136:139]
buffer_load_dwordx4 v41, s[48:51], s77 offen offset:3072 lds
v_mfma_f32_16x16x32_bf16 v[152:155], v[88:91], a[148:151], v[152:155]
ds_read_b64_tr_b16 v[122:123], v16 offset:53248
ds_read_b64_tr_b16 v[124:125], v17 offset:36864
v_mfma_f32_16x16x32_bf16 v[140:143], v[92:95], a[144:147], v[140:143]
ds_read_b64_tr_b16 v[126:127], v17 offset:53248
v_mfma_f32_16x16x32_bf16 v[156:159], v[92:95], a[148:151], v[156:159]
ds_read_b64_tr_b16 v[80:81], v14 offset:37888
ds_read_b64_tr_b16 v[82:83], v14 offset:54272
v_mfma_f32_16x16x32_bf16 v[128:131], v[96:99], a[152:155], v[128:131]
ds_read_b64_tr_b16 v[84:85], v15 offset:37888
v_mfma_f32_16x16x32_bf16 v[144:147], v[96:99], a[156:159], v[144:147]
ds_read_b64_tr_b16 v[86:87], v15 offset:54272
ds_read_b64_tr_b16 v[88:89], v16 offset:37888
v_mfma_f32_16x16x32_bf16 v[132:135], v[100:103], a[152:155], v[132:135]
ds_read_b64_tr_b16 v[90:91], v16 offset:54272
v_mfma_f32_16x16x32_bf16 v[148:151], v[100:103], a[156:159], v[148:151]
ds_read_b64_tr_b16 v[92:93], v17 offset:37888
s_waitcnt lgkmcnt(10)
v_mfma_f32_16x16x32_bf16 v[136:139], v[104:107], a[152:155], v[136:139]
ds_read_b64_tr_b16 v[94:95], v17 offset:54272
ds_read_b64_tr_b16 v[96:97], v14 offset:38912
v_mfma_f32_16x16x32_bf16 v[152:155], v[104:107], a[156:159], v[152:155]
ds_read_b64_tr_b16 v[98:99], v14 offset:55296
v_mfma_f32_16x16x32_bf16 v[140:143], v[108:111], a[152:155], v[140:143]
ds_read_b64_tr_b16 v[100:101], v15 offset:38912
ds_read_b64_tr_b16 v[102:103], v15 offset:55296
v_mfma_f32_16x16x32_bf16 v[156:159], v[108:111], a[156:159], v[156:159]
ds_read_b64_tr_b16 v[104:105], v16 offset:38912
s_waitcnt vmcnt(23)
v_mfma_f32_16x16x32_bf16 v[128:131], v[112:115], a[160:163], v[128:131]
ds_read_b64_tr_b16 v[106:107], v16 offset:55296
ds_read_b64_tr_b16 v[108:109], v17 offset:38912
s_waitcnt vmcnt(22)
v_mfma_f32_16x16x32_bf16 v[144:147], v[112:115], a[164:167], v[144:147]
ds_read_b64_tr_b16 v[110:111], v17 offset:55296
v_mfma_f32_16x16x32_bf16 v[132:135], v[116:119], a[160:163], v[132:135]
ds_read_b64_tr_b16 v[112:113], v14 offset:39936
v_mfma_f32_16x16x32_bf16 v[148:151], v[116:119], a[164:167], v[148:151]
ds_read_b64_tr_b16 v[114:115], v14 offset:56320
s_waitcnt lgkmcnt(9)
v_mfma_f32_16x16x32_bf16 v[136:139], v[120:123], a[160:163], v[136:139]
ds_read_b64_tr_b16 v[116:117], v15 offset:39936
v_mfma_f32_16x16x32_bf16 v[152:155], v[120:123], a[164:167], v[152:155]
ds_read_b64_tr_b16 v[118:119], v15 offset:56320
v_mfma_f32_16x16x32_bf16 v[140:143], v[124:127], a[160:163], v[140:143]
ds_read_b64_tr_b16 v[120:121], v16 offset:39936
v_mfma_f32_16x16x32_bf16 v[156:159], v[124:127], a[164:167], v[156:159]
ds_read_b64_tr_b16 v[122:123], v16 offset:56320
s_waitcnt vmcnt(20)
v_mfma_f32_16x16x32_bf16 v[128:131], v[80:83], a[168:171], v[128:131]
ds_read_b64_tr_b16 v[124:125], v17 offset:39936
s_waitcnt vmcnt(19)
v_mfma_f32_16x16x32_bf16 v[144:147], v[80:83], a[172:175], v[144:147]
ds_read_b64_tr_b16 v[126:127], v17 offset:56320
v_mfma_f32_16x16x32_bf16 v[132:135], v[84:87], a[168:171], v[132:135]
v_mfma_f32_16x16x32_bf16 v[148:151], v[84:87], a[172:175], v[148:151]
v_mfma_f32_16x16x32_bf16 v[136:139], v[88:91], a[168:171], v[136:139]
v_mfma_f32_16x16x32_bf16 v[152:155], v[88:91], a[172:175], v[152:155]
v_mfma_f32_16x16x32_bf16 v[140:143], v[92:95], a[168:171], v[140:143]
s_waitcnt lgkmcnt(0)
s_barrier
v_mfma_f32_16x16x32_bf16 v[156:159], v[92:95], a[172:175], v[156:159]
s_add_u32 m0, s76, 98304
s_waitcnt vmcnt(18)
v_mfma_f32_16x16x32_bf16 v[128:131], v[96:99], a[176:179], v[128:131]
s_add_u32 s77, s98, 0x0
ds_read_b64_tr_b16 v[80:81], v10 offset:0
s_waitcnt vmcnt(17)
v_mfma_f32_16x16x32_bf16 v[144:147], v[96:99], a[180:183], v[144:147]
buffer_load_dwordx4 v42, s[48:51], s77 offen offset:0 lds
v_mfma_f32_16x16x32_bf16 v[132:135], v[100:103], a[176:179], v[132:135]
ds_read_b64_tr_b16 v[82:83], v10 offset:16384
ds_read_b64_tr_b16 v[84:85], v11 offset:0
v_mfma_f32_16x16x32_bf16 v[148:151], v[100:103], a[180:183], v[148:151]
ds_read_b64_tr_b16 v[86:87], v11 offset:16384
v_mfma_f32_16x16x32_bf16 v[136:139], v[104:107], a[176:179], v[136:139]
ds_read_b64_tr_b16 v[88:89], v12 offset:0
ds_read_b64_tr_b16 v[90:91], v12 offset:16384
v_mfma_f32_16x16x32_bf16 v[152:155], v[104:107], a[180:183], v[152:155]
ds_read_b64_tr_b16 v[92:93], v13 offset:0
v_mfma_f32_16x16x32_bf16 v[140:143], v[108:111], a[176:179], v[140:143]
buffer_load_dwordx4 v43, s[48:51], s77 offen offset:1024 lds
v_mfma_f32_16x16x32_bf16 v[156:159], v[108:111], a[180:183], v[156:159]
ds_read_b64_tr_b16 v[94:95], v13 offset:16384
s_waitcnt vmcnt(18)
v_mfma_f32_16x16x32_bf16 v[128:131], v[112:115], a[184:187], v[128:131]
ds_read_b64_tr_b16 v[96:97], v10 offset:1024
ds_read_b64_tr_b16 v[98:99], v10 offset:17408
s_waitcnt vmcnt(16)
v_mfma_f32_16x16x32_bf16 v[144:147], v[112:115], a[188:191], v[144:147]
ds_read_b64_tr_b16 v[100:101], v11 offset:1024
v_mfma_f32_16x16x32_bf16 v[132:135], v[116:119], a[184:187], v[132:135]
ds_read_b64_tr_b16 v[102:103], v11 offset:17408
ds_read_b64_tr_b16 v[104:105], v12 offset:1024
v_mfma_f32_16x16x32_bf16 v[148:151], v[116:119], a[188:191], v[148:151]
buffer_load_dwordx4 v44, s[48:51], s77 offen offset:2048 lds
v_mfma_f32_16x16x32_bf16 v[136:139], v[120:123], a[184:187], v[136:139]
ds_read_b64_tr_b16 v[106:107], v12 offset:17408
ds_read_b64_tr_b16 v[108:109], v13 offset:1024
v_mfma_f32_16x16x32_bf16 v[152:155], v[120:123], a[188:191], v[152:155]
ds_read_b64_tr_b16 v[110:111], v13 offset:17408
v_mfma_f32_16x16x32_bf16 v[140:143], v[124:127], a[184:187], v[140:143]
ds_read_b64_tr_b16 v[112:113], v10 offset:2048
ds_read_b64_tr_b16 v[114:115], v10 offset:18432
v_mfma_f32_16x16x32_bf16 v[156:159], v[124:127], a[188:191], v[156:159]
ds_read_b64_tr_b16 v[116:117], v11 offset:2048
s_waitcnt vmcnt(16) lgkmcnt(9)
v_mfma_f32_16x16x32_bf16 v[128:131], v[80:83], a[192:195], v[128:131]
buffer_load_dwordx4 v45, s[48:51], s77 offen offset:3072 lds
s_waitcnt vmcnt(16)
v_mfma_f32_16x16x32_bf16 v[144:147], v[80:83], a[196:199], v[144:147]
ds_read_b64_tr_b16 v[118:119], v11 offset:18432
ds_read_b64_tr_b16 v[120:121], v12 offset:2048
v_mfma_f32_16x16x32_bf16 v[132:135], v[84:87], a[192:195], v[132:135]
ds_read_b64_tr_b16 v[122:123], v12 offset:18432
v_mfma_f32_16x16x32_bf16 v[148:151], v[84:87], a[196:199], v[148:151]
ds_read_b64_tr_b16 v[124:125], v13 offset:2048
ds_read_b64_tr_b16 v[126:127], v13 offset:18432
v_mfma_f32_16x16x32_bf16 v[136:139], v[88:91], a[192:195], v[136:139]
ds_read_b64_tr_b16 v[80:81], v10 offset:3072
v_mfma_f32_16x16x32_bf16 v[152:155], v[88:91], a[196:199], v[152:155]
s_add_u32 m0, s76, 102400
s_add_u32 s77, s98, 0x40000
v_mfma_f32_16x16x32_bf16 v[140:143], v[92:95], a[192:195], v[140:143]
buffer_load_dwordx4 v38, s[48:51], s77 offen offset:0 lds
v_mfma_f32_16x16x32_bf16 v[156:159], v[92:95], a[196:199], v[156:159]
ds_read_b64_tr_b16 v[82:83], v10 offset:19456
s_waitcnt vmcnt(15)
v_mfma_f32_16x16x32_bf16 v[128:131], v[96:99], a[200:203], v[128:131]
ds_read_b64_tr_b16 v[84:85], v11 offset:3072
ds_read_b64_tr_b16 v[86:87], v11 offset:19456
s_waitcnt vmcnt(14)
v_mfma_f32_16x16x32_bf16 v[144:147], v[96:99], a[204:207], v[144:147]
ds_read_b64_tr_b16 v[88:89], v12 offset:3072
s_waitcnt lgkmcnt(7)
v_mfma_f32_16x16x32_bf16 v[132:135], v[100:103], a[200:203], v[132:135]
ds_read_b64_tr_b16 v[90:91], v12 offset:19456
ds_read_b64_tr_b16 v[92:93], v13 offset:3072
v_mfma_f32_16x16x32_bf16 v[148:151], v[100:103], a[204:207], v[148:151]
buffer_load_dwordx4 v39, s[48:51], s77 offen offset:1024 lds
v_mfma_f32_16x16x32_bf16 v[136:139], v[104:107], a[200:203], v[136:139]
ds_read_b64_tr_b16 v[94:95], v13 offset:19456
v_mfma_f32_16x16x32_bf16 v[152:155], v[104:107], a[204:207], v[152:155]
buffer_load_dwordx4 v40, s[48:51], s77 offen offset:2048 lds
v_mfma_f32_16x16x32_bf16 v[140:143], v[108:111], a[200:203], v[140:143]
buffer_load_dwordx4 v41, s[48:51], s77 offen offset:3072 lds
v_mfma_f32_16x16x32_bf16 v[156:159], v[108:111], a[204:207], v[156:159]
s_waitcnt vmcnt(16)
v_mfma_f32_16x16x32_bf16 v[128:131], v[112:115], a[208:211], v[128:131]
s_waitcnt vmcnt(14)
v_mfma_f32_16x16x32_bf16 v[144:147], v[112:115], a[212:215], v[144:147]
s_waitcnt lgkmcnt(0)
s_barrier
v_mfma_f32_16x16x32_bf16 v[132:135], v[116:119], a[208:211], v[132:135]
ds_read_b64_tr_b16 v[96:97], v10 offset:32768
s_add_u32 m0, s76, 0
v_mfma_f32_16x16x32_bf16 v[148:151], v[116:119], a[212:215], v[148:151]
ds_read_b64_tr_b16 v[98:99], v10 offset:49152
s_add_u32 s77, s98, 0x50000
v_mfma_f32_16x16x32_bf16 v[136:139], v[120:123], a[208:211], v[136:139]
ds_read_b64_tr_b16 v[100:101], v11 offset:32768
ds_read_b64_tr_b16 v[102:103], v11 offset:49152
v_mfma_f32_16x16x32_bf16 v[152:155], v[120:123], a[212:215], v[152:155]
buffer_load_dwordx4 v38, s[48:51], s77 offen offset:0 lds
v_mfma_f32_16x16x32_bf16 v[140:143], v[124:127], a[208:211], v[140:143]
ds_read_b64_tr_b16 v[104:105], v12 offset:32768
ds_read_b64_tr_b16 v[106:107], v12 offset:49152
v_mfma_f32_16x16x32_bf16 v[156:159], v[124:127], a[212:215], v[156:159]
ds_read_b64_tr_b16 v[108:109], v13 offset:32768
s_waitcnt vmcnt(14)
v_mfma_f32_16x16x32_bf16 v[128:131], v[80:83], a[216:219], v[128:131]
ds_read_b64_tr_b16 v[110:111], v13 offset:49152
ds_read_b64_tr_b16 v[112:113], v10 offset:33792
s_waitcnt vmcnt(13)
v_mfma_f32_16x16x32_bf16 v[144:147], v[80:83], a[220:223], v[144:147]
ds_read_b64_tr_b16 v[114:115], v10 offset:50176
v_mfma_f32_16x16x32_bf16 v[132:135], v[84:87], a[216:219], v[132:135]
buffer_load_dwordx4 v39, s[48:51], s77 offen offset:1024 lds
v_mfma_f32_16x16x32_bf16 v[148:151], v[84:87], a[220:223], v[148:151]
ds_read_b64_tr_b16 v[116:117], v11 offset:33792
ds_read_b64_tr_b16 v[118:119], v11 offset:50176
v_mfma_f32_16x16x32_bf16 v[136:139], v[88:91], a[216:219], v[136:139]
ds_read_b64_tr_b16 v[120:121], v12 offset:33792
v_mfma_f32_16x16x32_bf16 v[152:155], v[88:91], a[220:223], v[152:155]
ds_read_b64_tr_b16 v[122:123], v12 offset:50176
ds_read_b64_tr_b16 v[124:125], v13 offset:33792
v_mfma_f32_16x16x32_bf16 v[140:143], v[92:95], a[216:219], v[140:143]
ds_read_b64_tr_b16 v[126:127], v13 offset:50176
v_mfma_f32_16x16x32_bf16 v[156:159], v[92:95], a[220:223], v[156:159]
buffer_load_dwordx4 v40, s[48:51], s77 offen offset:2048 lds
S_D1:
s_waitcnt lgkmcnt(7)
v_mfma_f32_16x16x32_bf16 v[160:163], v[96:99], a[0:3], 0
ds_read_b64_tr_b16 v[80:81], v10 offset:34816
ds_read_b64_tr_b16 v[82:83], v10 offset:51200
v_mfma_f32_16x16x32_bf16 v[176:179], v[96:99], a[4:7], 0
ds_read_b64_tr_b16 v[84:85], v11 offset:34816
v_mfma_f32_16x16x32_bf16 v[164:167], v[100:103], a[0:3], 0
ds_read_b64_tr_b16 v[86:87], v11 offset:51200
ds_read_b64_tr_b16 v[88:89], v12 offset:34816
v_mfma_f32_16x16x32_bf16 v[180:183], v[100:103], a[4:7], 0
s_add_u32 s70, s0, S_D2 - K_pc + 0
s_addc_u32 s71, s1, 0
global_load_dword v57, v9, s[70:71]
v_mfma_f32_16x16x32_bf16 v[168:171], v[104:107], a[0:3], 0
buffer_load_dwordx4 v41, s[48:51], s77 offen offset:3072 lds
v_mfma_f32_16x16x32_bf16 v[184:187], v[104:107], a[4:7], 0
v_cvt_pk_bf16_f32 v128, v128, v129
v_cvt_pk_bf16_f32 v129, v130, v131
v_mfma_f32_16x16x32_bf16 v[172:175], v[108:111], a[0:3], 0
v_cvt_pk_bf16_f32 v130, v132, v133
v_cvt_pk_bf16_f32 v131, v134, v135
v_mfma_f32_16x16x32_bf16 v[188:191], v[108:111], a[4:7], 0
ds_read_b64_tr_b16 v[90:91], v12 offset:51200
s_waitcnt lgkmcnt(4)
v_mfma_f32_16x16x32_bf16 v[160:163], v[112:115], a[8:11], v[160:163]
ds_read_b64_tr_b16 v[92:93], v13 offset:34816
ds_read_b64_tr_b16 v[94:95], v13 offset:51200
v_mfma_f32_16x16x32_bf16 v[176:179], v[112:115], a[12:15], v[176:179]
buffer_store_dwordx4 v[128:131], v46, s[60:63], s8 offen offset:0 sc1
v_mfma_f32_16x16x32_bf16 v[164:167], v[116:119], a[8:11], v[164:167]
ds_read_b64_tr_b16 v[96:97], v10 offset:35840
v_cvt_pk_bf16_f32 v136, v136, v137
v_mfma_f32_16x16x32_bf16 v[180:183], v[116:119], a[12:15], v[180:183]
ds_read_b64_tr_b16 v[98:99], v10 offset:52224
v_cvt_pk_bf16_f32 v137, v138, v139
v_mfma_f32_16x16x32_bf16 v[168:171], v[120:123], a[8:11], v[168:171]
ds_read_b64_tr_b16 v[100:101], v11 offset:35840
v_cvt_pk_bf16_f32 v138, v140, v141
v_mfma_f32_16x16x32_bf16 v[184:187], v[120:123], a[12:15], v[184:187]
ds_read_b64_tr_b16 v[102:103], v11 offset:52224
v_cvt_pk_bf16_f32 v139, v142, v143
v_mfma_f32_16x16x32_bf16 v[172:175], v[124:127], a[8:11], v[172:175]
ds_read_b64_tr_b16 v[104:105], v12 offset:35840
ds_read_b64_tr_b16 v[106:107], v12 offset:52224
v_mfma_f32_16x16x32_bf16 v[188:191], v[124:127], a[12:15], v[188:191]
buffer_store_dwordx4 v[136:139], v46, s[60:63], s8 offen offset:1024 sc1
v_mfma_f32_16x16x32_bf16 v[160:163], v[80:83], a[16:19], v[160:163]
ds_read_b64_tr_b16 v[108:109], v13 offset:35840
v_cvt_pk_bf16_f32 v144, v144, v145
v_mfma_f32_16x16x32_bf16 v[176:179], v[80:83], a[20:23], v[176:179]
ds_read_b64_tr_b16 v[110:111], v13 offset:52224
s_waitcnt lgkmcnt(7)
v_mfma_f32_16x16x32_bf16 v[164:167], v[84:87], a[16:19], v[164:167]
ds_read_b64_tr_b16 v[112:113], v10 offset:36864
v_cvt_pk_bf16_f32 v145, v146, v147
v_mfma_f32_16x16x32_bf16 v[180:183], v[84:87], a[20:23], v[180:183]
ds_read_b64_tr_b16 v[114:115], v10 offset:53248
v_cvt_pk_bf16_f32 v146, v148, v149
v_mfma_f32_16x16x32_bf16 v[168:171], v[88:91], a[16:19], v[168:171]
ds_read_b64_tr_b16 v[116:117], v11 offset:36864
v_cvt_pk_bf16_f32 v147, v150, v151
v_mfma_f32_16x16x32_bf16 v[184:187], v[88:91], a[20:23], v[184:187]
ds_read_b64_tr_b16 v[118:119], v11 offset:53248
ds_read_b64_tr_b16 v[120:121], v12 offset:36864
v_mfma_f32_16x16x32_bf16 v[172:175], v[92:95], a[16:19], v[172:175]
buffer_store_dwordx4 v[144:147], v46, s[60:63], s8 offen offset:2048 sc1
v_mfma_f32_16x16x32_bf16 v[188:191], v[92:95], a[20:23], v[188:191]
ds_read_b64_tr_b16 v[122:123], v12 offset:53248
s_waitcnt lgkmcnt(7)
v_mfma_f32_16x16x32_bf16 v[160:163], v[96:99], a[24:27], v[160:163]
ds_read_b64_tr_b16 v[124:125], v13 offset:36864
v_cvt_pk_bf16_f32 v152, v152, v153
v_mfma_f32_16x16x32_bf16 v[176:179], v[96:99], a[28:31], v[176:179]
ds_read_b64_tr_b16 v[126:127], v13 offset:53248
v_cvt_pk_bf16_f32 v153, v154, v155
v_mfma_f32_16x16x32_bf16 v[164:167], v[100:103], a[24:27], v[164:167]
ds_read_b64_tr_b16 v[80:81], v10 offset:37888
v_cvt_pk_bf16_f32 v154, v156, v157
v_mfma_f32_16x16x32_bf16 v[180:183], v[100:103], a[28:31], v[180:183]
ds_read_b64_tr_b16 v[82:83], v10 offset:54272
v_cvt_pk_bf16_f32 v155, v158, v159
v_mfma_f32_16x16x32_bf16 v[168:171], v[104:107], a[24:27], v[168:171]
ds_read_b64_tr_b16 v[84:85], v11 offset:37888
ds_read_b64_tr_b16 v[86:87], v11 offset:54272
v_mfma_f32_16x16x32_bf16 v[184:187], v[104:107], a[28:31], v[184:187]
ds_read_b64_tr_b16 v[88:89], v12 offset:37888
s_waitcnt lgkmcnt(8)
v_mfma_f32_16x16x32_bf16 v[172:175], v[108:111], a[24:27], v[172:175]
buffer_store_dwordx4 v[152:155], v46, s[60:63], s8 offen offset:3072 sc1
v_mfma_f32_16x16x32_bf16 v[188:191], v[108:111], a[28:31], v[188:191]
ds_read_b64_tr_b16 v[90:91], v12 offset:54272
ds_read_b64_tr_b16 v[92:93], v13 offset:37888
v_mfma_f32_16x16x32_bf16 v[160:163], v[112:115], a[32:35], v[160:163]
ds_read_b64_tr_b16 v[94:95], v13 offset:54272
v_mfma_f32_16x16x32_bf16 v[176:179], v[112:115], a[36:39], v[176:179]
ds_read_b64_tr_b16 v[96:97], v10 offset:38912
ds_read_b64_tr_b16 v[98:99], v10 offset:55296
v_mfma_f32_16x16x32_bf16 v[164:167], v[116:119], a[32:35], v[164:167]
ds_read_b64_tr_b16 v[100:101], v11 offset:38912
v_mfma_f32_16x16x32_bf16 v[180:183], v[116:119], a[36:39], v[180:183]
ds_read_b64_tr_b16 v[102:103], v11 offset:55296
s_waitcnt lgkmcnt(8)
v_mfma_f32_16x16x32_bf16 v[168:171], v[120:123], a[32:35], v[168:171]
ds_read_b64_tr_b16 v[104:105], v12 offset:38912
ds_read_b64_tr_b16 v[106:107], v12 offset:55296
v_mfma_f32_16x16x32_bf16 v[184:187], v[120:123], a[36:39], v[184:187]
ds_read_b64_tr_b16 v[108:109], v13 offset:38912
v_mfma_f32_16x16x32_bf16 v[172:175], v[124:127], a[32:35], v[172:175]
ds_read_b64_tr_b16 v[110:111], v13 offset:55296
ds_read_b64_tr_b16 v[112:113], v10 offset:39936
v_mfma_f32_16x16x32_bf16 v[188:191], v[124:127], a[36:39], v[188:191]
ds_read_b64_tr_b16 v[114:115], v10 offset:56320
v_mfma_f32_16x16x32_bf16 v[160:163], v[80:83], a[40:43], v[160:163]
ds_read_b64_tr_b16 v[116:117], v11 offset:39936
ds_read_b64_tr_b16 v[118:119], v11 offset:56320
v_mfma_f32_16x16x32_bf16 v[176:179], v[80:83], a[44:47], v[176:179]
ds_read_b64_tr_b16 v[120:121], v12 offset:39936
v_mfma_f32_16x16x32_bf16 v[164:167], v[84:87], a[40:43], v[164:167]
ds_read_b64_tr_b16 v[122:123], v12 offset:56320
ds_read_b64_tr_b16 v[124:125], v13 offset:39936
v_mfma_f32_16x16x32_bf16 v[180:183], v[84:87], a[44:47], v[180:183]
ds_read_b64_tr_b16 v[126:127], v13 offset:56320
s_waitcnt lgkmcnt(10)
v_mfma_f32_16x16x32_bf16 v[168:171], v[88:91], a[40:43], v[168:171]
v_mfma_f32_16x16x32_bf16 v[184:187], v[88:91], a[44:47], v[184:187]
v_mfma_f32_16x16x32_bf16 v[172:175], v[92:95], a[40:43], v[172:175]
v_mfma_f32_16x16x32_bf16 v[188:191], v[92:95], a[44:47], v[188:191]
v_mfma_f32_16x16x32_bf16 v[160:163], v[96:99], a[48:51], v[160:163]
s_waitcnt vmcnt(17) lgkmcnt(0)
s_barrier
v_mfma_f32_16x16x32_bf16 v[176:179], v[96:99], a[52:55], v[176:179]
s_add_u32 m0, s76, 32768
s_add_u32 s77, s99, 0x0
v_mfma_f32_16x16x32_bf16 v[164:167], v[100:103], a[48:51], v[164:167]
ds_read_b64_tr_b16 v[80:81], v14 offset:0
ds_read_b64_tr_b16 v[82:83], v14 offset:16384
v_mfma_f32_16x16x32_bf16 v[180:183], v[100:103], a[52:55], v[180:183]
buffer_load_dwordx4 v38, s[48:51], s77 offen offset:0 lds
v_mfma_f32_16x16x32_bf16 v[168:171], v[104:107], a[48:51], v[168:171]
ds_read_b64_tr_b16 v[84:85], v15 offset:0
ds_read_b64_tr_b16 v[86:87], v15 offset:16384
v_mfma_f32_16x16x32_bf16 v[184:187], v[104:107], a[52:55], v[184:187]
ds_read_b64_tr_b16 v[88:89], v16 offset:0
v_mfma_f32_16x16x32_bf16 v[172:175], v[108:111], a[48:51], v[172:175]
ds_read_b64_tr_b16 v[90:91], v16 offset:16384
ds_read_b64_tr_b16 v[92:93], v17 offset:0
v_mfma_f32_16x16x32_bf16 v[188:191], v[108:111], a[52:55], v[188:191]
ds_read_b64_tr_b16 v[94:95], v17 offset:16384
v_mfma_f32_16x16x32_bf16 v[160:163], v[112:115], a[56:59], v[160:163]
buffer_load_dwordx4 v39, s[48:51], s77 offen offset:1024 lds
v_mfma_f32_16x16x32_bf16 v[176:179], v[112:115], a[60:63], v[176:179]
ds_read_b64_tr_b16 v[96:97], v14 offset:1024
ds_read_b64_tr_b16 v[98:99], v14 offset:17408
v_mfma_f32_16x16x32_bf16 v[164:167], v[116:119], a[56:59], v[164:167]
ds_read_b64_tr_b16 v[100:101], v15 offset:1024
v_mfma_f32_16x16x32_bf16 v[180:183], v[116:119], a[60:63], v[180:183]
ds_read_b64_tr_b16 v[102:103], v15 offset:17408
ds_read_b64_tr_b16 v[104:105], v16 offset:1024
v_mfma_f32_16x16x32_bf16 v[168:171], v[120:123], a[56:59], v[168:171]
ds_read_b64_tr_b16 v[106:107], v16 offset:17408
v_mfma_f32_16x16x32_bf16 v[184:187], v[120:123], a[60:63], v[184:187]
buffer_load_dwordx4 v40, s[48:51], s77 offen offset:2048 lds
v_mfma_f32_16x16x32_bf16 v[172:175], v[124:127], a[56:59], v[172:175]
ds_read_b64_tr_b16 v[108:109], v17 offset:1024
ds_read_b64_tr_b16 v[110:111], v17 offset:17408
v_mfma_f32_16x16x32_bf16 v[188:191], v[124:127], a[60:63], v[188:191]
ds_read_b64_tr_b16 v[112:113], v14 offset:2048
s_waitcnt lgkmcnt(9)
v_mfma_f32_16x16x32_bf16 v[160:163], v[80:83], a[64:67], v[160:163]
ds_read_b64_tr_b16 v[114:115], v14 offset:18432
ds_read_b64_tr_b16 v[116:117], v15 offset:2048
v_mfma_f32_16x16x32_bf16 v[176:179], v[80:83], a[68:71], v[176:179]
ds_read_b64_tr_b16 v[118:119], v15 offset:18432
v_mfma_f32_16x16x32_bf16 v[164:167], v[84:87], a[64:67], v[164:167]
buffer_load_dwordx4 v41, s[48:51], s77 offen offset:3072 lds
v_mfma_f32_16x16x32_bf16 v[180:183], v[84:87], a[68:71], v[180:183]
ds_read_b64_tr_b16 v[120:121], v16 offset:2048
ds_read_b64_tr_b16 v[122:123], v16 offset:18432
v_mfma_f32_16x16x32_bf16 v[168:171], v[88:91], a[64:67], v[168:171]
ds_read_b64_tr_b16 v[124:125], v17 offset:2048
v_mfma_f32_16x16x32_bf16 v[184:187], v[88:91], a[68:71], v[184:187]
ds_read_b64_tr_b16 v[126:127], v17 offset:18432
ds_read_b64_tr_b16 v[80:81], v14 offset:3072
v_mfma_f32_16x16x32_bf16 v[172:175], v[92:95], a[64:67], v[172:175]
ds_read_b64_tr_b16 v[82:83], v14 offset:19456
v_mfma_f32_16x16x32_bf16 v[188:191], v[92:95], a[68:71], v[188:191]
s_add_u32 m0, s76, 36864
s_waitcnt lgkmcnt(7)
v_mfma_f32_16x16x32_bf16 v[160:163], v[96:99], a[72:75], v[160:163]
s_add_u32 s77, s99, 0x10000
ds_read_b64_tr_b16 v[84:85], v15 offset:3072
v_mfma_f32_16x16x32_bf16 v[176:179], v[96:99], a[76:79], v[176:179]
buffer_load_dwordx4 v38, s[48:51], s77 offen offset:0 lds
v_mfma_f32_16x16x32_bf16 v[164:167], v[100:103], a[72:75], v[164:167]
ds_read_b64_tr_b16 v[86:87], v15 offset:19456
ds_read_b64_tr_b16 v[88:89], v16 offset:3072
v_mfma_f32_16x16x32_bf16 v[180:183], v[100:103], a[76:79], v[180:183]
ds_read_b64_tr_b16 v[90:91], v16 offset:19456
v_mfma_f32_16x16x32_bf16 v[168:171], v[104:107], a[72:75], v[168:171]
ds_read_b64_tr_b16 v[92:93], v17 offset:3072
ds_read_b64_tr_b16 v[94:95], v17 offset:19456
v_mfma_f32_16x16x32_bf16 v[184:187], v[104:107], a[76:79], v[184:187]
ds_read_b64_tr_b16 v[96:97], v14 offset:4096
v_mfma_f32_16x16x32_bf16 v[172:175], v[108:111], a[72:75], v[172:175]
buffer_load_dwordx4 v39, s[48:51], s77 offen offset:1024 lds
v_mfma_f32_16x16x32_bf16 v[188:191], v[108:111], a[76:79], v[188:191]
ds_read_b64_tr_b16 v[98:99], v14 offset:20480
ds_read_b64_tr_b16 v[100:101], v15 offset:4096
v_mfma_f32_16x16x32_bf16 v[160:163], v[112:115], a[80:83], v[160:163]
ds_read_b64_tr_b16 v[102:103], v15 offset:20480
v_mfma_f32_16x16x32_bf16 v[176:179], v[112:115], a[84:87], v[176:179]
ds_read_b64_tr_b16 v[104:105], v16 offset:4096
s_waitcnt lgkmcnt(8)
v_mfma_f32_16x16x32_bf16 v[164:167], v[116:119], a[80:83], v[164:167]
ds_read_b64_tr_b16 v[106:107], v16 offset:20480
ds_read_b64_tr_b16 v[108:109], v17 offset:4096
v_mfma_f32_16x16x32_bf16 v[180:183], v[116:119], a[84:87], v[180:183]
buffer_load_dwordx4 v40, s[48:51], s77 offen offset:2048 lds
v_mfma_f32_16x16x32_bf16 v[168:171], v[120:123], a[80:83], v[168:171]
ds_read_b64_tr_b16 v[110:111], v17 offset:20480
ds_read_b64_tr_b16 v[112:113], v14 offset:5120
v_mfma_f32_16x16x32_bf16 v[184:187], v[120:123], a[84:87], v[184:187]
ds_read_b64_tr_b16 v[114:115], v14 offset:21504
v_mfma_f32_16x16x32_bf16 v[172:175], v[124:127], a[80:83], v[172:175]
ds_read_b64_tr_b16 v[116:117], v15 offset:5120
ds_read_b64_tr_b16 v[118:119], v15 offset:21504
v_mfma_f32_16x16x32_bf16 v[188:191], v[124:127], a[84:87], v[188:191]
ds_read_b64_tr_b16 v[120:121], v16 offset:5120
v_mfma_f32_16x16x32_bf16 v[160:163], v[80:83], a[88:91], v[160:163]
buffer_load_dwordx4 v41, s[48:51], s77 offen offset:3072 lds
v_mfma_f32_16x16x32_bf16 v[176:179], v[80:83], a[92:95], v[176:179]
ds_read_b64_tr_b16 v[122:123], v16 offset:21504
ds_read_b64_tr_b16 v[124:125], v17 offset:5120
v_mfma_f32_16x16x32_bf16 v[164:167], v[84:87], a[88:91], v[164:167]
ds_read_b64_tr_b16 v[126:127], v17 offset:21504
v_mfma_f32_16x16x32_bf16 v[180:183], v[84:87], a[92:95], v[180:183]
s_waitcnt vmcnt(8)
s_waitcnt lgkmcnt(7)
v_mfma_f32_16x16x32_bf16 v[168:171], v[88:91], a[88:91], v[168:171]
buffer_atomic_add v52, v53, s[60:63], 0 offen sc1
v_mfma_f32_16x16x32_bf16 v[184:187], v[88:91], a[92:95], v[184:187]
ds_read_b64_tr_b16 v[80:81], v14 offset:6144
ds_read_b64_tr_b16 v[82:83], v14 offset:22528
v_mfma_f32_16x16x32_bf16 v[172:175], v[92:95], a[88:91], v[172:175]
ds_read_b64_tr_b16 v[84:85], v15 offset:6144
v_mfma_f32_16x16x32_bf16 v[188:191], v[92:95], a[92:95], v[188:191]
ds_read_b64_tr_b16 v[86:87], v15 offset:22528
ds_read_b64_tr_b16 v[88:89], v16 offset:6144
v_mfma_f32_16x16x32_bf16 v[160:163], v[96:99], a[96:99], v[160:163]
ds_read_b64_tr_b16 v[90:91], v16 offset:22528
v_mfma_f32_16x16x32_bf16 v[176:179], v[96:99], a[100:103], v[176:179]
ds_read_b64_tr_b16 v[92:93], v17 offset:6144
ds_read_b64_tr_b16 v[94:95], v17 offset:22528
v_mfma_f32_16x16x32_bf16 v[164:167], v[100:103], a[96:99], v[164:167]
ds_read_b64_tr_b16 v[96:97], v14 offset:7168
v_mfma_f32_16x16x32_bf16 v[180:183], v[100:103], a[100:103], v[180:183]
ds_read_b64_tr_b16 v[98:99], v14 offset:23552
v_mfma_f32_16x16x32_bf16 v[168:171], v[104:107], a[96:99], v[168:171]
ds_read_b64_tr_b16 v[100:101], v15 offset:7168
v_mfma_f32_16x16x32_bf16 v[184:187], v[104:107], a[100:103], v[184:187]
ds_read_b64_tr_b16 v[102:103], v15 offset:23552
v_mfma_f32_16x16x32_bf16 v[172:175], v[108:111], a[96:99], v[172:175]
ds_read_b64_tr_b16 v[104:105], v16 offset:7168
v_mfma_f32_16x16x32_bf16 v[188:191], v[108:111], a[100:103], v[188:191]
ds_read_b64_tr_b16 v[106:107], v16 offset:23552
s_waitcnt lgkmcnt(8)
v_mfma_f32_16x16x32_bf16 v[160:163], v[112:115], a[104:107], v[160:163]
ds_read_b64_tr_b16 v[108:109], v17 offset:7168
v_mfma_f32_16x16x32_bf16 v[176:179], v[112:115], a[108:111], v[176:179]
ds_read_b64_tr_b16 v[110:111], v17 offset:23552
v_mfma_f32_16x16x32_bf16 v[164:167], v[116:119], a[104:107], v[164:167]
v_mfma_f32_16x16x32_bf16 v[180:183], v[116:119], a[108:111], v[180:183]
v_mfma_f32_16x16x32_bf16 v[168:171], v[120:123], a[104:107], v[168:171]
v_mfma_f32_16x16x32_bf16 v[184:187], v[120:123], a[108:111], v[184:187]
v_mfma_f32_16x16x32_bf16 v[172:175], v[124:127], a[104:107], v[172:175]
s_waitcnt lgkmcnt(0)
s_barrier
v_mfma_f32_16x16x32_bf16 v[188:191], v[124:127], a[108:111], v[188:191]
s_add_u32 m0, s76, 65536
s_add_u32 s77, s99, 0x20000
v_mfma_f32_16x16x32_bf16 v[160:163], v[80:83], a[112:115], v[160:163]
buffer_load_dwordx4 v38, s[48:51], s77 offen offset:0 lds
v_mfma_f32_16x16x32_bf16 v[176:179], v[80:83], a[116:119], v[176:179]
ds_read_b64_tr_b16 v[112:113], v14 offset:32768
ds_read_b64_tr_b16 v[114:115], v14 offset:49152
v_mfma_f32_16x16x32_bf16 v[164:167], v[84:87], a[112:115], v[164:167]
ds_read_b64_tr_b16 v[116:117], v15 offset:32768
v_mfma_f32_16x16x32_bf16 v[180:183], v[84:87], a[116:119], v[180:183]
ds_read_b64_tr_b16 v[118:119], v15 offset:49152
ds_read_b64_tr_b16 v[120:121], v16 offset:32768
v_mfma_f32_16x16x32_bf16 v[168:171], v[88:91], a[112:115], v[168:171]
ds_read_b64_tr_b16 v[122:123], v16 offset:49152
v_mfma_f32_16x16x32_bf16 v[184:187], v[88:91], a[116:119], v[184:187]
buffer_load_dwordx4 v39, s[48:51], s77 offen offset:1024 lds
v_mfma_f32_16x16x32_bf16 v[172:175], v[92:95], a[112:115], v[172:175]
ds_read_b64_tr_b16 v[124:125], v17 offset:32768
ds_read_b64_tr_b16 v[126:127], v17 offset:49152
v_mfma_f32_16x16x32_bf16 v[188:191], v[92:95], a[116:119], v[188:191]
ds_read_b64_tr_b16 v[80:81], v14 offset:33792
v_mfma_f32_16x16x32_bf16 v[160:163], v[96:99], a[120:123], v[160:163]
ds_read_b64_tr_b16 v[82:83], v14 offset:50176
ds_read_b64_tr_b16 v[84:85], v15 offset:33792
v_mfma_f32_16x16x32_bf16 v[176:179], v[96:99], a[124:127], v[176:179]
ds_read_b64_tr_b16 v[86:87], v15 offset:50176
v_mfma_f32_16x16x32_bf16 v[164:167], v[100:103], a[120:123], v[164:167]
buffer_load_dwordx4 v40, s[48:51], s77 offen offset:2048 lds
v_mfma_f32_16x16x32_bf16 v[180:183], v[100:103], a[124:127], v[180:183]
ds_read_b64_tr_b16 v[88:89], v16 offset:33792
ds_read_b64_tr_b16 v[90:91], v16 offset:50176
v_mfma_f32_16x16x32_bf16 v[168:171], v[104:107], a[120:123], v[168:171]
ds_read_b64_tr_b16 v[92:93], v17 offset:33792
v_mfma_f32_16x16x32_bf16 v[184:187], v[104:107], a[124:127], v[184:187]
ds_read_b64_tr_b16 v[94:95], v17 offset:50176
ds_read_b64_tr_b16 v[96:97], v14 offset:34816
v_mfma_f32_16x16x32_bf16 v[172:175], v[108:111], a[120:123], v[172:175]
ds_read_b64_tr_b16 v[98:99], v14 offset:51200
v_mfma_f32_16x16x32_bf16 v[188:191], v[108:111], a[124:127], v[188:191]
ds_read_b64_tr_b16 v[100:101], v15 offset:34816
s_waitcnt lgkmcnt(8)
v_mfma_f32_16x16x32_bf16 v[160:163], v[112:115], a[128:131], v[160:163]
buffer_load_dwordx4 v41, s[48:51], s77 offen offset:3072 lds
v_mfma_f32_16x16x32_bf16 v[176:179], v[112:115], a[132:135], v[176:179]
ds_read_b64_tr_b16 v[102:103], v15 offset:51200
ds_read_b64_tr_b16 v[104:105], v16 offset:34816
v_mfma_f32_16x16x32_bf16 v[164:167], v[116:119], a[128:131], v[164:167]
ds_read_b64_tr_b16 v[106:107], v16 offset:51200
v_mfma_f32_16x16x32_bf16 v[180:183], v[116:119], a[132:135], v[180:183]
ds_read_b64_tr_b16 v[108:109], v17 offset:34816
ds_read_b64_tr_b16 v[110:111], v17 offset:51200
v_mfma_f32_16x16x32_bf16 v[168:171], v[120:123], a[128:131], v[168:171]
ds_read_b64_tr_b16 v[112:113], v14 offset:35840
v_mfma_f32_16x16x32_bf16 v[184:187], v[120:123], a[132:135], v[184:187]
s_add_u32 m0, s76, 69632
s_add_u32 s77, s99, 0x30000
v_mfma_f32_16x16x32_bf16 v[172:175], v[124:127], a[128:131], v[172:175]
buffer_load_dwordx4 v38, s[48:51], s77 offen offset:0 lds
v_mfma_f32_16x16x32_bf16 v[188:191], v[124:127], a[132:135], v[188:191]
ds_read_b64_tr_b16 v[114:115], v14 offset:52224
ds_read_b64_tr_b16 v[116:117], v15 offset:35840
v_mfma_f32_16x16x32_bf16 v[160:163], v[80:83], a[136:139], v[160:163]
ds_read_b64_tr_b16 v[118:119], v15 offset:52224
v_mfma_f32_16x16x32_bf16 v[176:179], v[80:83], a[140:143], v[176:179]
ds_read_b64_tr_b16 v[120:121], v16 offset:35840
s_waitcnt lgkmcnt(7)
v_mfma_f32_16x16x32_bf16 v[164:167], v[84:87], a[136:139], v[164:167]
ds_read_b64_tr_b16 v[122:123], v16 offset:52224
ds_read_b64_tr_b16 v[124:125], v17 offset:35840
v_mfma_f32_16x16x32_bf16 v[180:183], v[84:87], a[140:143], v[180:183]
buffer_load_dwordx4 v39, s[48:51], s77 offen offset:1024 lds
v_mfma_f32_16x16x32_bf16 v[168:171], v[88:91], a[136:139], v[168:171]
ds_read_b64_tr_b16 v[126:127], v17 offset:52224
ds_read_b64_tr_b16 v[80:81], v14 offset:36864
v_mfma_f32_16x16x32_bf16 v[184:187], v[88:91], a[140:143], v[184:187]
ds_read_b64_tr_b16 v[82:83], v14 offset:53248
v_mfma_f32_16x16x32_bf16 v[172:175], v[92:95], a[136:139], v[172:175]
ds_read_b64_tr_b16 v[84:85], v15 offset:36864
ds_read_b64_tr_b16 v[86:87], v15 offset:53248
v_mfma_f32_16x16x32_bf16 v[188:191], v[92:95], a[140:143], v[188:191]
ds_read_b64_tr_b16 v[88:89], v16 offset:36864
v_mfma_f32_16x16x32_bf16 v[160:163], v[96:99], a[144:147], v[160:163]
buffer_load_dwordx4 v40, s[48:51], s77 offen offset:2048 lds
v_mfma_f32_16x16x32_bf16 v[176:179], v[96:99], a[148:151], v[176:179]
ds_read_b64_tr_b16 v[90:91], v16 offset:53248
ds_read_b64_tr_b16 v[92:93], v17 offset:36864
v_mfma_f32_16x16x32_bf16 v[164:167], v[100:103], a[144:147], v[164:167]
ds_read_b64_tr_b16 v[94:95], v17 offset:53248
v_mfma_f32_16x16x32_bf16 v[180:183], v[100:103], a[148:151], v[180:183]
ds_read_b64_tr_b16 v[96:97], v14 offset:37888
ds_read_b64_tr_b16 v[98:99], v14 offset:54272
v_mfma_f32_16x16x32_bf16 v[168:171], v[104:107], a[144:147], v[168:171]
ds_read_b64_tr_b16 v[100:101], v15 offset:37888
v_mfma_f32_16x16x32_bf16 v[184:187], v[104:107], a[148:151], v[184:187]
ds_read_b64_tr_b16 v[102:103], v15 offset:54272
s_waitcnt lgkmcnt(8)
v_mfma_f32_16x16x32_bf16 v[172:175], v[108:111], a[144:147], v[172:175]
buffer_load_dwordx4 v41, s[48:51], s77 offen offset:3072 lds
v_mfma_f32_16x16x32_bf16 v[188:191], v[108:111], a[148:151], v[188:191]
ds_read_b64_tr_b16 v[104:105], v16 offset:37888
ds_read_b64_tr_b16 v[106:107], v16 offset:54272
v_mfma_f32_16x16x32_bf16 v[160:163], v[112:115], a[152:155], v[160:163]
ds_read_b64_tr_b16 v[108:109], v17 offset:37888
v_mfma_f32_16x16x32_bf16 v[176:179], v[112:115], a[156:159], v[176:179]
ds_read_b64_tr_b16 v[110:111], v17 offset:54272
v_mfma_f32_16x16x32_bf16 v[164:167], v[116:119], a[152:155], v[164:167]
ds_read_b64_tr_b16 v[112:113], v14 offset:38912
v_mfma_f32_16x16x32_bf16 v[180:183], v[116:119], a[156:159], v[180:183]
ds_read_b64_tr_b16 v[114:115], v14 offset:55296
v_mfma_f32_16x16x32_bf16 v[168:171], v[120:123], a[152:155], v[168:171]
ds_read_b64_tr_b16 v[116:117], v15 offset:38912
v_mfma_f32_16x16x32_bf16 v[184:187], v[120:123], a[156:159], v[184:187]
ds_read_b64_tr_b16 v[118:119], v15 offset:55296
v_mfma_f32_16x16x32_bf16 v[172:175], v[124:127], a[152:155], v[172:175]
ds_read_b64_tr_b16 v[120:121], v16 offset:38912
v_mfma_f32_16x16x32_bf16 v[188:191], v[124:127], a[156:159], v[188:191]
ds_read_b64_tr_b16 v[122:123], v16 offset:55296
v_mfma_f32_16x16x32_bf16 v[160:163], v[80:83], a[160:163], v[160:163]
ds_read_b64_tr_b16 v[124:125], v17 offset:38912
v_mfma_f32_16x16x32_bf16 v[176:179], v[80:83], a[164:167], v[176:179]
ds_read_b64_tr_b16 v[126:127], v17 offset:55296
v_mfma_f32_16x16x32_bf16 v[164:167], v[84:87], a[160:163], v[164:167]
ds_read_b64_tr_b16 v[80:81], v14 offset:39936
v_mfma_f32_16x16x32_bf16 v[180:183], v[84:87], a[164:167], v[180:183]
ds_read_b64_tr_b16 v[82:83], v14 offset:56320
s_waitcnt lgkmcnt(7)
v_mfma_f32_16x16x32_bf16 v[168:171], v[88:91], a[160:163], v[168:171]
ds_read_b64_tr_b16 v[84:85], v15 offset:39936
v_mfma_f32_16x16x32_bf16 v[184:187], v[88:91], a[164:167], v[184:187]
ds_read_b64_tr_b16 v[86:87], v15 offset:56320
v_mfma_f32_16x16x32_bf16 v[172:175], v[92:95], a[160:163], v[172:175]
ds_read_b64_tr_b16 v[88:89], v16 offset:39936
v_mfma_f32_16x16x32_bf16 v[188:191], v[92:95], a[164:167], v[188:191]
ds_read_b64_tr_b16 v[90:91], v16 offset:56320
v_mfma_f32_16x16x32_bf16 v[160:163], v[96:99], a[168:171], v[160:163]
ds_read_b64_tr_b16 v[92:93], v17 offset:39936
v_mfma_f32_16x16x32_bf16 v[176:179], v[96:99], a[172:175], v[176:179]
ds_read_b64_tr_b16 v[94:95], v17 offset:56320
v_mfma_f32_16x16x32_bf16 v[164:167], v[100:103], a[168:171], v[164:167]
v_mfma_f32_16x16x32_bf16 v[180:183], v[100:103], a[172:175], v[180:183]
v_mfma_f32_16x16x32_bf16 v[168:171], v[104:107], a[168:171], v[168:171]
v_mfma_f32_16x16x32_bf16 v[184:187], v[104:107], a[172:175], v[184:187]
v_mfma_f32_16x16x32_bf16 v[172:175], v[108:111], a[168:171], v[172:175]
s_waitcnt lgkmcnt(0)
s_barrier
v_mfma_f32_16x16x32_bf16 v[188:191], v[108:111], a[172:175], v[188:191]
s_add_u32 m0, s76, 98304
s_add_u32 s77, s99, 0x0
v_mfma_f32_16x16x32_bf16 v[160:163], v[112:115], a[176:179], v[160:163]
buffer_load_dwordx4 v42, s[48:51], s77 offen offset:0 lds
v_mfma_f32_16x16x32_bf16 v[176:179], v[112:115], a[180:183], v[176:179]
ds_read_b64_tr_b16 v[96:97], v10 offset:0
ds_read_b64_tr_b16 v[98:99], v10 offset:16384
v_mfma_f32_16x16x32_bf16 v[164:167], v[116:119], a[176:179], v[164:167]
ds_read_b64_tr_b16 v[100:101], v11 offset:0
v_mfma_f32_16x16x32_bf16 v[180:183], v[116:119], a[180:183], v[180:183]
ds_read_b64_tr_b16 v[102:103], v11 offset:16384
ds_read_b64_tr_b16 v[104:105], v12 offset:0
v_mfma_f32_16x16x32_bf16 v[168:171], v[120:123], a[176:179], v[168:171]
ds_read_b64_tr_b16 v[106:107], v12 offset:16384
v_mfma_f32_16x16x32_bf16 v[184:187], v[120:123], a[180:183], v[184:187]
buffer_load_dwordx4 v43, s[48:51], s77 offen offset:1024 lds
v_mfma_f32_16x16x32_bf16 v[172:175], v[124:127], a[176:179], v[172:175]
ds_read_b64_tr_b16 v[108:109], v13 offset:0
ds_read_b64_tr_b16 v[110:111], v13 offset:16384
v_mfma_f32_16x16x32_bf16 v[188:191], v[124:127], a[180:183], v[188:191]
ds_read_b64_tr_b16 v[112:113], v10 offset:1024
v_mfma_f32_16x16x32_bf16 v[160:163], v[80:83], a[184:187], v[160:163]
ds_read_b64_tr_b16 v[114:115], v10 offset:17408
ds_read_b64_tr_b16 v[116:117], v11 offset:1024
v_mfma_f32_16x16x32_bf16 v[176:179], v[80:83], a[188:191], v[176:179]
ds_read_b64_tr_b16 v[118:119], v11 offset:17408
v_mfma_f32_16x16x32_bf16 v[164:167], v[84:87], a[184:187], v[164:167]
buffer_load_dwordx4 v44, s[48:51], s77 offen offset:2048 lds
v_mfma_f32_16x16x32_bf16 v[180:183], v[84:87], a[188:191], v[180:183]
ds_read_b64_tr_b16 v[120:121], v12 offset:1024
ds_read_b64_tr_b16 v[122:123], v12 offset:17408
v_mfma_f32_16x16x32_bf16 v[168:171], v[88:91], a[184:187], v[168:171]
ds_read_b64_tr_b16 v[124:125], v13 offset:1024
v_mfma_f32_16x16x32_bf16 v[184:187], v[88:91], a[188:191], v[184:187]
ds_read_b64_tr_b16 v[126:127], v13 offset:17408
ds_read_b64_tr_b16 v[80:81], v10 offset:2048
v_mfma_f32_16x16x32_bf16 v[172:175], v[92:95], a[184:187], v[172:175]
ds_read_b64_tr_b16 v[82:83], v10 offset:18432
v_mfma_f32_16x16x32_bf16 v[188:191], v[92:95], a[188:191], v[188:191]
ds_read_b64_tr_b16 v[84:85], v11 offset:2048
s_waitcnt lgkmcnt(8)
v_mfma_f32_16x16x32_bf16 v[160:163], v[96:99], a[192:195], v[160:163]
buffer_load_dwordx4 v45, s[48:51], s77 offen offset:3072 lds
v_mfma_f32_16x16x32_bf16 v[176:179], v[96:99], a[196:199], v[176:179]
ds_read_b64_tr_b16 v[86:87], v11 offset:18432
ds_read_b64_tr_b16 v[88:89], v12 offset:2048
v_mfma_f32_16x16x32_bf16 v[164:167], v[100:103], a[192:195], v[164:167]
ds_read_b64_tr_b16 v[90:91], v12 offset:18432
v_mfma_f32_16x16x32_bf16 v[180:183], v[100:103], a[196:199], v[180:183]
ds_read_b64_tr_b16 v[92:93], v13 offset:2048
ds_read_b64_tr_b16 v[94:95], v13 offset:18432
v_mfma_f32_16x16x32_bf16 v[168:171], v[104:107], a[192:195], v[168:171]
ds_read_b64_tr_b16 v[96:97], v10 offset:3072
v_mfma_f32_16x16x32_bf16 v[184:187], v[104:107], a[196:199], v[184:187]
s_add_u32 m0, s76, 102400
s_add_u32 s77, s99, 0x40000
v_mfma_f32_16x16x32_bf16 v[172:175], v[108:111], a[192:195], v[172:175]
buffer_load_dwordx4 v38, s[48:51], s77 offen offset:0 lds
v_mfma_f32_16x16x32_bf16 v[188:191], v[108:111], a[196:199], v[188:191]
ds_read_b64_tr_b16 v[98:99], v10 offset:19456
ds_read_b64_tr_b16 v[100:101], v11 offset:3072
v_mfma_f32_16x16x32_bf16 v[160:163], v[112:115], a[200:203], v[160:163]
ds_read_b64_tr_b16 v[102:103], v11 offset:19456
v_mfma_f32_16x16x32_bf16 v[176:179], v[112:115], a[204:207], v[176:179]
ds_read_b64_tr_b16 v[104:105], v12 offset:3072
s_waitcnt lgkmcnt(7)
v_mfma_f32_16x16x32_bf16 v[164:167], v[116:119], a[200:203], v[164:167]
ds_read_b64_tr_b16 v[106:107], v12 offset:19456
ds_read_b64_tr_b16 v[108:109], v13 offset:3072
v_mfma_f32_16x16x32_bf16 v[180:183], v[116:119], a[204:207], v[180:183]
buffer_load_dwordx4 v39, s[48:51], s77 offen offset:1024 lds
v_mfma_f32_16x16x32_bf16 v[168:171], v[120:123], a[200:203], v[168:171]
ds_read_b64_tr_b16 v[110:111], v13 offset:19456
v_mfma_f32_16x16x32_bf16 v[184:187], v[120:123], a[204:207], v[184:187]
buffer_load_dwordx4 v40, s[48:51], s77 offen offset:2048 lds
v_mfma_f32_16x16x32_bf16 v[172:175], v[124:127], a[200:203], v[172:175]
buffer_load_dwordx4 v41, s[48:51], s77 offen offset:3072 lds
v_mfma_f32_16x16x32_bf16 v[188:191], v[124:127], a[204:207], v[188:191]
v_mfma_f32_16x16x32_bf16 v[160:163], v[80:83], a[208:211], v[160:163]
v_mfma_f32_16x16x32_bf16 v[176:179], v[80:83], a[212:215], v[176:179]
s_waitcnt vmcnt(17) lgkmcnt(0)
s_barrier
v_mfma_f32_16x16x32_bf16 v[164:167], v[84:87], a[208:211], v[164:167]
ds_read_b64_tr_b16 v[112:113], v10 offset:32768
s_add_u32 m0, s76, 0
v_mfma_f32_16x16x32_bf16 v[180:183], v[84:87], a[212:215], v[180:183]
ds_read_b64_tr_b16 v[114:115], v10 offset:49152
s_add_u32 s77, s99, 0x50000
v_mfma_f32_16x16x32_bf16 v[168:171], v[88:91], a[208:211], v[168:171]
ds_read_b64_tr_b16 v[116:117], v11 offset:32768
ds_read_b64_tr_b16 v[118:119], v11 offset:49152
v_mfma_f32_16x16x32_bf16 v[184:187], v[88:91], a[212:215], v[184:187]
buffer_load_dwordx4 v38, s[48:51], s77 offen offset:0 lds
v_mfma_f32_16x16x32_bf16 v[172:175], v[92:95], a[208:211], v[172:175]
ds_read_b64_tr_b16 v[120:121], v12 offset:32768
ds_read_b64_tr_b16 v[122:123], v12 offset:49152
v_mfma_f32_16x16x32_bf16 v[188:191], v[92:95], a[212:215], v[188:191]
ds_read_b64_tr_b16 v[124:125], v13 offset:32768
v_mfma_f32_16x16x32_bf16 v[160:163], v[96:99], a[216:219], v[160:163]
ds_read_b64_tr_b16 v[126:127], v13 offset:49152
ds_read_b64_tr_b16 v[80:81], v10 offset:33792
v_mfma_f32_16x16x32_bf16 v[176:179], v[96:99], a[220:223], v[176:179]
ds_read_b64_tr_b16 v[82:83], v10 offset:50176
v_mfma_f32_16x16x32_bf16 v[164:167], v[100:103], a[216:219], v[164:167]
buffer_load_dwordx4 v39, s[48:51], s77 offen offset:1024 lds
v_mfma_f32_16x16x32_bf16 v[180:183], v[100:103], a[220:223], v[180:183]
ds_read_b64_tr_b16 v[84:85], v11 offset:33792
ds_read_b64_tr_b16 v[86:87], v11 offset:50176
v_mfma_f32_16x16x32_bf16 v[168:171], v[104:107], a[216:219], v[168:171]
ds_read_b64_tr_b16 v[88:89], v12 offset:33792
v_mfma_f32_16x16x32_bf16 v[184:187], v[104:107], a[220:223], v[184:187]
ds_read_b64_tr_b16 v[90:91], v12 offset:50176
ds_read_b64_tr_b16 v[92:93], v13 offset:33792
v_mfma_f32_16x16x32_bf16 v[172:175], v[108:111], a[216:219], v[172:175]
ds_read_b64_tr_b16 v[94:95], v13 offset:50176
v_mfma_f32_16x16x32_bf16 v[188:191], v[108:111], a[220:223], v[188:191]
buffer_load_dwordx4 v40, s[48:51], s77 offen offset:2048 lds
S_D2:
s_waitcnt lgkmcnt(7)
v_mfma_f32_16x16x32_bf16 v[192:195], v[112:115], a[0:3], 0
ds_read_b64_tr_b16 v[96:97], v10 offset:34816
ds_read_b64_tr_b16 v[98:99], v10 offset:51200
v_mfma_f32_16x16x32_bf16 v[208:211], v[112:115], a[4:7], 0
ds_read_b64_tr_b16 v[100:101], v11 offset:34816
v_mfma_f32_16x16x32_bf16 v[196:199], v[116:119], a[0:3], 0
ds_read_b64_tr_b16 v[102:103], v11 offset:51200
ds_read_b64_tr_b16 v[104:105], v12 offset:34816
v_mfma_f32_16x16x32_bf16 v[212:215], v[116:119], a[4:7], 0
s_add_u32 s70, s0, S_D3 - K_pc + 0
s_addc_u32 s71, s1, 0
global_load_dword v57, v9, s[70:71]
v_mfma_f32_16x16x32_bf16 v[200:203], v[120:123], a[0:3], 0
buffer_load_dwordx4 v41, s[48:51], s77 offen offset:3072 lds
v_mfma_f32_16x16x32_bf16 v[216:219], v[120:123], a[4:7], 0
v_cvt_pk_bf16_f32 v160, v160, v161
v_cvt_pk_bf16_f32 v161, v162, v163
v_mfma_f32_16x16x32_bf16 v[204:207], v[124:127], a[0:3], 0
v_cvt_pk_bf16_f32 v162, v164, v165
v_cvt_pk_bf16_f32 v163, v166, v167
v_mfma_f32_16x16x32_bf16 v[220:223], v[124:127], a[4:7], 0
ds_read_b64_tr_b16 v[106:107], v12 offset:51200
s_waitcnt lgkmcnt(4)
v_mfma_f32_16x16x32_bf16 v[192:195], v[80:83], a[8:11], v[192:195]
ds_read_b64_tr_b16 v[108:109], v13 offset:34816
ds_read_b64_tr_b16 v[110:111], v13 offset:51200
v_mfma_f32_16x16x32_bf16 v[208:211], v[80:83], a[12:15], v[208:211]
buffer_store_dwordx4 v[160:163], v46, s[60:63], s9 offen offset:0 sc1
v_mfma_f32_16x16x32_bf16 v[196:199], v[84:87], a[8:11], v[196:199]
ds_read_b64_tr_b16 v[112:113], v10 offset:35840
v_cvt_pk_bf16_f32 v168, v168, v169
v_mfma_f32_16x16x32_bf16 v[212:215], v[84:87], a[12:15], v[212:215]
ds_read_b64_tr_b16 v[114:115], v10 offset:52224
v_cvt_pk_bf16_f32 v169, v170, v171
v_mfma_f32_16x16x32_bf16 v[200:203], v[88:91], a[8:11], v[200:203]
ds_read_b64_tr_b16 v[116:117], v11 offset:35840
v_cvt_pk_bf16_f32 v170, v172, v173
v_mfma_f32_16x16x32_bf16 v[216:219], v[88:91], a[12:15], v[216:219]
ds_read_b64_tr_b16 v[118:119], v11 offset:52224
v_cvt_pk_bf16_f32 v171, v174, v175
v_mfma_f32_16x16x32_bf16 v[204:207], v[92:95], a[8:11], v[204:207]
ds_read_b64_tr_b16 v[120:121], v12 offset:35840
ds_read_b64_tr_b16 v[122:123], v12 offset:52224
v_mfma_f32_16x16x32_bf16 v[220:223], v[92:95], a[12:15], v[220:223]
buffer_store_dwordx4 v[168:171], v46, s[60:63], s9 offen offset:1024 sc1
v_mfma_f32_16x16x32_bf16 v[192:195], v[96:99], a[16:19], v[192:195]
ds_read_b64_tr_b16 v[124:125], v13 offset:35840
v_cvt_pk_bf16_f32 v176, v176, v177
v_mfma_f32_16x16x32_bf16 v[208:211], v[96:99], a[20:23], v[208:211]
ds_read_b64_tr_b16 v[126:127], v13 offset:52224
s_waitcnt lgkmcnt(7)
v_mfma_f32_16x16x32_bf16 v[196:199], v[100:103], a[16:19], v[196:199]
ds_read_b64_tr_b16 v[80:81], v10 offset:36864
v_cvt_pk_bf16_f32 v177, v178, v179
v_mfma_f32_16x16x32_bf16 v[212:215], v[100:103], a[20:23], v[212:215]
ds_read_b64_tr_b16 v[82:83], v10 offset:53248
v_cvt_pk_bf16_f32 v178, v180, v181
v_mfma_f32_16x16x32_bf16 v[200:203], v[104:107], a[16:19], v[200:203]
ds_read_b64_tr_b16 v[84:85], v11 offset:36864
v_cvt_pk_bf16_f32 v179, v182, v183
v_mfma_f32_16x16x32_bf16 v[216:219], v[104:107], a[20:23], v[216:219]
ds_read_b64_tr_b16 v[86:87], v11 offset:53248
ds_read_b64_tr_b16 v[88:89], v12 offset:36864
v_mfma_f32_16x16x32_bf16 v[204:207], v[108:111], a[16:19], v[204:207]
buffer_store_dwordx4 v[176:179], v46, s[60:63], s9 offen offset:2048 sc1
v_mfma_f32_16x16x32_bf16 v[220:223], v[108:111], a[20:23], v[220:223]
ds_read_b64_tr_b16 v[90:91], v12 offset:53248
s_waitcnt lgkmcnt(7)
v_mfma_f32_16x16x32_bf16 v[192:195], v[112:115], a[24:27], v[192:195]
ds_read_b64_tr_b16 v[92:93], v13 offset:36864
v_cvt_pk_bf16_f32 v184, v184, v185
v_mfma_f32_16x16x32_bf16 v[208:211], v[112:115], a[28:31], v[208:211]
ds_read_b64_tr_b16 v[94:95], v13 offset:53248
v_cvt_pk_bf16_f32 v185, v186, v187
v_mfma_f32_16x16x32_bf16 v[196:199], v[116:119], a[24:27], v[196:199]
ds_read_b64_tr_b16 v[96:97], v10 offset:37888
v_cvt_pk_bf16_f32 v186, v188, v189
v_mfma_f32_16x16x32_bf16 v[212:215], v[116:119], a[28:31], v[212:215]
ds_read_b64_tr_b16 v[98:99], v10 offset:54272
v_cvt_pk_bf16_f32 v187, v190, v191
v_mfma_f32_16x16x32_bf16 v[200:203], v[120:123], a[24:27], v[200:203]
ds_read_b64_tr_b16 v[100:101], v11 offset:37888
ds_read_b64_tr_b16 v[102:103], v11 offset:54272
v_mfma_f32_16x16x32_bf16 v[216:219], v[120:123], a[28:31], v[216:219]
ds_read_b64_tr_b16 v[104:105], v12 offset:37888
s_waitcnt lgkmcnt(8)
v_mfma_f32_16x16x32_bf16 v[204:207], v[124:127], a[24:27], v[204:207]
buffer_store_dwordx4 v[184:187], v46, s[60:63], s9 offen offset:3072 sc1
v_mfma_f32_16x16x32_bf16 v[220:223], v[124:127], a[28:31], v[220:223]
ds_read_b64_tr_b16 v[106:107], v12 offset:54272
ds_read_b64_tr_b16 v[108:109], v13 offset:37888
v_mfma_f32_16x16x32_bf16 v[192:195], v[80:83], a[32:35], v[192:195]
ds_read_b64_tr_b16 v[110:111], v13 offset:54272
v_mfma_f32_16x16x32_bf16 v[208:211], v[80:83], a[36:39], v[208:211]
ds_read_b64_tr_b16 v[112:113], v10 offset:38912
ds_read_b64_tr_b16 v[114:115], v10 offset:55296
v_mfma_f32_16x16x32_bf16 v[196:199], v[84:87], a[32:35], v[196:199]
ds_read_b64_tr_b16 v[116:117], v11 offset:38912
v_mfma_f32_16x16x32_bf16 v[212:215], v[84:87], a[36:39], v[212:215]
ds_read_b64_tr_b16 v[118:119], v11 offset:55296
s_waitcnt lgkmcnt(8)
v_mfma_f32_16x16x32_bf16 v[200:203], v[88:91], a[32:35], v[200:203]
ds_read_b64_tr_b16 v[120:121], v12 offset:38912
ds_read_b64_tr_b16 v[122:123], v12 offset:55296
v_mfma_f32_16x16x32_bf16 v[216:219], v[88:91], a[36:39], v[216:219]
ds_read_b64_tr_b16 v[124:125], v13 offset:38912
v_mfma_f32_16x16x32_bf16 v[204:207], v[92:95], a[32:35], v[204:207]
ds_read_b64_tr_b16 v[126:127], v13 offset:55296
ds_read_b64_tr_b16 v[80:81], v10 offset:39936
v_mfma_f32_16x16x32_bf16 v[220:223], v[92:95], a[36:39], v[220:223]
ds_read_b64_tr_b16 v[82:83], v10 offset:56320
v_mfma_f32_16x16x32_bf16 v[192:195], v[96:99], a[40:43], v[192:195]
ds_read_b64_tr_b16 v[84:85], v11 offset:39936
ds_read_b64_tr_b16 v[86:87], v11 offset:56320
v_mfma_f32_16x16x32_bf16 v[208:211], v[96:99], a[44:47], v[208:211]
ds_read_b64_tr_b16 v[88:89], v12 offset:39936
v_mfma_f32_16x16x32_bf16 v[196:199], v[100:103], a[40:43], v[196:199]
ds_read_b64_tr_b16 v[90:91], v12 offset:56320
ds_read_b64_tr_b16 v[92:93], v13 offset:39936
v_mfma_f32_16x16x32_bf16 v[212:215], v[100:103], a[44:47], v[212:215]
ds_read_b64_tr_b16 v[94:95], v13 offset:56320
s_waitcnt lgkmcnt(10)
v_mfma_f32_16x16x32_bf16 v[200:203], v[104:107], a[40:43], v[200:203]
v_mfma_f32_16x16x32_bf16 v[216:219], v[104:107], a[44:47], v[216:219]
v_mfma_f32_16x16x32_bf16 v[204:207], v[108:111], a[40:43], v[204:207]
v_mfma_f32_16x16x32_bf16 v[220:223], v[108:111], a[44:47], v[220:223]
v_mfma_f32_16x16x32_bf16 v[192:195], v[112:115], a[48:51], v[192:195]
s_waitcnt vmcnt(17) lgkmcnt(0)
s_barrier
v_mfma_f32_16x16x32_bf16 v[208:211], v[112:115], a[52:55], v[208:211]
s_add_u32 m0, s76, 32768
s_add_u32 s77, s100, 0x0
v_mfma_f32_16x16x32_bf16 v[196:199], v[116:119], a[48:51], v[196:199]
ds_read_b64_tr_b16 v[96:97], v14 offset:0
ds_read_b64_tr_b16 v[98:99], v14 offset:16384
v_mfma_f32_16x16x32_bf16 v[212:215], v[116:119], a[52:55], v[212:215]
buffer_load_dwordx4 v38, s[48:51], s77 offen offset:0 lds
v_mfma_f32_16x16x32_bf16 v[200:203], v[120:123], a[48:51], v[200:203]
ds_read_b64_tr_b16 v[100:101], v15 offset:0
ds_read_b64_tr_b16 v[102:103], v15 offset:16384
v_mfma_f32_16x16x32_bf16 v[216:219], v[120:123], a[52:55], v[216:219]
ds_read_b64_tr_b16 v[104:105], v16 offset:0
v_mfma_f32_16x16x32_bf16 v[204:207], v[124:127], a[48:51], v[204:207]
ds_read_b64_tr_b16 v[106:107], v16 offset:16384
ds_read_b64_tr_b16 v[108:109], v17 offset:0
v_mfma_f32_16x16x32_bf16 v[220:223], v[124:127], a[52:55], v[220:223]
ds_read_b64_tr_b16 v[110:111], v17 offset:16384
v_mfma_f32_16x16x32_bf16 v[192:195], v[80:83], a[56:59], v[192:195]
buffer_load_dwordx4 v39, s[48:51], s77 offen offset:1024 lds
v_mfma_f32_16x16x32_bf16 v[208:211], v[80:83], a[60:63], v[208:211]
ds_read_b64_tr_b16 v[112:113], v14 offset:1024
ds_read_b64_tr_b16 v[114:115], v14 offset:17408
v_mfma_f32_16x16x32_bf16 v[196:199], v[84:87], a[56:59], v[196:199]
ds_read_b64_tr_b16 v[116:117], v15 offset:1024
v_mfma_f32_16x16x32_bf16 v[212:215], v[84:87], a[60:63], v[212:215]
ds_read_b64_tr_b16 v[118:119], v15 offset:17408
ds_read_b64_tr_b16 v[120:121], v16 offset:1024
v_mfma_f32_16x16x32_bf16 v[200:203], v[88:91], a[56:59], v[200:203]
ds_read_b64_tr_b16 v[122:123], v16 offset:17408
v_mfma_f32_16x16x32_bf16 v[216:219], v[88:91], a[60:63], v[216:219]
buffer_load_dwordx4 v40, s[48:51], s77 offen offset:2048 lds
v_mfma_f32_16x16x32_bf16 v[204:207], v[92:95], a[56:59], v[204:207]
ds_read_b64_tr_b16 v[124:125], v17 offset:1024
ds_read_b64_tr_b16 v[126:127], v17 offset:17408
v_mfma_f32_16x16x32_bf16 v[220:223], v[92:95], a[60:63], v[220:223]
ds_read_b64_tr_b16 v[80:81], v14 offset:2048
s_waitcnt lgkmcnt(9)
v_mfma_f32_16x16x32_bf16 v[192:195], v[96:99], a[64:67], v[192:195]
ds_read_b64_tr_b16 v[82:83], v14 offset:18432
ds_read_b64_tr_b16 v[84:85], v15 offset:2048
v_mfma_f32_16x16x32_bf16 v[208:211], v[96:99], a[68:71], v[208:211]
ds_read_b64_tr_b16 v[86:87], v15 offset:18432
v_mfma_f32_16x16x32_bf16 v[196:199], v[100:103], a[64:67], v[196:199]
buffer_load_dwordx4 v41, s[48:51], s77 offen offset:3072 lds
v_mfma_f32_16x16x32_bf16 v[212:215], v[100:103], a[68:71], v[212:215]
ds_read_b64_tr_b16 v[88:89], v16 offset:2048
ds_read_b64_tr_b16 v[90:91], v16 offset:18432
v_mfma_f32_16x16x32_bf16 v[200:203], v[104:107], a[64:67], v[200:203]
ds_read_b64_tr_b16 v[92:93], v17 offset:2048
v_mfma_f32_16x16x32_bf16 v[216:219], v[104:107], a[68:71], v[216:219]
ds_read_b64_tr_b16 v[94:95], v17 offset:18432
ds_read_b64_tr_b16 v[96:97], v14 offset:3072
v_mfma_f32_16x16x32_bf16 v[204:207], v[108:111], a[64:67], v[204:207]
ds_read_b64_tr_b16 v[98:99], v14 offset:19456
v_mfma_f32_16x16x32_bf16 v[220:223], v[108:111], a[68:71], v[220:223]
s_add_u32 m0, s76, 36864
s_waitcnt lgkmcnt(7)
v_mfma_f32_16x16x32_bf16 v[192:195], v[112:115], a[72:75], v[192:195]
s_add_u32 s77, s100, 0x10000
ds_read_b64_tr_b16 v[100:101], v15 offset:3072
v_mfma_f32_16x16x32_bf16 v[208:211], v[112:115], a[76:79], v[208:211]
buffer_load_dwordx4 v38, s[48:51], s77 offen offset:0 lds
v_mfma_f32_16x16x32_bf16 v[196:199], v[116:119], a[72:75], v[196:199]
ds_read_b64_tr_b16 v[102:103], v15 offset:19456
ds_read_b64_tr_b16 v[104:105], v16 offset:3072
v_mfma_f32_16x16x32_bf16 v[212:215], v[116:119], a[76:79], v[212:215]
ds_read_b64_tr_b16 v[106:107], v16 offset:19456
v_mfma_f32_16x16x32_bf16 v[200:203], v[120:123], a[72:75], v[200:203]
ds_read_b64_tr_b16 v[108:109], v17 offset:3072
ds_read_b64_tr_b16 v[110:111], v17 offset:19456
v_mfma_f32_16x16x32_bf16 v[216:219], v[120:123], a[76:79], v[216:219]
ds_read_b64_tr_b16 v[112:113], v14 offset:4096
v_mfma_f32_16x16x32_bf16 v[204:207], v[124:127], a[72:75], v[204:207]
buffer_load_dwordx4 v39, s[48:51], s77 offen offset:1024 lds
v_mfma_f32_16x16x32_bf16 v[220:223], v[124:127], a[76:79], v[220:223]
ds_read_b64_tr_b16 v[114:115], v14 offset:20480
ds_read_b64_tr_b16 v[116:117], v15 offset:4096
v_mfma_f32_16x16x32_bf16 v[192:195], v[80:83], a[80:83], v[192:195]
ds_read_b64_tr_b16 v[118:119], v15 offset:20480
v_mfma_f32_16x16x32_bf16 v[208:211], v[80:83], a[84:87], v[208:211]
ds_read_b64_tr_b16 v[120:121], v16 offset:4096
s_waitcnt lgkmcnt(8)
v_mfma_f32_16x16x32_bf16 v[196:199], v[84:87], a[80:83], v[196:199]
ds_read_b64_tr_b16 v[122:123], v16 offset:20480
ds_read_b64_tr_b16 v[124:125], v17 offset:4096
v_mfma_f32_16x16x32_bf16 v[212:215], v[84:87], a[84:87], v[212:215]
buffer_load_dwordx4 v40, s[48:51], s77 offen offset:2048 lds
v_mfma_f32_16x16x32_bf16 v[200:203], v[88:91], a[80:83], v[200:203]
ds_read_b64_tr_b16 v[126:127], v17 offset:20480
ds_read_b64_tr_b16 v[80:81], v14 offset:5120
v_mfma_f32_16x16x32_bf16 v[216:219], v[88:91], a[84:87], v[216:219]
ds_read_b64_tr_b16 v[82:83], v14 offset:21504
v_mfma_f32_16x16x32_bf16 v[204:207], v[92:95], a[80:83], v[204:207]
ds_read_b64_tr_b16 v[84:85], v15 offset:5120
ds_read_b64_tr_b16 v[86:87], v15 offset:21504
v_mfma_f32_16x16x32_bf16 v[220:223], v[92:95], a[84:87], v[220:223]
ds_read_b64_tr_b16 v[88:89], v16 offset:5120
v_mfma_f32_16x16x32_bf16 v[192:195], v[96:99], a[88:91], v[192:195]
buffer_load_dwordx4 v41, s[48:51], s77 offen offset:3072 lds
v_mfma_f32_16x16x32_bf16 v[208:211], v[96:99], a[92:95], v[208:211]
ds_read_b64_tr_b16 v[90:91], v16 offset:21504
ds_read_b64_tr_b16 v[92:93], v17 offset:5120
v_mfma_f32_16x16x32_bf16 v[196:199], v[100:103], a[88:91], v[196:199]
ds_read_b64_tr_b16 v[94:95], v17 offset:21504
v_mfma_f32_16x16x32_bf16 v[212:215], v[100:103], a[92:95], v[212:215]
s_waitcnt vmcnt(8)
s_waitcnt lgkmcnt(7)
v_mfma_f32_16x16x32_bf16 v[200:203], v[104:107], a[88:91], v[200:203]
buffer_atomic_add v52, v54, s[60:63], 0 offen sc1
v_mfma_f32_16x16x32_bf16 v[216:219], v[104:107], a[92:95], v[216:219]
ds_read_b64_tr_b16 v[96:97], v14 offset:6144
ds_read_b64_tr_b16 v[98:99], v14 offset:22528
v_mfma_f32_16x16x32_bf16 v[204:207], v[108:111], a[88:91], v[204:207]
ds_read_b64_tr_b16 v[100:101], v15 offset:6144
v_mfma_f32_16x16x32_bf16 v[220:223], v[108:111], a[92:95], v[220:223]
ds_read_b64_tr_b16 v[102:103], v15 offset:22528
ds_read_b64_tr_b16 v[104:105], v16 offset:6144
v_mfma_f32_16x16x32_bf16 v[192:195], v[112:115], a[96:99], v[192:195]
ds_read_b64_tr_b16 v[106:107], v16 offset:22528
v_mfma_f32_16x16x32_bf16 v[208:211], v[112:115], a[100:103], v[208:211]
ds_read_b64_tr_b16 v[108:109], v17 offset:6144
ds_read_b64_tr_b16 v[110:111], v17 offset:22528
v_mfma_f32_16x16x32_bf16 v[196:199], v[116:119], a[96:99], v[196:199]
ds_read_b64_tr_b16 v[112:113], v14 offset:7168
v_mfma_f32_16x16x32_bf16 v[212:215], v[116:119], a[100:103], v[212:215]
ds_read_b64_tr_b16 v[114:115], v14 offset:23552
v_mfma_f32_16x16x32_bf16 v[200:203], v[120:123], a[96:99], v[200:203]
ds_read_b64_tr_b16 v[116:117], v15 offset:7168
v_mfma_f32_16x16x32_bf16 v[216:219], v[120:123], a[100:103], v[216:219]
ds_read_b64_tr_b16 v[118:119], v15 offset:23552
v_mfma_f32_16x16x32_bf16 v[204:207], v[124:127], a[96:99], v[204:207]
ds_read_b64_tr_b16 v[120:121], v16 offset:7168
v_mfma_f32_16x16x32_bf16 v[220:223], v[124:127], a[100:103], v[220:223]
ds_read_b64_tr_b16 v[122:123], v16 offset:23552
s_waitcnt lgkmcnt(8)
v_mfma_f32_16x16x32_bf16 v[192:195], v[80:83], a[104:107], v[192:195]
ds_read_b64_tr_b16 v[124:125], v17 offset:7168
v_mfma_f32_16x16x32_bf16 v[208:211], v[80:83], a[108:111], v[208:211]
ds_read_b64_tr_b16 v[126:127], v17 offset:23552
v_mfma_f32_16x16x32_bf16 v[196:199], v[84:87], a[104:107], v[196:199]
v_mfma_f32_16x16x32_bf16 v[212:215], v[84:87], a[108:111], v[212:215]
v_mfma_f32_16x16x32_bf16 v[200:203], v[88:91], a[104:107], v[200:203]
v_mfma_f32_16x16x32_bf16 v[216:219], v[88:91], a[108:111], v[216:219]
v_mfma_f32_16x16x32_bf16 v[204:207], v[92:95], a[104:107], v[204:207]
s_waitcnt lgkmcnt(0)
s_barrier
v_mfma_f32_16x16x32_bf16 v[220:223], v[92:95], a[108:111], v[220:223]
s_add_u32 m0, s76, 65536
s_add_u32 s77, s100, 0x20000
v_mfma_f32_16x16x32_bf16 v[192:195], v[96:99], a[112:115], v[192:195]
buffer_load_dwordx4 v38, s[48:51], s77 offen offset:0 lds
v_mfma_f32_16x16x32_bf16 v[208:211], v[96:99], a[116:119], v[208:211]
ds_read_b64_tr_b16 v[80:81], v14 offset:32768
ds_read_b64_tr_b16 v[82:83], v14 offset:49152
v_mfma_f32_16x16x32_bf16 v[196:199], v[100:103], a[112:115], v[196:199]
ds_read_b64_tr_b16 v[84:85], v15 offset:32768
v_mfma_f32_16x16x32_bf16 v[212:215], v[100:103], a[116:119], v[212:215]
ds_read_b64_tr_b16 v[86:87], v15 offset:49152
ds_read_b64_tr_b16 v[88:89], v16 offset:32768
v_mfma_f32_16x16x32_bf16 v[200:203], v[104:107], a[112:115], v[200:203]
ds_read_b64_tr_b16 v[90:91], v16 offset:49152
v_mfma_f32_16x16x32_bf16 v[216:219], v[104:107], a[116:119], v[216:219]
buffer_load_dwordx4 v39, s[48:51], s77 offen offset:1024 lds
v_mfma_f32_16x16x32_bf16 v[204:207], v[108:111], a[112:115], v[204:207]
ds_read_b64_tr_b16 v[92:93], v17 offset:32768
ds_read_b64_tr_b16 v[94:95], v17 offset:49152
v_mfma_f32_16x16x32_bf16 v[220:223], v[108:111], a[116:119], v[220:223]
ds_read_b64_tr_b16 v[96:97], v14 offset:33792
v_mfma_f32_16x16x32_bf16 v[192:195], v[112:115], a[120:123], v[192:195]
ds_read_b64_tr_b16 v[98:99], v14 offset:50176
ds_read_b64_tr_b16 v[100:101], v15 offset:33792
v_mfma_f32_16x16x32_bf16 v[208:211], v[112:115], a[124:127], v[208:211]
ds_read_b64_tr_b16 v[102:103], v15 offset:50176
v_mfma_f32_16x16x32_bf16 v[196:199], v[116:119], a[120:123], v[196:199]
buffer_load_dwordx4 v40, s[48:51], s77 offen offset:2048 lds
v_mfma_f32_16x16x32_bf16 v[212:215], v[116:119], a[124:127], v[212:215]
ds_read_b64_tr_b16 v[104:105], v16 offset:33792
ds_read_b64_tr_b16 v[106:107], v16 offset:50176
v_mfma_f32_16x16x32_bf16 v[200:203], v[120:123], a[120:123], v[200:203]
ds_read_b64_tr_b16 v[108:109], v17 offset:33792
v_mfma_f32_16x16x32_bf16 v[216:219], v[120:123], a[124:127], v[216:219]
ds_read_b64_tr_b16 v[110:111], v17 offset:50176
ds_read_b64_tr_b16 v[112:113], v14 offset:34816
v_mfma_f32_16x16x32_bf16 v[204:207], v[124:127], a[120:123], v[204:207]
ds_read_b64_tr_b16 v[114:115], v14 offset:51200
v_mfma_f32_16x16x32_bf16 v[220:223], v[124:127], a[124:127], v[220:223]
ds_read_b64_tr_b16 v[116:117], v15 offset:34816
s_waitcnt lgkmcnt(8)
v_mfma_f32_16x16x32_bf16 v[192:195], v[80:83], a[128:131], v[192:195]
buffer_load_dwordx4 v41, s[48:51], s77 offen offset:3072 lds
v_mfma_f32_16x16x32_bf16 v[208:211], v[80:83], a[132:135], v[208:211]
ds_read_b64_tr_b16 v[118:119], v15 offset:51200
ds_read_b64_tr_b16 v[120:121], v16 offset:34816
v_mfma_f32_16x16x32_bf16 v[196:199], v[84:87], a[128:131], v[196:199]
ds_read_b64_tr_b16 v[122:123], v16 offset:51200
v_mfma_f32_16x16x32_bf16 v[212:215], v[84:87], a[132:135], v[212:215]
ds_read_b64_tr_b16 v[124:125], v17 offset:34816
ds_read_b64_tr_b16 v[126:127], v17 offset:51200
v_mfma_f32_16x16x32_bf16 v[200:203], v[88:91], a[128:131], v[200:203]
ds_read_b64_tr_b16 v[80:81], v14 offset:35840
v_mfma_f32_16x16x32_bf16 v[216:219], v[88:91], a[132:135], v[216:219]
s_add_u32 m0, s76, 69632
s_add_u32 s77, s100, 0x30000
v_mfma_f32_16x16x32_bf16 v[204:207], v[92:95], a[128:131], v[204:207]
buffer_load_dwordx4 v38, s[48:51], s77 offen offset:0 lds
v_mfma_f32_16x16x32_bf16 v[220:223], v[92:95], a[132:135], v[220:223]
ds_read_b64_tr_b16 v[82:83], v14 offset:52224
ds_read_b64_tr_b16 v[84:85], v15 offset:35840
v_mfma_f32_16x16x32_bf16 v[192:195], v[96:99], a[136:139], v[192:195]
ds_read_b64_tr_b16 v[86:87], v15 offset:52224
v_mfma_f32_16x16x32_bf16 v[208:211], v[96:99], a[140:143], v[208:211]
ds_read_b64_tr_b16 v[88:89], v16 offset:35840
s_waitcnt lgkmcnt(7)
v_mfma_f32_16x16x32_bf16 v[196:199], v[100:103], a[136:139], v[196:199]
ds_read_b64_tr_b16 v[90:91], v16 offset:52224
ds_read_b64_tr_b16 v[92:93], v17 offset:35840
v_mfma_f32_16x16x32_bf16 v[212:215], v[100:103], a[140:143], v[212:215]
buffer_load_dwordx4 v39, s[48:51], s77 offen offset:1024 lds
v_mfma_f32_16x16x32_bf16 v[200:203], v[104:107], a[136:139], v[200:203]
ds_read_b64_tr_b16 v[94:95], v17 offset:52224
ds_read_b64_tr_b16 v[96:97], v14 offset:36864
v_mfma_f32_16x16x32_bf16 v[216:219], v[104:107], a[140:143], v[216:219]
ds_read_b64_tr_b16 v[98:99], v14 offset:53248
v_mfma_f32_16x16x32_bf16 v[204:207], v[108:111], a[136:139], v[204:207]
ds_read_b64_tr_b16 v[100:101], v15 offset:36864
ds_read_b64_tr_b16 v[102:103], v15 offset:53248
v_mfma_f32_16x16x32_bf16 v[220:223], v[108:111], a[140:143], v[220:223]
ds_read_b64_tr_b16 v[104:105], v16 offset:36864
v_mfma_f32_16x16x32_bf16 v[192:195], v[112:115], a[144:147], v[192:195]
buffer_load_dwordx4 v40, s[48:51], s77 offen offset:2048 lds
v_mfma_f32_16x16x32_bf16 v[208:211], v[112:115], a[148:151], v[208:211]
ds_read_b64_tr_b16 v[106:107], v16 offset:53248
ds_read_b64_tr_b16 v[108:109], v17 offset:36864
v_mfma_f32_16x16x32_bf16 v[196:199], v[116:119], a[144:147], v[196:199]
ds_read_b64_tr_b16 v[110:111], v17 offset:53248
v_mfma_f32_16x16x32_bf16 v[212:215], v[116:119], a[148:151], v[212:215]
ds_read_b64_tr_b16 v[112:113], v14 offset:37888
ds_read_b64_tr_b16 v[114:115], v14 offset:54272
v_mfma_f32_16x16x32_bf16 v[200:203], v[120:123], a[144:147], v[200:203]
ds_read_b64_tr_b16 v[116:117], v15 offset:37888
v_mfma_f32_16x16x32_bf16 v[216:219], v[120:123], a[148:151], v[216:219]
ds_read_b64_tr_b16 v[118:119], v15 offset:54272
s_waitcnt lgkmcnt(8)
v_mfma_f32_16x16x32_bf16 v[204:207], v[124:127], a[144:147], v[204:207]
buffer_load_dwordx4 v41, s[48:51], s77 offen offset:3072 lds
v_mfma_f32_16x16x32_bf16 v[220:223], v[124:127], a[148:151], v[220:223]
ds_read_b64_tr_b16 v[120:121], v16 offset:37888
ds_read_b64_tr_b16 v[122:123], v16 offset:54272
v_mfma_f32_16x16x32_bf16 v[192:195], v[80:83], a[152:155], v[192:195]
ds_read_b64_tr_b16 v[124:125], v17 offset:37888
v_mfma_f32_16x16x32_bf16 v[208:211], v[80:83], a[156:159], v[208:211]
ds_read_b64_tr_b16 v[126:127], v17 offset:54272
v_mfma_f32_16x16x32_bf16 v[196:199], v[84:87], a[152:155], v[196:199]
ds_read_b64_tr_b16 v[80:81], v14 offset:38912
v_mfma_f32_16x16x32_bf16 v[212:215], v[84:87], a[156:159], v[212:215]
ds_read_b64_tr_b16 v[82:83], v14 offset:55296
v_mfma_f32_16x16x32_bf16 v[200:203], v[88:91], a[152:155], v[200:203]
ds_read_b64_tr_b16 v[84:85], v15 offset:38912
v_mfma_f32_16x16x32_bf16 v[216:219], v[88:91], a[156:159], v[216:219]
ds_read_b64_tr_b16 v[86:87], v15 offset:55296
v_mfma_f32_16x16x32_bf16 v[204:207], v[92:95], a[152:155], v[204:207]
ds_read_b64_tr_b16 v[88:89], v16 offset:38912
v_mfma_f32_16x16x32_bf16 v[220:223], v[92:95], a[156:159], v[220:223]
ds_read_b64_tr_b16 v[90:91], v16 offset:55296
v_mfma_f32_16x16x32_bf16 v[192:195], v[96:99], a[160:163], v[192:195]
ds_read_b64_tr_b16 v[92:93], v17 offset:38912
v_mfma_f32_16x16x32_bf16 v[208:211], v[96:99], a[164:167], v[208:211]
ds_read_b64_tr_b16 v[94:95], v17 offset:55296
v_mfma_f32_16x16x32_bf16 v[196:199], v[100:103], a[160:163], v[196:199]
ds_read_b64_tr_b16 v[96:97], v14 offset:39936
v_mfma_f32_16x16x32_bf16 v[212:215], v[100:103], a[164:167], v[212:215]
ds_read_b64_tr_b16 v[98:99], v14 offset:56320
s_waitcnt lgkmcnt(7)
v_mfma_f32_16x16x32_bf16 v[200:203], v[104:107], a[160:163], v[200:203]
ds_read_b64_tr_b16 v[100:101], v15 offset:39936
v_mfma_f32_16x16x32_bf16 v[216:219], v[104:107], a[164:167], v[216:219]
ds_read_b64_tr_b16 v[102:103], v15 offset:56320
v_mfma_f32_16x16x32_bf16 v[204:207], v[108:111], a[160:163], v[204:207]
ds_read_b64_tr_b16 v[104:105], v16 offset:39936
v_mfma_f32_16x16x32_bf16 v[220:223], v[108:111], a[164:167], v[220:223]
ds_read_b64_tr_b16 v[106:107], v16 offset:56320
v_mfma_f32_16x16x32_bf16 v[192:195], v[112:115], a[168:171], v[192:195]
ds_read_b64_tr_b16 v[108:109], v17 offset:39936
v_mfma_f32_16x16x32_bf16 v[208:211], v[112:115], a[172:175], v[208:211]
ds_read_b64_tr_b16 v[110:111], v17 offset:56320
v_mfma_f32_16x16x32_bf16 v[196:199], v[116:119], a[168:171], v[196:199]
v_mfma_f32_16x16x32_bf16 v[212:215], v[116:119], a[172:175], v[212:215]
v_mfma_f32_16x16x32_bf16 v[200:203], v[120:123], a[168:171], v[200:203]
v_mfma_f32_16x16x32_bf16 v[216:219], v[120:123], a[172:175], v[216:219]
v_mfma_f32_16x16x32_bf16 v[204:207], v[124:127], a[168:171], v[204:207]
s_waitcnt lgkmcnt(0)
s_barrier
v_mfma_f32_16x16x32_bf16 v[220:223], v[124:127], a[172:175], v[220:223]
s_add_u32 m0, s76, 98304
s_add_u32 s77, s100, 0x0
v_mfma_f32_16x16x32_bf16 v[192:195], v[80:83], a[176:179], v[192:195]
buffer_load_dwordx4 v42, s[48:51], s77 offen offset:0 lds
v_mfma_f32_16x16x32_bf16 v[208:211], v[80:83], a[180:183], v[208:211]
ds_read_b64_tr_b16 v[112:113], v10 offset:0
ds_read_b64_tr_b16 v[114:115], v10 offset:16384
v_mfma_f32_16x16x32_bf16 v[196:199], v[84:87], a[176:179], v[196:199]
ds_read_b64_tr_b16 v[116:117], v11 offset:0
v_mfma_f32_16x16x32_bf16 v[212:215], v[84:87], a[180:183], v[212:215]
ds_read_b64_tr_b16 v[118:119], v11 offset:16384
ds_read_b64_tr_b16 v[120:121], v12 offset:0
v_mfma_f32_16x16x32_bf16 v[200:203], v[88:91], a[176:179], v[200:203]
ds_read_b64_tr_b16 v[122:123], v12 offset:16384
v_mfma_f32_16x16x32_bf16 v[216:219], v[88:91], a[180:183], v[216:219]
buffer_load_dwordx4 v43, s[48:51], s77 offen offset:1024 lds
v_mfma_f32_16x16x32_bf16 v[204:207], v[92:95], a[176:179], v[204:207]
ds_read_b64_tr_b16 v[124:125], v13 offset:0
ds_read_b64_tr_b16 v[126:127], v13 offset:16384
v_mfma_f32_16x16x32_bf16 v[220:223], v[92:95], a[180:183], v[220:223]
ds_read_b64_tr_b16 v[80:81], v10 offset:1024
v_mfma_f32_16x16x32_bf16 v[192:195], v[96:99], a[184:187], v[192:195]
ds_read_b64_tr_b16 v[82:83], v10 offset:17408
ds_read_b64_tr_b16 v[84:85], v11 offset:1024
v_mfma_f32_16x16x32_bf16 v[208:211], v[96:99], a[188:191], v[208:211]
ds_read_b64_tr_b16 v[86:87], v11 offset:17408
v_mfma_f32_16x16x32_bf16 v[196:199], v[100:103], a[184:187], v[196:199]
buffer_load_dwordx4 v44, s[48:51], s77 offen offset:2048 lds
v_mfma_f32_16x16x32_bf16 v[212:215], v[100:103], a[188:191], v[212:215]
ds_read_b64_tr_b16 v[88:89], v12 offset:1024
ds_read_b64_tr_b16 v[90:91], v12 offset:17408
v_mfma_f32_16x16x32_bf16 v[200:203], v[104:107], a[184:187], v[200:203]
ds_read_b64_tr_b16 v[92:93], v13 offset:1024
v_mfma_f32_16x16x32_bf16 v[216:219], v[104:107], a[188:191], v[216:219]
ds_read_b64_tr_b16 v[94:95], v13 offset:17408
ds_read_b64_tr_b16 v[96:97], v10 offset:2048
v_mfma_f32_16x16x32_bf16 v[204:207], v[108:111], a[184:187], v[204:207]
ds_read_b64_tr_b16 v[98:99], v10 offset:18432
v_mfma_f32_16x16x32_bf16 v[220:223], v[108:111], a[188:191], v[220:223]
ds_read_b64_tr_b16 v[100:101], v11 offset:2048
s_waitcnt lgkmcnt(8)
v_mfma_f32_16x16x32_bf16 v[192:195], v[112:115], a[192:195], v[192:195]
buffer_load_dwordx4 v45, s[48:51], s77 offen offset:3072 lds
v_mfma_f32_16x16x32_bf16 v[208:211], v[112:115], a[196:199], v[208:211]
ds_read_b64_tr_b16 v[102:103], v11 offset:18432
ds_read_b64_tr_b16 v[104:105], v12 offset:2048
v_mfma_f32_16x16x32_bf16 v[196:199], v[116:119], a[192:195], v[196:199]
ds_read_b64_tr_b16 v[106:107], v12 offset:18432
v_mfma_f32_16x16x32_bf16 v[212:215], v[116:119], a[196:199], v[212:215]
ds_read_b64_tr_b16 v[108:109], v13 offset:2048
ds_read_b64_tr_b16 v[110:111], v13 offset:18432
v_mfma_f32_16x16x32_bf16 v[200:203], v[120:123], a[192:195], v[200:203]
ds_read_b64_tr_b16 v[112:113], v10 offset:3072
v_mfma_f32_16x16x32_bf16 v[216:219], v[120:123], a[196:199], v[216:219]
s_add_u32 m0, s76, 102400
s_add_u32 s77, s100, 0x40000
v_mfma_f32_16x16x32_bf16 v[204:207], v[124:127], a[192:195], v[204:207]
buffer_load_dwordx4 v38, s[48:51], s77 offen offset:0 lds
v_mfma_f32_16x16x32_bf16 v[220:223], v[124:127], a[196:199], v[220:223]
ds_read_b64_tr_b16 v[114:115], v10 offset:19456
ds_read_b64_tr_b16 v[116:117], v11 offset:3072
v_mfma_f32_16x16x32_bf16 v[192:195], v[80:83], a[200:203], v[192:195]
ds_read_b64_tr_b16 v[118:119], v11 offset:19456
v_mfma_f32_16x16x32_bf16 v[208:211], v[80:83], a[204:207], v[208:211]
ds_read_b64_tr_b16 v[120:121], v12 offset:3072
s_waitcnt lgkmcnt(7)
v_mfma_f32_16x16x32_bf16 v[196:199], v[84:87], a[200:203], v[196:199]
ds_read_b64_tr_b16 v[122:123], v12 offset:19456
ds_read_b64_tr_b16 v[124:125], v13 offset:3072
v_mfma_f32_16x16x32_bf16 v[212:215], v[84:87], a[204:207], v[212:215]
buffer_load_dwordx4 v39, s[48:51], s77 offen offset:1024 lds
v_mfma_f32_16x16x32_bf16 v[200:203], v[88:91], a[200:203], v[200:203]
ds_read_b64_tr_b16 v[126:127], v13 offset:19456
v_mfma_f32_16x16x32_bf16 v[216:219], v[88:91], a[204:207], v[216:219]
buffer_load_dwordx4 v40, s[48:51], s77 offen offset:2048 lds
v_mfma_f32_16x16x32_bf16 v[204:207], v[92:95], a[200:203], v[204:207]
buffer_load_dwordx4 v41, s[48:51], s77 offen offset:3072 lds
v_mfma_f32_16x16x32_bf16 v[220:223], v[92:95], a[204:207], v[220:223]
v_mfma_f32_16x16x32_bf16 v[192:195], v[96:99], a[208:211], v[192:195]
v_mfma_f32_16x16x32_bf16 v[208:211], v[96:99], a[212:215], v[208:211]
s_waitcnt vmcnt(17) lgkmcnt(0)
s_barrier
v_mfma_f32_16x16x32_bf16 v[196:199], v[100:103], a[208:211], v[196:199]
ds_read_b64_tr_b16 v[80:81], v10 offset:32768
s_add_u32 m0, s76, 0
v_mfma_f32_16x16x32_bf16 v[212:215], v[100:103], a[212:215], v[212:215]
ds_read_b64_tr_b16 v[82:83], v10 offset:49152
s_add_u32 s77, s100, 0x50000
v_mfma_f32_16x16x32_bf16 v[200:203], v[104:107], a[208:211], v[200:203]
ds_read_b64_tr_b16 v[84:85], v11 offset:32768
ds_read_b64_tr_b16 v[86:87], v11 offset:49152
v_mfma_f32_16x16x32_bf16 v[216:219], v[104:107], a[212:215], v[216:219]
buffer_load_dwordx4 v38, s[48:51], s77 offen offset:0 lds
v_mfma_f32_16x16x32_bf16 v[204:207], v[108:111], a[208:211], v[204:207]
ds_read_b64_tr_b16 v[88:89], v12 offset:32768
ds_read_b64_tr_b16 v[90:91], v12 offset:49152
v_mfma_f32_16x16x32_bf16 v[220:223], v[108:111], a[212:215], v[220:223]
ds_read_b64_tr_b16 v[92:93], v13 offset:32768
v_mfma_f32_16x16x32_bf16 v[192:195], v[112:115], a[216:219], v[192:195]
ds_read_b64_tr_b16 v[94:95], v13 offset:49152
ds_read_b64_tr_b16 v[96:97], v10 offset:33792
v_mfma_f32_16x16x32_bf16 v[208:211], v[112:115], a[220:223], v[208:211]
ds_read_b64_tr_b16 v[98:99], v10 offset:50176
v_mfma_f32_16x16x32_bf16 v[196:199], v[116:119], a[216:219], v[196:199]
buffer_load_dwordx4 v39, s[48:51], s77 offen offset:1024 lds
v_mfma_f32_16x16x32_bf16 v[212:215], v[116:119], a[220:223], v[212:215]
ds_read_b64_tr_b16 v[100:101], v11 offset:33792
ds_read_b64_tr_b16 v[102:103], v11 offset:50176
v_mfma_f32_16x16x32_bf16 v[200:203], v[120:123], a[216:219], v[200:203]
ds_read_b64_tr_b16 v[104:105], v12 offset:33792
v_mfma_f32_16x16x32_bf16 v[216:219], v[120:123], a[220:223], v[216:219]
ds_read_b64_tr_b16 v[106:107], v12 offset:50176
ds_read_b64_tr_b16 v[108:109], v13 offset:33792
v_mfma_f32_16x16x32_bf16 v[204:207], v[124:127], a[216:219], v[204:207]
ds_read_b64_tr_b16 v[110:111], v13 offset:50176
v_mfma_f32_16x16x32_bf16 v[220:223], v[124:127], a[220:223], v[220:223]
buffer_load_dwordx4 v40, s[48:51], s77 offen offset:2048 lds
S_D3:
s_waitcnt lgkmcnt(7)
v_mfma_f32_16x16x32_bf16 v[128:131], v[80:83], a[0:3], 0
s_lshl_b32 s78, s73, 4
s_add_u32 s78, s78, s19
s_lshl_b32 s78, s78, 10
s_add_u32 s78, s78, 32896
s_lshl_b32 s79, s72, 7
s_add_u32 s78, s78, s79
v_mov_b32 v49, s96
v_writelane_b32 v49, s78, 0
v_mfma_f32_16x16x32_bf16 v[144:147], v[80:83], a[4:7], 0
v_writelane_b32 v50, 3, 0
ds_read_b128 v[60:63], v56 offset:256
v_mfma_f32_16x16x32_bf16 v[132:135], v[84:87], a[0:3], 0
ds_read_b64_tr_b16 v[112:113], v10 offset:34816
ds_read_b128 v[64:67], v56 offset:320
v_mfma_f32_16x16x32_bf16 v[148:151], v[84:87], a[4:7], 0
ds_read_b64_tr_b16 v[114:115], v10 offset:51200
v_cvt_pk_bf16_f32 v192, v192, v193
v_mfma_f32_16x16x32_bf16 v[136:139], v[88:91], a[0:3], 0
ds_read_b64_tr_b16 v[116:117], v11 offset:34816
v_cvt_pk_bf16_f32 v193, v194, v195
v_mfma_f32_16x16x32_bf16 v[152:155], v[88:91], a[4:7], 0
ds_read_b64_tr_b16 v[118:119], v11 offset:51200
v_cvt_pk_bf16_f32 v194, v196, v197
v_mfma_f32_16x16x32_bf16 v[140:143], v[92:95], a[0:3], 0
ds_read_b64_tr_b16 v[120:121], v12 offset:34816
v_cvt_pk_bf16_f32 v195, v198, v199
v_mfma_f32_16x16x32_bf16 v[156:159], v[92:95], a[4:7], 0
ds_read_b64_tr_b16 v[122:123], v12 offset:51200
s_waitcnt lgkmcnt(8)
v_mfma_f32_16x16x32_bf16 v[128:131], v[96:99], a[8:11], v[128:131]
ds_read_b64_tr_b16 v[124:125], v13 offset:34816
ds_read_b128 v[68:71], v56 offset:384
v_mfma_f32_16x16x32_bf16 v[144:147], v[96:99], a[12:15], v[144:147]
ds_read_b64_tr_b16 v[126:127], v13 offset:51200
ds_read_b128 v[72:75], v56 offset:448
v_mfma_f32_16x16x32_bf16 v[132:135], v[100:103], a[8:11], v[132:135]
ds_read_b64_tr_b16 v[80:81], v10 offset:35840
v_and_b32 v2, 15, v1
v_mfma_f32_16x16x32_bf16 v[148:151], v[100:103], a[12:15], v[148:151]
ds_read_b64_tr_b16 v[82:83], v10 offset:52224
v_lshlrev_b32 v2, 11, v2
v_mfma_f32_16x16x32_bf16 v[136:139], v[104:107], a[8:11], v[136:139]
ds_read_b64_tr_b16 v[84:85], v11 offset:35840
v_bfe_u32 v3, v1, 4, 1
v_mfma_f32_16x16x32_bf16 v[152:155], v[104:107], a[12:15], v[152:155]
ds_read_b64_tr_b16 v[86:87], v11 offset:52224
v_lshl_add_u32 v2, v3, 5, v2
v_mfma_f32_16x16x32_bf16 v[140:143], v[108:111], a[8:11], v[140:143]
ds_read_b64_tr_b16 v[88:89], v12 offset:35840
v_bfe_u32 v3, v1, 5, 1
v_mfma_f32_16x16x32_bf16 v[156:159], v[108:111], a[12:15], v[156:159]
ds_read_b64_tr_b16 v[90:91], v12 offset:52224
s_waitcnt lgkmcnt(8)
v_mfma_f32_16x16x32_bf16 v[128:131], v[112:115], a[16:19], v[128:131]
ds_read_b64_tr_b16 v[92:93], v13 offset:35840
v_lshl_add_u32 v2, v3, 4, v2
v_mfma_f32_16x16x32_bf16 v[144:147], v[112:115], a[20:23], v[144:147]
ds_read_b64_tr_b16 v[94:95], v13 offset:52224
ds_read_b64_tr_b16 v[96:97], v10 offset:36864
v_mfma_f32_16x16x32_bf16 v[132:135], v[116:119], a[16:19], v[132:135]
buffer_load_dwordx4 v41, s[48:51], s77 offen offset:3072 lds
v_mfma_f32_16x16x32_bf16 v[148:151], v[116:119], a[20:23], v[148:151]
ds_read_b64_tr_b16 v[98:99], v10 offset:53248
ds_read_b64_tr_b16 v[100:101], v11 offset:36864
v_mfma_f32_16x16x32_bf16 v[136:139], v[120:123], a[16:19], v[136:139]
buffer_store_dwordx4 v[192:195], v46, s[60:63], s10 offen offset:0 sc1
v_mfma_f32_16x16x32_bf16 v[152:155], v[120:123], a[20:23], v[152:155]
ds_read_b64_tr_b16 v[102:103], v11 offset:53248
s_waitcnt lgkmcnt(7)
v_mfma_f32_16x16x32_bf16 v[140:143], v[124:127], a[16:19], v[140:143]
ds_read_b64_tr_b16 v[104:105], v12 offset:36864
v_cvt_pk_bf16_f32 v200, v200, v201
v_mfma_f32_16x16x32_bf16 v[156:159], v[124:127], a[20:23], v[156:159]
ds_read_b64_tr_b16 v[106:107], v12 offset:53248
v_cvt_pk_bf16_f32 v201, v202, v203
v_mfma_f32_16x16x32_bf16 v[128:131], v[80:83], a[24:27], v[128:131]
ds_read_b64_tr_b16 v[108:109], v13 offset:36864
v_cvt_pk_bf16_f32 v202, v204, v205
v_mfma_f32_16x16x32_bf16 v[144:147], v[80:83], a[28:31], v[144:147]
ds_read_b64_tr_b16 v[110:111], v13 offset:53248
v_cvt_pk_bf16_f32 v203, v206, v207
v_mfma_f32_16x16x32_bf16 v[132:135], v[84:87], a[24:27], v[132:135]
ds_read_b64_tr_b16 v[112:113], v10 offset:37888
ds_read_b64_tr_b16 v[114:115], v10 offset:54272
v_mfma_f32_16x16x32_bf16 v[148:151], v[84:87], a[28:31], v[148:151]
ds_read_b64_tr_b16 v[116:117], v11 offset:37888
s_waitcnt lgkmcnt(8)
v_mfma_f32_16x16x32_bf16 v[136:139], v[88:91], a[24:27], v[136:139]
buffer_store_dwordx4 v[200:203], v46, s[60:63], s10 offen offset:1024 sc1
v_mfma_f32_16x16x32_bf16 v[152:155], v[88:91], a[28:31], v[152:155]
ds_read_b64_tr_b16 v[118:119], v11 offset:54272
v_cvt_pk_bf16_f32 v208, v208, v209
v_mfma_f32_16x16x32_bf16 v[140:143], v[92:95], a[24:27], v[140:143]
ds_read_b64_tr_b16 v[120:121], v12 offset:37888
v_cvt_pk_bf16_f32 v209, v210, v211
v_mfma_f32_16x16x32_bf16 v[156:159], v[92:95], a[28:31], v[156:159]
ds_read_b64_tr_b16 v[122:123], v12 offset:54272
v_cvt_pk_bf16_f32 v210, v212, v213
v_mfma_f32_16x16x32_bf16 v[128:131], v[96:99], a[32:35], v[128:131]
ds_read_b64_tr_b16 v[124:125], v13 offset:37888
v_cvt_pk_bf16_f32 v211, v214, v215
v_mfma_f32_16x16x32_bf16 v[144:147], v[96:99], a[36:39], v[144:147]
ds_read_b64_tr_b16 v[126:127], v13 offset:54272
s_waitcnt lgkmcnt(6)
v_mfma_f32_16x16x32_bf16 v[132:135], v[100:103], a[32:35], v[132:135]
ds_read_b64_tr_b16 v[80:81], v10 offset:38912
ds_read_b64_tr_b16 v[82:83], v10 offset:55296
v_mfma_f32_16x16x32_bf16 v[148:151], v[100:103], a[36:39], v[148:151]
buffer_store_dwordx4 v[208:211], v46, s[60:63], s10 offen offset:2048 sc1
v_mfma_f32_16x16x32_bf16 v[136:139], v[104:107], a[32:35], v[136:139]
ds_read_b64_tr_b16 v[84:85], v11 offset:38912
v_cvt_pk_bf16_f32 v216, v216, v217
v_mfma_f32_16x16x32_bf16 v[152:155], v[104:107], a[36:39], v[152:155]
ds_read_b64_tr_b16 v[86:87], v11 offset:55296
v_cvt_pk_bf16_f32 v217, v218, v219
v_mfma_f32_16x16x32_bf16 v[140:143], v[108:111], a[32:35], v[140:143]
ds_read_b64_tr_b16 v[88:89], v12 offset:38912
v_cvt_pk_bf16_f32 v218, v220, v221
v_mfma_f32_16x16x32_bf16 v[156:159], v[108:111], a[36:39], v[156:159]
ds_read_b64_tr_b16 v[90:91], v12 offset:55296
v_cvt_pk_bf16_f32 v219, v222, v223
v_mfma_f32_16x16x32_bf16 v[128:131], v[112:115], a[40:43], v[128:131]
ds_read_b64_tr_b16 v[92:93], v13 offset:38912
ds_read_b64_tr_b16 v[94:95], v13 offset:55296
v_mfma_f32_16x16x32_bf16 v[144:147], v[112:115], a[44:47], v[144:147]
ds_read_b64_tr_b16 v[96:97], v10 offset:39936
s_waitcnt lgkmcnt(7)
v_mfma_f32_16x16x32_bf16 v[132:135], v[116:119], a[40:43], v[132:135]
buffer_store_dwordx4 v[216:219], v46, s[60:63], s10 offen offset:3072 sc1
v_mfma_f32_16x16x32_bf16 v[148:151], v[116:119], a[44:47], v[148:151]
ds_read_b64_tr_b16 v[98:99], v10 offset:56320
ds_read_b64_tr_b16 v[100:101], v11 offset:39936
v_mfma_f32_16x16x32_bf16 v[136:139], v[120:123], a[40:43], v[136:139]
ds_read_b64_tr_b16 v[102:103], v11 offset:56320
v_mfma_f32_16x16x32_bf16 v[152:155], v[120:123], a[44:47], v[152:155]
ds_read_b64_tr_b16 v[104:105], v12 offset:39936
ds_read_b64_tr_b16 v[106:107], v12 offset:56320
v_mfma_f32_16x16x32_bf16 v[140:143], v[124:127], a[40:43], v[140:143]
ds_read_b64_tr_b16 v[108:109], v13 offset:39936
v_mfma_f32_16x16x32_bf16 v[156:159], v[124:127], a[44:47], v[156:159]
ds_read_b64_tr_b16 v[110:111], v13 offset:56320
v_mfma_f32_16x16x32_bf16 v[128:131], v[80:83], a[48:51], v[128:131]
v_mfma_f32_16x16x32_bf16 v[144:147], v[80:83], a[52:55], v[144:147]
s_waitcnt lgkmcnt(7)
v_mfma_f32_16x16x32_bf16 v[132:135], v[84:87], a[48:51], v[132:135]
v_mfma_f32_16x16x32_bf16 v[148:151], v[84:87], a[52:55], v[148:151]
v_mfma_f32_16x16x32_bf16 v[136:139], v[88:91], a[48:51], v[136:139]
s_waitcnt vmcnt(16) lgkmcnt(0)
s_barrier
v_mfma_f32_16x16x32_bf16 v[152:155], v[88:91], a[52:55], v[152:155]
ds_read_b64_tr_b16 v[112:113], v14 offset:0
ds_read_b64_tr_b16 v[114:115], v14 offset:16384
v_mfma_f32_16x16x32_bf16 v[140:143], v[92:95], a[48:51], v[140:143]
ds_read_b64_tr_b16 v[116:117], v15 offset:0
ds_read_b64_tr_b16 v[118:119], v15 offset:16384
v_mfma_f32_16x16x32_bf16 v[156:159], v[92:95], a[52:55], v[156:159]
ds_read_b64_tr_b16 v[120:121], v16 offset:0
ds_read_b64_tr_b16 v[122:123], v16 offset:16384
v_mfma_f32_16x16x32_bf16 v[128:131], v[96:99], a[56:59], v[128:131]
ds_read_b64_tr_b16 v[124:125], v17 offset:0
v_mfma_f32_16x16x32_bf16 v[144:147], v[96:99], a[60:63], v[144:147]
ds_read_b64_tr_b16 v[126:127], v17 offset:16384
ds_read_b64_tr_b16 v[80:81], v14 offset:1024
v_mfma_f32_16x16x32_bf16 v[132:135], v[100:103], a[56:59], v[132:135]
ds_read_b64_tr_b16 v[82:83], v14 offset:17408
v_mfma_f32_16x16x32_bf16 v[148:151], v[100:103], a[60:63], v[148:151]
ds_read_b64_tr_b16 v[84:85], v15 offset:1024
ds_read_b64_tr_b16 v[86:87], v15 offset:17408
v_mfma_f32_16x16x32_bf16 v[136:139], v[104:107], a[56:59], v[136:139]
ds_read_b64_tr_b16 v[88:89], v16 offset:1024
v_mfma_f32_16x16x32_bf16 v[152:155], v[104:107], a[60:63], v[152:155]
ds_read_b64_tr_b16 v[90:91], v16 offset:17408
ds_read_b64_tr_b16 v[92:93], v17 offset:1024
v_mfma_f32_16x16x32_bf16 v[140:143], v[108:111], a[56:59], v[140:143]
ds_read_b64_tr_b16 v[94:95], v17 offset:17408
v_mfma_f32_16x16x32_bf16 v[156:159], v[108:111], a[60:63], v[156:159]
ds_read_b64_tr_b16 v[96:97], v14 offset:2048
s_waitcnt lgkmcnt(10)
v_mfma_f32_16x16x32_bf16 v[128:131], v[112:115], a[64:67], v[128:131]
ds_read_b64_tr_b16 v[98:99], v14 offset:18432
ds_read_b64_tr_b16 v[100:101], v15 offset:2048
v_mfma_f32_16x16x32_bf16 v[144:147], v[112:115], a[68:71], v[144:147]
ds_read_b64_tr_b16 v[102:103], v15 offset:18432
v_mfma_f32_16x16x32_bf16 v[132:135], v[116:119], a[64:67], v[132:135]
ds_read_b64_tr_b16 v[104:105], v16 offset:2048
ds_read_b64_tr_b16 v[106:107], v16 offset:18432
v_mfma_f32_16x16x32_bf16 v[148:151], v[116:119], a[68:71], v[148:151]
ds_read_b64_tr_b16 v[108:109], v17 offset:2048
v_mfma_f32_16x16x32_bf16 v[136:139], v[120:123], a[64:67], v[136:139]
ds_read_b64_tr_b16 v[110:111], v17 offset:18432
ds_read_b64_tr_b16 v[112:113], v14 offset:3072
v_mfma_f32_16x16x32_bf16 v[152:155], v[120:123], a[68:71], v[152:155]
ds_read_b64_tr_b16 v[114:115], v14 offset:19456
s_waitcnt lgkmcnt(10)
v_mfma_f32_16x16x32_bf16 v[140:143], v[124:127], a[64:67], v[140:143]
ds_read_b64_tr_b16 v[116:117], v15 offset:3072
ds_read_b64_tr_b16 v[118:119], v15 offset:19456
v_mfma_f32_16x16x32_bf16 v[156:159], v[124:127], a[68:71], v[156:159]
ds_read_b64_tr_b16 v[120:121], v16 offset:3072
v_mfma_f32_16x16x32_bf16 v[128:131], v[80:83], a[72:75], v[128:131]
ds_read_b64_tr_b16 v[122:123], v16 offset:19456
ds_read_b64_tr_b16 v[124:125], v17 offset:3072
v_mfma_f32_16x16x32_bf16 v[144:147], v[80:83], a[76:79], v[144:147]
ds_read_b64_tr_b16 v[126:127], v17 offset:19456
v_mfma_f32_16x16x32_bf16 v[132:135], v[84:87], a[72:75], v[132:135]
ds_read_b64_tr_b16 v[80:81], v14 offset:4096
v_mfma_f32_16x16x32_bf16 v[148:151], v[84:87], a[76:79], v[148:151]
ds_read_b64_tr_b16 v[82:83], v14 offset:20480
v_mfma_f32_16x16x32_bf16 v[136:139], v[88:91], a[72:75], v[136:139]
ds_read_b64_tr_b16 v[84:85], v15 offset:4096
v_mfma_f32_16x16x32_bf16 v[152:155], v[88:91], a[76:79], v[152:155]
ds_read_b64_tr_b16 v[86:87], v15 offset:20480
v_mfma_f32_16x16x32_bf16 v[140:143], v[92:95], a[72:75], v[140:143]
ds_read_b64_tr_b16 v[88:89], v16 offset:4096
v_mfma_f32_16x16x32_bf16 v[156:159], v[92:95], a[76:79], v[156:159]
ds_read_b64_tr_b16 v[90:91], v16 offset:20480
s_waitcnt lgkmcnt(7)
v_mfma_f32_16x16x32_bf16 v[128:131], v[96:99], a[80:83], v[128:131]
ds_read_b64_tr_b16 v[92:93], v17 offset:4096
v_mfma_f32_16x16x32_bf16 v[144:147], v[96:99], a[84:87], v[144:147]
ds_read_b64_tr_b16 v[94:95], v17 offset:20480
v_mfma_f32_16x16x32_bf16 v[132:135], v[100:103], a[80:83], v[132:135]
ds_read_b64_tr_b16 v[96:97], v14 offset:5120
v_mfma_f32_16x16x32_bf16 v[148:151], v[100:103], a[84:87], v[148:151]
ds_read_b64_tr_b16 v[98:99], v14 offset:21504
v_mfma_f32_16x16x32_bf16 v[136:139], v[104:107], a[80:83], v[136:139]
ds_read_b64_tr_b16 v[100:101], v15 offset:5120
v_mfma_f32_16x16x32_bf16 v[152:155], v[104:107], a[84:87], v[152:155]
ds_read_b64_tr_b16 v[102:103], v15 offset:21504
v_mfma_f32_16x16x32_bf16 v[140:143], v[108:111], a[80:83], v[140:143]
ds_read_b64_tr_b16 v[104:105], v16 offset:5120
v_mfma_f32_16x16x32_bf16 v[156:159], v[108:111], a[84:87], v[156:159]
ds_read_b64_tr_b16 v[106:107], v16 offset:21504
v_mfma_f32_16x16x32_bf16 v[128:131], v[112:115], a[88:91], v[128:131]
ds_read_b64_tr_b16 v[108:109], v17 offset:5120
v_mfma_f32_16x16x32_bf16 v[144:147], v[112:115], a[92:95], v[144:147]
ds_read_b64_tr_b16 v[110:111], v17 offset:21504
v_mfma_f32_16x16x32_bf16 v[132:135], v[116:119], a[88:91], v[132:135]
ds_read_b64_tr_b16 v[112:113], v14 offset:6144
v_mfma_f32_16x16x32_bf16 v[148:151], v[116:119], a[92:95], v[148:151]
ds_read_b64_tr_b16 v[114:115], v14 offset:22528
v_mfma_f32_16x16x32_bf16 v[136:139], v[120:123], a[88:91], v[136:139]
ds_read_b64_tr_b16 v[116:117], v15 offset:6144
v_mfma_f32_16x16x32_bf16 v[152:155], v[120:123], a[92:95], v[152:155]
ds_read_b64_tr_b16 v[118:119], v15 offset:22528
s_waitcnt lgkmcnt(7)
v_mfma_f32_16x16x32_bf16 v[140:143], v[124:127], a[88:91], v[140:143]
ds_read_b64_tr_b16 v[120:121], v16 offset:6144
v_mfma_f32_16x16x32_bf16 v[156:159], v[124:127], a[92:95], v[156:159]
ds_read_b64_tr_b16 v[122:123], v16 offset:22528
v_mfma_f32_16x16x32_bf16 v[128:131], v[80:83], a[96:99], v[128:131]
ds_read_b64_tr_b16 v[124:125], v17 offset:6144
v_mfma_f32_16x16x32_bf16 v[144:147], v[80:83], a[100:103], v[144:147]
ds_read_b64_tr_b16 v[126:127], v17 offset:22528
v_mfma_f32_16x16x32_bf16 v[132:135], v[84:87], a[96:99], v[132:135]
ds_read_b64_tr_b16 v[80:81], v14 offset:7168
v_mfma_f32_16x16x32_bf16 v[148:151], v[84:87], a[100:103], v[148:151]
ds_read_b64_tr_b16 v[82:83], v14 offset:23552
v_mfma_f32_16x16x32_bf16 v[136:139], v[88:91], a[96:99], v[136:139]
ds_read_b64_tr_b16 v[84:85], v15 offset:7168
v_mfma_f32_16x16x32_bf16 v[152:155], v[88:91], a[100:103], v[152:155]
ds_read_b64_tr_b16 v[86:87], v15 offset:23552
v_mfma_f32_16x16x32_bf16 v[140:143], v[92:95], a[96:99], v[140:143]
ds_read_b64_tr_b16 v[88:89], v16 offset:7168
v_mfma_f32_16x16x32_bf16 v[156:159], v[92:95], a[100:103], v[156:159]
s_waitcnt vmcnt(0)
ds_read_b64_tr_b16 v[90:91], v16 offset:23552
v_mfma_f32_16x16x32_bf16 v[128:131], v[96:99], a[104:107], v[128:131]
buffer_atomic_add v52, v55, s[60:63], 0 offen sc1
v_mfma_f32_16x16x32_bf16 v[144:147], v[96:99], a[108:111], v[144:147]
ds_read_b64_tr_b16 v[92:93], v17 offset:7168
ds_read_b64_tr_b16 v[94:95], v17 offset:23552
v_mfma_f32_16x16x32_bf16 v[132:135], v[100:103], a[104:107], v[132:135]
v_mfma_f32_16x16x32_bf16 v[148:151], v[100:103], a[108:111], v[148:151]
s_waitcnt lgkmcnt(5)
v_mfma_f32_16x16x32_bf16 v[136:139], v[104:107], a[104:107], v[136:139]
v_mfma_f32_16x16x32_bf16 v[152:155], v[104:107], a[108:111], v[152:155]
v_mfma_f32_16x16x32_bf16 v[140:143], v[108:111], a[104:107], v[140:143]
s_waitcnt lgkmcnt(0)
s_barrier
v_mfma_f32_16x16x32_bf16 v[156:159], v[108:111], a[108:111], v[156:159]
ds_read_b64_tr_b16 v[96:97], v14 offset:32768
ds_read_b64_tr_b16 v[98:99], v14 offset:49152
v_mfma_f32_16x16x32_bf16 v[128:131], v[112:115], a[112:115], v[128:131]
ds_read_b64_tr_b16 v[100:101], v15 offset:32768
v_mfma_f32_16x16x32_bf16 v[144:147], v[112:115], a[116:119], v[144:147]
ds_read_b64_tr_b16 v[102:103], v15 offset:49152
ds_read_b64_tr_b16 v[104:105], v16 offset:32768
v_mfma_f32_16x16x32_bf16 v[132:135], v[116:119], a[112:115], v[132:135]
ds_read_b64_tr_b16 v[106:107], v16 offset:49152
v_mfma_f32_16x16x32_bf16 v[148:151], v[116:119], a[116:119], v[148:151]
ds_read_b64_tr_b16 v[108:109], v17 offset:32768
ds_read_b64_tr_b16 v[110:111], v17 offset:49152
v_mfma_f32_16x16x32_bf16 v[136:139], v[120:123], a[112:115], v[136:139]
ds_read_b64_tr_b16 v[112:113], v14 offset:33792
v_mfma_f32_16x16x32_bf16 v[152:155], v[120:123], a[116:119], v[152:155]
ds_read_b64_tr_b16 v[114:115], v14 offset:50176
ds_read_b64_tr_b16 v[116:117], v15 offset:33792
v_mfma_f32_16x16x32_bf16 v[140:143], v[124:127], a[112:115], v[140:143]
ds_read_b64_tr_b16 v[118:119], v15 offset:50176
v_mfma_f32_16x16x32_bf16 v[156:159], v[124:127], a[116:119], v[156:159]
ds_read_b64_tr_b16 v[120:121], v16 offset:33792
ds_read_b64_tr_b16 v[122:123], v16 offset:50176
v_mfma_f32_16x16x32_bf16 v[128:131], v[80:83], a[120:123], v[128:131]
ds_read_b64_tr_b16 v[124:125], v17 offset:33792
v_mfma_f32_16x16x32_bf16 v[144:147], v[80:83], a[124:127], v[144:147]
ds_read_b64_tr_b16 v[126:127], v17 offset:50176
v_mfma_f32_16x16x32_bf16 v[132:135], v[84:87], a[120:123], v[132:135]
ds_read_b64_tr_b16 v[80:81], v14 offset:34816
v_mfma_f32_16x16x32_bf16 v[148:151], v[84:87], a[124:127], v[148:151]
ds_read_b64_tr_b16 v[82:83], v14 offset:51200
v_mfma_f32_16x16x32_bf16 v[136:139], v[88:91], a[120:123], v[136:139]
ds_read_b64_tr_b16 v[84:85], v15 offset:34816
v_mfma_f32_16x16x32_bf16 v[152:155], v[88:91], a[124:127], v[152:155]
ds_read_b64_tr_b16 v[86:87], v15 offset:51200
v_mfma_f32_16x16x32_bf16 v[140:143], v[92:95], a[120:123], v[140:143]
ds_read_b64_tr_b16 v[88:89], v16 offset:34816
v_mfma_f32_16x16x32_bf16 v[156:159], v[92:95], a[124:127], v[156:159]
ds_read_b64_tr_b16 v[90:91], v16 offset:51200
s_waitcnt lgkmcnt(7)
v_mfma_f32_16x16x32_bf16 v[128:131], v[96:99], a[128:131], v[128:131]
ds_read_b64_tr_b16 v[92:93], v17 offset:34816
v_mfma_f32_16x16x32_bf16 v[144:147], v[96:99], a[132:135], v[144:147]
ds_read_b64_tr_b16 v[94:95], v17 offset:51200
v_mfma_f32_16x16x32_bf16 v[132:135], v[100:103], a[128:131], v[132:135]
ds_read_b64_tr_b16 v[96:97], v14 offset:35840
v_mfma_f32_16x16x32_bf16 v[148:151], v[100:103], a[132:135], v[148:151]
ds_read_b64_tr_b16 v[98:99], v14 offset:52224
v_mfma_f32_16x16x32_bf16 v[136:139], v[104:107], a[128:131], v[136:139]
ds_read_b64_tr_b16 v[100:101], v15 offset:35840
v_mfma_f32_16x16x32_bf16 v[152:155], v[104:107], a[132:135], v[152:155]
ds_read_b64_tr_b16 v[102:103], v15 offset:52224
v_mfma_f32_16x16x32_bf16 v[140:143], v[108:111], a[128:131], v[140:143]
ds_read_b64_tr_b16 v[104:105], v16 offset:35840
v_mfma_f32_16x16x32_bf16 v[156:159], v[108:111], a[132:135], v[156:159]
ds_read_b64_tr_b16 v[106:107], v16 offset:52224
v_mfma_f32_16x16x32_bf16 v[128:131], v[112:115], a[136:139], v[128:131]
ds_read_b64_tr_b16 v[108:109], v17 offset:35840
v_mfma_f32_16x16x32_bf16 v[144:147], v[112:115], a[140:143], v[144:147]
ds_read_b64_tr_b16 v[110:111], v17 offset:52224
v_mfma_f32_16x16x32_bf16 v[132:135], v[116:119], a[136:139], v[132:135]
ds_read_b64_tr_b16 v[112:113], v14 offset:36864
v_mfma_f32_16x16x32_bf16 v[148:151], v[116:119], a[140:143], v[148:151]
ds_read_b64_tr_b16 v[114:115], v14 offset:53248
v_mfma_f32_16x16x32_bf16 v[136:139], v[120:123], a[136:139], v[136:139]
ds_read_b64_tr_b16 v[116:117], v15 offset:36864
v_mfma_f32_16x16x32_bf16 v[152:155], v[120:123], a[140:143], v[152:155]
ds_read_b64_tr_b16 v[118:119], v15 offset:53248
s_waitcnt lgkmcnt(7)
v_mfma_f32_16x16x32_bf16 v[140:143], v[124:127], a[136:139], v[140:143]
ds_read_b64_tr_b16 v[120:121], v16 offset:36864
v_mfma_f32_16x16x32_bf16 v[156:159], v[124:127], a[140:143], v[156:159]
ds_read_b64_tr_b16 v[122:123], v16 offset:53248
v_mfma_f32_16x16x32_bf16 v[128:131], v[80:83], a[144:147], v[128:131]
ds_read_b64_tr_b16 v[124:125], v17 offset:36864
v_mfma_f32_16x16x32_bf16 v[144:147], v[80:83], a[148:151], v[144:147]
ds_read_b64_tr_b16 v[126:127], v17 offset:53248
v_mfma_f32_16x16x32_bf16 v[132:135], v[84:87], a[144:147], v[132:135]
ds_read_b64_tr_b16 v[80:81], v14 offset:37888
v_mfma_f32_16x16x32_bf16 v[148:151], v[84:87], a[148:151], v[148:151]
ds_read_b64_tr_b16 v[82:83], v14 offset:54272
v_mfma_f32_16x16x32_bf16 v[136:139], v[88:91], a[144:147], v[136:139]
ds_read_b64_tr_b16 v[84:85], v15 offset:37888
v_mfma_f32_16x16x32_bf16 v[152:155], v[88:91], a[148:151], v[152:155]
ds_read_b64_tr_b16 v[86:87], v15 offset:54272
v_mfma_f32_16x16x32_bf16 v[140:143], v[92:95], a[144:147], v[140:143]
ds_read_b64_tr_b16 v[88:89], v16 offset:37888
v_mfma_f32_16x16x32_bf16 v[156:159], v[92:95], a[148:151], v[156:159]
ds_read_b64_tr_b16 v[90:91], v16 offset:54272
v_mfma_f32_16x16x32_bf16 v[128:131], v[96:99], a[152:155], v[128:131]
ds_read_b64_tr_b16 v[92:93], v17 offset:37888
v_mfma_f32_16x16x32_bf16 v[144:147], v[96:99], a[156:159], v[144:147]
ds_read_b64_tr_b16 v[94:95], v17 offset:54272
v_mfma_f32_16x16x32_bf16 v[132:135], v[100:103], a[152:155], v[132:135]
ds_read_b64_tr_b16 v[96:97], v14 offset:38912
v_mfma_f32_16x16x32_bf16 v[148:151], v[100:103], a[156:159], v[148:151]
ds_read_b64_tr_b16 v[98:99], v14 offset:55296
s_waitcnt lgkmcnt(7)
v_mfma_f32_16x16x32_bf16 v[136:139], v[104:107], a[152:155], v[136:139]
ds_read_b64_tr_b16 v[100:101], v15 offset:38912
v_mfma_f32_16x16x32_bf16 v[152:155], v[104:107], a[156:159], v[152:155]
ds_read_b64_tr_b16 v[102:103], v15 offset:55296
v_mfma_f32_16x16x32_bf16 v[140:143], v[108:111], a[152:155], v[140:143]
ds_read_b64_tr_b16 v[104:105], v16 offset:38912
v_mfma_f32_16x16x32_bf16 v[156:159], v[108:111], a[156:159], v[156:159]
ds_read_b64_tr_b16 v[106:107], v16 offset:55296
v_mfma_f32_16x16x32_bf16 v[128:131], v[112:115], a[160:163], v[128:131]
ds_read_b64_tr_b16 v[108:109], v17 offset:38912
v_mfma_f32_16x16x32_bf16 v[144:147], v[112:115], a[164:167], v[144:147]
ds_read_b64_tr_b16 v[110:111], v17 offset:55296
v_mfma_f32_16x16x32_bf16 v[132:135], v[116:119], a[160:163], v[132:135]
ds_read_b64_tr_b16 v[112:113], v14 offset:39936
v_mfma_f32_16x16x32_bf16 v[148:151], v[116:119], a[164:167], v[148:151]
ds_read_b64_tr_b16 v[114:115], v14 offset:56320
v_mfma_f32_16x16x32_bf16 v[136:139], v[120:123], a[160:163], v[136:139]
ds_read_b64_tr_b16 v[116:117], v15 offset:39936
v_mfma_f32_16x16x32_bf16 v[152:155], v[120:123], a[164:167], v[152:155]
ds_read_b64_tr_b16 v[118:119], v15 offset:56320
v_mfma_f32_16x16x32_bf16 v[140:143], v[124:127], a[160:163], v[140:143]
ds_read_b64_tr_b16 v[120:121], v16 offset:39936
v_mfma_f32_16x16x32_bf16 v[156:159], v[124:127], a[164:167], v[156:159]
ds_read_b64_tr_b16 v[122:123], v16 offset:56320
v_mfma_f32_16x16x32_bf16 v[128:131], v[80:83], a[168:171], v[128:131]
ds_read_b64_tr_b16 v[124:125], v17 offset:39936
v_mfma_f32_16x16x32_bf16 v[144:147], v[80:83], a[172:175], v[144:147]
ds_read_b64_tr_b16 v[126:127], v17 offset:56320
s_waitcnt lgkmcnt(7)
v_mfma_f32_16x16x32_bf16 v[132:135], v[84:87], a[168:171], v[132:135]
v_mfma_f32_16x16x32_bf16 v[148:151], v[84:87], a[172:175], v[148:151]
v_mfma_f32_16x16x32_bf16 v[136:139], v[88:91], a[168:171], v[136:139]
v_mfma_f32_16x16x32_bf16 v[152:155], v[88:91], a[172:175], v[152:155]
v_mfma_f32_16x16x32_bf16 v[140:143], v[92:95], a[168:171], v[140:143]
s_waitcnt lgkmcnt(0)
s_barrier
v_mfma_f32_16x16x32_bf16 v[156:159], v[92:95], a[172:175], v[156:159]
ds_read_b64_tr_b16 v[80:81], v10 offset:0
ds_read_b64_tr_b16 v[82:83], v10 offset:16384
v_mfma_f32_16x16x32_bf16 v[128:131], v[96:99], a[176:179], v[128:131]
ds_read_b64_tr_b16 v[84:85], v11 offset:0
v_mfma_f32_16x16x32_bf16 v[144:147], v[96:99], a[180:183], v[144:147]
ds_read_b64_tr_b16 v[86:87], v11 offset:16384
ds_read_b64_tr_b16 v[88:89], v12 offset:0
v_mfma_f32_16x16x32_bf16 v[132:135], v[100:103], a[176:179], v[132:135]
ds_read_b64_tr_b16 v[90:91], v12 offset:16384
v_mfma_f32_16x16x32_bf16 v[148:151], v[100:103], a[180:183], v[148:151]
ds_read_b64_tr_b16 v[92:93], v13 offset:0
ds_read_b64_tr_b16 v[94:95], v13 offset:16384
v_mfma_f32_16x16x32_bf16 v[136:139], v[104:107], a[176:179], v[136:139]
ds_read_b64_tr_b16 v[96:97], v10 offset:1024
v_mfma_f32_16x16x32_bf16 v[152:155], v[104:107], a[180:183], v[152:155]
ds_read_b64_tr_b16 v[98:99], v10 offset:17408
ds_read_b64_tr_b16 v[100:101], v11 offset:1024
v_mfma_f32_16x16x32_bf16 v[140:143], v[108:111], a[176:179], v[140:143]
ds_read_b64_tr_b16 v[102:103], v11 offset:17408
v_mfma_f32_16x16x32_bf16 v[156:159], v[108:111], a[180:183], v[156:159]
ds_read_b64_tr_b16 v[104:105], v12 offset:1024
ds_read_b64_tr_b16 v[106:107], v12 offset:17408
v_mfma_f32_16x16x32_bf16 v[128:131], v[112:115], a[184:187], v[128:131]
ds_read_b64_tr_b16 v[108:109], v13 offset:1024
v_mfma_f32_16x16x32_bf16 v[144:147], v[112:115], a[188:191], v[144:147]
ds_read_b64_tr_b16 v[110:111], v13 offset:17408
v_mfma_f32_16x16x32_bf16 v[132:135], v[116:119], a[184:187], v[132:135]
ds_read_b64_tr_b16 v[112:113], v10 offset:2048
v_mfma_f32_16x16x32_bf16 v[148:151], v[116:119], a[188:191], v[148:151]
ds_read_b64_tr_b16 v[114:115], v10 offset:18432
v_mfma_f32_16x16x32_bf16 v[136:139], v[120:123], a[184:187], v[136:139]
ds_read_b64_tr_b16 v[116:117], v11 offset:2048
v_mfma_f32_16x16x32_bf16 v[152:155], v[120:123], a[188:191], v[152:155]
ds_read_b64_tr_b16 v[118:119], v11 offset:18432
v_mfma_f32_16x16x32_bf16 v[140:143], v[124:127], a[184:187], v[140:143]
ds_read_b64_tr_b16 v[120:121], v12 offset:2048
v_mfma_f32_16x16x32_bf16 v[156:159], v[124:127], a[188:191], v[156:159]
ds_read_b64_tr_b16 v[122:123], v12 offset:18432
s_waitcnt lgkmcnt(7)
v_mfma_f32_16x16x32_bf16 v[128:131], v[80:83], a[192:195], v[128:131]
ds_read_b64_tr_b16 v[124:125], v13 offset:2048
v_mfma_f32_16x16x32_bf16 v[144:147], v[80:83], a[196:199], v[144:147]
ds_read_b64_tr_b16 v[126:127], v13 offset:18432
v_mfma_f32_16x16x32_bf16 v[132:135], v[84:87], a[192:195], v[132:135]
ds_read_b64_tr_b16 v[80:81], v10 offset:3072
v_mfma_f32_16x16x32_bf16 v[148:151], v[84:87], a[196:199], v[148:151]
ds_read_b64_tr_b16 v[82:83], v10 offset:19456
v_mfma_f32_16x16x32_bf16 v[136:139], v[88:91], a[192:195], v[136:139]
ds_read_b64_tr_b16 v[84:85], v11 offset:3072
v_mfma_f32_16x16x32_bf16 v[152:155], v[88:91], a[196:199], v[152:155]
ds_read_b64_tr_b16 v[86:87], v11 offset:19456
v_mfma_f32_16x16x32_bf16 v[140:143], v[92:95], a[192:195], v[140:143]
ds_read_b64_tr_b16 v[88:89], v12 offset:3072
v_mfma_f32_16x16x32_bf16 v[156:159], v[92:95], a[196:199], v[156:159]
ds_read_b64_tr_b16 v[90:91], v12 offset:19456
v_mfma_f32_16x16x32_bf16 v[128:131], v[96:99], a[200:203], v[128:131]
ds_read_b64_tr_b16 v[92:93], v13 offset:3072
v_mfma_f32_16x16x32_bf16 v[144:147], v[96:99], a[204:207], v[144:147]
ds_read_b64_tr_b16 v[94:95], v13 offset:19456
v_mfma_f32_16x16x32_bf16 v[132:135], v[100:103], a[200:203], v[132:135]
v_mfma_f32_16x16x32_bf16 v[148:151], v[100:103], a[204:207], v[148:151]
v_mfma_f32_16x16x32_bf16 v[136:139], v[104:107], a[200:203], v[136:139]
v_mfma_f32_16x16x32_bf16 v[152:155], v[104:107], a[204:207], v[152:155]
s_waitcnt lgkmcnt(3)
v_mfma_f32_16x16x32_bf16 v[140:143], v[108:111], a[200:203], v[140:143]
v_mfma_f32_16x16x32_bf16 v[156:159], v[108:111], a[204:207], v[156:159]
v_mfma_f32_16x16x32_bf16 v[128:131], v[112:115], a[208:211], v[128:131]
v_mfma_f32_16x16x32_bf16 v[144:147], v[112:115], a[212:215], v[144:147]
v_mfma_f32_16x16x32_bf16 v[132:135], v[116:119], a[208:211], v[132:135]
v_mfma_f32_16x16x32_bf16 v[148:151], v[116:119], a[212:215], v[148:151]
v_mfma_f32_16x16x32_bf16 v[136:139], v[120:123], a[208:211], v[136:139]
v_mfma_f32_16x16x32_bf16 v[152:155], v[120:123], a[212:215], v[152:155]
v_mfma_f32_16x16x32_bf16 v[140:143], v[124:127], a[208:211], v[140:143]
v_mfma_f32_16x16x32_bf16 v[156:159], v[124:127], a[212:215], v[156:159]
v_mfma_f32_16x16x32_bf16 v[128:131], v[80:83], a[216:219], v[128:131]
v_mfma_f32_16x16x32_bf16 v[144:147], v[80:83], a[220:223], v[144:147]
v_mfma_f32_16x16x32_bf16 v[132:135], v[84:87], a[216:219], v[132:135]
v_mfma_f32_16x16x32_bf16 v[148:151], v[84:87], a[220:223], v[148:151]
s_waitcnt lgkmcnt(0)
v_mfma_f32_16x16x32_bf16 v[136:139], v[88:91], a[216:219], v[136:139]
v_mfma_f32_16x16x32_bf16 v[152:155], v[88:91], a[220:223], v[152:155]
v_mfma_f32_16x16x32_bf16 v[140:143], v[92:95], a[216:219], v[140:143]
v_mfma_f32_16x16x32_bf16 v[156:159], v[92:95], a[220:223], v[156:159]
v_mov_b32 v51, 0
buffer_atomic_add v51, v49, s[60:63], 0 offen sc0 sc1
s_waitcnt vmcnt(0)
v_cmp_lt_u32 vcc, v51, v50
s_cbranch_vccnz pl_9_slow
pl_9_ok:
s_add_u32 s78, s11, 0
buffer_load_dwordx4 v[160:163], v46, s[60:63], s78 offen offset:0 sc1
buffer_load_dwordx4 v[164:167], v46, s[60:63], s78 offen offset:1024 sc1
buffer_load_dwordx4 v[168:171], v46, s[60:63], s78 offen offset:2048 sc1
buffer_load_dwordx4 v[172:175], v46, s[60:63], s78 offen offset:3072 sc1
s_add_u32 s78, s11, 4096
buffer_load_dwordx4 v[176:179], v46, s[60:63], s78 offen offset:0 sc1
buffer_load_dwordx4 v[180:183], v46, s[60:63], s78 offen offset:1024 sc1
buffer_load_dwordx4 v[184:187], v46, s[60:63], s78 offen offset:2048 sc1
buffer_load_dwordx4 v[188:191], v46, s[60:63], s78 offen offset:3072 sc1
s_add_u32 s78, s11, 8192
buffer_load_dwordx4 v[240:243], v46, s[60:63], s78 offen offset:0 sc1
buffer_load_dwordx4 v[244:247], v46, s[60:63], s78 offen offset:1024 sc1
buffer_load_dwordx4 v[248:251], v46, s[60:63], s78 offen offset:2048 sc1
buffer_load_dwordx4 v[252:255], v46, s[60:63], s78 offen offset:3072 sc1
s_add_u32 s91, s88, s83
s_add_u32 s7, s91, 32768
v_lshlrev_b32 v192, 16, v224
v_and_b32 v193, 0xffff0000, v224
v_lshlrev_b32 v194, 16, v225
v_and_b32 v195, 0xffff0000, v225
v_lshlrev_b32 v196, 16, v226
v_and_b32 v197, 0xffff0000, v226
v_lshlrev_b32 v198, 16, v227
v_and_b32 v199, 0xffff0000, v227
v_lshlrev_b32 v200, 16, v228
v_and_b32 v201, 0xffff0000, v228
v_lshlrev_b32 v202, 16, v229
v_and_b32 v203, 0xffff0000, v229
v_lshlrev_b32 v204, 16, v230
v_and_b32 v205, 0xffff0000, v230
v_lshlrev_b32 v206, 16, v231
v_and_b32 v207, 0xffff0000, v231
v_lshlrev_b32 v208, 16, v232
v_and_b32 v209, 0xffff0000, v232
v_lshlrev_b32 v210, 16, v233
v_and_b32 v211, 0xffff0000, v233
v_lshlrev_b32 v212, 16, v234
v_and_b32 v213, 0xffff0000, v234
v_lshlrev_b32 v214, 16, v235
v_and_b32 v215, 0xffff0000, v235
v_lshlrev_b32 v216, 16, v236
v_and_b32 v217, 0xffff0000, v236
v_lshlrev_b32 v218, 16, v237
v_and_b32 v219, 0xffff0000, v237
v_lshlrev_b32 v220, 16, v238
v_and_b32 v221, 0xffff0000, v238
v_lshlrev_b32 v222, 16, v239
v_and_b32 v223, 0xffff0000, v239
s_waitcnt vmcnt(11)
v_lshlrev_b32 v80, 16, v160
v_and_b32 v81, 0xffff0000, v160
v_lshlrev_b32 v82, 16, v161
v_and_b32 v83, 0xffff0000, v161
v_lshlrev_b32 v84, 16, v162
v_and_b32 v85, 0xffff0000, v162
v_lshlrev_b32 v86, 16, v163
v_and_b32 v87, 0xffff0000, v163
v_pk_add_f32 v[128:129], v[128:129], v[80:81]
v_pk_add_f32 v[130:131], v[130:131], v[82:83]
v_pk_add_f32 v[132:133], v[132:133], v[84:85]
v_pk_add_f32 v[134:135], v[134:135], v[86:87]
s_waitcnt vmcnt(10)
v_lshlrev_b32 v88, 16, v164
v_and_b32 v89, 0xffff0000, v164
v_lshlrev_b32 v90, 16, v165
v_and_b32 v91, 0xffff0000, v165
v_lshlrev_b32 v92, 16, v166
v_and_b32 v93, 0xffff0000, v166
v_lshlrev_b32 v94, 16, v167
v_and_b32 v95, 0xffff0000, v167
v_pk_add_f32 v[136:137], v[136:137], v[88:89]
v_pk_add_f32 v[138:139], v[138:139], v[90:91]
v_pk_add_f32 v[140:141], v[140:141], v[92:93]
v_pk_add_f32 v[142:143], v[142:143], v[94:95]
s_waitcnt vmcnt(9)
v_lshlrev_b32 v96, 16, v168
v_and_b32 v97, 0xffff0000, v168
v_lshlrev_b32 v98, 16, v169
v_and_b32 v99, 0xffff0000, v169
v_lshlrev_b32 v100, 16, v170
v_and_b32 v101, 0xffff0000, v170
v_lshlrev_b32 v102, 16, v171
v_and_b32 v103, 0xffff0000, v171
v_pk_add_f32 v[144:145], v[144:145], v[96:97]
v_pk_add_f32 v[146:147], v[146:147], v[98:99]
v_pk_add_f32 v[148:149], v[148:149], v[100:101]
v_pk_add_f32 v[150:151], v[150:151], v[102:103]
s_waitcnt vmcnt(8)
v_lshlrev_b32 v104, 16, v172
v_and_b32 v105, 0xffff0000, v172
v_lshlrev_b32 v106, 16, v173
v_and_b32 v107, 0xffff0000, v173
v_lshlrev_b32 v108, 16, v174
v_and_b32 v109, 0xffff0000, v174
v_lshlrev_b32 v110, 16, v175
v_and_b32 v111, 0xffff0000, v175
v_pk_add_f32 v[152:153], v[152:153], v[104:105]
v_pk_add_f32 v[154:155], v[154:155], v[106:107]
v_pk_add_f32 v[156:157], v[156:157], v[108:109]
v_pk_add_f32 v[158:159], v[158:159], v[110:111]
s_waitcnt vmcnt(7)
v_lshlrev_b32 v80, 16, v176
v_and_b32 v81, 0xffff0000, v176
v_lshlrev_b32 v82, 16, v177
v_and_b32 v83, 0xffff0000, v177
v_lshlrev_b32 v84, 16, v178
v_and_b32 v85, 0xffff0000, v178
v_lshlrev_b32 v86, 16, v179
v_and_b32 v87, 0xffff0000, v179
v_pk_add_f32 v[128:129], v[128:129], v[80:81]
v_pk_add_f32 v[130:131], v[130:131], v[82:83]
v_pk_add_f32 v[132:133], v[132:133], v[84:85]
v_pk_add_f32 v[134:135], v[134:135], v[86:87]
s_waitcnt vmcnt(6)
v_lshlrev_b32 v88, 16, v180
v_and_b32 v89, 0xffff0000, v180
v_lshlrev_b32 v90, 16, v181
v_and_b32 v91, 0xffff0000, v181
v_lshlrev_b32 v92, 16, v182
v_and_b32 v93, 0xffff0000, v182
v_lshlrev_b32 v94, 16, v183
v_and_b32 v95, 0xffff0000, v183
v_pk_add_f32 v[136:137], v[136:137], v[88:89]
v_pk_add_f32 v[138:139], v[138:139], v[90:91]
v_pk_add_f32 v[140:141], v[140:141], v[92:93]
v_pk_add_f32 v[142:143], v[142:143], v[94:95]
s_waitcnt vmcnt(5)
v_lshlrev_b32 v96, 16, v184
v_and_b32 v97, 0xffff0000, v184
v_lshlrev_b32 v98, 16, v185
v_and_b32 v99, 0xffff0000, v185
v_lshlrev_b32 v100, 16, v186
v_and_b32 v101, 0xffff0000, v186
v_lshlrev_b32 v102, 16, v187
v_and_b32 v103, 0xffff0000, v187
v_pk_add_f32 v[144:145], v[144:145], v[96:97]
v_pk_add_f32 v[146:147], v[146:147], v[98:99]
v_pk_add_f32 v[148:149], v[148:149], v[100:101]
v_pk_add_f32 v[150:151], v[150:151], v[102:103]
s_waitcnt vmcnt(4)
v_lshlrev_b32 v104, 16, v188
v_and_b32 v105, 0xffff0000, v188
v_lshlrev_b32 v106, 16, v189
v_and_b32 v107, 0xffff0000, v189
v_lshlrev_b32 v108, 16, v190
v_and_b32 v109, 0xffff0000, v190
v_lshlrev_b32 v110, 16, v191
v_and_b32 v111, 0xffff0000, v191
v_pk_add_f32 v[152:153], v[152:153], v[104:105]
v_pk_add_f32 v[154:155], v[154:155], v[106:107]
v_pk_add_f32 v[156:157], v[156:157], v[108:109]
v_pk_add_f32 v[158:159], v[158:159], v[110:111]
s_waitcnt vmcnt(3)
v_lshlrev_b32 v80, 16, v240
v_and_b32 v81, 0xffff0000, v240
v_lshlrev_b32 v82, 16, v241
v_and_b32 v83, 0xffff0000, v241
v_lshlrev_b32 v84, 16, v242
v_and_b32 v85, 0xffff0000, v242
v_lshlrev_b32 v86, 16, v243
v_and_b32 v87, 0xffff0000, v243
v_pk_add_f32 v[128:129], v[128:129], v[80:81]
v_pk_add_f32 v[130:131], v[130:131], v[82:83]
v_pk_add_f32 v[132:133], v[132:133], v[84:85]
v_pk_add_f32 v[134:135], v[134:135], v[86:87]
s_waitcnt vmcnt(2)
v_lshlrev_b32 v88, 16, v244
v_and_b32 v89, 0xffff0000, v244
v_lshlrev_b32 v90, 16, v245
v_and_b32 v91, 0xffff0000, v245
v_lshlrev_b32 v92, 16, v246
v_and_b32 v93, 0xffff0000, v246
v_lshlrev_b32 v94, 16, v247
v_and_b32 v95, 0xffff0000, v247
v_pk_add_f32 v[136:137], v[136:137], v[88:89]
v_pk_add_f32 v[138:139], v[138:139], v[90:91]
v_pk_add_f32 v[140:141], v[140:141], v[92:93]
v_pk_add_f32 v[142:143], v[142:143], v[94:95]
s_waitcnt vmcnt(1)
v_lshlrev_b32 v96, 16, v248
v_and_b32 v97, 0xffff0000, v248
v_lshlrev_b32 v98, 16, v249
v_and_b32 v99, 0xffff0000, v249
v_lshlrev_b32 v100, 16, v250
v_and_b32 v101, 0xffff0000, v250
v_lshlrev_b32 v102, 16, v251
v_and_b32 v103, 0xffff0000, v251
v_pk_add_f32 v[144:145], v[144:145], v[96:97]
v_pk_add_f32 v[146:147], v[146:147], v[98:99]
v_pk_add_f32 v[148:149], v[148:149], v[100:101]
v_pk_add_f32 v[150:151], v[150:151], v[102:103]
s_waitcnt vmcnt(0)
v_lshlrev_b32 v104, 16, v252
v_and_b32 v105, 0xffff0000, v252
v_lshlrev_b32 v106, 16, v253
v_and_b32 v107, 0xffff0000, v253
v_lshlrev_b32 v108, 16, v254
v_and_b32 v109, 0xffff0000, v254
v_lshlrev_b32 v110, 16, v255
v_and_b32 v111, 0xffff0000, v255
v_pk_add_f32 v[152:153], v[152:153], v[104:105]
v_pk_add_f32 v[154:155], v[154:155], v[106:107]
v_pk_add_f32 v[156:157], v[156:157], v[108:109]
v_pk_add_f32 v[158:159], v[158:159], v[110:111]
v_pk_fma_f32 v[128:129], v[128:129], v[60:61], v[192:193]
v_pk_fma_f32 v[130:131], v[130:131], v[62:63], v[194:195]
v_pk_fma_f32 v[132:133], v[132:133], v[64:65], v[196:197]
v_pk_fma_f32 v[134:135], v[134:135], v[66:67], v[198:199]
v_cvt_pk_bf16_f32 v128, v128, v129
v_cvt_pk_bf16_f32 v129, v130, v131
v_cvt_pk_bf16_f32 v130, v132, v133
v_cvt_pk_bf16_f32 v131, v134, v135
s_nop 0
v_permlane16_swap_b32 v128, v130
v_permlane16_swap_b32 v129, v131
buffer_store_dwordx4 v[128:131], v2, s[64:67], s91 offen offset:0
v_pk_fma_f32 v[136:137], v[136:137], v[68:69], v[200:201]
v_pk_fma_f32 v[138:139], v[138:139], v[70:71], v[202:203]
v_pk_fma_f32 v[140:141], v[140:141], v[72:73], v[204:205]
v_pk_fma_f32 v[142:143], v[142:143], v[74:75], v[206:207]
v_cvt_pk_bf16_f32 v136, v136, v137
v_cvt_pk_bf16_f32 v137, v138, v139
v_cvt_pk_bf16_f32 v138, v140, v141
v_cvt_pk_bf16_f32 v139, v142, v143
s_nop 0
v_permlane16_swap_b32 v136, v138
v_permlane16_swap_b32 v137, v139
buffer_store_dwordx4 v[136:139], v2, s[64:67], s91 offen offset:64
v_pk_fma_f32 v[144:145], v[144:145], v[60:61], v[208:209]
v_pk_fma_f32 v[146:147], v[146:147], v[62:63], v[210:211]
v_pk_fma_f32 v[148:149], v[148:149], v[64:65], v[212:213]
v_pk_fma_f32 v[150:151], v[150:151], v[66:67], v[214:215]
v_cvt_pk_bf16_f32 v144, v144, v145
v_cvt_pk_bf16_f32 v145, v146, v147
v_cvt_pk_bf16_f32 v146, v148, v149
v_cvt_pk_bf16_f32 v147, v150, v151
s_nop 0
v_permlane16_swap_b32 v144, v146
v_permlane16_swap_b32 v145, v147
buffer_store_dwordx4 v[144:147], v2, s[64:67], s7 offen offset:0
v_pk_fma_f32 v[152:153], v[152:153], v[68:69], v[216:217]
v_pk_fma_f32 v[154:155], v[154:155], v[70:71], v[218:219]
v_pk_fma_f32 v[156:157], v[156:157], v[72:73], v[220:221]
v_pk_fma_f32 v[158:159], v[158:159], v[74:75], v[222:223]
v_cvt_pk_bf16_f32 v152, v152, v153
v_cvt_pk_bf16_f32 v153, v154, v155
v_cvt_pk_bf16_f32 v154, v156, v157
v_cvt_pk_bf16_f32 v155, v158, v159
s_nop 0
v_permlane16_swap_b32 v152, v154
v_permlane16_swap_b32 v153, v155
buffer_store_dwordx4 v[152:155], v2, s[64:67], s7 offen offset:64
K_fin:
K_end:
s_endpgm
pl_1_slow:
s_mov_b32 s81, 0
pl_1_loop:
v_mov_b32 v51, 0
buffer_atomic_add v51, v49, s[60:63], 0 offen sc0 sc1
s_add_u32 s81, s81, 1
s_waitcnt vmcnt(0)
v_cmp_lt_u32 vcc, v51, v50
s_cbranch_vccz pl_1_ok
s_cmp_lt_u32 s81, 0x40000
s_cbranch_scc1 pl_1_loop
s_branch pl_1_ok
pl_2_slow:
s_mov_b32 s81, 0
pl_2_loop:
v_mov_b32 v51, 0
buffer_atomic_add v51, v49, s[60:63], 0 offen sc0 sc1
s_add_u32 s81, s81, 1
s_waitcnt vmcnt(0)
v_cmp_lt_u32 vcc, v51, v50
s_cbranch_vccz pl_2_ok
s_cmp_lt_u32 s81, 0x40000
s_cbranch_scc1 pl_2_loop
s_branch pl_2_ok
pl_3_slow:
s_mov_b32 s81, 0
pl_3_loop:
v_mov_b32 v51, 0
buffer_atomic_add v51, v49, s[60:63], 0 offen sc0 sc1
s_add_u32 s81, s81, 1
s_waitcnt vmcnt(0)
v_cmp_lt_u32 vcc, v51, v50
s_cbranch_vccz pl_3_ok
s_cmp_lt_u32 s81, 0x40000
s_cbranch_scc1 pl_3_loop
s_branch pl_3_ok
pl_4_slow:
s_mov_b32 s81, 0
pl_4_loop:
v_mov_b32 v51, 0
buffer_atomic_add v51, v49, s[60:63], 0 offen sc0 sc1
s_add_u32 s81, s81, 1
s_waitcnt vmcnt(0)
v_cmp_lt_u32 vcc, v51, v50
s_cbranch_vccz pl_4_ok
s_cmp_lt_u32 s81, 0x40000
s_cbranch_scc1 pl_4_loop
s_branch pl_4_ok
pl_5_slow:
s_mov_b32 s81, 0
pl_5_loop:
v_mov_b32 v51, 0
buffer_atomic_add v51, v49, s[60:63], 0 offen sc0 sc1
s_add_u32 s81, s81, 1
s_waitcnt vmcnt(0)
v_cmp_lt_u32 vcc, v51, v50
s_cbranch_vccz pl_5_ok
s_cmp_lt_u32 s81, 0x40000
s_cbranch_scc1 pl_5_loop
s_branch pl_5_ok
pl_6_slow:
s_mov_b32 s81, 0
pl_6_loop:
v_mov_b32 v51, 0
buffer_atomic_add v51, v49, s[60:63], 0 offen sc0 sc1
s_add_u32 s81, s81, 1
s_waitcnt vmcnt(0)
v_cmp_lt_u32 vcc, v51, v50
s_cbranch_vccz pl_6_ok
s_cmp_lt_u32 s81, 0x40000
s_cbranch_scc1 pl_6_loop
s_branch pl_6_ok
pl_7_slow:
s_mov_b32 s81, 0
pl_7_loop:
v_mov_b32 v51, 0
buffer_atomic_add v51, v53, s[60:63], 0 offen sc0 sc1
s_add_u32 s81, s81, 1
s_waitcnt vmcnt(0)
v_cmp_lt_u32 vcc, v51, v50
s_cbranch_vccz pl_7_ok
s_cmp_lt_u32 s81, 0x40000
s_cbranch_scc1 pl_7_loop
s_branch pl_7_ok
pl_8_slow:
s_mov_b32 s81, 0
pl_8_loop:
v_mov_b32 v51, 0
buffer_atomic_add v51, v54, s[60:63], 0 offen sc0 sc1
s_add_u32 s81, s81, 1
s_waitcnt vmcnt(0)
v_cmp_lt_u32 vcc, v51, v50
s_cbranch_vccz pl_8_ok
s_cmp_lt_u32 s81, 0x40000
s_cbranch_scc1 pl_8_loop
s_branch pl_8_ok
pl_9_slow:
s_mov_b32 s81, 0
pl_9_loop:
v_mov_b32 v51, 0
buffer_atomic_add v51, v49, s[60:63], 0 offen sc0 sc1
s_add_u32 s81, s81, 1
s_waitcnt vmcnt(0)
v_cmp_lt_u32 vcc, v51, v50
s_cbranch_vccz pl_9_ok
s_cmp_lt_u32 s81, 0x40000
s_cbranch_scc1 pl_9_loop
s_branch pl_9_ok
K_last:
.fill 4096, 4, 0xbf800000
.section .rodata,"a"
.p2align 6
.amdhsa_kernel adaLN_cond__sliding_local_dilated__glu_gated_swiglu__prompt_kernel
  .amdhsa_next_free_vgpr 512
  .amdhsa_next_free_sgpr 102
  .amdhsa_accum_offset 256
  .amdhsa_group_segment_fixed_size 0
  .amdhsa_kernarg_size 96
  .amdhsa_user_sgpr_count 2
  .amdhsa_user_sgpr_kernarg_segment_ptr 1
  .amdhsa_system_sgpr_workgroup_id_x 1
  .amdhsa_float_denorm_mode_32 3
.end_amdhsa_kernel
```

```asm
; @launch grid=(256,1,1) block=(256,1,1) lds=163840
.amdgcn_target "amdgcn-amd-amdhsa--gfx950"
.text
.globl adaLN_cond__sliding_local_dilated__glu_gated_swiglu__prompt_kernel
.p2align 8
.type adaLN_cond__sliding_local_dilated__glu_gated_swiglu__prompt_kernel,@function
adaLN_cond__sliding_local_dilated__glu_gated_swiglu__prompt_kernel:
s_cmp_ge_u32 s2, 256
s_cbranch_scc1 K_end
s_load_dwordx16 s[12:27], s[0:1], 32
s_load_dwordx4 s[4:7], s[0:1], 0
s_load_dwordx2 s[8:9], s[0:1], 16
v_lshrrev_b32 v2, 6, v0
v_and_b32 v1, 63, v0
v_readfirstlane_b32 s72, v2
s_and_b32 s3, s2, 7
s_lshr_b32 s78, s2, 3
s_and_b32 s74, s3, 1
s_lshl_b32 s74, s74, 3
s_and_b32 s79, s78, 7
s_add_u32 s74, s74, s79
s_lshr_b32 s73, s3, 1
s_lshl_b32 s73, s73, 2
s_lshr_b32 s79, s78, 3
s_add_u32 s73, s73, s79
s_mov_b32 s96, 0x7ffffff0
v_lshlrev_b32 v46, 4, v1
v_mov_b32 v52, 1
s_lshl_b32 s76, s72, 13
s_mov_b32 s69, 1
v_mov_b32 v3, 0
s_lshl_b32 s79, s73, 2
s_add_u32 s79, s79, s72
s_lshl_b32 s88, s79, 16
s_mul_i32 s89, s79, 229376
s_lshl_b32 s101, s2, 2
s_add_u32 s101, s101, s72
v_lshlrev_b32 v4, 7, v1
s_and_b32 s78, s74, 7
s_lshl_b32 s78, s78, 15
s_lshl_b32 s91, s73, 18
s_add_u32 s78, s78, s91
s_add_u32 s80, s78, s76
s_lshr_b32 s78, s2, 3
s_lshl_b32 s78, s78, 2
s_add_u32 s78, s78, s72
s_lshl_b32 s78, s78, 10
v_lshl_add_u32 v5, v1, 4, s78
v_min_u32 v5, K_last - K_pc, v5
s_lshr_b32 s78, s2, 6
s_lshl_b32 s78, s78, 9
v_lshl_add_u32 v6, v1, 3, s78
s_waitcnt lgkmcnt(0)
s_getpc_b64 s[0:1]
K_pc:
s_mov_b32 s60, s26
s_mov_b32 s61, s27
s_mov_b32 s62, 0x4800000
s_mov_b32 s63, 0x20000
s_mov_b32 s28, s4
s_mov_b32 s29, s5
s_mov_b32 s30, 0x400000
s_mov_b32 s31, 0x20000
s_cmp_lg_u32 s101, 1
s_cbranch_scc1 K_nz
s_movk_i32 s78, 8192
buffer_store_dword v3, v4, s[60:63], 0 offen sc1
buffer_store_dword v3, v4, s[60:63], s78 offen sc1
s_waitcnt vmcnt(0)
s_atomic_add s69, s[24:25], 0
K_nz:
global_load_dwordx2 v[132:133], v6, s[18:19]
global_load_dword v57, v5, s[0:1]
s_mov_b32 s56, s20
s_mov_b32 s57, s21
s_mov_b32 s58, 0xc00000
s_mov_b32 s59, 0x20000
s_cmp_lg_u32 s72, 0
s_cbranch_scc1 K_g1d
s_bfe_u32 s78, s2, 0x10003
s_and_b32 s79, s2, 7
s_lshl_b32 s79, s79, 1
s_or_b32 s78, s78, s79
s_and_b32 s79, s2, 0x30
s_or_b32 s87, s78, s79
s_lshr_b32 s81, s2, 6
v_lshrrev_b32 v136, 2, v1
s_movk_i32 s79, 12288
v_mul_u32_u24 v136, s79, v136
v_bfe_u32 v137, v1, 4, 1
v_lshlrev_b32 v137, 1, v137
v_and_b32 v138, 3, v1
v_xor_b32 v137, v137, v138
v_lshl_add_u32 v128, v137, 4, v136
v_add_u32 v129, 195584, v128
v_add_u32 v130, 391168, v128
v_add_u32 v131, 586752, v128
s_mul_i32 s78, s81, 3145728
s_lshl_b32 s79, s87, 6
s_add_u32 s78, s78, s79
s_mov_b32 m0, 147456
s_nop 0
buffer_load_dwordx4 v128, s[56:59], s78 offen offset:0 lds
buffer_load_dwordx4 v129, s[56:59], s78 offen offset:1024 lds
buffer_load_dwordx4 v130, s[56:59], s78 offen offset:2048 lds
buffer_load_dwordx4 v131, s[56:59], s78 offen offset:3072 lds
s_mov_b32 m0, 151552
s_add_u32 s78, s78, 786432
buffer_load_dwordx4 v128, s[56:59], s78 offen offset:0 lds
buffer_load_dwordx4 v129, s[56:59], s78 offen offset:1024 lds
buffer_load_dwordx4 v130, s[56:59], s78 offen offset:2048 lds
buffer_load_dwordx4 v131, s[56:59], s78 offen offset:3072 lds
s_mov_b32 m0, 155648
s_add_u32 s78, s78, 786432
buffer_load_dwordx4 v128, s[56:59], s78 offen offset:0 lds
buffer_load_dwordx4 v129, s[56:59], s78 offen offset:1024 lds
buffer_load_dwordx4 v130, s[56:59], s78 offen offset:2048 lds
buffer_load_dwordx4 v131, s[56:59], s78 offen offset:3072 lds
s_mov_b32 m0, 159744
s_add_u32 s78, s78, 786432
buffer_load_dwordx4 v128, s[56:59], s78 offen offset:0 lds
buffer_load_dwordx4 v129, s[56:59], s78 offen offset:1024 lds
buffer_load_dwordx4 v130, s[56:59], s78 offen offset:2048 lds
buffer_load_dwordx4 v131, s[56:59], s78 offen offset:3072 lds
K_g1d:
s_nop 4
buffer_load_dword v57, v4, s[28:31], s80 offen
v_lshrrev_b32 v2, 3, v1
v_lshlrev_b32 v2, 11, v2
v_add_u32 v2, s91, v2
v_and_b32 v3, 7, v1
v_lshrrev_b32 v4, 4, v1
v_xor_b32 v3, v3, v4
v_lshl_add_u32 v192, v3, 4, v2
v_xor_b32 v193, 64, v192
v_add_u32 v194, 30720, v192
v_add_u32 v195, 46080, v193
v_add_u32 v193, 15360, v193
s_mov_b32 s32, s6
s_mov_b32 s33, s7
s_mov_b32 s34, 0x600000
s_mov_b32 s35, 0x20000
s_mov_b32 s36, s8
s_mov_b32 s37, s9
s_mov_b32 s38, 0x200000
s_mov_b32 s39, 0x20000
s_mov_b32 s40, s12
s_mov_b32 s41, s13
s_mov_b32 s42, 0x700000
s_mov_b32 s43, 0x20000
s_mov_b32 s44, s14
s_mov_b32 s45, s15
s_mov_b32 s46, 0x700000
s_mov_b32 s47, 0x20000
s_mov_b32 s48, s16
s_mov_b32 s49, s17
s_mov_b32 s50, 0x700000
s_mov_b32 s51, 0x20000
s_mov_b32 s64, s22
s_mov_b32 s65, s23
s_mov_b32 s66, 0x400000
s_mov_b32 s67, 0x20000
s_cmp_ge_u32 s72, 2
s_cselect_b32 s52, s14, s12
s_cselect_b32 s53, s15, s13
s_mov_b32 s54, 0x700000
s_mov_b32 s55, 0x20000
v_bfe_u32 v2, v1, 2, 3
v_and_b32 v3, 6, v2
v_bfe_u32 v4, v1, 1, 1
v_xor_b32 v3, v3, v4
v_lshlrev_b32 v3, 4, v3
v_lshl_add_u32 v3, v2, 7, v3
v_and_b32 v4, 1, v1
v_lshl_add_u32 v3, v4, 3, v3
v_lshrrev_b32 v4, 5, v1
v_lshl_add_u32 v10, v4, 13, v3
v_xor_b32 v11, 32, v10
v_xor_b32 v12, 64, v10
v_xor_b32 v13, 96, v10
v_add_u32 v14, 0x10000, v10
v_add_u32 v15, 0x10000, v11
v_add_u32 v16, 0x10000, v12
v_add_u32 v17, 0x10000, v13
v_lshrrev_b32 v2, 2, v1
v_lshlrev_b32 v2, 6, v2
v_bfe_u32 v3, v1, 1, 1
v_bfe_u32 v4, v1, 4, 1
v_lshl_or_b32 v3, v4, 1, v3
v_lshl_add_u32 v2, v3, 4, v2
v_and_b32 v3, 1, v1
v_lshl_add_u32 v18, v3, 3, v2
v_xor_b32 v19, 32, v18
v_add_u32 v20, 0x10000, v18
v_add_u32 v21, 0x10000, v19
v_lshrrev_b32 v2, 3, v1
v_and_b32 v3, 6, v2
v_and_b32 v4, 7, v1
v_xor_b32 v3, v3, v4
v_lshlrev_b32 v3, 4, v3
s_lshl_b32 s78, s72, 3
v_add_u32 v4, s78, v2
s_movk_i32 s79, 2048
v_mad_u32_u24 v26, v4, s79, v3
v_add_u32 v27, 64512, v26
v_add_u32 v28, 129024, v26
v_add_u32 v29, 193536, v26
s_movk_i32 s79, 7168
v_mad_u32_u24 v30, v4, s79, v3
v_add_u32 v31, 228352, v30
v_add_u32 v32, 456704, v30
v_add_u32 v33, 685056, v30
s_movk_i32 s79, 12288
v_mad_u32_u24 v38, v4, s79, v3
v_add_u32 v39, 392192, v38
v_add_u32 v40, 784384, v38
v_add_u32 v41, 1176576, v38
s_and_b32 s78, s72, 1
s_lshl_b32 s78, s78, 4
s_lshr_b32 s79, s72, 1
s_lshl_b32 s79, s79, 2
s_add_u32 s79, s78, s79
v_and_b32 v4, 4, v2
v_add3_u32 v4, v4, v2, s79
s_movk_i32 s79, 6144
v_mad_u32_u24 v22, v4, s79, v3
v_add_u32 v23, 195584, v22
v_add_u32 v24, 391168, v22
v_add_u32 v25, 586752, v22
v_lshrrev_b32 v2, 2, v1
s_movk_i32 s80, 7168
v_mul_u32_u24 v2, s80, v2
v_bfe_u32 v3, v1, 4, 1
v_lshlrev_b32 v3, 1, v3
v_and_b32 v4, 3, v1
v_xor_b32 v3, v3, v4
v_lshl_add_u32 v34, v3, 4, v2
s_mul_i32 s78, s78, 7168
v_add_u32 v34, s78, v34
v_add_u32 v35, 228352, v34
v_add_u32 v36, 456704, v34
v_add_u32 v37, 685056, v34
s_lshl_b32 s82, s74, 7
s_and_b32 s78, s74, 3
s_lshl_b32 s75, s78, 2
s_lshr_b32 s79, s74, 2
s_add_u32 s75, s75, s79
s_lshl_b32 s83, s75, 7
s_lshr_b32 s78, s2, 6
s_mul_i32 s86, s78, 3145728
s_and_b32 s78, s2, 63
s_lshl_b32 s78, s78, 7
s_add_u32 s86, s86, s78
s_add_u32 s86, s86, 4096
v_mov_b32 v53, s96
v_mov_b32 v54, s96
s_lshl_b32 s78, s72, 11
v_lshl_add_u32 v9, v1, 5, s78
v_cmp_gt_u32 vcc, 16, v1
v_mov_b32 v3, s96
v_lshlrev_b32 v2, 7, v1
v_cndmask_b32 v8, v3, v2, vcc
v_cmp_gt_u32 vcc, 8, v1
s_lshr_b32 s100, s2, 4
s_nop 0
v_cndmask_b32 v50, v3, v2, vcc
s_lshl_b32 s100, s100, 7
s_lshl_b32 s90, s73, 4
s_add_u32 s90, s90, s72
s_lshl_b32 s90, s90, 10
s_add_u32 s90, s90, 33408
s_lshr_b32 s78, s2, 3
s_lshl_b32 s78, s78, 2
s_add_u32 s78, s78, s72
s_mul_i32 s78, s78, 49152
s_and_b32 s79, s74, 8
s_lshl_b32 s79, s79, 7
s_add_u32 s78, s78, s79
s_add_u32 s78, s78, 384
v_and_b32 v2, 7, v1
v_mul_u32_u24 v2, 6144, v2
v_add_u32 v2, s78, v2
v_cndmask_b32 v56, v3, v2, vcc
s_lshr_b32 s78, s2, 3
s_lshl_b32 s78, s78, 15
s_add_u32 s78, s78, s76
v_lshl_add_u32 v2, v1, 10, s78
v_add_u32 v49, v2, v56
v_and_b32 v2, 31, v0
v_mul_u32_u24 v2, 272, v2
v_add_u32 v2, 131328, v2
v_mov_b32 v4, 0
v_mov_b32 v5, 0
v_mov_b32 v6, 0
v_mov_b32 v7, 0
ds_write_b128 v2, v[4:7]
s_waitcnt lgkmcnt(0)
s_mul_i32 s97, s72, 24576
s_lshl_b32 s98, s72, 16
s_cmp_lg_u32 s72, 0
s_cbranch_scc1 K_g1a
s_lshl_b32 s78, s73, 4
s_add_u32 s78, s78, s74
s_lshl_b32 s78, s78, 10
s_add_u32 s78, s78, 32768
v_lshl_add_u32 v5, v1, 7, s78
v_cmp_gt_u32 vcc, 8, v1
v_mov_b32 v6, s96
s_nop 0
v_cndmask_b32 v5, v6, v5, vcc
s_and_b32 s78, s2, 127
s_lshl_b32 s78, s78, 7
s_add_u32 s78, s78, 16384
v_writelane_b32 v5, s78, 8
v_mov_b32 v6, 0
v_mov_b32 v7, 0
buffer_store_dwordx2 v[6:7], v5, s[60:63], 0 offen sc1
s_waitcnt vmcnt(19)
v_lshlrev_b32 v136, 16, v132
v_and_b32 v137, 0xffff0000, v132
v_lshlrev_b32 v138, 16, v133
v_and_b32 v139, 0xffff0000, v133
v_mul_f32 v140, 0xbfb8aa3b, v136
v_mul_f32 v141, 0xbfb8aa3b, v137
v_mul_f32 v142, 0xbfb8aa3b, v138
v_mul_f32 v143, 0xbfb8aa3b, v139
v_exp_f32 v140, v140
v_exp_f32 v141, v141
v_exp_f32 v142, v142
v_exp_f32 v143, v143
v_add_f32 v140, 1.0, v140
v_add_f32 v141, 1.0, v141
v_add_f32 v142, 1.0, v142
v_add_f32 v143, 1.0, v143
v_rcp_f32 v140, v140
v_rcp_f32 v141, v141
v_rcp_f32 v142, v142
v_rcp_f32 v143, v143
v_mul_f32 v136, v136, v140
v_mul_f32 v137, v137, v141
v_mul_f32 v138, v138, v142
v_mul_f32 v139, v139, v143
v_cvt_pk_bf16_f32 v140, v136, v137
v_cvt_pk_bf16_f32 v141, v138, v139
v_lshrrev_b32 v2, 3, v1
v_lshlrev_b32 v2, 6, v2
v_and_b32 v3, 3, v1
v_lshl_add_u32 v2, v3, 4, v2
v_bfe_u32 v3, v1, 2, 1
v_lshl_add_u32 v2, v3, 3, v2
v_add_u32 v2, 143872, v2
ds_write_b64 v2, v[140:141]
v_and_b32 v5, 48, v1
v_add_u32 v5, 143872, v5
s_waitcnt lgkmcnt(0)
ds_read_b128 v[224:227], v5 offset:0
ds_read_b128 v[228:231], v5 offset:64
ds_read_b128 v[232:235], v5 offset:128
ds_read_b128 v[236:239], v5 offset:192
ds_read_b128 v[240:243], v5 offset:256
ds_read_b128 v[244:247], v5 offset:320
ds_read_b128 v[248:251], v5 offset:384
ds_read_b128 v[252:255], v5 offset:448
v_add_u32 v55, 147456, v18
v_add_u32 v51, 147456, v19
s_lshl_b32 s78, s81, 13
s_lshl_b32 s79, s87, 7
s_add_u32 s78, s78, s79
s_add_u32 s78, s78, 524288
v_and_b32 v2, 15, v1
v_and_b32 v3, 48, v1
v_lshl_add_u32 v3, v2, 6, v3
v_add_u32 v3, s78, v3
v_cmp_gt_u32 vcc, 2, v2
v_mov_b32 v4, s96
s_nop 0
v_cndmask_b32 v53, v4, v3, vcc
s_and_b32 s78, s2, 7
s_lshl_b32 s78, s78, 11
v_lshl_add_u32 v3, v1, 7, s78
v_cmp_gt_u32 vcc, 16, v1
s_nop 1
v_cndmask_b32 v54, v4, v3, vcc
s_waitcnt lgkmcnt(0)
K_g1a:
s_nop 4
s_add_u32 m0, s97, 0
s_add_u32 s77, s98, 0
buffer_load_dwordx4 v192, s[28:31], s77 offen offset:0 lds
buffer_load_dwordx4 v193, s[28:31], s77 offen offset:1024 lds
buffer_load_dwordx4 v194, s[28:31], s77 offen offset:2048 lds
buffer_load_dwordx4 v195, s[28:31], s77 offen offset:3072 lds
s_add_u32 m0, s97, 4096
s_add_u32 s77, s98, 128
buffer_load_dwordx4 v192, s[28:31], s77 offen offset:0 lds
buffer_load_dwordx4 v193, s[28:31], s77 offen offset:1024 lds
buffer_load_dwordx4 v194, s[28:31], s77 offen offset:2048 lds
buffer_load_dwordx4 v195, s[28:31], s77 offen offset:3072 lds
s_add_u32 m0, s97, 8192
s_add_u32 s77, s98, 256
buffer_load_dwordx4 v192, s[28:31], s77 offen offset:0 lds
buffer_load_dwordx4 v193, s[28:31], s77 offen offset:1024 lds
buffer_load_dwordx4 v194, s[28:31], s77 offen offset:2048 lds
buffer_load_dwordx4 v195, s[28:31], s77 offen offset:3072 lds
s_add_u32 m0, s97, 12288
s_add_u32 s77, s98, 384
buffer_load_dwordx4 v192, s[28:31], s77 offen offset:0 lds
buffer_load_dwordx4 v193, s[28:31], s77 offen offset:1024 lds
buffer_load_dwordx4 v194, s[28:31], s77 offen offset:2048 lds
buffer_load_dwordx4 v195, s[28:31], s77 offen offset:3072 lds
v_and_b32 v2, 15, v1
v_lshrrev_b32 v3, 1, v2
v_lshrrev_b32 v4, 4, v1
v_xor_b32 v5, v3, v4
v_lshlrev_b32 v5, 4, v5
v_lshl_add_u32 v2, v2, 7, s97
v_add_u32 v196, v2, v5
v_xor_b32 v197, 64, v196
v_lshrrev_b32 v5, 5, v1
v_xor_b32 v5, v5, v3
v_lshl_add_u32 v2, v5, 4, v2
v_and_b32 v4, 1, v4
v_lshl_add_u32 v160, v4, 3, v2
v_xor_b32 v161, 32, v160
v_xor_b32 v162, 64, v160
v_xor_b32 v163, 96, v160
v_mov_b32 v200, 0x3f803f80
v_mov_b32 v201, 0x3f803f80
v_mov_b32 v202, 0x3f803f80
v_mov_b32 v203, 0x3f803f80
s_waitcnt vmcnt(12)
s_cmp_lg_u32 s72, 0
s_cbranch_scc1 K_g1c
v_and_b32 v2, 15, v1
v_cmp_eq_u32 vcc, 1, v2
ds_read_b64_tr_b16 v[80:81], v55 offset:0
ds_read_b64_tr_b16 v[82:83], v55 offset:1024
ds_read_b64_tr_b16 v[84:85], v51 offset:0
ds_read_b64_tr_b16 v[86:87], v51 offset:1024
ds_read_b64_tr_b16 v[88:89], v55 offset:2048
ds_read_b64_tr_b16 v[90:91], v55 offset:3072
ds_read_b64_tr_b16 v[92:93], v51 offset:2048
ds_read_b64_tr_b16 v[94:95], v51 offset:3072
ds_read_b64_tr_b16 v[96:97], v55 offset:4096
ds_read_b64_tr_b16 v[98:99], v55 offset:5120
ds_read_b64_tr_b16 v[100:101], v51 offset:4096
ds_read_b64_tr_b16 v[102:103], v51 offset:5120
ds_read_b64_tr_b16 v[104:105], v55 offset:6144
ds_read_b64_tr_b16 v[106:107], v55 offset:7168
ds_read_b64_tr_b16 v[108:109], v51 offset:6144
ds_read_b64_tr_b16 v[110:111], v51 offset:7168
ds_read_b64_tr_b16 v[112:113], v55 offset:8192
ds_read_b64_tr_b16 v[114:115], v55 offset:9216
ds_read_b64_tr_b16 v[116:117], v51 offset:8192
ds_read_b64_tr_b16 v[118:119], v51 offset:9216
ds_read_b64_tr_b16 v[120:121], v55 offset:10240
ds_read_b64_tr_b16 v[122:123], v55 offset:11264
ds_read_b64_tr_b16 v[124:125], v51 offset:10240
ds_read_b64_tr_b16 v[126:127], v51 offset:11264
ds_read_b64_tr_b16 v[128:129], v55 offset:12288
ds_read_b64_tr_b16 v[130:131], v55 offset:13312
ds_read_b64_tr_b16 v[132:133], v51 offset:12288
ds_read_b64_tr_b16 v[134:135], v51 offset:13312
ds_read_b64_tr_b16 v[136:137], v55 offset:14336
ds_read_b64_tr_b16 v[138:139], v55 offset:15360
ds_read_b64_tr_b16 v[140:141], v51 offset:14336
ds_read_b64_tr_b16 v[142:143], v51 offset:15360
s_waitcnt lgkmcnt(15)
v_mfma_f32_16x16x32_bf16 v[144:147], v[80:83], v[224:227], 0
v_mfma_f32_16x16x32_bf16 v[148:151], v[84:87], v[224:227], 0
v_mfma_f32_16x16x32_bf16 v[144:147], v[88:91], v[228:231], v[144:147]
v_mfma_f32_16x16x32_bf16 v[148:151], v[92:95], v[228:231], v[148:151]
v_mfma_f32_16x16x32_bf16 v[144:147], v[96:99], v[232:235], v[144:147]
v_mfma_f32_16x16x32_bf16 v[148:151], v[100:103], v[232:235], v[148:151]
v_mfma_f32_16x16x32_bf16 v[144:147], v[104:107], v[236:239], v[144:147]
v_mfma_f32_16x16x32_bf16 v[148:151], v[108:111], v[236:239], v[148:151]
s_waitcnt lgkmcnt(14)
v_mfma_f32_16x16x32_bf16 v[144:147], v[112:115], v[240:243], v[144:147]
s_waitcnt lgkmcnt(12)
v_mfma_f32_16x16x32_bf16 v[148:151], v[116:119], v[240:243], v[148:151]
s_waitcnt lgkmcnt(10)
v_mfma_f32_16x16x32_bf16 v[144:147], v[120:123], v[244:247], v[144:147]
s_waitcnt lgkmcnt(8)
v_mfma_f32_16x16x32_bf16 v[148:151], v[124:127], v[244:247], v[148:151]
s_waitcnt lgkmcnt(6)
v_mfma_f32_16x16x32_bf16 v[144:147], v[128:131], v[248:251], v[144:147]
s_waitcnt lgkmcnt(4)
v_mfma_f32_16x16x32_bf16 v[148:151], v[132:135], v[248:251], v[148:151]
s_waitcnt lgkmcnt(2)
v_mfma_f32_16x16x32_bf16 v[144:147], v[136:139], v[252:255], v[144:147]
s_waitcnt lgkmcnt(0)
v_mfma_f32_16x16x32_bf16 v[148:151], v[140:143], v[252:255], v[148:151]
s_nop 7
v_cndmask_b32 v144, v144, v148, vcc
v_cndmask_b32 v145, v145, v149, vcc
v_cndmask_b32 v146, v146, v150, vcc
v_cndmask_b32 v147, v147, v151, vcc
buffer_store_dwordx4 v[144:147], v53, s[60:63], 0 offen sc1
s_load_dword s87, s[24:25], 0
K_g1c:
s_nop 4
ds_read_b128 a[0:3], v196 offset:0
ds_read_b128 a[4:7], v196 offset:2048
ds_read_b128 a[8:11], v197 offset:0
ds_read_b128 a[12:15], v197 offset:2048
s_add_u32 m0, s97, 16384
s_add_u32 s77, s98, 512
buffer_load_dwordx4 v192, s[28:31], s77 offen offset:0 lds
buffer_load_dwordx4 v193, s[28:31], s77 offen offset:1024 lds
buffer_load_dwordx4 v194, s[28:31], s77 offen offset:2048 lds
buffer_load_dwordx4 v195, s[28:31], s77 offen offset:3072 lds
s_waitcnt vmcnt(12)
ds_read_b128 a[16:19], v196 offset:4096
ds_read_b128 a[20:23], v196 offset:6144
ds_read_b128 a[24:27], v197 offset:4096
ds_read_b128 a[28:31], v197 offset:6144
s_add_u32 m0, s97, 20480
s_add_u32 s77, s98, 640
buffer_load_dwordx4 v192, s[28:31], s77 offen offset:0 lds
buffer_load_dwordx4 v193, s[28:31], s77 offen offset:1024 lds
buffer_load_dwordx4 v194, s[28:31], s77 offen offset:2048 lds
buffer_load_dwordx4 v195, s[28:31], s77 offen offset:3072 lds
s_waitcnt lgkmcnt(7)
v_mfma_f32_16x16x32_bf16 v[164:167], v[200:203], a[0:3], 0
v_mfma_f32_16x16x32_bf16 v[172:175], a[0:3], a[0:3], 0
s_waitcnt lgkmcnt(6)
v_mfma_f32_16x16x32_bf16 v[168:171], v[200:203], a[4:7], 0
v_mfma_f32_16x16x32_bf16 v[176:179], a[4:7], a[4:7], 0
s_waitcnt lgkmcnt(5)
v_mfma_f32_16x16x32_bf16 v[164:167], v[200:203], a[8:11], v[164:167]
v_mfma_f32_16x16x32_bf16 v[172:175], a[8:11], a[8:11], v[172:175]
s_waitcnt lgkmcnt(4)
v_mfma_f32_16x16x32_bf16 v[168:171], v[200:203], a[12:15], v[168:171]
v_mfma_f32_16x16x32_bf16 v[176:179], a[12:15], a[12:15], v[176:179]
s_waitcnt vmcnt(12)
s_cmp_lg_u32 s72, 0
s_cbranch_scc1 K_g1s
s_waitcnt vmcnt(8) lgkmcnt(0)
s_mov_b32 s81, 0
K_dbgchk:
s_cmp_lg_u32 s87, 0
s_cbranch_scc1 K_dbgok
v_mov_b32 v2, 0
s_sleep 4
global_load_dword v3, v2, s[24:25] sc1
s_add_u32 s81, s81, 1
s_waitcnt vmcnt(0)
v_readfirstlane_b32 s87, v3
s_cmp_lt_u32 s81, 0x400000
s_nop 3
s_cbranch_scc1 K_dbgchk
K_dbgok:
buffer_atomic_add v52, v54, s[60:63], 0 offen sc1
s_waitcnt lgkmcnt(0)
K_g1s:
s_nop 4
ds_read_b128 a[32:35], v196 offset:8192
ds_read_b128 a[36:39], v196 offset:10240
ds_read_b128 a[40:43], v197 offset:8192
ds_read_b128 a[44:47], v197 offset:10240
s_add_u32 m0, s97, 0
s_add_u32 s77, s98, 768
buffer_load_dwordx4 v192, s[28:31], s77 offen offset:0 lds
buffer_load_dwordx4 v193, s[28:31], s77 offen offset:1024 lds
buffer_load_dwordx4 v194, s[28:31], s77 offen offset:2048 lds
buffer_load_dwordx4 v195, s[28:31], s77 offen offset:3072 lds
s_waitcnt lgkmcnt(7)
v_mfma_f32_16x16x32_bf16 v[164:167], v[200:203], a[16:19], v[164:167]
v_mfma_f32_16x16x32_bf16 v[172:175], a[16:19], a[16:19], v[172:175]
s_waitcnt lgkmcnt(6)
v_mfma_f32_16x16x32_bf16 v[168:171], v[200:203], a[20:23], v[168:171]
v_mfma_f32_16x16x32_bf16 v[176:179], a[20:23], a[20:23], v[176:179]
s_waitcnt lgkmcnt(5)
v_mfma_f32_16x16x32_bf16 v[164:167], v[200:203], a[24:27], v[164:167]
v_mfma_f32_16x16x32_bf16 v[172:175], a[24:27], a[24:27], v[172:175]
s_waitcnt lgkmcnt(4)
v_mfma_f32_16x16x32_bf16 v[168:171], v[200:203], a[28:31], v[168:171]
v_mfma_f32_16x16x32_bf16 v[176:179], a[28:31], a[28:31], v[176:179]
s_waitcnt vmcnt(12)
ds_read_b128 a[48:51], v196 offset:12288
ds_read_b128 a[52:55], v196 offset:14336
ds_read_b128 a[56:59], v197 offset:12288
ds_read_b128 a[60:63], v197 offset:14336
s_add_u32 m0, s97, 4096
s_add_u32 s77, s98, 896
buffer_load_dwordx4 v192, s[28:31], s77 offen offset:0 lds
buffer_load_dwordx4 v193, s[28:31], s77 offen offset:1024 lds
buffer_load_dwordx4 v194, s[28:31], s77 offen offset:2048 lds
buffer_load_dwordx4 v195, s[28:31], s77 offen offset:3072 lds
s_waitcnt lgkmcnt(7)
v_mfma_f32_16x16x32_bf16 v[164:167], v[200:203], a[32:35], v[164:167]
v_mfma_f32_16x16x32_bf16 v[172:175], a[32:35], a[32:35], v[172:175]
s_waitcnt lgkmcnt(6)
v_mfma_f32_16x16x32_bf16 v[168:171], v[200:203], a[36:39], v[168:171]
v_mfma_f32_16x16x32_bf16 v[176:179], a[36:39], a[36:39], v[176:179]
s_waitcnt lgkmcnt(5)
v_mfma_f32_16x16x32_bf16 v[164:167], v[200:203], a[40:43], v[164:167]
v_mfma_f32_16x16x32_bf16 v[172:175], a[40:43], a[40:43], v[172:175]
s_waitcnt lgkmcnt(4)
v_mfma_f32_16x16x32_bf16 v[168:171], v[200:203], a[44:47], v[168:171]
v_mfma_f32_16x16x32_bf16 v[176:179], a[44:47], a[44:47], v[176:179]
s_waitcnt vmcnt(12)
ds_read_b128 a[64:67], v196 offset:16384
ds_read_b128 a[68:71], v196 offset:18432
ds_read_b128 a[72:75], v197 offset:16384
ds_read_b128 a[76:79], v197 offset:18432
s_add_u32 m0, s97, 8192
s_add_u32 s77, s98, 1024
buffer_load_dwordx4 v192, s[28:31], s77 offen offset:0 lds
buffer_load_dwordx4 v193, s[28:31], s77 offen offset:1024 lds
buffer_load_dwordx4 v194, s[28:31], s77 offen offset:2048 lds
buffer_load_dwordx4 v195, s[28:31], s77 offen offset:3072 lds
s_waitcnt lgkmcnt(7)
v_mfma_f32_16x16x32_bf16 v[164:167], v[200:203], a[48:51], v[164:167]
v_mfma_f32_16x16x32_bf16 v[172:175], a[48:51], a[48:51], v[172:175]
s_waitcnt lgkmcnt(6)
v_mfma_f32_16x16x32_bf16 v[168:171], v[200:203], a[52:55], v[168:171]
v_mfma_f32_16x16x32_bf16 v[176:179], a[52:55], a[52:55], v[176:179]
s_waitcnt lgkmcnt(5)
v_mfma_f32_16x16x32_bf16 v[164:167], v[200:203], a[56:59], v[164:167]
v_mfma_f32_16x16x32_bf16 v[172:175], a[56:59], a[56:59], v[172:175]
s_waitcnt lgkmcnt(4)
v_mfma_f32_16x16x32_bf16 v[168:171], v[200:203], a[60:63], v[168:171]
v_mfma_f32_16x16x32_bf16 v[176:179], a[60:63], a[60:63], v[176:179]
s_waitcnt vmcnt(12)
ds_read_b128 a[80:83], v196 offset:20480
ds_read_b128 a[84:87], v196 offset:22528
ds_read_b128 a[88:91], v197 offset:20480
ds_read_b128 a[92:95], v197 offset:22528
s_add_u32 m0, s97, 12288
s_add_u32 s77, s98, 1152
buffer_load_dwordx4 v192, s[28:31], s77 offen offset:0 lds
buffer_load_dwordx4 v193, s[28:31], s77 offen offset:1024 lds
buffer_load_dwordx4 v194, s[28:31], s77 offen offset:2048 lds
buffer_load_dwordx4 v195, s[28:31], s77 offen offset:3072 lds
s_waitcnt lgkmcnt(7)
v_mfma_f32_16x16x32_bf16 v[164:167], v[200:203], a[64:67], v[164:167]
v_mfma_f32_16x16x32_bf16 v[172:175], a[64:67], a[64:67], v[172:175]
s_waitcnt lgkmcnt(6)
v_mfma_f32_16x16x32_bf16 v[168:171], v[200:203], a[68:71], v[168:171]
v_mfma_f32_16x16x32_bf16 v[176:179], a[68:71], a[68:71], v[176:179]
s_waitcnt lgkmcnt(5)
v_mfma_f32_16x16x32_bf16 v[164:167], v[200:203], a[72:75], v[164:167]
v_mfma_f32_16x16x32_bf16 v[172:175], a[72:75], a[72:75], v[172:175]
s_waitcnt lgkmcnt(4)
v_mfma_f32_16x16x32_bf16 v[168:171], v[200:203], a[76:79], v[168:171]
v_mfma_f32_16x16x32_bf16 v[176:179], a[76:79], a[76:79], v[176:179]
s_waitcnt vmcnt(12)
ds_read_b128 a[96:99], v196 offset:0
ds_read_b128 a[100:103], v196 offset:2048
ds_read_b128 a[104:107], v197 offset:0
ds_read_b128 a[108:111], v197 offset:2048
s_add_u32 m0, s97, 16384
s_add_u32 s77, s98, 1280
buffer_load_dwordx4 v192, s[28:31], s77 offen offset:0 lds
buffer_load_dwordx4 v193, s[28:31], s77 offen offset:1024 lds
buffer_load_dwordx4 v194, s[28:31], s77 offen offset:2048 lds
buffer_load_dwordx4 v195, s[28:31], s77 offen offset:3072 lds
s_waitcnt lgkmcnt(7)
v_mfma_f32_16x16x32_bf16 v[164:167], v[200:203], a[80:83], v[164:167]
v_mfma_f32_16x16x32_bf16 v[172:175], a[80:83], a[80:83], v[172:175]
s_waitcnt lgkmcnt(6)
v_mfma_f32_16x16x32_bf16 v[168:171], v[200:203], a[84:87], v[168:171]
v_mfma_f32_16x16x32_bf16 v[176:179], a[84:87], a[84:87], v[176:179]
s_waitcnt lgkmcnt(5)
v_mfma_f32_16x16x32_bf16 v[164:167], v[200:203], a[88:91], v[164:167]
v_mfma_f32_16x16x32_bf16 v[172:175], a[88:91], a[88:91], v[172:175]
s_waitcnt lgkmcnt(4)
v_mfma_f32_16x16x32_bf16 v[168:171], v[200:203], a[92:95], v[168:171]
v_mfma_f32_16x16x32_bf16 v[176:179], a[92:95], a[92:95], v[176:179]
s_waitcnt vmcnt(12)
ds_read_b128 a[112:115], v196 offset:4096
ds_read_b128 a[116:119], v196 offset:6144
ds_read_b128 a[120:123], v197 offset:4096
ds_read_b128 a[124:127], v197 offset:6144
s_add_u32 m0, s97, 20480
s_add_u32 s77, s98, 1408
buffer_load_dwordx4 v192, s[28:31], s77 offen offset:0 lds
buffer_load_dwordx4 v193, s[28:31], s77 offen offset:1024 lds
buffer_load_dwordx4 v194, s[28:31], s77 offen offset:2048 lds
buffer_load_dwordx4 v195, s[28:31], s77 offen offset:3072 lds
s_waitcnt lgkmcnt(7)
v_mfma_f32_16x16x32_bf16 v[164:167], v[200:203], a[96:99], v[164:167]
v_mfma_f32_16x16x32_bf16 v[172:175], a[96:99], a[96:99], v[172:175]
s_waitcnt lgkmcnt(6)
v_mfma_f32_16x16x32_bf16 v[168:171], v[200:203], a[100:103], v[168:171]
v_mfma_f32_16x16x32_bf16 v[176:179], a[100:103], a[100:103], v[176:179]
s_waitcnt lgkmcnt(5)
v_mfma_f32_16x16x32_bf16 v[164:167], v[200:203], a[104:107], v[164:167]
v_mfma_f32_16x16x32_bf16 v[172:175], a[104:107], a[104:107], v[172:175]
s_waitcnt lgkmcnt(4)
v_mfma_f32_16x16x32_bf16 v[168:171], v[200:203], a[108:111], v[168:171]
v_mfma_f32_16x16x32_bf16 v[176:179], a[108:111], a[108:111], v[176:179]
s_waitcnt vmcnt(12)
ds_read_b128 a[128:131], v196 offset:8192
ds_read_b128 a[132:135], v196 offset:10240
ds_read_b128 a[136:139], v197 offset:8192
ds_read_b128 a[140:143], v197 offset:10240
s_add_u32 m0, s97, 0
s_add_u32 s77, s98, 1536
buffer_load_dwordx4 v192, s[28:31], s77 offen offset:0 lds
buffer_load_dwordx4 v193, s[28:31], s77 offen offset:1024 lds
buffer_load_dwordx4 v194, s[28:31], s77 offen offset:2048 lds
buffer_load_dwordx4 v195, s[28:31], s77 offen offset:3072 lds
s_waitcnt lgkmcnt(7)
v_mfma_f32_16x16x32_bf16 v[164:167], v[200:203], a[112:115], v[164:167]
v_mfma_f32_16x16x32_bf16 v[172:175], a[112:115], a[112:115], v[172:175]
s_waitcnt lgkmcnt(6)
v_mfma_f32_16x16x32_bf16 v[168:171], v[200:203], a[116:119], v[168:171]
v_mfma_f32_16x16x32_bf16 v[176:179], a[116:119], a[116:119], v[176:179]
s_waitcnt lgkmcnt(5)
v_mfma_f32_16x16x32_bf16 v[164:167], v[200:203], a[120:123], v[164:167]
v_mfma_f32_16x16x32_bf16 v[172:175], a[120:123], a[120:123], v[172:175]
s_waitcnt lgkmcnt(4)
v_mfma_f32_16x16x32_bf16 v[168:171], v[200:203], a[124:127], v[168:171]
v_mfma_f32_16x16x32_bf16 v[176:179], a[124:127], a[124:127], v[176:179]
s_load_dword s87, s[24:25], 0
s_waitcnt vmcnt(12)
ds_read_b128 a[144:147], v196 offset:12288
ds_read_b128 a[148:151], v196 offset:14336
ds_read_b128 a[152:155], v197 offset:12288
ds_read_b128 a[156:159], v197 offset:14336
s_add_u32 m0, s97, 4096
s_add_u32 s77, s98, 1664
buffer_load_dwordx4 v192, s[28:31], s77 offen offset:0 lds
buffer_load_dwordx4 v193, s[28:31], s77 offen offset:1024 lds
buffer_load_dwordx4 v194, s[28:31], s77 offen offset:2048 lds
buffer_load_dwordx4 v195, s[28:31], s77 offen offset:3072 lds
s_waitcnt lgkmcnt(7)
v_mfma_f32_16x16x32_bf16 v[164:167], v[200:203], a[128:131], v[164:167]
v_mfma_f32_16x16x32_bf16 v[172:175], a[128:131], a[128:131], v[172:175]
s_waitcnt lgkmcnt(6)
v_mfma_f32_16x16x32_bf16 v[168:171], v[200:203], a[132:135], v[168:171]
v_mfma_f32_16x16x32_bf16 v[176:179], a[132:135], a[132:135], v[176:179]
s_waitcnt lgkmcnt(5)
v_mfma_f32_16x16x32_bf16 v[164:167], v[200:203], a[136:139], v[164:167]
v_mfma_f32_16x16x32_bf16 v[172:175], a[136:139], a[136:139], v[172:175]
s_waitcnt lgkmcnt(4)
v_mfma_f32_16x16x32_bf16 v[168:171], v[200:203], a[140:143], v[168:171]
v_mfma_f32_16x16x32_bf16 v[176:179], a[140:143], a[140:143], v[176:179]
s_waitcnt vmcnt(12)
ds_read_b128 a[160:163], v196 offset:16384
ds_read_b128 a[164:167], v196 offset:18432
ds_read_b128 a[168:171], v197 offset:16384
ds_read_b128 a[172:175], v197 offset:18432
s_add_u32 m0, s97, 8192
s_add_u32 s77, s98, 1792
buffer_load_dwordx4 v192, s[28:31], s77 offen offset:0 lds
buffer_load_dwordx4 v193, s[28:31], s77 offen offset:1024 lds
buffer_load_dwordx4 v194, s[28:31], s77 offen offset:2048 lds
buffer_load_dwordx4 v195, s[28:31], s77 offen offset:3072 lds
s_waitcnt lgkmcnt(7)
v_mfma_f32_16x16x32_bf16 v[164:167], v[200:203], a[144:147], v[164:167]
v_mfma_f32_16x16x32_bf16 v[172:175], a[144:147], a[144:147], v[172:175]
s_waitcnt lgkmcnt(6)
v_mfma_f32_16x16x32_bf16 v[168:171], v[200:203], a[148:151], v[168:171]
v_mfma_f32_16x16x32_bf16 v[176:179], a[148:151], a[148:151], v[176:179]
s_waitcnt lgkmcnt(5)
v_mfma_f32_16x16x32_bf16 v[164:167], v[200:203], a[152:155], v[164:167]
v_mfma_f32_16x16x32_bf16 v[172:175], a[152:155], a[152:155], v[172:175]
s_waitcnt lgkmcnt(4)
v_mfma_f32_16x16x32_bf16 v[168:171], v[200:203], a[156:159], v[168:171]
v_mfma_f32_16x16x32_bf16 v[176:179], a[156:159], a[156:159], v[176:179]
s_waitcnt vmcnt(12)
ds_read_b128 a[176:179], v196 offset:20480
ds_read_b128 a[180:183], v196 offset:22528
ds_read_b128 a[184:187], v197 offset:20480
ds_read_b128 a[188:191], v197 offset:22528
s_add_u32 m0, s97, 12288
s_add_u32 s77, s98, 1920
buffer_load_dwordx4 v192, s[28:31], s77 offen offset:0 lds
buffer_load_dwordx4 v193, s[28:31], s77 offen offset:1024 lds
buffer_load_dwordx4 v194, s[28:31], s77 offen offset:2048 lds
buffer_load_dwordx4 v195, s[28:31], s77 offen offset:3072 lds
s_waitcnt lgkmcnt(7)
v_mfma_f32_16x16x32_bf16 v[164:167], v[200:203], a[160:163], v[164:167]
v_mfma_f32_16x16x32_bf16 v[172:175], a[160:163], a[160:163], v[172:175]
s_waitcnt lgkmcnt(6)
v_mfma_f32_16x16x32_bf16 v[168:171], v[200:203], a[164:167], v[168:171]
v_mfma_f32_16x16x32_bf16 v[176:179], a[164:167], a[164:167], v[176:179]
s_waitcnt lgkmcnt(5)
v_mfma_f32_16x16x32_bf16 v[164:167], v[200:203], a[168:171], v[164:167]
v_mfma_f32_16x16x32_bf16 v[172:175], a[168:171], a[168:171], v[172:175]
s_waitcnt lgkmcnt(4)
v_mfma_f32_16x16x32_bf16 v[168:171], v[200:203], a[172:175], v[168:171]
v_mfma_f32_16x16x32_bf16 v[176:179], a[172:175], a[172:175], v[176:179]
s_waitcnt vmcnt(12)
ds_read_b128 a[192:195], v196 offset:0
ds_read_b128 a[196:199], v196 offset:2048
ds_read_b128 a[200:203], v197 offset:0
ds_read_b128 a[204:207], v197 offset:2048
s_add_u32 m0, s97, 16384
s_add_u32 s77, s98, s83
buffer_load_dwordx4 v192, s[28:31], s77 offen offset:0 lds
buffer_load_dwordx4 v193, s[28:31], s77 offen offset:1024 lds
buffer_load_dwordx4 v194, s[28:31], s77 offen offset:2048 lds
buffer_load_dwordx4 v195, s[28:31], s77 offen offset:3072 lds
s_waitcnt lgkmcnt(7)
v_mfma_f32_16x16x32_bf16 v[164:167], v[200:203], a[176:179], v[164:167]
v_mfma_f32_16x16x32_bf16 v[172:175], a[176:179], a[176:179], v[172:175]
s_waitcnt lgkmcnt(6)
v_mfma_f32_16x16x32_bf16 v[168:171], v[200:203], a[180:183], v[168:171]
v_mfma_f32_16x16x32_bf16 v[176:179], a[180:183], a[180:183], v[176:179]
s_waitcnt lgkmcnt(5)
v_mfma_f32_16x16x32_bf16 v[164:167], v[200:203], a[184:187], v[164:167]
v_mfma_f32_16x16x32_bf16 v[172:175], a[184:187], a[184:187], v[172:175]
s_waitcnt lgkmcnt(4)
v_mfma_f32_16x16x32_bf16 v[168:171], v[200:203], a[188:191], v[168:171]
v_mfma_f32_16x16x32_bf16 v[176:179], a[188:191], a[188:191], v[176:179]
s_cmp_lg_u32 s72, 3
s_cbranch_scc1 h0_noi
s_waitcnt lgkmcnt(0)
s_mov_b32 s81, 0
K_dbhchk:
s_cmp_lg_u32 s87, 0
s_cbranch_scc1 K_dbhok
v_mov_b32 v2, 0
s_sleep 4
global_load_dword v3, v2, s[24:25] sc1
s_add_u32 s81, s81, 1
s_waitcnt vmcnt(0)
v_readfirstlane_b32 s87, v3
s_cmp_lt_u32 s81, 0x400000
s_nop 3
s_cbranch_scc1 K_dbhchk
K_dbhok:
s_mov_b32 s4, 0
s_atomic_add s4, s[60:61], s100 glc
s_mov_b32 s5, 0
s_atomic_add s5, s[60:61], s100 offset:2048 glc
s_mov_b32 s6, 0
s_atomic_add s6, s[60:61], s100 offset:4096 glc
s_mov_b32 s7, 0
s_atomic_add s7, s[60:61], s100 offset:6144 glc
s_mov_b32 s8, 0
s_atomic_add s8, s[60:61], s100 offset:8192 glc
s_mov_b32 s9, 0
s_atomic_add s9, s[60:61], s100 offset:10240 glc
s_mov_b32 s10, 0
s_atomic_add s10, s[60:61], s100 offset:12288 glc
s_mov_b32 s11, 0
s_atomic_add s11, s[60:61], s100 offset:14336 glc
h0_noi:
s_waitcnt vmcnt(12)
ds_read_b128 a[208:211], v196 offset:4096
ds_read_b128 a[212:215], v196 offset:6144
ds_read_b128 a[216:219], v197 offset:4096
ds_read_b128 a[220:223], v197 offset:6144
s_waitcnt lgkmcnt(7)
v_mfma_f32_16x16x32_bf16 v[164:167], v[200:203], a[192:195], v[164:167]
v_mfma_f32_16x16x32_bf16 v[172:175], a[192:195], a[192:195], v[172:175]
s_waitcnt lgkmcnt(6)
v_mfma_f32_16x16x32_bf16 v[168:171], v[200:203], a[196:199], v[168:171]
v_mfma_f32_16x16x32_bf16 v[176:179], a[196:199], a[196:199], v[176:179]
s_waitcnt lgkmcnt(5)
v_mfma_f32_16x16x32_bf16 v[164:167], v[200:203], a[200:203], v[164:167]
v_mfma_f32_16x16x32_bf16 v[172:175], a[200:203], a[200:203], v[172:175]
s_waitcnt lgkmcnt(4)
v_mfma_f32_16x16x32_bf16 v[168:171], v[200:203], a[204:207], v[168:171]
v_mfma_f32_16x16x32_bf16 v[176:179], a[204:207], a[204:207], v[176:179]
s_waitcnt lgkmcnt(0)
s_cmp_lg_u32 s72, 3
s_cbranch_scc1 h0_done
s_mov_b32 s81, 0
h0_loop:
s_min_u32 s4, s4, s5
s_min_u32 s4, s4, s6
s_min_u32 s4, s4, s7
s_min_u32 s4, s4, s8
s_min_u32 s4, s4, s9
s_min_u32 s4, s4, s10
s_min_u32 s4, s4, s11
s_cmp_ge_u32 s4, 32
s_cbranch_scc1 h0_done
s_mov_b32 s4, 0
s_atomic_add s4, s[60:61], s100 glc
s_mov_b32 s5, 0
s_atomic_add s5, s[60:61], s100 offset:2048 glc
s_mov_b32 s6, 0
s_atomic_add s6, s[60:61], s100 offset:4096 glc
s_mov_b32 s7, 0
s_atomic_add s7, s[60:61], s100 offset:6144 glc
s_mov_b32 s8, 0
s_atomic_add s8, s[60:61], s100 offset:8192 glc
s_mov_b32 s9, 0
s_atomic_add s9, s[60:61], s100 offset:10240 glc
s_mov_b32 s10, 0
s_atomic_add s10, s[60:61], s100 offset:12288 glc
s_mov_b32 s11, 0
s_atomic_add s11, s[60:61], s100 offset:14336 glc
s_add_u32 s81, s81, 1
s_cmp_lt_u32 s81, 0x400000
s_waitcnt lgkmcnt(0)
s_cbranch_scc1 h0_loop
h0_done:
s_barrier
v_lshlrev_b32 v2, 4, v0
s_mov_b32 s78, 0x80000
buffer_load_dwordx4 v[80:83], v2, s[60:63], s78 offen sc1
s_mov_b32 s78, 0x82000
buffer_load_dwordx4 v[84:87], v2, s[60:63], s78 offen sc1
s_mov_b32 s78, 0x84000
buffer_load_dwordx4 v[88:91], v2, s[60:63], s78 offen sc1
s_mov_b32 s78, 0x86000
buffer_load_dwordx4 v[92:95], v2, s[60:63], s78 offen sc1
s_mov_b32 s78, 0x81000
buffer_load_dwordx4 v[96:99], v2, s[60:63], s78 offen sc1
s_mov_b32 s78, 0x83000
buffer_load_dwordx4 v[100:103], v2, s[60:63], s78 offen sc1
s_mov_b32 s78, 0x85000
buffer_load_dwordx4 v[104:107], v2, s[60:63], s78 offen sc1
s_mov_b32 s78, 0x87000
buffer_load_dwordx4 v[108:111], v2, s[60:63], s78 offen sc1
s_add_u32 s70, s0, S_K - K_pc + 0
s_addc_u32 s71, s1, 0
global_load_dword v57, v9, s[70:71]
s_mul_i32 s3, s101, 6144
s_add_u32 s3, s3, 0x800
buffer_load_dword v57, v8, s[32:35], s3 offen
s_movk_i32 s3, 2048
buffer_load_dword v57, v56, s[32:35], s3 offen
s_waitcnt vmcnt(19)
ds_read_b128 a[224:227], v196 offset:8192
ds_read_b128 a[228:231], v196 offset:10240
ds_read_b128 a[232:235], v197 offset:8192
ds_read_b128 a[236:239], v197 offset:10240
v_mfma_f32_16x16x32_bf16 v[164:167], v[200:203], a[208:211], v[164:167]
v_mfma_f32_16x16x32_bf16 v[172:175], a[208:211], a[208:211], v[172:175]
v_mfma_f32_16x16x32_bf16 v[168:171], v[200:203], a[212:215], v[168:171]
v_mfma_f32_16x16x32_bf16 v[176:179], a[212:215], a[212:215], v[176:179]
v_mfma_f32_16x16x32_bf16 v[164:167], v[200:203], a[216:219], v[164:167]
v_mfma_f32_16x16x32_bf16 v[172:175], a[216:219], a[216:219], v[172:175]
v_mfma_f32_16x16x32_bf16 v[168:171], v[200:203], a[220:223], v[168:171]
v_mfma_f32_16x16x32_bf16 v[176:179], a[220:223], a[220:223], v[176:179]
s_waitcnt vmcnt(15)
ds_read_b128 a[240:243], v196 offset:12288
ds_read_b128 a[244:247], v196 offset:14336
ds_read_b128 a[248:251], v197 offset:12288
ds_read_b128 a[252:255], v197 offset:14336
s_waitcnt lgkmcnt(7)
v_mfma_f32_16x16x32_bf16 v[164:167], v[200:203], a[224:227], v[164:167]
v_mfma_f32_16x16x32_bf16 v[172:175], a[224:227], a[224:227], v[172:175]
s_waitcnt lgkmcnt(6)
v_mfma_f32_16x16x32_bf16 v[168:171], v[200:203], a[228:231], v[168:171]
v_mfma_f32_16x16x32_bf16 v[176:179], a[228:231], a[228:231], v[176:179]
s_waitcnt lgkmcnt(5)
v_mfma_f32_16x16x32_bf16 v[164:167], v[200:203], a[232:235], v[164:167]
v_mfma_f32_16x16x32_bf16 v[172:175], a[232:235], a[232:235], v[172:175]
s_waitcnt lgkmcnt(4)
v_mfma_f32_16x16x32_bf16 v[168:171], v[200:203], a[236:239], v[168:171]
v_mfma_f32_16x16x32_bf16 v[176:179], a[236:239], a[236:239], v[176:179]
s_waitcnt vmcnt(11)
ds_read_b64 v[216:217], v160 offset:16384
ds_read_b64 v[218:219], v161 offset:16384
ds_read_b64 v[220:221], v162 offset:16384
ds_read_b64 v[222:223], v163 offset:16384
ds_read_b64 v[248:249], v160 offset:18432
ds_read_b64 v[250:251], v161 offset:18432
ds_read_b64 v[252:253], v162 offset:18432
ds_read_b64 v[254:255], v163 offset:18432
s_waitcnt lgkmcnt(11)
v_mfma_f32_16x16x32_bf16 v[164:167], v[200:203], a[240:243], v[164:167]
v_mfma_f32_16x16x32_bf16 v[172:175], a[240:243], a[240:243], v[172:175]
s_waitcnt lgkmcnt(10)
v_mfma_f32_16x16x32_bf16 v[168:171], v[200:203], a[244:247], v[168:171]
v_mfma_f32_16x16x32_bf16 v[176:179], a[244:247], a[244:247], v[176:179]
s_waitcnt lgkmcnt(9)
v_mfma_f32_16x16x32_bf16 v[164:167], v[200:203], a[248:251], v[164:167]
v_mfma_f32_16x16x32_bf16 v[172:175], a[248:251], a[248:251], v[172:175]
s_waitcnt lgkmcnt(8)
v_mfma_f32_16x16x32_bf16 v[168:171], v[200:203], a[252:255], v[168:171]
v_mfma_f32_16x16x32_bf16 v[176:179], a[252:255], a[252:255], v[176:179]
v_and_b32 v2, 3, v1
v_cmp_eq_u32 vcc, 1, v2
s_nop 2
v_cndmask_b32 v172, v172, v173, vcc
s_nop 1
v_cndmask_b32 v176, v176, v177, vcc
v_cmp_eq_u32 vcc, 2, v2
s_nop 1
v_cndmask_b32 v172, v172, v174, vcc
v_cndmask_b32 v176, v176, v178, vcc
v_cmp_eq_u32 vcc, 3, v2
s_nop 1
v_cndmask_b32 v172, v172, v175, vcc
v_cndmask_b32 v176, v176, v179, vcc
v_and_b32 v2, 15, v1
v_lshrrev_b32 v3, 2, v2
v_lshl_add_u32 v2, v3, 4, v2
v_lshlrev_b32 v2, 2, v2
ds_bpermute_b32 v173, v2, v172
ds_bpermute_b32 v177, v2, v176
v_mul_f32 v164, 0x3a800000, v164
v_mul_f32 v168, 0x3a800000, v168
v_mul_f32 v165, v164, v164
v_mul_f32 v169, v168, v168
s_waitcnt lgkmcnt(1)
v_mul_f32 v173, 0x3a800000, v173
s_waitcnt lgkmcnt(0)
v_mul_f32 v177, 0x3a800000, v177
v_sub_f32 v173, v173, v165
v_sub_f32 v177, v177, v169
v_max_f32 v173, 0, v173
v_max_f32 v177, 0, v177
v_cvt_pk_bf16_f32 v166, v173, v173
v_lshlrev_b32 v173, 16, v166
v_cvt_pk_bf16_f32 v170, v177, v177
v_lshlrev_b32 v177, 16, v170
v_add_f32 v173, 0x3727c5ac, v173
v_add_f32 v177, 0x3727c5ac, v177
v_cvt_pk_bf16_f32 v166, v173, v173
v_lshlrev_b32 v173, 16, v166
v_cvt_pk_bf16_f32 v170, v177, v177
v_lshlrev_b32 v177, 16, v170
v_sqrt_f32 v173, v173
v_sqrt_f32 v177, v177
v_sub_f32 v164, 0, v164
v_sub_f32 v168, 0, v168
v_cmp_gt_u32 vcc, 16, v1
v_cvt_pk_bf16_f32 v166, v173, v164
v_cvt_pk_bf16_f32 v170, v177, v168
v_lshlrev_b32 v76, 16, v166
v_lshlrev_b32 v77, 16, v170
v_cndmask_b32 v68, 0, v166, vcc
v_mov_b32 v69, 0
v_mov_b32 v70, 0
v_mov_b32 v71, v68
v_cndmask_b32 v72, 0, v170, vcc
v_mov_b32 v73, 0
v_mov_b32 v74, 0
v_mov_b32 v75, v72
v_rcp_f32 v58, v76
v_rcp_f32 v59, v77
v_and_b32 v2, 48, v1
v_add_u32 v3, 0, v2
v_add_u32 v4, 4, v2
v_add_u32 v5, 8, v2
v_add_u32 v6, 12, v2
ds_bpermute_b32 v60, v3, v58
ds_bpermute_b32 v61, v4, v58
ds_bpermute_b32 v62, v5, v58
ds_bpermute_b32 v63, v6, v58
ds_bpermute_b32 v64, v3, v59
ds_bpermute_b32 v65, v4, v59
ds_bpermute_b32 v66, v5, v59
ds_bpermute_b32 v67, v6, v59
v_lshrrev_b32 v2, 3, v0
v_bfe_u32 v3, v0, 1, 2
v_and_b32 v4, 1, v0
v_mul_u32_u24 v5, 272, v2
v_lshl_add_u32 v5, v3, 6, v5
v_lshl_add_u32 v5, v4, 3, v5
v_add_u32 v5, 131072, v5
v_lshlrev_b32 v6, 7, v2
v_lshl_add_u32 v6, v3, 5, v6
v_lshl_add_u32 v6, v4, 2, v6
v_add_u32 v6, 139776, v6
v_mov_b32 v113, 0
v_mov_b32 v115, 0
v_mov_b32 v116, 0
v_mov_b32 v118, 0
s_waitcnt vmcnt(9)
v_pk_add_f32 v[80:81], v[80:81], v[84:85]
s_waitcnt vmcnt(7)
v_pk_add_f32 v[88:89], v[88:89], v[92:93]
v_pk_add_f32 v[82:83], v[82:83], v[86:87]
v_pk_add_f32 v[90:91], v[90:91], v[94:95]
v_pk_add_f32 v[80:81], v[80:81], v[88:89]
v_pk_add_f32 v[82:83], v[82:83], v[90:91]
s_waitcnt vmcnt(5)
v_pk_add_f32 v[96:97], v[96:97], v[100:101]
s_waitcnt vmcnt(3)
v_pk_add_f32 v[104:105], v[104:105], v[108:109]
v_pk_add_f32 v[98:99], v[98:99], v[102:103]
v_pk_add_f32 v[106:107], v[106:107], v[110:111]
v_pk_add_f32 v[96:97], v[96:97], v[104:105]
v_pk_add_f32 v[98:99], v[98:99], v[106:107]
v_cvt_pk_bf16_f32 v100, v96, v97
v_cvt_pk_bf16_f32 v102, v98, v99
v_lshlrev_b32 v96, 16, v100
v_and_b32 v97, 0xffff0000, v100
v_lshlrev_b32 v98, 16, v102
v_and_b32 v99, 0xffff0000, v102
v_add_f32 v96, 1.0, v96
v_add_f32 v97, 1.0, v97
v_add_f32 v98, 1.0, v98
v_add_f32 v99, 1.0, v99
v_cvt_pk_bf16_f32 v120, v80, v96
v_cvt_pk_bf16_f32 v121, v81, v97
v_cvt_pk_bf16_f32 v122, v82, v98
v_cvt_pk_bf16_f32 v123, v83, v99
v_lshrrev_b32 v112, 16, v120
v_and_b32 v114, 0xffff0000, v121
v_lshrrev_b32 v117, 16, v122
v_and_b32 v119, 0xffff0000, v123
ds_write_b64 v5, v[112:113] offset:0
ds_write_b64 v5, v[114:115] offset:16
ds_write_b64 v5, v[116:117] offset:32
ds_write_b64 v5, v[118:119] offset:48
ds_write2_b32 v6, v120, v121 offset0:0 offset1:2
ds_write2_b32 v6, v122, v123 offset0:4 offset1:6
s_waitcnt lgkmcnt(0)
s_barrier
v_and_b32 v2, 15, v1
v_lshrrev_b32 v3, 2, v2
v_lshrrev_b32 v4, 4, v1
v_cmp_eq_u32 vcc, v3, v4
v_lshlrev_b32 v3, 4, v2
v_mov_b32 v4, 256
v_cndmask_b32 v3, v4, v3, vcc
v_add_u32 v53, 131072, v3
v_lshlrev_b32 v2, 3, v2
v_add_u32 v54, 139776, v2
ds_read_b128 v[128:131], v53 offset:0
ds_read_b64 v[132:133], v54 offset:0
ds_read_b128 v[136:139], v53 offset:272
ds_read_b64 v[140:141], v54 offset:128
ds_read_b128 v[144:147], v53 offset:544
ds_read_b64 v[148:149], v54 offset:256
s_waitcnt lgkmcnt(4)
v_mfma_f32_16x16x16_bf16 v[160:163], v[132:133], v[68:69], 0
v_mfma_f32_16x16x16_bf16 v[164:167], v[132:133], v[70:71], 0
ds_read_b128 v[152:155], v53 offset:816
v_mfma_f32_16x16x16_bf16 v[160:163], v[128:129], a[0:1], v[160:163]
v_mfma_f32_16x16x16_bf16 v[164:167], v[130:131], a[2:3], v[164:167]
v_mfma_f32_16x16x16_bf16 v[168:171], v[132:133], v[72:73], 0
v_mfma_f32_16x16x16_bf16 v[172:175], v[132:133], v[74:75], 0
ds_read_b64 v[156:157], v54 offset:384
v_mfma_f32_16x16x16_bf16 v[168:171], v[128:129], a[4:5], v[168:171]
v_mfma_f32_16x16x16_bf16 v[172:175], v[130:131], a[6:7], v[172:175]
s_waitcnt lgkmcnt(4)
v_mfma_f32_16x16x16_bf16 v[176:179], v[140:141], v[68:69], 0
v_cvt_pk_bf16_f32 v160, v160, v161
v_cvt_pk_bf16_f32 v161, v162, v163
v_mfma_f32_16x16x16_bf16 v[180:183], v[140:141], v[70:71], 0
v_cvt_pk_bf16_f32 v164, v164, v165
v_cvt_pk_bf16_f32 v165, v166, v167
ds_read_b128 v[128:131], v53 offset:1088
v_mfma_f32_16x16x16_bf16 v[176:179], v[136:137], a[8:9], v[176:179]
v_accvgpr_write_b32 a0, v160
v_accvgpr_write_b32 a1, v161
v_mfma_f32_16x16x16_bf16 v[180:183], v[138:139], a[10:11], v[180:183]
v_accvgpr_write_b32 a2, v164
v_accvgpr_write_b32 a3, v165
v_mfma_f32_16x16x16_bf16 v[184:187], v[140:141], v[72:73], 0
v_cvt_pk_bf16_f32 v168, v168, v169
v_cvt_pk_bf16_f32 v169, v170, v171
v_mfma_f32_16x16x16_bf16 v[188:191], v[140:141], v[74:75], 0
v_cvt_pk_bf16_f32 v172, v172, v173
v_cvt_pk_bf16_f32 v173, v174, v175
ds_read_b64 v[132:133], v54 offset:512
v_mfma_f32_16x16x16_bf16 v[184:187], v[136:137], a[12:13], v[184:187]
v_accvgpr_write_b32 a4, v168
v_accvgpr_write_b32 a5, v169
v_mfma_f32_16x16x16_bf16 v[188:191], v[138:139], a[14:15], v[188:191]
v_accvgpr_write_b32 a6, v172
v_accvgpr_write_b32 a7, v173
s_waitcnt lgkmcnt(4)
v_mfma_f32_16x16x16_bf16 v[160:163], v[148:149], v[68:69], 0
v_cvt_pk_bf16_f32 v176, v176, v177
v_cvt_pk_bf16_f32 v177, v178, v179
v_mfma_f32_16x16x16_bf16 v[164:167], v[148:149], v[70:71], 0
v_cvt_pk_bf16_f32 v180, v180, v181
v_cvt_pk_bf16_f32 v181, v182, v183
ds_read_b128 v[136:139], v53 offset:1360
v_mfma_f32_16x16x16_bf16 v[160:163], v[144:145], a[16:17], v[160:163]
v_accvgpr_write_b32 a8, v176
v_accvgpr_write_b32 a9, v177
v_mfma_f32_16x16x16_bf16 v[164:167], v[146:147], a[18:19], v[164:167]
v_accvgpr_write_b32 a10, v180
v_accvgpr_write_b32 a11, v181
s_add_u32 m0, s76, 0
s_add_u32 s77, s82, 0x800
buffer_load_dwordx4 v22, s[32:35], s77 offen offset:0 lds
buffer_load_dwordx4 v23, s[32:35], s77 offen offset:1024 lds
buffer_load_dwordx4 v24, s[32:35], s77 offen offset:2048 lds
buffer_load_dwordx4 v25, s[32:35], s77 offen offset:3072 lds
v_mfma_f32_16x16x16_bf16 v[168:171], v[148:149], v[72:73], 0
v_cvt_pk_bf16_f32 v184, v184, v185
v_cvt_pk_bf16_f32 v185, v186, v187
v_mfma_f32_16x16x16_bf16 v[172:175], v[148:149], v[74:75], 0
v_cvt_pk_bf16_f32 v188, v188, v189
v_cvt_pk_bf16_f32 v189, v190, v191
ds_read_b64 v[140:141], v54 offset:640
v_mfma_f32_16x16x16_bf16 v[168:171], v[144:145], a[20:21], v[168:171]
v_accvgpr_write_b32 a12, v184
v_accvgpr_write_b32 a13, v185
v_mfma_f32_16x16x16_bf16 v[172:175], v[146:147], a[22:23], v[172:175]
v_accvgpr_write_b32 a14, v188
v_accvgpr_write_b32 a15, v189
s_waitcnt lgkmcnt(4)
v_mfma_f32_16x16x16_bf16 v[176:179], v[156:157], v[68:69], 0
v_cvt_pk_bf16_f32 v160, v160, v161
v_cvt_pk_bf16_f32 v161, v162, v163
v_mfma_f32_16x16x16_bf16 v[180:183], v[156:157], v[70:71], 0
v_cvt_pk_bf16_f32 v164, v164, v165
v_cvt_pk_bf16_f32 v165, v166, v167
ds_read_b128 v[144:147], v53 offset:1632
v_mfma_f32_16x16x16_bf16 v[176:179], v[152:153], a[24:25], v[176:179]
v_accvgpr_write_b32 a16, v160
v_accvgpr_write_b32 a17, v161
v_mfma_f32_16x16x16_bf16 v[180:183], v[154:155], a[26:27], v[180:183]
v_accvgpr_write_b32 a18, v164
v_accvgpr_write_b32 a19, v165
v_mfma_f32_16x16x16_bf16 v[184:187], v[156:157], v[72:73], 0
v_cvt_pk_bf16_f32 v168, v168, v169
v_cvt_pk_bf16_f32 v169, v170, v171
v_mfma_f32_16x16x16_bf16 v[188:191], v[156:157], v[74:75], 0
v_cvt_pk_bf16_f32 v172, v172, v173
v_cvt_pk_bf16_f32 v173, v174, v175
ds_read_b64 v[148:149], v54 offset:768
v_mfma_f32_16x16x16_bf16 v[184:187], v[152:153], a[28:29], v[184:187]
v_accvgpr_write_b32 a20, v168
v_accvgpr_write_b32 a21, v169
v_mfma_f32_16x16x16_bf16 v[188:191], v[154:155], a[30:31], v[188:191]
v_accvgpr_write_b32 a22, v172
v_accvgpr_write_b32 a23, v173
s_waitcnt lgkmcnt(4)
v_mfma_f32_16x16x16_bf16 v[160:163], v[132:133], v[68:69], 0
v_cvt_pk_bf16_f32 v176, v176, v177
v_cvt_pk_bf16_f32 v177, v178, v179
v_mfma_f32_16x16x16_bf16 v[164:167], v[132:133], v[70:71], 0
v_cvt_pk_bf16_f32 v180, v180, v181
v_cvt_pk_bf16_f32 v181, v182, v183
ds_read_b128 v[152:155], v53 offset:1904
v_mfma_f32_16x16x16_bf16 v[160:163], v[128:129], a[32:33], v[160:163]
v_accvgpr_write_b32 a24, v176
v_accvgpr_write_b32 a25, v177
v_mfma_f32_16x16x16_bf16 v[164:167], v[130:131], a[34:35], v[164:167]
v_accvgpr_write_b32 a26, v180
v_accvgpr_write_b32 a27, v181
v_mfma_f32_16x16x16_bf16 v[168:171], v[132:133], v[72:73], 0
v_cvt_pk_bf16_f32 v184, v184, v185
v_cvt_pk_bf16_f32 v185, v186, v187
v_mfma_f32_16x16x16_bf16 v[172:175], v[132:133], v[74:75], 0
v_cvt_pk_bf16_f32 v188, v188, v189
v_cvt_pk_bf16_f32 v189, v190, v191
ds_read_b64 v[156:157], v54 offset:896
v_mfma_f32_16x16x16_bf16 v[168:171], v[128:129], a[36:37], v[168:171]
v_accvgpr_write_b32 a28, v184
v_accvgpr_write_b32 a29, v185
v_mfma_f32_16x16x16_bf16 v[172:175], v[130:131], a[38:39], v[172:175]
v_accvgpr_write_b32 a30, v188
v_accvgpr_write_b32 a31, v189
s_add_u32 m0, s76, 4096
s_add_u32 s77, s82, 0xc0800
buffer_load_dwordx4 v22, s[32:35], s77 offen offset:0 lds
buffer_load_dwordx4 v23, s[32:35], s77 offen offset:1024 lds
buffer_load_dwordx4 v24, s[32:35], s77 offen offset:2048 lds
buffer_load_dwordx4 v25, s[32:35], s77 offen offset:3072 lds
s_waitcnt lgkmcnt(4)
v_mfma_f32_16x16x16_bf16 v[176:179], v[140:141], v[68:69], 0
v_cvt_pk_bf16_f32 v160, v160, v161
v_cvt_pk_bf16_f32 v161, v162, v163
v_mfma_f32_16x16x16_bf16 v[180:183], v[140:141], v[70:71], 0
v_cvt_pk_bf16_f32 v164, v164, v165
v_cvt_pk_bf16_f32 v165, v166, v167
ds_read_b128 v[128:131], v53 offset:2176
v_mfma_f32_16x16x16_bf16 v[176:179], v[136:137], a[40:41], v[176:179]
v_accvgpr_write_b32 a32, v160
v_accvgpr_write_b32 a33, v161
v_mfma_f32_16x16x16_bf16 v[180:183], v[138:139], a[42:43], v[180:183]
v_accvgpr_write_b32 a34, v164
v_accvgpr_write_b32 a35, v165
v_mfma_f32_16x16x16_bf16 v[184:187], v[140:141], v[72:73], 0
v_cvt_pk_bf16_f32 v168, v168, v169
v_cvt_pk_bf16_f32 v169, v170, v171
v_mfma_f32_16x16x16_bf16 v[188:191], v[140:141], v[74:75], 0
v_cvt_pk_bf16_f32 v172, v172, v173
v_cvt_pk_bf16_f32 v173, v174, v175
ds_read_b64 v[132:133], v54 offset:1024
v_mfma_f32_16x16x16_bf16 v[184:187], v[136:137], a[44:45], v[184:187]
v_accvgpr_write_b32 a36, v168
v_accvgpr_write_b32 a37, v169
v_mfma_f32_16x16x16_bf16 v[188:191], v[138:139], a[46:47], v[188:191]
v_accvgpr_write_b32 a38, v172
v_accvgpr_write_b32 a39, v173
s_waitcnt lgkmcnt(4)
v_mfma_f32_16x16x16_bf16 v[160:163], v[148:149], v[68:69], 0
v_cvt_pk_bf16_f32 v176, v176, v177
v_cvt_pk_bf16_f32 v177, v178, v179
v_mfma_f32_16x16x16_bf16 v[164:167], v[148:149], v[70:71], 0
v_cvt_pk_bf16_f32 v180, v180, v181
v_cvt_pk_bf16_f32 v181, v182, v183
ds_read_b128 v[136:139], v53 offset:2448
v_mfma_f32_16x16x16_bf16 v[160:163], v[144:145], a[48:49], v[160:163]
v_accvgpr_write_b32 a40, v176
v_accvgpr_write_b32 a41, v177
v_mfma_f32_16x16x16_bf16 v[164:167], v[146:147], a[50:51], v[164:167]
v_accvgpr_write_b32 a42, v180
v_accvgpr_write_b32 a43, v181
v_mfma_f32_16x16x16_bf16 v[168:171], v[148:149], v[72:73], 0
v_cvt_pk_bf16_f32 v184, v184, v185
v_cvt_pk_bf16_f32 v185, v186, v187
v_mfma_f32_16x16x16_bf16 v[172:175], v[148:149], v[74:75], 0
v_cvt_pk_bf16_f32 v188, v188, v189
v_cvt_pk_bf16_f32 v189, v190, v191
ds_read_b64 v[140:141], v54 offset:1152
v_mfma_f32_16x16x16_bf16 v[168:171], v[144:145], a[52:53], v[168:171]
v_accvgpr_write_b32 a44, v184
v_accvgpr_write_b32 a45, v185
v_mfma_f32_16x16x16_bf16 v[172:175], v[146:147], a[54:55], v[172:175]
v_accvgpr_write_b32 a46, v188
v_accvgpr_write_b32 a47, v189
s_waitcnt lgkmcnt(4)
v_mfma_f32_16x16x16_bf16 v[176:179], v[156:157], v[68:69], 0
v_cvt_pk_bf16_f32 v160, v160, v161
v_cvt_pk_bf16_f32 v161, v162, v163
v_mfma_f32_16x16x16_bf16 v[180:183], v[156:157], v[70:71], 0
v_cvt_pk_bf16_f32 v164, v164, v165
v_cvt_pk_bf16_f32 v165, v166, v167
ds_read_b128 v[144:147], v53 offset:2720
v_mfma_f32_16x16x16_bf16 v[176:179], v[152:153], a[56:57], v[176:179]
v_accvgpr_write_b32 a48, v160
v_accvgpr_write_b32 a49, v161
v_mfma_f32_16x16x16_bf16 v[180:183], v[154:155], a[58:59], v[180:183]
v_accvgpr_write_b32 a50, v164
v_accvgpr_write_b32 a51, v165
s_add_u32 m0, s76, 32768
s_add_u32 s77, s82, 0x180800
buffer_load_dwordx4 v22, s[32:35], s77 offen offset:0 lds
buffer_load_dwordx4 v23, s[32:35], s77 offen offset:1024 lds
buffer_load_dwordx4 v24, s[32:35], s77 offen offset:2048 lds
buffer_load_dwordx4 v25, s[32:35], s77 offen offset:3072 lds
v_mfma_f32_16x16x16_bf16 v[184:187], v[156:157], v[72:73], 0
v_cvt_pk_bf16_f32 v168, v168, v169
v_cvt_pk_bf16_f32 v169, v170, v171
v_mfma_f32_16x16x16_bf16 v[188:191], v[156:157], v[74:75], 0
v_cvt_pk_bf16_f32 v172, v172, v173
v_cvt_pk_bf16_f32 v173, v174, v175
ds_read_b64 v[148:149], v54 offset:1280
v_mfma_f32_16x16x16_bf16 v[184:187], v[152:153], a[60:61], v[184:187]
v_accvgpr_write_b32 a52, v168
v_accvgpr_write_b32 a53, v169
v_mfma_f32_16x16x16_bf16 v[188:191], v[154:155], a[62:63], v[188:191]
v_accvgpr_write_b32 a54, v172
v_accvgpr_write_b32 a55, v173
s_waitcnt lgkmcnt(4)
v_mfma_f32_16x16x16_bf16 v[160:163], v[132:133], v[68:69], 0
v_cvt_pk_bf16_f32 v176, v176, v177
v_cvt_pk_bf16_f32 v177, v178, v179
v_mfma_f32_16x16x16_bf16 v[164:167], v[132:133], v[70:71], 0
v_cvt_pk_bf16_f32 v180, v180, v181
v_cvt_pk_bf16_f32 v181, v182, v183
ds_read_b128 v[152:155], v53 offset:2992
v_mfma_f32_16x16x16_bf16 v[160:163], v[128:129], a[64:65], v[160:163]
v_accvgpr_write_b32 a56, v176
v_accvgpr_write_b32 a57, v177
v_mfma_f32_16x16x16_bf16 v[164:167], v[130:131], a[66:67], v[164:167]
v_accvgpr_write_b32 a58, v180
v_accvgpr_write_b32 a59, v181
v_mfma_f32_16x16x16_bf16 v[168:171], v[132:133], v[72:73], 0
v_cvt_pk_bf16_f32 v184, v184, v185
v_cvt_pk_bf16_f32 v185, v186, v187
v_mfma_f32_16x16x16_bf16 v[172:175], v[132:133], v[74:75], 0
v_cvt_pk_bf16_f32 v188, v188, v189
v_cvt_pk_bf16_f32 v189, v190, v191
ds_read_b64 v[156:157], v54 offset:1408
v_mfma_f32_16x16x16_bf16 v[168:171], v[128:129], a[68:69], v[168:171]
v_accvgpr_write_b32 a60, v184
v_accvgpr_write_b32 a61, v185
v_mfma_f32_16x16x16_bf16 v[172:175], v[130:131], a[70:71], v[172:175]
v_accvgpr_write_b32 a62, v188
v_accvgpr_write_b32 a63, v189
s_waitcnt lgkmcnt(4)
v_mfma_f32_16x16x16_bf16 v[176:179], v[140:141], v[68:69], 0
v_cvt_pk_bf16_f32 v160, v160, v161
v_cvt_pk_bf16_f32 v161, v162, v163
v_mfma_f32_16x16x16_bf16 v[180:183], v[140:141], v[70:71], 0
v_cvt_pk_bf16_f32 v164, v164, v165
v_cvt_pk_bf16_f32 v165, v166, v167
ds_read_b128 v[128:131], v53 offset:3264
v_mfma_f32_16x16x16_bf16 v[176:179], v[136:137], a[72:73], v[176:179]
v_accvgpr_write_b32 a64, v160
v_accvgpr_write_b32 a65, v161
v_mfma_f32_16x16x16_bf16 v[180:183], v[138:139], a[74:75], v[180:183]
v_accvgpr_write_b32 a66, v164
v_accvgpr_write_b32 a67, v165
v_mfma_f32_16x16x16_bf16 v[184:187], v[140:141], v[72:73], 0
v_cvt_pk_bf16_f32 v168, v168, v169
v_cvt_pk_bf16_f32 v169, v170, v171
v_mfma_f32_16x16x16_bf16 v[188:191], v[140:141], v[74:75], 0
v_cvt_pk_bf16_f32 v172, v172, v173
v_cvt_pk_bf16_f32 v173, v174, v175
ds_read_b64 v[132:133], v54 offset:1536
v_mfma_f32_16x16x16_bf16 v[184:187], v[136:137], a[76:77], v[184:187]
v_accvgpr_write_b32 a68, v168
v_accvgpr_write_b32 a69, v169
v_mfma_f32_16x16x16_bf16 v[188:191], v[138:139], a[78:79], v[188:191]
v_accvgpr_write_b32 a70, v172
v_accvgpr_write_b32 a71, v173
s_add_u32 m0, s76, 36864
s_add_u32 s77, s82, 0x240800
buffer_load_dwordx4 v22, s[32:35], s77 offen offset:0 lds
buffer_load_dwordx4 v23, s[32:35], s77 offen offset:1024 lds
buffer_load_dwordx4 v24, s[32:35], s77 offen offset:2048 lds
buffer_load_dwordx4 v25, s[32:35], s77 offen offset:3072 lds
s_waitcnt lgkmcnt(4)
v_mfma_f32_16x16x16_bf16 v[160:163], v[148:149], v[68:69], 0
v_cvt_pk_bf16_f32 v176, v176, v177
v_cvt_pk_bf16_f32 v177, v178, v179
v_mfma_f32_16x16x16_bf16 v[164:167], v[148:149], v[70:71], 0
v_cvt_pk_bf16_f32 v180, v180, v181
v_cvt_pk_bf16_f32 v181, v182, v183
ds_read_b128 v[136:139], v53 offset:3536
v_mfma_f32_16x16x16_bf16 v[160:163], v[144:145], a[80:81], v[160:163]
v_accvgpr_write_b32 a72, v176
v_accvgpr_write_b32 a73, v177
v_mfma_f32_16x16x16_bf16 v[164:167], v[146:147], a[82:83], v[164:167]
v_accvgpr_write_b32 a74, v180
v_accvgpr_write_b32 a75, v181
v_mfma_f32_16x16x16_bf16 v[168:171], v[148:149], v[72:73], 0
v_cvt_pk_bf16_f32 v184, v184, v185
v_cvt_pk_bf16_f32 v185, v186, v187
v_mfma_f32_16x16x16_bf16 v[172:175], v[148:149], v[74:75], 0
v_cvt_pk_bf16_f32 v188, v188, v189
v_cvt_pk_bf16_f32 v189, v190, v191
ds_read_b64 v[140:141], v54 offset:1664
v_mfma_f32_16x16x16_bf16 v[168:171], v[144:145], a[84:85], v[168:171]
v_accvgpr_write_b32 a76, v184
v_accvgpr_write_b32 a77, v185
v_mfma_f32_16x16x16_bf16 v[172:175], v[146:147], a[86:87], v[172:175]
v_accvgpr_write_b32 a78, v188
v_accvgpr_write_b32 a79, v189
s_waitcnt lgkmcnt(4)
v_mfma_f32_16x16x16_bf16 v[176:179], v[156:157], v[68:69], 0
v_cvt_pk_bf16_f32 v160, v160, v161
v_cvt_pk_bf16_f32 v161, v162, v163
v_mfma_f32_16x16x16_bf16 v[180:183], v[156:157], v[70:71], 0
v_cvt_pk_bf16_f32 v164, v164, v165
v_cvt_pk_bf16_f32 v165, v166, v167
ds_read_b128 v[144:147], v53 offset:3808
v_mfma_f32_16x16x16_bf16 v[176:179], v[152:153], a[88:89], v[176:179]
v_accvgpr_write_b32 a80, v160
v_accvgpr_write_b32 a81, v161
v_mfma_f32_16x16x16_bf16 v[180:183], v[154:155], a[90:91], v[180:183]
v_accvgpr_write_b32 a82, v164
v_accvgpr_write_b32 a83, v165
v_mfma_f32_16x16x16_bf16 v[184:187], v[156:157], v[72:73], 0
v_cvt_pk_bf16_f32 v168, v168, v169
v_cvt_pk_bf16_f32 v169, v170, v171
v_mfma_f32_16x16x16_bf16 v[188:191], v[156:157], v[74:75], 0
v_cvt_pk_bf16_f32 v172, v172, v173
v_cvt_pk_bf16_f32 v173, v174, v175
ds_read_b64 v[148:149], v54 offset:1792
v_mfma_f32_16x16x16_bf16 v[184:187], v[152:153], a[92:93], v[184:187]
v_accvgpr_write_b32 a84, v168
v_accvgpr_write_b32 a85, v169
v_mfma_f32_16x16x16_bf16 v[188:191], v[154:155], a[94:95], v[188:191]
v_accvgpr_write_b32 a86, v172
v_accvgpr_write_b32 a87, v173
s_waitcnt lgkmcnt(4)
v_mfma_f32_16x16x16_bf16 v[160:163], v[132:133], v[68:69], 0
v_cvt_pk_bf16_f32 v176, v176, v177
v_cvt_pk_bf16_f32 v177, v178, v179
v_mfma_f32_16x16x16_bf16 v[164:167], v[132:133], v[70:71], 0
v_cvt_pk_bf16_f32 v180, v180, v181
v_cvt_pk_bf16_f32 v181, v182, v183
ds_read_b128 v[152:155], v53 offset:4080
v_mfma_f32_16x16x16_bf16 v[160:163], v[128:129], a[96:97], v[160:163]
v_accvgpr_write_b32 a88, v176
v_accvgpr_write_b32 a89, v177
v_mfma_f32_16x16x16_bf16 v[164:167], v[130:131], a[98:99], v[164:167]
v_accvgpr_write_b32 a90, v180
v_accvgpr_write_b32 a91, v181
s_add_u32 m0, s76, 65536
s_add_u32 s77, s82, 0x300800
buffer_load_dwordx4 v22, s[32:35], s77 offen offset:0 lds
buffer_load_dwordx4 v23, s[32:35], s77 offen offset:1024 lds
buffer_load_dwordx4 v24, s[32:35], s77 offen offset:2048 lds
buffer_load_dwordx4 v25, s[32:35], s77 offen offset:3072 lds
v_mfma_f32_16x16x16_bf16 v[168:171], v[132:133], v[72:73], 0
v_cvt_pk_bf16_f32 v184, v184, v185
v_cvt_pk_bf16_f32 v185, v186, v187
v_mfma_f32_16x16x16_bf16 v[172:175], v[132:133], v[74:75], 0
v_cvt_pk_bf16_f32 v188, v188, v189
v_cvt_pk_bf16_f32 v189, v190, v191
ds_read_b64 v[156:157], v54 offset:1920
v_mfma_f32_16x16x16_bf16 v[168:171], v[128:129], a[100:101], v[168:171]
v_accvgpr_write_b32 a92, v184
v_accvgpr_write_b32 a93, v185
v_mfma_f32_16x16x16_bf16 v[172:175], v[130:131], a[102:103], v[172:175]
v_accvgpr_write_b32 a94, v188
v_accvgpr_write_b32 a95, v189
s_waitcnt lgkmcnt(4)
v_mfma_f32_16x16x16_bf16 v[176:179], v[140:141], v[68:69], 0
v_cvt_pk_bf16_f32 v160, v160, v161
v_cvt_pk_bf16_f32 v161, v162, v163
v_mfma_f32_16x16x16_bf16 v[180:183], v[140:141], v[70:71], 0
v_cvt_pk_bf16_f32 v164, v164, v165
v_cvt_pk_bf16_f32 v165, v166, v167
ds_read_b128 v[128:131], v53 offset:4352
v_mfma_f32_16x16x16_bf16 v[176:179], v[136:137], a[104:105], v[176:179]
v_accvgpr_write_b32 a96, v160
v_accvgpr_write_b32 a97, v161
v_mfma_f32_16x16x16_bf16 v[180:183], v[138:139], a[106:107], v[180:183]
v_accvgpr_write_b32 a98, v164
v_accvgpr_write_b32 a99, v165
v_mfma_f32_16x16x16_bf16 v[184:187], v[140:141], v[72:73], 0
v_cvt_pk_bf16_f32 v168, v168, v169
v_cvt_pk_bf16_f32 v169, v170, v171
v_mfma_f32_16x16x16_bf16 v[188:191], v[140:141], v[74:75], 0
v_cvt_pk_bf16_f32 v172, v172, v173
v_cvt_pk_bf16_f32 v173, v174, v175
ds_read_b64 v[132:133], v54 offset:2048
v_mfma_f32_16x16x16_bf16 v[184:187], v[136:137], a[108:109], v[184:187]
v_accvgpr_write_b32 a100, v168
v_accvgpr_write_b32 a101, v169
v_mfma_f32_16x16x16_bf16 v[188:191], v[138:139], a[110:111], v[188:191]
v_accvgpr_write_b32 a102, v172
v_accvgpr_write_b32 a103, v173
s_waitcnt lgkmcnt(4)
v_mfma_f32_16x16x16_bf16 v[160:163], v[148:149], v[68:69], 0
v_cvt_pk_bf16_f32 v176, v176, v177
v_cvt_pk_bf16_f32 v177, v178, v179
v_mfma_f32_16x16x16_bf16 v[164:167], v[148:149], v[70:71], 0
v_cvt_pk_bf16_f32 v180, v180, v181
v_cvt_pk_bf16_f32 v181, v182, v183
ds_read_b128 v[136:139], v53 offset:4624
v_mfma_f32_16x16x16_bf16 v[160:163], v[144:145], a[112:113], v[160:163]
v_accvgpr_write_b32 a104, v176
v_accvgpr_write_b32 a105, v177
v_mfma_f32_16x16x16_bf16 v[164:167], v[146:147], a[114:115], v[164:167]
v_accvgpr_write_b32 a106, v180
v_accvgpr_write_b32 a107, v181
v_mfma_f32_16x16x16_bf16 v[168:171], v[148:149], v[72:73], 0
v_cvt_pk_bf16_f32 v184, v184, v185
v_cvt_pk_bf16_f32 v185, v186, v187
v_mfma_f32_16x16x16_bf16 v[172:175], v[148:149], v[74:75], 0
v_cvt_pk_bf16_f32 v188, v188, v189
v_cvt_pk_bf16_f32 v189, v190, v191
ds_read_b64 v[140:141], v54 offset:2176
v_mfma_f32_16x16x16_bf16 v[168:171], v[144:145], a[116:117], v[168:171]
v_accvgpr_write_b32 a108, v184
v_accvgpr_write_b32 a109, v185
v_mfma_f32_16x16x16_bf16 v[172:175], v[146:147], a[118:119], v[172:175]
v_accvgpr_write_b32 a110, v188
v_accvgpr_write_b32 a111, v189
s_add_u32 m0, s76, 69632
s_add_u32 s77, s82, 0x3c0800
buffer_load_dwordx4 v22, s[32:35], s77 offen offset:0 lds
buffer_load_dwordx4 v23, s[32:35], s77 offen offset:1024 lds
buffer_load_dwordx4 v24, s[32:35], s77 offen offset:2048 lds
buffer_load_dwordx4 v25, s[32:35], s77 offen offset:3072 lds
s_waitcnt lgkmcnt(4)
v_mfma_f32_16x16x16_bf16 v[176:179], v[156:157], v[68:69], 0
v_cvt_pk_bf16_f32 v160, v160, v161
v_cvt_pk_bf16_f32 v161, v162, v163
v_mfma_f32_16x16x16_bf16 v[180:183], v[156:157], v[70:71], 0
v_cvt_pk_bf16_f32 v164, v164, v165
v_cvt_pk_bf16_f32 v165, v166, v167
ds_read_b128 v[144:147], v53 offset:4896
v_mfma_f32_16x16x16_bf16 v[176:179], v[152:153], a[120:121], v[176:179]
v_accvgpr_write_b32 a112, v160
v_accvgpr_write_b32 a113, v161
v_mfma_f32_16x16x16_bf16 v[180:183], v[154:155], a[122:123], v[180:183]
v_accvgpr_write_b32 a114, v164
v_accvgpr_write_b32 a115, v165
v_mfma_f32_16x16x16_bf16 v[184:187], v[156:157], v[72:73], 0
v_cvt_pk_bf16_f32 v168, v168, v169
v_cvt_pk_bf16_f32 v169, v170, v171
v_mfma_f32_16x16x16_bf16 v[188:191], v[156:157], v[74:75], 0
v_cvt_pk_bf16_f32 v172, v172, v173
v_cvt_pk_bf16_f32 v173, v174, v175
ds_read_b64 v[148:149], v54 offset:2304
v_mfma_f32_16x16x16_bf16 v[184:187], v[152:153], a[124:125], v[184:187]
v_accvgpr_write_b32 a116, v168
v_accvgpr_write_b32 a117, v169
v_mfma_f32_16x16x16_bf16 v[188:191], v[154:155], a[126:127], v[188:191]
v_accvgpr_write_b32 a118, v172
v_accvgpr_write_b32 a119, v173
s_waitcnt lgkmcnt(4)
v_mfma_f32_16x16x16_bf16 v[160:163], v[132:133], v[68:69], 0
v_cvt_pk_bf16_f32 v176, v176, v177
v_cvt_pk_bf16_f32 v177, v178, v179
v_mfma_f32_16x16x16_bf16 v[164:167], v[132:133], v[70:71], 0
v_cvt_pk_bf16_f32 v180, v180, v181
v_cvt_pk_bf16_f32 v181, v182, v183
ds_read_b128 v[152:155], v53 offset:5168
v_mfma_f32_16x16x16_bf16 v[160:163], v[128:129], a[128:129], v[160:163]
v_accvgpr_write_b32 a120, v176
v_accvgpr_write_b32 a121, v177
v_mfma_f32_16x16x16_bf16 v[164:167], v[130:131], a[130:131], v[164:167]
v_accvgpr_write_b32 a122, v180
v_accvgpr_write_b32 a123, v181
v_mfma_f32_16x16x16_bf16 v[168:171], v[132:133], v[72:73], 0
v_cvt_pk_bf16_f32 v184, v184, v185
v_cvt_pk_bf16_f32 v185, v186, v187
v_mfma_f32_16x16x16_bf16 v[172:175], v[132:133], v[74:75], 0
v_cvt_pk_bf16_f32 v188, v188, v189
v_cvt_pk_bf16_f32 v189, v190, v191
ds_read_b64 v[156:157], v54 offset:2432
v_mfma_f32_16x16x16_bf16 v[168:171], v[128:129], a[132:133], v[168:171]
v_accvgpr_write_b32 a124, v184
v_accvgpr_write_b32 a125, v185
v_mfma_f32_16x16x16_bf16 v[172:175], v[130:131], a[134:135], v[172:175]
v_accvgpr_write_b32 a126, v188
v_accvgpr_write_b32 a127, v189
s_waitcnt lgkmcnt(4)
v_mfma_f32_16x16x16_bf16 v[176:179], v[140:141], v[68:69], 0
v_cvt_pk_bf16_f32 v160, v160, v161
v_cvt_pk_bf16_f32 v161, v162, v163
v_mfma_f32_16x16x16_bf16 v[180:183], v[140:141], v[70:71], 0
v_cvt_pk_bf16_f32 v164, v164, v165
v_cvt_pk_bf16_f32 v165, v166, v167
ds_read_b128 v[128:131], v53 offset:5440
v_mfma_f32_16x16x16_bf16 v[176:179], v[136:137], a[136:137], v[176:179]
v_accvgpr_write_b32 a128, v160
v_accvgpr_write_b32 a129, v161
v_mfma_f32_16x16x16_bf16 v[180:183], v[138:139], a[138:139], v[180:183]
v_accvgpr_write_b32 a130, v164
v_accvgpr_write_b32 a131, v165
s_add_u32 m0, s76, 98304
s_add_u32 s77, s86, 0x0
buffer_load_dwordx4 v38, s[56:59], s77 offen offset:0 lds
buffer_load_dwordx4 v39, s[56:59], s77 offen offset:1024 lds
buffer_load_dwordx4 v40, s[56:59], s77 offen offset:2048 lds
buffer_load_dwordx4 v41, s[56:59], s77 offen offset:3072 lds
v_mfma_f32_16x16x16_bf16 v[184:187], v[140:141], v[72:73], 0
v_cvt_pk_bf16_f32 v168, v168, v169
v_cvt_pk_bf16_f32 v169, v170, v171
v_mfma_f32_16x16x16_bf16 v[188:191], v[140:141], v[74:75], 0
v_cvt_pk_bf16_f32 v172, v172, v173
v_cvt_pk_bf16_f32 v173, v174, v175
ds_read_b64 v[132:133], v54 offset:2560
v_mfma_f32_16x16x16_bf16 v[184:187], v[136:137], a[140:141], v[184:187]
v_accvgpr_write_b32 a132, v168
v_accvgpr_write_b32 a133, v169
v_mfma_f32_16x16x16_bf16 v[188:191], v[138:139], a[142:143], v[188:191]
v_accvgpr_write_b32 a134, v172
v_accvgpr_write_b32 a135, v173
s_waitcnt lgkmcnt(4)
v_mfma_f32_16x16x16_bf16 v[160:163], v[148:149], v[68:69], 0
v_cvt_pk_bf16_f32 v176, v176, v177
v_cvt_pk_bf16_f32 v177, v178, v179
v_mfma_f32_16x16x16_bf16 v[164:167], v[148:149], v[70:71], 0
v_cvt_pk_bf16_f32 v180, v180, v181
v_cvt_pk_bf16_f32 v181, v182, v183
ds_read_b128 v[136:139], v53 offset:5712
v_mfma_f32_16x16x16_bf16 v[160:163], v[144:145], a[144:145], v[160:163]
v_accvgpr_write_b32 a136, v176
v_accvgpr_write_b32 a137, v177
v_mfma_f32_16x16x16_bf16 v[164:167], v[146:147], a[146:147], v[164:167]
v_accvgpr_write_b32 a138, v180
v_accvgpr_write_b32 a139, v181
v_mfma_f32_16x16x16_bf16 v[168:171], v[148:149], v[72:73], 0
v_cvt_pk_bf16_f32 v184, v184, v185
v_cvt_pk_bf16_f32 v185, v186, v187
v_mfma_f32_16x16x16_bf16 v[172:175], v[148:149], v[74:75], 0
v_cvt_pk_bf16_f32 v188, v188, v189
v_cvt_pk_bf16_f32 v189, v190, v191
ds_read_b64 v[140:141], v54 offset:2688
v_mfma_f32_16x16x16_bf16 v[168:171], v[144:145], a[148:149], v[168:171]
v_accvgpr_write_b32 a140, v184
v_accvgpr_write_b32 a141, v185
v_mfma_f32_16x16x16_bf16 v[172:175], v[146:147], a[150:151], v[172:175]
v_accvgpr_write_b32 a142, v188
v_accvgpr_write_b32 a143, v189
s_waitcnt lgkmcnt(4)
v_mfma_f32_16x16x16_bf16 v[176:179], v[156:157], v[68:69], 0
v_cvt_pk_bf16_f32 v160, v160, v161
v_cvt_pk_bf16_f32 v161, v162, v163
v_mfma_f32_16x16x16_bf16 v[180:183], v[156:157], v[70:71], 0
v_cvt_pk_bf16_f32 v164, v164, v165
v_cvt_pk_bf16_f32 v165, v166, v167
ds_read_b128 v[144:147], v53 offset:5984
v_mfma_f32_16x16x16_bf16 v[176:179], v[152:153], a[152:153], v[176:179]
v_accvgpr_write_b32 a144, v160
v_accvgpr_write_b32 a145, v161
v_mfma_f32_16x16x16_bf16 v[180:183], v[154:155], a[154:155], v[180:183]
v_accvgpr_write_b32 a146, v164
v_accvgpr_write_b32 a147, v165
v_mfma_f32_16x16x16_bf16 v[184:187], v[156:157], v[72:73], 0
v_cvt_pk_bf16_f32 v168, v168, v169
v_cvt_pk_bf16_f32 v169, v170, v171
v_mfma_f32_16x16x16_bf16 v[188:191], v[156:157], v[74:75], 0
v_cvt_pk_bf16_f32 v172, v172, v173
v_cvt_pk_bf16_f32 v173, v174, v175
ds_read_b64 v[148:149], v54 offset:2816
v_mfma_f32_16x16x16_bf16 v[184:187], v[152:153], a[156:157], v[184:187]
v_accvgpr_write_b32 a148, v168
v_accvgpr_write_b32 a149, v169
v_mfma_f32_16x16x16_bf16 v[188:191], v[154:155], a[158:159], v[188:191]
v_accvgpr_write_b32 a150, v172
v_accvgpr_write_b32 a151, v173
s_add_u32 m0, s76, 102400
s_add_u32 s77, s86, 0x180000
buffer_load_dwordx4 v38, s[56:59], s77 offen offset:0 lds
buffer_load_dwordx4 v39, s[56:59], s77 offen offset:1024 lds
buffer_load_dwordx4 v40, s[56:59], s77 offen offset:2048 lds
buffer_load_dwordx4 v41, s[56:59], s77 offen offset:3072 lds
s_waitcnt lgkmcnt(4)
v_mfma_f32_16x16x16_bf16 v[160:163], v[132:133], v[68:69], 0
v_cvt_pk_bf16_f32 v176, v176, v177
v_cvt_pk_bf16_f32 v177, v178, v179
v_mfma_f32_16x16x16_bf16 v[164:167], v[132:133], v[70:71], 0
v_cvt_pk_bf16_f32 v180, v180, v181
v_cvt_pk_bf16_f32 v181, v182, v183
ds_read_b128 v[152:155], v53 offset:6256
v_mfma_f32_16x16x16_bf16 v[160:163], v[128:129], a[160:161], v[160:163]
v_accvgpr_write_b32 a152, v176
v_accvgpr_write_b32 a153, v177
v_mfma_f32_16x16x16_bf16 v[164:167], v[130:131], a[162:163], v[164:167]
v_accvgpr_write_b32 a154, v180
v_accvgpr_write_b32 a155, v181
v_mfma_f32_16x16x16_bf16 v[168:171], v[132:133], v[72:73], 0
v_cvt_pk_bf16_f32 v184, v184, v185
v_cvt_pk_bf16_f32 v185, v186, v187
v_mfma_f32_16x16x16_bf16 v[172:175], v[132:133], v[74:75], 0
v_cvt_pk_bf16_f32 v188, v188, v189
v_cvt_pk_bf16_f32 v189, v190, v191
ds_read_b64 v[156:157], v54 offset:2944
v_mfma_f32_16x16x16_bf16 v[168:171], v[128:129], a[164:165], v[168:171]
v_accvgpr_write_b32 a156, v184
v_accvgpr_write_b32 a157, v185
v_mfma_f32_16x16x16_bf16 v[172:175], v[130:131], a[166:167], v[172:175]
v_accvgpr_write_b32 a158, v188
v_accvgpr_write_b32 a159, v189
s_waitcnt lgkmcnt(4)
v_mfma_f32_16x16x16_bf16 v[176:179], v[140:141], v[68:69], 0
v_cvt_pk_bf16_f32 v160, v160, v161
v_cvt_pk_bf16_f32 v161, v162, v163
v_mfma_f32_16x16x16_bf16 v[180:183], v[140:141], v[70:71], 0
v_cvt_pk_bf16_f32 v164, v164, v165
v_cvt_pk_bf16_f32 v165, v166, v167
ds_read_b128 v[128:131], v53 offset:6528
v_mfma_f32_16x16x16_bf16 v[176:179], v[136:137], a[168:169], v[176:179]
v_accvgpr_write_b32 a160, v160
v_accvgpr_write_b32 a161, v161
v_mfma_f32_16x16x16_bf16 v[180:183], v[138:139], a[170:171], v[180:183]
v_accvgpr_write_b32 a162, v164
v_accvgpr_write_b32 a163, v165
v_mfma_f32_16x16x16_bf16 v[184:187], v[140:141], v[72:73], 0
v_cvt_pk_bf16_f32 v168, v168, v169
v_cvt_pk_bf16_f32 v169, v170, v171
v_mfma_f32_16x16x16_bf16 v[188:191], v[140:141], v[74:75], 0
v_cvt_pk_bf16_f32 v172, v172, v173
v_cvt_pk_bf16_f32 v173, v174, v175
ds_read_b64 v[132:133], v54 offset:3072
v_mfma_f32_16x16x16_bf16 v[184:187], v[136:137], a[172:173], v[184:187]
v_accvgpr_write_b32 a164, v168
v_accvgpr_write_b32 a165, v169
v_mfma_f32_16x16x16_bf16 v[188:191], v[138:139], a[174:175], v[188:191]
v_accvgpr_write_b32 a166, v172
v_accvgpr_write_b32 a167, v173
s_waitcnt lgkmcnt(4)
v_mfma_f32_16x16x16_bf16 v[160:163], v[148:149], v[68:69], 0
v_cvt_pk_bf16_f32 v176, v176, v177
v_cvt_pk_bf16_f32 v177, v178, v179
v_mfma_f32_16x16x16_bf16 v[164:167], v[148:149], v[70:71], 0
v_cvt_pk_bf16_f32 v180, v180, v181
v_cvt_pk_bf16_f32 v181, v182, v183
ds_read_b128 v[136:139], v53 offset:6800
v_mfma_f32_16x16x16_bf16 v[160:163], v[144:145], a[176:177], v[160:163]
v_accvgpr_write_b32 a168, v176
v_accvgpr_write_b32 a169, v177
v_mfma_f32_16x16x16_bf16 v[164:167], v[146:147], a[178:179], v[164:167]
v_accvgpr_write_b32 a170, v180
v_accvgpr_write_b32 a171, v181
s_mul_i32 s3, s101, 6144
s_add_u32 s3, s3, 0x1000
buffer_load_dword v57, v8, s[32:35], s3 offen
s_movk_i32 s3, 4096
buffer_load_dword v57, v56, s[32:35], s3 offen
v_mfma_f32_16x16x16_bf16 v[168:171], v[148:149], v[72:73], 0
v_cvt_pk_bf16_f32 v184, v184, v185
v_cvt_pk_bf16_f32 v185, v186, v187
v_mfma_f32_16x16x16_bf16 v[172:175], v[148:149], v[74:75], 0
v_cvt_pk_bf16_f32 v188, v188, v189
v_cvt_pk_bf16_f32 v189, v190, v191
ds_read_b64 v[140:141], v54 offset:3200
v_mfma_f32_16x16x16_bf16 v[168:171], v[144:145], a[180:181], v[168:171]
v_accvgpr_write_b32 a172, v184
v_accvgpr_write_b32 a173, v185
v_mfma_f32_16x16x16_bf16 v[172:175], v[146:147], a[182:183], v[172:175]
v_accvgpr_write_b32 a174, v188
v_accvgpr_write_b32 a175, v189
s_waitcnt lgkmcnt(4)
v_mfma_f32_16x16x16_bf16 v[176:179], v[156:157], v[68:69], 0
v_cvt_pk_bf16_f32 v160, v160, v161
v_cvt_pk_bf16_f32 v161, v162, v163
v_mfma_f32_16x16x16_bf16 v[180:183], v[156:157], v[70:71], 0
v_cvt_pk_bf16_f32 v164, v164, v165
v_cvt_pk_bf16_f32 v165, v166, v167
ds_read_b128 v[144:147], v53 offset:7072
v_mfma_f32_16x16x16_bf16 v[176:179], v[152:153], a[184:185], v[176:179]
v_accvgpr_write_b32 a176, v160
v_accvgpr_write_b32 a177, v161
v_mfma_f32_16x16x16_bf16 v[180:183], v[154:155], a[186:187], v[180:183]
v_accvgpr_write_b32 a178, v164
v_accvgpr_write_b32 a179, v165
v_mfma_f32_16x16x16_bf16 v[184:187], v[156:157], v[72:73], 0
v_cvt_pk_bf16_f32 v168, v168, v169
v_cvt_pk_bf16_f32 v169, v170, v171
v_mfma_f32_16x16x16_bf16 v[188:191], v[156:157], v[74:75], 0
v_cvt_pk_bf16_f32 v172, v172, v173
v_cvt_pk_bf16_f32 v173, v174, v175
ds_read_b64 v[148:149], v54 offset:3328
v_mfma_f32_16x16x16_bf16 v[184:187], v[152:153], a[188:189], v[184:187]
v_accvgpr_write_b32 a180, v168
v_accvgpr_write_b32 a181, v169
v_mfma_f32_16x16x16_bf16 v[188:191], v[154:155], a[190:191], v[188:191]
v_accvgpr_write_b32 a182, v172
v_accvgpr_write_b32 a183, v173
s_waitcnt lgkmcnt(4)
v_mfma_f32_16x16x16_bf16 v[160:163], v[132:133], v[68:69], 0
v_cvt_pk_bf16_f32 v176, v176, v177
v_cvt_pk_bf16_f32 v177, v178, v179
v_mfma_f32_16x16x16_bf16 v[164:167], v[132:133], v[70:71], 0
v_cvt_pk_bf16_f32 v180, v180, v181
v_cvt_pk_bf16_f32 v181, v182, v183
ds_read_b128 v[152:155], v53 offset:7344
v_mfma_f32_16x16x16_bf16 v[160:163], v[128:129], a[192:193], v[160:163]
v_accvgpr_write_b32 a184, v176
v_accvgpr_write_b32 a185, v177
v_mfma_f32_16x16x16_bf16 v[164:167], v[130:131], a[194:195], v[164:167]
v_accvgpr_write_b32 a186, v180
v_accvgpr_write_b32 a187, v181
v_mfma_f32_16x16x16_bf16 v[168:171], v[132:133], v[72:73], 0
v_cvt_pk_bf16_f32 v184, v184, v185
v_cvt_pk_bf16_f32 v185, v186, v187
v_mfma_f32_16x16x16_bf16 v[172:175], v[132:133], v[74:75], 0
v_cvt_pk_bf16_f32 v188, v188, v189
v_cvt_pk_bf16_f32 v189, v190, v191
ds_read_b64 v[156:157], v54 offset:3456
v_mfma_f32_16x16x16_bf16 v[168:171], v[128:129], a[196:197], v[168:171]
v_accvgpr_write_b32 a188, v184
v_accvgpr_write_b32 a189, v185
v_mfma_f32_16x16x16_bf16 v[172:175], v[130:131], a[198:199], v[172:175]
v_accvgpr_write_b32 a190, v188
v_accvgpr_write_b32 a191, v189
s_mul_i32 s3, s101, 6144
s_add_u32 s3, s3, 0x0
buffer_load_dword v57, v8, s[32:35], s3 offen
s_movk_i32 s3, 0
buffer_load_dword v57, v56, s[32:35], s3 offen
s_waitcnt lgkmcnt(4)
v_mfma_f32_16x16x16_bf16 v[176:179], v[140:141], v[68:69], 0
v_cvt_pk_bf16_f32 v160, v160, v161
v_cvt_pk_bf16_f32 v161, v162, v163
v_mfma_f32_16x16x16_bf16 v[180:183], v[140:141], v[70:71], 0
v_cvt_pk_bf16_f32 v164, v164, v165
v_cvt_pk_bf16_f32 v165, v166, v167
ds_read_b128 v[128:131], v53 offset:7616
v_mfma_f32_16x16x16_bf16 v[176:179], v[136:137], a[200:201], v[176:179]
v_accvgpr_write_b32 a192, v160
v_accvgpr_write_b32 a193, v161
v_mfma_f32_16x16x16_bf16 v[180:183], v[138:139], a[202:203], v[180:183]
v_accvgpr_write_b32 a194, v164
v_accvgpr_write_b32 a195, v165
v_mfma_f32_16x16x16_bf16 v[184:187], v[140:141], v[72:73], 0
v_cvt_pk_bf16_f32 v168, v168, v169
v_cvt_pk_bf16_f32 v169, v170, v171
v_mfma_f32_16x16x16_bf16 v[188:191], v[140:141], v[74:75], 0
v_cvt_pk_bf16_f32 v172, v172, v173
v_cvt_pk_bf16_f32 v173, v174, v175
ds_read_b64 v[132:133], v54 offset:3584
v_mfma_f32_16x16x16_bf16 v[184:187], v[136:137], a[204:205], v[184:187]
v_accvgpr_write_b32 a196, v168
v_accvgpr_write_b32 a197, v169
v_mfma_f32_16x16x16_bf16 v[188:191], v[138:139], a[206:207], v[188:191]
v_accvgpr_write_b32 a198, v172
v_accvgpr_write_b32 a199, v173
s_waitcnt lgkmcnt(4)
v_mfma_f32_16x16x16_bf16 v[160:163], v[148:149], v[68:69], 0
v_cvt_pk_bf16_f32 v176, v176, v177
v_cvt_pk_bf16_f32 v177, v178, v179
v_mfma_f32_16x16x16_bf16 v[164:167], v[148:149], v[70:71], 0
v_cvt_pk_bf16_f32 v180, v180, v181
v_cvt_pk_bf16_f32 v181, v182, v183
ds_read_b128 v[136:139], v53 offset:7888
v_mfma_f32_16x16x16_bf16 v[160:163], v[144:145], a[208:209], v[160:163]
v_accvgpr_write_b32 a200, v176
v_accvgpr_write_b32 a201, v177
v_mfma_f32_16x16x16_bf16 v[164:167], v[146:147], a[210:211], v[164:167]
v_accvgpr_write_b32 a202, v180
v_accvgpr_write_b32 a203, v181
v_mfma_f32_16x16x16_bf16 v[168:171], v[148:149], v[72:73], 0
v_cvt_pk_bf16_f32 v184, v184, v185
v_cvt_pk_bf16_f32 v185, v186, v187
v_mfma_f32_16x16x16_bf16 v[172:175], v[148:149], v[74:75], 0
v_cvt_pk_bf16_f32 v188, v188, v189
v_cvt_pk_bf16_f32 v189, v190, v191
ds_read_b64 v[140:141], v54 offset:3712
v_mfma_f32_16x16x16_bf16 v[168:171], v[144:145], a[212:213], v[168:171]
v_accvgpr_write_b32 a204, v184
v_accvgpr_write_b32 a205, v185
v_mfma_f32_16x16x16_bf16 v[172:175], v[146:147], a[214:215], v[172:175]
v_accvgpr_write_b32 a206, v188
v_accvgpr_write_b32 a207, v189
s_waitcnt lgkmcnt(4)
v_mfma_f32_16x16x16_bf16 v[176:179], v[156:157], v[68:69], 0
v_cvt_pk_bf16_f32 v160, v160, v161
v_cvt_pk_bf16_f32 v161, v162, v163
v_mfma_f32_16x16x16_bf16 v[180:183], v[156:157], v[70:71], 0
v_cvt_pk_bf16_f32 v164, v164, v165
v_cvt_pk_bf16_f32 v165, v166, v167
ds_read_b128 v[144:147], v53 offset:8160
v_mfma_f32_16x16x16_bf16 v[176:179], v[152:153], a[216:217], v[176:179]
v_accvgpr_write_b32 a208, v160
v_accvgpr_write_b32 a209, v161
v_mfma_f32_16x16x16_bf16 v[180:183], v[154:155], a[218:219], v[180:183]
v_accvgpr_write_b32 a210, v164
v_accvgpr_write_b32 a211, v165
v_mfma_f32_16x16x16_bf16 v[184:187], v[156:157], v[72:73], 0
v_cvt_pk_bf16_f32 v168, v168, v169
v_cvt_pk_bf16_f32 v169, v170, v171
v_mfma_f32_16x16x16_bf16 v[188:191], v[156:157], v[74:75], 0
v_cvt_pk_bf16_f32 v172, v172, v173
v_cvt_pk_bf16_f32 v173, v174, v175
ds_read_b64 v[148:149], v54 offset:3840
v_mfma_f32_16x16x16_bf16 v[184:187], v[152:153], a[220:221], v[184:187]
v_accvgpr_write_b32 a212, v168
v_accvgpr_write_b32 a213, v169
v_mfma_f32_16x16x16_bf16 v[188:191], v[154:155], a[222:223], v[188:191]
v_accvgpr_write_b32 a214, v172
v_accvgpr_write_b32 a215, v173
s_waitcnt lgkmcnt(4)
v_mfma_f32_16x16x16_bf16 v[160:163], v[132:133], v[68:69], 0
v_cvt_pk_bf16_f32 v176, v176, v177
v_cvt_pk_bf16_f32 v177, v178, v179
v_mfma_f32_16x16x16_bf16 v[164:167], v[132:133], v[70:71], 0
v_cvt_pk_bf16_f32 v180, v180, v181
v_cvt_pk_bf16_f32 v181, v182, v183
ds_read_b128 v[152:155], v53 offset:8432
v_mfma_f32_16x16x16_bf16 v[160:163], v[128:129], a[224:225], v[160:163]
v_accvgpr_write_b32 a216, v176
v_accvgpr_write_b32 a217, v177
v_mfma_f32_16x16x16_bf16 v[164:167], v[130:131], a[226:227], v[164:167]
v_accvgpr_write_b32 a218, v180
v_accvgpr_write_b32 a219, v181
v_mfma_f32_16x16x16_bf16 v[168:171], v[132:133], v[72:73], 0
v_cvt_pk_bf16_f32 v184, v184, v185
v_cvt_pk_bf16_f32 v185, v186, v187
v_mfma_f32_16x16x16_bf16 v[172:175], v[132:133], v[74:75], 0
v_cvt_pk_bf16_f32 v188, v188, v189
v_cvt_pk_bf16_f32 v189, v190, v191
ds_read_b64 v[156:157], v54 offset:3968
v_mfma_f32_16x16x16_bf16 v[168:171], v[128:129], a[228:229], v[168:171]
v_accvgpr_write_b32 a220, v184
v_accvgpr_write_b32 a221, v185
v_mfma_f32_16x16x16_bf16 v[172:175], v[130:131], a[230:231], v[172:175]
v_accvgpr_write_b32 a222, v188
v_accvgpr_write_b32 a223, v189
s_waitcnt lgkmcnt(4)
v_mfma_f32_16x16x16_bf16 v[176:179], v[140:141], v[68:69], 0
v_cvt_pk_bf16_f32 v160, v160, v161
v_cvt_pk_bf16_f32 v161, v162, v163
v_mfma_f32_16x16x16_bf16 v[180:183], v[140:141], v[70:71], 0
v_cvt_pk_bf16_f32 v164, v164, v165
v_cvt_pk_bf16_f32 v165, v166, v167
v_mfma_f32_16x16x16_bf16 v[176:179], v[136:137], a[232:233], v[176:179]
v_accvgpr_write_b32 a224, v160
v_accvgpr_write_b32 a225, v161
v_mfma_f32_16x16x16_bf16 v[180:183], v[138:139], a[234:235], v[180:183]
v_accvgpr_write_b32 a226, v164
v_accvgpr_write_b32 a227, v165
v_mfma_f32_16x16x16_bf16 v[184:187], v[140:141], v[72:73], 0
v_cvt_pk_bf16_f32 v168, v168, v169
v_cvt_pk_bf16_f32 v169, v170, v171
v_mfma_f32_16x16x16_bf16 v[188:191], v[140:141], v[74:75], 0
v_cvt_pk_bf16_f32 v172, v172, v173
v_cvt_pk_bf16_f32 v173, v174, v175
v_mfma_f32_16x16x16_bf16 v[184:187], v[136:137], a[236:237], v[184:187]
v_accvgpr_write_b32 a228, v168
v_accvgpr_write_b32 a229, v169
v_mfma_f32_16x16x16_bf16 v[188:191], v[138:139], a[238:239], v[188:191]
v_accvgpr_write_b32 a230, v172
v_accvgpr_write_b32 a231, v173
s_waitcnt lgkmcnt(2)
v_mfma_f32_16x16x16_bf16 v[160:163], v[148:149], v[68:69], 0
v_cvt_pk_bf16_f32 v176, v176, v177
v_cvt_pk_bf16_f32 v177, v178, v179
v_mfma_f32_16x16x16_bf16 v[164:167], v[148:149], v[70:71], 0
v_cvt_pk_bf16_f32 v180, v180, v181
v_cvt_pk_bf16_f32 v181, v182, v183
v_mfma_f32_16x16x16_bf16 v[160:163], v[144:145], a[240:241], v[160:163]
v_accvgpr_write_b32 a232, v176
v_accvgpr_write_b32 a233, v177
v_mfma_f32_16x16x16_bf16 v[164:167], v[146:147], a[242:243], v[164:167]
v_accvgpr_write_b32 a234, v180
v_accvgpr_write_b32 a235, v181
v_mfma_f32_16x16x16_bf16 v[168:171], v[148:149], v[72:73], 0
v_cvt_pk_bf16_f32 v184, v184, v185
v_cvt_pk_bf16_f32 v185, v186, v187
v_mfma_f32_16x16x16_bf16 v[172:175], v[148:149], v[74:75], 0
v_cvt_pk_bf16_f32 v188, v188, v189
v_cvt_pk_bf16_f32 v189, v190, v191
v_mfma_f32_16x16x16_bf16 v[168:171], v[144:145], a[244:245], v[168:171]
v_accvgpr_write_b32 a236, v184
v_accvgpr_write_b32 a237, v185
v_mfma_f32_16x16x16_bf16 v[172:175], v[146:147], a[246:247], v[172:175]
v_accvgpr_write_b32 a238, v188
v_accvgpr_write_b32 a239, v189
s_waitcnt lgkmcnt(0)
v_mfma_f32_16x16x16_bf16 v[176:179], v[156:157], v[68:69], 0
v_cvt_pk_bf16_f32 v160, v160, v161
v_cvt_pk_bf16_f32 v161, v162, v163
v_mfma_f32_16x16x16_bf16 v[180:183], v[156:157], v[70:71], 0
v_cvt_pk_bf16_f32 v164, v164, v165
v_cvt_pk_bf16_f32 v165, v166, v167
v_mfma_f32_16x16x16_bf16 v[176:179], v[152:153], a[248:249], v[176:179]
v_accvgpr_write_b32 a240, v160
v_accvgpr_write_b32 a241, v161
v_mfma_f32_16x16x16_bf16 v[180:183], v[154:155], a[250:251], v[180:183]
v_accvgpr_write_b32 a242, v164
v_accvgpr_write_b32 a243, v165
v_mfma_f32_16x16x16_bf16 v[184:187], v[156:157], v[72:73], 0
v_cvt_pk_bf16_f32 v168, v168, v169
v_cvt_pk_bf16_f32 v169, v170, v171
v_mfma_f32_16x16x16_bf16 v[188:191], v[156:157], v[74:75], 0
v_cvt_pk_bf16_f32 v172, v172, v173
v_cvt_pk_bf16_f32 v173, v174, v175
v_mfma_f32_16x16x16_bf16 v[184:187], v[152:153], a[252:253], v[184:187]
v_accvgpr_write_b32 a244, v168
v_accvgpr_write_b32 a245, v169
v_mfma_f32_16x16x16_bf16 v[188:191], v[154:155], a[254:255], v[188:191]
v_accvgpr_write_b32 a246, v172
v_accvgpr_write_b32 a247, v173
v_cvt_pk_bf16_f32 v176, v176, v177
v_cvt_pk_bf16_f32 v177, v178, v179
v_cvt_pk_bf16_f32 v180, v180, v181
v_cvt_pk_bf16_f32 v181, v182, v183
v_accvgpr_write_b32 a248, v176
v_accvgpr_write_b32 a249, v177
v_accvgpr_write_b32 a250, v180
v_accvgpr_write_b32 a251, v181
v_cvt_pk_bf16_f32 v184, v184, v185
v_cvt_pk_bf16_f32 v185, v186, v187
v_cvt_pk_bf16_f32 v188, v188, v189
v_cvt_pk_bf16_f32 v189, v190, v191
v_accvgpr_write_b32 a252, v184
v_accvgpr_write_b32 a253, v185
v_accvgpr_write_b32 a254, v188
v_accvgpr_write_b32 a255, v189
s_waitcnt vmcnt(28)
s_barrier
ds_read_b64_tr_b16 v[80:81], v10 offset:0
ds_read_b64_tr_b16 v[82:83], v10 offset:16384
ds_read_b64_tr_b16 v[84:85], v11 offset:0
ds_read_b64_tr_b16 v[86:87], v11 offset:16384
ds_read_b64_tr_b16 v[88:89], v12 offset:0
ds_read_b64_tr_b16 v[90:91], v12 offset:16384
ds_read_b64_tr_b16 v[92:93], v13 offset:0
ds_read_b64_tr_b16 v[94:95], v13 offset:16384
ds_read_b64_tr_b16 v[96:97], v10 offset:1024
ds_read_b64_tr_b16 v[98:99], v10 offset:17408
ds_read_b64_tr_b16 v[100:101], v11 offset:1024
ds_read_b64_tr_b16 v[102:103], v11 offset:17408
ds_read_b64_tr_b16 v[104:105], v12 offset:1024
ds_read_b64_tr_b16 v[106:107], v12 offset:17408
ds_read_b64_tr_b16 v[108:109], v13 offset:1024
ds_read_b64_tr_b16 v[110:111], v13 offset:17408
S_K:
s_waitcnt lgkmcnt(14)
v_mfma_f32_16x16x32_bf16 v[128:131], v[80:83], a[0:3], 0
ds_read_b64_tr_b16 v[112:113], v10 offset:2048
ds_read_b64_tr_b16 v[114:115], v10 offset:18432
v_mfma_f32_16x16x32_bf16 v[144:147], v[80:83], a[4:7], 0
ds_read_b64_tr_b16 v[116:117], v11 offset:2048
s_waitcnt lgkmcnt(15)
v_mfma_f32_16x16x32_bf16 v[132:135], v[84:87], a[0:3], 0
ds_read_b64_tr_b16 v[118:119], v11 offset:18432
ds_read_b64_tr_b16 v[120:121], v12 offset:2048
v_mfma_f32_16x16x32_bf16 v[148:151], v[84:87], a[4:7], 0
ds_read_b64_tr_b16 v[122:123], v12 offset:18432
s_waitcnt lgkmcnt(15)
v_mfma_f32_16x16x32_bf16 v[136:139], v[88:91], a[0:3], 0
s_add_u32 s70, s0, S_V - K_pc + 0
s_addc_u32 s71, s1, 0
global_load_dword v57, v9, s[70:71]
v_mfma_f32_16x16x32_bf16 v[152:155], v[88:91], a[4:7], 0
ds_read_b64_tr_b16 v[124:125], v13 offset:2048
s_waitcnt lgkmcnt(7)
v_mfma_f32_16x16x32_bf16 v[140:143], v[92:95], a[0:3], 0
ds_read_b64_tr_b16 v[126:127], v13 offset:18432
ds_read_b64_tr_b16 v[80:81], v10 offset:3072
v_mfma_f32_16x16x32_bf16 v[156:159], v[92:95], a[4:7], 0
ds_read_b64_tr_b16 v[82:83], v10 offset:19456
s_lshl_b32 s78, s72, 5
v_mfma_f32_16x16x32_bf16 v[128:131], v[96:99], a[8:11], v[128:131]
ds_read_b64_tr_b16 v[84:85], v11 offset:3072
ds_read_b64_tr_b16 v[86:87], v11 offset:19456
v_mfma_f32_16x16x32_bf16 v[144:147], v[96:99], a[12:15], v[144:147]
ds_read_b64_tr_b16 v[88:89], v12 offset:3072
v_xor_b32 v55, s78, v14
v_mfma_f32_16x16x32_bf16 v[132:135], v[100:103], a[8:11], v[132:135]
ds_read_b64_tr_b16 v[90:91], v12 offset:19456
ds_read_b64_tr_b16 v[92:93], v13 offset:3072
v_mfma_f32_16x16x32_bf16 v[148:151], v[100:103], a[12:15], v[148:151]
ds_read_b64_tr_b16 v[94:95], v13 offset:19456
v_and_b32 v71, 48, v1
v_mfma_f32_16x16x32_bf16 v[136:139], v[104:107], a[8:11], v[136:139]
ds_read_b64_tr_b16 v[96:97], v10 offset:4096
v_add_u32 v71, 143872, v71
v_mfma_f32_16x16x32_bf16 v[152:155], v[104:107], a[12:15], v[152:155]
ds_read_b64_tr_b16 v[98:99], v10 offset:20480
ds_read_b128 v[160:163], v71 offset:0
v_mfma_f32_16x16x32_bf16 v[140:143], v[108:111], a[8:11], v[140:143]
ds_read_b64_tr_b16 v[100:101], v11 offset:4096
ds_read_b128 v[164:167], v71 offset:64
v_mfma_f32_16x16x32_bf16 v[156:159], v[108:111], a[12:15], v[156:159]
ds_read_b64_tr_b16 v[102:103], v11 offset:20480
s_waitcnt lgkmcnt(9)
v_mfma_f32_16x16x32_bf16 v[128:131], v[112:115], a[16:19], v[128:131]
ds_read_b64_tr_b16 v[104:105], v12 offset:4096
ds_read_b128 v[168:171], v71 offset:128
v_mfma_f32_16x16x32_bf16 v[144:147], v[112:115], a[20:23], v[144:147]
ds_read_b64_tr_b16 v[106:107], v12 offset:20480
ds_read_b128 v[172:175], v71 offset:192
v_mfma_f32_16x16x32_bf16 v[132:135], v[116:119], a[16:19], v[132:135]
ds_read_b64_tr_b16 v[108:109], v13 offset:4096
ds_read_b128 v[176:179], v71 offset:256
v_mfma_f32_16x16x32_bf16 v[148:151], v[116:119], a[20:23], v[148:151]
ds_read_b64_tr_b16 v[110:111], v13 offset:20480
ds_read_b128 v[180:183], v71 offset:320
v_mfma_f32_16x16x32_bf16 v[136:139], v[120:123], a[16:19], v[136:139]
ds_read_b64_tr_b16 v[112:113], v10 offset:5120
ds_read_b128 v[184:187], v71 offset:384
v_mfma_f32_16x16x32_bf16 v[152:155], v[120:123], a[20:23], v[152:155]
ds_read_b64_tr_b16 v[114:115], v10 offset:21504
ds_read_b128 v[188:191], v71 offset:448
v_mfma_f32_16x16x32_bf16 v[140:143], v[124:127], a[16:19], v[140:143]
ds_read_b64_tr_b16 v[116:117], v11 offset:5120
s_lshr_b32 s78, s2, 6
v_mfma_f32_16x16x32_bf16 v[156:159], v[124:127], a[20:23], v[156:159]
ds_read_b64_tr_b16 v[118:119], v11 offset:21504
s_lshl_b32 s78, s78, 14
v_mfma_f32_16x16x32_bf16 v[128:131], v[80:83], a[24:27], v[128:131]
ds_read_b64_tr_b16 v[120:121], v12 offset:5120
s_and_b32 s79, s2, 63
v_mfma_f32_16x16x32_bf16 v[144:147], v[80:83], a[28:31], v[144:147]
ds_read_b64_tr_b16 v[122:123], v12 offset:21504
s_lshl_b32 s79, s79, 8
v_mfma_f32_16x16x32_bf16 v[132:135], v[84:87], a[24:27], v[132:135]
ds_read_b64_tr_b16 v[124:125], v13 offset:5120
s_add_u32 s78, s78, s79
v_mfma_f32_16x16x32_bf16 v[148:151], v[84:87], a[28:31], v[148:151]
ds_read_b64_tr_b16 v[126:127], v13 offset:21504
s_waitcnt lgkmcnt(6)
v_mfma_f32_16x16x32_bf16 v[136:139], v[88:91], a[24:27], v[136:139]
ds_read_b64_tr_b16 v[80:81], v10 offset:6144
s_lshl_b32 s79, s72, 6
v_mfma_f32_16x16x32_bf16 v[152:155], v[88:91], a[28:31], v[152:155]
ds_read_b64_tr_b16 v[82:83], v10 offset:22528
s_add_u32 s78, s78, s79
v_mfma_f32_16x16x32_bf16 v[140:143], v[92:95], a[24:27], v[140:143]
ds_read_b64_tr_b16 v[84:85], v11 offset:6144
s_add_u32 s78, s78, 589824
v_mfma_f32_16x16x32_bf16 v[156:159], v[92:95], a[28:31], v[156:159]
ds_read_b64_tr_b16 v[86:87], v11 offset:22528
v_add_u32 v69, s78, v1
v_mfma_f32_16x16x32_bf16 v[128:131], v[96:99], a[32:35], v[128:131]
ds_read_b64_tr_b16 v[88:89], v12 offset:6144
v_mov_b32 v6, s96
v_mfma_f32_16x16x32_bf16 v[144:147], v[96:99], a[36:39], v[144:147]
ds_read_b64_tr_b16 v[90:91], v12 offset:22528
v_and_b32 v5, 15, v1
v_mfma_f32_16x16x32_bf16 v[132:135], v[100:103], a[32:35], v[132:135]
v_cmp_eq_u32 vcc, 0, v5
s_nop 1
v_cndmask_b32 v69, v6, v69, vcc
v_mfma_f32_16x16x32_bf16 v[148:151], v[100:103], a[36:39], v[148:151]
ds_read_b64_tr_b16 v[92:93], v13 offset:6144
ds_read_b64_tr_b16 v[94:95], v13 offset:22528
v_mfma_f32_16x16x32_bf16 v[136:139], v[104:107], a[32:35], v[136:139]
ds_read_b64_tr_b16 v[96:97], v10 offset:7168
s_and_b32 s78, s2, 7
v_mfma_f32_16x16x32_bf16 v[152:155], v[104:107], a[36:39], v[152:155]
ds_read_b64_tr_b16 v[98:99], v10 offset:23552
s_lshl_b32 s78, s78, 11
v_mfma_f32_16x16x32_bf16 v[140:143], v[108:111], a[32:35], v[140:143]
ds_read_b64_tr_b16 v[100:101], v11 offset:7168
s_add_u32 s78, s78, 16384
v_mfma_f32_16x16x32_bf16 v[156:159], v[108:111], a[36:39], v[156:159]
ds_read_b64_tr_b16 v[102:103], v11 offset:23552
v_lshl_add_u32 v70, v1, 7, s78
v_mfma_f32_16x16x32_bf16 v[128:131], v[112:115], a[40:43], v[128:131]
v_cmp_gt_u32 vcc, 16, v0
s_nop 1
v_cndmask_b32 v70, v6, v70, vcc
v_mfma_f32_16x16x32_bf16 v[144:147], v[112:115], a[44:47], v[144:147]
ds_read_b64_tr_b16 v[104:105], v12 offset:7168
s_waitcnt lgkmcnt(5)
v_mfma_f32_16x16x32_bf16 v[132:135], v[116:119], a[40:43], v[132:135]
ds_read_b64_tr_b16 v[106:107], v12 offset:23552
ds_read_b64_tr_b16 v[108:109], v13 offset:7168
v_mfma_f32_16x16x32_bf16 v[148:151], v[116:119], a[44:47], v[148:151]
ds_read_b64_tr_b16 v[110:111], v13 offset:23552
s_lshl_b32 s80, s73, 4
v_mfma_f32_16x16x32_bf16 v[136:139], v[120:123], a[40:43], v[136:139]
s_add_u32 s80, s80, s74
v_lshrrev_b32 v5, 1, v46
v_mfma_f32_16x16x32_bf16 v[152:155], v[120:123], a[44:47], v[152:155]
s_lshl_b32 s78, s72, 12
s_add_u32 s78, s78, 147456
v_mfma_f32_16x16x32_bf16 v[140:143], v[124:127], a[40:43], v[140:143]
v_add_u32 v74, s78, v46
v_add_u32 v75, s78, v5
v_mfma_f32_16x16x32_bf16 v[156:159], v[124:127], a[44:47], v[156:159]
v_add_u32 v53, 4096, v74
v_add_u32 v72, 4096, v75
v_mfma_f32_16x16x32_bf16 v[128:131], v[80:83], a[48:51], v[128:131]
s_waitcnt vmcnt(21) lgkmcnt(0)
s_barrier
v_mfma_f32_16x16x32_bf16 v[144:147], v[80:83], a[52:55], v[144:147]
ds_read_b64_tr_b16 v[112:113], v10 offset:32768
ds_read_b64_tr_b16 v[114:115], v10 offset:49152
v_mfma_f32_16x16x32_bf16 v[132:135], v[84:87], a[48:51], v[132:135]
ds_read_b64_tr_b16 v[116:117], v11 offset:32768
s_add_u32 m0, s76, 0
v_mfma_f32_16x16x32_bf16 v[148:151], v[84:87], a[52:55], v[148:151]
ds_read_b64_tr_b16 v[118:119], v11 offset:49152
s_add_u32 s77, s82, 0x480800
v_mfma_f32_16x16x32_bf16 v[136:139], v[88:91], a[48:51], v[136:139]
ds_read_b64_tr_b16 v[120:121], v12 offset:32768
ds_read_b64_tr_b16 v[122:123], v12 offset:49152
v_mfma_f32_16x16x32_bf16 v[152:155], v[88:91], a[52:55], v[152:155]
buffer_load_dwordx4 v22, s[32:35], s77 offen offset:0 lds
v_mfma_f32_16x16x32_bf16 v[140:143], v[92:95], a[48:51], v[140:143]
ds_read_b64_tr_b16 v[124:125], v13 offset:32768
ds_read_b64_tr_b16 v[126:127], v13 offset:49152
v_mfma_f32_16x16x32_bf16 v[156:159], v[92:95], a[52:55], v[156:159]
ds_read_b64_tr_b16 v[80:81], v10 offset:33792
s_lshl_b32 s78, s80, 12
v_mfma_f32_16x16x32_bf16 v[128:131], v[96:99], a[56:59], v[128:131]
ds_read_b64_tr_b16 v[82:83], v10 offset:50176
ds_read_b64_tr_b16 v[84:85], v11 offset:33792
v_mfma_f32_16x16x32_bf16 v[144:147], v[96:99], a[60:63], v[144:147]
ds_read_b64_tr_b16 v[86:87], v11 offset:50176
s_add_u32 s78, s78, 0x100000
v_mfma_f32_16x16x32_bf16 v[132:135], v[100:103], a[56:59], v[132:135]
s_cmp_eq_u32 s72, 3
s_cselect_b32 s79, s78, s96
v_mfma_f32_16x16x32_bf16 v[148:151], v[100:103], a[60:63], v[148:151]
ds_read_b64_tr_b16 v[88:89], v12 offset:33792
ds_read_b64_tr_b16 v[90:91], v12 offset:50176
v_mfma_f32_16x16x32_bf16 v[136:139], v[104:107], a[56:59], v[136:139]
buffer_load_dwordx4 v23, s[32:35], s77 offen offset:1024 lds
v_mfma_f32_16x16x32_bf16 v[152:155], v[104:107], a[60:63], v[152:155]
ds_read_b64_tr_b16 v[92:93], v13 offset:33792
ds_read_b64_tr_b16 v[94:95], v13 offset:50176
v_mfma_f32_16x16x32_bf16 v[140:143], v[108:111], a[56:59], v[140:143]
ds_read_b64_tr_b16 v[96:97], v10 offset:34816
v_add_u32 v54, s79, v46
v_mfma_f32_16x16x32_bf16 v[156:159], v[108:111], a[60:63], v[156:159]
ds_read_b64_tr_b16 v[98:99], v10 offset:51200
s_waitcnt lgkmcnt(6)
v_mfma_f32_16x16x32_bf16 v[128:131], v[112:115], a[64:67], v[128:131]
ds_read_b64_tr_b16 v[100:101], v11 offset:34816
ds_read_b64_tr_b16 v[102:103], v11 offset:51200
v_mfma_f32_16x16x32_bf16 v[144:147], v[112:115], a[68:71], v[144:147]
ds_read_b64_tr_b16 v[104:105], v12 offset:34816
v_add_u32 v73, s79, v5
v_mfma_f32_16x16x32_bf16 v[132:135], v[116:119], a[64:67], v[132:135]
buffer_load_dwordx4 v24, s[32:35], s77 offen offset:2048 lds
v_mfma_f32_16x16x32_bf16 v[148:151], v[116:119], a[68:71], v[148:151]
ds_read_b64_tr_b16 v[106:107], v12 offset:51200
ds_read_b64_tr_b16 v[108:109], v13 offset:34816
v_mfma_f32_16x16x32_bf16 v[136:139], v[120:123], a[64:67], v[136:139]
ds_read_b64_tr_b16 v[110:111], v13 offset:51200
s_sub_u32 s78, s78, 65536
v_mfma_f32_16x16x32_bf16 v[152:155], v[120:123], a[68:71], v[152:155]
s_cmp_eq_u32 s72, 0
s_cselect_b32 s79, s73, 0
s_cselect_b32 s68, 0, 16384
v_mfma_f32_16x16x32_bf16 v[140:143], v[124:127], a[64:67], v[140:143]
ds_read_b64_tr_b16 v[112:113], v10 offset:35840
ds_read_b64_tr_b16 v[114:115], v10 offset:52224
v_mfma_f32_16x16x32_bf16 v[156:159], v[124:127], a[68:71], v[156:159]
ds_read_b64_tr_b16 v[116:117], v11 offset:35840
s_add_u32 s68, s68, 147456
v_mfma_f32_16x16x32_bf16 v[128:131], v[80:83], a[72:75], v[128:131]
buffer_load_dwordx4 v25, s[32:35], s77 offen offset:3072 lds
v_mfma_f32_16x16x32_bf16 v[144:147], v[80:83], a[76:79], v[144:147]
ds_read_b64_tr_b16 v[118:119], v11 offset:52224
ds_read_b64_tr_b16 v[120:121], v12 offset:35840
v_mfma_f32_16x16x32_bf16 v[132:135], v[84:87], a[72:75], v[132:135]
s_cmp_lg_u32 s79, 0
s_cselect_b32 s78, s78, s96
v_mfma_f32_16x16x32_bf16 v[148:151], v[84:87], a[76:79], v[148:151]
ds_read_b64_tr_b16 v[122:123], v12 offset:52224
s_waitcnt lgkmcnt(6)
v_mfma_f32_16x16x32_bf16 v[136:139], v[88:91], a[72:75], v[136:139]
ds_read_b64_tr_b16 v[124:125], v13 offset:35840
s_add_u32 m0, s76, 4096
v_mfma_f32_16x16x32_bf16 v[152:155], v[88:91], a[76:79], v[152:155]
ds_read_b64_tr_b16 v[126:127], v13 offset:52224
s_add_u32 s77, s82, 0x540800
v_mfma_f32_16x16x32_bf16 v[140:143], v[92:95], a[72:75], v[140:143]
buffer_load_dwordx4 v22, s[32:35], s77 offen offset:0 lds
v_mfma_f32_16x16x32_bf16 v[156:159], v[92:95], a[76:79], v[156:159]
ds_read_b64_tr_b16 v[80:81], v10 offset:36864
ds_read_b64_tr_b16 v[82:83], v10 offset:53248
v_mfma_f32_16x16x32_bf16 v[128:131], v[96:99], a[80:83], v[128:131]
ds_read_b64_tr_b16 v[84:85], v11 offset:36864
v_add_u32 v68, s78, v46
v_mfma_f32_16x16x32_bf16 v[144:147], v[96:99], a[84:87], v[144:147]
ds_read_b64_tr_b16 v[86:87], v11 offset:53248
ds_read_b64_tr_b16 v[88:89], v12 offset:36864
v_mfma_f32_16x16x32_bf16 v[132:135], v[100:103], a[80:83], v[132:135]
ds_read_b64_tr_b16 v[90:91], v12 offset:53248
s_lshl_b32 s80, s80, 10
v_mfma_f32_16x16x32_bf16 v[148:151], v[100:103], a[84:87], v[148:151]
ds_read_b64_tr_b16 v[92:93], v13 offset:36864
ds_read_b64_tr_b16 v[94:95], v13 offset:53248
v_mfma_f32_16x16x32_bf16 v[136:139], v[104:107], a[80:83], v[136:139]
buffer_load_dwordx4 v23, s[32:35], s77 offen offset:1024 lds
v_mfma_f32_16x16x32_bf16 v[152:155], v[104:107], a[84:87], v[152:155]
ds_read_b64_tr_b16 v[96:97], v10 offset:37888
ds_read_b64_tr_b16 v[98:99], v10 offset:54272
v_mfma_f32_16x16x32_bf16 v[140:143], v[108:111], a[80:83], v[140:143]
ds_read_b64_tr_b16 v[100:101], v11 offset:37888
s_add_u32 s80, s80, 32768
v_mfma_f32_16x16x32_bf16 v[156:159], v[108:111], a[84:87], v[156:159]
ds_read_b64_tr_b16 v[102:103], v11 offset:54272
s_waitcnt lgkmcnt(7)
v_mfma_f32_16x16x32_bf16 v[128:131], v[112:115], a[88:91], v[128:131]
s_cmp_lg_u32 s79, 0
s_cselect_b32 s98, s80, s90
s_cselect_b32 s99, 1, 0
v_mfma_f32_16x16x32_bf16 v[144:147], v[112:115], a[92:95], v[144:147]
ds_read_b64_tr_b16 v[104:105], v12 offset:37888
ds_read_b64_tr_b16 v[106:107], v12 offset:54272
v_mfma_f32_16x16x32_bf16 v[132:135], v[116:119], a[88:91], v[132:135]
buffer_load_dwordx4 v24, s[32:35], s77 offen offset:2048 lds
v_mfma_f32_16x16x32_bf16 v[148:151], v[116:119], a[92:95], v[148:151]
ds_read_b64_tr_b16 v[108:109], v13 offset:37888
ds_read_b64_tr_b16 v[110:111], v13 offset:54272
v_mfma_f32_16x16x32_bf16 v[136:139], v[120:123], a[88:91], v[136:139]
ds_read_b64_tr_b16 v[112:113], v10 offset:38912
s_add_u32 s80, s80, 16384
v_mfma_f32_16x16x32_bf16 v[152:155], v[120:123], a[92:95], v[152:155]
s_cmp_eq_u32 s72, 3
s_cselect_b32 s78, s73, 15
v_mfma_f32_16x16x32_bf16 v[140:143], v[124:127], a[88:91], v[140:143]
ds_read_b64_tr_b16 v[114:115], v10 offset:55296
ds_read_b64_tr_b16 v[116:117], v11 offset:38912
v_mfma_f32_16x16x32_bf16 v[156:159], v[124:127], a[92:95], v[156:159]
s_cmp_lt_u32 s78, 15
s_cselect_b32 s97, s80, s90
s_cselect_b32 s85, 1, 0
v_mfma_f32_16x16x32_bf16 v[128:131], v[80:83], a[96:99], v[128:131]
ds_read_b64_tr_b16 v[118:119], v11 offset:55296
ds_read_b64_tr_b16 v[120:121], v12 offset:38912
v_mfma_f32_16x16x32_bf16 v[144:147], v[80:83], a[100:103], v[144:147]
buffer_load_dwordx4 v25, s[32:35], s77 offen offset:3072 lds
v_mfma_f32_16x16x32_bf16 v[132:135], v[84:87], a[96:99], v[132:135]
ds_read_b64_tr_b16 v[122:123], v12 offset:55296
ds_read_b64_tr_b16 v[124:125], v13 offset:38912
v_mfma_f32_16x16x32_bf16 v[148:151], v[84:87], a[100:103], v[148:151]
ds_read_b64_tr_b16 v[126:127], v13 offset:55296
s_waitcnt lgkmcnt(7)
v_mfma_f32_16x16x32_bf16 v[136:139], v[88:91], a[96:99], v[136:139]
ds_read_b64_tr_b16 v[80:81], v10 offset:39936
ds_read_b64_tr_b16 v[82:83], v10 offset:56320
v_mfma_f32_16x16x32_bf16 v[152:155], v[88:91], a[100:103], v[152:155]
ds_read_b64_tr_b16 v[84:85], v11 offset:39936
v_mfma_f32_16x16x32_bf16 v[140:143], v[92:95], a[96:99], v[140:143]
ds_read_b64_tr_b16 v[86:87], v11 offset:56320
ds_read_b64_tr_b16 v[88:89], v12 offset:39936
v_mfma_f32_16x16x32_bf16 v[156:159], v[92:95], a[100:103], v[156:159]
ds_read_b64_tr_b16 v[90:91], v12 offset:56320
v_mfma_f32_16x16x32_bf16 v[128:131], v[96:99], a[104:107], v[128:131]
ds_read_b64_tr_b16 v[92:93], v13 offset:39936
v_mfma_f32_16x16x32_bf16 v[144:147], v[96:99], a[108:111], v[144:147]
ds_read_b64_tr_b16 v[94:95], v13 offset:56320
v_mfma_f32_16x16x32_bf16 v[132:135], v[100:103], a[104:107], v[132:135]
v_mfma_f32_16x16x32_bf16 v[148:151], v[100:103], a[108:111], v[148:151]
v_mfma_f32_16x16x32_bf16 v[136:139], v[104:107], a[104:107], v[136:139]
v_mfma_f32_16x16x32_bf16 v[152:155], v[104:107], a[108:111], v[152:155]
v_mfma_f32_16x16x32_bf16 v[140:143], v[108:111], a[104:107], v[140:143]
s_waitcnt vmcnt(21) lgkmcnt(0)
s_barrier
v_mfma_f32_16x16x32_bf16 v[156:159], v[108:111], a[108:111], v[156:159]
ds_read_b64_tr_b16 v[96:97], v14 offset:0
ds_read_b64_tr_b16 v[98:99], v14 offset:16384
v_mfma_f32_16x16x32_bf16 v[128:131], v[112:115], a[112:115], v[128:131]
ds_read_b64_tr_b16 v[100:101], v15 offset:0
s_add_u32 m0, s76, 32768
v_mfma_f32_16x16x32_bf16 v[144:147], v[112:115], a[116:119], v[144:147]
ds_read_b64_tr_b16 v[102:103], v15 offset:16384
s_add_u32 s77, s82, 0x1000
v_mfma_f32_16x16x32_bf16 v[132:135], v[116:119], a[112:115], v[132:135]
buffer_load_dwordx4 v22, s[32:35], s77 offen offset:0 lds
v_mfma_f32_16x16x32_bf16 v[148:151], v[116:119], a[116:119], v[148:151]
ds_read_b64_tr_b16 v[104:105], v16 offset:0
ds_read_b64_tr_b16 v[106:107], v16 offset:16384
v_mfma_f32_16x16x32_bf16 v[136:139], v[120:123], a[112:115], v[136:139]
ds_read_b64_tr_b16 v[108:109], v17 offset:0
v_mfma_f32_16x16x32_bf16 v[152:155], v[120:123], a[116:119], v[152:155]
ds_read_b64_tr_b16 v[110:111], v17 offset:16384
ds_read_b64_tr_b16 v[112:113], v14 offset:1024
v_mfma_f32_16x16x32_bf16 v[140:143], v[124:127], a[112:115], v[140:143]
ds_read_b64_tr_b16 v[114:115], v14 offset:17408
v_mfma_f32_16x16x32_bf16 v[156:159], v[124:127], a[116:119], v[156:159]
ds_read_b64_tr_b16 v[116:117], v15 offset:1024
ds_read_b64_tr_b16 v[118:119], v15 offset:17408
v_mfma_f32_16x16x32_bf16 v[128:131], v[80:83], a[120:123], v[128:131]
buffer_load_dwordx4 v23, s[32:35], s77 offen offset:1024 lds
v_mfma_f32_16x16x32_bf16 v[144:147], v[80:83], a[124:127], v[144:147]
ds_read_b64_tr_b16 v[120:121], v16 offset:1024
ds_read_b64_tr_b16 v[122:123], v16 offset:17408
v_mfma_f32_16x16x32_bf16 v[132:135], v[84:87], a[120:123], v[132:135]
ds_read_b64_tr_b16 v[124:125], v17 offset:1024
v_mfma_f32_16x16x32_bf16 v[148:151], v[84:87], a[124:127], v[148:151]
ds_read_b64_tr_b16 v[126:127], v17 offset:17408
ds_read_b64_tr_b16 v[80:81], v14 offset:2048
v_mfma_f32_16x16x32_bf16 v[136:139], v[88:91], a[120:123], v[136:139]
ds_read_b64_tr_b16 v[82:83], v14 offset:18432
v_mfma_f32_16x16x32_bf16 v[152:155], v[88:91], a[124:127], v[152:155]
ds_read_b64_tr_b16 v[84:85], v15 offset:2048
ds_read_b64_tr_b16 v[86:87], v15 offset:18432
v_mfma_f32_16x16x32_bf16 v[140:143], v[92:95], a[120:123], v[140:143]
buffer_load_dwordx4 v24, s[32:35], s77 offen offset:2048 lds
v_mfma_f32_16x16x32_bf16 v[156:159], v[92:95], a[124:127], v[156:159]
ds_read_b64_tr_b16 v[88:89], v16 offset:2048
s_waitcnt lgkmcnt(7)
v_mfma_f32_16x16x32_bf16 v[128:131], v[96:99], a[128:131], v[128:131]
ds_read_b64_tr_b16 v[90:91], v16 offset:18432
ds_read_b64_tr_b16 v[92:93], v17 offset:2048
v_mfma_f32_16x16x32_bf16 v[144:147], v[96:99], a[132:135], v[144:147]
ds_read_b64_tr_b16 v[94:95], v17 offset:18432
v_mfma_f32_16x16x32_bf16 v[132:135], v[100:103], a[128:131], v[132:135]
ds_read_b64_tr_b16 v[96:97], v14 offset:3072
v_mfma_f32_16x16x32_bf16 v[148:151], v[100:103], a[132:135], v[148:151]
ds_read_b64_tr_b16 v[98:99], v14 offset:19456
v_mfma_f32_16x16x32_bf16 v[136:139], v[104:107], a[128:131], v[136:139]
buffer_load_dwordx4 v25, s[32:35], s77 offen offset:3072 lds
v_mfma_f32_16x16x32_bf16 v[152:155], v[104:107], a[132:135], v[152:155]
ds_read_b64_tr_b16 v[100:101], v15 offset:3072
ds_read_b64_tr_b16 v[102:103], v15 offset:19456
v_mfma_f32_16x16x32_bf16 v[140:143], v[108:111], a[128:131], v[140:143]
ds_read_b64_tr_b16 v[104:105], v16 offset:3072
v_mfma_f32_16x16x32_bf16 v[156:159], v[108:111], a[132:135], v[156:159]
ds_read_b64_tr_b16 v[106:107], v16 offset:19456
s_add_u32 m0, s76, 36864
v_mfma_f32_16x16x32_bf16 v[128:131], v[112:115], a[136:139], v[128:131]
ds_read_b64_tr_b16 v[108:109], v17 offset:3072
s_add_u32 s77, s82, 0xc1000
v_mfma_f32_16x16x32_bf16 v[144:147], v[112:115], a[140:143], v[144:147]
ds_read_b64_tr_b16 v[110:111], v17 offset:19456
v_mfma_f32_16x16x32_bf16 v[132:135], v[116:119], a[136:139], v[132:135]
buffer_load_dwordx4 v22, s[32:35], s77 offen offset:0 lds
v_mfma_f32_16x16x32_bf16 v[148:151], v[116:119], a[140:143], v[148:151]
ds_read_b64_tr_b16 v[112:113], v14 offset:4096
s_mul_i32 s3, s101, 2048
v_mfma_f32_16x16x32_bf16 v[136:139], v[120:123], a[136:139], v[136:139]
ds_read_b64_tr_b16 v[114:115], v14 offset:20480
s_add_u32 s3, s3, 0x0
v_mfma_f32_16x16x32_bf16 v[152:155], v[120:123], a[140:143], v[152:155]
ds_read_b64_tr_b16 v[116:117], v15 offset:4096
s_waitcnt lgkmcnt(5)
v_mfma_f32_16x16x32_bf16 v[140:143], v[124:127], a[136:139], v[140:143]
ds_read_b64_tr_b16 v[118:119], v15 offset:20480
ds_read_b64_tr_b16 v[120:121], v16 offset:4096
v_mfma_f32_16x16x32_bf16 v[156:159], v[124:127], a[140:143], v[156:159]
ds_read_b64_tr_b16 v[122:123], v16 offset:20480
v_mfma_f32_16x16x32_bf16 v[128:131], v[80:83], a[144:147], v[128:131]
buffer_load_dwordx4 v23, s[32:35], s77 offen offset:1024 lds
v_mfma_f32_16x16x32_bf16 v[144:147], v[80:83], a[148:151], v[144:147]
ds_read_b64_tr_b16 v[124:125], v17 offset:4096
ds_read_b64_tr_b16 v[126:127], v17 offset:20480
v_mfma_f32_16x16x32_bf16 v[132:135], v[84:87], a[144:147], v[132:135]
ds_read_b64_tr_b16 v[80:81], v14 offset:5120
v_mfma_f32_16x16x32_bf16 v[148:151], v[84:87], a[148:151], v[148:151]
ds_read_b64_tr_b16 v[82:83], v14 offset:21504
v_mfma_f32_16x16x32_bf16 v[136:139], v[88:91], a[144:147], v[136:139]
ds_read_b64_tr_b16 v[84:85], v15 offset:5120
v_mfma_f32_16x16x32_bf16 v[152:155], v[88:91], a[148:151], v[152:155]
ds_read_b64_tr_b16 v[86:87], v15 offset:21504
v_mfma_f32_16x16x32_bf16 v[140:143], v[92:95], a[144:147], v[140:143]
buffer_load_dwordx4 v24, s[32:35], s77 offen offset:2048 lds
v_mfma_f32_16x16x32_bf16 v[156:159], v[92:95], a[148:151], v[156:159]
ds_read_b64_tr_b16 v[88:89], v16 offset:5120
ds_read_b64_tr_b16 v[90:91], v16 offset:21504
v_mfma_f32_16x16x32_bf16 v[128:131], v[96:99], a[152:155], v[128:131]
ds_read_b64_tr_b16 v[92:93], v17 offset:5120
v_mfma_f32_16x16x32_bf16 v[144:147], v[96:99], a[156:159], v[144:147]
ds_read_b64_tr_b16 v[94:95], v17 offset:21504
v_mfma_f32_16x16x32_bf16 v[132:135], v[100:103], a[152:155], v[132:135]
ds_read_b64_tr_b16 v[96:97], v14 offset:6144
v_mfma_f32_16x16x32_bf16 v[148:151], v[100:103], a[156:159], v[148:151]
ds_read_b64_tr_b16 v[98:99], v14 offset:22528
v_mfma_f32_16x16x32_bf16 v[136:139], v[104:107], a[152:155], v[136:139]
buffer_load_dwordx4 v25, s[32:35], s77 offen offset:3072 lds
v_mfma_f32_16x16x32_bf16 v[152:155], v[104:107], a[156:159], v[152:155]
ds_read_b64_tr_b16 v[100:101], v15 offset:6144
s_waitcnt lgkmcnt(5)
v_mfma_f32_16x16x32_bf16 v[140:143], v[108:111], a[152:155], v[140:143]
buffer_load_dword v57, v8, s[36:39], s3 offen
v_mfma_f32_16x16x32_bf16 v[156:159], v[108:111], a[156:159], v[156:159]
ds_read_b64_tr_b16 v[102:103], v15 offset:22528
s_mul_i32 s3, s101, 1024
v_mfma_f32_16x16x32_bf16 v[128:131], v[112:115], a[160:163], v[128:131]
ds_read_b64_tr_b16 v[104:105], v16 offset:6144
s_add_u32 s3, s3, 0x0
v_mfma_f32_16x16x32_bf16 v[144:147], v[112:115], a[164:167], v[144:147]
buffer_load_dword v57, v50, s[48:51], s3 offen
v_mfma_f32_16x16x32_bf16 v[132:135], v[116:119], a[160:163], v[132:135]
ds_read_b64_tr_b16 v[106:107], v16 offset:22528
ds_read_b64_tr_b16 v[108:109], v17 offset:6144
v_mfma_f32_16x16x32_bf16 v[148:151], v[116:119], a[164:167], v[148:151]
ds_read_b64_tr_b16 v[110:111], v17 offset:22528
v_mfma_f32_16x16x32_bf16 v[136:139], v[120:123], a[160:163], v[136:139]
ds_read_b64_tr_b16 v[112:113], v14 offset:7168
ds_read_b64_tr_b16 v[114:115], v14 offset:23552
v_mfma_f32_16x16x32_bf16 v[152:155], v[120:123], a[164:167], v[152:155]
ds_read_b64_tr_b16 v[116:117], v15 offset:7168
v_mfma_f32_16x16x32_bf16 v[140:143], v[124:127], a[160:163], v[140:143]
ds_read_b64_tr_b16 v[118:119], v15 offset:23552
ds_read_b64_tr_b16 v[120:121], v16 offset:7168
v_mfma_f32_16x16x32_bf16 v[156:159], v[124:127], a[164:167], v[156:159]
ds_read_b64_tr_b16 v[122:123], v16 offset:23552
v_mfma_f32_16x16x32_bf16 v[128:131], v[80:83], a[168:171], v[128:131]
ds_read_b64_tr_b16 v[124:125], v17 offset:7168
v_mfma_f32_16x16x32_bf16 v[144:147], v[80:83], a[172:175], v[144:147]
ds_read_b64_tr_b16 v[126:127], v17 offset:23552
v_mfma_f32_16x16x32_bf16 v[132:135], v[84:87], a[168:171], v[132:135]
v_mfma_f32_16x16x32_bf16 v[148:151], v[84:87], a[172:175], v[148:151]
v_mfma_f32_16x16x32_bf16 v[136:139], v[88:91], a[168:171], v[136:139]
v_mfma_f32_16x16x32_bf16 v[152:155], v[88:91], a[172:175], v[152:155]
s_waitcnt lgkmcnt(2)
v_mfma_f32_16x16x32_bf16 v[140:143], v[92:95], a[168:171], v[140:143]
s_waitcnt vmcnt(23) lgkmcnt(0)
s_barrier
v_mfma_f32_16x16x32_bf16 v[156:159], v[92:95], a[172:175], v[156:159]
ds_read_b64_tr_b16 v[80:81], v55 offset:32768
ds_read_b64_tr_b16 v[82:83], v55 offset:49152
v_mfma_f32_16x16x32_bf16 v[128:131], v[96:99], a[176:179], v[128:131]
ds_read_b64_tr_b16 v[84:85], v55 offset:33792
s_add_u32 m0, s76, 65536
v_mfma_f32_16x16x32_bf16 v[144:147], v[96:99], a[180:183], v[144:147]
ds_read_b64_tr_b16 v[86:87], v55 offset:50176
s_add_u32 s77, s82, 0x181000
v_mfma_f32_16x16x32_bf16 v[132:135], v[100:103], a[176:179], v[132:135]
buffer_load_dwordx4 v22, s[32:35], s77 offen offset:0 lds
v_mfma_f32_16x16x32_bf16 v[148:151], v[100:103], a[180:183], v[148:151]
ds_read_b64_tr_b16 v[88:89], v55 offset:34816
ds_read_b64_tr_b16 v[90:91], v55 offset:51200
v_mfma_f32_16x16x32_bf16 v[136:139], v[104:107], a[176:179], v[136:139]
ds_read_b64_tr_b16 v[92:93], v55 offset:35840
v_mfma_f32_16x16x32_bf16 v[152:155], v[104:107], a[180:183], v[152:155]
ds_read_b64_tr_b16 v[94:95], v55 offset:52224
ds_read_b64_tr_b16 v[96:97], v55 offset:36864
v_mfma_f32_16x16x32_bf16 v[140:143], v[108:111], a[176:179], v[140:143]
ds_read_b64_tr_b16 v[98:99], v55 offset:53248
v_mfma_f32_16x16x32_bf16 v[156:159], v[108:111], a[180:183], v[156:159]
ds_read_b64_tr_b16 v[100:101], v55 offset:37888
ds_read_b64_tr_b16 v[102:103], v55 offset:54272
v_mfma_f32_16x16x32_bf16 v[128:131], v[112:115], a[184:187], v[128:131]
buffer_load_dwordx4 v23, s[32:35], s77 offen offset:1024 lds
v_mfma_f32_16x16x32_bf16 v[144:147], v[112:115], a[188:191], v[144:147]
ds_read_b64_tr_b16 v[104:105], v55 offset:38912
ds_read_b64_tr_b16 v[106:107], v55 offset:55296
v_mfma_f32_16x16x32_bf16 v[132:135], v[116:119], a[184:187], v[132:135]
ds_read_b64_tr_b16 v[108:109], v55 offset:39936
v_mfma_f32_16x16x32_bf16 v[148:151], v[116:119], a[188:191], v[148:151]
ds_read_b64_tr_b16 v[110:111], v55 offset:56320
v_mfma_f32_16x16x32_bf16 v[136:139], v[120:123], a[184:187], v[136:139]
v_mfma_f32_16x16x32_bf16 v[152:155], v[120:123], a[188:191], v[152:155]
v_mfma_f32_16x16x32_bf16 v[140:143], v[124:127], a[184:187], v[140:143]
buffer_load_dwordx4 v24, s[32:35], s77 offen offset:2048 lds
v_mfma_f32_16x16x32_bf16 v[156:159], v[124:127], a[188:191], v[156:159]
s_waitcnt lgkmcnt(2)
v_mfma_f32_16x16x32_bf16 v[76:79], v[80:83], v[160:163], 0
s_waitcnt vmcnt(13) lgkmcnt(0)
s_barrier
v_mfma_f32_16x16x32_bf16 v[76:79], v[84:87], v[164:167], v[76:79]
ds_read_b64_tr_b16 v[112:113], v10 offset:0
ds_read_b64_tr_b16 v[114:115], v10 offset:16384
v_mfma_f32_16x16x32_bf16 v[76:79], v[88:91], v[168:171], v[76:79]
ds_read_b64_tr_b16 v[116:117], v11 offset:0
ds_read_b64_tr_b16 v[118:119], v11 offset:16384
v_mfma_f32_16x16x32_bf16 v[76:79], v[92:95], v[172:175], v[76:79]
ds_read_b64_tr_b16 v[120:121], v12 offset:0
ds_read_b64_tr_b16 v[122:123], v12 offset:16384
v_mfma_f32_16x16x32_bf16 v[76:79], v[96:99], v[176:179], v[76:79]
ds_read_b64_tr_b16 v[124:125], v13 offset:0
ds_read_b64_tr_b16 v[126:127], v13 offset:16384
v_mfma_f32_16x16x32_bf16 v[76:79], v[100:103], v[180:183], v[76:79]
ds_read_b64_tr_b16 v[80:81], v10 offset:1024
ds_read_b64_tr_b16 v[82:83], v10 offset:17408
v_mfma_f32_16x16x32_bf16 v[76:79], v[104:107], v[184:187], v[76:79]
ds_read_b64_tr_b16 v[84:85], v11 offset:1024
ds_read_b64_tr_b16 v[86:87], v11 offset:17408
v_mfma_f32_16x16x32_bf16 v[76:79], v[108:111], v[188:191], v[76:79]
ds_read_b64_tr_b16 v[88:89], v12 offset:1024
s_waitcnt lgkmcnt(11)
v_mfma_f32_16x16x32_bf16 v[128:131], v[112:115], a[192:195], v[128:131]
ds_read_b64_tr_b16 v[90:91], v12 offset:17408
ds_read_b64_tr_b16 v[92:93], v13 offset:1024
v_mfma_f32_16x16x32_bf16 v[144:147], v[112:115], a[196:199], v[144:147]
ds_read_b64_tr_b16 v[94:95], v13 offset:17408
s_waitcnt lgkmcnt(10)
v_mfma_f32_16x16x32_bf16 v[132:135], v[116:119], a[192:195], v[132:135]
ds_read_b64_tr_b16 v[96:97], v10 offset:2048
ds_read_b64_tr_b16 v[98:99], v10 offset:18432
v_mfma_f32_16x16x32_bf16 v[148:151], v[116:119], a[196:199], v[148:151]
ds_read_b64_tr_b16 v[100:101], v11 offset:2048
ds_read_b64_tr_b16 v[102:103], v11 offset:18432
v_mfma_f32_16x16x32_bf16 v[136:139], v[120:123], a[192:195], v[136:139]
ds_read_b64_tr_b16 v[104:105], v12 offset:2048
v_mfma_f32_16x16x32_bf16 v[152:155], v[120:123], a[196:199], v[152:155]
ds_read_b64_tr_b16 v[106:107], v12 offset:18432
s_waitcnt lgkmcnt(9)
v_mfma_f32_16x16x32_bf16 v[140:143], v[124:127], a[192:195], v[140:143]
ds_read_b64_tr_b16 v[108:109], v13 offset:2048
ds_read_b64_tr_b16 v[110:111], v13 offset:18432
v_mfma_f32_16x16x32_bf16 v[156:159], v[124:127], a[196:199], v[156:159]
buffer_load_dwordx4 v25, s[32:35], s77 offen offset:3072 lds
v_mfma_f32_16x16x32_bf16 v[128:131], v[80:83], a[200:203], v[128:131]
ds_read_b64_tr_b16 v[112:113], v10 offset:3072
ds_read_b64_tr_b16 v[114:115], v10 offset:19456
v_mfma_f32_16x16x32_bf16 v[144:147], v[80:83], a[204:207], v[144:147]
buffer_store_dwordx4 v[76:79], v69, s[60:63], 0 offen sc1
v_mfma_f32_16x16x32_bf16 v[132:135], v[84:87], a[200:203], v[132:135]
ds_read_b64_tr_b16 v[116:117], v11 offset:3072
ds_read_b64_tr_b16 v[118:119], v11 offset:19456
v_mfma_f32_16x16x32_bf16 v[148:151], v[84:87], a[204:207], v[148:151]
ds_read_b64_tr_b16 v[120:121], v12 offset:3072
s_waitcnt lgkmcnt(7)
v_mfma_f32_16x16x32_bf16 v[136:139], v[88:91], a[200:203], v[136:139]
ds_read_b64_tr_b16 v[122:123], v12 offset:19456
s_add_u32 m0, s76, 69632
v_mfma_f32_16x16x32_bf16 v[152:155], v[88:91], a[204:207], v[152:155]
ds_read_b64_tr_b16 v[124:125], v13 offset:3072
s_add_u32 s77, s82, 0x241000
v_mfma_f32_16x16x32_bf16 v[140:143], v[92:95], a[200:203], v[140:143]
buffer_load_dwordx4 v22, s[32:35], s77 offen offset:0 lds
v_mfma_f32_16x16x32_bf16 v[156:159], v[92:95], a[204:207], v[156:159]
ds_read_b64_tr_b16 v[126:127], v13 offset:19456
ds_read_b64_tr_b16 v[80:81], v10 offset:4096
v_mfma_f32_16x16x32_bf16 v[128:131], v[96:99], a[208:211], v[128:131]
ds_read_b64_tr_b16 v[82:83], v10 offset:20480
v_mfma_f32_16x16x32_bf16 v[144:147], v[96:99], a[212:215], v[144:147]
ds_read_b64_tr_b16 v[84:85], v11 offset:4096
ds_read_b64_tr_b16 v[86:87], v11 offset:20480
v_mfma_f32_16x16x32_bf16 v[132:135], v[100:103], a[208:211], v[132:135]
buffer_load_dwordx4 v23, s[32:35], s77 offen offset:1024 lds
v_mfma_f32_16x16x32_bf16 v[148:151], v[100:103], a[212:215], v[148:151]
ds_read_b64_tr_b16 v[88:89], v12 offset:4096
ds_read_b64_tr_b16 v[90:91], v12 offset:20480
v_mfma_f32_16x16x32_bf16 v[136:139], v[104:107], a[208:211], v[136:139]
ds_read_b64_tr_b16 v[92:93], v13 offset:4096
v_mfma_f32_16x16x32_bf16 v[152:155], v[104:107], a[212:215], v[152:155]
ds_read_b64_tr_b16 v[94:95], v13 offset:20480
s_waitcnt lgkmcnt(7)
v_mfma_f32_16x16x32_bf16 v[140:143], v[108:111], a[208:211], v[140:143]
buffer_load_dwordx4 v24, s[32:35], s77 offen offset:2048 lds
v_mfma_f32_16x16x32_bf16 v[156:159], v[108:111], a[212:215], v[156:159]
ds_read_b64_tr_b16 v[96:97], v10 offset:5120
ds_read_b64_tr_b16 v[98:99], v10 offset:21504
v_mfma_f32_16x16x32_bf16 v[128:131], v[112:115], a[216:219], v[128:131]
ds_read_b64_tr_b16 v[100:101], v11 offset:5120
v_mfma_f32_16x16x32_bf16 v[144:147], v[112:115], a[220:223], v[144:147]
ds_read_b64_tr_b16 v[102:103], v11 offset:21504
ds_read_b64_tr_b16 v[104:105], v12 offset:5120
v_mfma_f32_16x16x32_bf16 v[132:135], v[116:119], a[216:219], v[132:135]
buffer_load_dwordx4 v25, s[32:35], s77 offen offset:3072 lds
v_mfma_f32_16x16x32_bf16 v[148:151], v[116:119], a[220:223], v[148:151]
ds_read_b64_tr_b16 v[106:107], v12 offset:21504
ds_read_b64_tr_b16 v[108:109], v13 offset:5120
v_mfma_f32_16x16x32_bf16 v[136:139], v[120:123], a[216:219], v[136:139]
ds_read_b64_tr_b16 v[110:111], v13 offset:21504
v_mfma_f32_16x16x32_bf16 v[152:155], v[120:123], a[220:223], v[152:155]
ds_read_b64_tr_b16 v[112:113], v10 offset:6144
ds_read_b64_tr_b16 v[114:115], v10 offset:22528
v_mfma_f32_16x16x32_bf16 v[140:143], v[124:127], a[216:219], v[140:143]
ds_read_b64_tr_b16 v[116:117], v11 offset:6144
v_mfma_f32_16x16x32_bf16 v[156:159], v[124:127], a[220:223], v[156:159]
ds_read_b64_tr_b16 v[118:119], v11 offset:22528
s_waitcnt lgkmcnt(7)
v_mfma_f32_16x16x32_bf16 v[128:131], v[80:83], a[224:227], v[128:131]
ds_read_b64_tr_b16 v[120:121], v12 offset:6144
ds_read_b64_tr_b16 v[122:123], v12 offset:22528
v_mfma_f32_16x16x32_bf16 v[144:147], v[80:83], a[228:231], v[144:147]
ds_read_b64_tr_b16 v[124:125], v13 offset:6144
v_mfma_f32_16x16x32_bf16 v[132:135], v[84:87], a[224:227], v[132:135]
ds_read_b64_tr_b16 v[126:127], v13 offset:22528
ds_read_b64_tr_b16 v[80:81], v10 offset:7168
v_mfma_f32_16x16x32_bf16 v[148:151], v[84:87], a[228:231], v[148:151]
ds_read_b64_tr_b16 v[82:83], v10 offset:23552
v_mfma_f32_16x16x32_bf16 v[136:139], v[88:91], a[224:227], v[136:139]
ds_read_b64_tr_b16 v[84:85], v11 offset:7168
v_mfma_f32_16x16x32_bf16 v[152:155], v[88:91], a[228:231], v[152:155]
ds_read_b64_tr_b16 v[86:87], v11 offset:23552
v_mfma_f32_16x16x32_bf16 v[140:143], v[92:95], a[224:227], v[140:143]
ds_read_b64_tr_b16 v[88:89], v12 offset:7168
v_mfma_f32_16x16x32_bf16 v[156:159], v[92:95], a[228:231], v[156:159]
ds_read_b64_tr_b16 v[90:91], v12 offset:23552
v_mfma_f32_16x16x32_bf16 v[128:131], v[96:99], a[232:235], v[128:131]
ds_read_b64_tr_b16 v[92:93], v13 offset:7168
v_mfma_f32_16x16x32_bf16 v[144:147], v[96:99], a[236:239], v[144:147]
ds_read_b64_tr_b16 v[94:95], v13 offset:23552
v_mfma_f32_16x16x32_bf16 v[132:135], v[100:103], a[232:235], v[132:135]
v_mfma_f32_16x16x32_bf16 v[148:151], v[100:103], a[236:239], v[148:151]
s_waitcnt lgkmcnt(4)
v_mfma_f32_16x16x32_bf16 v[136:139], v[104:107], a[232:235], v[136:139]
v_mfma_f32_16x16x32_bf16 v[152:155], v[104:107], a[236:239], v[152:155]
v_mfma_f32_16x16x32_bf16 v[140:143], v[108:111], a[232:235], v[140:143]
s_waitcnt vmcnt(11) lgkmcnt(0)
s_barrier
v_mfma_f32_16x16x32_bf16 v[156:159], v[108:111], a[236:239], v[156:159]
ds_read_b64_tr_b16 v[96:97], v10 offset:32768
ds_read_b64_tr_b16 v[98:99], v10 offset:49152
v_mfma_f32_16x16x32_bf16 v[128:131], v[112:115], a[240:243], v[128:131]
ds_read_b64_tr_b16 v[100:101], v11 offset:32768
v_mfma_f32_16x16x32_bf16 v[144:147], v[112:115], a[244:247], v[144:147]
ds_read_b64_tr_b16 v[102:103], v11 offset:49152
ds_read_b64_tr_b16 v[104:105], v12 offset:32768
v_mfma_f32_16x16x32_bf16 v[132:135], v[116:119], a[240:243], v[132:135]
ds_read_b64_tr_b16 v[106:107], v12 offset:49152
v_mfma_f32_16x16x32_bf16 v[148:151], v[116:119], a[244:247], v[148:151]
ds_read_b64_tr_b16 v[108:109], v13 offset:32768
ds_read_b64_tr_b16 v[110:111], v13 offset:49152
v_mfma_f32_16x16x32_bf16 v[136:139], v[120:123], a[240:243], v[136:139]
ds_read_b64_tr_b16 v[112:113], v10 offset:33792
v_mfma_f32_16x16x32_bf16 v[152:155], v[120:123], a[244:247], v[152:155]
ds_read_b64_tr_b16 v[114:115], v10 offset:50176
ds_read_b64_tr_b16 v[116:117], v11 offset:33792
v_mfma_f32_16x16x32_bf16 v[140:143], v[124:127], a[240:243], v[140:143]
ds_read_b64_tr_b16 v[118:119], v11 offset:50176
v_mfma_f32_16x16x32_bf16 v[156:159], v[124:127], a[244:247], v[156:159]
ds_read_b64_tr_b16 v[120:121], v12 offset:33792
ds_read_b64_tr_b16 v[122:123], v12 offset:50176
v_mfma_f32_16x16x32_bf16 v[128:131], v[80:83], a[248:251], v[128:131]
ds_read_b64_tr_b16 v[124:125], v13 offset:33792
v_mfma_f32_16x16x32_bf16 v[144:147], v[80:83], a[252:255], v[144:147]
ds_read_b64_tr_b16 v[126:127], v13 offset:50176
v_mfma_f32_16x16x32_bf16 v[132:135], v[84:87], a[248:251], v[132:135]
ds_read_b64_tr_b16 v[80:81], v10 offset:34816
v_mfma_f32_16x16x32_bf16 v[148:151], v[84:87], a[252:255], v[148:151]
ds_read_b64_tr_b16 v[82:83], v10 offset:51200
v_mfma_f32_16x16x32_bf16 v[136:139], v[88:91], a[248:251], v[136:139]
ds_read_b64_tr_b16 v[84:85], v11 offset:34816
v_mfma_f32_16x16x32_bf16 v[152:155], v[88:91], a[252:255], v[152:155]
ds_read_b64_tr_b16 v[86:87], v11 offset:51200
v_mfma_f32_16x16x32_bf16 v[140:143], v[92:95], a[248:251], v[140:143]
ds_read_b64_tr_b16 v[88:89], v12 offset:34816
v_mfma_f32_16x16x32_bf16 v[156:159], v[92:95], a[252:255], v[156:159]
ds_read_b64_tr_b16 v[90:91], v12 offset:51200
S_V:
s_waitcnt lgkmcnt(6)
v_mfma_f32_16x16x32_bf16 v[160:163], a[0:3], v[96:99], 0
ds_read_b64_tr_b16 v[92:93], v13 offset:34816
v_and_b32 v2, 15, v1
v_mfma_f32_16x16x32_bf16 v[176:179], a[4:7], v[96:99], 0
ds_read_b64_tr_b16 v[94:95], v13 offset:51200
v_lshrrev_b32 v3, 4, v1
v_mfma_f32_16x16x32_bf16 v[164:167], a[0:3], v[100:103], 0
ds_read_b64_tr_b16 v[96:97], v10 offset:35840
v_lshlrev_b32 v3, 2, v3
v_mfma_f32_16x16x32_bf16 v[180:183], a[4:7], v[100:103], 0
s_add_u32 s70, s0, S_Q - K_pc + 0
s_addc_u32 s71, s1, 0
global_load_dword v57, v9, s[70:71]
v_mfma_f32_16x16x32_bf16 v[168:171], a[0:3], v[104:107], 0
ds_read_b64_tr_b16 v[98:99], v10 offset:52224
v_mul_f32 v144, v59, v144
v_mfma_f32_16x16x32_bf16 v[184:187], a[4:7], v[104:107], 0
ds_read_b64_tr_b16 v[100:101], v11 offset:35840
v_mul_f32 v145, v59, v145
v_mfma_f32_16x16x32_bf16 v[172:175], a[0:3], v[108:111], 0
ds_read_b64_tr_b16 v[102:103], v11 offset:52224
v_mul_f32 v146, v59, v146
v_mfma_f32_16x16x32_bf16 v[188:191], a[4:7], v[108:111], 0
ds_read_b64_tr_b16 v[104:105], v12 offset:35840
v_mul_f32 v147, v59, v147
v_mfma_f32_16x16x32_bf16 v[160:163], a[8:11], v[112:115], v[160:163]
ds_read_b64_tr_b16 v[106:107], v12 offset:52224
v_mul_f32 v148, v59, v148
v_mfma_f32_16x16x32_bf16 v[176:179], a[12:15], v[112:115], v[176:179]
ds_read_b64_tr_b16 v[108:109], v13 offset:35840
v_mul_f32 v149, v59, v149
v_mfma_f32_16x16x32_bf16 v[164:167], a[8:11], v[116:119], v[164:167]
ds_read_b64_tr_b16 v[110:111], v13 offset:52224
v_mul_f32 v150, v59, v150
v_mfma_f32_16x16x32_bf16 v[180:183], a[12:15], v[116:119], v[180:183]
ds_read_b64_tr_b16 v[112:113], v10 offset:36864
v_mul_f32 v151, v59, v151
v_mfma_f32_16x16x32_bf16 v[168:171], a[8:11], v[120:123], v[168:171]
ds_read_b64_tr_b16 v[114:115], v10 offset:53248
v_cvt_pk_bf16_f32 v200, v144, v145
v_mfma_f32_16x16x32_bf16 v[184:187], a[12:15], v[120:123], v[184:187]
ds_read_b64_tr_b16 v[116:117], v11 offset:36864
v_cvt_pk_bf16_f32 v201, v146, v147
v_mfma_f32_16x16x32_bf16 v[172:175], a[8:11], v[124:127], v[172:175]
ds_read_b64_tr_b16 v[118:119], v11 offset:53248
v_cvt_pk_bf16_f32 v202, v148, v149
v_mfma_f32_16x16x32_bf16 v[188:191], a[12:15], v[124:127], v[188:191]
ds_read_b64_tr_b16 v[120:121], v12 offset:36864
s_waitcnt lgkmcnt(6)
v_mfma_f32_16x16x32_bf16 v[160:163], a[16:19], v[80:83], v[160:163]
ds_read_b64_tr_b16 v[122:123], v12 offset:53248
v_cvt_pk_bf16_f32 v203, v150, v151
v_mfma_f32_16x16x32_bf16 v[176:179], a[20:23], v[80:83], v[176:179]
ds_read_b64_tr_b16 v[124:125], v13 offset:36864
v_mul_f32 v152, v59, v152
v_mfma_f32_16x16x32_bf16 v[164:167], a[16:19], v[84:87], v[164:167]
ds_read_b64_tr_b16 v[126:127], v13 offset:53248
v_mul_f32 v153, v59, v153
v_mfma_f32_16x16x32_bf16 v[180:183], a[20:23], v[84:87], v[180:183]
ds_read_b64_tr_b16 v[80:81], v10 offset:37888
v_mul_f32 v154, v59, v154
v_mfma_f32_16x16x32_bf16 v[168:171], a[16:19], v[88:91], v[168:171]
s_waitcnt vmcnt(5)
ds_read_b64_tr_b16 v[82:83], v10 offset:54272
v_mfma_f32_16x16x32_bf16 v[184:187], a[20:23], v[88:91], v[184:187]
ds_read_b64_tr_b16 v[84:85], v11 offset:37888
v_mul_f32 v155, v59, v155
v_mfma_f32_16x16x32_bf16 v[172:175], a[16:19], v[92:95], v[172:175]
ds_read_b64_tr_b16 v[86:87], v11 offset:54272
v_mul_f32 v156, v59, v156
v_mfma_f32_16x16x32_bf16 v[188:191], a[20:23], v[92:95], v[188:191]
ds_read_b64_tr_b16 v[88:89], v12 offset:37888
v_mul_f32 v157, v59, v157
v_mfma_f32_16x16x32_bf16 v[160:163], a[24:27], v[96:99], v[160:163]
ds_read_b64_tr_b16 v[90:91], v12 offset:54272
s_add_u32 m0, s76, 98304
v_mfma_f32_16x16x32_bf16 v[176:179], a[28:31], v[96:99], v[176:179]
ds_read_b64_tr_b16 v[92:93], v13 offset:37888
s_add_u32 s77, s82, 0x301000
v_mfma_f32_16x16x32_bf16 v[164:167], a[24:27], v[100:103], v[164:167]
buffer_load_dwordx4 v22, s[32:35], s77 offen offset:0 lds
v_mfma_f32_16x16x32_bf16 v[180:183], a[28:31], v[100:103], v[180:183]
ds_read_b64_tr_b16 v[94:95], v13 offset:54272
v_mul_f32 v158, v59, v158
v_mfma_f32_16x16x32_bf16 v[168:171], a[24:27], v[104:107], v[168:171]
ds_read_b64_tr_b16 v[96:97], v10 offset:38912
v_mul_f32 v159, v59, v159
v_mfma_f32_16x16x32_bf16 v[184:187], a[28:31], v[104:107], v[184:187]
ds_read_b64_tr_b16 v[98:99], v10 offset:55296
s_waitcnt lgkmcnt(5)
v_mfma_f32_16x16x32_bf16 v[172:175], a[24:27], v[108:111], v[172:175]
buffer_load_dwordx4 v23, s[32:35], s77 offen offset:1024 lds
v_mfma_f32_16x16x32_bf16 v[188:191], a[28:31], v[108:111], v[188:191]
ds_read_b64_tr_b16 v[100:101], v11 offset:38912
ds_read_b64_tr_b16 v[102:103], v11 offset:55296
v_mfma_f32_16x16x32_bf16 v[160:163], a[32:35], v[112:115], v[160:163]
ds_read_b64_tr_b16 v[104:105], v12 offset:38912
v_cvt_pk_bf16_f32 v204, v152, v153
v_mfma_f32_16x16x32_bf16 v[176:179], a[36:39], v[112:115], v[176:179]
ds_read_b64_tr_b16 v[106:107], v12 offset:55296
v_cvt_pk_bf16_f32 v205, v154, v155
v_mfma_f32_16x16x32_bf16 v[164:167], a[32:35], v[116:119], v[164:167]
buffer_load_dwordx4 v24, s[32:35], s77 offen offset:2048 lds
v_mfma_f32_16x16x32_bf16 v[180:183], a[36:39], v[116:119], v[180:183]
ds_read_b64_tr_b16 v[108:109], v13 offset:38912
ds_read_b64_tr_b16 v[110:111], v13 offset:55296
v_mfma_f32_16x16x32_bf16 v[168:171], a[32:35], v[120:123], v[168:171]
ds_read_b64_tr_b16 v[112:113], v10 offset:39936
v_cvt_pk_bf16_f32 v206, v156, v157
v_mfma_f32_16x16x32_bf16 v[184:187], a[36:39], v[120:123], v[184:187]
ds_read_b64_tr_b16 v[114:115], v10 offset:56320
v_cvt_pk_bf16_f32 v207, v158, v159
v_mfma_f32_16x16x32_bf16 v[172:175], a[32:35], v[124:127], v[172:175]
buffer_load_dwordx4 v25, s[32:35], s77 offen offset:3072 lds
v_mfma_f32_16x16x32_bf16 v[188:191], a[36:39], v[124:127], v[188:191]
ds_read_b64_tr_b16 v[116:117], v11 offset:39936
ds_read_b64_tr_b16 v[118:119], v11 offset:56320
v_mfma_f32_16x16x32_bf16 v[160:163], a[40:43], v[80:83], v[160:163]
buffer_store_dwordx4 v[200:203], v54, s[60:63], 0 offen offset:0 sc1
v_mfma_f32_16x16x32_bf16 v[176:179], a[44:47], v[80:83], v[176:179]
ds_read_b64_tr_b16 v[120:121], v12 offset:39936
ds_read_b64_tr_b16 v[122:123], v12 offset:56320
v_mfma_f32_16x16x32_bf16 v[164:167], a[40:43], v[84:87], v[164:167]
ds_write_b128 v53, v[200:203] offset:0
v_mfma_f32_16x16x32_bf16 v[180:183], a[44:47], v[84:87], v[180:183]
ds_read_b64_tr_b16 v[124:125], v13 offset:39936
s_waitcnt lgkmcnt(6)
v_mfma_f32_16x16x32_bf16 v[168:171], a[40:43], v[88:91], v[168:171]
buffer_store_dwordx4 v[204:207], v54, s[60:63], 0 offen offset:1024 sc1
v_mfma_f32_16x16x32_bf16 v[184:187], a[44:47], v[88:91], v[184:187]
ds_read_b64_tr_b16 v[126:127], v13 offset:56320
s_add_u32 m0, s76, 102400
v_mfma_f32_16x16x32_bf16 v[172:175], a[40:43], v[92:95], v[172:175]
s_add_u32 s77, s82, 0x3c1000
v_sub_u32 v3, v2, v3
v_mfma_f32_16x16x32_bf16 v[188:191], a[44:47], v[92:95], v[188:191]
buffer_load_dwordx4 v22, s[32:35], s77 offen offset:0 lds
v_mfma_f32_16x16x32_bf16 v[160:163], a[48:51], v[96:99], v[160:163]
s_mov_b32 s78, 0x80000001
v_sub_u32 v4, -2, v3
v_mfma_f32_16x16x32_bf16 v[176:179], a[52:55], v[96:99], v[176:179]
v_and_b32 v4, s78, v4
v_cmp_eq_u32 s[4:5], 0, v4
v_mfma_f32_16x16x32_bf16 v[164:167], a[48:51], v[100:103], v[164:167]
s_waitcnt vmcnt(8) lgkmcnt(0)
s_barrier
buffer_atomic_add v52, v70, s[60:63], 0 offen sc1
v_mfma_f32_16x16x32_bf16 v[180:183], a[52:55], v[100:103], v[180:183]
ds_read_b64_tr_b16 v[80:81], v14 offset:0
ds_read_b64_tr_b16 v[82:83], v14 offset:16384
v_mfma_f32_16x16x32_bf16 v[168:171], a[48:51], v[104:107], v[168:171]
ds_read_b64_tr_b16 v[84:85], v15 offset:0
ds_read_b64_tr_b16 v[86:87], v15 offset:16384
v_mfma_f32_16x16x32_bf16 v[184:187], a[52:55], v[104:107], v[184:187]
ds_read_b64_tr_b16 v[88:89], v16 offset:0
ds_read_b64_tr_b16 v[90:91], v16 offset:16384
v_mfma_f32_16x16x32_bf16 v[172:175], a[48:51], v[108:111], v[172:175]
ds_read_b64_tr_b16 v[92:93], v17 offset:0
v_subrev_u32 v4, 0, v3
v_mfma_f32_16x16x32_bf16 v[188:191], a[52:55], v[108:111], v[188:191]
ds_read_b64_tr_b16 v[94:95], v17 offset:16384
ds_read_b64_tr_b16 v[96:97], v14 offset:1024
v_mfma_f32_16x16x32_bf16 v[160:163], a[56:59], v[112:115], v[160:163]
buffer_load_dwordx4 v23, s[32:35], s77 offen offset:1024 lds
v_mfma_f32_16x16x32_bf16 v[176:179], a[60:63], v[112:115], v[176:179]
ds_read_b64_tr_b16 v[98:99], v14 offset:17408
ds_read_b64_tr_b16 v[100:101], v15 offset:1024
v_mfma_f32_16x16x32_bf16 v[164:167], a[56:59], v[116:119], v[164:167]
ds_write_b128 v53, v[204:207] offset:1024
v_mfma_f32_16x16x32_bf16 v[180:183], a[60:63], v[116:119], v[180:183]
ds_read_b64_tr_b16 v[102:103], v15 offset:17408
ds_read_b64_tr_b16 v[104:105], v16 offset:1024
v_mfma_f32_16x16x32_bf16 v[168:171], a[56:59], v[120:123], v[168:171]
buffer_load_dwordx4 v24, s[32:35], s77 offen offset:2048 lds
v_mfma_f32_16x16x32_bf16 v[184:187], a[60:63], v[120:123], v[184:187]
ds_read_b64_tr_b16 v[106:107], v16 offset:17408
ds_read_b64_tr_b16 v[108:109], v17 offset:1024
v_mfma_f32_16x16x32_bf16 v[172:175], a[56:59], v[124:127], v[172:175]
ds_read_b64_tr_b16 v[110:111], v17 offset:17408
s_mul_i32 s3, s101, 7168
v_mfma_f32_16x16x32_bf16 v[188:191], a[60:63], v[124:127], v[188:191]
ds_read_b64_tr_b16 v[112:113], v14 offset:2048
s_waitcnt lgkmcnt(7)
v_mfma_f32_16x16x32_bf16 v[160:163], a[64:67], v[80:83], v[160:163]
buffer_load_dwordx4 v25, s[32:35], s77 offen offset:3072 lds
v_mfma_f32_16x16x32_bf16 v[176:179], a[68:71], v[80:83], v[176:179]
ds_read_b64_tr_b16 v[114:115], v14 offset:18432
ds_read_b64_tr_b16 v[116:117], v15 offset:2048
v_mfma_f32_16x16x32_bf16 v[164:167], a[64:67], v[84:87], v[164:167]
ds_read_b64_tr_b16 v[118:119], v15 offset:18432
s_add_u32 m0, s76, 0
v_mfma_f32_16x16x32_bf16 v[180:183], a[68:71], v[84:87], v[180:183]
ds_read_b64_tr_b16 v[120:121], v16 offset:2048
s_add_u32 s77, s82, 0x481000
v_mfma_f32_16x16x32_bf16 v[168:171], a[64:67], v[88:91], v[168:171]
buffer_load_dwordx4 v22, s[32:35], s77 offen offset:0 lds
v_mfma_f32_16x16x32_bf16 v[184:187], a[68:71], v[88:91], v[184:187]
ds_read_b64_tr_b16 v[122:123], v16 offset:18432
ds_read_b64_tr_b16 v[124:125], v17 offset:2048
v_mfma_f32_16x16x32_bf16 v[172:175], a[64:67], v[92:95], v[172:175]
ds_read_b64_tr_b16 v[126:127], v17 offset:18432
s_add_u32 s3, s3, 0x0
v_mfma_f32_16x16x32_bf16 v[188:191], a[68:71], v[92:95], v[188:191]
ds_read_b64_tr_b16 v[80:81], v14 offset:3072
ds_read_b64_tr_b16 v[82:83], v14 offset:19456
v_mfma_f32_16x16x32_bf16 v[160:163], a[72:75], v[96:99], v[160:163]
buffer_load_dwordx4 v23, s[32:35], s77 offen offset:1024 lds
v_mfma_f32_16x16x32_bf16 v[176:179], a[76:79], v[96:99], v[176:179]
ds_read_b64_tr_b16 v[84:85], v15 offset:3072
s_waitcnt lgkmcnt(6)
v_mfma_f32_16x16x32_bf16 v[164:167], a[72:75], v[100:103], v[164:167]
ds_read_b64_tr_b16 v[86:87], v15 offset:19456
ds_read_b64_tr_b16 v[88:89], v16 offset:3072
v_mfma_f32_16x16x32_bf16 v[180:183], a[76:79], v[100:103], v[180:183]
ds_read_b64_tr_b16 v[90:91], v16 offset:19456
v_mul_f32 v128, v58, v128
v_mfma_f32_16x16x32_bf16 v[168:171], a[72:75], v[104:107], v[168:171]
buffer_load_dwordx4 v24, s[32:35], s77 offen offset:2048 lds
v_mfma_f32_16x16x32_bf16 v[184:187], a[76:79], v[104:107], v[184:187]
ds_read_b64_tr_b16 v[92:93], v17 offset:3072
ds_read_b64_tr_b16 v[94:95], v17 offset:19456
v_mfma_f32_16x16x32_bf16 v[172:175], a[72:75], v[108:111], v[172:175]
ds_read_b64_tr_b16 v[96:97], v14 offset:4096
v_mul_f32 v129, v58, v129
v_mfma_f32_16x16x32_bf16 v[188:191], a[76:79], v[108:111], v[188:191]
ds_read_b64_tr_b16 v[98:99], v14 offset:20480
ds_read_b64_tr_b16 v[100:101], v15 offset:4096
v_mfma_f32_16x16x32_bf16 v[160:163], a[80:83], v[112:115], v[160:163]
buffer_load_dwordx4 v25, s[32:35], s77 offen offset:3072 lds
v_mfma_f32_16x16x32_bf16 v[176:179], a[84:87], v[112:115], v[176:179]
ds_read_b64_tr_b16 v[102:103], v15 offset:20480
ds_read_b64_tr_b16 v[104:105], v16 offset:4096
v_mfma_f32_16x16x32_bf16 v[164:167], a[80:83], v[116:119], v[164:167]
ds_read_b64_tr_b16 v[106:107], v16 offset:20480
s_add_u32 m0, s76, 4096
v_mfma_f32_16x16x32_bf16 v[180:183], a[84:87], v[116:119], v[180:183]
ds_read_b64_tr_b16 v[108:109], v17 offset:4096
s_waitcnt lgkmcnt(7)
v_mfma_f32_16x16x32_bf16 v[168:171], a[80:83], v[120:123], v[168:171]
ds_read_b64_tr_b16 v[110:111], v17 offset:20480
s_add_u32 s77, s82, 0x541000
v_mfma_f32_16x16x32_bf16 v[184:187], a[84:87], v[120:123], v[184:187]
buffer_load_dwordx4 v22, s[32:35], s77 offen offset:0 lds
v_mfma_f32_16x16x32_bf16 v[172:175], a[80:83], v[124:127], v[172:175]
ds_read_b64_tr_b16 v[112:113], v14 offset:5120
ds_read_b64_tr_b16 v[114:115], v14 offset:21504
v_mfma_f32_16x16x32_bf16 v[188:191], a[84:87], v[124:127], v[188:191]
ds_read_b64_tr_b16 v[116:117], v15 offset:5120
v_mul_f32 v130, v58, v130
v_mfma_f32_16x16x32_bf16 v[160:163], a[88:91], v[80:83], v[160:163]
ds_read_b64_tr_b16 v[118:119], v15 offset:21504
ds_read_b64_tr_b16 v[120:121], v16 offset:5120
v_mfma_f32_16x16x32_bf16 v[176:179], a[92:95], v[80:83], v[176:179]
buffer_load_dwordx4 v23, s[32:35], s77 offen offset:1024 lds
v_mfma_f32_16x16x32_bf16 v[164:167], a[88:91], v[84:87], v[164:167]
ds_read_b64_tr_b16 v[122:123], v16 offset:21504
ds_read_b64_tr_b16 v[124:125], v17 offset:5120
v_mfma_f32_16x16x32_bf16 v[180:183], a[92:95], v[84:87], v[180:183]
ds_read_b64_tr_b16 v[126:127], v17 offset:21504
v_mul_f32 v131, v58, v131
v_mfma_f32_16x16x32_bf16 v[168:171], a[88:91], v[88:91], v[168:171]
ds_read_b64_tr_b16 v[80:81], v14 offset:6144
v_mul_f32 v132, v58, v132
v_mfma_f32_16x16x32_bf16 v[184:187], a[92:95], v[88:91], v[184:187]
buffer_load_dwordx4 v24, s[32:35], s77 offen offset:2048 lds
v_mfma_f32_16x16x32_bf16 v[172:175], a[88:91], v[92:95], v[172:175]
ds_read_b64_tr_b16 v[82:83], v14 offset:22528
ds_read_b64_tr_b16 v[84:85], v15 offset:6144
v_mfma_f32_16x16x32_bf16 v[188:191], a[92:95], v[92:95], v[188:191]
ds_read_b64_tr_b16 v[86:87], v15 offset:22528
s_waitcnt lgkmcnt(7)
v_mfma_f32_16x16x32_bf16 v[160:163], a[96:99], v[96:99], v[160:163]
ds_read_b64_tr_b16 v[88:89], v16 offset:6144
v_mul_f32 v133, v58, v133
v_mfma_f32_16x16x32_bf16 v[176:179], a[100:103], v[96:99], v[176:179]
buffer_load_dwordx4 v25, s[32:35], s77 offen offset:3072 lds
v_mfma_f32_16x16x32_bf16 v[164:167], a[96:99], v[100:103], v[164:167]
ds_read_b64_tr_b16 v[90:91], v16 offset:22528
ds_read_b64_tr_b16 v[92:93], v17 offset:6144
v_mfma_f32_16x16x32_bf16 v[180:183], a[100:103], v[100:103], v[180:183]
ds_read_b64_tr_b16 v[94:95], v17 offset:22528
s_add_u32 m0, s76, 32768
v_mfma_f32_16x16x32_bf16 v[168:171], a[96:99], v[104:107], v[168:171]
ds_read_b64_tr_b16 v[96:97], v14 offset:7168
s_add_u32 s77, s82, 0x0
v_mfma_f32_16x16x32_bf16 v[184:187], a[100:103], v[104:107], v[184:187]
buffer_load_dwordx4 v22, s[32:35], s77 offen offset:0 lds
v_mfma_f32_16x16x32_bf16 v[172:175], a[96:99], v[108:111], v[172:175]
ds_read_b64_tr_b16 v[98:99], v14 offset:23552
ds_read_b64_tr_b16 v[100:101], v15 offset:7168
v_mfma_f32_16x16x32_bf16 v[188:191], a[100:103], v[108:111], v[188:191]
ds_read_b64_tr_b16 v[102:103], v15 offset:23552
v_mul_f32 v134, v58, v134
v_mfma_f32_16x16x32_bf16 v[160:163], a[104:107], v[112:115], v[160:163]
ds_read_b64_tr_b16 v[104:105], v16 offset:7168
v_mul_f32 v135, v58, v135
v_mfma_f32_16x16x32_bf16 v[176:179], a[108:111], v[112:115], v[176:179]
buffer_load_dwordx4 v23, s[32:35], s77 offen offset:1024 lds
v_mfma_f32_16x16x32_bf16 v[164:167], a[104:107], v[116:119], v[164:167]
ds_read_b64_tr_b16 v[106:107], v16 offset:23552
ds_read_b64_tr_b16 v[108:109], v17 offset:7168
v_mfma_f32_16x16x32_bf16 v[180:183], a[108:111], v[116:119], v[180:183]
ds_read_b64_tr_b16 v[110:111], v17 offset:23552
s_waitcnt lgkmcnt(7)
v_mfma_f32_16x16x32_bf16 v[168:171], a[104:107], v[120:123], v[168:171]
v_cvt_pk_bf16_f32 v192, v128, v129
v_cvt_pk_bf16_f32 v193, v130, v131
v_mfma_f32_16x16x32_bf16 v[184:187], a[108:111], v[120:123], v[184:187]
buffer_load_dwordx4 v24, s[32:35], s77 offen offset:2048 lds
v_mfma_f32_16x16x32_bf16 v[172:175], a[104:107], v[124:127], v[172:175]
v_cvt_pk_bf16_f32 v194, v132, v133
v_cvt_pk_bf16_f32 v195, v134, v135
v_mfma_f32_16x16x32_bf16 v[188:191], a[108:111], v[124:127], v[188:191]
v_mul_f32 v136, v58, v136
v_mul_f32 v137, v58, v137
v_mfma_f32_16x16x32_bf16 v[160:163], a[112:115], v[80:83], v[160:163]
s_waitcnt vmcnt(11) lgkmcnt(0)
s_barrier
s_atomic_add s85, s[60:61], s97
v_mfma_f32_16x16x32_bf16 v[176:179], a[116:119], v[80:83], v[176:179]
ds_read_b64_tr_b16 v[112:113], v14 offset:32768
ds_read_b64_tr_b16 v[114:115], v14 offset:49152
v_mfma_f32_16x16x32_bf16 v[164:167], a[112:115], v[84:87], v[164:167]
ds_read_b64_tr_b16 v[116:117], v15 offset:32768
v_mul_f32 v138, v58, v138
v_mfma_f32_16x16x32_bf16 v[180:183], a[116:119], v[84:87], v[180:183]
ds_read_b64_tr_b16 v[118:119], v15 offset:49152
ds_read_b64_tr_b16 v[120:121], v16 offset:32768
v_mfma_f32_16x16x32_bf16 v[168:171], a[112:115], v[88:91], v[168:171]
buffer_load_dwordx4 v25, s[32:35], s77 offen offset:3072 lds
v_mfma_f32_16x16x32_bf16 v[184:187], a[116:119], v[88:91], v[184:187]
ds_read_b64_tr_b16 v[122:123], v16 offset:49152
ds_read_b64_tr_b16 v[124:125], v17 offset:32768
v_mfma_f32_16x16x32_bf16 v[172:175], a[112:115], v[92:95], v[172:175]
ds_read_b64_tr_b16 v[126:127], v17 offset:49152
s_add_u32 m0, s76, 36864
v_mfma_f32_16x16x32_bf16 v[188:191], a[116:119], v[92:95], v[188:191]
ds_read_b64_tr_b16 v[80:81], v14 offset:33792
s_add_u32 s77, s82, 0xc0000
v_mfma_f32_16x16x32_bf16 v[160:163], a[120:123], v[96:99], v[160:163]
buffer_load_dwordx4 v22, s[32:35], s77 offen offset:0 lds
v_mfma_f32_16x16x32_bf16 v[176:179], a[124:127], v[96:99], v[176:179]
ds_read_b64_tr_b16 v[82:83], v14 offset:50176
ds_read_b64_tr_b16 v[84:85], v15 offset:33792
v_mfma_f32_16x16x32_bf16 v[164:167], a[120:123], v[100:103], v[164:167]
ds_read_b64_tr_b16 v[86:87], v15 offset:50176
v_mul_f32 v139, v58, v139
v_mfma_f32_16x16x32_bf16 v[180:183], a[124:127], v[100:103], v[180:183]
ds_read_b64_tr_b16 v[88:89], v16 offset:33792
ds_read_b64_tr_b16 v[90:91], v16 offset:50176
v_mfma_f32_16x16x32_bf16 v[168:171], a[120:123], v[104:107], v[168:171]
buffer_load_dwordx4 v23, s[32:35], s77 offen offset:1024 lds
v_mfma_f32_16x16x32_bf16 v[184:187], a[124:127], v[104:107], v[184:187]
ds_read_b64_tr_b16 v[92:93], v17 offset:33792
ds_read_b64_tr_b16 v[94:95], v17 offset:50176
v_mfma_f32_16x16x32_bf16 v[172:175], a[120:123], v[108:111], v[172:175]
ds_read_b64_tr_b16 v[96:97], v14 offset:34816
v_mul_f32 v140, v58, v140
v_mfma_f32_16x16x32_bf16 v[188:191], a[124:127], v[108:111], v[188:191]
ds_read_b64_tr_b16 v[98:99], v14 offset:51200
s_waitcnt lgkmcnt(7)
v_mfma_f32_16x16x32_bf16 v[160:163], a[128:131], v[112:115], v[160:163]
buffer_load_dwordx4 v24, s[32:35], s77 offen offset:2048 lds
v_mfma_f32_16x16x32_bf16 v[176:179], a[132:135], v[112:115], v[176:179]
ds_read_b64_tr_b16 v[100:101], v15 offset:34816
ds_read_b64_tr_b16 v[102:103], v15 offset:51200
v_mfma_f32_16x16x32_bf16 v[164:167], a[128:131], v[116:119], v[164:167]
ds_read_b64_tr_b16 v[104:105], v16 offset:34816
v_mul_f32 v141, v58, v141
v_mfma_f32_16x16x32_bf16 v[180:183], a[132:135], v[116:119], v[180:183]
ds_read_b64_tr_b16 v[106:107], v16 offset:51200
ds_read_b64_tr_b16 v[108:109], v17 offset:34816
v_mfma_f32_16x16x32_bf16 v[168:171], a[128:131], v[120:123], v[168:171]
buffer_load_dwordx4 v25, s[32:35], s77 offen offset:3072 lds
v_mfma_f32_16x16x32_bf16 v[184:187], a[132:135], v[120:123], v[184:187]
ds_read_b64_tr_b16 v[110:111], v17 offset:51200
ds_read_b64_tr_b16 v[112:113], v14 offset:35840
v_mfma_f32_16x16x32_bf16 v[172:175], a[128:131], v[124:127], v[172:175]
ds_read_b64_tr_b16 v[114:115], v14 offset:52224
s_add_u32 m0, s76, 65536
v_mfma_f32_16x16x32_bf16 v[188:191], a[132:135], v[124:127], v[188:191]
ds_read_b64_tr_b16 v[116:117], v15 offset:35840
s_add_u32 s77, s82, 0x180000
v_mfma_f32_16x16x32_bf16 v[160:163], a[136:139], v[80:83], v[160:163]
buffer_load_dwordx4 v22, s[32:35], s77 offen offset:0 lds
v_mfma_f32_16x16x32_bf16 v[176:179], a[140:143], v[80:83], v[176:179]
ds_read_b64_tr_b16 v[118:119], v15 offset:52224
s_waitcnt lgkmcnt(5)
v_mfma_f32_16x16x32_bf16 v[164:167], a[136:139], v[84:87], v[164:167]
ds_read_b64_tr_b16 v[120:121], v16 offset:35840
ds_read_b64_tr_b16 v[122:123], v16 offset:52224
v_mfma_f32_16x16x32_bf16 v[180:183], a[140:143], v[84:87], v[180:183]
ds_read_b64_tr_b16 v[124:125], v17 offset:35840
v_mul_f32 v142, v58, v142
v_mfma_f32_16x16x32_bf16 v[168:171], a[136:139], v[88:91], v[168:171]
buffer_load_dwordx4 v23, s[32:35], s77 offen offset:1024 lds
v_mfma_f32_16x16x32_bf16 v[184:187], a[140:143], v[88:91], v[184:187]
ds_read_b64_tr_b16 v[126:127], v17 offset:52224
ds_read_b64_tr_b16 v[80:81], v14 offset:36864
v_mfma_f32_16x16x32_bf16 v[172:175], a[136:139], v[92:95], v[172:175]
ds_read_b64_tr_b16 v[82:83], v14 offset:53248
v_mul_f32 v143, v58, v143
v_mfma_f32_16x16x32_bf16 v[188:191], a[140:143], v[92:95], v[188:191]
ds_read_b64_tr_b16 v[84:85], v15 offset:36864
ds_read_b64_tr_b16 v[86:87], v15 offset:53248
v_mfma_f32_16x16x32_bf16 v[160:163], a[144:147], v[96:99], v[160:163]
buffer_load_dwordx4 v24, s[32:35], s77 offen offset:2048 lds
v_mfma_f32_16x16x32_bf16 v[176:179], a[148:151], v[96:99], v[176:179]
ds_read_b64_tr_b16 v[88:89], v16 offset:36864
ds_read_b64_tr_b16 v[90:91], v16 offset:53248
v_mfma_f32_16x16x32_bf16 v[164:167], a[144:147], v[100:103], v[164:167]
ds_read_b64_tr_b16 v[92:93], v17 offset:36864
v_cvt_pk_bf16_f32 v196, v136, v137
v_mfma_f32_16x16x32_bf16 v[180:183], a[148:151], v[100:103], v[180:183]
ds_read_b64_tr_b16 v[94:95], v17 offset:53248
v_cvt_pk_bf16_f32 v197, v138, v139
v_mfma_f32_16x16x32_bf16 v[168:171], a[144:147], v[104:107], v[168:171]
buffer_load_dwordx4 v25, s[32:35], s77 offen offset:3072 lds
v_mfma_f32_16x16x32_bf16 v[184:187], a[148:151], v[104:107], v[184:187]
ds_read_b64_tr_b16 v[96:97], v14 offset:37888
s_waitcnt lgkmcnt(5)
v_mfma_f32_16x16x32_bf16 v[172:175], a[144:147], v[108:111], v[172:175]
ds_read_b64_tr_b16 v[98:99], v14 offset:54272
s_add_u32 m0, s76, 69632
v_mfma_f32_16x16x32_bf16 v[188:191], a[148:151], v[108:111], v[188:191]
ds_read_b64_tr_b16 v[100:101], v15 offset:37888
s_add_u32 s77, s82, 0x240000
v_mfma_f32_16x16x32_bf16 v[160:163], a[152:155], v[112:115], v[160:163]
buffer_load_dwordx4 v22, s[32:35], s77 offen offset:0 lds
v_mfma_f32_16x16x32_bf16 v[176:179], a[156:159], v[112:115], v[176:179]
ds_read_b64_tr_b16 v[102:103], v15 offset:54272
ds_read_b64_tr_b16 v[104:105], v16 offset:37888
v_mfma_f32_16x16x32_bf16 v[164:167], a[152:155], v[116:119], v[164:167]
ds_read_b64_tr_b16 v[106:107], v16 offset:54272
v_cvt_pk_bf16_f32 v198, v140, v141
v_mfma_f32_16x16x32_bf16 v[180:183], a[156:159], v[116:119], v[180:183]
ds_read_b64_tr_b16 v[108:109], v17 offset:37888
ds_read_b64_tr_b16 v[110:111], v17 offset:54272
v_mfma_f32_16x16x32_bf16 v[168:171], a[152:155], v[120:123], v[168:171]
buffer_load_dwordx4 v23, s[32:35], s77 offen offset:1024 lds
v_mfma_f32_16x16x32_bf16 v[184:187], a[156:159], v[120:123], v[184:187]
ds_read_b64_tr_b16 v[112:113], v14 offset:38912
ds_read_b64_tr_b16 v[114:115], v14 offset:55296
v_mfma_f32_16x16x32_bf16 v[172:175], a[152:155], v[124:127], v[172:175]
ds_read_b64_tr_b16 v[116:117], v15 offset:38912
v_cvt_pk_bf16_f32 v199, v142, v143
v_mfma_f32_16x16x32_bf16 v[188:191], a[156:159], v[124:127], v[188:191]
ds_read_b64_tr_b16 v[118:119], v15 offset:55296
v_and_b32 v4, s78, v4
v_mfma_f32_16x16x32_bf16 v[160:163], a[160:163], v[80:83], v[160:163]
buffer_load_dwordx4 v24, s[32:35], s77 offen offset:2048 lds
v_mfma_f32_16x16x32_bf16 v[176:179], a[164:167], v[80:83], v[176:179]
ds_read_b64_tr_b16 v[120:121], v16 offset:38912
ds_read_b64_tr_b16 v[122:123], v16 offset:55296
v_mfma_f32_16x16x32_bf16 v[164:167], a[160:163], v[84:87], v[164:167]
ds_read_b64_tr_b16 v[124:125], v17 offset:38912
v_cmp_eq_u32 s[12:13], 0, v4
v_mfma_f32_16x16x32_bf16 v[180:183], a[164:167], v[84:87], v[180:183]
ds_read_b64_tr_b16 v[126:127], v17 offset:55296
s_waitcnt lgkmcnt(6)
v_mfma_f32_16x16x32_bf16 v[168:171], a[160:163], v[88:91], v[168:171]
buffer_load_dwordx4 v25, s[32:35], s77 offen offset:3072 lds
v_mfma_f32_16x16x32_bf16 v[184:187], a[164:167], v[88:91], v[184:187]
ds_read_b64_tr_b16 v[80:81], v14 offset:39936
ds_read_b64_tr_b16 v[82:83], v14 offset:56320
v_mfma_f32_16x16x32_bf16 v[172:175], a[160:163], v[92:95], v[172:175]
buffer_load_dword v57, v8, s[40:43], s3 offen
v_mfma_f32_16x16x32_bf16 v[188:191], a[164:167], v[92:95], v[188:191]
ds_read_b64_tr_b16 v[84:85], v15 offset:39936
ds_read_b64_tr_b16 v[86:87], v15 offset:56320
v_mfma_f32_16x16x32_bf16 v[160:163], a[168:171], v[96:99], v[160:163]
ds_read_b64_tr_b16 v[88:89], v16 offset:39936
s_mul_i32 s3, s101, 1024
v_mfma_f32_16x16x32_bf16 v[176:179], a[172:175], v[96:99], v[176:179]
ds_read_b64_tr_b16 v[90:91], v16 offset:56320
s_add_u32 s3, s3, 0x100000
v_mfma_f32_16x16x32_bf16 v[164:167], a[168:171], v[100:103], v[164:167]
buffer_load_dword v57, v50, s[48:51], s3 offen
v_mfma_f32_16x16x32_bf16 v[180:183], a[172:175], v[100:103], v[180:183]
ds_read_b64_tr_b16 v[92:93], v17 offset:39936
ds_read_b64_tr_b16 v[94:95], v17 offset:56320
v_mfma_f32_16x16x32_bf16 v[168:171], a[168:171], v[104:107], v[168:171]
v_sub_u32 v4, -1, v3
v_and_b32 v4, s78, v4
v_mfma_f32_16x16x32_bf16 v[184:187], a[172:175], v[104:107], v[184:187]
v_cmp_eq_u32 s[6:7], 0, v4
v_subrev_u32 v4, 1, v3
v_mfma_f32_16x16x32_bf16 v[172:175], a[168:171], v[108:111], v[172:175]
v_and_b32 v4, s78, v4
v_cmp_eq_u32 s[14:15], 0, v4
v_mfma_f32_16x16x32_bf16 v[188:191], a[172:175], v[108:111], v[188:191]
v_sub_u32 v4, 0, v3
v_and_b32 v4, s78, v4
v_mfma_f32_16x16x32_bf16 v[160:163], a[176:179], v[112:115], v[160:163]
s_waitcnt vmcnt(18) lgkmcnt(0)
s_barrier
v_mfma_f32_16x16x32_bf16 v[176:179], a[180:183], v[112:115], v[176:179]
ds_read_b64_tr_b16 v[96:97], v10 offset:0
ds_read_b64_tr_b16 v[98:99], v10 offset:16384
v_mfma_f32_16x16x32_bf16 v[164:167], a[176:179], v[116:119], v[164:167]
ds_read_b64_tr_b16 v[100:101], v11 offset:0
s_add_u32 m0, s76, 98304
v_mfma_f32_16x16x32_bf16 v[180:183], a[180:183], v[116:119], v[180:183]
ds_read_b64_tr_b16 v[102:103], v11 offset:16384
s_add_u32 s77, s82, 0x300000
v_mfma_f32_16x16x32_bf16 v[168:171], a[176:179], v[120:123], v[168:171]
ds_read_b64_tr_b16 v[104:105], v12 offset:0
ds_read_b64_tr_b16 v[106:107], v12 offset:16384
v_mfma_f32_16x16x32_bf16 v[184:187], a[180:183], v[120:123], v[184:187]
buffer_load_dwordx4 v22, s[32:35], s77 offen offset:0 lds
v_mfma_f32_16x16x32_bf16 v[172:175], a[176:179], v[124:127], v[172:175]
ds_read_b64_tr_b16 v[108:109], v13 offset:0
ds_read_b64_tr_b16 v[110:111], v13 offset:16384
v_mfma_f32_16x16x32_bf16 v[188:191], a[180:183], v[124:127], v[188:191]
ds_read_b64_tr_b16 v[112:113], v10 offset:1024
v_cmp_eq_u32 s[8:9], 0, v4
v_mfma_f32_16x16x32_bf16 v[160:163], a[184:187], v[80:83], v[160:163]
ds_read_b64_tr_b16 v[114:115], v10 offset:17408
ds_read_b64_tr_b16 v[116:117], v11 offset:1024
v_mfma_f32_16x16x32_bf16 v[176:179], a[188:191], v[80:83], v[176:179]
ds_read_b64_tr_b16 v[118:119], v11 offset:17408
v_subrev_u32 v4, 2, v3
v_mfma_f32_16x16x32_bf16 v[164:167], a[184:187], v[84:87], v[164:167]
ds_read_b64_tr_b16 v[120:121], v12 offset:1024
ds_read_b64_tr_b16 v[122:123], v12 offset:17408
v_mfma_f32_16x16x32_bf16 v[180:183], a[188:191], v[84:87], v[180:183]
buffer_load_dwordx4 v23, s[32:35], s77 offen offset:1024 lds
v_mfma_f32_16x16x32_bf16 v[168:171], a[184:187], v[88:91], v[168:171]
ds_read_b64_tr_b16 v[124:125], v13 offset:1024
ds_read_b64_tr_b16 v[126:127], v13 offset:17408
v_mfma_f32_16x16x32_bf16 v[184:187], a[188:191], v[88:91], v[184:187]
ds_read_b64_tr_b16 v[80:81], v10 offset:2048
v_and_b32 v4, s78, v4
v_mfma_f32_16x16x32_bf16 v[172:175], a[184:187], v[92:95], v[172:175]
ds_read_b64_tr_b16 v[82:83], v10 offset:18432
ds_read_b64_tr_b16 v[84:85], v11 offset:2048
v_mfma_f32_16x16x32_bf16 v[188:191], a[188:191], v[92:95], v[188:191]
ds_read_b64_tr_b16 v[86:87], v11 offset:18432
s_waitcnt lgkmcnt(8)
v_mfma_f32_16x16x32_bf16 v[160:163], a[192:195], v[96:99], v[160:163]
ds_read_b64_tr_b16 v[88:89], v12 offset:2048
v_cmp_eq_u32 s[16:17], 0, v4
v_mfma_f32_16x16x32_bf16 v[176:179], a[196:199], v[96:99], v[176:179]
buffer_load_dwordx4 v24, s[32:35], s77 offen offset:2048 lds
v_mfma_f32_16x16x32_bf16 v[164:167], a[192:195], v[100:103], v[164:167]
ds_read_b64_tr_b16 v[90:91], v12 offset:18432
ds_read_b64_tr_b16 v[92:93], v13 offset:2048
v_mfma_f32_16x16x32_bf16 v[180:183], a[196:199], v[100:103], v[180:183]
ds_read_b64_tr_b16 v[94:95], v13 offset:18432
v_sub_u32 v4, 1, v3
v_mfma_f32_16x16x32_bf16 v[168:171], a[192:195], v[104:107], v[168:171]
ds_read_b64_tr_b16 v[96:97], v10 offset:3072
v_and_b32 v4, s78, v4
v_mfma_f32_16x16x32_bf16 v[184:187], a[196:199], v[104:107], v[184:187]
ds_read_b64_tr_b16 v[98:99], v10 offset:19456
v_cmp_eq_u32 s[10:11], 0, v4
v_mfma_f32_16x16x32_bf16 v[172:175], a[192:195], v[108:111], v[172:175]
ds_read_b64_tr_b16 v[100:101], v11 offset:3072
v_subrev_u32 v4, 3, v3
v_mfma_f32_16x16x32_bf16 v[188:191], a[196:199], v[108:111], v[188:191]
buffer_load_dwordx4 v25, s[32:35], s77 offen offset:3072 lds
v_mfma_f32_16x16x32_bf16 v[160:163], a[200:203], v[112:115], v[160:163]
ds_read_b64_tr_b16 v[102:103], v11 offset:19456
ds_read_b64_tr_b16 v[104:105], v12 offset:3072
v_mfma_f32_16x16x32_bf16 v[176:179], a[204:207], v[112:115], v[176:179]
ds_read_b64_tr_b16 v[106:107], v12 offset:19456
v_and_b32 v4, s78, v4
v_mfma_f32_16x16x32_bf16 v[164:167], a[200:203], v[116:119], v[164:167]
ds_read_b64_tr_b16 v[108:109], v13 offset:3072
s_add_u32 m0, s76, 102400
v_mfma_f32_16x16x32_bf16 v[180:183], a[204:207], v[116:119], v[180:183]
ds_read_b64_tr_b16 v[110:111], v13 offset:19456
s_waitcnt lgkmcnt(6)
v_mfma_f32_16x16x32_bf16 v[168:171], a[200:203], v[120:123], v[168:171]
ds_read_b64_tr_b16 v[112:113], v10 offset:4096
s_add_u32 s77, s82, 0x3c0000
v_mfma_f32_16x16x32_bf16 v[184:187], a[204:207], v[120:123], v[184:187]
buffer_load_dwordx4 v22, s[32:35], s77 offen offset:0 lds
v_mfma_f32_16x16x32_bf16 v[172:175], a[200:203], v[124:127], v[172:175]
ds_read_b64_tr_b16 v[114:115], v10 offset:20480
ds_read_b64_tr_b16 v[116:117], v11 offset:4096
v_mfma_f32_16x16x32_bf16 v[188:191], a[204:207], v[124:127], v[188:191]
ds_read_b64_tr_b16 v[118:119], v11 offset:20480
v_cmp_eq_u32 s[18:19], 0, v4
v_mfma_f32_16x16x32_bf16 v[160:163], a[208:211], v[80:83], v[160:163]
s_cmp_eq_u32 s88, 0
s_cselect_b64 s[20:21], 0, s[4:5]
s_cselect_b64 s[22:23], 0, s[6:7]
s_cselect_b64 s[24:25], 0, s[8:9]
s_cselect_b64 s[26:27], 0, s[10:11]
v_mfma_f32_16x16x32_bf16 v[176:179], a[212:215], v[80:83], v[176:179]
ds_read_b64_tr_b16 v[120:121], v12 offset:4096
ds_read_b64_tr_b16 v[122:123], v12 offset:20480
v_mfma_f32_16x16x32_bf16 v[164:167], a[208:211], v[84:87], v[164:167]
ds_read_b64_tr_b16 v[124:125], v13 offset:4096
v_mfma_f32_16x16x32_bf16 v[180:183], a[212:215], v[84:87], v[180:183]
buffer_load_dwordx4 v23, s[32:35], s77 offen offset:1024 lds
v_mfma_f32_16x16x32_bf16 v[168:171], a[208:211], v[88:91], v[168:171]
ds_read_b64_tr_b16 v[126:127], v13 offset:20480
ds_read_b64_tr_b16 v[80:81], v10 offset:5120
v_mfma_f32_16x16x32_bf16 v[184:187], a[212:215], v[88:91], v[184:187]
ds_read_b64_tr_b16 v[82:83], v10 offset:21504
v_mfma_f32_16x16x32_bf16 v[172:175], a[208:211], v[92:95], v[172:175]
ds_read_b64_tr_b16 v[84:85], v11 offset:5120
ds_read_b64_tr_b16 v[86:87], v11 offset:21504
v_mfma_f32_16x16x32_bf16 v[188:191], a[212:215], v[92:95], v[188:191]
ds_read_b64_tr_b16 v[88:89], v12 offset:5120
v_mfma_f32_16x16x32_bf16 v[160:163], a[216:219], v[96:99], v[160:163]
ds_read_b64_tr_b16 v[90:91], v12 offset:21504
ds_read_b64_tr_b16 v[92:93], v13 offset:5120
v_mfma_f32_16x16x32_bf16 v[176:179], a[220:223], v[96:99], v[176:179]
ds_read_b64_tr_b16 v[94:95], v13 offset:21504
s_waitcnt lgkmcnt(9)
v_mfma_f32_16x16x32_bf16 v[164:167], a[216:219], v[100:103], v[164:167]
buffer_load_dwordx4 v24, s[32:35], s77 offen offset:2048 lds
v_mfma_f32_16x16x32_bf16 v[180:183], a[220:223], v[100:103], v[180:183]
ds_read_b64_tr_b16 v[96:97], v10 offset:6144
ds_read_b64_tr_b16 v[98:99], v10 offset:22528
v_mfma_f32_16x16x32_bf16 v[168:171], a[216:219], v[104:107], v[168:171]
ds_read_b64_tr_b16 v[100:101], v11 offset:6144
v_mfma_f32_16x16x32_bf16 v[184:187], a[220:223], v[104:107], v[184:187]
ds_read_b64_tr_b16 v[102:103], v11 offset:22528
v_mfma_f32_16x16x32_bf16 v[172:175], a[216:219], v[108:111], v[172:175]
ds_read_b64_tr_b16 v[104:105], v12 offset:6144
v_mfma_f32_16x16x32_bf16 v[188:191], a[220:223], v[108:111], v[188:191]
ds_read_b64_tr_b16 v[106:107], v12 offset:22528
v_mfma_f32_16x16x32_bf16 v[160:163], a[224:227], v[112:115], v[160:163]
buffer_load_dwordx4 v25, s[32:35], s77 offen offset:3072 lds
v_mfma_f32_16x16x32_bf16 v[176:179], a[228:231], v[112:115], v[176:179]
ds_read_b64_tr_b16 v[108:109], v13 offset:6144
ds_read_b64_tr_b16 v[110:111], v13 offset:22528
v_mfma_f32_16x16x32_bf16 v[164:167], a[224:227], v[116:119], v[164:167]
ds_read_b64_tr_b16 v[112:113], v10 offset:7168
v_mfma_f32_16x16x32_bf16 v[180:183], a[228:231], v[116:119], v[180:183]
ds_read_b64_tr_b16 v[114:115], v10 offset:23552
v_mfma_f32_16x16x32_bf16 v[168:171], a[224:227], v[120:123], v[168:171]
ds_read_b64_tr_b16 v[116:117], v11 offset:7168
v_mfma_f32_16x16x32_bf16 v[184:187], a[228:231], v[120:123], v[184:187]
ds_read_b64_tr_b16 v[118:119], v11 offset:23552
s_waitcnt lgkmcnt(6)
v_mfma_f32_16x16x32_bf16 v[172:175], a[224:227], v[124:127], v[172:175]
ds_read_b64_tr_b16 v[120:121], v12 offset:7168
v_mfma_f32_16x16x32_bf16 v[188:191], a[228:231], v[124:127], v[188:191]
ds_read_b64_tr_b16 v[122:123], v12 offset:23552
v_mfma_f32_16x16x32_bf16 v[160:163], a[232:235], v[80:83], v[160:163]
ds_read_b64_tr_b16 v[124:125], v13 offset:7168
v_mfma_f32_16x16x32_bf16 v[176:179], a[236:239], v[80:83], v[176:179]
ds_read_b64_tr_b16 v[126:127], v13 offset:23552
v_mfma_f32_16x16x32_bf16 v[164:167], a[232:235], v[84:87], v[164:167]
v_mfma_f32_16x16x32_bf16 v[180:183], a[236:239], v[84:87], v[180:183]
v_mfma_f32_16x16x32_bf16 v[168:171], a[232:235], v[88:91], v[168:171]
v_mfma_f32_16x16x32_bf16 v[184:187], a[236:239], v[88:91], v[184:187]
v_mfma_f32_16x16x32_bf16 v[172:175], a[232:235], v[92:95], v[172:175]
s_waitcnt vmcnt(18) lgkmcnt(0)
s_barrier
v_mfma_f32_16x16x32_bf16 v[188:191], a[236:239], v[92:95], v[188:191]
ds_read_b64_tr_b16 v[80:81], v10 offset:32768
ds_read_b64_tr_b16 v[82:83], v10 offset:49152
v_mfma_f32_16x16x32_bf16 v[160:163], a[240:243], v[96:99], v[160:163]
ds_read_b64_tr_b16 v[84:85], v11 offset:32768
v_mfma_f32_16x16x32_bf16 v[176:179], a[244:247], v[96:99], v[176:179]
ds_read_b64_tr_b16 v[86:87], v11 offset:49152
ds_read_b64_tr_b16 v[88:89], v12 offset:32768
v_mfma_f32_16x16x32_bf16 v[164:167], a[240:243], v[100:103], v[164:167]
ds_read_b64_tr_b16 v[90:91], v12 offset:49152
v_mfma_f32_16x16x32_bf16 v[180:183], a[244:247], v[100:103], v[180:183]
ds_read_b64_tr_b16 v[92:93], v13 offset:32768
ds_read_b64_tr_b16 v[94:95], v13 offset:49152
v_mfma_f32_16x16x32_bf16 v[168:171], a[240:243], v[104:107], v[168:171]
ds_read_b64_tr_b16 v[96:97], v10 offset:33792
v_mfma_f32_16x16x32_bf16 v[184:187], a[244:247], v[104:107], v[184:187]
ds_read_b64_tr_b16 v[98:99], v10 offset:50176
ds_read_b64_tr_b16 v[100:101], v11 offset:33792
v_mfma_f32_16x16x32_bf16 v[172:175], a[240:243], v[108:111], v[172:175]
ds_read_b64_tr_b16 v[102:103], v11 offset:50176
v_mfma_f32_16x16x32_bf16 v[188:191], a[244:247], v[108:111], v[188:191]
ds_read_b64_tr_b16 v[104:105], v12 offset:33792
ds_read_b64_tr_b16 v[106:107], v12 offset:50176
v_mfma_f32_16x16x32_bf16 v[160:163], a[248:251], v[112:115], v[160:163]
ds_read_b64_tr_b16 v[108:109], v13 offset:33792
v_mfma_f32_16x16x32_bf16 v[176:179], a[252:255], v[112:115], v[176:179]
ds_read_b64_tr_b16 v[110:111], v13 offset:50176
v_mfma_f32_16x16x32_bf16 v[164:167], a[248:251], v[116:119], v[164:167]
ds_read_b64_tr_b16 v[112:113], v10 offset:34816
v_mfma_f32_16x16x32_bf16 v[180:183], a[252:255], v[116:119], v[180:183]
ds_read_b64_tr_b16 v[114:115], v10 offset:51200
v_mfma_f32_16x16x32_bf16 v[168:171], a[248:251], v[120:123], v[168:171]
ds_read_b64_tr_b16 v[116:117], v11 offset:34816
v_mfma_f32_16x16x32_bf16 v[184:187], a[252:255], v[120:123], v[184:187]
ds_read_b64_tr_b16 v[118:119], v11 offset:51200
v_mfma_f32_16x16x32_bf16 v[172:175], a[248:251], v[124:127], v[172:175]
ds_read_b64_tr_b16 v[120:121], v12 offset:34816
v_mfma_f32_16x16x32_bf16 v[188:191], a[252:255], v[124:127], v[188:191]
ds_read_b64_tr_b16 v[122:123], v12 offset:51200
S_Q:
s_waitcnt lgkmcnt(6)
v_mfma_f32_16x16x32_bf16 v[128:131], v[80:83], a[0:3], 0
ds_read_b64_tr_b16 v[124:125], v13 offset:34816
v_mfma_f32_16x16x32_bf16 v[144:147], v[80:83], a[4:7], 0
ds_read_b64_tr_b16 v[126:127], v13 offset:51200
v_mfma_f32_16x16x32_bf16 v[132:135], v[84:87], a[0:3], 0
ds_read_b64_tr_b16 v[80:81], v10 offset:35840
v_mfma_f32_16x16x32_bf16 v[148:151], v[84:87], a[4:7], 0
s_add_u32 s70, s0, T_attn - K_pc + 0
s_addc_u32 s71, s1, 0
global_load_dword v57, v9, s[70:71]
v_mfma_f32_16x16x32_bf16 v[136:139], v[88:91], a[0:3], 0
ds_read_b64_tr_b16 v[82:83], v10 offset:52224
v_mul_f32 v176, v64, v176
v_mfma_f32_16x16x32_bf16 v[152:155], v[88:91], a[4:7], 0
s_add_u32 s70, s0, T_attn - K_pc + 8192
s_addc_u32 s71, s1, 0
global_load_dword v57, v9, s[70:71]
v_mfma_f32_16x16x32_bf16 v[140:143], v[92:95], a[0:3], 0
ds_read_b64_tr_b16 v[84:85], v11 offset:35840
v_mul_f32 v177, v65, v177
v_mfma_f32_16x16x32_bf16 v[156:159], v[92:95], a[4:7], 0
ds_read_b64_tr_b16 v[86:87], v11 offset:52224
v_mul_f32 v178, v66, v178
v_mfma_f32_16x16x32_bf16 v[128:131], v[96:99], a[8:11], v[128:131]
ds_read_b64_tr_b16 v[88:89], v12 offset:35840
v_mul_f32 v179, v67, v179
v_mfma_f32_16x16x32_bf16 v[144:147], v[96:99], a[12:15], v[144:147]
ds_read_b64_tr_b16 v[90:91], v12 offset:52224
v_cvt_pk_bf16_f32 v228, v176, v177
v_mfma_f32_16x16x32_bf16 v[132:135], v[100:103], a[8:11], v[132:135]
ds_read_b64_tr_b16 v[92:93], v13 offset:35840
v_cvt_pk_bf16_f32 v229, v178, v179
v_mfma_f32_16x16x32_bf16 v[148:151], v[100:103], a[12:15], v[148:151]
ds_read_b64_tr_b16 v[94:95], v13 offset:52224
s_mul_i32 s3, s101, 7168
v_mfma_f32_16x16x32_bf16 v[136:139], v[104:107], a[8:11], v[136:139]
ds_read_b64_tr_b16 v[96:97], v10 offset:36864
s_add_u32 s3, s3, 0x1800
v_mfma_f32_16x16x32_bf16 v[152:155], v[104:107], a[12:15], v[152:155]
buffer_load_dword v57, v50, s[40:43], s3 offen
v_mfma_f32_16x16x32_bf16 v[140:143], v[108:111], a[8:11], v[140:143]
ds_read_b64_tr_b16 v[98:99], v10 offset:53248
ds_read_b64_tr_b16 v[100:101], v11 offset:36864
v_mfma_f32_16x16x32_bf16 v[156:159], v[108:111], a[12:15], v[156:159]
ds_read_b64_tr_b16 v[102:103], v11 offset:53248
s_waitcnt lgkmcnt(6)
v_mfma_f32_16x16x32_bf16 v[128:131], v[112:115], a[16:19], v[128:131]
buffer_load_dword v57, v50, s[44:47], s3 offen
v_mfma_f32_16x16x32_bf16 v[144:147], v[112:115], a[20:23], v[144:147]
ds_read_b64_tr_b16 v[104:105], v12 offset:36864
ds_read_b64_tr_b16 v[106:107], v12 offset:53248
v_mfma_f32_16x16x32_bf16 v[132:135], v[116:119], a[16:19], v[132:135]
ds_read_b64_tr_b16 v[108:109], v13 offset:36864
s_mul_i32 s3, s101, 1024
v_mfma_f32_16x16x32_bf16 v[148:151], v[116:119], a[20:23], v[148:151]
ds_read_b64_tr_b16 v[110:111], v13 offset:53248
s_add_u32 s3, s3, 0x200000
v_mfma_f32_16x16x32_bf16 v[136:139], v[120:123], a[16:19], v[136:139]
buffer_load_dword v57, v50, s[48:51], s3 offen
v_mfma_f32_16x16x32_bf16 v[152:155], v[120:123], a[20:23], v[152:155]
ds_read_b64_tr_b16 v[112:113], v10 offset:37888
ds_read_b64_tr_b16 v[114:115], v10 offset:54272
v_mfma_f32_16x16x32_bf16 v[140:143], v[124:127], a[16:19], v[140:143]
ds_read_b64_tr_b16 v[116:117], v11 offset:37888
v_mul_f32 v180, v64, v180
v_mfma_f32_16x16x32_bf16 v[156:159], v[124:127], a[20:23], v[156:159]
ds_read_b64_tr_b16 v[118:119], v11 offset:54272
v_mul_f32 v181, v65, v181
v_mfma_f32_16x16x32_bf16 v[128:131], v[80:83], a[24:27], v[128:131]
ds_read_b64_tr_b16 v[120:121], v12 offset:37888
v_mul_f32 v182, v66, v182
v_mfma_f32_16x16x32_bf16 v[144:147], v[80:83], a[28:31], v[144:147]
ds_read_b64_tr_b16 v[122:123], v12 offset:54272
v_mul_f32 v183, v67, v183
v_mfma_f32_16x16x32_bf16 v[132:135], v[84:87], a[24:27], v[132:135]
ds_read_b64_tr_b16 v[124:125], v13 offset:37888
v_cvt_pk_bf16_f32 v234, v180, v181
v_mfma_f32_16x16x32_bf16 v[148:151], v[84:87], a[28:31], v[148:151]
ds_read_b64_tr_b16 v[126:127], v13 offset:54272
v_cvt_pk_bf16_f32 v235, v182, v183
v_mfma_f32_16x16x32_bf16 v[136:139], v[88:91], a[24:27], v[136:139]
ds_read_b64_tr_b16 v[80:81], v10 offset:38912
v_mul_f32 v184, v64, v184
v_mfma_f32_16x16x32_bf16 v[152:155], v[88:91], a[28:31], v[152:155]
ds_read_b64_tr_b16 v[82:83], v10 offset:55296
s_waitcnt lgkmcnt(6)
v_mfma_f32_16x16x32_bf16 v[140:143], v[92:95], a[24:27], v[140:143]
ds_read_b64_tr_b16 v[84:85], v11 offset:38912
v_mul_f32 v185, v65, v185
v_mfma_f32_16x16x32_bf16 v[156:159], v[92:95], a[28:31], v[156:159]
ds_read_b64_tr_b16 v[86:87], v11 offset:55296
v_mul_f32 v186, v66, v186
v_mfma_f32_16x16x32_bf16 v[128:131], v[96:99], a[32:35], v[128:131]
ds_read_b64_tr_b16 v[88:89], v12 offset:38912
v_mul_f32 v187, v67, v187
v_mfma_f32_16x16x32_bf16 v[144:147], v[96:99], a[36:39], v[144:147]
ds_read_b64_tr_b16 v[90:91], v12 offset:55296
v_cvt_pk_bf16_f32 v240, v184, v185
v_mfma_f32_16x16x32_bf16 v[132:135], v[100:103], a[32:35], v[132:135]
ds_read_b64_tr_b16 v[92:93], v13 offset:38912
v_cvt_pk_bf16_f32 v241, v186, v187
v_mfma_f32_16x16x32_bf16 v[148:151], v[100:103], a[36:39], v[148:151]
ds_read_b64_tr_b16 v[94:95], v13 offset:55296
v_mul_f32 v188, v64, v188
v_mfma_f32_16x16x32_bf16 v[136:139], v[104:107], a[32:35], v[136:139]
ds_read_b64_tr_b16 v[96:97], v10 offset:39936
v_mul_f32 v189, v65, v189
v_mfma_f32_16x16x32_bf16 v[152:155], v[104:107], a[36:39], v[152:155]
ds_read_b64_tr_b16 v[98:99], v10 offset:56320
v_mul_f32 v190, v66, v190
v_mfma_f32_16x16x32_bf16 v[140:143], v[108:111], a[32:35], v[140:143]
ds_read_b64_tr_b16 v[100:101], v11 offset:39936
v_mul_f32 v191, v67, v191
v_mfma_f32_16x16x32_bf16 v[156:159], v[108:111], a[36:39], v[156:159]
ds_read_b64_tr_b16 v[102:103], v11 offset:56320
v_cvt_pk_bf16_f32 v246, v188, v189
v_mfma_f32_16x16x32_bf16 v[128:131], v[112:115], a[40:43], v[128:131]
ds_read_b64_tr_b16 v[104:105], v12 offset:39936
s_add_u32 m0, s76, 0
v_mfma_f32_16x16x32_bf16 v[144:147], v[112:115], a[44:47], v[144:147]
ds_read_b64_tr_b16 v[106:107], v12 offset:56320
s_add_u32 s77, s82, 0x480000
v_mfma_f32_16x16x32_bf16 v[132:135], v[116:119], a[40:43], v[132:135]
buffer_load_dwordx4 v22, s[32:35], s77 offen offset:0 lds
v_mfma_f32_16x16x32_bf16 v[148:151], v[116:119], a[44:47], v[148:151]
ds_read_b64_tr_b16 v[108:109], v13 offset:39936
s_waitcnt lgkmcnt(5)
v_mfma_f32_16x16x32_bf16 v[136:139], v[120:123], a[40:43], v[136:139]
ds_read_b64_tr_b16 v[110:111], v13 offset:56320
v_cvt_pk_bf16_f32 v247, v190, v191
v_mfma_f32_16x16x32_bf16 v[152:155], v[120:123], a[44:47], v[152:155]
buffer_store_dwordx2 v[228:229], v73, s[60:63], 0 offen offset:2048 sc1
v_mfma_f32_16x16x32_bf16 v[140:143], v[124:127], a[40:43], v[140:143]
v_mfma_f32_16x16x32_bf16 v[156:159], v[124:127], a[44:47], v[156:159]
buffer_load_dwordx4 v23, s[32:35], s77 offen offset:1024 lds
v_mfma_f32_16x16x32_bf16 v[128:131], v[80:83], a[48:51], v[128:131]
v_mfma_f32_16x16x32_bf16 v[144:147], v[80:83], a[52:55], v[144:147]
s_waitcnt vmcnt(18) lgkmcnt(0)
s_barrier
v_mfma_f32_16x16x32_bf16 v[132:135], v[84:87], a[48:51], v[132:135]
ds_read_b64_tr_b16 v[112:113], v14 offset:0
ds_read_b64_tr_b16 v[114:115], v14 offset:16384
v_mfma_f32_16x16x32_bf16 v[148:151], v[84:87], a[52:55], v[148:151]
ds_read_b64_tr_b16 v[116:117], v15 offset:0
ds_read_b64_tr_b16 v[118:119], v15 offset:16384
v_mfma_f32_16x16x32_bf16 v[136:139], v[88:91], a[48:51], v[136:139]
ds_read_b64_tr_b16 v[120:121], v16 offset:0
v_mfma_f32_16x16x32_bf16 v[152:155], v[88:91], a[52:55], v[152:155]
ds_read_b64_tr_b16 v[122:123], v16 offset:16384
ds_read_b64_tr_b16 v[124:125], v17 offset:0
v_mfma_f32_16x16x32_bf16 v[140:143], v[92:95], a[48:51], v[140:143]
buffer_load_dwordx4 v24, s[32:35], s77 offen offset:2048 lds
v_mfma_f32_16x16x32_bf16 v[156:159], v[92:95], a[52:55], v[156:159]
ds_read_b64_tr_b16 v[126:127], v17 offset:16384
ds_read_b64_tr_b16 v[80:81], v14 offset:1024
v_mfma_f32_16x16x32_bf16 v[128:131], v[96:99], a[56:59], v[128:131]
ds_write_b64 v72, v[228:229] offset:2048
v_mfma_f32_16x16x32_bf16 v[144:147], v[96:99], a[60:63], v[144:147]
ds_read_b64_tr_b16 v[82:83], v14 offset:17408
ds_read_b64_tr_b16 v[84:85], v15 offset:1024
v_mfma_f32_16x16x32_bf16 v[132:135], v[100:103], a[56:59], v[132:135]
buffer_load_dwordx4 v25, s[32:35], s77 offen offset:3072 lds
v_mfma_f32_16x16x32_bf16 v[148:151], v[100:103], a[60:63], v[148:151]
ds_read_b64_tr_b16 v[86:87], v15 offset:17408
ds_read_b64_tr_b16 v[88:89], v16 offset:1024
v_mfma_f32_16x16x32_bf16 v[136:139], v[104:107], a[56:59], v[136:139]
buffer_store_dwordx2 v[234:235], v73, s[60:63], 0 offen offset:2560 sc1
v_mfma_f32_16x16x32_bf16 v[152:155], v[104:107], a[60:63], v[152:155]
ds_read_b64_tr_b16 v[90:91], v16 offset:17408
ds_read_b64_tr_b16 v[92:93], v17 offset:1024
v_mfma_f32_16x16x32_bf16 v[140:143], v[108:111], a[56:59], v[140:143]
ds_write_b64 v72, v[234:235] offset:2560
v_mfma_f32_16x16x32_bf16 v[156:159], v[108:111], a[60:63], v[156:159]
ds_read_b64_tr_b16 v[94:95], v17 offset:17408
s_waitcnt lgkmcnt(6)
v_mfma_f32_16x16x32_bf16 v[128:131], v[112:115], a[64:67], v[128:131]
ds_read_b64_tr_b16 v[96:97], v14 offset:2048
s_add_u32 m0, s76, 4096
v_mfma_f32_16x16x32_bf16 v[144:147], v[112:115], a[68:71], v[144:147]
ds_read_b64_tr_b16 v[98:99], v14 offset:18432
s_add_u32 s77, s82, 0x540000
v_mfma_f32_16x16x32_bf16 v[132:135], v[116:119], a[64:67], v[132:135]
ds_read_b64_tr_b16 v[100:101], v15 offset:2048
ds_read_b64_tr_b16 v[102:103], v15 offset:18432
v_mfma_f32_16x16x32_bf16 v[148:151], v[116:119], a[68:71], v[148:151]
buffer_load_dwordx4 v22, s[32:35], s77 offen offset:0 lds
v_mfma_f32_16x16x32_bf16 v[136:139], v[120:123], a[64:67], v[136:139]
ds_read_b64_tr_b16 v[104:105], v16 offset:2048
ds_read_b64_tr_b16 v[106:107], v16 offset:18432
v_mfma_f32_16x16x32_bf16 v[152:155], v[120:123], a[68:71], v[152:155]
buffer_store_dwordx2 v[240:241], v73, s[60:63], 0 offen offset:3072 sc1
v_mfma_f32_16x16x32_bf16 v[140:143], v[124:127], a[64:67], v[140:143]
ds_read_b64_tr_b16 v[108:109], v17 offset:2048
ds_read_b64_tr_b16 v[110:111], v17 offset:18432
v_mfma_f32_16x16x32_bf16 v[156:159], v[124:127], a[68:71], v[156:159]
buffer_load_dwordx4 v23, s[32:35], s77 offen offset:1024 lds
v_mfma_f32_16x16x32_bf16 v[128:131], v[80:83], a[72:75], v[128:131]
ds_read_b64_tr_b16 v[112:113], v14 offset:3072
ds_read_b64_tr_b16 v[114:115], v14 offset:19456
v_mfma_f32_16x16x32_bf16 v[144:147], v[80:83], a[76:79], v[144:147]
ds_read_b64_tr_b16 v[116:117], v15 offset:3072
s_waitcnt lgkmcnt(7)
v_mfma_f32_16x16x32_bf16 v[132:135], v[84:87], a[72:75], v[132:135]
ds_write_b64 v72, v[240:241] offset:3072
v_mfma_f32_16x16x32_bf16 v[148:151], v[84:87], a[76:79], v[148:151]
ds_read_b64_tr_b16 v[118:119], v15 offset:19456
ds_read_b64_tr_b16 v[120:121], v16 offset:3072
v_mfma_f32_16x16x32_bf16 v[136:139], v[88:91], a[72:75], v[136:139]
buffer_load_dwordx4 v24, s[32:35], s77 offen offset:2048 lds
v_mfma_f32_16x16x32_bf16 v[152:155], v[88:91], a[76:79], v[152:155]
ds_read_b64_tr_b16 v[122:123], v16 offset:19456
ds_read_b64_tr_b16 v[124:125], v17 offset:3072
v_mfma_f32_16x16x32_bf16 v[140:143], v[92:95], a[72:75], v[140:143]
buffer_store_dwordx2 v[246:247], v73, s[60:63], 0 offen offset:3584 sc1
v_mfma_f32_16x16x32_bf16 v[156:159], v[92:95], a[76:79], v[156:159]
ds_read_b64_tr_b16 v[126:127], v17 offset:19456
ds_read_b64_tr_b16 v[80:81], v14 offset:4096
v_mfma_f32_16x16x32_bf16 v[128:131], v[96:99], a[80:83], v[128:131]
buffer_load_dwordx4 v25, s[32:35], s77 offen offset:3072 lds
v_mfma_f32_16x16x32_bf16 v[144:147], v[96:99], a[84:87], v[144:147]
ds_read_b64_tr_b16 v[82:83], v14 offset:20480
ds_read_b64_tr_b16 v[84:85], v15 offset:4096
v_mfma_f32_16x16x32_bf16 v[132:135], v[100:103], a[80:83], v[132:135]
ds_write_b64 v72, v[246:247] offset:3584
v_mfma_f32_16x16x32_bf16 v[148:151], v[100:103], a[84:87], v[148:151]
ds_read_b64_tr_b16 v[86:87], v15 offset:20480
s_waitcnt lgkmcnt(6)
v_mfma_f32_16x16x32_bf16 v[136:139], v[104:107], a[80:83], v[136:139]
ds_read_b64_tr_b16 v[88:89], v16 offset:4096
s_add_u32 m0, s76, 32768
v_mfma_f32_16x16x32_bf16 v[152:155], v[104:107], a[84:87], v[152:155]
ds_read_b64_tr_b16 v[90:91], v16 offset:20480
s_add_u32 s77, s83, 0x0
v_mfma_f32_16x16x32_bf16 v[140:143], v[108:111], a[80:83], v[140:143]
ds_read_b64_tr_b16 v[92:93], v17 offset:4096
ds_read_b64_tr_b16 v[94:95], v17 offset:20480
v_mfma_f32_16x16x32_bf16 v[156:159], v[108:111], a[84:87], v[156:159]
buffer_load_dwordx4 v26, s[36:39], s77 offen offset:0 lds
v_mfma_f32_16x16x32_bf16 v[128:131], v[112:115], a[88:91], v[128:131]
ds_read_b64_tr_b16 v[96:97], v14 offset:5120
ds_read_b64_tr_b16 v[98:99], v14 offset:21504
v_mfma_f32_16x16x32_bf16 v[144:147], v[112:115], a[92:95], v[144:147]
ds_read_b64_tr_b16 v[100:101], v15 offset:5120
v_mul_f32 v160, v60, v160
v_mfma_f32_16x16x32_bf16 v[132:135], v[116:119], a[88:91], v[132:135]
ds_read_b64_tr_b16 v[102:103], v15 offset:21504
ds_read_b64_tr_b16 v[104:105], v16 offset:5120
v_mfma_f32_16x16x32_bf16 v[148:151], v[116:119], a[92:95], v[148:151]
buffer_load_dwordx4 v27, s[36:39], s77 offen offset:1024 lds
v_mfma_f32_16x16x32_bf16 v[136:139], v[120:123], a[88:91], v[136:139]
ds_read_b64_tr_b16 v[106:107], v16 offset:21504
ds_read_b64_tr_b16 v[108:109], v17 offset:5120
v_mfma_f32_16x16x32_bf16 v[152:155], v[120:123], a[92:95], v[152:155]
ds_read_b64_tr_b16 v[110:111], v17 offset:21504
s_waitcnt lgkmcnt(8)
v_mfma_f32_16x16x32_bf16 v[140:143], v[124:127], a[88:91], v[140:143]
ds_read_b64_tr_b16 v[112:113], v14 offset:6144
ds_read_b64_tr_b16 v[114:115], v14 offset:22528
v_mfma_f32_16x16x32_bf16 v[156:159], v[124:127], a[92:95], v[156:159]
buffer_load_dwordx4 v28, s[36:39], s77 offen offset:2048 lds
v_mfma_f32_16x16x32_bf16 v[128:131], v[80:83], a[96:99], v[128:131]
ds_read_b64_tr_b16 v[116:117], v15 offset:6144
ds_read_b64_tr_b16 v[118:119], v15 offset:22528
v_mfma_f32_16x16x32_bf16 v[144:147], v[80:83], a[100:103], v[144:147]
ds_read_b64_tr_b16 v[120:121], v16 offset:6144
v_mul_f32 v161, v61, v161
v_mfma_f32_16x16x32_bf16 v[132:135], v[84:87], a[96:99], v[132:135]
ds_read_b64_tr_b16 v[122:123], v16 offset:22528
ds_read_b64_tr_b16 v[124:125], v17 offset:6144
v_mfma_f32_16x16x32_bf16 v[148:151], v[84:87], a[100:103], v[148:151]
buffer_load_dwordx4 v29, s[36:39], s77 offen offset:3072 lds
v_mfma_f32_16x16x32_bf16 v[136:139], v[88:91], a[96:99], v[136:139]
ds_read_b64_tr_b16 v[126:127], v17 offset:22528
ds_read_b64_tr_b16 v[80:81], v14 offset:7168
v_mfma_f32_16x16x32_bf16 v[152:155], v[88:91], a[100:103], v[152:155]
ds_read_b64_tr_b16 v[82:83], v14 offset:23552
s_add_u32 m0, s76, 36864
v_mfma_f32_16x16x32_bf16 v[140:143], v[92:95], a[96:99], v[140:143]
ds_read_b64_tr_b16 v[84:85], v15 offset:7168
s_add_u32 s77, s83, 0x40000
v_mfma_f32_16x16x32_bf16 v[156:159], v[92:95], a[100:103], v[156:159]
ds_read_b64_tr_b16 v[86:87], v15 offset:23552
s_waitcnt lgkmcnt(7)
v_mfma_f32_16x16x32_bf16 v[128:131], v[96:99], a[104:107], v[128:131]
buffer_load_dwordx4 v26, s[36:39], s77 offen offset:0 lds
v_mfma_f32_16x16x32_bf16 v[144:147], v[96:99], a[108:111], v[144:147]
ds_read_b64_tr_b16 v[88:89], v16 offset:7168
ds_read_b64_tr_b16 v[90:91], v16 offset:23552
v_mfma_f32_16x16x32_bf16 v[132:135], v[100:103], a[104:107], v[132:135]
ds_read_b64_tr_b16 v[92:93], v17 offset:7168
v_mul_f32 v162, v62, v162
v_mfma_f32_16x16x32_bf16 v[148:151], v[100:103], a[108:111], v[148:151]
ds_read_b64_tr_b16 v[94:95], v17 offset:23552
v_mul_f32 v163, v63, v163
v_mfma_f32_16x16x32_bf16 v[136:139], v[104:107], a[104:107], v[136:139]
buffer_load_dwordx4 v27, s[36:39], s77 offen offset:1024 lds
v_mfma_f32_16x16x32_bf16 v[152:155], v[104:107], a[108:111], v[152:155]
v_cvt_pk_bf16_f32 v226, v160, v161
v_cvt_pk_bf16_f32 v227, v162, v163
v_mfma_f32_16x16x32_bf16 v[140:143], v[108:111], a[104:107], v[140:143]
v_mul_f32 v164, v60, v164
v_mul_f32 v165, v61, v165
v_mfma_f32_16x16x32_bf16 v[156:159], v[108:111], a[108:111], v[156:159]
v_mul_f32 v166, v62, v166
v_mul_f32 v167, v63, v167
v_mfma_f32_16x16x32_bf16 v[128:131], v[112:115], a[112:115], v[128:131]
s_waitcnt vmcnt(23) lgkmcnt(0)
s_barrier
s_waitcnt vmcnt(7)
s_atomic_add s85, s[60:61], s97
s_mov_b32 s87, 0
s_atomic_add s87, s[60:61], s98 glc
v_mfma_f32_16x16x32_bf16 v[144:147], v[112:115], a[116:119], v[144:147]
ds_read_b64_tr_b16 v[96:97], v14 offset:32768
ds_read_b64_tr_b16 v[98:99], v14 offset:49152
v_mfma_f32_16x16x32_bf16 v[132:135], v[116:119], a[112:115], v[132:135]
ds_read_b64_tr_b16 v[100:101], v15 offset:32768
v_cvt_pk_bf16_f32 v232, v164, v165
v_mfma_f32_16x16x32_bf16 v[148:151], v[116:119], a[116:119], v[148:151]
ds_read_b64_tr_b16 v[102:103], v15 offset:49152
ds_read_b64_tr_b16 v[104:105], v16 offset:32768
v_mfma_f32_16x16x32_bf16 v[136:139], v[120:123], a[112:115], v[136:139]
buffer_load_dwordx4 v28, s[36:39], s77 offen offset:2048 lds
v_mfma_f32_16x16x32_bf16 v[152:155], v[120:123], a[116:119], v[152:155]
ds_read_b64_tr_b16 v[106:107], v16 offset:49152
ds_read_b64_tr_b16 v[108:109], v17 offset:32768
v_mfma_f32_16x16x32_bf16 v[140:143], v[124:127], a[112:115], v[140:143]
ds_read_b64_tr_b16 v[110:111], v17 offset:49152
v_cvt_pk_bf16_f32 v233, v166, v167
v_mfma_f32_16x16x32_bf16 v[156:159], v[124:127], a[116:119], v[156:159]
ds_read_b64_tr_b16 v[112:113], v14 offset:33792
ds_read_b64_tr_b16 v[114:115], v14 offset:50176
v_mfma_f32_16x16x32_bf16 v[128:131], v[80:83], a[120:123], v[128:131]
buffer_load_dwordx4 v29, s[36:39], s77 offen offset:3072 lds
v_mfma_f32_16x16x32_bf16 v[144:147], v[80:83], a[124:127], v[144:147]
ds_read_b64_tr_b16 v[116:117], v15 offset:33792
ds_read_b64_tr_b16 v[118:119], v15 offset:50176
v_mfma_f32_16x16x32_bf16 v[132:135], v[84:87], a[120:123], v[132:135]
ds_read_b64_tr_b16 v[120:121], v16 offset:33792
s_add_u32 m0, s76, 65536
v_mfma_f32_16x16x32_bf16 v[148:151], v[84:87], a[124:127], v[148:151]
ds_read_b64_tr_b16 v[122:123], v16 offset:50176
s_add_u32 s77, s83, 0x80000
v_mfma_f32_16x16x32_bf16 v[136:139], v[88:91], a[120:123], v[136:139]
buffer_load_dwordx4 v26, s[36:39], s77 offen offset:0 lds
v_mfma_f32_16x16x32_bf16 v[152:155], v[88:91], a[124:127], v[152:155]
ds_read_b64_tr_b16 v[124:125], v17 offset:33792
ds_read_b64_tr_b16 v[126:127], v17 offset:50176
v_mfma_f32_16x16x32_bf16 v[140:143], v[92:95], a[120:123], v[140:143]
ds_read_b64_tr_b16 v[80:81], v14 offset:34816
v_mul_f32 v168, v60, v168
v_mfma_f32_16x16x32_bf16 v[156:159], v[92:95], a[124:127], v[156:159]
ds_read_b64_tr_b16 v[82:83], v14 offset:51200
s_waitcnt lgkmcnt(6)
v_mfma_f32_16x16x32_bf16 v[128:131], v[96:99], a[128:131], v[128:131]
buffer_load_dwordx4 v27, s[36:39], s77 offen offset:1024 lds
v_mfma_f32_16x16x32_bf16 v[144:147], v[96:99], a[132:135], v[144:147]
ds_read_b64_tr_b16 v[84:85], v15 offset:34816
ds_read_b64_tr_b16 v[86:87], v15 offset:51200
v_mfma_f32_16x16x32_bf16 v[132:135], v[100:103], a[128:131], v[132:135]
ds_read_b64_tr_b16 v[88:89], v16 offset:34816
v_mul_f32 v169, v61, v169
v_mfma_f32_16x16x32_bf16 v[148:151], v[100:103], a[132:135], v[148:151]
ds_read_b64_tr_b16 v[90:91], v16 offset:51200
ds_read_b64_tr_b16 v[92:93], v17 offset:34816
v_mfma_f32_16x16x32_bf16 v[136:139], v[104:107], a[128:131], v[136:139]
buffer_load_dwordx4 v28, s[36:39], s77 offen offset:2048 lds
v_mfma_f32_16x16x32_bf16 v[152:155], v[104:107], a[132:135], v[152:155]
ds_read_b64_tr_b16 v[94:95], v17 offset:51200
ds_read_b64_tr_b16 v[96:97], v14 offset:35840
v_mfma_f32_16x16x32_bf16 v[140:143], v[108:111], a[128:131], v[140:143]
ds_read_b64_tr_b16 v[98:99], v14 offset:52224
v_mul_f32 v170, v62, v170
v_mfma_f32_16x16x32_bf16 v[156:159], v[108:111], a[132:135], v[156:159]
ds_read_b64_tr_b16 v[100:101], v15 offset:35840
ds_read_b64_tr_b16 v[102:103], v15 offset:52224
v_mfma_f32_16x16x32_bf16 v[128:131], v[112:115], a[136:139], v[128:131]
buffer_load_dwordx4 v29, s[36:39], s77 offen offset:3072 lds
v_mfma_f32_16x16x32_bf16 v[144:147], v[112:115], a[140:143], v[144:147]
ds_read_b64_tr_b16 v[104:105], v16 offset:35840
ds_read_b64_tr_b16 v[106:107], v16 offset:52224
v_mfma_f32_16x16x32_bf16 v[132:135], v[116:119], a[136:139], v[132:135]
ds_read_b64_tr_b16 v[108:109], v17 offset:35840
s_add_u32 m0, s76, 69632
v_mfma_f32_16x16x32_bf16 v[148:151], v[116:119], a[140:143], v[148:151]
ds_read_b64_tr_b16 v[110:111], v17 offset:52224
s_waitcnt lgkmcnt(7)
v_mfma_f32_16x16x32_bf16 v[136:139], v[120:123], a[136:139], v[136:139]
ds_read_b64_tr_b16 v[112:113], v14 offset:36864
s_add_u32 s77, s83, 0xc0000
v_mfma_f32_16x16x32_bf16 v[152:155], v[120:123], a[140:143], v[152:155]
buffer_load_dwordx4 v26, s[36:39], s77 offen offset:0 lds
v_mfma_f32_16x16x32_bf16 v[140:143], v[124:127], a[136:139], v[140:143]
ds_read_b64_tr_b16 v[114:115], v14 offset:53248
ds_read_b64_tr_b16 v[116:117], v15 offset:36864
v_mfma_f32_16x16x32_bf16 v[156:159], v[124:127], a[140:143], v[156:159]
ds_read_b64_tr_b16 v[118:119], v15 offset:53248
v_mul_f32 v171, v63, v171
v_mfma_f32_16x16x32_bf16 v[128:131], v[80:83], a[144:147], v[128:131]
ds_read_b64_tr_b16 v[120:121], v16 offset:36864
v_cvt_pk_bf16_f32 v238, v168, v169
v_mfma_f32_16x16x32_bf16 v[144:147], v[80:83], a[148:151], v[144:147]
buffer_load_dwordx4 v27, s[36:39], s77 offen offset:1024 lds
v_mfma_f32_16x16x32_bf16 v[132:135], v[84:87], a[144:147], v[132:135]
ds_read_b64_tr_b16 v[122:123], v16 offset:53248
ds_read_b64_tr_b16 v[124:125], v17 offset:36864
v_mfma_f32_16x16x32_bf16 v[148:151], v[84:87], a[148:151], v[148:151]
ds_read_b64_tr_b16 v[126:127], v17 offset:53248
v_cvt_pk_bf16_f32 v239, v170, v171
v_mfma_f32_16x16x32_bf16 v[136:139], v[88:91], a[144:147], v[136:139]
ds_read_b64_tr_b16 v[80:81], v14 offset:37888
v_mul_f32 v172, v60, v172
v_mfma_f32_16x16x32_bf16 v[152:155], v[88:91], a[148:151], v[152:155]
buffer_load_dwordx4 v28, s[36:39], s77 offen offset:2048 lds
v_mfma_f32_16x16x32_bf16 v[140:143], v[92:95], a[144:147], v[140:143]
ds_read_b64_tr_b16 v[82:83], v14 offset:54272
ds_read_b64_tr_b16 v[84:85], v15 offset:37888
v_mfma_f32_16x16x32_bf16 v[156:159], v[92:95], a[148:151], v[156:159]
ds_read_b64_tr_b16 v[86:87], v15 offset:54272
s_waitcnt lgkmcnt(7)
v_mfma_f32_16x16x32_bf16 v[128:131], v[96:99], a[152:155], v[128:131]
ds_read_b64_tr_b16 v[88:89], v16 offset:37888
v_mul_f32 v173, v61, v173
v_mfma_f32_16x16x32_bf16 v[144:147], v[96:99], a[156:159], v[144:147]
buffer_load_dwordx4 v29, s[36:39], s77 offen offset:3072 lds
v_mfma_f32_16x16x32_bf16 v[132:135], v[100:103], a[152:155], v[132:135]
ds_read_b64_tr_b16 v[90:91], v16 offset:54272
ds_read_b64_tr_b16 v[92:93], v17 offset:37888
v_mfma_f32_16x16x32_bf16 v[148:151], v[100:103], a[156:159], v[148:151]
ds_read_b64_tr_b16 v[94:95], v17 offset:54272
v_mul_f32 v174, v62, v174
v_mfma_f32_16x16x32_bf16 v[136:139], v[104:107], a[152:155], v[136:139]
ds_read_b64_tr_b16 v[96:97], v14 offset:38912
v_mul_f32 v175, v63, v175
v_mfma_f32_16x16x32_bf16 v[152:155], v[104:107], a[156:159], v[152:155]
ds_read_b64_tr_b16 v[98:99], v14 offset:55296
v_cvt_pk_bf16_f32 v244, v172, v173
v_mfma_f32_16x16x32_bf16 v[140:143], v[108:111], a[152:155], v[140:143]
ds_read_b64_tr_b16 v[100:101], v15 offset:38912
v_cvt_pk_bf16_f32 v245, v174, v175
v_mfma_f32_16x16x32_bf16 v[156:159], v[108:111], a[156:159], v[156:159]
ds_read_b64_tr_b16 v[102:103], v15 offset:55296
ds_read_b64_tr_b16 v[104:105], v16 offset:38912
v_mfma_f32_16x16x32_bf16 v[128:131], v[112:115], a[160:163], v[128:131]
ds_read_b64_tr_b16 v[106:107], v16 offset:55296
v_mfma_f32_16x16x32_bf16 v[144:147], v[112:115], a[164:167], v[144:147]
ds_read_b64_tr_b16 v[108:109], v17 offset:38912
ds_read_b64_tr_b16 v[110:111], v17 offset:55296
v_mfma_f32_16x16x32_bf16 v[132:135], v[116:119], a[160:163], v[132:135]
ds_read_b64_tr_b16 v[112:113], v14 offset:39936
v_mfma_f32_16x16x32_bf16 v[148:151], v[116:119], a[164:167], v[148:151]
ds_read_b64_tr_b16 v[114:115], v14 offset:56320
s_waitcnt lgkmcnt(8)
v_mfma_f32_16x16x32_bf16 v[136:139], v[120:123], a[160:163], v[136:139]
ds_read_b64_tr_b16 v[116:117], v15 offset:39936
v_mfma_f32_16x16x32_bf16 v[152:155], v[120:123], a[164:167], v[152:155]
ds_read_b64_tr_b16 v[118:119], v15 offset:56320
v_mfma_f32_16x16x32_bf16 v[140:143], v[124:127], a[160:163], v[140:143]
ds_read_b64_tr_b16 v[120:121], v16 offset:39936
v_mfma_f32_16x16x32_bf16 v[156:159], v[124:127], a[164:167], v[156:159]
ds_read_b64_tr_b16 v[122:123], v16 offset:56320
v_mfma_f32_16x16x32_bf16 v[128:131], v[80:83], a[168:171], v[128:131]
ds_read_b64_tr_b16 v[124:125], v17 offset:39936
v_mfma_f32_16x16x32_bf16 v[144:147], v[80:83], a[172:175], v[144:147]
ds_read_b64_tr_b16 v[126:127], v17 offset:56320
v_mfma_f32_16x16x32_bf16 v[132:135], v[84:87], a[168:171], v[132:135]
v_mfma_f32_16x16x32_bf16 v[148:151], v[84:87], a[172:175], v[148:151]
v_mfma_f32_16x16x32_bf16 v[136:139], v[88:91], a[168:171], v[136:139]
v_mfma_f32_16x16x32_bf16 v[152:155], v[88:91], a[172:175], v[152:155]
v_mfma_f32_16x16x32_bf16 v[140:143], v[92:95], a[168:171], v[140:143]
s_waitcnt vmcnt(16) lgkmcnt(0)
s_barrier
s_cmp_lt_u32 s87, s99
s_cbranch_scc1 pl_1_slow
pl_1_ok:
v_mfma_f32_16x16x32_bf16 v[156:159], v[92:95], a[172:175], v[156:159]
ds_read_b64_tr_b16 v[80:81], v10 offset:0
ds_read_b64_tr_b16 v[82:83], v10 offset:16384
v_mfma_f32_16x16x32_bf16 v[128:131], v[96:99], a[176:179], v[128:131]
s_mov_b32 m0, s68
s_nop 0
buffer_load_dwordx4 v68, s[60:63], 0 offen offset:0 sc1 lds
buffer_load_dwordx4 v68, s[60:63], 0 offen offset:1024 sc1 lds
v_mfma_f32_16x16x32_bf16 v[144:147], v[96:99], a[180:183], v[144:147]
ds_read_b64_tr_b16 v[84:85], v11 offset:0
ds_read_b64_tr_b16 v[86:87], v11 offset:16384
v_mfma_f32_16x16x32_bf16 v[132:135], v[100:103], a[176:179], v[132:135]
ds_read_b64_tr_b16 v[88:89], v12 offset:0
s_add_u32 m0, s76, 98304
v_mfma_f32_16x16x32_bf16 v[148:151], v[100:103], a[180:183], v[148:151]
ds_read_b64_tr_b16 v[90:91], v12 offset:16384
s_add_u32 s77, s83, 0x100000
v_mfma_f32_16x16x32_bf16 v[136:139], v[104:107], a[176:179], v[136:139]
buffer_load_dwordx4 v26, s[36:39], s77 offen offset:0 lds
v_mfma_f32_16x16x32_bf16 v[152:155], v[104:107], a[180:183], v[152:155]
ds_read_b64_tr_b16 v[92:93], v13 offset:0
ds_read_b64_tr_b16 v[94:95], v13 offset:16384
v_mfma_f32_16x16x32_bf16 v[140:143], v[108:111], a[176:179], v[140:143]
ds_read_b64_tr_b16 v[96:97], v10 offset:1024
v_mfma_f32_16x16x32_bf16 v[156:159], v[108:111], a[180:183], v[156:159]
ds_read_b64_tr_b16 v[98:99], v10 offset:17408
ds_read_b64_tr_b16 v[100:101], v11 offset:1024
v_mfma_f32_16x16x32_bf16 v[128:131], v[112:115], a[184:187], v[128:131]
ds_read_b64_tr_b16 v[102:103], v11 offset:17408
v_mfma_f32_16x16x32_bf16 v[144:147], v[112:115], a[188:191], v[144:147]
ds_read_b64_tr_b16 v[104:105], v12 offset:1024
ds_read_b64_tr_b16 v[106:107], v12 offset:17408
v_mfma_f32_16x16x32_bf16 v[132:135], v[116:119], a[184:187], v[132:135]
buffer_load_dwordx4 v27, s[36:39], s77 offen offset:1024 lds
v_mfma_f32_16x16x32_bf16 v[148:151], v[116:119], a[188:191], v[148:151]
ds_read_b64_tr_b16 v[108:109], v13 offset:1024
ds_read_b64_tr_b16 v[110:111], v13 offset:17408
v_mfma_f32_16x16x32_bf16 v[136:139], v[120:123], a[184:187], v[136:139]
ds_read_b64_tr_b16 v[112:113], v10 offset:2048
v_mfma_f32_16x16x32_bf16 v[152:155], v[120:123], a[188:191], v[152:155]
ds_read_b64_tr_b16 v[114:115], v10 offset:18432
ds_read_b64_tr_b16 v[116:117], v11 offset:2048
v_mfma_f32_16x16x32_bf16 v[140:143], v[124:127], a[184:187], v[140:143]
ds_read_b64_tr_b16 v[118:119], v11 offset:18432
v_mfma_f32_16x16x32_bf16 v[156:159], v[124:127], a[188:191], v[156:159]
ds_read_b64_tr_b16 v[120:121], v12 offset:2048
s_waitcnt lgkmcnt(7)
v_mfma_f32_16x16x32_bf16 v[128:131], v[80:83], a[192:195], v[128:131]
buffer_load_dwordx4 v28, s[36:39], s77 offen offset:2048 lds
v_mfma_f32_16x16x32_bf16 v[144:147], v[80:83], a[196:199], v[144:147]
ds_read_b64_tr_b16 v[122:123], v12 offset:18432
ds_read_b64_tr_b16 v[124:125], v13 offset:2048
v_mfma_f32_16x16x32_bf16 v[132:135], v[84:87], a[192:195], v[132:135]
ds_read_b64_tr_b16 v[126:127], v13 offset:18432
v_mfma_f32_16x16x32_bf16 v[148:151], v[84:87], a[196:199], v[148:151]
ds_read_b64_tr_b16 v[80:81], v10 offset:3072
ds_read_b64_tr_b16 v[82:83], v10 offset:19456
v_mfma_f32_16x16x32_bf16 v[136:139], v[88:91], a[192:195], v[136:139]
ds_read_b64_tr_b16 v[84:85], v11 offset:3072
v_mfma_f32_16x16x32_bf16 v[152:155], v[88:91], a[196:199], v[152:155]
ds_read_b64_tr_b16 v[86:87], v11 offset:19456
v_mfma_f32_16x16x32_bf16 v[140:143], v[92:95], a[192:195], v[140:143]
buffer_load_dwordx4 v29, s[36:39], s77 offen offset:3072 lds
v_mfma_f32_16x16x32_bf16 v[156:159], v[92:95], a[196:199], v[156:159]
ds_read_b64_tr_b16 v[88:89], v12 offset:3072
ds_read_b64_tr_b16 v[90:91], v12 offset:19456
v_mfma_f32_16x16x32_bf16 v[128:131], v[96:99], a[200:203], v[128:131]
ds_read_b64_tr_b16 v[92:93], v13 offset:3072
v_mfma_f32_16x16x32_bf16 v[144:147], v[96:99], a[204:207], v[144:147]
ds_read_b64_tr_b16 v[94:95], v13 offset:19456
s_add_u32 m0, s76, 102400
v_mfma_f32_16x16x32_bf16 v[132:135], v[100:103], a[200:203], v[132:135]
ds_read_b64_tr_b16 v[96:97], v10 offset:4096
s_add_u32 s77, s83, 0x140000
v_mfma_f32_16x16x32_bf16 v[148:151], v[100:103], a[204:207], v[148:151]
ds_read_b64_tr_b16 v[98:99], v10 offset:20480
v_mfma_f32_16x16x32_bf16 v[136:139], v[104:107], a[200:203], v[136:139]
buffer_load_dwordx4 v26, s[36:39], s77 offen offset:0 lds
v_mfma_f32_16x16x32_bf16 v[152:155], v[104:107], a[204:207], v[152:155]
ds_read_b64_tr_b16 v[100:101], v11 offset:4096
s_waitcnt lgkmcnt(5)
v_mfma_f32_16x16x32_bf16 v[140:143], v[108:111], a[200:203], v[140:143]
ds_read_b64_tr_b16 v[102:103], v11 offset:20480
ds_read_b64_tr_b16 v[104:105], v12 offset:4096
v_mfma_f32_16x16x32_bf16 v[156:159], v[108:111], a[204:207], v[156:159]
ds_read_b64_tr_b16 v[106:107], v12 offset:20480
v_mfma_f32_16x16x32_bf16 v[128:131], v[112:115], a[208:211], v[128:131]
ds_read_b64_tr_b16 v[108:109], v13 offset:4096
v_mfma_f32_16x16x32_bf16 v[144:147], v[112:115], a[212:215], v[144:147]
ds_read_b64_tr_b16 v[110:111], v13 offset:20480
v_mfma_f32_16x16x32_bf16 v[132:135], v[116:119], a[208:211], v[132:135]
buffer_load_dwordx4 v27, s[36:39], s77 offen offset:1024 lds
v_mfma_f32_16x16x32_bf16 v[148:151], v[116:119], a[212:215], v[148:151]
ds_read_b64_tr_b16 v[112:113], v10 offset:5120
ds_read_b64_tr_b16 v[114:115], v10 offset:21504
v_mfma_f32_16x16x32_bf16 v[136:139], v[120:123], a[208:211], v[136:139]
ds_read_b64_tr_b16 v[116:117], v11 offset:5120
v_mfma_f32_16x16x32_bf16 v[152:155], v[120:123], a[212:215], v[152:155]
ds_read_b64_tr_b16 v[118:119], v11 offset:21504
v_mfma_f32_16x16x32_bf16 v[140:143], v[124:127], a[208:211], v[140:143]
ds_read_b64_tr_b16 v[120:121], v12 offset:5120
v_mfma_f32_16x16x32_bf16 v[156:159], v[124:127], a[212:215], v[156:159]
ds_read_b64_tr_b16 v[122:123], v12 offset:21504
v_mfma_f32_16x16x32_bf16 v[128:131], v[80:83], a[216:219], v[128:131]
buffer_load_dwordx4 v28, s[36:39], s77 offen offset:2048 lds
v_mfma_f32_16x16x32_bf16 v[144:147], v[80:83], a[220:223], v[144:147]
ds_read_b64_tr_b16 v[124:125], v13 offset:5120
ds_read_b64_tr_b16 v[126:127], v13 offset:21504
v_mfma_f32_16x16x32_bf16 v[132:135], v[84:87], a[216:219], v[132:135]
ds_read_b64_tr_b16 v[80:81], v10 offset:6144
v_mfma_f32_16x16x32_bf16 v[148:151], v[84:87], a[220:223], v[148:151]
ds_read_b64_tr_b16 v[82:83], v10 offset:22528
v_mfma_f32_16x16x32_bf16 v[136:139], v[88:91], a[216:219], v[136:139]
ds_read_b64_tr_b16 v[84:85], v11 offset:6144
v_mfma_f32_16x16x32_bf16 v[152:155], v[88:91], a[220:223], v[152:155]
ds_read_b64_tr_b16 v[86:87], v11 offset:22528
s_waitcnt lgkmcnt(6)
v_mfma_f32_16x16x32_bf16 v[140:143], v[92:95], a[216:219], v[140:143]
buffer_load_dwordx4 v29, s[36:39], s77 offen offset:3072 lds
v_mfma_f32_16x16x32_bf16 v[156:159], v[92:95], a[220:223], v[156:159]
ds_read_b64_tr_b16 v[88:89], v12 offset:6144
ds_read_b64_tr_b16 v[90:91], v12 offset:22528
v_mfma_f32_16x16x32_bf16 v[128:131], v[96:99], a[224:227], v[128:131]
ds_read_b64_tr_b16 v[92:93], v13 offset:6144
v_mfma_f32_16x16x32_bf16 v[144:147], v[96:99], a[228:231], v[144:147]
ds_read_b64_tr_b16 v[94:95], v13 offset:22528
v_mfma_f32_16x16x32_bf16 v[132:135], v[100:103], a[224:227], v[132:135]
ds_read_b64_tr_b16 v[96:97], v10 offset:7168
v_mfma_f32_16x16x32_bf16 v[148:151], v[100:103], a[228:231], v[148:151]
ds_read_b64_tr_b16 v[98:99], v10 offset:23552
v_mfma_f32_16x16x32_bf16 v[136:139], v[104:107], a[224:227], v[136:139]
ds_read_b64_tr_b16 v[100:101], v11 offset:7168
v_mfma_f32_16x16x32_bf16 v[152:155], v[104:107], a[228:231], v[152:155]
ds_read_b64_tr_b16 v[102:103], v11 offset:23552
v_mfma_f32_16x16x32_bf16 v[140:143], v[108:111], a[224:227], v[140:143]
ds_read_b64_tr_b16 v[104:105], v12 offset:7168
v_mfma_f32_16x16x32_bf16 v[156:159], v[108:111], a[228:231], v[156:159]
ds_read_b64_tr_b16 v[106:107], v12 offset:23552
v_mfma_f32_16x16x32_bf16 v[128:131], v[112:115], a[232:235], v[128:131]
ds_read_b64_tr_b16 v[108:109], v13 offset:7168
v_mfma_f32_16x16x32_bf16 v[144:147], v[112:115], a[236:239], v[144:147]
ds_read_b64_tr_b16 v[110:111], v13 offset:23552
v_mfma_f32_16x16x32_bf16 v[132:135], v[116:119], a[232:235], v[132:135]
v_mfma_f32_16x16x32_bf16 v[148:151], v[116:119], a[236:239], v[148:151]
v_mfma_f32_16x16x32_bf16 v[136:139], v[120:123], a[232:235], v[136:139]
v_mfma_f32_16x16x32_bf16 v[152:155], v[120:123], a[236:239], v[152:155]
s_waitcnt lgkmcnt(2)
v_mfma_f32_16x16x32_bf16 v[140:143], v[124:127], a[232:235], v[140:143]
s_waitcnt vmcnt(18) lgkmcnt(0)
s_barrier
v_mfma_f32_16x16x32_bf16 v[156:159], v[124:127], a[236:239], v[156:159]
s_add_u32 m0, s76, 0
s_add_u32 s77, s83, 0x180000
v_mfma_f32_16x16x32_bf16 v[128:131], v[80:83], a[240:243], v[128:131]
buffer_load_dwordx4 v26, s[36:39], s77 offen offset:0 lds
v_mfma_f32_16x16x32_bf16 v[144:147], v[80:83], a[244:247], v[144:147]
v_mfma_f32_16x16x32_bf16 v[132:135], v[84:87], a[240:243], v[132:135]
v_mfma_f32_16x16x32_bf16 v[148:151], v[84:87], a[244:247], v[148:151]
v_mfma_f32_16x16x32_bf16 v[136:139], v[88:91], a[240:243], v[136:139]
v_mfma_f32_16x16x32_bf16 v[152:155], v[88:91], a[244:247], v[152:155]
v_mfma_f32_16x16x32_bf16 v[140:143], v[92:95], a[240:243], v[140:143]
buffer_load_dwordx4 v27, s[36:39], s77 offen offset:1024 lds
v_mfma_f32_16x16x32_bf16 v[156:159], v[92:95], a[244:247], v[156:159]
v_mfma_f32_16x16x32_bf16 v[128:131], v[96:99], a[248:251], v[128:131]
v_mfma_f32_16x16x32_bf16 v[144:147], v[96:99], a[252:255], v[144:147]
v_mfma_f32_16x16x32_bf16 v[132:135], v[100:103], a[248:251], v[132:135]
v_mfma_f32_16x16x32_bf16 v[148:151], v[100:103], a[252:255], v[148:151]
v_mfma_f32_16x16x32_bf16 v[136:139], v[104:107], a[248:251], v[136:139]
buffer_load_dwordx4 v28, s[36:39], s77 offen offset:2048 lds
v_mfma_f32_16x16x32_bf16 v[152:155], v[104:107], a[252:255], v[152:155]
v_mfma_f32_16x16x32_bf16 v[140:143], v[108:111], a[248:251], v[140:143]
v_mfma_f32_16x16x32_bf16 v[156:159], v[108:111], a[252:255], v[156:159]
buffer_load_dwordx4 v29, s[36:39], s77 offen offset:3072 lds
s_add_u32 m0, s76, 4096
s_add_u32 s77, s83, 0x1c0000
buffer_load_dwordx4 v26, s[36:39], s77 offen offset:0 lds
buffer_load_dwordx4 v27, s[36:39], s77 offen offset:1024 lds
buffer_load_dwordx4 v28, s[36:39], s77 offen offset:2048 lds
buffer_load_dwordx4 v29, s[36:39], s77 offen offset:3072 lds
T_attn:
s_lshl_b32 s99, s99, 1
s_waitcnt vmcnt(16)
ds_read_b128 v[208:211], v74 offset:0
ds_read_b128 v[212:215], v74 offset:1024
s_waitcnt lgkmcnt(0)
s_mov_b32 s87, 0
s_atomic_add s87, s[60:61], s98 glc
v_mov_b32 v4, v58
v_mov_b32 v5, v58
v_mov_b32 v6, v59
v_mov_b32 v7, v59
v_pk_mul_f32 v[128:129], v[128:129], v[4:5]
v_pk_mul_f32 v[130:131], v[130:131], v[4:5]
v_pk_mul_f32 v[132:133], v[132:133], v[4:5]
v_pk_mul_f32 v[134:135], v[134:135], v[4:5]
v_pk_mul_f32 v[136:137], v[136:137], v[4:5]
v_pk_mul_f32 v[138:139], v[138:139], v[4:5]
v_pk_mul_f32 v[140:141], v[140:141], v[4:5]
v_pk_mul_f32 v[142:143], v[142:143], v[4:5]
v_pk_mul_f32 v[144:145], v[144:145], v[6:7]
v_pk_mul_f32 v[146:147], v[146:147], v[6:7]
v_pk_mul_f32 v[148:149], v[148:149], v[6:7]
v_pk_mul_f32 v[150:151], v[150:151], v[6:7]
v_pk_mul_f32 v[152:153], v[152:153], v[6:7]
v_pk_mul_f32 v[154:155], v[154:155], v[6:7]
v_pk_mul_f32 v[156:157], v[156:157], v[6:7]
v_pk_mul_f32 v[158:159], v[158:159], v[6:7]
v_cvt_pk_bf16_f32 v80, v128, v129
v_cvt_pk_bf16_f32 v81, v130, v131
v_cvt_pk_bf16_f32 v82, v132, v133
v_cvt_pk_bf16_f32 v83, v134, v135
v_cvt_pk_bf16_f32 v84, v136, v137
v_cvt_pk_bf16_f32 v85, v138, v139
v_cvt_pk_bf16_f32 v86, v140, v141
v_cvt_pk_bf16_f32 v87, v142, v143
v_cvt_pk_bf16_f32 v88, v144, v145
v_cvt_pk_bf16_f32 v89, v146, v147
v_cvt_pk_bf16_f32 v90, v148, v149
v_cvt_pk_bf16_f32 v91, v150, v151
v_cvt_pk_bf16_f32 v92, v152, v153
v_cvt_pk_bf16_f32 v93, v154, v155
v_cvt_pk_bf16_f32 v94, v156, v157
v_cvt_pk_bf16_f32 v95, v158, v159
v_mfma_f32_16x16x32_bf16 v[164:167], v[192:195], v[80:83], 0
v_mfma_f32_16x16x32_bf16 v[160:163], v[208:211], v[80:83], 0
v_mfma_f32_16x16x32_bf16 v[172:175], v[196:199], v[84:87], 0
v_mfma_f32_16x16x32_bf16 v[168:171], v[212:215], v[84:87], 0
v_mfma_f32_16x16x32_bf16 v[180:183], v[200:203], v[88:91], 0
v_mfma_f32_16x16x32_bf16 v[176:179], v[192:195], v[88:91], 0
v_mfma_f32_16x16x32_bf16 v[188:191], v[204:207], v[92:95], 0
v_mfma_f32_16x16x32_bf16 v[184:187], v[196:199], v[92:95], 0
s_waitcnt lgkmcnt(0)
s_cmp_lt_u32 s87, s99
s_cbranch_scc1 pl_2_slow
pl_2_ok:
s_mov_b32 m0, s68
s_nop 0
buffer_load_dwordx4 v68, s[60:63], 0 offen offset:2048 sc1 lds
buffer_load_dwordx4 v68, s[60:63], 0 offen offset:3072 sc1 lds
s_mov_b32 s78, 0x3e8293ee
s_mov_b32 s79, 0x3e8293ee
v_mov_b32 v2, 0xf149f2ca
v_pk_mul_f32 v[160:161], v[160:161], s[78:79]
v_pk_mul_f32 v[162:163], v[162:163], s[78:79]
v_pk_mul_f32 v[164:165], v[164:165], s[78:79]
v_pk_mul_f32 v[166:167], v[166:167], s[78:79]
v_pk_mul_f32 v[168:169], v[168:169], s[78:79]
v_pk_mul_f32 v[170:171], v[170:171], s[78:79]
v_pk_mul_f32 v[172:173], v[172:173], s[78:79]
v_pk_mul_f32 v[174:175], v[174:175], s[78:79]
v_pk_mul_f32 v[176:177], v[176:177], s[78:79]
v_pk_mul_f32 v[178:179], v[178:179], s[78:79]
v_pk_mul_f32 v[180:181], v[180:181], s[78:79]
v_pk_mul_f32 v[182:183], v[182:183], s[78:79]
v_pk_mul_f32 v[184:185], v[184:185], s[78:79]
v_pk_mul_f32 v[186:187], v[186:187], s[78:79]
v_pk_mul_f32 v[188:189], v[188:189], s[78:79]
v_pk_mul_f32 v[190:191], v[190:191], s[78:79]
v_cndmask_b32 v160, v2, v160, s[20:21]
v_cndmask_b32 v164, v2, v164, s[12:13]
v_cndmask_b32 v161, v2, v161, s[22:23]
v_cndmask_b32 v165, v2, v165, s[14:15]
v_cndmask_b32 v162, v2, v162, s[24:25]
v_cndmask_b32 v166, v2, v166, s[16:17]
v_cndmask_b32 v163, v2, v163, s[26:27]
v_cndmask_b32 v167, v2, v167, s[18:19]
v_cndmask_b32 v168, v2, v168, s[20:21]
v_cndmask_b32 v172, v2, v172, s[12:13]
v_cndmask_b32 v169, v2, v169, s[22:23]
v_cndmask_b32 v173, v2, v173, s[14:15]
v_cndmask_b32 v170, v2, v170, s[24:25]
v_cndmask_b32 v174, v2, v174, s[16:17]
v_cndmask_b32 v171, v2, v171, s[26:27]
v_cndmask_b32 v175, v2, v175, s[18:19]
v_cndmask_b32 v176, v2, v176, s[4:5]
v_cndmask_b32 v180, v2, v180, s[12:13]
v_cndmask_b32 v177, v2, v177, s[6:7]
v_cndmask_b32 v181, v2, v181, s[14:15]
v_cndmask_b32 v178, v2, v178, s[8:9]
v_cndmask_b32 v182, v2, v182, s[16:17]
v_cndmask_b32 v179, v2, v179, s[10:11]
v_cndmask_b32 v183, v2, v183, s[18:19]
v_cndmask_b32 v184, v2, v184, s[4:5]
v_cndmask_b32 v188, v2, v188, s[12:13]
v_cndmask_b32 v185, v2, v185, s[6:7]
v_cndmask_b32 v189, v2, v189, s[14:15]
v_cndmask_b32 v186, v2, v186, s[8:9]
v_cndmask_b32 v190, v2, v190, s[16:17]
v_cndmask_b32 v187, v2, v187, s[10:11]
v_cndmask_b32 v191, v2, v191, s[18:19]
s_cmp_lg_u32 s72, 1
s_cbranch_scc1 h0b_noi
s_mov_b32 s4, 0
s_atomic_add s4, s[60:61], s100 offset:16384 glc
s_mov_b32 s5, 0
s_atomic_add s5, s[60:61], s100 offset:18432 glc
s_mov_b32 s6, 0
s_atomic_add s6, s[60:61], s100 offset:20480 glc
s_mov_b32 s7, 0
s_atomic_add s7, s[60:61], s100 offset:22528 glc
s_mov_b32 s8, 0
s_atomic_add s8, s[60:61], s100 offset:24576 glc
s_mov_b32 s9, 0
s_atomic_add s9, s[60:61], s100 offset:26624 glc
s_mov_b32 s10, 0
s_atomic_add s10, s[60:61], s100 offset:28672 glc
s_mov_b32 s11, 0
s_atomic_add s11, s[60:61], s100 offset:30720 glc
h0b_noi:
v_max3_f32 v112, v160, v161, v162
v_max3_f32 v116, v163, v164, v165
v_max3_f32 v113, v168, v169, v170
v_max3_f32 v117, v171, v172, v173
v_max3_f32 v114, v176, v177, v178
v_max3_f32 v118, v179, v180, v181
v_max3_f32 v115, v184, v185, v186
v_max3_f32 v119, v187, v188, v189
v_max3_f32 v112, v112, v166, v167
v_max3_f32 v113, v113, v174, v175
v_max3_f32 v114, v114, v182, v183
v_max3_f32 v115, v115, v190, v191
v_max_f32 v112, v112, v116
v_max_f32 v113, v113, v117
v_max_f32 v114, v114, v118
v_max_f32 v115, v115, v119
v_mov_b32 v116, v112
v_mov_b32 v117, v113
v_mov_b32 v118, v114
v_mov_b32 v119, v115
v_permlane32_swap_b32 v112, v116
v_permlane32_swap_b32 v113, v117
v_permlane32_swap_b32 v114, v118
v_permlane32_swap_b32 v115, v119
v_max_f32 v112, v112, v116
v_max_f32 v113, v113, v117
v_max_f32 v114, v114, v118
v_max_f32 v115, v115, v119
v_mov_b32 v116, v112
v_mov_b32 v117, v113
v_mov_b32 v118, v114
v_mov_b32 v119, v115
v_permlane16_swap_b32 v112, v116
v_permlane16_swap_b32 v113, v117
v_permlane16_swap_b32 v114, v118
v_permlane16_swap_b32 v115, v119
v_max_f32 v112, v112, v116
v_max_f32 v113, v113, v117
v_max_f32 v114, v114, v118
v_max_f32 v115, v115, v119
v_sub_f32 v160, v160, v112
v_sub_f32 v161, v161, v112
v_sub_f32 v162, v162, v112
v_sub_f32 v163, v163, v112
v_sub_f32 v164, v164, v112
v_sub_f32 v165, v165, v112
v_sub_f32 v166, v166, v112
v_sub_f32 v167, v167, v112
v_sub_f32 v168, v168, v113
v_sub_f32 v169, v169, v113
v_sub_f32 v170, v170, v113
v_sub_f32 v171, v171, v113
v_sub_f32 v172, v172, v113
v_sub_f32 v173, v173, v113
v_sub_f32 v174, v174, v113
v_sub_f32 v175, v175, v113
v_sub_f32 v176, v176, v114
v_sub_f32 v177, v177, v114
v_sub_f32 v178, v178, v114
v_sub_f32 v179, v179, v114
v_sub_f32 v180, v180, v114
v_sub_f32 v181, v181, v114
v_sub_f32 v182, v182, v114
v_sub_f32 v183, v183, v114
v_sub_f32 v184, v184, v115
v_sub_f32 v185, v185, v115
v_sub_f32 v186, v186, v115
v_sub_f32 v187, v187, v115
v_sub_f32 v188, v188, v115
v_sub_f32 v189, v189, v115
v_sub_f32 v190, v190, v115
v_sub_f32 v191, v191, v115
v_exp_f32 v160, v160
v_exp_f32 v161, v161
v_exp_f32 v162, v162
v_exp_f32 v163, v163
v_exp_f32 v164, v164
v_exp_f32 v165, v165
v_exp_f32 v166, v166
v_exp_f32 v167, v167
v_exp_f32 v168, v168
v_exp_f32 v169, v169
v_exp_f32 v170, v170
v_exp_f32 v171, v171
v_exp_f32 v172, v172
v_exp_f32 v173, v173
v_exp_f32 v174, v174
v_exp_f32 v175, v175
v_exp_f32 v176, v176
v_exp_f32 v177, v177
v_exp_f32 v178, v178
v_exp_f32 v179, v179
v_exp_f32 v180, v180
v_exp_f32 v181, v181
v_exp_f32 v182, v182
v_exp_f32 v183, v183
v_exp_f32 v184, v184
v_exp_f32 v185, v185
v_exp_f32 v186, v186
v_exp_f32 v187, v187
v_exp_f32 v188, v188
v_exp_f32 v189, v189
v_exp_f32 v190, v190
v_exp_f32 v191, v191
s_waitcnt vmcnt(0)
ds_read_b64 v[224:225], v75 offset:2048
ds_read_b64 v[230:231], v75 offset:2560
ds_read_b64 v[236:237], v75 offset:3072
ds_read_b64 v[242:243], v75 offset:3584
v_pk_add_f32 v[120:121], v[160:161], v[162:163]
v_pk_add_f32 v[122:123], v[168:169], v[170:171]
v_pk_add_f32 v[124:125], v[176:177], v[178:179]
v_pk_add_f32 v[126:127], v[184:185], v[186:187]
v_pk_add_f32 v[120:121], v[120:121], v[164:165]
v_pk_add_f32 v[122:123], v[122:123], v[172:173]
v_pk_add_f32 v[124:125], v[124:125], v[180:181]
v_pk_add_f32 v[126:127], v[126:127], v[188:189]
v_pk_add_f32 v[120:121], v[120:121], v[166:167]
v_pk_add_f32 v[122:123], v[122:123], v[174:175]
v_pk_add_f32 v[124:125], v[124:125], v[182:183]
v_pk_add_f32 v[126:127], v[126:127], v[190:191]
v_add_f32 v120, v120, v121
v_add_f32 v122, v122, v123
v_add_f32 v124, v124, v125
v_add_f32 v126, v126, v127
v_mov_b32 v116, v120
v_mov_b32 v117, v122
v_mov_b32 v118, v124
v_mov_b32 v119, v126
v_permlane32_swap_b32 v120, v116
v_permlane32_swap_b32 v122, v117
v_permlane32_swap_b32 v124, v118
v_permlane32_swap_b32 v126, v119
v_add_f32 v120, v120, v116
v_add_f32 v122, v122, v117
v_add_f32 v124, v124, v118
v_add_f32 v126, v126, v119
v_mov_b32 v116, v120
v_mov_b32 v117, v122
v_mov_b32 v118, v124
v_mov_b32 v119, v126
v_permlane16_swap_b32 v120, v116
v_permlane16_swap_b32 v122, v117
v_permlane16_swap_b32 v124, v118
v_permlane16_swap_b32 v126, v119
v_add_f32 v120, v120, v116
v_add_f32 v122, v122, v117
v_add_f32 v124, v124, v118
v_add_f32 v126, v126, v119
v_rcp_f32 v120, v120
v_rcp_f32 v122, v122
v_rcp_f32 v124, v124
v_rcp_f32 v126, v126
v_mov_b32 v121, v120
v_mov_b32 v123, v122
v_mov_b32 v125, v124
v_mov_b32 v127, v126
v_pk_mul_f32 v[160:161], v[160:161], v[120:121]
v_pk_mul_f32 v[162:163], v[162:163], v[120:121]
v_pk_mul_f32 v[164:165], v[164:165], v[120:121]
v_pk_mul_f32 v[166:167], v[166:167], v[120:121]
v_pk_mul_f32 v[168:169], v[168:169], v[122:123]
v_pk_mul_f32 v[170:171], v[170:171], v[122:123]
v_pk_mul_f32 v[172:173], v[172:173], v[122:123]
v_pk_mul_f32 v[174:175], v[174:175], v[122:123]
v_pk_mul_f32 v[176:177], v[176:177], v[124:125]
v_pk_mul_f32 v[178:179], v[178:179], v[124:125]
v_pk_mul_f32 v[180:181], v[180:181], v[124:125]
v_pk_mul_f32 v[182:183], v[182:183], v[124:125]
v_pk_mul_f32 v[184:185], v[184:185], v[126:127]
v_pk_mul_f32 v[186:187], v[186:187], v[126:127]
v_pk_mul_f32 v[188:189], v[188:189], v[126:127]
v_pk_mul_f32 v[190:191], v[190:191], v[126:127]
v_cvt_pk_bf16_f32 v96, v160, v161
v_cvt_pk_bf16_f32 v97, v162, v163
v_cvt_pk_bf16_f32 v98, v164, v165
v_cvt_pk_bf16_f32 v99, v166, v167
v_cvt_pk_bf16_f32 v100, v168, v169
v_cvt_pk_bf16_f32 v101, v170, v171
v_cvt_pk_bf16_f32 v102, v172, v173
v_cvt_pk_bf16_f32 v103, v174, v175
v_cvt_pk_bf16_f32 v104, v176, v177
v_cvt_pk_bf16_f32 v105, v178, v179
v_cvt_pk_bf16_f32 v106, v180, v181
v_cvt_pk_bf16_f32 v107, v182, v183
v_cvt_pk_bf16_f32 v108, v184, v185
v_cvt_pk_bf16_f32 v109, v186, v187
v_cvt_pk_bf16_f32 v110, v188, v189
v_cvt_pk_bf16_f32 v111, v190, v191
s_waitcnt lgkmcnt(3)
v_mfma_f32_16x16x32_bf16 v[128:131], v[224:227], v[96:99], 0
s_waitcnt lgkmcnt(2)
v_mfma_f32_16x16x32_bf16 v[132:135], v[230:233], v[96:99], 0
s_waitcnt lgkmcnt(1)
v_mfma_f32_16x16x32_bf16 v[136:139], v[236:239], v[100:103], 0
s_waitcnt lgkmcnt(0)
v_mfma_f32_16x16x32_bf16 v[140:143], v[242:245], v[100:103], 0
v_mfma_f32_16x16x32_bf16 v[144:147], v[226:229], v[104:107], 0
v_mfma_f32_16x16x32_bf16 v[148:151], v[232:235], v[104:107], 0
v_mfma_f32_16x16x32_bf16 v[152:155], v[238:241], v[108:111], 0
v_mfma_f32_16x16x32_bf16 v[156:159], v[244:247], v[108:111], 0
s_lshl_b32 s78, s74, 12
s_add_u32 s78, s78, s88
s_add_u32 s91, s78, 0x200000
v_cvt_pk_bf16_f32 v80, v128, v129
v_cvt_pk_bf16_f32 v81, v130, v131
v_cvt_pk_bf16_f32 v82, v132, v133
v_cvt_pk_bf16_f32 v83, v134, v135
buffer_store_dwordx4 v[80:83], v46, s[60:63], s91 offen offset:0 sc1
v_cvt_pk_bf16_f32 v84, v136, v137
v_cvt_pk_bf16_f32 v85, v138, v139
v_cvt_pk_bf16_f32 v86, v140, v141
v_cvt_pk_bf16_f32 v87, v142, v143
buffer_store_dwordx4 v[84:87], v46, s[60:63], s91 offen offset:2048 sc1
v_cvt_pk_bf16_f32 v88, v144, v145
v_cvt_pk_bf16_f32 v89, v146, v147
v_cvt_pk_bf16_f32 v90, v148, v149
v_cvt_pk_bf16_f32 v91, v150, v151
buffer_store_dwordx4 v[88:91], v46, s[60:63], s91 offen offset:1024 sc1
v_cvt_pk_bf16_f32 v92, v152, v153
v_cvt_pk_bf16_f32 v93, v154, v155
v_cvt_pk_bf16_f32 v94, v156, v157
v_cvt_pk_bf16_f32 v95, v158, v159
buffer_store_dwordx4 v[92:95], v46, s[60:63], s91 offen offset:3072 sc1
s_cmp_lg_u32 s72, 1
s_cbranch_scc1 h0b_done
s_mov_b32 s81, 0
h0b_loop:
s_min_u32 s4, s4, s5
s_min_u32 s4, s4, s6
s_min_u32 s4, s4, s7
s_min_u32 s4, s4, s8
s_min_u32 s4, s4, s9
s_min_u32 s4, s4, s10
s_min_u32 s4, s4, s11
s_cmp_ge_u32 s4, 32
s_cbranch_scc1 h0b_done
s_mov_b32 s4, 0
s_atomic_add s4, s[60:61], s100 offset:16384 glc
s_mov_b32 s5, 0
s_atomic_add s5, s[60:61], s100 offset:18432 glc
s_mov_b32 s6, 0
s_atomic_add s6, s[60:61], s100 offset:20480 glc
s_mov_b32 s7, 0
s_atomic_add s7, s[60:61], s100 offset:22528 glc
s_mov_b32 s8, 0
s_atomic_add s8, s[60:61], s100 offset:24576 glc
s_mov_b32 s9, 0
s_atomic_add s9, s[60:61], s100 offset:26624 glc
s_mov_b32 s10, 0
s_atomic_add s10, s[60:61], s100 offset:28672 glc
s_mov_b32 s11, 0
s_atomic_add s11, s[60:61], s100 offset:30720 glc
s_add_u32 s81, s81, 1
s_cmp_lt_u32 s81, 0x400000
s_waitcnt lgkmcnt(0)
s_cbranch_scc1 h0b_loop
h0b_done:
s_barrier
v_lshlrev_b32 v2, 4, v0
s_mov_b32 s78, 0x91000
buffer_load_dwordx4 v[128:131], v2, s[60:63], s78 offen sc1
s_mov_b32 s78, 0x95000
buffer_load_dwordx4 v[132:135], v2, s[60:63], s78 offen sc1
s_mov_b32 s78, 0x99000
buffer_load_dwordx4 v[136:139], v2, s[60:63], s78 offen sc1
s_mov_b32 s78, 0x9d000
buffer_load_dwordx4 v[140:143], v2, s[60:63], s78 offen sc1
s_mov_b32 s78, 0x92000
buffer_load_dwordx4 v[144:147], v2, s[60:63], s78 offen sc1
s_mov_b32 s78, 0x96000
buffer_load_dwordx4 v[148:151], v2, s[60:63], s78 offen sc1
s_mov_b32 s78, 0x9a000
buffer_load_dwordx4 v[152:155], v2, s[60:63], s78 offen sc1
s_mov_b32 s78, 0x9e000
buffer_load_dwordx4 v[156:159], v2, s[60:63], s78 offen sc1
s_lshl_b32 s78, s75, 8
v_and_b32 v7, 15, v1
v_lshl_add_u32 v7, v7, 4, s78
v_bfe_u32 v6, v1, 4, 1
v_mul_u32_u24 v6, 12288, v6
v_add_u32 v7, v7, v6
s_mov_b32 s78, 0x90000
buffer_load_dwordx4 v[192:195], v7, s[60:63], s78 offen sc1
s_mov_b32 s78, 0x94000
buffer_load_dwordx4 v[196:199], v7, s[60:63], s78 offen sc1
s_mov_b32 s78, 0x98000
buffer_load_dwordx4 v[200:203], v7, s[60:63], s78 offen sc1
s_mov_b32 s78, 0x9c000
buffer_load_dwordx4 v[204:207], v7, s[60:63], s78 offen sc1
ds_read_b64_tr_b16 v[112:113], v10 offset:32768
ds_read_b64_tr_b16 v[114:115], v10 offset:49152
ds_read_b64_tr_b16 v[116:117], v11 offset:32768
ds_read_b64_tr_b16 v[118:119], v11 offset:49152
ds_read_b64_tr_b16 v[120:121], v12 offset:32768
ds_read_b64_tr_b16 v[122:123], v12 offset:49152
ds_read_b64_tr_b16 v[124:125], v13 offset:32768
ds_read_b64_tr_b16 v[126:127], v13 offset:49152
ds_read_b64_tr_b16 v[80:81], v10 offset:33792
ds_read_b64_tr_b16 v[82:83], v10 offset:50176
ds_read_b64_tr_b16 v[84:85], v11 offset:33792
ds_read_b64_tr_b16 v[86:87], v11 offset:50176
ds_read_b64_tr_b16 v[88:89], v12 offset:33792
ds_read_b64_tr_b16 v[90:91], v12 offset:50176
ds_read_b64_tr_b16 v[92:93], v13 offset:33792
ds_read_b64_tr_b16 v[94:95], v13 offset:50176
s_waitcnt vmcnt(12)
s_atomic_add s69, s[60:61], s90
v_lshrrev_b32 v2, 3, v0
v_and_b32 v3, 3, v0
v_bfe_u32 v4, v0, 2, 1
v_mul_u32_u24 v5, 272, v2
v_lshl_add_u32 v5, v3, 6, v5
v_add_u32 v5, 131072, v5
v_mul_u32_u24 v6, 16392, v4
v_add_u32 v6, v5, v6
v_xor_b32 v5, 8, v6
v_mov_b32 v161, 0
v_mov_b32 v163, 0
v_mov_b32 v164, 0
v_mov_b32 v166, 0
s_waitcnt vmcnt(10)
v_pk_add_f32 v[128:129], v[128:129], v[132:133]
s_waitcnt vmcnt(8)
v_pk_add_f32 v[136:137], v[136:137], v[140:141]
v_pk_add_f32 v[130:131], v[130:131], v[134:135]
v_pk_add_f32 v[138:139], v[138:139], v[142:143]
v_pk_add_f32 v[128:129], v[128:129], v[136:137]
v_pk_add_f32 v[130:131], v[130:131], v[138:139]
s_waitcnt vmcnt(6)
v_pk_add_f32 v[144:145], v[144:145], v[148:149]
s_waitcnt vmcnt(4)
v_pk_add_f32 v[152:153], v[152:153], v[156:157]
v_pk_add_f32 v[146:147], v[146:147], v[150:151]
v_pk_add_f32 v[154:155], v[154:155], v[158:159]
v_pk_add_f32 v[144:145], v[144:145], v[152:153]
v_pk_add_f32 v[146:147], v[146:147], v[154:155]
v_cvt_pk_bf16_f32 v148, v144, v145
v_cvt_pk_bf16_f32 v150, v146, v147
v_lshlrev_b32 v144, 16, v148
v_and_b32 v145, 0xffff0000, v148
v_lshlrev_b32 v146, 16, v150
v_and_b32 v147, 0xffff0000, v150
v_add_f32 v144, 1.0, v144
v_add_f32 v145, 1.0, v145
v_add_f32 v146, 1.0, v146
v_add_f32 v147, 1.0, v147
v_cvt_pk_bf16_f32 v168, v128, v144
v_cvt_pk_bf16_f32 v169, v129, v145
v_cvt_pk_bf16_f32 v170, v130, v146
v_cvt_pk_bf16_f32 v171, v131, v147
v_lshrrev_b32 v160, 16, v168
v_and_b32 v162, 0xffff0000, v169
v_lshrrev_b32 v165, 16, v170
v_and_b32 v167, 0xffff0000, v171
ds_write_b64 v5, v[160:161] offset:0
ds_write_b64 v5, v[162:163] offset:16
ds_write_b64 v5, v[164:165] offset:32
ds_write_b64 v5, v[166:167] offset:48
ds_write2_b32 v6, v168, v161 offset0:0 offset1:1
ds_write2_b32 v6, v169, v161 offset0:4 offset1:5
ds_write2_b32 v6, v170, v161 offset0:8 offset1:9
ds_write2_b32 v6, v171, v161 offset0:12 offset1:13
s_waitcnt vmcnt(2)
v_pk_add_f32 v[192:193], v[192:193], v[196:197]
s_waitcnt vmcnt(0)
v_pk_add_f32 v[200:201], v[200:201], v[204:205]
v_pk_add_f32 v[194:195], v[194:195], v[198:199]
v_pk_add_f32 v[202:203], v[202:203], v[206:207]
v_pk_add_f32 v[192:193], v[192:193], v[200:201]
v_pk_add_f32 v[194:195], v[194:195], v[202:203]
v_cvt_pk_bf16_f32 v196, v192, v193
v_cvt_pk_bf16_f32 v198, v194, v195
v_lshlrev_b32 v192, 16, v196
v_and_b32 v193, 0xffff0000, v196
v_lshlrev_b32 v194, 16, v198
v_and_b32 v195, 0xffff0000, v198
v_and_b32 v7, 0x1f0, v46
v_add_u32 v7, 144384, v7
ds_write_b128 v7, v[192:195]
s_mov_b32 s87, 0
s_atomic_add s87, s[60:61], s90 glc
v_and_b32 v56, 48, v1
v_add_u32 v56, 144384, v56
v_lshlrev_b32 v160, 16, v216
v_and_b32 v161, 0xffff0000, v216
v_lshlrev_b32 v162, 16, v217
v_and_b32 v163, 0xffff0000, v217
v_lshlrev_b32 v164, 16, v218
v_and_b32 v165, 0xffff0000, v218
v_lshlrev_b32 v166, 16, v219
v_and_b32 v167, 0xffff0000, v219
v_lshlrev_b32 v168, 16, v220
v_and_b32 v169, 0xffff0000, v220
v_lshlrev_b32 v170, 16, v221
v_and_b32 v171, 0xffff0000, v221
v_lshlrev_b32 v172, 16, v222
v_and_b32 v173, 0xffff0000, v222
v_lshlrev_b32 v174, 16, v223
v_and_b32 v175, 0xffff0000, v223
v_lshlrev_b32 v176, 16, v248
v_and_b32 v177, 0xffff0000, v248
v_lshlrev_b32 v178, 16, v249
v_and_b32 v179, 0xffff0000, v249
v_lshlrev_b32 v180, 16, v250
v_and_b32 v181, 0xffff0000, v250
v_lshlrev_b32 v182, 16, v251
v_and_b32 v183, 0xffff0000, v251
v_lshlrev_b32 v184, 16, v252
v_and_b32 v185, 0xffff0000, v252
v_lshlrev_b32 v186, 16, v253
v_and_b32 v187, 0xffff0000, v253
v_lshlrev_b32 v188, 16, v254
v_and_b32 v189, 0xffff0000, v254
v_lshlrev_b32 v190, 16, v255
v_and_b32 v191, 0xffff0000, v255
s_waitcnt lgkmcnt(0)
s_cmp_lt_u32 s87, 16
s_cbranch_scc1 pl_3_slow
pl_3_ok:
s_add_u32 s91, s88, 0x200000
buffer_load_dwordx4 a[0:3], v46, s[60:63], s91 offen offset:0 sc1
buffer_load_dwordx4 a[4:7], v46, s[60:63], s91 offen offset:1024 sc1
buffer_load_dwordx4 a[8:11], v46, s[60:63], s91 offen offset:2048 sc1
buffer_load_dwordx4 a[12:15], v46, s[60:63], s91 offen offset:3072 sc1
s_add_u32 s91, s88, 0x201000
buffer_load_dwordx4 a[16:19], v46, s[60:63], s91 offen offset:0 sc1
buffer_load_dwordx4 a[20:23], v46, s[60:63], s91 offen offset:1024 sc1
buffer_load_dwordx4 a[24:27], v46, s[60:63], s91 offen offset:2048 sc1
buffer_load_dwordx4 a[28:31], v46, s[60:63], s91 offen offset:3072 sc1
s_add_u32 s91, s88, 0x202000
buffer_load_dwordx4 a[32:35], v46, s[60:63], s91 offen offset:0 sc1
buffer_load_dwordx4 a[36:39], v46, s[60:63], s91 offen offset:1024 sc1
buffer_load_dwordx4 a[40:43], v46, s[60:63], s91 offen offset:2048 sc1
buffer_load_dwordx4 a[44:47], v46, s[60:63], s91 offen offset:3072 sc1
s_add_u32 s91, s88, 0x203000
buffer_load_dwordx4 a[48:51], v46, s[60:63], s91 offen offset:0 sc1
buffer_load_dwordx4 a[52:55], v46, s[60:63], s91 offen offset:1024 sc1
buffer_load_dwordx4 a[56:59], v46, s[60:63], s91 offen offset:2048 sc1
buffer_load_dwordx4 a[60:63], v46, s[60:63], s91 offen offset:3072 sc1
ds_read_b128 v[192:195], v56 offset:0
ds_read_b128 v[196:199], v56 offset:64
ds_read_b128 v[200:203], v56 offset:128
ds_read_b128 v[204:207], v56 offset:192
S_O:
s_waitcnt vmcnt(15)
v_mfma_f32_16x16x32_bf16 v[128:131], v[112:115], a[0:3], 0
ds_read_b64_tr_b16 v[96:97], v10 offset:34816
s_waitcnt vmcnt(14)
v_mfma_f32_16x16x32_bf16 v[144:147], v[112:115], a[4:7], 0
ds_read_b64_tr_b16 v[98:99], v10 offset:51200
ds_read_b64_tr_b16 v[100:101], v11 offset:34816
v_mfma_f32_16x16x32_bf16 v[132:135], v[116:119], a[0:3], 0
s_add_u32 s91, s88, 0x204000
buffer_load_dwordx4 a[64:67], v46, s[60:63], s91 offen offset:0 sc1
v_mfma_f32_16x16x32_bf16 v[148:151], v[116:119], a[4:7], 0
ds_read_b64_tr_b16 v[102:103], v11 offset:51200
ds_read_b64_tr_b16 v[104:105], v12 offset:34816
v_mfma_f32_16x16x32_bf16 v[136:139], v[120:123], a[0:3], 0
ds_read_b64_tr_b16 v[106:107], v12 offset:51200
v_mov_b32 v208, 0x3f803f80
v_mfma_f32_16x16x32_bf16 v[152:155], v[120:123], a[4:7], 0
buffer_load_dwordx4 a[68:71], v46, s[60:63], s91 offen offset:1024 sc1
v_mfma_f32_16x16x32_bf16 v[140:143], v[124:127], a[0:3], 0
ds_read_b64_tr_b16 v[108:109], v13 offset:34816
ds_read_b64_tr_b16 v[110:111], v13 offset:51200
v_mfma_f32_16x16x32_bf16 v[156:159], v[124:127], a[4:7], 0
ds_read_b64_tr_b16 v[112:113], v10 offset:35840
s_waitcnt vmcnt(15)
v_mfma_f32_16x16x32_bf16 v[128:131], v[80:83], a[8:11], v[128:131]
ds_read_b64_tr_b16 v[114:115], v10 offset:52224
s_waitcnt vmcnt(14)
v_mfma_f32_16x16x32_bf16 v[144:147], v[80:83], a[12:15], v[144:147]
buffer_load_dwordx4 a[72:75], v46, s[60:63], s91 offen offset:2048 sc1
v_mfma_f32_16x16x32_bf16 v[132:135], v[84:87], a[8:11], v[132:135]
ds_read_b64_tr_b16 v[116:117], v11 offset:35840
ds_read_b64_tr_b16 v[118:119], v11 offset:52224
v_mfma_f32_16x16x32_bf16 v[148:151], v[84:87], a[12:15], v[148:151]
ds_read_b64_tr_b16 v[120:121], v12 offset:35840
v_mov_b32 v209, 0x3f803f80
v_mfma_f32_16x16x32_bf16 v[136:139], v[88:91], a[8:11], v[136:139]
ds_read_b64_tr_b16 v[122:123], v12 offset:52224
ds_read_b64_tr_b16 v[124:125], v13 offset:35840
v_mfma_f32_16x16x32_bf16 v[152:155], v[88:91], a[12:15], v[152:155]
buffer_load_dwordx4 a[76:79], v46, s[60:63], s91 offen offset:3072 sc1
v_mfma_f32_16x16x32_bf16 v[140:143], v[92:95], a[8:11], v[140:143]
ds_read_b64_tr_b16 v[126:127], v13 offset:52224
ds_read_b64_tr_b16 v[80:81], v10 offset:36864
v_mfma_f32_16x16x32_bf16 v[156:159], v[92:95], a[12:15], v[156:159]
ds_read_b64_tr_b16 v[82:83], v10 offset:53248
s_waitcnt vmcnt(15) lgkmcnt(8)
v_mfma_f32_16x16x32_bf16 v[128:131], v[96:99], a[16:19], v[128:131]
ds_read_b64_tr_b16 v[84:85], v11 offset:36864
s_waitcnt vmcnt(14)
v_mfma_f32_16x16x32_bf16 v[144:147], v[96:99], a[20:23], v[144:147]
s_add_u32 s91, s88, 0x205000
buffer_load_dwordx4 a[80:83], v46, s[60:63], s91 offen offset:0 sc1
v_mfma_f32_16x16x32_bf16 v[132:135], v[100:103], a[16:19], v[132:135]
ds_read_b64_tr_b16 v[86:87], v11 offset:53248
ds_read_b64_tr_b16 v[88:89], v12 offset:36864
v_mfma_f32_16x16x32_bf16 v[148:151], v[100:103], a[20:23], v[148:151]
ds_read_b64_tr_b16 v[90:91], v12 offset:53248
v_mov_b32 v210, 0x3f803f80
v_mfma_f32_16x16x32_bf16 v[136:139], v[104:107], a[16:19], v[136:139]
ds_read_b64_tr_b16 v[92:93], v13 offset:36864
ds_read_b64_tr_b16 v[94:95], v13 offset:53248
v_mfma_f32_16x16x32_bf16 v[152:155], v[104:107], a[20:23], v[152:155]
buffer_load_dwordx4 a[84:87], v46, s[60:63], s91 offen offset:1024 sc1
v_mfma_f32_16x16x32_bf16 v[140:143], v[108:111], a[16:19], v[140:143]
ds_read_b64_tr_b16 v[96:97], v10 offset:37888
ds_read_b64_tr_b16 v[98:99], v10 offset:54272
v_mfma_f32_16x16x32_bf16 v[156:159], v[108:111], a[20:23], v[156:159]
ds_read_b64_tr_b16 v[100:101], v11 offset:37888
s_waitcnt vmcnt(15)
v_mfma_f32_16x16x32_bf16 v[128:131], v[112:115], a[24:27], v[128:131]
ds_read_b64_tr_b16 v[102:103], v11 offset:54272
s_waitcnt vmcnt(14)
v_mfma_f32_16x16x32_bf16 v[144:147], v[112:115], a[28:31], v[144:147]
ds_read_b64_tr_b16 v[104:105], v12 offset:37888
s_waitcnt lgkmcnt(7)
v_mfma_f32_16x16x32_bf16 v[132:135], v[116:119], a[24:27], v[132:135]
buffer_load_dwordx4 a[88:91], v46, s[60:63], s91 offen offset:2048 sc1
v_mfma_f32_16x16x32_bf16 v[148:151], v[116:119], a[28:31], v[148:151]
ds_read_b64_tr_b16 v[106:107], v12 offset:54272
ds_read_b64_tr_b16 v[108:109], v13 offset:37888
v_mfma_f32_16x16x32_bf16 v[136:139], v[120:123], a[24:27], v[136:139]
ds_read_b64_tr_b16 v[110:111], v13 offset:54272
v_mov_b32 v211, 0x3f803f80
v_mfma_f32_16x16x32_bf16 v[152:155], v[120:123], a[28:31], v[152:155]
buffer_load_dwordx4 a[92:95], v46, s[60:63], s91 offen offset:3072 sc1
v_mfma_f32_16x16x32_bf16 v[140:143], v[124:127], a[24:27], v[140:143]
ds_read_b64_tr_b16 v[112:113], v10 offset:38912
ds_read_b64_tr_b16 v[114:115], v10 offset:55296
v_mfma_f32_16x16x32_bf16 v[156:159], v[124:127], a[28:31], v[156:159]
ds_read_b64_tr_b16 v[116:117], v11 offset:38912
s_waitcnt vmcnt(15)
v_mfma_f32_16x16x32_bf16 v[128:131], v[80:83], a[32:35], v[128:131]
ds_read_b64_tr_b16 v[118:119], v11 offset:55296
s_waitcnt vmcnt(14)
v_mfma_f32_16x16x32_bf16 v[144:147], v[80:83], a[36:39], v[144:147]
s_add_u32 s91, s88, 0x206000
buffer_load_dwordx4 a[96:99], v46, s[60:63], s91 offen offset:0 sc1
v_mfma_f32_16x16x32_bf16 v[132:135], v[84:87], a[32:35], v[132:135]
ds_read_b64_tr_b16 v[120:121], v12 offset:38912
ds_read_b64_tr_b16 v[122:123], v12 offset:55296
v_mfma_f32_16x16x32_bf16 v[148:151], v[84:87], a[36:39], v[148:151]
ds_read_b64_tr_b16 v[124:125], v13 offset:38912
v_and_b32 v2, 3, v1
v_mfma_f32_16x16x32_bf16 v[136:139], v[88:91], a[32:35], v[136:139]
ds_read_b64_tr_b16 v[126:127], v13 offset:55296
ds_read_b64_tr_b16 v[80:81], v10 offset:39936
v_mfma_f32_16x16x32_bf16 v[152:155], v[88:91], a[36:39], v[152:155]
ds_read_b64_tr_b16 v[82:83], v10 offset:56320
s_waitcnt lgkmcnt(7)
v_mfma_f32_16x16x32_bf16 v[140:143], v[92:95], a[32:35], v[140:143]
buffer_load_dwordx4 a[100:103], v46, s[60:63], s91 offen offset:1024 sc1
v_mfma_f32_16x16x32_bf16 v[156:159], v[92:95], a[36:39], v[156:159]
ds_read_b64_tr_b16 v[84:85], v11 offset:39936
s_waitcnt vmcnt(15)
v_mfma_f32_16x16x32_bf16 v[128:131], v[96:99], a[40:43], v[128:131]
ds_read_b64_tr_b16 v[86:87], v11 offset:56320
s_waitcnt vmcnt(14)
v_mfma_f32_16x16x32_bf16 v[144:147], v[96:99], a[44:47], v[144:147]
buffer_load_dwordx4 a[104:107], v46, s[60:63], s91 offen offset:2048 sc1
v_mfma_f32_16x16x32_bf16 v[132:135], v[100:103], a[40:43], v[132:135]
ds_read_b64_tr_b16 v[88:89], v12 offset:39936
ds_read_b64_tr_b16 v[90:91], v12 offset:56320
v_mfma_f32_16x16x32_bf16 v[148:151], v[100:103], a[44:47], v[148:151]
ds_read_b64_tr_b16 v[92:93], v13 offset:39936
v_cmp_eq_u32 s[4:5], 1, v2
v_mfma_f32_16x16x32_bf16 v[136:139], v[104:107], a[40:43], v[136:139]
ds_read_b64_tr_b16 v[94:95], v13 offset:56320
v_cmp_eq_u32 s[6:7], 2, v2
v_mfma_f32_16x16x32_bf16 v[152:155], v[104:107], a[44:47], v[152:155]
buffer_load_dwordx4 a[108:111], v46, s[60:63], s91 offen offset:3072 sc1
v_mfma_f32_16x16x32_bf16 v[140:143], v[108:111], a[40:43], v[140:143]
v_cmp_eq_u32 s[8:9], 3, v2
s_lshl_b32 s85, s74, 6
v_mfma_f32_16x16x32_bf16 v[156:159], v[108:111], a[44:47], v[156:159]
s_add_u32 s85, s85, 6144
s_waitcnt vmcnt(15)
v_mfma_f32_16x16x32_bf16 v[128:131], v[112:115], a[48:51], v[128:131]
s_lshl_b32 s78, s75, 12
s_waitcnt vmcnt(14)
v_mfma_f32_16x16x32_bf16 v[144:147], v[112:115], a[52:55], v[144:147]
s_waitcnt lgkmcnt(0)
s_barrier
v_mfma_f32_16x16x32_bf16 v[132:135], v[116:119], a[48:51], v[132:135]
ds_read_b64_tr_b16 v[96:97], v14 offset:0
ds_read_b64_tr_b16 v[98:99], v14 offset:16384
v_mfma_f32_16x16x32_bf16 v[148:151], v[116:119], a[52:55], v[148:151]
ds_read_b64_tr_b16 v[100:101], v15 offset:0
ds_read_b64_tr_b16 v[102:103], v15 offset:16384
v_mfma_f32_16x16x32_bf16 v[136:139], v[120:123], a[48:51], v[136:139]
ds_read_b64_tr_b16 v[104:105], v16 offset:0
s_add_u32 s78, s78, s88
v_mfma_f32_16x16x32_bf16 v[152:155], v[120:123], a[52:55], v[152:155]
ds_read_b64_tr_b16 v[106:107], v16 offset:16384
ds_read_b64_tr_b16 v[108:109], v17 offset:0
v_mfma_f32_16x16x32_bf16 v[140:143], v[124:127], a[48:51], v[140:143]
s_add_u32 s91, s88, 0x207000
buffer_load_dwordx4 a[112:115], v46, s[60:63], s91 offen offset:0 sc1
v_mfma_f32_16x16x32_bf16 v[156:159], v[124:127], a[52:55], v[156:159]
ds_read_b64_tr_b16 v[110:111], v17 offset:16384
s_waitcnt vmcnt(14)
v_mfma_f32_16x16x32_bf16 v[128:131], v[80:83], a[56:59], v[128:131]
ds_read_b64_tr_b16 v[112:113], v14 offset:1024
s_waitcnt vmcnt(13)
v_mfma_f32_16x16x32_bf16 v[144:147], v[80:83], a[60:63], v[144:147]
ds_read_b64_tr_b16 v[114:115], v14 offset:17408
ds_read_b64_tr_b16 v[116:117], v15 offset:1024
v_mfma_f32_16x16x32_bf16 v[132:135], v[84:87], a[56:59], v[132:135]
buffer_load_dwordx4 a[116:119], v46, s[60:63], s91 offen offset:1024 sc1
v_mfma_f32_16x16x32_bf16 v[148:151], v[84:87], a[60:63], v[148:151]
ds_read_b64_tr_b16 v[118:119], v15 offset:17408
ds_read_b64_tr_b16 v[120:121], v16 offset:1024
v_mfma_f32_16x16x32_bf16 v[136:139], v[88:91], a[56:59], v[136:139]
buffer_load_dwordx4 a[120:123], v46, s[60:63], s91 offen offset:2048 sc1
v_mfma_f32_16x16x32_bf16 v[152:155], v[88:91], a[60:63], v[152:155]
ds_read_b64_tr_b16 v[122:123], v16 offset:17408
ds_read_b64_tr_b16 v[124:125], v17 offset:1024
v_mfma_f32_16x16x32_bf16 v[140:143], v[92:95], a[56:59], v[140:143]
buffer_load_dwordx4 a[124:127], v46, s[60:63], s91 offen offset:3072 sc1
v_mfma_f32_16x16x32_bf16 v[156:159], v[92:95], a[60:63], v[156:159]
ds_read_b64_tr_b16 v[126:127], v17 offset:17408
s_waitcnt vmcnt(15) lgkmcnt(5)
v_mfma_f32_16x16x32_bf16 v[128:131], v[96:99], a[64:67], v[128:131]
ds_read_b64_tr_b16 v[80:81], v14 offset:2048
s_waitcnt vmcnt(14)
v_mfma_f32_16x16x32_bf16 v[144:147], v[96:99], a[68:71], v[144:147]
ds_read_b64_tr_b16 v[82:83], v14 offset:18432
ds_read_b64_tr_b16 v[84:85], v15 offset:2048
v_mfma_f32_16x16x32_bf16 v[132:135], v[100:103], a[64:67], v[132:135]
s_add_u32 s91, s88, 0x208000
buffer_load_dwordx4 a[128:131], v46, s[60:63], s91 offen offset:0 sc1
v_mfma_f32_16x16x32_bf16 v[148:151], v[100:103], a[68:71], v[148:151]
ds_read_b64_tr_b16 v[86:87], v15 offset:18432
ds_read_b64_tr_b16 v[88:89], v16 offset:2048
v_mfma_f32_16x16x32_bf16 v[136:139], v[104:107], a[64:67], v[136:139]
ds_read_b64_tr_b16 v[90:91], v16 offset:18432
s_add_u32 s27, s78, 0x600000
v_mfma_f32_16x16x32_bf16 v[152:155], v[104:107], a[68:71], v[152:155]
buffer_load_dwordx4 a[132:135], v46, s[60:63], s91 offen offset:1024 sc1
v_mfma_f32_16x16x32_bf16 v[140:143], v[108:111], a[64:67], v[140:143]
ds_read_b64_tr_b16 v[92:93], v17 offset:2048
ds_read_b64_tr_b16 v[94:95], v17 offset:18432
v_mfma_f32_16x16x32_bf16 v[156:159], v[108:111], a[68:71], v[156:159]
ds_read_b64_tr_b16 v[96:97], v14 offset:3072
s_waitcnt vmcnt(15)
v_mfma_f32_16x16x32_bf16 v[128:131], v[112:115], a[72:75], v[128:131]
ds_read_b64_tr_b16 v[98:99], v14 offset:19456
s_waitcnt vmcnt(14)
v_mfma_f32_16x16x32_bf16 v[144:147], v[112:115], a[76:79], v[144:147]
ds_read_b64_tr_b16 v[100:101], v15 offset:3072
s_waitcnt lgkmcnt(6)
v_mfma_f32_16x16x32_bf16 v[132:135], v[116:119], a[72:75], v[132:135]
buffer_load_dwordx4 a[136:139], v46, s[60:63], s91 offen offset:2048 sc1
v_mfma_f32_16x16x32_bf16 v[148:151], v[116:119], a[76:79], v[148:151]
ds_read_b64_tr_b16 v[102:103], v15 offset:19456
ds_read_b64_tr_b16 v[104:105], v16 offset:3072
v_mfma_f32_16x16x32_bf16 v[136:139], v[120:123], a[72:75], v[136:139]
ds_read_b64_tr_b16 v[106:107], v16 offset:19456
s_lshr_b32 s78, s78, 4
v_mfma_f32_16x16x32_bf16 v[152:155], v[120:123], a[76:79], v[152:155]
buffer_load_dwordx4 a[140:143], v46, s[60:63], s91 offen offset:3072 sc1
v_mfma_f32_16x16x32_bf16 v[140:143], v[124:127], a[72:75], v[140:143]
ds_read_b64_tr_b16 v[108:109], v17 offset:3072
ds_read_b64_tr_b16 v[110:111], v17 offset:19456
v_mfma_f32_16x16x32_bf16 v[156:159], v[124:127], a[76:79], v[156:159]
ds_read_b64_tr_b16 v[112:113], v14 offset:4096
s_waitcnt vmcnt(15)
v_mfma_f32_16x16x32_bf16 v[128:131], v[80:83], a[80:83], v[128:131]
ds_read_b64_tr_b16 v[114:115], v14 offset:20480
s_waitcnt vmcnt(14)
v_mfma_f32_16x16x32_bf16 v[144:147], v[80:83], a[84:87], v[144:147]
s_add_u32 s91, s88, 0x209000
buffer_load_dwordx4 a[144:147], v46, s[60:63], s91 offen offset:0 sc1
v_mfma_f32_16x16x32_bf16 v[132:135], v[84:87], a[80:83], v[132:135]
ds_read_b64_tr_b16 v[116:117], v15 offset:4096
ds_read_b64_tr_b16 v[118:119], v15 offset:20480
v_mfma_f32_16x16x32_bf16 v[148:151], v[84:87], a[84:87], v[148:151]
ds_read_b64_tr_b16 v[120:121], v16 offset:4096
s_waitcnt lgkmcnt(7)
v_mfma_f32_16x16x32_bf16 v[136:139], v[88:91], a[80:83], v[136:139]
ds_read_b64_tr_b16 v[122:123], v16 offset:20480
ds_read_b64_tr_b16 v[124:125], v17 offset:4096
v_mfma_f32_16x16x32_bf16 v[152:155], v[88:91], a[84:87], v[152:155]
buffer_load_dwordx4 a[148:151], v46, s[60:63], s91 offen offset:1024 sc1
v_mfma_f32_16x16x32_bf16 v[140:143], v[92:95], a[80:83], v[140:143]
ds_read_b64_tr_b16 v[126:127], v17 offset:20480
ds_read_b64_tr_b16 v[80:81], v14 offset:5120
v_mfma_f32_16x16x32_bf16 v[156:159], v[92:95], a[84:87], v[156:159]
ds_read_b64_tr_b16 v[82:83], v14 offset:21504
s_waitcnt vmcnt(15)
v_mfma_f32_16x16x32_bf16 v[128:131], v[96:99], a[88:91], v[128:131]
ds_read_b64_tr_b16 v[84:85], v15 offset:5120
s_waitcnt vmcnt(14)
v_mfma_f32_16x16x32_bf16 v[144:147], v[96:99], a[92:95], v[144:147]
buffer_load_dwordx4 a[152:155], v46, s[60:63], s91 offen offset:2048 sc1
v_mfma_f32_16x16x32_bf16 v[132:135], v[100:103], a[88:91], v[132:135]
ds_read_b64_tr_b16 v[86:87], v15 offset:21504
ds_read_b64_tr_b16 v[88:89], v16 offset:5120
v_mfma_f32_16x16x32_bf16 v[148:151], v[100:103], a[92:95], v[148:151]
ds_read_b64_tr_b16 v[90:91], v16 offset:21504
s_add_u32 s78, s78, 0xb0000
v_mfma_f32_16x16x32_bf16 v[136:139], v[104:107], a[88:91], v[136:139]
ds_read_b64_tr_b16 v[92:93], v17 offset:5120
ds_read_b64_tr_b16 v[94:95], v17 offset:21504
v_mfma_f32_16x16x32_bf16 v[152:155], v[104:107], a[92:95], v[152:155]
ds_read_b64_tr_b16 v[96:97], v14 offset:6144
s_waitcnt lgkmcnt(7)
v_mfma_f32_16x16x32_bf16 v[140:143], v[108:111], a[88:91], v[140:143]
buffer_load_dwordx4 a[156:159], v46, s[60:63], s91 offen offset:3072 sc1
v_mfma_f32_16x16x32_bf16 v[156:159], v[108:111], a[92:95], v[156:159]
ds_read_b64_tr_b16 v[98:99], v14 offset:22528
s_waitcnt vmcnt(15)
v_mfma_f32_16x16x32_bf16 v[128:131], v[112:115], a[96:99], v[128:131]
ds_read_b64_tr_b16 v[100:101], v15 offset:6144
s_waitcnt vmcnt(14)
v_mfma_f32_16x16x32_bf16 v[144:147], v[112:115], a[100:103], v[144:147]
s_add_u32 s91, s88, 0x20a000
buffer_load_dwordx4 a[160:163], v46, s[60:63], s91 offen offset:0 sc1
v_mfma_f32_16x16x32_bf16 v[132:135], v[116:119], a[96:99], v[132:135]
ds_read_b64_tr_b16 v[102:103], v15 offset:22528
ds_read_b64_tr_b16 v[104:105], v16 offset:6144
v_mfma_f32_16x16x32_bf16 v[148:151], v[116:119], a[100:103], v[148:151]
ds_read_b64_tr_b16 v[106:107], v16 offset:22528
s_lshr_b32 s11, s88, 4
v_mfma_f32_16x16x32_bf16 v[136:139], v[120:123], a[96:99], v[136:139]
ds_read_b64_tr_b16 v[108:109], v17 offset:6144
ds_read_b64_tr_b16 v[110:111], v17 offset:22528
v_mfma_f32_16x16x32_bf16 v[152:155], v[120:123], a[100:103], v[152:155]
buffer_load_dwordx4 a[164:167], v46, s[60:63], s91 offen offset:1024 sc1
v_mfma_f32_16x16x32_bf16 v[140:143], v[124:127], a[96:99], v[140:143]
ds_read_b64_tr_b16 v[112:113], v14 offset:7168
ds_read_b64_tr_b16 v[114:115], v14 offset:23552
v_mfma_f32_16x16x32_bf16 v[156:159], v[124:127], a[100:103], v[156:159]
ds_read_b64_tr_b16 v[116:117], v15 offset:7168
s_waitcnt vmcnt(15)
v_mfma_f32_16x16x32_bf16 v[128:131], v[80:83], a[104:107], v[128:131]
ds_read_b64_tr_b16 v[118:119], v15 offset:23552
s_waitcnt vmcnt(14)
v_mfma_f32_16x16x32_bf16 v[144:147], v[80:83], a[108:111], v[144:147]
ds_read_b64_tr_b16 v[120:121], v16 offset:7168
s_waitcnt lgkmcnt(7)
v_mfma_f32_16x16x32_bf16 v[132:135], v[84:87], a[104:107], v[132:135]
buffer_load_dwordx4 a[168:171], v46, s[60:63], s91 offen offset:2048 sc1
v_mfma_f32_16x16x32_bf16 v[148:151], v[84:87], a[108:111], v[148:151]
ds_read_b64_tr_b16 v[122:123], v16 offset:23552
ds_read_b64_tr_b16 v[124:125], v17 offset:7168
v_mfma_f32_16x16x32_bf16 v[136:139], v[88:91], a[104:107], v[136:139]
ds_read_b64_tr_b16 v[126:127], v17 offset:23552
s_add_u32 s11, s11, 0xb0000
v_mfma_f32_16x16x32_bf16 v[152:155], v[88:91], a[108:111], v[152:155]
buffer_load_dwordx4 a[172:175], v46, s[60:63], s91 offen offset:3072 sc1
v_mfma_f32_16x16x32_bf16 v[140:143], v[92:95], a[104:107], v[140:143]
v_and_b32 v2, 15, v1
v_lshl_add_u32 v3, v2, 4, s78
v_mfma_f32_16x16x32_bf16 v[156:159], v[92:95], a[108:111], v[156:159]
v_lshrrev_b32 v5, 4, v1
s_waitcnt vmcnt(15)
v_mfma_f32_16x16x32_bf16 v[128:131], v[96:99], a[112:115], v[128:131]
v_lshlrev_b32 v55, 4, v2
s_waitcnt vmcnt(14)
v_mfma_f32_16x16x32_bf16 v[144:147], v[96:99], a[116:119], v[144:147]
s_waitcnt lgkmcnt(0)
s_barrier
v_mfma_f32_16x16x32_bf16 v[132:135], v[100:103], a[112:115], v[132:135]
ds_read_b64_tr_b16 v[80:81], v14 offset:32768
ds_read_b64_tr_b16 v[82:83], v14 offset:49152
v_mfma_f32_16x16x32_bf16 v[148:151], v[100:103], a[116:119], v[148:151]
ds_read_b64_tr_b16 v[84:85], v15 offset:32768
ds_read_b64_tr_b16 v[86:87], v15 offset:49152
v_mfma_f32_16x16x32_bf16 v[136:139], v[104:107], a[112:115], v[136:139]
ds_read_b64_tr_b16 v[88:89], v16 offset:32768
v_lshl_add_u32 v55, v5, 10, v55
v_mfma_f32_16x16x32_bf16 v[152:155], v[104:107], a[116:119], v[152:155]
ds_read_b64_tr_b16 v[90:91], v16 offset:49152
ds_read_b64_tr_b16 v[92:93], v17 offset:32768
v_mfma_f32_16x16x32_bf16 v[140:143], v[108:111], a[112:115], v[140:143]
s_add_u32 s91, s88, 0x20b000
buffer_load_dwordx4 a[176:179], v46, s[60:63], s91 offen offset:0 sc1
v_mfma_f32_16x16x32_bf16 v[156:159], v[108:111], a[116:119], v[156:159]
ds_read_b64_tr_b16 v[94:95], v17 offset:49152
s_waitcnt vmcnt(14)
v_mfma_f32_16x16x32_bf16 v[128:131], v[112:115], a[120:123], v[128:131]
ds_read_b64_tr_b16 v[96:97], v14 offset:33792
s_waitcnt vmcnt(13)
v_mfma_f32_16x16x32_bf16 v[144:147], v[112:115], a[124:127], v[144:147]
ds_read_b64_tr_b16 v[98:99], v14 offset:50176
ds_read_b64_tr_b16 v[100:101], v15 offset:33792
v_mfma_f32_16x16x32_bf16 v[132:135], v[116:119], a[120:123], v[132:135]
buffer_load_dwordx4 a[180:183], v46, s[60:63], s91 offen offset:1024 sc1
v_mfma_f32_16x16x32_bf16 v[148:151], v[116:119], a[124:127], v[148:151]
ds_read_b64_tr_b16 v[102:103], v15 offset:50176
ds_read_b64_tr_b16 v[104:105], v16 offset:33792
v_mfma_f32_16x16x32_bf16 v[136:139], v[120:123], a[120:123], v[136:139]
buffer_load_dwordx4 a[184:187], v46, s[60:63], s91 offen offset:2048 sc1
v_mfma_f32_16x16x32_bf16 v[152:155], v[120:123], a[124:127], v[152:155]
ds_read_b64_tr_b16 v[106:107], v16 offset:50176
ds_read_b64_tr_b16 v[108:109], v17 offset:33792
v_mfma_f32_16x16x32_bf16 v[140:143], v[124:127], a[120:123], v[140:143]
buffer_load_dwordx4 a[188:191], v46, s[60:63], s91 offen offset:3072 sc1
v_mfma_f32_16x16x32_bf16 v[156:159], v[124:127], a[124:127], v[156:159]
ds_read_b64_tr_b16 v[110:111], v17 offset:50176
s_waitcnt vmcnt(15) lgkmcnt(5)
v_mfma_f32_16x16x32_bf16 v[128:131], v[80:83], a[128:131], v[128:131]
ds_read_b64_tr_b16 v[112:113], v14 offset:34816
s_waitcnt vmcnt(14)
v_mfma_f32_16x16x32_bf16 v[144:147], v[80:83], a[132:135], v[144:147]
ds_read_b64_tr_b16 v[114:115], v14 offset:51200
ds_read_b64_tr_b16 v[116:117], v15 offset:34816
v_mfma_f32_16x16x32_bf16 v[132:135], v[84:87], a[128:131], v[132:135]
s_add_u32 s91, s88, 0x20c000
buffer_load_dwordx4 a[192:195], v46, s[60:63], s91 offen offset:0 sc1
v_mfma_f32_16x16x32_bf16 v[148:151], v[84:87], a[132:135], v[148:151]
ds_read_b64_tr_b16 v[118:119], v15 offset:51200
ds_read_b64_tr_b16 v[120:121], v16 offset:34816
v_mfma_f32_16x16x32_bf16 v[136:139], v[88:91], a[128:131], v[136:139]
ds_read_b64_tr_b16 v[122:123], v16 offset:51200
v_lshrrev_b32 v4, 2, v2
v_mfma_f32_16x16x32_bf16 v[152:155], v[88:91], a[132:135], v[152:155]
buffer_load_dwordx4 a[196:199], v46, s[60:63], s91 offen offset:1024 sc1
v_mfma_f32_16x16x32_bf16 v[140:143], v[92:95], a[128:131], v[140:143]
ds_read_b64_tr_b16 v[124:125], v17 offset:34816
ds_read_b64_tr_b16 v[126:127], v17 offset:51200
v_mfma_f32_16x16x32_bf16 v[156:159], v[92:95], a[132:135], v[156:159]
ds_read_b64_tr_b16 v[80:81], v14 offset:35840
s_waitcnt vmcnt(15)
v_mfma_f32_16x16x32_bf16 v[128:131], v[96:99], a[136:139], v[128:131]
ds_read_b64_tr_b16 v[82:83], v14 offset:52224
s_waitcnt vmcnt(14)
v_mfma_f32_16x16x32_bf16 v[144:147], v[96:99], a[140:143], v[144:147]
ds_read_b64_tr_b16 v[84:85], v15 offset:35840
s_waitcnt lgkmcnt(6)
v_mfma_f32_16x16x32_bf16 v[132:135], v[100:103], a[136:139], v[132:135]
buffer_load_dwordx4 a[200:203], v46, s[60:63], s91 offen offset:2048 sc1
v_mfma_f32_16x16x32_bf16 v[148:151], v[100:103], a[140:143], v[148:151]
ds_read_b64_tr_b16 v[86:87], v15 offset:52224
ds_read_b64_tr_b16 v[88:89], v16 offset:35840
v_mfma_f32_16x16x32_bf16 v[136:139], v[104:107], a[136:139], v[136:139]
ds_read_b64_tr_b16 v[90:91], v16 offset:52224
v_mov_b32 v2, s96
v_mfma_f32_16x16x32_bf16 v[152:155], v[104:107], a[140:143], v[152:155]
buffer_load_dwordx4 a[204:207], v46, s[60:63], s91 offen offset:3072 sc1
v_mfma_f32_16x16x32_bf16 v[140:143], v[108:111], a[136:139], v[140:143]
ds_read_b64_tr_b16 v[92:93], v17 offset:35840
ds_read_b64_tr_b16 v[94:95], v17 offset:52224
v_mfma_f32_16x16x32_bf16 v[156:159], v[108:111], a[140:143], v[156:159]
ds_read_b64_tr_b16 v[96:97], v14 offset:36864
s_waitcnt vmcnt(15)
v_mfma_f32_16x16x32_bf16 v[128:131], v[112:115], a[144:147], v[128:131]
ds_read_b64_tr_b16 v[98:99], v14 offset:53248
s_waitcnt vmcnt(14)
v_mfma_f32_16x16x32_bf16 v[144:147], v[112:115], a[148:151], v[144:147]
s_add_u32 s91, s88, 0x20d000
buffer_load_dwordx4 a[208:211], v46, s[60:63], s91 offen offset:0 sc1
v_mfma_f32_16x16x32_bf16 v[132:135], v[116:119], a[144:147], v[132:135]
ds_read_b64_tr_b16 v[100:101], v15 offset:36864
ds_read_b64_tr_b16 v[102:103], v15 offset:53248
v_mfma_f32_16x16x32_bf16 v[148:151], v[116:119], a[148:151], v[148:151]
ds_read_b64_tr_b16 v[104:105], v16 offset:36864
s_waitcnt lgkmcnt(7)
v_mfma_f32_16x16x32_bf16 v[136:139], v[120:123], a[144:147], v[136:139]
v_cmp_eq_u32 vcc, v4, v5
s_nop 1
v_cndmask_b32 v51, v2, v3, vcc
v_mfma_f32_16x16x32_bf16 v[152:155], v[120:123], a[148:151], v[152:155]
ds_read_b64_tr_b16 v[106:107], v16 offset:53248
ds_read_b64_tr_b16 v[108:109], v17 offset:36864
v_mfma_f32_16x16x32_bf16 v[140:143], v[124:127], a[144:147], v[140:143]
buffer_load_dwordx4 a[212:215], v46, s[60:63], s91 offen offset:1024 sc1
v_mfma_f32_16x16x32_bf16 v[156:159], v[124:127], a[148:151], v[156:159]
ds_read_b64_tr_b16 v[110:111], v17 offset:53248
s_waitcnt vmcnt(15)
v_mfma_f32_16x16x32_bf16 v[128:131], v[80:83], a[152:155], v[128:131]
ds_read_b64_tr_b16 v[112:113], v14 offset:37888
s_waitcnt vmcnt(14)
v_mfma_f32_16x16x32_bf16 v[144:147], v[80:83], a[156:159], v[144:147]
ds_read_b64_tr_b16 v[114:115], v14 offset:54272
ds_read_b64_tr_b16 v[116:117], v15 offset:37888
v_mfma_f32_16x16x32_bf16 v[132:135], v[84:87], a[152:155], v[132:135]
buffer_load_dwordx4 a[216:219], v46, s[60:63], s91 offen offset:2048 sc1
v_mfma_f32_16x16x32_bf16 v[148:151], v[84:87], a[156:159], v[148:151]
ds_read_b64_tr_b16 v[118:119], v15 offset:54272
ds_read_b64_tr_b16 v[120:121], v16 offset:37888
v_mfma_f32_16x16x32_bf16 v[136:139], v[88:91], a[152:155], v[136:139]
ds_read_b64_tr_b16 v[122:123], v16 offset:54272
v_mfma_f32_16x16x32_bf16 v[152:155], v[88:91], a[156:159], v[152:155]
ds_read_b64_tr_b16 v[124:125], v17 offset:37888
s_waitcnt lgkmcnt(7)
v_mfma_f32_16x16x32_bf16 v[140:143], v[92:95], a[152:155], v[140:143]
buffer_load_dwordx4 a[220:223], v46, s[60:63], s91 offen offset:3072 sc1
v_mfma_f32_16x16x32_bf16 v[156:159], v[92:95], a[156:159], v[156:159]
ds_read_b64_tr_b16 v[126:127], v17 offset:54272
s_waitcnt vmcnt(15)
v_mfma_f32_16x16x32_bf16 v[128:131], v[96:99], a[160:163], v[128:131]
ds_read_b64_tr_b16 v[80:81], v14 offset:38912
s_waitcnt vmcnt(14)
v_mfma_f32_16x16x32_bf16 v[144:147], v[96:99], a[164:167], v[144:147]
ds_read_b64_tr_b16 v[82:83], v14 offset:55296
ds_read_b64_tr_b16 v[84:85], v15 offset:38912
v_mfma_f32_16x16x32_bf16 v[132:135], v[100:103], a[160:163], v[132:135]
s_add_u32 s91, s88, 0x20e000
buffer_load_dwordx4 a[224:227], v46, s[60:63], s91 offen offset:0 sc1
v_mfma_f32_16x16x32_bf16 v[148:151], v[100:103], a[164:167], v[148:151]
ds_read_b64_tr_b16 v[86:87], v15 offset:55296
ds_read_b64_tr_b16 v[88:89], v16 offset:38912
v_mfma_f32_16x16x32_bf16 v[136:139], v[104:107], a[160:163], v[136:139]
ds_read_b64_tr_b16 v[90:91], v16 offset:55296
v_mfma_f32_16x16x32_bf16 v[152:155], v[104:107], a[164:167], v[152:155]
buffer_load_dwordx4 a[228:231], v46, s[60:63], s91 offen offset:1024 sc1
v_mfma_f32_16x16x32_bf16 v[140:143], v[108:111], a[160:163], v[140:143]
ds_read_b64_tr_b16 v[92:93], v17 offset:38912
ds_read_b64_tr_b16 v[94:95], v17 offset:55296
v_mfma_f32_16x16x32_bf16 v[156:159], v[108:111], a[164:167], v[156:159]
ds_read_b64_tr_b16 v[96:97], v14 offset:39936
s_waitcnt vmcnt(15) lgkmcnt(6)
v_mfma_f32_16x16x32_bf16 v[128:131], v[112:115], a[168:171], v[128:131]
ds_read_b64_tr_b16 v[98:99], v14 offset:56320
s_waitcnt vmcnt(14)
v_mfma_f32_16x16x32_bf16 v[144:147], v[112:115], a[172:175], v[144:147]
buffer_load_dwordx4 a[232:235], v46, s[60:63], s91 offen offset:2048 sc1
v_mfma_f32_16x16x32_bf16 v[132:135], v[116:119], a[168:171], v[132:135]
ds_read_b64_tr_b16 v[100:101], v15 offset:39936
ds_read_b64_tr_b16 v[102:103], v15 offset:56320
v_mfma_f32_16x16x32_bf16 v[148:151], v[116:119], a[172:175], v[148:151]
ds_read_b64_tr_b16 v[104:105], v16 offset:39936
v_mfma_f32_16x16x32_bf16 v[136:139], v[120:123], a[168:171], v[136:139]
ds_read_b64_tr_b16 v[106:107], v16 offset:56320
ds_read_b64_tr_b16 v[108:109], v17 offset:39936
v_mfma_f32_16x16x32_bf16 v[152:155], v[120:123], a[172:175], v[152:155]
buffer_load_dwordx4 a[236:239], v46, s[60:63], s91 offen offset:3072 sc1
v_mfma_f32_16x16x32_bf16 v[140:143], v[124:127], a[168:171], v[140:143]
ds_read_b64_tr_b16 v[110:111], v17 offset:56320
v_mfma_f32_16x16x32_bf16 v[156:159], v[124:127], a[172:175], v[156:159]
s_waitcnt vmcnt(15)
v_mfma_f32_16x16x32_bf16 v[128:131], v[80:83], a[176:179], v[128:131]
s_waitcnt vmcnt(14)
v_mfma_f32_16x16x32_bf16 v[144:147], v[80:83], a[180:183], v[144:147]
s_waitcnt lgkmcnt(3)
v_mfma_f32_16x16x32_bf16 v[132:135], v[84:87], a[176:179], v[132:135]
s_add_u32 s91, s88, 0x20f000
buffer_load_dwordx4 a[240:243], v46, s[60:63], s91 offen offset:0 sc1
v_mfma_f32_16x16x32_bf16 v[148:151], v[84:87], a[180:183], v[148:151]
s_waitcnt lgkmcnt(0)
s_barrier
v_mfma_f32_16x16x32_bf16 v[136:139], v[88:91], a[176:179], v[136:139]
ds_read_b64_tr_b16 v[112:113], v10 offset:0
ds_read_b64_tr_b16 v[114:115], v10 offset:16384
v_mfma_f32_16x16x32_bf16 v[152:155], v[88:91], a[180:183], v[152:155]
ds_read_b64_tr_b16 v[116:117], v11 offset:0
ds_read_b64_tr_b16 v[118:119], v11 offset:16384
v_mfma_f32_16x16x32_bf16 v[140:143], v[92:95], a[176:179], v[140:143]
ds_read_b64_tr_b16 v[120:121], v12 offset:0
ds_read_b64_tr_b16 v[122:123], v12 offset:16384
v_mfma_f32_16x16x32_bf16 v[156:159], v[92:95], a[180:183], v[156:159]
ds_read_b64_tr_b16 v[124:125], v13 offset:0
s_waitcnt vmcnt(14)
v_mfma_f32_16x16x32_bf16 v[128:131], v[96:99], a[184:187], v[128:131]
ds_read_b64_tr_b16 v[126:127], v13 offset:16384
s_waitcnt vmcnt(13)
v_mfma_f32_16x16x32_bf16 v[144:147], v[96:99], a[188:191], v[144:147]
ds_read_b64_tr_b16 v[80:81], v10 offset:1024
ds_read_b64_tr_b16 v[82:83], v10 offset:17408
v_mfma_f32_16x16x32_bf16 v[132:135], v[100:103], a[184:187], v[132:135]
ds_read_b64_tr_b16 v[84:85], v11 offset:1024
v_mfma_f32_16x16x32_bf16 v[148:151], v[100:103], a[188:191], v[148:151]
ds_read_b64_tr_b16 v[86:87], v11 offset:17408
ds_read_b64_tr_b16 v[88:89], v12 offset:1024
v_mfma_f32_16x16x32_bf16 v[136:139], v[104:107], a[184:187], v[136:139]
buffer_load_dwordx4 a[244:247], v46, s[60:63], s91 offen offset:1024 sc1
v_mfma_f32_16x16x32_bf16 v[152:155], v[104:107], a[188:191], v[152:155]
ds_read_b64_tr_b16 v[90:91], v12 offset:17408
ds_read_b64_tr_b16 v[92:93], v13 offset:1024
v_mfma_f32_16x16x32_bf16 v[140:143], v[108:111], a[184:187], v[140:143]
buffer_load_dwordx4 a[248:251], v46, s[60:63], s91 offen offset:2048 sc1
v_mfma_f32_16x16x32_bf16 v[156:159], v[108:111], a[188:191], v[156:159]
ds_read_b64_tr_b16 v[94:95], v13 offset:17408
s_waitcnt vmcnt(14) lgkmcnt(6)
v_mfma_f32_16x16x32_bf16 v[128:131], v[112:115], a[192:195], v[128:131]
ds_read_b64_tr_b16 v[96:97], v10 offset:2048
s_waitcnt vmcnt(13)
v_mfma_f32_16x16x32_bf16 v[144:147], v[112:115], a[196:199], v[144:147]
ds_read_b64_tr_b16 v[98:99], v10 offset:18432
ds_read_b64_tr_b16 v[100:101], v11 offset:2048
v_mfma_f32_16x16x32_bf16 v[132:135], v[116:119], a[192:195], v[132:135]
buffer_load_dwordx4 a[252:255], v46, s[60:63], s91 offen offset:3072 sc1
v_mfma_f32_16x16x32_bf16 v[148:151], v[116:119], a[196:199], v[148:151]
ds_read_b64_tr_b16 v[102:103], v11 offset:18432
ds_read_b64_tr_b16 v[104:105], v12 offset:2048
v_mfma_f32_16x16x32_bf16 v[136:139], v[120:123], a[192:195], v[136:139]
s_add_u32 s70, s0, T_wo - K_pc + 0
s_addc_u32 s71, s1, 0
global_load_dword v57, v9, s[70:71]
v_mfma_f32_16x16x32_bf16 v[152:155], v[120:123], a[196:199], v[152:155]
ds_read_b64_tr_b16 v[106:107], v12 offset:18432
ds_read_b64_tr_b16 v[108:109], v13 offset:2048
v_mfma_f32_16x16x32_bf16 v[140:143], v[124:127], a[192:195], v[140:143]
s_add_u32 s70, s0, T_wo - K_pc + 8192
s_addc_u32 s71, s1, 0
global_load_dword v57, v9, s[70:71]
v_mfma_f32_16x16x32_bf16 v[156:159], v[124:127], a[196:199], v[156:159]
ds_read_b64_tr_b16 v[110:111], v13 offset:18432
s_waitcnt vmcnt(15)
v_mfma_f32_16x16x32_bf16 v[128:131], v[80:83], a[200:203], v[128:131]
ds_read_b64_tr_b16 v[112:113], v10 offset:3072
s_waitcnt vmcnt(14)
v_mfma_f32_16x16x32_bf16 v[144:147], v[80:83], a[204:207], v[144:147]
ds_read_b64_tr_b16 v[114:115], v10 offset:19456
s_waitcnt lgkmcnt(5)
v_mfma_f32_16x16x32_bf16 v[132:135], v[84:87], a[200:203], v[132:135]
ds_read_b64_tr_b16 v[116:117], v11 offset:3072
ds_read_b64_tr_b16 v[118:119], v11 offset:19456
v_mfma_f32_16x16x32_bf16 v[148:151], v[84:87], a[204:207], v[148:151]
ds_read_b64_tr_b16 v[120:121], v12 offset:3072
v_mfma_f32_16x16x32_bf16 v[136:139], v[88:91], a[200:203], v[136:139]
ds_read_b64_tr_b16 v[122:123], v12 offset:19456
ds_read_b64_tr_b16 v[124:125], v13 offset:3072
v_mfma_f32_16x16x32_bf16 v[152:155], v[88:91], a[204:207], v[152:155]
ds_read_b64_tr_b16 v[126:127], v13 offset:19456
v_mfma_f32_16x16x32_bf16 v[140:143], v[92:95], a[200:203], v[140:143]
ds_read_b64_tr_b16 v[80:81], v10 offset:4096
ds_read_b64_tr_b16 v[82:83], v10 offset:20480
v_mfma_f32_16x16x32_bf16 v[156:159], v[92:95], a[204:207], v[156:159]
ds_read_b64_tr_b16 v[84:85], v11 offset:4096
s_waitcnt vmcnt(13)
v_mfma_f32_16x16x32_bf16 v[128:131], v[96:99], a[208:211], v[128:131]
ds_read_b64_tr_b16 v[86:87], v11 offset:20480
s_waitcnt vmcnt(12)
v_mfma_f32_16x16x32_bf16 v[144:147], v[96:99], a[212:215], v[144:147]
ds_read_b64_tr_b16 v[88:89], v12 offset:4096
ds_read_b64_tr_b16 v[90:91], v12 offset:20480
v_mfma_f32_16x16x32_bf16 v[132:135], v[100:103], a[208:211], v[132:135]
ds_read_b64_tr_b16 v[92:93], v13 offset:4096
v_mfma_f32_16x16x32_bf16 v[148:151], v[100:103], a[212:215], v[148:151]
ds_read_b64_tr_b16 v[94:95], v13 offset:20480
s_waitcnt lgkmcnt(8)
v_mfma_f32_16x16x32_bf16 v[136:139], v[104:107], a[208:211], v[136:139]
ds_read_b64_tr_b16 v[96:97], v10 offset:5120
ds_read_b64_tr_b16 v[98:99], v10 offset:21504
v_mfma_f32_16x16x32_bf16 v[152:155], v[104:107], a[212:215], v[152:155]
ds_read_b64_tr_b16 v[100:101], v11 offset:5120
v_mfma_f32_16x16x32_bf16 v[140:143], v[108:111], a[208:211], v[140:143]
ds_read_b64_tr_b16 v[102:103], v11 offset:21504
ds_read_b64_tr_b16 v[104:105], v12 offset:5120
v_mfma_f32_16x16x32_bf16 v[156:159], v[108:111], a[212:215], v[156:159]
ds_read_b64_tr_b16 v[106:107], v12 offset:21504
s_waitcnt vmcnt(11)
v_mfma_f32_16x16x32_bf16 v[128:131], v[112:115], a[216:219], v[128:131]
ds_read_b64_tr_b16 v[108:109], v13 offset:5120
s_waitcnt vmcnt(10)
v_mfma_f32_16x16x32_bf16 v[144:147], v[112:115], a[220:223], v[144:147]
ds_read_b64_tr_b16 v[110:111], v13 offset:21504
v_mfma_f32_16x16x32_bf16 v[132:135], v[116:119], a[216:219], v[132:135]
ds_read_b64_tr_b16 v[112:113], v10 offset:6144
v_mfma_f32_16x16x32_bf16 v[148:151], v[116:119], a[220:223], v[148:151]
ds_read_b64_tr_b16 v[114:115], v10 offset:22528
v_mfma_f32_16x16x32_bf16 v[136:139], v[120:123], a[216:219], v[136:139]
ds_read_b64_tr_b16 v[116:117], v11 offset:6144
v_mfma_f32_16x16x32_bf16 v[152:155], v[120:123], a[220:223], v[152:155]
ds_read_b64_tr_b16 v[118:119], v11 offset:22528
v_mfma_f32_16x16x32_bf16 v[140:143], v[124:127], a[216:219], v[140:143]
ds_read_b64_tr_b16 v[120:121], v12 offset:6144
v_mfma_f32_16x16x32_bf16 v[156:159], v[124:127], a[220:223], v[156:159]
ds_read_b64_tr_b16 v[122:123], v12 offset:22528
s_waitcnt vmcnt(9) lgkmcnt(6)
v_mfma_f32_16x16x32_bf16 v[128:131], v[80:83], a[224:227], v[128:131]
ds_read_b64_tr_b16 v[124:125], v13 offset:6144
s_waitcnt vmcnt(8)
v_mfma_f32_16x16x32_bf16 v[144:147], v[80:83], a[228:231], v[144:147]
ds_read_b64_tr_b16 v[126:127], v13 offset:22528
v_mfma_f32_16x16x32_bf16 v[132:135], v[84:87], a[224:227], v[132:135]
ds_read_b64_tr_b16 v[80:81], v10 offset:7168
v_mfma_f32_16x16x32_bf16 v[148:151], v[84:87], a[228:231], v[148:151]
ds_read_b64_tr_b16 v[82:83], v10 offset:23552
v_mfma_f32_16x16x32_bf16 v[136:139], v[88:91], a[224:227], v[136:139]
ds_read_b64_tr_b16 v[84:85], v11 offset:7168
v_mfma_f32_16x16x32_bf16 v[152:155], v[88:91], a[228:231], v[152:155]
ds_read_b64_tr_b16 v[86:87], v11 offset:23552
v_mfma_f32_16x16x32_bf16 v[140:143], v[92:95], a[224:227], v[140:143]
ds_read_b64_tr_b16 v[88:89], v12 offset:7168
v_mfma_f32_16x16x32_bf16 v[156:159], v[92:95], a[228:231], v[156:159]
ds_read_b64_tr_b16 v[90:91], v12 offset:23552
s_waitcnt vmcnt(7)
v_mfma_f32_16x16x32_bf16 v[128:131], v[96:99], a[232:235], v[128:131]
ds_read_b64_tr_b16 v[92:93], v13 offset:7168
s_waitcnt vmcnt(6)
v_mfma_f32_16x16x32_bf16 v[144:147], v[96:99], a[236:239], v[144:147]
ds_read_b64_tr_b16 v[94:95], v13 offset:23552
v_mfma_f32_16x16x32_bf16 v[132:135], v[100:103], a[232:235], v[132:135]
v_mfma_f32_16x16x32_bf16 v[148:151], v[100:103], a[236:239], v[148:151]
v_mfma_f32_16x16x32_bf16 v[136:139], v[104:107], a[232:235], v[136:139]
v_mfma_f32_16x16x32_bf16 v[152:155], v[104:107], a[236:239], v[152:155]
v_mfma_f32_16x16x32_bf16 v[140:143], v[108:111], a[232:235], v[140:143]
v_mfma_f32_16x16x32_bf16 v[156:159], v[108:111], a[236:239], v[156:159]
s_waitcnt vmcnt(5) lgkmcnt(0)
v_mfma_f32_16x16x32_bf16 v[128:131], v[112:115], a[240:243], v[128:131]
s_waitcnt vmcnt(4)
v_mfma_f32_16x16x32_bf16 v[144:147], v[112:115], a[244:247], v[144:147]
v_mfma_f32_16x16x32_bf16 v[132:135], v[116:119], a[240:243], v[132:135]
v_mfma_f32_16x16x32_bf16 v[148:151], v[116:119], a[244:247], v[148:151]
v_mfma_f32_16x16x32_bf16 v[136:139], v[120:123], a[240:243], v[136:139]
v_mfma_f32_16x16x32_bf16 v[152:155], v[120:123], a[244:247], v[152:155]
v_mfma_f32_16x16x32_bf16 v[140:143], v[124:127], a[240:243], v[140:143]
v_mfma_f32_16x16x32_bf16 v[156:159], v[124:127], a[244:247], v[156:159]
s_waitcnt vmcnt(3)
v_mfma_f32_16x16x32_bf16 v[128:131], v[80:83], a[248:251], v[128:131]
s_waitcnt vmcnt(2)
v_mfma_f32_16x16x32_bf16 v[144:147], v[80:83], a[252:255], v[144:147]
v_mfma_f32_16x16x32_bf16 v[132:135], v[84:87], a[248:251], v[132:135]
v_mfma_f32_16x16x32_bf16 v[148:151], v[84:87], a[252:255], v[148:151]
v_mfma_f32_16x16x32_bf16 v[136:139], v[88:91], a[248:251], v[136:139]
v_mfma_f32_16x16x32_bf16 v[152:155], v[88:91], a[252:255], v[152:155]
v_mfma_f32_16x16x32_bf16 v[140:143], v[92:95], a[248:251], v[140:143]
v_mfma_f32_16x16x32_bf16 v[156:159], v[92:95], a[252:255], v[156:159]
T_wo:
v_pk_fma_f32 v[160:161], v[128:129], v[192:193], v[160:161]
v_pk_fma_f32 v[162:163], v[130:131], v[194:195], v[162:163]
s_nop 0
v_pk_fma_f32 v[164:165], v[132:133], v[196:197], v[164:165]
v_pk_fma_f32 v[166:167], v[134:135], v[198:199], v[166:167]
v_pk_fma_f32 v[168:169], v[136:137], v[200:201], v[168:169]
v_pk_fma_f32 v[170:171], v[138:139], v[202:203], v[170:171]
v_pk_fma_f32 v[172:173], v[140:141], v[204:205], v[172:173]
v_pk_fma_f32 v[174:175], v[142:143], v[206:207], v[174:175]
v_pk_fma_f32 v[176:177], v[144:145], v[192:193], v[176:177]
v_pk_fma_f32 v[178:179], v[146:147], v[194:195], v[178:179]
v_pk_fma_f32 v[180:181], v[148:149], v[196:197], v[180:181]
v_pk_fma_f32 v[182:183], v[150:151], v[198:199], v[182:183]
v_pk_fma_f32 v[184:185], v[152:153], v[200:201], v[184:185]
v_pk_fma_f32 v[186:187], v[154:155], v[202:203], v[186:187]
v_pk_fma_f32 v[188:189], v[156:157], v[204:205], v[188:189]
v_pk_fma_f32 v[190:191], v[158:159], v[206:207], v[190:191]
v_cvt_pk_bf16_f32 v224, v160, v161
v_cvt_pk_bf16_f32 v225, v162, v163
v_cvt_pk_bf16_f32 v226, v164, v165
v_cvt_pk_bf16_f32 v227, v166, v167
buffer_store_dwordx4 v[224:227], v46, s[60:63], s27 offen offset:0 sc1
s_nop 0
v_mfma_f32_16x16x32_bf16 v[220:223], v[224:227], v[224:227], 0
v_mfma_f32_16x16x32_bf16 v[212:215], v[208:211], v[224:227], 0
v_cvt_pk_bf16_f32 v228, v168, v169
v_cvt_pk_bf16_f32 v229, v170, v171
v_cvt_pk_bf16_f32 v230, v172, v173
v_cvt_pk_bf16_f32 v231, v174, v175
buffer_store_dwordx4 v[228:231], v46, s[60:63], s27 offen offset:2048 sc1
s_nop 0
v_mfma_f32_16x16x32_bf16 v[220:223], v[228:231], v[228:231], v[220:223]
v_mfma_f32_16x16x32_bf16 v[212:215], v[208:211], v[228:231], v[212:215]
v_cvt_pk_bf16_f32 v232, v176, v177
v_cvt_pk_bf16_f32 v233, v178, v179
v_cvt_pk_bf16_f32 v234, v180, v181
v_cvt_pk_bf16_f32 v235, v182, v183
buffer_store_dwordx4 v[232:235], v46, s[60:63], s27 offen offset:1024 sc1
s_nop 0
v_mfma_f32_16x16x32_bf16 v[76:79], v[232:235], v[232:235], 0
v_mfma_f32_16x16x32_bf16 v[216:219], v[208:211], v[232:235], 0
v_cvt_pk_bf16_f32 v236, v184, v185
v_cvt_pk_bf16_f32 v237, v186, v187
v_cvt_pk_bf16_f32 v238, v188, v189
v_cvt_pk_bf16_f32 v239, v190, v191
buffer_store_dwordx4 v[236:239], v46, s[60:63], s27 offen offset:3072 sc1
s_nop 0
v_mfma_f32_16x16x32_bf16 v[76:79], v[236:239], v[236:239], v[76:79]
v_mfma_f32_16x16x32_bf16 v[216:219], v[208:211], v[236:239], v[216:219]
v_cndmask_b32 v69, v220, v221, s[4:5]
v_cndmask_b32 v69, v69, v222, s[6:7]
v_cndmask_b32 v69, v69, v223, s[8:9]
v_mov_b32 v68, v212
s_nop 2
v_cndmask_b32 v71, v76, v77, s[4:5]
v_cndmask_b32 v71, v71, v78, s[6:7]
v_cndmask_b32 v71, v71, v79, s[8:9]
v_mov_b32 v70, v216
buffer_store_dwordx4 v[68:71], v51, s[60:63], 0 offen sc1
s_add_u32 m0, s76, 32768
s_add_u32 s77, s82, 0x0
buffer_load_dwordx4 v30, s[40:43], s77 offen offset:0 lds
buffer_load_dwordx4 v31, s[40:43], s77 offen offset:1024 lds
buffer_load_dwordx4 v32, s[40:43], s77 offen offset:2048 lds
buffer_load_dwordx4 v33, s[40:43], s77 offen offset:3072 lds
s_add_u32 m0, s76, 36864
s_add_u32 s77, s82, 0xe0000
buffer_load_dwordx4 v30, s[40:43], s77 offen offset:0 lds
buffer_load_dwordx4 v31, s[40:43], s77 offen offset:1024 lds
buffer_load_dwordx4 v32, s[40:43], s77 offen offset:2048 lds
buffer_load_dwordx4 v33, s[40:43], s77 offen offset:3072 lds
v_and_b32 v2, 15, v1
v_lshrrev_b32 v3, 2, v2
v_lshrrev_b32 v4, 4, v1
v_cmp_eq_u32 vcc, v3, v4
v_lshlrev_b32 v3, 4, v2
v_mov_b32 v4, 131328
v_add_u32 v5, 131072, v3
v_add_u32 v6, 147456, v3
v_cndmask_b32 v53, v4, v5, vcc
v_cndmask_b32 v54, v4, v6, vcc
v_mov_b32 v81, 0
v_mov_b32 v87, 0
v_mov_b32 v93, 0
v_mov_b32 v99, 0
v_mov_b32 v105, 0
v_mov_b32 v111, 0
v_mov_b32 v117, 0
v_mov_b32 v123, 0
v_mov_b32 v129, 0
v_mov_b32 v131, 0
v_mov_b32 v137, 0
v_mov_b32 v143, 0
v_mov_b32 v149, 0
v_mov_b32 v155, 0
v_mov_b32 v161, 0
v_mov_b32 v167, 0
v_mov_b32 v173, 0
v_mov_b32 v179, 0
ds_read_b128 v[180:183], v53 offset:0
ds_read_b128 v[184:187], v54 offset:0
ds_read_b128 v[188:191], v53 offset:272
ds_read_b128 v[192:195], v54 offset:272
s_waitcnt vmcnt(8)
s_atomic_add s69, s[60:61], s90 offset:4096
s_add_u32 m0, s76, 65536
s_add_u32 s77, s82, 0x1c0000
buffer_load_dwordx4 v30, s[40:43], s77 offen offset:0 lds
buffer_load_dwordx4 v31, s[40:43], s77 offen offset:1024 lds
buffer_load_dwordx4 v32, s[40:43], s77 offen offset:2048 lds
buffer_load_dwordx4 v33, s[40:43], s77 offen offset:3072 lds
s_add_u32 m0, s76, 69632
s_add_u32 s77, s82, 0x2a0000
buffer_load_dwordx4 v30, s[40:43], s77 offen offset:0 lds
buffer_load_dwordx4 v31, s[40:43], s77 offen offset:1024 lds
buffer_load_dwordx4 v32, s[40:43], s77 offen offset:2048 lds
buffer_load_dwordx4 v33, s[40:43], s77 offen offset:3072 lds
s_add_u32 s70, s0, S_G0 - K_pc + 0
s_addc_u32 s71, s1, 0
global_load_dword v57, v9, s[70:71]
s_mov_b32 s87, 0
s_atomic_add s87, s[60:61], s90 offset:4096 glc
s_waitcnt lgkmcnt(0)
s_cmp_lt_u32 s87, 16
s_cbranch_scc1 pl_4_slow
pl_4_ok:
buffer_load_dwordx4 v[204:207], v55, s[60:63], s11 offen offset:0 sc1
buffer_load_dwordx4 v[208:211], v55, s[60:63], s11 offen offset:256 sc1
buffer_load_dwordx4 v[212:215], v55, s[60:63], s11 offen offset:512 sc1
buffer_load_dwordx4 v[216:219], v55, s[60:63], s11 offen offset:768 sc1
s_add_u32 s91, s88, 0x600000
buffer_load_dwordx4 v[82:85], v46, s[60:63], s91 offen offset:0 sc1
buffer_load_dwordx4 v[132:135], v46, s[60:63], s91 offen offset:1024 sc1
buffer_load_dwordx4 v[88:91], v46, s[60:63], s91 offen offset:2048 sc1
buffer_load_dwordx4 v[138:141], v46, s[60:63], s91 offen offset:3072 sc1
s_add_u32 s91, s88, 0x601000
buffer_load_dwordx4 v[94:97], v46, s[60:63], s91 offen offset:0 sc1
buffer_load_dwordx4 v[144:147], v46, s[60:63], s91 offen offset:1024 sc1
buffer_load_dwordx4 v[100:103], v46, s[60:63], s91 offen offset:2048 sc1
buffer_load_dwordx4 v[150:153], v46, s[60:63], s91 offen offset:3072 sc1
s_add_u32 s91, s88, 0x602000
buffer_load_dwordx4 v[106:109], v46, s[60:63], s91 offen offset:0 sc1
buffer_load_dwordx4 v[156:159], v46, s[60:63], s91 offen offset:1024 sc1
buffer_load_dwordx4 v[112:115], v46, s[60:63], s91 offen offset:2048 sc1
buffer_load_dwordx4 v[162:165], v46, s[60:63], s91 offen offset:3072 sc1
s_add_u32 s91, s88, 0x603000
buffer_load_dwordx4 v[118:121], v46, s[60:63], s91 offen offset:0 sc1
buffer_load_dwordx4 v[168:171], v46, s[60:63], s91 offen offset:1024 sc1
buffer_load_dwordx4 v[124:127], v46, s[60:63], s91 offen offset:2048 sc1
buffer_load_dwordx4 v[174:177], v46, s[60:63], s91 offen offset:3072 sc1
s_waitcnt vmcnt(18)
v_pk_add_f32 v[204:205], v[204:205], v[208:209]
s_waitcnt vmcnt(16)
v_pk_add_f32 v[212:213], v[212:213], v[216:217]
v_pk_add_f32 v[206:207], v[206:207], v[210:211]
v_pk_add_f32 v[214:215], v[214:215], v[218:219]
v_pk_add_f32 v[204:205], v[204:205], v[212:213]
v_pk_add_f32 v[206:207], v[206:207], v[214:215]
v_mov_b32 v208, v204
v_mov_b32 v209, v205
v_mov_b32 v210, v206
v_mov_b32 v211, v207
v_permlane32_swap_b32 v204, v208
v_permlane32_swap_b32 v205, v209
v_permlane32_swap_b32 v206, v210
v_permlane32_swap_b32 v207, v211
v_add_f32 v204, v204, v208
v_add_f32 v205, v205, v209
v_add_f32 v206, v206, v210
v_add_f32 v207, v207, v211
v_mov_b32 v208, v204
v_mov_b32 v209, v205
v_mov_b32 v210, v206
v_mov_b32 v211, v207
v_permlane16_swap_b32 v204, v208
v_permlane16_swap_b32 v205, v209
v_permlane16_swap_b32 v206, v210
v_permlane16_swap_b32 v207, v211
v_add_f32 v204, v204, v208
v_add_f32 v205, v205, v209
v_add_f32 v206, v206, v210
v_add_f32 v207, v207, v211
v_mul_f32 v204, 0x3a800000, v204
v_mul_f32 v205, 0x3a800000, v205
v_mul_f32 v206, 0x3a800000, v206
v_mul_f32 v207, 0x3a800000, v207
v_mul_f32 v208, v204, v204
v_mul_f32 v209, v206, v206
v_sub_f32 v205, v205, v208
v_sub_f32 v207, v207, v209
v_max_f32 v205, 0, v205
v_max_f32 v207, 0, v207
v_cvt_pk_bf16_f32 v68, v205, v205
v_lshlrev_b32 v205, 16, v68
v_cvt_pk_bf16_f32 v69, v207, v207
v_lshlrev_b32 v207, 16, v69
v_add_f32 v205, 0x3727c5ac, v205
v_add_f32 v207, 0x3727c5ac, v207
v_cvt_pk_bf16_f32 v68, v205, v205
v_lshlrev_b32 v205, 16, v68
v_cvt_pk_bf16_f32 v69, v207, v207
v_lshlrev_b32 v207, 16, v69
v_sqrt_f32 v205, v205
v_sqrt_f32 v207, v207
v_sub_f32 v204, 0, v204
v_sub_f32 v206, 0, v206
v_cvt_pk_bf16_f32 v68, v205, v204
v_cvt_pk_bf16_f32 v69, v207, v206
v_lshlrev_b32 v76, 16, v68
v_lshlrev_b32 v77, 16, v69
v_rcp_f32 v58, v76
v_rcp_f32 v59, v77
v_mov_b32 v80, v68
v_mov_b32 v130, v69
v_mov_b32 v86, v68
v_mov_b32 v136, v69
v_mov_b32 v92, v68
v_mov_b32 v142, v69
v_mov_b32 v98, v68
v_mov_b32 v148, v69
v_mov_b32 v104, v68
v_mov_b32 v154, v69
v_mov_b32 v110, v68
v_mov_b32 v160, v69
v_mov_b32 v116, v68
v_mov_b32 v166, v69
v_mov_b32 v122, v68
v_mov_b32 v172, v69
v_mov_b32 v128, v68
v_mov_b32 v178, v69
s_waitcnt vmcnt(15)
v_mfma_f32_16x16x32_bf16 v[204:207], v[180:183], v[80:83], 0
v_mfma_f32_16x16x32_bf16 v[208:211], v[184:187], v[84:87], 0
s_add_u32 s91, s88, 0x604000
buffer_load_dwordx4 v[82:85], v46, s[60:63], s91 offen offset:0 sc1
ds_read_b128 v[196:199], v53 offset:544
s_waitcnt vmcnt(15)
v_mfma_f32_16x16x32_bf16 v[212:215], v[180:183], v[130:133], 0
v_mfma_f32_16x16x32_bf16 v[216:219], v[184:187], v[134:137], 0
buffer_load_dwordx4 v[132:135], v46, s[60:63], s91 offen offset:1024 sc1
ds_read_b128 v[200:203], v54 offset:544
s_waitcnt vmcnt(15)
v_mfma_f32_16x16x32_bf16 v[240:243], v[188:191], v[86:89], 0
v_cvt_pk_bf16_f32 v204, v204, v205
v_cvt_pk_bf16_f32 v205, v206, v207
v_cvt_pk_bf16_f32 v208, v208, v209
v_cvt_pk_bf16_f32 v209, v210, v211
v_mfma_f32_16x16x32_bf16 v[244:247], v[192:195], v[90:93], 0
buffer_load_dwordx4 v[88:91], v46, s[60:63], s91 offen offset:2048 sc1
ds_read_b128 v[180:183], v53 offset:816
v_accvgpr_write_b32 a0, v204
v_accvgpr_write_b32 a1, v205
v_accvgpr_write_b32 a2, v208
v_accvgpr_write_b32 a3, v209
s_waitcnt vmcnt(15)
v_mfma_f32_16x16x32_bf16 v[248:251], v[188:191], v[136:139], 0
v_cvt_pk_bf16_f32 v212, v212, v213
v_cvt_pk_bf16_f32 v213, v214, v215
v_cvt_pk_bf16_f32 v216, v216, v217
v_cvt_pk_bf16_f32 v217, v218, v219
v_mfma_f32_16x16x32_bf16 v[252:255], v[192:195], v[140:143], 0
buffer_load_dwordx4 v[138:141], v46, s[60:63], s91 offen offset:3072 sc1
ds_read_b128 v[184:187], v54 offset:816
v_accvgpr_write_b32 a4, v212
v_accvgpr_write_b32 a5, v213
v_accvgpr_write_b32 a6, v216
v_accvgpr_write_b32 a7, v217
s_waitcnt vmcnt(15) lgkmcnt(3)
v_mfma_f32_16x16x32_bf16 v[204:207], v[196:199], v[92:95], 0
v_cvt_pk_bf16_f32 v240, v240, v241
v_cvt_pk_bf16_f32 v241, v242, v243
v_cvt_pk_bf16_f32 v244, v244, v245
v_cvt_pk_bf16_f32 v245, v246, v247
s_waitcnt lgkmcnt(2)
v_mfma_f32_16x16x32_bf16 v[208:211], v[200:203], v[96:99], 0
s_add_u32 s91, s88, 0x605000
buffer_load_dwordx4 v[94:97], v46, s[60:63], s91 offen offset:0 sc1
ds_read_b128 v[188:191], v53 offset:1088
v_accvgpr_write_b32 a8, v240
v_accvgpr_write_b32 a9, v241
v_accvgpr_write_b32 a10, v244
v_accvgpr_write_b32 a11, v245
s_waitcnt vmcnt(15)
v_mfma_f32_16x16x32_bf16 v[212:215], v[196:199], v[142:145], 0
v_cvt_pk_bf16_f32 v248, v248, v249
v_cvt_pk_bf16_f32 v249, v250, v251
v_cvt_pk_bf16_f32 v252, v252, v253
v_cvt_pk_bf16_f32 v253, v254, v255
v_mfma_f32_16x16x32_bf16 v[216:219], v[200:203], v[146:149], 0
buffer_load_dwordx4 v[144:147], v46, s[60:63], s91 offen offset:1024 sc1
ds_read_b128 v[192:195], v54 offset:1088
v_accvgpr_write_b32 a12, v248
v_accvgpr_write_b32 a13, v249
v_accvgpr_write_b32 a14, v252
v_accvgpr_write_b32 a15, v253
s_waitcnt vmcnt(15) lgkmcnt(3)
v_mfma_f32_16x16x32_bf16 v[240:243], v[180:183], v[98:101], 0
v_cvt_pk_bf16_f32 v204, v204, v205
v_cvt_pk_bf16_f32 v205, v206, v207
v_cvt_pk_bf16_f32 v208, v208, v209
v_cvt_pk_bf16_f32 v209, v210, v211
s_waitcnt lgkmcnt(2)
v_mfma_f32_16x16x32_bf16 v[244:247], v[184:187], v[102:105], 0
buffer_load_dwordx4 v[100:103], v46, s[60:63], s91 offen offset:2048 sc1
ds_read_b128 v[196:199], v53 offset:1360
v_accvgpr_write_b32 a16, v204
v_accvgpr_write_b32 a17, v205
v_accvgpr_write_b32 a18, v208
v_accvgpr_write_b32 a19, v209
s_waitcnt vmcnt(15)
v_mfma_f32_16x16x32_bf16 v[248:251], v[180:183], v[148:151], 0
v_cvt_pk_bf16_f32 v212, v212, v213
v_cvt_pk_bf16_f32 v213, v214, v215
v_cvt_pk_bf16_f32 v216, v216, v217
v_cvt_pk_bf16_f32 v217, v218, v219
v_mfma_f32_16x16x32_bf16 v[252:255], v[184:187], v[152:155], 0
buffer_load_dwordx4 v[150:153], v46, s[60:63], s91 offen offset:3072 sc1
ds_read_b128 v[200:203], v54 offset:1360
v_accvgpr_write_b32 a20, v212
v_accvgpr_write_b32 a21, v213
v_accvgpr_write_b32 a22, v216
v_accvgpr_write_b32 a23, v217
s_waitcnt vmcnt(15) lgkmcnt(3)
v_mfma_f32_16x16x32_bf16 v[204:207], v[188:191], v[104:107], 0
v_cvt_pk_bf16_f32 v240, v240, v241
v_cvt_pk_bf16_f32 v241, v242, v243
v_cvt_pk_bf16_f32 v244, v244, v245
v_cvt_pk_bf16_f32 v245, v246, v247
s_waitcnt lgkmcnt(2)
v_mfma_f32_16x16x32_bf16 v[208:211], v[192:195], v[108:111], 0
s_add_u32 s91, s88, 0x606000
buffer_load_dwordx4 v[106:109], v46, s[60:63], s91 offen offset:0 sc1
ds_read_b128 v[180:183], v53 offset:1632
v_accvgpr_write_b32 a24, v240
v_accvgpr_write_b32 a25, v241
v_accvgpr_write_b32 a26, v244
v_accvgpr_write_b32 a27, v245
s_waitcnt vmcnt(15)
v_mfma_f32_16x16x32_bf16 v[212:215], v[188:191], v[154:157], 0
v_cvt_pk_bf16_f32 v248, v248, v249
v_cvt_pk_bf16_f32 v249, v250, v251
v_cvt_pk_bf16_f32 v252, v252, v253
v_cvt_pk_bf16_f32 v253, v254, v255
v_mfma_f32_16x16x32_bf16 v[216:219], v[192:195], v[158:161], 0
buffer_load_dwordx4 v[156:159], v46, s[60:63], s91 offen offset:1024 sc1
ds_read_b128 v[184:187], v54 offset:1632
v_accvgpr_write_b32 a28, v248
v_accvgpr_write_b32 a29, v249
v_accvgpr_write_b32 a30, v252
v_accvgpr_write_b32 a31, v253
s_waitcnt vmcnt(15) lgkmcnt(3)
v_mfma_f32_16x16x32_bf16 v[240:243], v[196:199], v[110:113], 0
v_cvt_pk_bf16_f32 v204, v204, v205
v_cvt_pk_bf16_f32 v205, v206, v207
v_cvt_pk_bf16_f32 v208, v208, v209
v_cvt_pk_bf16_f32 v209, v210, v211
s_waitcnt lgkmcnt(2)
v_mfma_f32_16x16x32_bf16 v[244:247], v[200:203], v[114:117], 0
buffer_load_dwordx4 v[112:115], v46, s[60:63], s91 offen offset:2048 sc1
ds_read_b128 v[188:191], v53 offset:1904
v_accvgpr_write_b32 a32, v204
v_accvgpr_write_b32 a33, v205
v_accvgpr_write_b32 a34, v208
v_accvgpr_write_b32 a35, v209
s_waitcnt vmcnt(15)
v_mfma_f32_16x16x32_bf16 v[248:251], v[196:199], v[160:163], 0
v_cvt_pk_bf16_f32 v212, v212, v213
v_cvt_pk_bf16_f32 v213, v214, v215
v_cvt_pk_bf16_f32 v216, v216, v217
v_cvt_pk_bf16_f32 v217, v218, v219
v_mfma_f32_16x16x32_bf16 v[252:255], v[200:203], v[164:167], 0
buffer_load_dwordx4 v[162:165], v46, s[60:63], s91 offen offset:3072 sc1
ds_read_b128 v[192:195], v54 offset:1904
v_accvgpr_write_b32 a36, v212
v_accvgpr_write_b32 a37, v213
v_accvgpr_write_b32 a38, v216
v_accvgpr_write_b32 a39, v217
s_waitcnt vmcnt(15) lgkmcnt(3)
v_mfma_f32_16x16x32_bf16 v[204:207], v[180:183], v[116:119], 0
v_cvt_pk_bf16_f32 v240, v240, v241
v_cvt_pk_bf16_f32 v241, v242, v243
v_cvt_pk_bf16_f32 v244, v244, v245
v_cvt_pk_bf16_f32 v245, v246, v247
s_waitcnt lgkmcnt(2)
v_mfma_f32_16x16x32_bf16 v[208:211], v[184:187], v[120:123], 0
s_add_u32 s91, s88, 0x607000
buffer_load_dwordx4 v[118:121], v46, s[60:63], s91 offen offset:0 sc1
ds_read_b128 v[196:199], v53 offset:2176
v_accvgpr_write_b32 a40, v240
v_accvgpr_write_b32 a41, v241
v_accvgpr_write_b32 a42, v244
v_accvgpr_write_b32 a43, v245
s_waitcnt vmcnt(15)
v_mfma_f32_16x16x32_bf16 v[212:215], v[180:183], v[166:169], 0
v_cvt_pk_bf16_f32 v248, v248, v249
v_cvt_pk_bf16_f32 v249, v250, v251
v_cvt_pk_bf16_f32 v252, v252, v253
v_cvt_pk_bf16_f32 v253, v254, v255
v_mfma_f32_16x16x32_bf16 v[216:219], v[184:187], v[170:173], 0
buffer_load_dwordx4 v[168:171], v46, s[60:63], s91 offen offset:1024 sc1
ds_read_b128 v[200:203], v54 offset:2176
v_accvgpr_write_b32 a44, v248
v_accvgpr_write_b32 a45, v249
v_accvgpr_write_b32 a46, v252
v_accvgpr_write_b32 a47, v253
s_waitcnt vmcnt(15) lgkmcnt(3)
v_mfma_f32_16x16x32_bf16 v[240:243], v[188:191], v[122:125], 0
v_cvt_pk_bf16_f32 v204, v204, v205
v_cvt_pk_bf16_f32 v205, v206, v207
v_cvt_pk_bf16_f32 v208, v208, v209
v_cvt_pk_bf16_f32 v209, v210, v211
s_waitcnt lgkmcnt(2)
v_mfma_f32_16x16x32_bf16 v[244:247], v[192:195], v[126:129], 0
buffer_load_dwordx4 v[124:127], v46, s[60:63], s91 offen offset:2048 sc1
ds_read_b128 v[180:183], v53 offset:2448
v_accvgpr_write_b32 a48, v204
v_accvgpr_write_b32 a49, v205
v_accvgpr_write_b32 a50, v208
v_accvgpr_write_b32 a51, v209
s_waitcnt vmcnt(15)
v_mfma_f32_16x16x32_bf16 v[248:251], v[188:191], v[172:175], 0
v_cvt_pk_bf16_f32 v212, v212, v213
v_cvt_pk_bf16_f32 v213, v214, v215
v_cvt_pk_bf16_f32 v216, v216, v217
v_cvt_pk_bf16_f32 v217, v218, v219
v_mfma_f32_16x16x32_bf16 v[252:255], v[192:195], v[176:179], 0
buffer_load_dwordx4 v[174:177], v46, s[60:63], s91 offen offset:3072 sc1
ds_read_b128 v[184:187], v54 offset:2448
v_accvgpr_write_b32 a52, v212
v_accvgpr_write_b32 a53, v213
v_accvgpr_write_b32 a54, v216
v_accvgpr_write_b32 a55, v217
s_waitcnt vmcnt(15) lgkmcnt(3)
v_mfma_f32_16x16x32_bf16 v[204:207], v[196:199], v[80:83], 0
v_cvt_pk_bf16_f32 v240, v240, v241
v_cvt_pk_bf16_f32 v241, v242, v243
v_cvt_pk_bf16_f32 v244, v244, v245
v_cvt_pk_bf16_f32 v245, v246, v247
s_waitcnt lgkmcnt(2)
v_mfma_f32_16x16x32_bf16 v[208:211], v[200:203], v[84:87], 0
s_add_u32 s91, s88, 0x608000
buffer_load_dwordx4 v[82:85], v46, s[60:63], s91 offen offset:0 sc1
ds_read_b128 v[188:191], v53 offset:2720
v_accvgpr_write_b32 a56, v240
v_accvgpr_write_b32 a57, v241
v_accvgpr_write_b32 a58, v244
v_accvgpr_write_b32 a59, v245
s_waitcnt vmcnt(15)
v_mfma_f32_16x16x32_bf16 v[212:215], v[196:199], v[130:133], 0
v_cvt_pk_bf16_f32 v248, v248, v249
v_cvt_pk_bf16_f32 v249, v250, v251
v_cvt_pk_bf16_f32 v252, v252, v253
v_cvt_pk_bf16_f32 v253, v254, v255
v_mfma_f32_16x16x32_bf16 v[216:219], v[200:203], v[134:137], 0
buffer_load_dwordx4 v[132:135], v46, s[60:63], s91 offen offset:1024 sc1
ds_read_b128 v[192:195], v54 offset:2720
v_accvgpr_write_b32 a60, v248
v_accvgpr_write_b32 a61, v249
v_accvgpr_write_b32 a62, v252
v_accvgpr_write_b32 a63, v253
s_waitcnt vmcnt(15) lgkmcnt(3)
v_mfma_f32_16x16x32_bf16 v[240:243], v[180:183], v[86:89], 0
v_cvt_pk_bf16_f32 v204, v204, v205
v_cvt_pk_bf16_f32 v205, v206, v207
v_cvt_pk_bf16_f32 v208, v208, v209
v_cvt_pk_bf16_f32 v209, v210, v211
s_waitcnt lgkmcnt(2)
v_mfma_f32_16x16x32_bf16 v[244:247], v[184:187], v[90:93], 0
buffer_load_dwordx4 v[88:91], v46, s[60:63], s91 offen offset:2048 sc1
ds_read_b128 v[196:199], v53 offset:2992
v_accvgpr_write_b32 a64, v204
v_accvgpr_write_b32 a65, v205
v_accvgpr_write_b32 a66, v208
v_accvgpr_write_b32 a67, v209
s_waitcnt vmcnt(15)
v_mfma_f32_16x16x32_bf16 v[248:251], v[180:183], v[136:139], 0
v_cvt_pk_bf16_f32 v212, v212, v213
v_cvt_pk_bf16_f32 v213, v214, v215
v_cvt_pk_bf16_f32 v216, v216, v217
v_cvt_pk_bf16_f32 v217, v218, v219
v_mfma_f32_16x16x32_bf16 v[252:255], v[184:187], v[140:143], 0
buffer_load_dwordx4 v[138:141], v46, s[60:63], s91 offen offset:3072 sc1
ds_read_b128 v[200:203], v54 offset:2992
v_accvgpr_write_b32 a68, v212
v_accvgpr_write_b32 a69, v213
v_accvgpr_write_b32 a70, v216
v_accvgpr_write_b32 a71, v217
s_waitcnt vmcnt(15) lgkmcnt(3)
v_mfma_f32_16x16x32_bf16 v[204:207], v[188:191], v[92:95], 0
v_cvt_pk_bf16_f32 v240, v240, v241
v_cvt_pk_bf16_f32 v241, v242, v243
v_cvt_pk_bf16_f32 v244, v244, v245
v_cvt_pk_bf16_f32 v245, v246, v247
s_waitcnt lgkmcnt(2)
v_mfma_f32_16x16x32_bf16 v[208:211], v[192:195], v[96:99], 0
s_add_u32 s91, s88, 0x609000
buffer_load_dwordx4 v[94:97], v46, s[60:63], s91 offen offset:0 sc1
ds_read_b128 v[180:183], v53 offset:3264
v_accvgpr_write_b32 a72, v240
v_accvgpr_write_b32 a73, v241
v_accvgpr_write_b32 a74, v244
v_accvgpr_write_b32 a75, v245
s_waitcnt vmcnt(15)
v_mfma_f32_16x16x32_bf16 v[212:215], v[188:191], v[142:145], 0
v_cvt_pk_bf16_f32 v248, v248, v249
v_cvt_pk_bf16_f32 v249, v250, v251
v_cvt_pk_bf16_f32 v252, v252, v253
v_cvt_pk_bf16_f32 v253, v254, v255
v_mfma_f32_16x16x32_bf16 v[216:219], v[192:195], v[146:149], 0
buffer_load_dwordx4 v[144:147], v46, s[60:63], s91 offen offset:1024 sc1
ds_read_b128 v[184:187], v54 offset:3264
v_accvgpr_write_b32 a76, v248
v_accvgpr_write_b32 a77, v249
v_accvgpr_write_b32 a78, v252
v_accvgpr_write_b32 a79, v253
s_waitcnt vmcnt(15) lgkmcnt(3)
v_mfma_f32_16x16x32_bf16 v[240:243], v[196:199], v[98:101], 0
v_cvt_pk_bf16_f32 v204, v204, v205
v_cvt_pk_bf16_f32 v205, v206, v207
v_cvt_pk_bf16_f32 v208, v208, v209
v_cvt_pk_bf16_f32 v209, v210, v211
s_waitcnt lgkmcnt(2)
v_mfma_f32_16x16x32_bf16 v[244:247], v[200:203], v[102:105], 0
buffer_load_dwordx4 v[100:103], v46, s[60:63], s91 offen offset:2048 sc1
ds_read_b128 v[188:191], v53 offset:3536
v_accvgpr_write_b32 a80, v204
v_accvgpr_write_b32 a81, v205
v_accvgpr_write_b32 a82, v208
v_accvgpr_write_b32 a83, v209
s_waitcnt vmcnt(15)
v_mfma_f32_16x16x32_bf16 v[248:251], v[196:199], v[148:151], 0
v_cvt_pk_bf16_f32 v212, v212, v213
v_cvt_pk_bf16_f32 v213, v214, v215
v_cvt_pk_bf16_f32 v216, v216, v217
v_cvt_pk_bf16_f32 v217, v218, v219
v_mfma_f32_16x16x32_bf16 v[252:255], v[200:203], v[152:155], 0
buffer_load_dwordx4 v[150:153], v46, s[60:63], s91 offen offset:3072 sc1
ds_read_b128 v[192:195], v54 offset:3536
v_accvgpr_write_b32 a84, v212
v_accvgpr_write_b32 a85, v213
v_accvgpr_write_b32 a86, v216
v_accvgpr_write_b32 a87, v217
s_waitcnt vmcnt(15) lgkmcnt(3)
v_mfma_f32_16x16x32_bf16 v[204:207], v[180:183], v[104:107], 0
v_cvt_pk_bf16_f32 v240, v240, v241
v_cvt_pk_bf16_f32 v241, v242, v243
v_cvt_pk_bf16_f32 v244, v244, v245
v_cvt_pk_bf16_f32 v245, v246, v247
s_waitcnt lgkmcnt(2)
v_mfma_f32_16x16x32_bf16 v[208:211], v[184:187], v[108:111], 0
s_add_u32 s91, s88, 0x60a000
buffer_load_dwordx4 v[106:109], v46, s[60:63], s91 offen offset:0 sc1
ds_read_b128 v[196:199], v53 offset:3808
v_accvgpr_write_b32 a88, v240
v_accvgpr_write_b32 a89, v241
v_accvgpr_write_b32 a90, v244
v_accvgpr_write_b32 a91, v245
s_waitcnt vmcnt(15)
v_mfma_f32_16x16x32_bf16 v[212:215], v[180:183], v[154:157], 0
v_cvt_pk_bf16_f32 v248, v248, v249
v_cvt_pk_bf16_f32 v249, v250, v251
v_cvt_pk_bf16_f32 v252, v252, v253
v_cvt_pk_bf16_f32 v253, v254, v255
v_mfma_f32_16x16x32_bf16 v[216:219], v[184:187], v[158:161], 0
buffer_load_dwordx4 v[156:159], v46, s[60:63], s91 offen offset:1024 sc1
ds_read_b128 v[200:203], v54 offset:3808
v_accvgpr_write_b32 a92, v248
v_accvgpr_write_b32 a93, v249
v_accvgpr_write_b32 a94, v252
v_accvgpr_write_b32 a95, v253
s_waitcnt vmcnt(15) lgkmcnt(3)
v_mfma_f32_16x16x32_bf16 v[240:243], v[188:191], v[110:113], 0
v_cvt_pk_bf16_f32 v204, v204, v205
v_cvt_pk_bf16_f32 v205, v206, v207
v_cvt_pk_bf16_f32 v208, v208, v209
v_cvt_pk_bf16_f32 v209, v210, v211
s_waitcnt lgkmcnt(2)
v_mfma_f32_16x16x32_bf16 v[244:247], v[192:195], v[114:117], 0
buffer_load_dwordx4 v[112:115], v46, s[60:63], s91 offen offset:2048 sc1
ds_read_b128 v[180:183], v53 offset:4080
v_accvgpr_write_b32 a96, v204
v_accvgpr_write_b32 a97, v205
v_accvgpr_write_b32 a98, v208
v_accvgpr_write_b32 a99, v209
s_waitcnt vmcnt(15)
v_mfma_f32_16x16x32_bf16 v[248:251], v[188:191], v[160:163], 0
v_cvt_pk_bf16_f32 v212, v212, v213
v_cvt_pk_bf16_f32 v213, v214, v215
v_cvt_pk_bf16_f32 v216, v216, v217
v_cvt_pk_bf16_f32 v217, v218, v219
v_mfma_f32_16x16x32_bf16 v[252:255], v[192:195], v[164:167], 0
buffer_load_dwordx4 v[162:165], v46, s[60:63], s91 offen offset:3072 sc1
ds_read_b128 v[184:187], v54 offset:4080
v_accvgpr_write_b32 a100, v212
v_accvgpr_write_b32 a101, v213
v_accvgpr_write_b32 a102, v216
v_accvgpr_write_b32 a103, v217
s_waitcnt vmcnt(15) lgkmcnt(3)
v_mfma_f32_16x16x32_bf16 v[204:207], v[196:199], v[116:119], 0
v_cvt_pk_bf16_f32 v240, v240, v241
v_cvt_pk_bf16_f32 v241, v242, v243
v_cvt_pk_bf16_f32 v244, v244, v245
v_cvt_pk_bf16_f32 v245, v246, v247
s_waitcnt lgkmcnt(2)
v_mfma_f32_16x16x32_bf16 v[208:211], v[200:203], v[120:123], 0
s_add_u32 s91, s88, 0x60b000
buffer_load_dwordx4 v[118:121], v46, s[60:63], s91 offen offset:0 sc1
ds_read_b128 v[188:191], v53 offset:4352
v_accvgpr_write_b32 a104, v240
v_accvgpr_write_b32 a105, v241
v_accvgpr_write_b32 a106, v244
v_accvgpr_write_b32 a107, v245
s_waitcnt vmcnt(15)
v_mfma_f32_16x16x32_bf16 v[212:215], v[196:199], v[166:169], 0
v_cvt_pk_bf16_f32 v248, v248, v249
v_cvt_pk_bf16_f32 v249, v250, v251
v_cvt_pk_bf16_f32 v252, v252, v253
v_cvt_pk_bf16_f32 v253, v254, v255
v_mfma_f32_16x16x32_bf16 v[216:219], v[200:203], v[170:173], 0
buffer_load_dwordx4 v[168:171], v46, s[60:63], s91 offen offset:1024 sc1
ds_read_b128 v[192:195], v54 offset:4352
v_accvgpr_write_b32 a108, v248
v_accvgpr_write_b32 a109, v249
v_accvgpr_write_b32 a110, v252
v_accvgpr_write_b32 a111, v253
s_waitcnt vmcnt(15) lgkmcnt(3)
v_mfma_f32_16x16x32_bf16 v[240:243], v[180:183], v[122:125], 0
v_cvt_pk_bf16_f32 v204, v204, v205
v_cvt_pk_bf16_f32 v205, v206, v207
v_cvt_pk_bf16_f32 v208, v208, v209
v_cvt_pk_bf16_f32 v209, v210, v211
s_waitcnt lgkmcnt(2)
v_mfma_f32_16x16x32_bf16 v[244:247], v[184:187], v[126:129], 0
buffer_load_dwordx4 v[124:127], v46, s[60:63], s91 offen offset:2048 sc1
ds_read_b128 v[196:199], v53 offset:4624
v_accvgpr_write_b32 a112, v204
v_accvgpr_write_b32 a113, v205
v_accvgpr_write_b32 a114, v208
v_accvgpr_write_b32 a115, v209
s_waitcnt vmcnt(15)
v_mfma_f32_16x16x32_bf16 v[248:251], v[180:183], v[172:175], 0
v_cvt_pk_bf16_f32 v212, v212, v213
v_cvt_pk_bf16_f32 v213, v214, v215
v_cvt_pk_bf16_f32 v216, v216, v217
v_cvt_pk_bf16_f32 v217, v218, v219
v_mfma_f32_16x16x32_bf16 v[252:255], v[184:187], v[176:179], 0
buffer_load_dwordx4 v[174:177], v46, s[60:63], s91 offen offset:3072 sc1
ds_read_b128 v[200:203], v54 offset:4624
v_accvgpr_write_b32 a116, v212
v_accvgpr_write_b32 a117, v213
v_accvgpr_write_b32 a118, v216
v_accvgpr_write_b32 a119, v217
s_waitcnt vmcnt(15) lgkmcnt(3)
v_mfma_f32_16x16x32_bf16 v[204:207], v[188:191], v[80:83], 0
v_cvt_pk_bf16_f32 v240, v240, v241
v_cvt_pk_bf16_f32 v241, v242, v243
v_cvt_pk_bf16_f32 v244, v244, v245
v_cvt_pk_bf16_f32 v245, v246, v247
s_waitcnt lgkmcnt(2)
v_mfma_f32_16x16x32_bf16 v[208:211], v[192:195], v[84:87], 0
s_add_u32 s91, s88, 0x60c000
buffer_load_dwordx4 v[82:85], v46, s[60:63], s91 offen offset:0 sc1
ds_read_b128 v[180:183], v53 offset:4896
v_accvgpr_write_b32 a120, v240
v_accvgpr_write_b32 a121, v241
v_accvgpr_write_b32 a122, v244
v_accvgpr_write_b32 a123, v245
s_waitcnt vmcnt(15)
v_mfma_f32_16x16x32_bf16 v[212:215], v[188:191], v[130:133], 0
v_cvt_pk_bf16_f32 v248, v248, v249
v_cvt_pk_bf16_f32 v249, v250, v251
v_cvt_pk_bf16_f32 v252, v252, v253
v_cvt_pk_bf16_f32 v253, v254, v255
v_mfma_f32_16x16x32_bf16 v[216:219], v[192:195], v[134:137], 0
buffer_load_dwordx4 v[132:135], v46, s[60:63], s91 offen offset:1024 sc1
ds_read_b128 v[184:187], v54 offset:4896
v_accvgpr_write_b32 a124, v248
v_accvgpr_write_b32 a125, v249
v_accvgpr_write_b32 a126, v252
v_accvgpr_write_b32 a127, v253
s_waitcnt vmcnt(15) lgkmcnt(3)
v_mfma_f32_16x16x32_bf16 v[240:243], v[196:199], v[86:89], 0
v_cvt_pk_bf16_f32 v204, v204, v205
v_cvt_pk_bf16_f32 v205, v206, v207
v_cvt_pk_bf16_f32 v208, v208, v209
v_cvt_pk_bf16_f32 v209, v210, v211
s_waitcnt lgkmcnt(2)
v_mfma_f32_16x16x32_bf16 v[244:247], v[200:203], v[90:93], 0
buffer_load_dwordx4 v[88:91], v46, s[60:63], s91 offen offset:2048 sc1
ds_read_b128 v[188:191], v53 offset:5168
v_accvgpr_write_b32 a128, v204
v_accvgpr_write_b32 a129, v205
v_accvgpr_write_b32 a130, v208
v_accvgpr_write_b32 a131, v209
s_waitcnt vmcnt(15)
v_mfma_f32_16x16x32_bf16 v[248:251], v[196:199], v[136:139], 0
v_cvt_pk_bf16_f32 v212, v212, v213
v_cvt_pk_bf16_f32 v213, v214, v215
v_cvt_pk_bf16_f32 v216, v216, v217
v_cvt_pk_bf16_f32 v217, v218, v219
v_mfma_f32_16x16x32_bf16 v[252:255], v[200:203], v[140:143], 0
buffer_load_dwordx4 v[138:141], v46, s[60:63], s91 offen offset:3072 sc1
ds_read_b128 v[192:195], v54 offset:5168
v_accvgpr_write_b32 a132, v212
v_accvgpr_write_b32 a133, v213
v_accvgpr_write_b32 a134, v216
v_accvgpr_write_b32 a135, v217
s_waitcnt vmcnt(15) lgkmcnt(3)
v_mfma_f32_16x16x32_bf16 v[204:207], v[180:183], v[92:95], 0
v_cvt_pk_bf16_f32 v240, v240, v241
v_cvt_pk_bf16_f32 v241, v242, v243
v_cvt_pk_bf16_f32 v244, v244, v245
v_cvt_pk_bf16_f32 v245, v246, v247
s_waitcnt lgkmcnt(2)
v_mfma_f32_16x16x32_bf16 v[208:211], v[184:187], v[96:99], 0
s_add_u32 s91, s88, 0x60d000
buffer_load_dwordx4 v[94:97], v46, s[60:63], s91 offen offset:0 sc1
ds_read_b128 v[196:199], v53 offset:5440
v_accvgpr_write_b32 a136, v240
v_accvgpr_write_b32 a137, v241
v_accvgpr_write_b32 a138, v244
v_accvgpr_write_b32 a139, v245
s_waitcnt vmcnt(15)
v_mfma_f32_16x16x32_bf16 v[212:215], v[180:183], v[142:145], 0
v_cvt_pk_bf16_f32 v248, v248, v249
v_cvt_pk_bf16_f32 v249, v250, v251
v_cvt_pk_bf16_f32 v252, v252, v253
v_cvt_pk_bf16_f32 v253, v254, v255
v_mfma_f32_16x16x32_bf16 v[216:219], v[184:187], v[146:149], 0
buffer_load_dwordx4 v[144:147], v46, s[60:63], s91 offen offset:1024 sc1
ds_read_b128 v[200:203], v54 offset:5440
v_accvgpr_write_b32 a140, v248
v_accvgpr_write_b32 a141, v249
v_accvgpr_write_b32 a142, v252
v_accvgpr_write_b32 a143, v253
s_waitcnt vmcnt(15) lgkmcnt(3)
v_mfma_f32_16x16x32_bf16 v[240:243], v[188:191], v[98:101], 0
v_cvt_pk_bf16_f32 v204, v204, v205
v_cvt_pk_bf16_f32 v205, v206, v207
v_cvt_pk_bf16_f32 v208, v208, v209
v_cvt_pk_bf16_f32 v209, v210, v211
s_waitcnt lgkmcnt(2)
v_mfma_f32_16x16x32_bf16 v[244:247], v[192:195], v[102:105], 0
buffer_load_dwordx4 v[100:103], v46, s[60:63], s91 offen offset:2048 sc1
ds_read_b128 v[180:183], v53 offset:5712
v_accvgpr_write_b32 a144, v204
v_accvgpr_write_b32 a145, v205
v_accvgpr_write_b32 a146, v208
v_accvgpr_write_b32 a147, v209
s_waitcnt vmcnt(15)
v_mfma_f32_16x16x32_bf16 v[248:251], v[188:191], v[148:151], 0
v_cvt_pk_bf16_f32 v212, v212, v213
v_cvt_pk_bf16_f32 v213, v214, v215
v_cvt_pk_bf16_f32 v216, v216, v217
v_cvt_pk_bf16_f32 v217, v218, v219
v_mfma_f32_16x16x32_bf16 v[252:255], v[192:195], v[152:155], 0
buffer_load_dwordx4 v[150:153], v46, s[60:63], s91 offen offset:3072 sc1
ds_read_b128 v[184:187], v54 offset:5712
v_accvgpr_write_b32 a148, v212
v_accvgpr_write_b32 a149, v213
v_accvgpr_write_b32 a150, v216
v_accvgpr_write_b32 a151, v217
s_waitcnt vmcnt(15) lgkmcnt(3)
v_mfma_f32_16x16x32_bf16 v[204:207], v[196:199], v[104:107], 0
v_cvt_pk_bf16_f32 v240, v240, v241
v_cvt_pk_bf16_f32 v241, v242, v243
v_cvt_pk_bf16_f32 v244, v244, v245
v_cvt_pk_bf16_f32 v245, v246, v247
s_waitcnt lgkmcnt(2)
v_mfma_f32_16x16x32_bf16 v[208:211], v[200:203], v[108:111], 0
s_add_u32 s91, s88, 0x60e000
buffer_load_dwordx4 v[106:109], v46, s[60:63], s91 offen offset:0 sc1
ds_read_b128 v[188:191], v53 offset:5984
v_accvgpr_write_b32 a152, v240
v_accvgpr_write_b32 a153, v241
v_accvgpr_write_b32 a154, v244
v_accvgpr_write_b32 a155, v245
s_waitcnt vmcnt(15)
v_mfma_f32_16x16x32_bf16 v[212:215], v[196:199], v[154:157], 0
v_cvt_pk_bf16_f32 v248, v248, v249
v_cvt_pk_bf16_f32 v249, v250, v251
v_cvt_pk_bf16_f32 v252, v252, v253
v_cvt_pk_bf16_f32 v253, v254, v255
v_mfma_f32_16x16x32_bf16 v[216:219], v[200:203], v[158:161], 0
buffer_load_dwordx4 v[156:159], v46, s[60:63], s91 offen offset:1024 sc1
ds_read_b128 v[192:195], v54 offset:5984
v_accvgpr_write_b32 a156, v248
v_accvgpr_write_b32 a157, v249
v_accvgpr_write_b32 a158, v252
v_accvgpr_write_b32 a159, v253
s_waitcnt vmcnt(15) lgkmcnt(3)
v_mfma_f32_16x16x32_bf16 v[240:243], v[180:183], v[110:113], 0
v_cvt_pk_bf16_f32 v204, v204, v205
v_cvt_pk_bf16_f32 v205, v206, v207
v_cvt_pk_bf16_f32 v208, v208, v209
v_cvt_pk_bf16_f32 v209, v210, v211
s_waitcnt lgkmcnt(2)
v_mfma_f32_16x16x32_bf16 v[244:247], v[184:187], v[114:117], 0
buffer_load_dwordx4 v[112:115], v46, s[60:63], s91 offen offset:2048 sc1
ds_read_b128 v[196:199], v53 offset:6256
v_accvgpr_write_b32 a160, v204
v_accvgpr_write_b32 a161, v205
v_accvgpr_write_b32 a162, v208
v_accvgpr_write_b32 a163, v209
s_waitcnt vmcnt(15)
v_mfma_f32_16x16x32_bf16 v[248:251], v[180:183], v[160:163], 0
v_cvt_pk_bf16_f32 v212, v212, v213
v_cvt_pk_bf16_f32 v213, v214, v215
v_cvt_pk_bf16_f32 v216, v216, v217
v_cvt_pk_bf16_f32 v217, v218, v219
v_mfma_f32_16x16x32_bf16 v[252:255], v[184:187], v[164:167], 0
buffer_load_dwordx4 v[162:165], v46, s[60:63], s91 offen offset:3072 sc1
ds_read_b128 v[200:203], v54 offset:6256
v_accvgpr_write_b32 a164, v212
v_accvgpr_write_b32 a165, v213
v_accvgpr_write_b32 a166, v216
v_accvgpr_write_b32 a167, v217
s_waitcnt vmcnt(15) lgkmcnt(3)
v_mfma_f32_16x16x32_bf16 v[204:207], v[188:191], v[116:119], 0
v_cvt_pk_bf16_f32 v240, v240, v241
v_cvt_pk_bf16_f32 v241, v242, v243
v_cvt_pk_bf16_f32 v244, v244, v245
v_cvt_pk_bf16_f32 v245, v246, v247
s_waitcnt lgkmcnt(2)
v_mfma_f32_16x16x32_bf16 v[208:211], v[192:195], v[120:123], 0
s_add_u32 s91, s88, 0x60f000
buffer_load_dwordx4 v[118:121], v46, s[60:63], s91 offen offset:0 sc1
ds_read_b128 v[180:183], v53 offset:6528
v_accvgpr_write_b32 a168, v240
v_accvgpr_write_b32 a169, v241
v_accvgpr_write_b32 a170, v244
v_accvgpr_write_b32 a171, v245
s_waitcnt vmcnt(15)
v_mfma_f32_16x16x32_bf16 v[212:215], v[188:191], v[166:169], 0
v_cvt_pk_bf16_f32 v248, v248, v249
v_cvt_pk_bf16_f32 v249, v250, v251
v_cvt_pk_bf16_f32 v252, v252, v253
v_cvt_pk_bf16_f32 v253, v254, v255
v_mfma_f32_16x16x32_bf16 v[216:219], v[192:195], v[170:173], 0
buffer_load_dwordx4 v[168:171], v46, s[60:63], s91 offen offset:1024 sc1
ds_read_b128 v[184:187], v54 offset:6528
v_accvgpr_write_b32 a172, v248
v_accvgpr_write_b32 a173, v249
v_accvgpr_write_b32 a174, v252
v_accvgpr_write_b32 a175, v253
s_waitcnt vmcnt(15) lgkmcnt(3)
v_mfma_f32_16x16x32_bf16 v[240:243], v[196:199], v[122:125], 0
v_cvt_pk_bf16_f32 v204, v204, v205
v_cvt_pk_bf16_f32 v205, v206, v207
v_cvt_pk_bf16_f32 v208, v208, v209
v_cvt_pk_bf16_f32 v209, v210, v211
s_waitcnt lgkmcnt(2)
v_mfma_f32_16x16x32_bf16 v[244:247], v[200:203], v[126:129], 0
buffer_load_dwordx4 v[124:127], v46, s[60:63], s91 offen offset:2048 sc1
ds_read_b128 v[188:191], v53 offset:6800
v_accvgpr_write_b32 a176, v204
v_accvgpr_write_b32 a177, v205
v_accvgpr_write_b32 a178, v208
v_accvgpr_write_b32 a179, v209
s_waitcnt vmcnt(15)
v_mfma_f32_16x16x32_bf16 v[248:251], v[196:199], v[172:175], 0
v_cvt_pk_bf16_f32 v212, v212, v213
v_cvt_pk_bf16_f32 v213, v214, v215
v_cvt_pk_bf16_f32 v216, v216, v217
v_cvt_pk_bf16_f32 v217, v218, v219
v_mfma_f32_16x16x32_bf16 v[252:255], v[200:203], v[176:179], 0
buffer_load_dwordx4 v[174:177], v46, s[60:63], s91 offen offset:3072 sc1
ds_read_b128 v[192:195], v54 offset:6800
v_accvgpr_write_b32 a180, v212
v_accvgpr_write_b32 a181, v213
v_accvgpr_write_b32 a182, v216
v_accvgpr_write_b32 a183, v217
s_waitcnt vmcnt(15) lgkmcnt(3)
v_mfma_f32_16x16x32_bf16 v[204:207], v[180:183], v[80:83], 0
v_cvt_pk_bf16_f32 v240, v240, v241
v_cvt_pk_bf16_f32 v241, v242, v243
v_cvt_pk_bf16_f32 v244, v244, v245
v_cvt_pk_bf16_f32 v245, v246, v247
s_waitcnt lgkmcnt(2)
v_mfma_f32_16x16x32_bf16 v[208:211], v[184:187], v[84:87], 0
ds_read_b128 v[196:199], v53 offset:7072
v_accvgpr_write_b32 a184, v240
v_accvgpr_write_b32 a185, v241
v_accvgpr_write_b32 a186, v244
v_accvgpr_write_b32 a187, v245
s_waitcnt vmcnt(14)
v_mfma_f32_16x16x32_bf16 v[212:215], v[180:183], v[130:133], 0
v_cvt_pk_bf16_f32 v248, v248, v249
v_cvt_pk_bf16_f32 v249, v250, v251
v_cvt_pk_bf16_f32 v252, v252, v253
v_cvt_pk_bf16_f32 v253, v254, v255
v_mfma_f32_16x16x32_bf16 v[216:219], v[184:187], v[134:137], 0
ds_read_b128 v[200:203], v54 offset:7072
v_accvgpr_write_b32 a188, v248
v_accvgpr_write_b32 a189, v249
v_accvgpr_write_b32 a190, v252
v_accvgpr_write_b32 a191, v253
s_add_u32 m0, s76, 98304
s_add_u32 s77, s82, 0x380000
buffer_load_dwordx4 v30, s[40:43], s77 offen offset:0 lds
buffer_load_dwordx4 v31, s[40:43], s77 offen offset:1024 lds
buffer_load_dwordx4 v32, s[40:43], s77 offen offset:2048 lds
buffer_load_dwordx4 v33, s[40:43], s77 offen offset:3072 lds
s_waitcnt vmcnt(17) lgkmcnt(3)
v_mfma_f32_16x16x32_bf16 v[240:243], v[188:191], v[86:89], 0
v_cvt_pk_bf16_f32 v204, v204, v205
v_cvt_pk_bf16_f32 v205, v206, v207
v_cvt_pk_bf16_f32 v208, v208, v209
v_cvt_pk_bf16_f32 v209, v210, v211
s_waitcnt lgkmcnt(2)
v_mfma_f32_16x16x32_bf16 v[244:247], v[192:195], v[90:93], 0
ds_read_b128 v[180:183], v53 offset:7344
v_accvgpr_write_b32 a192, v204
v_accvgpr_write_b32 a193, v205
v_accvgpr_write_b32 a194, v208
v_accvgpr_write_b32 a195, v209
s_waitcnt vmcnt(16)
v_mfma_f32_16x16x32_bf16 v[248:251], v[188:191], v[136:139], 0
v_cvt_pk_bf16_f32 v212, v212, v213
v_cvt_pk_bf16_f32 v213, v214, v215
v_cvt_pk_bf16_f32 v216, v216, v217
v_cvt_pk_bf16_f32 v217, v218, v219
v_mfma_f32_16x16x32_bf16 v[252:255], v[192:195], v[140:143], 0
ds_read_b128 v[184:187], v54 offset:7344
v_accvgpr_write_b32 a196, v212
v_accvgpr_write_b32 a197, v213
v_accvgpr_write_b32 a198, v216
v_accvgpr_write_b32 a199, v217
s_waitcnt vmcnt(15) lgkmcnt(3)
v_mfma_f32_16x16x32_bf16 v[204:207], v[196:199], v[92:95], 0
v_cvt_pk_bf16_f32 v240, v240, v241
v_cvt_pk_bf16_f32 v241, v242, v243
v_cvt_pk_bf16_f32 v244, v244, v245
v_cvt_pk_bf16_f32 v245, v246, v247
s_waitcnt lgkmcnt(2)
v_mfma_f32_16x16x32_bf16 v[208:211], v[200:203], v[96:99], 0
ds_read_b128 v[188:191], v53 offset:7616
v_accvgpr_write_b32 a200, v240
v_accvgpr_write_b32 a201, v241
v_accvgpr_write_b32 a202, v244
v_accvgpr_write_b32 a203, v245
s_add_u32 m0, s76, 102400
s_add_u32 s77, s82, 0x460000
buffer_load_dwordx4 v30, s[40:43], s77 offen offset:0 lds
buffer_load_dwordx4 v31, s[40:43], s77 offen offset:1024 lds
buffer_load_dwordx4 v32, s[40:43], s77 offen offset:2048 lds
buffer_load_dwordx4 v33, s[40:43], s77 offen offset:3072 lds
s_waitcnt vmcnt(18)
v_mfma_f32_16x16x32_bf16 v[212:215], v[196:199], v[142:145], 0
v_cvt_pk_bf16_f32 v248, v248, v249
v_cvt_pk_bf16_f32 v249, v250, v251
v_cvt_pk_bf16_f32 v252, v252, v253
v_cvt_pk_bf16_f32 v253, v254, v255
v_mfma_f32_16x16x32_bf16 v[216:219], v[200:203], v[146:149], 0
ds_read_b128 v[192:195], v54 offset:7616
v_accvgpr_write_b32 a204, v248
v_accvgpr_write_b32 a205, v249
v_accvgpr_write_b32 a206, v252
v_accvgpr_write_b32 a207, v253
s_waitcnt vmcnt(17) lgkmcnt(3)
v_mfma_f32_16x16x32_bf16 v[240:243], v[180:183], v[98:101], 0
v_cvt_pk_bf16_f32 v204, v204, v205
v_cvt_pk_bf16_f32 v205, v206, v207
v_cvt_pk_bf16_f32 v208, v208, v209
v_cvt_pk_bf16_f32 v209, v210, v211
s_waitcnt lgkmcnt(2)
v_mfma_f32_16x16x32_bf16 v[244:247], v[184:187], v[102:105], 0
ds_read_b128 v[196:199], v53 offset:7888
v_accvgpr_write_b32 a208, v204
v_accvgpr_write_b32 a209, v205
v_accvgpr_write_b32 a210, v208
v_accvgpr_write_b32 a211, v209
s_waitcnt vmcnt(16)
v_mfma_f32_16x16x32_bf16 v[248:251], v[180:183], v[148:151], 0
v_cvt_pk_bf16_f32 v212, v212, v213
v_cvt_pk_bf16_f32 v213, v214, v215
v_cvt_pk_bf16_f32 v216, v216, v217
v_cvt_pk_bf16_f32 v217, v218, v219
v_mfma_f32_16x16x32_bf16 v[252:255], v[184:187], v[152:155], 0
ds_read_b128 v[200:203], v54 offset:7888
v_accvgpr_write_b32 a212, v212
v_accvgpr_write_b32 a213, v213
v_accvgpr_write_b32 a214, v216
v_accvgpr_write_b32 a215, v217
s_mul_i32 s3, s101, 7168
s_add_u32 s3, s3, 0x0
buffer_load_dword v57, v8, s[44:47], s3 offen
s_waitcnt vmcnt(16) lgkmcnt(3)
v_mfma_f32_16x16x32_bf16 v[204:207], v[188:191], v[104:107], 0
v_cvt_pk_bf16_f32 v240, v240, v241
v_cvt_pk_bf16_f32 v241, v242, v243
v_cvt_pk_bf16_f32 v244, v244, v245
v_cvt_pk_bf16_f32 v245, v246, v247
s_waitcnt lgkmcnt(2)
v_mfma_f32_16x16x32_bf16 v[208:211], v[192:195], v[108:111], 0
ds_read_b128 v[180:183], v53 offset:8160
v_accvgpr_write_b32 a216, v240
v_accvgpr_write_b32 a217, v241
v_accvgpr_write_b32 a218, v244
v_accvgpr_write_b32 a219, v245
s_waitcnt vmcnt(15)
v_mfma_f32_16x16x32_bf16 v[212:215], v[188:191], v[154:157], 0
v_cvt_pk_bf16_f32 v248, v248, v249
v_cvt_pk_bf16_f32 v249, v250, v251
v_cvt_pk_bf16_f32 v252, v252, v253
v_cvt_pk_bf16_f32 v253, v254, v255
v_mfma_f32_16x16x32_bf16 v[216:219], v[192:195], v[158:161], 0
ds_read_b128 v[184:187], v54 offset:8160
v_accvgpr_write_b32 a220, v248
v_accvgpr_write_b32 a221, v249
v_accvgpr_write_b32 a222, v252
v_accvgpr_write_b32 a223, v253
s_waitcnt vmcnt(14) lgkmcnt(3)
v_mfma_f32_16x16x32_bf16 v[240:243], v[196:199], v[110:113], 0
v_cvt_pk_bf16_f32 v204, v204, v205
v_cvt_pk_bf16_f32 v205, v206, v207
v_cvt_pk_bf16_f32 v208, v208, v209
v_cvt_pk_bf16_f32 v209, v210, v211
s_waitcnt lgkmcnt(2)
v_mfma_f32_16x16x32_bf16 v[244:247], v[200:203], v[114:117], 0
ds_read_b128 v[188:191], v53 offset:8432
v_accvgpr_write_b32 a224, v204
v_accvgpr_write_b32 a225, v205
v_accvgpr_write_b32 a226, v208
v_accvgpr_write_b32 a227, v209
s_waitcnt vmcnt(13)
v_mfma_f32_16x16x32_bf16 v[248:251], v[196:199], v[160:163], 0
v_cvt_pk_bf16_f32 v212, v212, v213
v_cvt_pk_bf16_f32 v213, v214, v215
v_cvt_pk_bf16_f32 v216, v216, v217
v_cvt_pk_bf16_f32 v217, v218, v219
v_mfma_f32_16x16x32_bf16 v[252:255], v[200:203], v[164:167], 0
ds_read_b128 v[192:195], v54 offset:8432
v_accvgpr_write_b32 a228, v212
v_accvgpr_write_b32 a229, v213
v_accvgpr_write_b32 a230, v216
v_accvgpr_write_b32 a231, v217
s_waitcnt vmcnt(12) lgkmcnt(3)
v_mfma_f32_16x16x32_bf16 v[204:207], v[180:183], v[116:119], 0
v_cvt_pk_bf16_f32 v240, v240, v241
v_cvt_pk_bf16_f32 v241, v242, v243
v_cvt_pk_bf16_f32 v244, v244, v245
v_cvt_pk_bf16_f32 v245, v246, v247
s_waitcnt lgkmcnt(2)
v_mfma_f32_16x16x32_bf16 v[208:211], v[184:187], v[120:123], 0
v_accvgpr_write_b32 a232, v240
v_accvgpr_write_b32 a233, v241
v_accvgpr_write_b32 a234, v244
v_accvgpr_write_b32 a235, v245
s_waitcnt vmcnt(11)
v_mfma_f32_16x16x32_bf16 v[212:215], v[180:183], v[166:169], 0
v_cvt_pk_bf16_f32 v248, v248, v249
v_cvt_pk_bf16_f32 v249, v250, v251
v_cvt_pk_bf16_f32 v252, v252, v253
v_cvt_pk_bf16_f32 v253, v254, v255
v_mfma_f32_16x16x32_bf16 v[216:219], v[184:187], v[170:173], 0
v_accvgpr_write_b32 a236, v248
v_accvgpr_write_b32 a237, v249
v_accvgpr_write_b32 a238, v252
v_accvgpr_write_b32 a239, v253
s_waitcnt vmcnt(10) lgkmcnt(1)
v_mfma_f32_16x16x32_bf16 v[240:243], v[188:191], v[122:125], 0
v_cvt_pk_bf16_f32 v204, v204, v205
v_cvt_pk_bf16_f32 v205, v206, v207
v_cvt_pk_bf16_f32 v208, v208, v209
v_cvt_pk_bf16_f32 v209, v210, v211
s_waitcnt lgkmcnt(0)
v_mfma_f32_16x16x32_bf16 v[244:247], v[192:195], v[126:129], 0
v_accvgpr_write_b32 a240, v204
v_accvgpr_write_b32 a241, v205
v_accvgpr_write_b32 a242, v208
v_accvgpr_write_b32 a243, v209
s_waitcnt vmcnt(9)
v_mfma_f32_16x16x32_bf16 v[248:251], v[188:191], v[172:175], 0
v_cvt_pk_bf16_f32 v212, v212, v213
v_cvt_pk_bf16_f32 v213, v214, v215
v_cvt_pk_bf16_f32 v216, v216, v217
v_cvt_pk_bf16_f32 v217, v218, v219
v_mfma_f32_16x16x32_bf16 v[252:255], v[192:195], v[176:179], 0
v_accvgpr_write_b32 a244, v212
v_accvgpr_write_b32 a245, v213
v_accvgpr_write_b32 a246, v216
v_accvgpr_write_b32 a247, v217
v_cvt_pk_bf16_f32 v240, v240, v241
v_cvt_pk_bf16_f32 v241, v242, v243
v_cvt_pk_bf16_f32 v244, v244, v245
v_cvt_pk_bf16_f32 v245, v246, v247
v_accvgpr_write_b32 a248, v240
v_accvgpr_write_b32 a249, v241
v_accvgpr_write_b32 a250, v244
v_accvgpr_write_b32 a251, v245
v_cvt_pk_bf16_f32 v248, v248, v249
v_cvt_pk_bf16_f32 v249, v250, v251
v_cvt_pk_bf16_f32 v252, v252, v253
v_cvt_pk_bf16_f32 v253, v254, v255
v_accvgpr_write_b32 a252, v248
v_accvgpr_write_b32 a253, v249
v_accvgpr_write_b32 a254, v252
v_accvgpr_write_b32 a255, v253
v_mul_f32 v60, 0xbfb8aa3b, v58
v_mul_f32 v62, v76, v76
v_mul_f32 v61, 0xbfb8aa3b, v59
v_mul_f32 v63, v77, v77
s_barrier
ds_read_b64_tr_b16 v[96:97], v10 offset:32768
ds_read_b64_tr_b16 v[98:99], v10 offset:49152
ds_read_b64_tr_b16 v[100:101], v11 offset:32768
ds_read_b64_tr_b16 v[102:103], v11 offset:49152
ds_read_b64_tr_b16 v[104:105], v12 offset:32768
ds_read_b64_tr_b16 v[106:107], v12 offset:49152
ds_read_b64_tr_b16 v[108:109], v13 offset:32768
ds_read_b64_tr_b16 v[110:111], v13 offset:49152
ds_read_b64_tr_b16 v[112:113], v10 offset:33792
ds_read_b64_tr_b16 v[114:115], v10 offset:50176
ds_read_b64_tr_b16 v[116:117], v11 offset:33792
ds_read_b64_tr_b16 v[118:119], v11 offset:50176
ds_read_b64_tr_b16 v[120:121], v12 offset:33792
ds_read_b64_tr_b16 v[122:123], v12 offset:50176
ds_read_b64_tr_b16 v[124:125], v13 offset:33792
ds_read_b64_tr_b16 v[126:127], v13 offset:50176
S_G0:
s_waitcnt lgkmcnt(14)
v_mfma_f32_16x16x32_bf16 v[128:131], v[96:99], a[0:3], 0
ds_read_b64_tr_b16 v[80:81], v10 offset:34816
ds_read_b64_tr_b16 v[82:83], v10 offset:51200
v_mfma_f32_16x16x32_bf16 v[144:147], v[96:99], a[4:7], 0
ds_read_b64_tr_b16 v[84:85], v11 offset:34816
s_waitcnt lgkmcnt(15)
v_mfma_f32_16x16x32_bf16 v[132:135], v[100:103], a[0:3], 0
ds_read_b64_tr_b16 v[86:87], v11 offset:51200
s_add_u32 m0, s76, 0
v_mfma_f32_16x16x32_bf16 v[148:151], v[100:103], a[4:7], 0
ds_read_b64_tr_b16 v[88:89], v12 offset:34816
s_waitcnt lgkmcnt(15)
v_mfma_f32_16x16x32_bf16 v[136:139], v[104:107], a[0:3], 0
s_add_u32 s70, s0, S_H0 - K_pc + 0
s_addc_u32 s71, s1, 0
global_load_dword v57, v9, s[70:71]
v_mfma_f32_16x16x32_bf16 v[152:155], v[104:107], a[4:7], 0
ds_read_b64_tr_b16 v[90:91], v12 offset:51200
s_waitcnt lgkmcnt(6)
v_mfma_f32_16x16x32_bf16 v[140:143], v[108:111], a[0:3], 0
ds_read_b64_tr_b16 v[92:93], v13 offset:34816
s_add_u32 s77, s82, 0x540000
v_mfma_f32_16x16x32_bf16 v[156:159], v[108:111], a[4:7], 0
ds_read_b64_tr_b16 v[94:95], v13 offset:51200
ds_read_b64_tr_b16 v[96:97], v10 offset:35840
v_mfma_f32_16x16x32_bf16 v[128:131], v[112:115], a[8:11], v[128:131]
buffer_load_dwordx4 v30, s[40:43], s77 offen offset:0 lds
v_mfma_f32_16x16x32_bf16 v[144:147], v[112:115], a[12:15], v[144:147]
ds_read_b64_tr_b16 v[98:99], v10 offset:52224
ds_read_b64_tr_b16 v[100:101], v11 offset:35840
v_mfma_f32_16x16x32_bf16 v[132:135], v[116:119], a[8:11], v[132:135]
ds_read_b64_tr_b16 v[102:103], v11 offset:52224
s_and_b32 s79, s74, 12
v_mfma_f32_16x16x32_bf16 v[148:151], v[116:119], a[12:15], v[148:151]
ds_read_b64_tr_b16 v[104:105], v12 offset:35840
ds_read_b64_tr_b16 v[106:107], v12 offset:52224
v_mfma_f32_16x16x32_bf16 v[136:139], v[120:123], a[8:11], v[136:139]
ds_read_b64_tr_b16 v[108:109], v13 offset:35840
s_add_u32 s78, s74, 1
v_mfma_f32_16x16x32_bf16 v[152:155], v[120:123], a[12:15], v[152:155]
ds_read_b64_tr_b16 v[110:111], v13 offset:52224
ds_read_b64_tr_b16 v[112:113], v10 offset:36864
v_mfma_f32_16x16x32_bf16 v[140:143], v[124:127], a[8:11], v[140:143]
buffer_load_dwordx4 v31, s[40:43], s77 offen offset:1024 lds
v_mfma_f32_16x16x32_bf16 v[156:159], v[124:127], a[12:15], v[156:159]
ds_read_b64_tr_b16 v[114:115], v10 offset:53248
s_waitcnt lgkmcnt(7)
v_mfma_f32_16x16x32_bf16 v[128:131], v[80:83], a[16:19], v[128:131]
ds_read_b64_tr_b16 v[116:117], v11 offset:36864
ds_read_b64_tr_b16 v[118:119], v11 offset:53248
v_mfma_f32_16x16x32_bf16 v[144:147], v[80:83], a[20:23], v[144:147]
ds_read_b64_tr_b16 v[120:121], v12 offset:36864
s_and_b32 s78, s78, 3
v_mfma_f32_16x16x32_bf16 v[132:135], v[84:87], a[16:19], v[132:135]
ds_read_b64_tr_b16 v[122:123], v12 offset:53248
ds_read_b64_tr_b16 v[124:125], v13 offset:36864
v_mfma_f32_16x16x32_bf16 v[148:151], v[84:87], a[20:23], v[148:151]
ds_read_b64_tr_b16 v[126:127], v13 offset:53248
s_add_u32 s78, s78, s79
v_mfma_f32_16x16x32_bf16 v[136:139], v[88:91], a[16:19], v[136:139]
buffer_load_dwordx4 v32, s[40:43], s77 offen offset:2048 lds
v_mfma_f32_16x16x32_bf16 v[152:155], v[88:91], a[20:23], v[152:155]
ds_read_b64_tr_b16 v[80:81], v10 offset:37888
ds_read_b64_tr_b16 v[82:83], v10 offset:54272
v_mfma_f32_16x16x32_bf16 v[140:143], v[92:95], a[16:19], v[140:143]
ds_read_b64_tr_b16 v[84:85], v11 offset:37888
s_lshl_b32 s78, s78, 7
v_mfma_f32_16x16x32_bf16 v[156:159], v[92:95], a[20:23], v[156:159]
ds_read_b64_tr_b16 v[86:87], v11 offset:54272
s_add_u32 s84, s78, 2048
v_mfma_f32_16x16x32_bf16 v[128:131], v[96:99], a[24:27], v[128:131]
ds_read_b64_tr_b16 v[88:89], v12 offset:37888
s_add_u32 s78, s74, 2
v_mfma_f32_16x16x32_bf16 v[144:147], v[96:99], a[28:31], v[144:147]
ds_read_b64_tr_b16 v[90:91], v12 offset:54272
s_waitcnt lgkmcnt(6)
v_mfma_f32_16x16x32_bf16 v[132:135], v[100:103], a[24:27], v[132:135]
buffer_load_dwordx4 v33, s[40:43], s77 offen offset:3072 lds
v_mfma_f32_16x16x32_bf16 v[148:151], v[100:103], a[28:31], v[148:151]
ds_read_b64_tr_b16 v[92:93], v13 offset:37888
ds_read_b64_tr_b16 v[94:95], v13 offset:54272
v_mfma_f32_16x16x32_bf16 v[136:139], v[104:107], a[24:27], v[136:139]
ds_read_b64_tr_b16 v[96:97], v10 offset:38912
s_and_b32 s78, s78, 3
v_mfma_f32_16x16x32_bf16 v[152:155], v[104:107], a[28:31], v[152:155]
ds_read_b64_tr_b16 v[98:99], v10 offset:55296
s_add_u32 m0, s76, 4096
v_mfma_f32_16x16x32_bf16 v[140:143], v[108:111], a[24:27], v[140:143]
ds_read_b64_tr_b16 v[100:101], v11 offset:38912
s_add_u32 s77, s82, 0x620000
v_mfma_f32_16x16x32_bf16 v[156:159], v[108:111], a[28:31], v[156:159]
ds_read_b64_tr_b16 v[102:103], v11 offset:55296
s_add_u32 s78, s78, s79
v_mfma_f32_16x16x32_bf16 v[128:131], v[112:115], a[32:35], v[128:131]
buffer_load_dwordx4 v30, s[40:43], s77 offen offset:0 lds
v_mfma_f32_16x16x32_bf16 v[144:147], v[112:115], a[36:39], v[144:147]
ds_read_b64_tr_b16 v[104:105], v12 offset:38912
ds_read_b64_tr_b16 v[106:107], v12 offset:55296
v_mfma_f32_16x16x32_bf16 v[132:135], v[116:119], a[32:35], v[132:135]
ds_read_b64_tr_b16 v[108:109], v13 offset:38912
s_lshl_b32 s78, s78, 7
v_mfma_f32_16x16x32_bf16 v[148:151], v[116:119], a[36:39], v[148:151]
ds_read_b64_tr_b16 v[110:111], v13 offset:55296
s_add_u32 s25, s78, 4096
v_mfma_f32_16x16x32_bf16 v[136:139], v[120:123], a[32:35], v[136:139]
ds_read_b64_tr_b16 v[112:113], v10 offset:39936
s_lshr_b32 s12, s74, 2
v_mfma_f32_16x16x32_bf16 v[152:155], v[120:123], a[36:39], v[152:155]
ds_read_b64_tr_b16 v[114:115], v10 offset:56320
s_and_b32 s13, s74, 3
v_mfma_f32_16x16x32_bf16 v[140:143], v[124:127], a[32:35], v[140:143]
buffer_load_dwordx4 v31, s[40:43], s77 offen offset:1024 lds
v_mfma_f32_16x16x32_bf16 v[156:159], v[124:127], a[36:39], v[156:159]
ds_read_b64_tr_b16 v[116:117], v11 offset:39936
s_waitcnt lgkmcnt(5)
v_mfma_f32_16x16x32_bf16 v[128:131], v[80:83], a[40:43], v[128:131]
ds_read_b64_tr_b16 v[118:119], v11 offset:56320
ds_read_b64_tr_b16 v[120:121], v12 offset:39936
v_mfma_f32_16x16x32_bf16 v[144:147], v[80:83], a[44:47], v[144:147]
ds_read_b64_tr_b16 v[122:123], v12 offset:56320
s_add_u32 s4, s89, 0xa00000
v_mfma_f32_16x16x32_bf16 v[132:135], v[84:87], a[40:43], v[132:135]
ds_read_b64_tr_b16 v[124:125], v13 offset:39936
s_lshl_b32 s5, s85, 5
v_mfma_f32_16x16x32_bf16 v[148:151], v[84:87], a[44:47], v[148:151]
ds_read_b64_tr_b16 v[126:127], v13 offset:56320
s_add_u32 s5, s5, s4
v_mfma_f32_16x16x32_bf16 v[136:139], v[88:91], a[40:43], v[136:139]
buffer_load_dwordx4 v32, s[40:43], s77 offen offset:2048 lds
v_mfma_f32_16x16x32_bf16 v[152:155], v[88:91], a[44:47], v[152:155]
s_lshl_b32 s6, s12, 14
s_add_u32 s6, s6, s4
v_mfma_f32_16x16x32_bf16 v[140:143], v[92:95], a[40:43], v[140:143]
s_lshl_b32 s26, s12, 13
s_add_u32 s26, s26, s4
v_mfma_f32_16x16x32_bf16 v[156:159], v[92:95], a[44:47], v[156:159]
s_add_u32 s26, s26, 196608
s_lshl_b32 s14, s12, 18
v_mfma_f32_16x16x32_bf16 v[128:131], v[96:99], a[48:51], v[128:131]
s_waitcnt lgkmcnt(0)
s_barrier
v_mfma_f32_16x16x32_bf16 v[144:147], v[96:99], a[52:55], v[144:147]
ds_read_b64_tr_b16 v[80:81], v14 offset:0
ds_read_b64_tr_b16 v[82:83], v14 offset:16384
v_mfma_f32_16x16x32_bf16 v[132:135], v[100:103], a[48:51], v[132:135]
ds_read_b64_tr_b16 v[84:85], v15 offset:0
v_add_u32 v38, s14, v26
v_mfma_f32_16x16x32_bf16 v[148:151], v[100:103], a[52:55], v[148:151]
ds_read_b64_tr_b16 v[86:87], v15 offset:16384
ds_read_b64_tr_b16 v[88:89], v16 offset:0
v_mfma_f32_16x16x32_bf16 v[136:139], v[104:107], a[48:51], v[136:139]
buffer_load_dwordx4 v33, s[40:43], s77 offen offset:3072 lds
v_mfma_f32_16x16x32_bf16 v[152:155], v[104:107], a[52:55], v[152:155]
ds_read_b64_tr_b16 v[90:91], v16 offset:16384
ds_read_b64_tr_b16 v[92:93], v17 offset:0
v_mfma_f32_16x16x32_bf16 v[140:143], v[108:111], a[48:51], v[140:143]
ds_read_b64_tr_b16 v[94:95], v17 offset:16384
v_add_u32 v39, s14, v27
v_mfma_f32_16x16x32_bf16 v[156:159], v[108:111], a[52:55], v[156:159]
ds_read_b64_tr_b16 v[96:97], v14 offset:1024
s_add_u32 m0, s76, 32768
v_mfma_f32_16x16x32_bf16 v[128:131], v[112:115], a[56:59], v[128:131]
ds_read_b64_tr_b16 v[98:99], v14 offset:17408
s_add_u32 s77, s85, 0x0
v_mfma_f32_16x16x32_bf16 v[144:147], v[112:115], a[60:63], v[144:147]
ds_read_b64_tr_b16 v[100:101], v15 offset:1024
ds_read_b64_tr_b16 v[102:103], v15 offset:17408
v_mfma_f32_16x16x32_bf16 v[132:135], v[116:119], a[56:59], v[132:135]
buffer_load_dwordx4 v34, s[52:55], s77 offen offset:0 lds
v_mfma_f32_16x16x32_bf16 v[148:151], v[116:119], a[60:63], v[148:151]
ds_read_b64_tr_b16 v[104:105], v16 offset:1024
ds_read_b64_tr_b16 v[106:107], v16 offset:17408
v_mfma_f32_16x16x32_bf16 v[136:139], v[120:123], a[56:59], v[136:139]
ds_read_b64_tr_b16 v[108:109], v17 offset:1024
v_add_u32 v40, s14, v28
v_mfma_f32_16x16x32_bf16 v[152:155], v[120:123], a[60:63], v[152:155]
ds_read_b64_tr_b16 v[110:111], v17 offset:17408
ds_read_b64_tr_b16 v[112:113], v14 offset:2048
v_mfma_f32_16x16x32_bf16 v[140:143], v[124:127], a[56:59], v[140:143]
ds_read_b64_tr_b16 v[114:115], v14 offset:18432
v_add_u32 v41, s14, v29
v_mfma_f32_16x16x32_bf16 v[156:159], v[124:127], a[60:63], v[156:159]
ds_read_b64_tr_b16 v[116:117], v15 offset:2048
s_waitcnt lgkmcnt(7)
v_mfma_f32_16x16x32_bf16 v[128:131], v[80:83], a[64:67], v[128:131]
buffer_load_dwordx4 v35, s[52:55], s77 offen offset:1024 lds
v_mfma_f32_16x16x32_bf16 v[144:147], v[80:83], a[68:71], v[144:147]
ds_read_b64_tr_b16 v[118:119], v15 offset:18432
ds_read_b64_tr_b16 v[120:121], v16 offset:2048
v_mfma_f32_16x16x32_bf16 v[132:135], v[84:87], a[64:67], v[132:135]
ds_read_b64_tr_b16 v[122:123], v16 offset:18432
s_lshl_b32 s78, s13, 9
v_mfma_f32_16x16x32_bf16 v[148:151], v[84:87], a[68:71], v[148:151]
ds_read_b64_tr_b16 v[124:125], v17 offset:2048
ds_read_b64_tr_b16 v[126:127], v17 offset:18432
v_mfma_f32_16x16x32_bf16 v[136:139], v[88:91], a[64:67], v[136:139]
ds_read_b64_tr_b16 v[80:81], v14 offset:3072
s_add_u32 s14, s14, s78
v_mfma_f32_16x16x32_bf16 v[152:155], v[88:91], a[68:71], v[152:155]
ds_read_b64_tr_b16 v[82:83], v14 offset:19456
s_lshr_b32 s15, s88, 12
v_mfma_f32_16x16x32_bf16 v[140:143], v[92:95], a[64:67], v[140:143]
buffer_load_dwordx4 v36, s[52:55], s77 offen offset:2048 lds
v_mfma_f32_16x16x32_bf16 v[156:159], v[92:95], a[68:71], v[156:159]
ds_read_b64_tr_b16 v[84:85], v15 offset:3072
ds_read_b64_tr_b16 v[86:87], v15 offset:19456
v_mfma_f32_16x16x32_bf16 v[128:131], v[96:99], a[72:75], v[128:131]
ds_read_b64_tr_b16 v[88:89], v16 offset:3072
s_lshl_b32 s17, s73, 14
v_mfma_f32_16x16x32_bf16 v[144:147], v[96:99], a[76:79], v[144:147]
ds_read_b64_tr_b16 v[90:91], v16 offset:19456
s_lshl_b32 s78, s72, 7
v_mfma_f32_16x16x32_bf16 v[132:135], v[100:103], a[72:75], v[132:135]
ds_read_b64_tr_b16 v[92:93], v17 offset:3072
s_add_u32 s17, s17, 32768
v_mfma_f32_16x16x32_bf16 v[148:151], v[100:103], a[76:79], v[148:151]
ds_read_b64_tr_b16 v[94:95], v17 offset:19456
s_waitcnt lgkmcnt(6)
v_mfma_f32_16x16x32_bf16 v[136:139], v[104:107], a[72:75], v[136:139]
buffer_load_dwordx4 v37, s[52:55], s77 offen offset:3072 lds
v_mfma_f32_16x16x32_bf16 v[152:155], v[104:107], a[76:79], v[152:155]
ds_read_b64_tr_b16 v[96:97], v14 offset:4096
ds_read_b64_tr_b16 v[98:99], v14 offset:20480
v_mfma_f32_16x16x32_bf16 v[140:143], v[108:111], a[72:75], v[140:143]
ds_read_b64_tr_b16 v[100:101], v15 offset:4096
s_add_u32 s18, s17, s78
v_mfma_f32_16x16x32_bf16 v[156:159], v[108:111], a[76:79], v[156:159]
ds_read_b64_tr_b16 v[102:103], v15 offset:20480
s_add_u32 m0, s76, 36864
v_mfma_f32_16x16x32_bf16 v[128:131], v[112:115], a[80:83], v[128:131]
ds_read_b64_tr_b16 v[104:105], v16 offset:4096
s_add_u32 s77, s85, 0xe0000
v_mfma_f32_16x16x32_bf16 v[144:147], v[112:115], a[84:87], v[144:147]
ds_read_b64_tr_b16 v[106:107], v16 offset:20480
s_add_u32 s79, s12, 1
v_mfma_f32_16x16x32_bf16 v[132:135], v[116:119], a[80:83], v[132:135]
buffer_load_dwordx4 v34, s[52:55], s77 offen offset:0 lds
v_mfma_f32_16x16x32_bf16 v[148:151], v[116:119], a[84:87], v[148:151]
ds_read_b64_tr_b16 v[108:109], v17 offset:4096
ds_read_b64_tr_b16 v[110:111], v17 offset:20480
v_mfma_f32_16x16x32_bf16 v[136:139], v[120:123], a[80:83], v[136:139]
ds_read_b64_tr_b16 v[112:113], v14 offset:5120
s_and_b32 s79, s79, 3
v_mfma_f32_16x16x32_bf16 v[152:155], v[120:123], a[84:87], v[152:155]
ds_read_b64_tr_b16 v[114:115], v14 offset:21504
s_lshl_b32 s78, s79, 7
v_mfma_f32_16x16x32_bf16 v[140:143], v[124:127], a[80:83], v[140:143]
ds_read_b64_tr_b16 v[116:117], v15 offset:5120
s_add_u32 s97, s14, s78
v_mfma_f32_16x16x32_bf16 v[156:159], v[124:127], a[84:87], v[156:159]
ds_read_b64_tr_b16 v[118:119], v15 offset:21504
s_lshl_b32 s79, s79, 2
v_mfma_f32_16x16x32_bf16 v[128:131], v[80:83], a[88:91], v[128:131]
buffer_load_dwordx4 v35, s[52:55], s77 offen offset:1024 lds
v_mfma_f32_16x16x32_bf16 v[144:147], v[80:83], a[92:95], v[144:147]
ds_read_b64_tr_b16 v[120:121], v16 offset:5120
s_waitcnt lgkmcnt(5)
v_mfma_f32_16x16x32_bf16 v[132:135], v[84:87], a[88:91], v[132:135]
ds_read_b64_tr_b16 v[122:123], v16 offset:21504
ds_read_b64_tr_b16 v[124:125], v17 offset:5120
v_mfma_f32_16x16x32_bf16 v[148:151], v[84:87], a[92:95], v[148:151]
ds_read_b64_tr_b16 v[126:127], v17 offset:21504
s_add_u32 s16, s79, s13
v_mfma_f32_16x16x32_bf16 v[136:139], v[88:91], a[88:91], v[136:139]
ds_read_b64_tr_b16 v[80:81], v14 offset:6144
s_add_u32 s78, s15, s16
v_mfma_f32_16x16x32_bf16 v[152:155], v[88:91], a[92:95], v[152:155]
ds_read_b64_tr_b16 v[82:83], v14 offset:22528
s_mul_i32 s78, s78, 12288
v_mfma_f32_16x16x32_bf16 v[140:143], v[92:95], a[88:91], v[140:143]
buffer_load_dwordx4 v36, s[52:55], s77 offen offset:2048 lds
v_mfma_f32_16x16x32_bf16 v[156:159], v[92:95], a[92:95], v[156:159]
ds_read_b64_tr_b16 v[84:85], v15 offset:6144
ds_read_b64_tr_b16 v[86:87], v15 offset:22528
v_mfma_f32_16x16x32_bf16 v[128:131], v[96:99], a[96:99], v[128:131]
ds_read_b64_tr_b16 v[88:89], v16 offset:6144
s_add_u32 s8, s78, 0x1900000
v_mfma_f32_16x16x32_bf16 v[144:147], v[96:99], a[100:103], v[144:147]
ds_read_b64_tr_b16 v[90:91], v16 offset:22528
s_lshl_b32 s16, s16, 10
v_mfma_f32_16x16x32_bf16 v[132:135], v[100:103], a[96:99], v[132:135]
ds_read_b64_tr_b16 v[92:93], v17 offset:6144
s_add_u32 s20, s16, s18
v_mfma_f32_16x16x32_bf16 v[148:151], v[100:103], a[100:103], v[148:151]
ds_read_b64_tr_b16 v[94:95], v17 offset:22528
s_mul_i32 s3, s101, 7168
v_mfma_f32_16x16x32_bf16 v[136:139], v[104:107], a[96:99], v[136:139]
buffer_load_dwordx4 v37, s[52:55], s77 offen offset:3072 lds
v_mfma_f32_16x16x32_bf16 v[152:155], v[104:107], a[100:103], v[152:155]
ds_read_b64_tr_b16 v[96:97], v14 offset:7168
ds_read_b64_tr_b16 v[98:99], v14 offset:23552
v_mfma_f32_16x16x32_bf16 v[140:143], v[108:111], a[96:99], v[140:143]
ds_read_b64_tr_b16 v[100:101], v15 offset:7168
s_add_u32 s3, s3, 0x800
v_mfma_f32_16x16x32_bf16 v[156:159], v[108:111], a[100:103], v[156:159]
ds_read_b64_tr_b16 v[102:103], v15 offset:23552
s_waitcnt lgkmcnt(6)
v_mfma_f32_16x16x32_bf16 v[128:131], v[112:115], a[104:107], v[128:131]
buffer_load_dword v57, v8, s[40:43], s3 offen
v_mfma_f32_16x16x32_bf16 v[144:147], v[112:115], a[108:111], v[144:147]
ds_read_b64_tr_b16 v[104:105], v16 offset:7168
ds_read_b64_tr_b16 v[106:107], v16 offset:23552
v_mfma_f32_16x16x32_bf16 v[132:135], v[116:119], a[104:107], v[132:135]
ds_read_b64_tr_b16 v[108:109], v17 offset:7168
s_mul_i32 s3, s101, 1024
v_mfma_f32_16x16x32_bf16 v[148:151], v[116:119], a[108:111], v[148:151]
ds_read_b64_tr_b16 v[110:111], v17 offset:23552
s_add_u32 s3, s3, 0x300000
v_mfma_f32_16x16x32_bf16 v[136:139], v[120:123], a[104:107], v[136:139]
buffer_load_dword v57, v50, s[48:51], s3 offen
v_mfma_f32_16x16x32_bf16 v[152:155], v[120:123], a[108:111], v[152:155]
s_add_u32 s79, s12, 2
s_and_b32 s79, s79, 3
v_mfma_f32_16x16x32_bf16 v[140:143], v[124:127], a[104:107], v[140:143]
s_lshl_b32 s78, s79, 7
s_add_u32 s98, s14, s78
v_mfma_f32_16x16x32_bf16 v[156:159], v[124:127], a[108:111], v[156:159]
s_lshl_b32 s79, s79, 2
s_add_u32 s16, s79, s13
v_mfma_f32_16x16x32_bf16 v[128:131], v[80:83], a[112:115], v[128:131]
s_waitcnt vmcnt(20) lgkmcnt(0)
s_barrier
v_mfma_f32_16x16x32_bf16 v[144:147], v[80:83], a[116:119], v[144:147]
ds_read_b64_tr_b16 v[112:113], v14 offset:32768
ds_read_b64_tr_b16 v[114:115], v14 offset:49152
v_mfma_f32_16x16x32_bf16 v[132:135], v[84:87], a[112:115], v[132:135]
ds_read_b64_tr_b16 v[116:117], v15 offset:32768
s_add_u32 m0, s76, 65536
v_mfma_f32_16x16x32_bf16 v[148:151], v[84:87], a[116:119], v[148:151]
ds_read_b64_tr_b16 v[118:119], v15 offset:49152
s_add_u32 s77, s82, 0x0
v_mfma_f32_16x16x32_bf16 v[136:139], v[88:91], a[112:115], v[136:139]
ds_read_b64_tr_b16 v[120:121], v16 offset:32768
ds_read_b64_tr_b16 v[122:123], v16 offset:49152
v_mfma_f32_16x16x32_bf16 v[152:155], v[88:91], a[116:119], v[152:155]
buffer_load_dwordx4 v30, s[44:47], s77 offen offset:0 lds
v_mfma_f32_16x16x32_bf16 v[140:143], v[92:95], a[112:115], v[140:143]
ds_read_b64_tr_b16 v[124:125], v17 offset:32768
ds_read_b64_tr_b16 v[126:127], v17 offset:49152
v_mfma_f32_16x16x32_bf16 v[156:159], v[92:95], a[116:119], v[156:159]
ds_read_b64_tr_b16 v[80:81], v14 offset:33792
s_add_u32 s78, s15, s16
v_mfma_f32_16x16x32_bf16 v[128:131], v[96:99], a[120:123], v[128:131]
ds_read_b64_tr_b16 v[82:83], v14 offset:50176
ds_read_b64_tr_b16 v[84:85], v15 offset:33792
v_mfma_f32_16x16x32_bf16 v[144:147], v[96:99], a[124:127], v[144:147]
ds_read_b64_tr_b16 v[86:87], v15 offset:50176
s_mul_i32 s78, s78, 12288
v_mfma_f32_16x16x32_bf16 v[132:135], v[100:103], a[120:123], v[132:135]
ds_read_b64_tr_b16 v[88:89], v16 offset:33792
ds_read_b64_tr_b16 v[90:91], v16 offset:50176
v_mfma_f32_16x16x32_bf16 v[148:151], v[100:103], a[124:127], v[148:151]
buffer_load_dwordx4 v31, s[44:47], s77 offen offset:1024 lds
v_mfma_f32_16x16x32_bf16 v[136:139], v[104:107], a[120:123], v[136:139]
ds_read_b64_tr_b16 v[92:93], v17 offset:33792
ds_read_b64_tr_b16 v[94:95], v17 offset:50176
v_mfma_f32_16x16x32_bf16 v[152:155], v[104:107], a[124:127], v[152:155]
ds_read_b64_tr_b16 v[96:97], v14 offset:34816
s_add_u32 s9, s78, 0x1901000
v_mfma_f32_16x16x32_bf16 v[140:143], v[108:111], a[120:123], v[140:143]
ds_read_b64_tr_b16 v[98:99], v14 offset:51200
ds_read_b64_tr_b16 v[100:101], v15 offset:34816
v_mfma_f32_16x16x32_bf16 v[156:159], v[108:111], a[124:127], v[156:159]
ds_read_b64_tr_b16 v[102:103], v15 offset:51200
s_waitcnt lgkmcnt(8)
v_mfma_f32_16x16x32_bf16 v[128:131], v[112:115], a[128:131], v[128:131]
ds_read_b64_tr_b16 v[104:105], v16 offset:34816
s_lshl_b32 s16, s16, 10
v_mfma_f32_16x16x32_bf16 v[144:147], v[112:115], a[132:135], v[144:147]
buffer_load_dwordx4 v32, s[44:47], s77 offen offset:2048 lds
v_mfma_f32_16x16x32_bf16 v[132:135], v[116:119], a[128:131], v[132:135]
ds_read_b64_tr_b16 v[106:107], v16 offset:51200
ds_read_b64_tr_b16 v[108:109], v17 offset:34816
v_mfma_f32_16x16x32_bf16 v[148:151], v[116:119], a[132:135], v[148:151]
ds_read_b64_tr_b16 v[110:111], v17 offset:51200
s_add_u32 s21, s16, s18
v_mfma_f32_16x16x32_bf16 v[136:139], v[120:123], a[128:131], v[136:139]
ds_read_b64_tr_b16 v[112:113], v14 offset:35840
s_add_u32 s79, s12, 3
v_mfma_f32_16x16x32_bf16 v[152:155], v[120:123], a[132:135], v[152:155]
ds_read_b64_tr_b16 v[114:115], v14 offset:52224
s_and_b32 s79, s79, 3
v_mfma_f32_16x16x32_bf16 v[140:143], v[124:127], a[128:131], v[140:143]
ds_read_b64_tr_b16 v[116:117], v15 offset:35840
s_lshl_b32 s78, s79, 7
v_mfma_f32_16x16x32_bf16 v[156:159], v[124:127], a[132:135], v[156:159]
buffer_load_dwordx4 v33, s[44:47], s77 offen offset:3072 lds
v_mfma_f32_16x16x32_bf16 v[128:131], v[80:83], a[136:139], v[128:131]
ds_read_b64_tr_b16 v[118:119], v15 offset:52224
ds_read_b64_tr_b16 v[120:121], v16 offset:35840
v_mfma_f32_16x16x32_bf16 v[144:147], v[80:83], a[140:143], v[144:147]
ds_read_b64_tr_b16 v[122:123], v16 offset:52224
s_add_u32 s99, s14, s78
v_mfma_f32_16x16x32_bf16 v[132:135], v[84:87], a[136:139], v[132:135]
ds_read_b64_tr_b16 v[124:125], v17 offset:35840
s_add_u32 m0, s76, 69632
v_mfma_f32_16x16x32_bf16 v[148:151], v[84:87], a[140:143], v[148:151]
ds_read_b64_tr_b16 v[126:127], v17 offset:52224
s_waitcnt lgkmcnt(6)
v_mfma_f32_16x16x32_bf16 v[136:139], v[88:91], a[136:139], v[136:139]
ds_read_b64_tr_b16 v[80:81], v14 offset:36864
s_add_u32 s77, s82, 0xe0000
v_mfma_f32_16x16x32_bf16 v[152:155], v[88:91], a[140:143], v[152:155]
buffer_load_dwordx4 v30, s[44:47], s77 offen offset:0 lds
v_mfma_f32_16x16x32_bf16 v[140:143], v[92:95], a[136:139], v[140:143]
ds_read_b64_tr_b16 v[82:83], v14 offset:53248
ds_read_b64_tr_b16 v[84:85], v15 offset:36864
v_mfma_f32_16x16x32_bf16 v[156:159], v[92:95], a[140:143], v[156:159]
ds_read_b64_tr_b16 v[86:87], v15 offset:53248
s_lshl_b32 s79, s79, 2
v_mfma_f32_16x16x32_bf16 v[128:131], v[96:99], a[144:147], v[128:131]
ds_read_b64_tr_b16 v[88:89], v16 offset:36864
s_add_u32 s16, s79, s13
v_mfma_f32_16x16x32_bf16 v[144:147], v[96:99], a[148:151], v[144:147]
ds_read_b64_tr_b16 v[90:91], v16 offset:53248
s_add_u32 s78, s15, s16
v_mfma_f32_16x16x32_bf16 v[132:135], v[100:103], a[144:147], v[132:135]
ds_read_b64_tr_b16 v[92:93], v17 offset:36864
s_mul_i32 s78, s78, 12288
v_mfma_f32_16x16x32_bf16 v[148:151], v[100:103], a[148:151], v[148:151]
buffer_load_dwordx4 v31, s[44:47], s77 offen offset:1024 lds
v_mfma_f32_16x16x32_bf16 v[136:139], v[104:107], a[144:147], v[136:139]
ds_read_b64_tr_b16 v[94:95], v17 offset:53248
ds_read_b64_tr_b16 v[96:97], v14 offset:37888
v_mfma_f32_16x16x32_bf16 v[152:155], v[104:107], a[148:151], v[152:155]
ds_read_b64_tr_b16 v[98:99], v14 offset:54272
s_add_u32 s10, s78, 0x1902000
v_mfma_f32_16x16x32_bf16 v[140:143], v[108:111], a[144:147], v[140:143]
ds_read_b64_tr_b16 v[100:101], v15 offset:37888
s_lshl_b32 s16, s16, 10
v_mfma_f32_16x16x32_bf16 v[156:159], v[108:111], a[148:151], v[156:159]
ds_read_b64_tr_b16 v[102:103], v15 offset:54272
s_add_u32 s22, s16, s18
v_mfma_f32_16x16x32_bf16 v[128:131], v[112:115], a[152:155], v[128:131]
ds_read_b64_tr_b16 v[104:105], v16 offset:37888
s_add_u32 s79, s12, 4
v_mfma_f32_16x16x32_bf16 v[144:147], v[112:115], a[156:159], v[144:147]
ds_read_b64_tr_b16 v[106:107], v16 offset:54272
s_waitcnt lgkmcnt(7)
v_mfma_f32_16x16x32_bf16 v[132:135], v[116:119], a[152:155], v[132:135]
buffer_load_dwordx4 v32, s[44:47], s77 offen offset:2048 lds
v_mfma_f32_16x16x32_bf16 v[148:151], v[116:119], a[156:159], v[148:151]
ds_read_b64_tr_b16 v[108:109], v17 offset:37888
ds_read_b64_tr_b16 v[110:111], v17 offset:54272
v_mfma_f32_16x16x32_bf16 v[136:139], v[120:123], a[152:155], v[136:139]
ds_read_b64_tr_b16 v[112:113], v14 offset:38912
s_and_b32 s79, s79, 3
v_mfma_f32_16x16x32_bf16 v[152:155], v[120:123], a[156:159], v[152:155]
ds_read_b64_tr_b16 v[114:115], v14 offset:55296
s_lshl_b32 s78, s79, 7
v_mfma_f32_16x16x32_bf16 v[140:143], v[124:127], a[152:155], v[140:143]
ds_read_b64_tr_b16 v[116:117], v15 offset:38912
s_add_u32 s100, s14, s78
v_mfma_f32_16x16x32_bf16 v[156:159], v[124:127], a[156:159], v[156:159]
ds_read_b64_tr_b16 v[118:119], v15 offset:55296
s_lshl_b32 s79, s79, 2
v_mfma_f32_16x16x32_bf16 v[128:131], v[80:83], a[160:163], v[128:131]
buffer_load_dwordx4 v33, s[44:47], s77 offen offset:3072 lds
v_mfma_f32_16x16x32_bf16 v[144:147], v[80:83], a[164:167], v[144:147]
ds_read_b64_tr_b16 v[120:121], v16 offset:38912
ds_read_b64_tr_b16 v[122:123], v16 offset:55296
v_mfma_f32_16x16x32_bf16 v[132:135], v[84:87], a[160:163], v[132:135]
ds_read_b64_tr_b16 v[124:125], v17 offset:38912
s_add_u32 s16, s79, s13
v_mfma_f32_16x16x32_bf16 v[148:151], v[84:87], a[164:167], v[148:151]
ds_read_b64_tr_b16 v[126:127], v17 offset:55296
s_add_u32 s78, s15, s16
v_mfma_f32_16x16x32_bf16 v[136:139], v[88:91], a[160:163], v[136:139]
ds_read_b64_tr_b16 v[80:81], v14 offset:39936
s_mul_i32 s78, s78, 12288
v_mfma_f32_16x16x32_bf16 v[152:155], v[88:91], a[164:167], v[152:155]
ds_read_b64_tr_b16 v[82:83], v14 offset:56320
s_waitcnt lgkmcnt(6)
v_mfma_f32_16x16x32_bf16 v[140:143], v[92:95], a[160:163], v[140:143]
ds_read_b64_tr_b16 v[84:85], v15 offset:39936
s_add_u32 s11, s78, 0x1900000
v_mfma_f32_16x16x32_bf16 v[156:159], v[92:95], a[164:167], v[156:159]
ds_read_b64_tr_b16 v[86:87], v15 offset:56320
s_lshl_b32 s16, s16, 10
v_mfma_f32_16x16x32_bf16 v[128:131], v[96:99], a[168:171], v[128:131]
ds_read_b64_tr_b16 v[88:89], v16 offset:39936
s_add_u32 s23, s16, s18
v_mfma_f32_16x16x32_bf16 v[144:147], v[96:99], a[172:175], v[144:147]
ds_read_b64_tr_b16 v[90:91], v16 offset:56320
s_and_b32 s79, s74, 12
v_mfma_f32_16x16x32_bf16 v[132:135], v[100:103], a[168:171], v[132:135]
ds_read_b64_tr_b16 v[92:93], v17 offset:39936
s_add_u32 s79, s79, s72
v_mfma_f32_16x16x32_bf16 v[148:151], v[100:103], a[172:175], v[148:151]
ds_read_b64_tr_b16 v[94:95], v17 offset:56320
s_lshl_b32 s79, s79, 10
v_mfma_f32_16x16x32_bf16 v[136:139], v[104:107], a[168:171], v[136:139]
s_add_u32 s24, s79, s17
v_mfma_f32_16x16x32_bf16 v[152:155], v[104:107], a[172:175], v[152:155]
v_mfma_f32_16x16x32_bf16 v[140:143], v[108:111], a[168:171], v[140:143]
v_mfma_f32_16x16x32_bf16 v[156:159], v[108:111], a[172:175], v[156:159]
v_mfma_f32_16x16x32_bf16 v[128:131], v[112:115], a[176:179], v[128:131]
s_waitcnt vmcnt(18) lgkmcnt(0)
s_barrier
v_mfma_f32_16x16x32_bf16 v[144:147], v[112:115], a[180:183], v[144:147]
ds_read_b64_tr_b16 v[96:97], v10 offset:0
ds_read_b64_tr_b16 v[98:99], v10 offset:16384
v_mfma_f32_16x16x32_bf16 v[132:135], v[116:119], a[176:179], v[132:135]
ds_read_b64_tr_b16 v[100:101], v11 offset:0
v_mfma_f32_16x16x32_bf16 v[148:151], v[116:119], a[180:183], v[148:151]
ds_read_b64_tr_b16 v[102:103], v11 offset:16384
ds_read_b64_tr_b16 v[104:105], v12 offset:0
v_mfma_f32_16x16x32_bf16 v[136:139], v[120:123], a[176:179], v[136:139]
ds_read_b64_tr_b16 v[106:107], v12 offset:16384
v_mfma_f32_16x16x32_bf16 v[152:155], v[120:123], a[180:183], v[152:155]
ds_read_b64_tr_b16 v[108:109], v13 offset:0
ds_read_b64_tr_b16 v[110:111], v13 offset:16384
v_mfma_f32_16x16x32_bf16 v[140:143], v[124:127], a[176:179], v[140:143]
ds_read_b64_tr_b16 v[112:113], v10 offset:1024
v_mfma_f32_16x16x32_bf16 v[156:159], v[124:127], a[180:183], v[156:159]
ds_read_b64_tr_b16 v[114:115], v10 offset:17408
ds_read_b64_tr_b16 v[116:117], v11 offset:1024
v_mfma_f32_16x16x32_bf16 v[128:131], v[80:83], a[184:187], v[128:131]
ds_read_b64_tr_b16 v[118:119], v11 offset:17408
v_mfma_f32_16x16x32_bf16 v[144:147], v[80:83], a[188:191], v[144:147]
ds_read_b64_tr_b16 v[120:121], v12 offset:1024
ds_read_b64_tr_b16 v[122:123], v12 offset:17408
v_mfma_f32_16x16x32_bf16 v[132:135], v[84:87], a[184:187], v[132:135]
ds_read_b64_tr_b16 v[124:125], v13 offset:1024
v_mfma_f32_16x16x32_bf16 v[148:151], v[84:87], a[188:191], v[148:151]
ds_read_b64_tr_b16 v[126:127], v13 offset:17408
ds_read_b64_tr_b16 v[80:81], v10 offset:2048
v_mfma_f32_16x16x32_bf16 v[136:139], v[88:91], a[184:187], v[136:139]
ds_read_b64_tr_b16 v[82:83], v10 offset:18432
v_mfma_f32_16x16x32_bf16 v[152:155], v[88:91], a[188:191], v[152:155]
ds_read_b64_tr_b16 v[84:85], v11 offset:2048
ds_read_b64_tr_b16 v[86:87], v11 offset:18432
v_mfma_f32_16x16x32_bf16 v[140:143], v[92:95], a[184:187], v[140:143]
ds_read_b64_tr_b16 v[88:89], v12 offset:2048
v_mfma_f32_16x16x32_bf16 v[156:159], v[92:95], a[188:191], v[156:159]
ds_read_b64_tr_b16 v[90:91], v12 offset:18432
s_waitcnt lgkmcnt(8)
v_mfma_f32_16x16x32_bf16 v[128:131], v[96:99], a[192:195], v[128:131]
ds_read_b64_tr_b16 v[92:93], v13 offset:2048
v_mfma_f32_16x16x32_bf16 v[144:147], v[96:99], a[196:199], v[144:147]
ds_read_b64_tr_b16 v[94:95], v13 offset:18432
v_mfma_f32_16x16x32_bf16 v[132:135], v[100:103], a[192:195], v[132:135]
ds_read_b64_tr_b16 v[96:97], v10 offset:3072
v_mfma_f32_16x16x32_bf16 v[148:151], v[100:103], a[196:199], v[148:151]
ds_read_b64_tr_b16 v[98:99], v10 offset:19456
v_mfma_f32_16x16x32_bf16 v[136:139], v[104:107], a[192:195], v[136:139]
ds_read_b64_tr_b16 v[100:101], v11 offset:3072
v_mfma_f32_16x16x32_bf16 v[152:155], v[104:107], a[196:199], v[152:155]
ds_read_b64_tr_b16 v[102:103], v11 offset:19456
v_mfma_f32_16x16x32_bf16 v[140:143], v[108:111], a[192:195], v[140:143]
ds_read_b64_tr_b16 v[104:105], v12 offset:3072
v_mfma_f32_16x16x32_bf16 v[156:159], v[108:111], a[196:199], v[156:159]
ds_read_b64_tr_b16 v[106:107], v12 offset:19456
v_mfma_f32_16x16x32_bf16 v[128:131], v[112:115], a[200:203], v[128:131]
ds_read_b64_tr_b16 v[108:109], v13 offset:3072
v_mfma_f32_16x16x32_bf16 v[144:147], v[112:115], a[204:207], v[144:147]
ds_read_b64_tr_b16 v[110:111], v13 offset:19456
v_mfma_f32_16x16x32_bf16 v[132:135], v[116:119], a[200:203], v[132:135]
ds_read_b64_tr_b16 v[112:113], v10 offset:4096
v_mfma_f32_16x16x32_bf16 v[148:151], v[116:119], a[204:207], v[148:151]
ds_read_b64_tr_b16 v[114:115], v10 offset:20480
v_mfma_f32_16x16x32_bf16 v[136:139], v[120:123], a[200:203], v[136:139]
ds_read_b64_tr_b16 v[116:117], v11 offset:4096
v_mfma_f32_16x16x32_bf16 v[152:155], v[120:123], a[204:207], v[152:155]
ds_read_b64_tr_b16 v[118:119], v11 offset:20480
s_waitcnt lgkmcnt(6)
v_mfma_f32_16x16x32_bf16 v[140:143], v[124:127], a[200:203], v[140:143]
ds_read_b64_tr_b16 v[120:121], v12 offset:4096
v_mfma_f32_16x16x32_bf16 v[156:159], v[124:127], a[204:207], v[156:159]
ds_read_b64_tr_b16 v[122:123], v12 offset:20480
v_mfma_f32_16x16x32_bf16 v[128:131], v[80:83], a[208:211], v[128:131]
ds_read_b64_tr_b16 v[124:125], v13 offset:4096
v_mfma_f32_16x16x32_bf16 v[144:147], v[80:83], a[212:215], v[144:147]
ds_read_b64_tr_b16 v[126:127], v13 offset:20480
v_mfma_f32_16x16x32_bf16 v[132:135], v[84:87], a[208:211], v[132:135]
ds_read_b64_tr_b16 v[80:81], v10 offset:5120
v_mfma_f32_16x16x32_bf16 v[148:151], v[84:87], a[212:215], v[148:151]
ds_read_b64_tr_b16 v[82:83], v10 offset:21504
v_mfma_f32_16x16x32_bf16 v[136:139], v[88:91], a[208:211], v[136:139]
ds_read_b64_tr_b16 v[84:85], v11 offset:5120
v_mfma_f32_16x16x32_bf16 v[152:155], v[88:91], a[212:215], v[152:155]
ds_read_b64_tr_b16 v[86:87], v11 offset:21504
v_mfma_f32_16x16x32_bf16 v[140:143], v[92:95], a[208:211], v[140:143]
ds_read_b64_tr_b16 v[88:89], v12 offset:5120
v_mfma_f32_16x16x32_bf16 v[156:159], v[92:95], a[212:215], v[156:159]
ds_read_b64_tr_b16 v[90:91], v12 offset:21504
v_mfma_f32_16x16x32_bf16 v[128:131], v[96:99], a[216:219], v[128:131]
ds_read_b64_tr_b16 v[92:93], v13 offset:5120
v_mfma_f32_16x16x32_bf16 v[144:147], v[96:99], a[220:223], v[144:147]
ds_read_b64_tr_b16 v[94:95], v13 offset:21504
v_mfma_f32_16x16x32_bf16 v[132:135], v[100:103], a[216:219], v[132:135]
ds_read_b64_tr_b16 v[96:97], v10 offset:6144
v_mfma_f32_16x16x32_bf16 v[148:151], v[100:103], a[220:223], v[148:151]
ds_read_b64_tr_b16 v[98:99], v10 offset:22528
v_mfma_f32_16x16x32_bf16 v[136:139], v[104:107], a[216:219], v[136:139]
ds_read_b64_tr_b16 v[100:101], v11 offset:6144
v_mfma_f32_16x16x32_bf16 v[152:155], v[104:107], a[220:223], v[152:155]
ds_read_b64_tr_b16 v[102:103], v11 offset:22528
s_waitcnt lgkmcnt(6)
v_mfma_f32_16x16x32_bf16 v[140:143], v[108:111], a[216:219], v[140:143]
ds_read_b64_tr_b16 v[104:105], v12 offset:6144
v_mfma_f32_16x16x32_bf16 v[156:159], v[108:111], a[220:223], v[156:159]
ds_read_b64_tr_b16 v[106:107], v12 offset:22528
v_mfma_f32_16x16x32_bf16 v[128:131], v[112:115], a[224:227], v[128:131]
ds_read_b64_tr_b16 v[108:109], v13 offset:6144
v_mfma_f32_16x16x32_bf16 v[144:147], v[112:115], a[228:231], v[144:147]
ds_read_b64_tr_b16 v[110:111], v13 offset:22528
v_mfma_f32_16x16x32_bf16 v[132:135], v[116:119], a[224:227], v[132:135]
ds_read_b64_tr_b16 v[112:113], v10 offset:7168
v_mfma_f32_16x16x32_bf16 v[148:151], v[116:119], a[228:231], v[148:151]
ds_read_b64_tr_b16 v[114:115], v10 offset:23552
v_mfma_f32_16x16x32_bf16 v[136:139], v[120:123], a[224:227], v[136:139]
ds_read_b64_tr_b16 v[116:117], v11 offset:7168
v_mfma_f32_16x16x32_bf16 v[152:155], v[120:123], a[228:231], v[152:155]
ds_read_b64_tr_b16 v[118:119], v11 offset:23552
v_mfma_f32_16x16x32_bf16 v[140:143], v[124:127], a[224:227], v[140:143]
ds_read_b64_tr_b16 v[120:121], v12 offset:7168
v_mfma_f32_16x16x32_bf16 v[156:159], v[124:127], a[228:231], v[156:159]
ds_read_b64_tr_b16 v[122:123], v12 offset:23552
v_mfma_f32_16x16x32_bf16 v[128:131], v[80:83], a[232:235], v[128:131]
ds_read_b64_tr_b16 v[124:125], v13 offset:7168
v_mfma_f32_16x16x32_bf16 v[144:147], v[80:83], a[236:239], v[144:147]
ds_read_b64_tr_b16 v[126:127], v13 offset:23552
v_mfma_f32_16x16x32_bf16 v[132:135], v[84:87], a[232:235], v[132:135]
s_add_u32 m0, s76, 98304
s_add_u32 s77, s82, 0x1c0000
v_mfma_f32_16x16x32_bf16 v[148:151], v[84:87], a[236:239], v[148:151]
buffer_load_dwordx4 v30, s[44:47], s77 offen offset:0 lds
v_mfma_f32_16x16x32_bf16 v[136:139], v[88:91], a[232:235], v[136:139]
v_mfma_f32_16x16x32_bf16 v[152:155], v[88:91], a[236:239], v[152:155]
s_waitcnt lgkmcnt(2)
v_mfma_f32_16x16x32_bf16 v[140:143], v[92:95], a[232:235], v[140:143]
s_waitcnt vmcnt(11) lgkmcnt(0)
s_barrier
v_mfma_f32_16x16x32_bf16 v[156:159], v[92:95], a[236:239], v[156:159]
ds_read_b64_tr_b16 v[80:81], v18 offset:32768
ds_read_b64_tr_b16 v[82:83], v18 offset:40960
v_mfma_f32_16x16x32_bf16 v[128:131], v[96:99], a[240:243], v[128:131]
buffer_load_dwordx4 v31, s[44:47], s77 offen offset:1024 lds
v_mfma_f32_16x16x32_bf16 v[144:147], v[96:99], a[244:247], v[144:147]
ds_read_b64_tr_b16 v[84:85], v19 offset:32768
ds_read_b64_tr_b16 v[86:87], v19 offset:40960
v_mfma_f32_16x16x32_bf16 v[132:135], v[100:103], a[240:243], v[132:135]
ds_read_b64_tr_b16 v[88:89], v18 offset:49152
v_mfma_f32_16x16x32_bf16 v[148:151], v[100:103], a[244:247], v[148:151]
ds_read_b64_tr_b16 v[90:91], v18 offset:57344
ds_read_b64_tr_b16 v[92:93], v19 offset:49152
v_mfma_f32_16x16x32_bf16 v[136:139], v[104:107], a[240:243], v[136:139]
buffer_load_dwordx4 v32, s[44:47], s77 offen offset:2048 lds
v_mfma_f32_16x16x32_bf16 v[152:155], v[104:107], a[244:247], v[152:155]
ds_read_b64_tr_b16 v[94:95], v19 offset:57344
ds_read_b64_tr_b16 v[96:97], v18 offset:33792
v_mfma_f32_16x16x32_bf16 v[140:143], v[108:111], a[240:243], v[140:143]
ds_read_b64_tr_b16 v[98:99], v18 offset:41984
v_mfma_f32_16x16x32_bf16 v[156:159], v[108:111], a[244:247], v[156:159]
ds_read_b64_tr_b16 v[100:101], v19 offset:33792
ds_read_b64_tr_b16 v[102:103], v19 offset:41984
v_mfma_f32_16x16x32_bf16 v[128:131], v[112:115], a[248:251], v[128:131]
buffer_load_dwordx4 v33, s[44:47], s77 offen offset:3072 lds
v_mfma_f32_16x16x32_bf16 v[144:147], v[112:115], a[252:255], v[144:147]
ds_read_b64_tr_b16 v[104:105], v18 offset:50176
ds_read_b64_tr_b16 v[106:107], v18 offset:58368
v_mfma_f32_16x16x32_bf16 v[132:135], v[116:119], a[248:251], v[132:135]
ds_read_b64_tr_b16 v[108:109], v19 offset:50176
s_add_u32 m0, s76, 102400
v_mfma_f32_16x16x32_bf16 v[148:151], v[116:119], a[252:255], v[148:151]
ds_read_b64_tr_b16 v[110:111], v19 offset:58368
s_add_u32 s77, s82, 0x2a0000
v_mfma_f32_16x16x32_bf16 v[136:139], v[120:123], a[248:251], v[136:139]
buffer_load_dwordx4 v30, s[44:47], s77 offen offset:0 lds
v_mfma_f32_16x16x32_bf16 v[152:155], v[120:123], a[252:255], v[152:155]
ds_read_b64_tr_b16 v[112:113], v18 offset:34816
ds_read_b64_tr_b16 v[114:115], v18 offset:43008
v_mfma_f32_16x16x32_bf16 v[140:143], v[124:127], a[248:251], v[140:143]
ds_read_b64_tr_b16 v[116:117], v19 offset:34816
v_mfma_f32_16x16x32_bf16 v[156:159], v[124:127], a[252:255], v[156:159]
ds_read_b64_tr_b16 v[118:119], v19 offset:43008
ds_read_b64_tr_b16 v[120:121], v18 offset:51200
S_H0:
s_waitcnt lgkmcnt(7)
v_mfma_f32_16x16x32_bf16 v[224:227], v[80:83], a[0:3], 0
buffer_load_dwordx4 v31, s[44:47], s77 offen offset:1024 lds
v_mfma_f32_16x16x32_bf16 v[240:243], v[80:83], a[4:7], 0
ds_read_b64_tr_b16 v[122:123], v18 offset:59392
ds_read_b64_tr_b16 v[124:125], v19 offset:51200
v_mfma_f32_16x16x32_bf16 v[228:231], v[84:87], a[0:3], 0
ds_read_b64_tr_b16 v[126:127], v19 offset:59392
v_mfma_f32_16x16x32_bf16 v[244:247], v[84:87], a[4:7], 0
s_add_u32 s70, s0, S_H1 - K_pc + 0
s_addc_u32 s71, s1, 0
global_load_dword v57, v9, s[70:71]
v_mfma_f32_16x16x32_bf16 v[232:235], v[88:91], a[0:3], 0
ds_read_b64_tr_b16 v[80:81], v18 offset:35840
v_mul_f32 v68, v60, v128
v_mfma_f32_16x16x32_bf16 v[248:251], v[88:91], a[4:7], 0
buffer_load_dwordx4 v32, s[44:47], s77 offen offset:2048 lds
v_mfma_f32_16x16x32_bf16 v[236:239], v[92:95], a[0:3], 0
ds_read_b64_tr_b16 v[82:83], v18 offset:44032
ds_read_b64_tr_b16 v[84:85], v19 offset:35840
v_mfma_f32_16x16x32_bf16 v[252:255], v[92:95], a[4:7], 0
ds_read_b64_tr_b16 v[86:87], v19 offset:44032
s_mul_i32 s3, s101, 7168
v_mfma_f32_16x16x32_bf16 v[224:227], v[96:99], a[8:11], v[224:227]
ds_read_b64_tr_b16 v[88:89], v18 offset:52224
s_add_u32 s3, s3, 0x800
v_mfma_f32_16x16x32_bf16 v[240:243], v[96:99], a[12:15], v[240:243]
buffer_load_dwordx4 v33, s[44:47], s77 offen offset:3072 lds
v_mfma_f32_16x16x32_bf16 v[228:231], v[100:103], a[8:11], v[228:231]
ds_read_b64_tr_b16 v[90:91], v18 offset:60416
ds_read_b64_tr_b16 v[92:93], v19 offset:52224
v_mfma_f32_16x16x32_bf16 v[244:247], v[100:103], a[12:15], v[244:247]
ds_read_b64_tr_b16 v[94:95], v19 offset:60416
s_add_u32 m0, s76, 0
v_mfma_f32_16x16x32_bf16 v[232:235], v[104:107], a[8:11], v[232:235]
ds_read_b64_tr_b16 v[96:97], v18 offset:36864
s_add_u32 s77, s82, 0x380000
v_mfma_f32_16x16x32_bf16 v[248:251], v[104:107], a[12:15], v[248:251]
ds_read_b64_tr_b16 v[98:99], v18 offset:45056
s_waitcnt lgkmcnt(6)
v_mfma_f32_16x16x32_bf16 v[236:239], v[108:111], a[8:11], v[236:239]
buffer_load_dwordx4 v30, s[44:47], s77 offen offset:0 lds
v_mfma_f32_16x16x32_bf16 v[252:255], v[108:111], a[12:15], v[252:255]
ds_read_b64_tr_b16 v[100:101], v19 offset:36864
ds_read_b64_tr_b16 v[102:103], v19 offset:45056
v_mfma_f32_16x16x32_bf16 v[224:227], v[112:115], a[16:19], v[224:227]
ds_read_b64_tr_b16 v[104:105], v18 offset:53248
v_mul_f32 v69, v60, v129
v_mfma_f32_16x16x32_bf16 v[240:243], v[112:115], a[20:23], v[240:243]
ds_read_b64_tr_b16 v[106:107], v18 offset:61440
v_mul_f32 v70, v60, v130
v_mfma_f32_16x16x32_bf16 v[228:231], v[116:119], a[16:19], v[228:231]
buffer_load_dwordx4 v31, s[44:47], s77 offen offset:1024 lds
v_mfma_f32_16x16x32_bf16 v[244:247], v[116:119], a[20:23], v[244:247]
ds_read_b64_tr_b16 v[108:109], v19 offset:53248
ds_read_b64_tr_b16 v[110:111], v19 offset:61440
v_mfma_f32_16x16x32_bf16 v[232:235], v[120:123], a[16:19], v[232:235]
ds_read_b64_tr_b16 v[112:113], v18 offset:37888
v_mul_f32 v71, v60, v131
v_mfma_f32_16x16x32_bf16 v[248:251], v[120:123], a[20:23], v[248:251]
v_exp_f32 v68, v68
v_mfma_f32_16x16x32_bf16 v[236:239], v[124:127], a[16:19], v[236:239]
ds_read_b64_tr_b16 v[114:115], v18 offset:46080
ds_read_b64_tr_b16 v[116:117], v19 offset:37888
v_mfma_f32_16x16x32_bf16 v[252:255], v[124:127], a[20:23], v[252:255]
buffer_load_dwordx4 v32, s[44:47], s77 offen offset:2048 lds
v_mfma_f32_16x16x32_bf16 v[224:227], v[80:83], a[24:27], v[224:227]
ds_read_b64_tr_b16 v[118:119], v19 offset:46080
ds_read_b64_tr_b16 v[120:121], v18 offset:54272
v_mfma_f32_16x16x32_bf16 v[240:243], v[80:83], a[28:31], v[240:243]
v_exp_f32 v69, v69
v_mfma_f32_16x16x32_bf16 v[228:231], v[84:87], a[24:27], v[228:231]
ds_read_b64_tr_b16 v[122:123], v18 offset:62464
ds_read_b64_tr_b16 v[124:125], v19 offset:54272
v_mfma_f32_16x16x32_bf16 v[244:247], v[84:87], a[28:31], v[244:247]
ds_read_b64_tr_b16 v[126:127], v19 offset:62464
s_waitcnt lgkmcnt(7)
v_mfma_f32_16x16x32_bf16 v[232:235], v[88:91], a[24:27], v[232:235]
buffer_load_dwordx4 v33, s[44:47], s77 offen offset:3072 lds
v_mfma_f32_16x16x32_bf16 v[248:251], v[88:91], a[28:31], v[248:251]
ds_read_b64_tr_b16 v[80:81], v18 offset:38912
ds_read_b64_tr_b16 v[82:83], v18 offset:47104
v_mfma_f32_16x16x32_bf16 v[236:239], v[92:95], a[24:27], v[236:239]
v_exp_f32 v70, v70
v_mfma_f32_16x16x32_bf16 v[252:255], v[92:95], a[28:31], v[252:255]
ds_read_b64_tr_b16 v[84:85], v19 offset:38912
ds_read_b64_tr_b16 v[86:87], v19 offset:47104
v_mfma_f32_16x16x32_bf16 v[224:227], v[96:99], a[32:35], v[224:227]
v_exp_f32 v71, v71
v_mfma_f32_16x16x32_bf16 v[240:243], v[96:99], a[36:39], v[240:243]
ds_read_b64_tr_b16 v[88:89], v18 offset:55296
ds_read_b64_tr_b16 v[90:91], v18 offset:63488
v_mfma_f32_16x16x32_bf16 v[228:231], v[100:103], a[32:35], v[228:231]
ds_read_b64_tr_b16 v[92:93], v19 offset:55296
s_add_u32 m0, s76, 4096
v_mfma_f32_16x16x32_bf16 v[244:247], v[100:103], a[36:39], v[244:247]
ds_read_b64_tr_b16 v[94:95], v19 offset:63488
s_add_u32 s77, s82, 0x460000
v_mfma_f32_16x16x32_bf16 v[232:235], v[104:107], a[32:35], v[232:235]
buffer_load_dwordx4 v30, s[44:47], s77 offen offset:0 lds
v_mfma_f32_16x16x32_bf16 v[248:251], v[104:107], a[36:39], v[248:251]
ds_read_b64_tr_b16 v[96:97], v18 offset:39936
ds_read_b64_tr_b16 v[98:99], v18 offset:48128
v_mfma_f32_16x16x32_bf16 v[236:239], v[108:111], a[32:35], v[236:239]
ds_read_b64_tr_b16 v[100:101], v19 offset:39936
v_fma_f32 v68, v68, v62, v62
v_mfma_f32_16x16x32_bf16 v[252:255], v[108:111], a[36:39], v[252:255]
ds_read_b64_tr_b16 v[102:103], v19 offset:48128
s_waitcnt lgkmcnt(6)
v_mfma_f32_16x16x32_bf16 v[224:227], v[112:115], a[40:43], v[224:227]
buffer_load_dwordx4 v31, s[44:47], s77 offen offset:1024 lds
v_mfma_f32_16x16x32_bf16 v[240:243], v[112:115], a[44:47], v[240:243]
ds_read_b64_tr_b16 v[104:105], v18 offset:56320
ds_read_b64_tr_b16 v[106:107], v18 offset:64512
v_mfma_f32_16x16x32_bf16 v[228:231], v[116:119], a[40:43], v[228:231]
ds_read_b64_tr_b16 v[108:109], v19 offset:56320
v_fma_f32 v69, v69, v62, v62
v_mfma_f32_16x16x32_bf16 v[244:247], v[116:119], a[44:47], v[244:247]
ds_read_b64_tr_b16 v[110:111], v19 offset:64512
v_fma_f32 v70, v70, v62, v62
v_mfma_f32_16x16x32_bf16 v[232:235], v[120:123], a[40:43], v[232:235]
buffer_load_dwordx4 v32, s[44:47], s77 offen offset:2048 lds
v_mfma_f32_16x16x32_bf16 v[248:251], v[120:123], a[44:47], v[248:251]
v_fma_f32 v71, v71, v62, v62
v_mfma_f32_16x16x32_bf16 v[236:239], v[124:127], a[40:43], v[236:239]
v_rcp_f32 v68, v68
v_mfma_f32_16x16x32_bf16 v[252:255], v[124:127], a[44:47], v[252:255]
v_rcp_f32 v69, v69
v_mfma_f32_16x16x32_bf16 v[224:227], v[80:83], a[48:51], v[224:227]
s_waitcnt vmcnt(16) lgkmcnt(0)
s_barrier
v_mfma_f32_16x16x32_bf16 v[240:243], v[80:83], a[52:55], v[240:243]
ds_read_b64_tr_b16 v[112:113], v14 offset:0
ds_read_b64_tr_b16 v[114:115], v14 offset:16384
v_mfma_f32_16x16x32_bf16 v[228:231], v[84:87], a[48:51], v[228:231]
ds_read_b64_tr_b16 v[116:117], v15 offset:0
v_mfma_f32_16x16x32_bf16 v[244:247], v[84:87], a[52:55], v[244:247]
ds_read_b64_tr_b16 v[118:119], v15 offset:16384
ds_read_b64_tr_b16 v[120:121], v16 offset:0
v_mfma_f32_16x16x32_bf16 v[232:235], v[88:91], a[48:51], v[232:235]
buffer_load_dwordx4 v33, s[44:47], s77 offen offset:3072 lds
v_mfma_f32_16x16x32_bf16 v[248:251], v[88:91], a[52:55], v[248:251]
ds_read_b64_tr_b16 v[122:123], v16 offset:16384
ds_read_b64_tr_b16 v[124:125], v17 offset:0
v_mfma_f32_16x16x32_bf16 v[236:239], v[92:95], a[48:51], v[236:239]
v_rcp_f32 v70, v70
v_mfma_f32_16x16x32_bf16 v[252:255], v[92:95], a[52:55], v[252:255]
ds_read_b64_tr_b16 v[126:127], v17 offset:16384
ds_read_b64_tr_b16 v[80:81], v14 offset:1024
v_mfma_f32_16x16x32_bf16 v[224:227], v[96:99], a[56:59], v[224:227]
v_rcp_f32 v71, v71
v_mfma_f32_16x16x32_bf16 v[240:243], v[96:99], a[60:63], v[240:243]
ds_read_b64_tr_b16 v[82:83], v14 offset:17408
ds_read_b64_tr_b16 v[84:85], v15 offset:1024
v_mfma_f32_16x16x32_bf16 v[228:231], v[100:103], a[56:59], v[228:231]
ds_read_b64_tr_b16 v[86:87], v15 offset:17408
s_add_u32 m0, s76, 32768
v_mfma_f32_16x16x32_bf16 v[244:247], v[100:103], a[60:63], v[244:247]
ds_read_b64_tr_b16 v[88:89], v16 offset:1024
s_add_u32 s77, s82, 0x540000
v_mfma_f32_16x16x32_bf16 v[232:235], v[104:107], a[56:59], v[232:235]
buffer_load_dwordx4 v30, s[44:47], s77 offen offset:0 lds
v_mfma_f32_16x16x32_bf16 v[248:251], v[104:107], a[60:63], v[248:251]
ds_read_b64_tr_b16 v[90:91], v16 offset:17408
ds_read_b64_tr_b16 v[92:93], v17 offset:1024
v_mfma_f32_16x16x32_bf16 v[236:239], v[108:111], a[56:59], v[236:239]
ds_read_b64_tr_b16 v[94:95], v17 offset:17408
v_mul_f32 v128, v128, v68
v_mfma_f32_16x16x32_bf16 v[252:255], v[108:111], a[60:63], v[252:255]
ds_read_b64_tr_b16 v[96:97], v14 offset:2048
s_waitcnt lgkmcnt(6)
v_mfma_f32_16x16x32_bf16 v[192:195], v[112:115], a[0:3], 0
buffer_load_dwordx4 v31, s[44:47], s77 offen offset:1024 lds
v_mfma_f32_16x16x32_bf16 v[208:211], v[112:115], a[4:7], 0
ds_read_b64_tr_b16 v[98:99], v14 offset:18432
ds_read_b64_tr_b16 v[100:101], v15 offset:2048
v_mfma_f32_16x16x32_bf16 v[196:199], v[116:119], a[0:3], 0
ds_read_b64_tr_b16 v[102:103], v15 offset:18432
v_mul_f32 v129, v129, v69
v_mfma_f32_16x16x32_bf16 v[212:215], v[116:119], a[4:7], 0
ds_read_b64_tr_b16 v[104:105], v16 offset:2048
ds_read_b64_tr_b16 v[106:107], v16 offset:18432
v_mfma_f32_16x16x32_bf16 v[200:203], v[120:123], a[0:3], 0
buffer_load_dwordx4 v32, s[44:47], s77 offen offset:2048 lds
v_mfma_f32_16x16x32_bf16 v[216:219], v[120:123], a[4:7], 0
ds_read_b64_tr_b16 v[108:109], v17 offset:2048
ds_read_b64_tr_b16 v[110:111], v17 offset:18432
v_mfma_f32_16x16x32_bf16 v[204:207], v[124:127], a[0:3], 0
ds_read_b64_tr_b16 v[112:113], v14 offset:3072
v_mul_f32 v130, v130, v70
v_mfma_f32_16x16x32_bf16 v[220:223], v[124:127], a[4:7], 0
ds_read_b64_tr_b16 v[114:115], v14 offset:19456
ds_read_b64_tr_b16 v[116:117], v15 offset:3072
v_mfma_f32_16x16x32_bf16 v[192:195], v[80:83], a[8:11], v[192:195]
buffer_load_dwordx4 v33, s[44:47], s77 offen offset:3072 lds
v_mfma_f32_16x16x32_bf16 v[208:211], v[80:83], a[12:15], v[208:211]
ds_read_b64_tr_b16 v[118:119], v15 offset:19456
s_waitcnt lgkmcnt(6)
v_mfma_f32_16x16x32_bf16 v[196:199], v[84:87], a[8:11], v[196:199]
ds_read_b64_tr_b16 v[120:121], v16 offset:3072
s_add_u32 m0, s76, 36864
v_mfma_f32_16x16x32_bf16 v[212:215], v[84:87], a[12:15], v[212:215]
ds_read_b64_tr_b16 v[122:123], v16 offset:19456
s_add_u32 s77, s82, 0x620000
v_mfma_f32_16x16x32_bf16 v[200:203], v[88:91], a[8:11], v[200:203]
buffer_load_dwordx4 v30, s[44:47], s77 offen offset:0 lds
v_mfma_f32_16x16x32_bf16 v[216:219], v[88:91], a[12:15], v[216:219]
ds_read_b64_tr_b16 v[124:125], v17 offset:3072
ds_read_b64_tr_b16 v[126:127], v17 offset:19456
v_mfma_f32_16x16x32_bf16 v[204:207], v[92:95], a[8:11], v[204:207]
ds_read_b64_tr_b16 v[80:81], v14 offset:4096
v_mul_f32 v131, v131, v71
v_mfma_f32_16x16x32_bf16 v[220:223], v[92:95], a[12:15], v[220:223]
ds_read_b64_tr_b16 v[82:83], v14 offset:20480
ds_read_b64_tr_b16 v[84:85], v15 offset:4096
v_mfma_f32_16x16x32_bf16 v[192:195], v[96:99], a[16:19], v[192:195]
buffer_load_dwordx4 v31, s[44:47], s77 offen offset:1024 lds
v_mfma_f32_16x16x32_bf16 v[208:211], v[96:99], a[20:23], v[208:211]
ds_read_b64_tr_b16 v[86:87], v15 offset:20480
ds_read_b64_tr_b16 v[88:89], v16 offset:4096
v_mfma_f32_16x16x32_bf16 v[196:199], v[100:103], a[16:19], v[196:199]
ds_read_b64_tr_b16 v[90:91], v16 offset:20480
v_mul_f32 v72, v60, v132
v_mfma_f32_16x16x32_bf16 v[212:215], v[100:103], a[20:23], v[212:215]
ds_read_b64_tr_b16 v[92:93], v17 offset:4096
ds_read_b64_tr_b16 v[94:95], v17 offset:20480
v_mfma_f32_16x16x32_bf16 v[200:203], v[104:107], a[16:19], v[200:203]
buffer_load_dwordx4 v32, s[44:47], s77 offen offset:2048 lds
v_mfma_f32_16x16x32_bf16 v[216:219], v[104:107], a[20:23], v[216:219]
ds_read_b64_tr_b16 v[96:97], v14 offset:5120
s_waitcnt lgkmcnt(6)
v_mfma_f32_16x16x32_bf16 v[204:207], v[108:111], a[16:19], v[204:207]
ds_read_b64_tr_b16 v[98:99], v14 offset:21504
ds_read_b64_tr_b16 v[100:101], v15 offset:5120
v_mfma_f32_16x16x32_bf16 v[220:223], v[108:111], a[20:23], v[220:223]
ds_read_b64_tr_b16 v[102:103], v15 offset:21504
v_mul_f32 v73, v60, v133
v_mfma_f32_16x16x32_bf16 v[192:195], v[112:115], a[24:27], v[192:195]
buffer_load_dwordx4 v33, s[44:47], s77 offen offset:3072 lds
v_mfma_f32_16x16x32_bf16 v[208:211], v[112:115], a[28:31], v[208:211]
ds_read_b64_tr_b16 v[104:105], v16 offset:5120
ds_read_b64_tr_b16 v[106:107], v16 offset:21504
v_mfma_f32_16x16x32_bf16 v[196:199], v[116:119], a[24:27], v[196:199]
buffer_load_dword v57, v8, s[44:47], s3 offen
v_mfma_f32_16x16x32_bf16 v[212:215], v[116:119], a[28:31], v[212:215]
ds_read_b64_tr_b16 v[108:109], v17 offset:5120
ds_read_b64_tr_b16 v[110:111], v17 offset:21504
v_mfma_f32_16x16x32_bf16 v[200:203], v[120:123], a[24:27], v[200:203]
ds_read_b64_tr_b16 v[112:113], v14 offset:6144
s_mul_i32 s3, s101, 1024
v_mfma_f32_16x16x32_bf16 v[216:219], v[120:123], a[28:31], v[216:219]
ds_read_b64_tr_b16 v[114:115], v14 offset:22528
s_add_u32 s3, s3, 0x400000
v_mfma_f32_16x16x32_bf16 v[204:207], v[124:127], a[24:27], v[204:207]
buffer_load_dword v57, v50, s[48:51], s3 offen
v_mfma_f32_16x16x32_bf16 v[220:223], v[124:127], a[28:31], v[220:223]
ds_read_b64_tr_b16 v[116:117], v15 offset:6144
ds_read_b64_tr_b16 v[118:119], v15 offset:22528
v_mfma_f32_16x16x32_bf16 v[192:195], v[80:83], a[32:35], v[192:195]
ds_read_b64_tr_b16 v[120:121], v16 offset:6144
v_mul_f32 v74, v60, v134
v_mfma_f32_16x16x32_bf16 v[208:211], v[80:83], a[36:39], v[208:211]
ds_read_b64_tr_b16 v[122:123], v16 offset:22528
s_waitcnt lgkmcnt(6)
v_mfma_f32_16x16x32_bf16 v[196:199], v[84:87], a[32:35], v[196:199]
ds_read_b64_tr_b16 v[124:125], v17 offset:6144
v_mul_f32 v75, v60, v135
v_mfma_f32_16x16x32_bf16 v[212:215], v[84:87], a[36:39], v[212:215]
v_exp_f32 v72, v72
v_mfma_f32_16x16x32_bf16 v[200:203], v[88:91], a[32:35], v[200:203]
ds_read_b64_tr_b16 v[126:127], v17 offset:22528
ds_read_b64_tr_b16 v[80:81], v14 offset:7168
v_mfma_f32_16x16x32_bf16 v[216:219], v[88:91], a[36:39], v[216:219]
v_exp_f32 v73, v73
v_mfma_f32_16x16x32_bf16 v[204:207], v[92:95], a[32:35], v[204:207]
ds_read_b64_tr_b16 v[82:83], v14 offset:23552
ds_read_b64_tr_b16 v[84:85], v15 offset:7168
v_mfma_f32_16x16x32_bf16 v[220:223], v[92:95], a[36:39], v[220:223]
v_exp_f32 v74, v74
v_mfma_f32_16x16x32_bf16 v[192:195], v[96:99], a[40:43], v[192:195]
ds_read_b64_tr_b16 v[86:87], v15 offset:23552
ds_read_b64_tr_b16 v[88:89], v16 offset:7168
v_mfma_f32_16x16x32_bf16 v[208:211], v[96:99], a[44:47], v[208:211]
v_exp_f32 v75, v75
v_mfma_f32_16x16x32_bf16 v[196:199], v[100:103], a[40:43], v[196:199]
ds_read_b64_tr_b16 v[90:91], v16 offset:23552
ds_read_b64_tr_b16 v[92:93], v17 offset:7168
v_mfma_f32_16x16x32_bf16 v[212:215], v[100:103], a[44:47], v[212:215]
ds_read_b64_tr_b16 v[94:95], v17 offset:23552
v_fma_f32 v72, v72, v62, v62
v_mfma_f32_16x16x32_bf16 v[200:203], v[104:107], a[40:43], v[200:203]
v_fma_f32 v73, v73, v62, v62
v_fma_f32 v74, v74, v62, v62
v_mfma_f32_16x16x32_bf16 v[216:219], v[104:107], a[44:47], v[216:219]
v_fma_f32 v75, v75, v62, v62
v_mfma_f32_16x16x32_bf16 v[204:207], v[108:111], a[40:43], v[204:207]
v_rcp_f32 v72, v72
v_mfma_f32_16x16x32_bf16 v[220:223], v[108:111], a[44:47], v[220:223]
s_waitcnt lgkmcnt(3)
v_mfma_f32_16x16x32_bf16 v[192:195], v[112:115], a[48:51], v[192:195]
s_waitcnt vmcnt(18) lgkmcnt(0)
s_barrier
v_mfma_f32_16x16x32_bf16 v[208:211], v[112:115], a[52:55], v[208:211]
ds_read_b64_tr_b16 v[96:97], v14 offset:32768
ds_read_b64_tr_b16 v[98:99], v14 offset:49152
v_mfma_f32_16x16x32_bf16 v[196:199], v[116:119], a[48:51], v[196:199]
ds_read_b64_tr_b16 v[100:101], v15 offset:32768
s_add_u32 m0, s76, 65536
v_mfma_f32_16x16x32_bf16 v[212:215], v[116:119], a[52:55], v[212:215]
ds_read_b64_tr_b16 v[102:103], v15 offset:49152
s_add_u32 s77, s85, 0x1c0000
v_mfma_f32_16x16x32_bf16 v[200:203], v[120:123], a[48:51], v[200:203]
ds_read_b64_tr_b16 v[104:105], v16 offset:32768
ds_read_b64_tr_b16 v[106:107], v16 offset:49152
v_mfma_f32_16x16x32_bf16 v[216:219], v[120:123], a[52:55], v[216:219]
buffer_load_dwordx4 v34, s[52:55], s77 offen offset:0 lds
v_mfma_f32_16x16x32_bf16 v[204:207], v[124:127], a[48:51], v[204:207]
ds_read_b64_tr_b16 v[108:109], v17 offset:32768
ds_read_b64_tr_b16 v[110:111], v17 offset:49152
v_mfma_f32_16x16x32_bf16 v[220:223], v[124:127], a[52:55], v[220:223]
v_rcp_f32 v73, v73
v_mfma_f32_16x16x32_bf16 v[192:195], v[80:83], a[56:59], v[192:195]
ds_read_b64_tr_b16 v[112:113], v14 offset:33792
ds_read_b64_tr_b16 v[114:115], v14 offset:50176
v_mfma_f32_16x16x32_bf16 v[208:211], v[80:83], a[60:63], v[208:211]
v_rcp_f32 v74, v74
v_mfma_f32_16x16x32_bf16 v[196:199], v[84:87], a[56:59], v[196:199]
ds_read_b64_tr_b16 v[116:117], v15 offset:33792
ds_read_b64_tr_b16 v[118:119], v15 offset:50176
v_mfma_f32_16x16x32_bf16 v[212:215], v[84:87], a[60:63], v[212:215]
buffer_load_dwordx4 v35, s[52:55], s77 offen offset:1024 lds
v_mfma_f32_16x16x32_bf16 v[200:203], v[88:91], a[56:59], v[200:203]
ds_read_b64_tr_b16 v[120:121], v16 offset:33792
ds_read_b64_tr_b16 v[122:123], v16 offset:50176
v_mfma_f32_16x16x32_bf16 v[216:219], v[88:91], a[60:63], v[216:219]
v_rcp_f32 v75, v75
v_mfma_f32_16x16x32_bf16 v[204:207], v[92:95], a[56:59], v[204:207]
ds_read_b64_tr_b16 v[124:125], v17 offset:33792
ds_read_b64_tr_b16 v[126:127], v17 offset:50176
v_mfma_f32_16x16x32_bf16 v[220:223], v[92:95], a[60:63], v[220:223]
ds_read_b64_tr_b16 v[80:81], v14 offset:34816
s_waitcnt lgkmcnt(7)
v_mfma_f32_16x16x32_bf16 v[192:195], v[96:99], a[64:67], v[192:195]
ds_read_b64_tr_b16 v[82:83], v14 offset:51200
ds_read_b64_tr_b16 v[84:85], v15 offset:34816
v_mfma_f32_16x16x32_bf16 v[208:211], v[96:99], a[68:71], v[208:211]
buffer_load_dwordx4 v36, s[52:55], s77 offen offset:2048 lds
v_mfma_f32_16x16x32_bf16 v[196:199], v[100:103], a[64:67], v[196:199]
ds_read_b64_tr_b16 v[86:87], v15 offset:51200
ds_read_b64_tr_b16 v[88:89], v16 offset:34816
v_mfma_f32_16x16x32_bf16 v[212:215], v[100:103], a[68:71], v[212:215]
ds_read_b64_tr_b16 v[90:91], v16 offset:51200
v_mul_f32 v132, v132, v72
v_mfma_f32_16x16x32_bf16 v[200:203], v[104:107], a[64:67], v[200:203]
ds_read_b64_tr_b16 v[92:93], v17 offset:34816
ds_read_b64_tr_b16 v[94:95], v17 offset:51200
v_mfma_f32_16x16x32_bf16 v[216:219], v[104:107], a[68:71], v[216:219]
ds_read_b64_tr_b16 v[96:97], v14 offset:35840
v_mul_f32 v133, v133, v73
v_mfma_f32_16x16x32_bf16 v[204:207], v[108:111], a[64:67], v[204:207]
ds_read_b64_tr_b16 v[98:99], v14 offset:52224
ds_read_b64_tr_b16 v[100:101], v15 offset:35840
v_mfma_f32_16x16x32_bf16 v[220:223], v[108:111], a[68:71], v[220:223]
buffer_load_dwordx4 v37, s[52:55], s77 offen offset:3072 lds
v_mfma_f32_16x16x32_bf16 v[192:195], v[112:115], a[72:75], v[192:195]
ds_read_b64_tr_b16 v[102:103], v15 offset:52224
ds_read_b64_tr_b16 v[104:105], v16 offset:35840
v_mfma_f32_16x16x32_bf16 v[208:211], v[112:115], a[76:79], v[208:211]
ds_read_b64_tr_b16 v[106:107], v16 offset:52224
s_waitcnt lgkmcnt(8)
v_mfma_f32_16x16x32_bf16 v[196:199], v[116:119], a[72:75], v[196:199]
ds_read_b64_tr_b16 v[108:109], v17 offset:35840
s_add_u32 m0, s76, 69632
v_mfma_f32_16x16x32_bf16 v[212:215], v[116:119], a[76:79], v[212:215]
ds_read_b64_tr_b16 v[110:111], v17 offset:52224
s_add_u32 s77, s85, 0x2a0000
v_mfma_f32_16x16x32_bf16 v[200:203], v[120:123], a[72:75], v[200:203]
ds_read_b64_tr_b16 v[112:113], v14 offset:36864
v_mul_f32 v134, v134, v74
v_mfma_f32_16x16x32_bf16 v[216:219], v[120:123], a[76:79], v[216:219]
buffer_load_dwordx4 v34, s[52:55], s77 offen offset:0 lds
v_mfma_f32_16x16x32_bf16 v[204:207], v[124:127], a[72:75], v[204:207]
ds_read_b64_tr_b16 v[114:115], v14 offset:53248
ds_read_b64_tr_b16 v[116:117], v15 offset:36864
v_mfma_f32_16x16x32_bf16 v[220:223], v[124:127], a[76:79], v[220:223]
ds_read_b64_tr_b16 v[118:119], v15 offset:53248
v_mul_f32 v135, v135, v75
v_mfma_f32_16x16x32_bf16 v[192:195], v[80:83], a[80:83], v[192:195]
ds_read_b64_tr_b16 v[120:121], v16 offset:36864
v_mul_f32 v68, v60, v136
v_mfma_f32_16x16x32_bf16 v[208:211], v[80:83], a[84:87], v[208:211]
ds_read_b64_tr_b16 v[122:123], v16 offset:53248
v_mul_f32 v69, v60, v137
v_mfma_f32_16x16x32_bf16 v[196:199], v[84:87], a[80:83], v[196:199]
ds_read_b64_tr_b16 v[124:125], v17 offset:36864
v_mul_f32 v70, v60, v138
v_mfma_f32_16x16x32_bf16 v[212:215], v[84:87], a[84:87], v[212:215]
buffer_load_dwordx4 v35, s[52:55], s77 offen offset:1024 lds
v_mfma_f32_16x16x32_bf16 v[200:203], v[88:91], a[80:83], v[200:203]
ds_read_b64_tr_b16 v[126:127], v17 offset:53248
ds_read_b64_tr_b16 v[80:81], v14 offset:37888
v_mfma_f32_16x16x32_bf16 v[216:219], v[88:91], a[84:87], v[216:219]
ds_read_b64_tr_b16 v[82:83], v14 offset:54272
s_waitcnt lgkmcnt(6)
v_mfma_f32_16x16x32_bf16 v[204:207], v[92:95], a[80:83], v[204:207]
ds_read_b64_tr_b16 v[84:85], v15 offset:37888
v_mul_f32 v71, v60, v139
v_mfma_f32_16x16x32_bf16 v[220:223], v[92:95], a[84:87], v[220:223]
v_exp_f32 v68, v68
v_mfma_f32_16x16x32_bf16 v[192:195], v[96:99], a[88:91], v[192:195]
ds_read_b64_tr_b16 v[86:87], v15 offset:54272
ds_read_b64_tr_b16 v[88:89], v16 offset:37888
v_mfma_f32_16x16x32_bf16 v[208:211], v[96:99], a[92:95], v[208:211]
buffer_load_dwordx4 v36, s[52:55], s77 offen offset:2048 lds
v_mfma_f32_16x16x32_bf16 v[196:199], v[100:103], a[88:91], v[196:199]
ds_read_b64_tr_b16 v[90:91], v16 offset:54272
ds_read_b64_tr_b16 v[92:93], v17 offset:37888
v_mfma_f32_16x16x32_bf16 v[212:215], v[100:103], a[92:95], v[212:215]
v_exp_f32 v69, v69
v_mfma_f32_16x16x32_bf16 v[200:203], v[104:107], a[88:91], v[200:203]
ds_read_b64_tr_b16 v[94:95], v17 offset:54272
ds_read_b64_tr_b16 v[96:97], v14 offset:38912
v_mfma_f32_16x16x32_bf16 v[216:219], v[104:107], a[92:95], v[216:219]
v_exp_f32 v70, v70
v_mfma_f32_16x16x32_bf16 v[204:207], v[108:111], a[88:91], v[204:207]
ds_read_b64_tr_b16 v[98:99], v14 offset:55296
ds_read_b64_tr_b16 v[100:101], v15 offset:38912
v_mfma_f32_16x16x32_bf16 v[220:223], v[108:111], a[92:95], v[220:223]
buffer_load_dwordx4 v37, s[52:55], s77 offen offset:3072 lds
v_mfma_f32_16x16x32_bf16 v[192:195], v[112:115], a[96:99], v[192:195]
ds_read_b64_tr_b16 v[102:103], v15 offset:55296
ds_read_b64_tr_b16 v[104:105], v16 offset:38912
v_mfma_f32_16x16x32_bf16 v[208:211], v[112:115], a[100:103], v[208:211]
v_exp_f32 v71, v71
v_mfma_f32_16x16x32_bf16 v[196:199], v[116:119], a[96:99], v[196:199]
ds_read_b64_tr_b16 v[106:107], v16 offset:55296
ds_read_b64_tr_b16 v[108:109], v17 offset:38912
v_mfma_f32_16x16x32_bf16 v[212:215], v[116:119], a[100:103], v[212:215]
ds_read_b64_tr_b16 v[110:111], v17 offset:55296
s_waitcnt lgkmcnt(7)
v_mfma_f32_16x16x32_bf16 v[200:203], v[120:123], a[96:99], v[200:203]
ds_read_b64_tr_b16 v[112:113], v14 offset:39936
v_fma_f32 v68, v68, v62, v62
v_mfma_f32_16x16x32_bf16 v[216:219], v[120:123], a[100:103], v[216:219]
ds_read_b64_tr_b16 v[114:115], v14 offset:56320
v_fma_f32 v69, v69, v62, v62
v_mfma_f32_16x16x32_bf16 v[204:207], v[124:127], a[96:99], v[204:207]
ds_read_b64_tr_b16 v[116:117], v15 offset:39936
v_fma_f32 v70, v70, v62, v62
v_mfma_f32_16x16x32_bf16 v[220:223], v[124:127], a[100:103], v[220:223]
ds_read_b64_tr_b16 v[118:119], v15 offset:56320
v_fma_f32 v71, v71, v62, v62
v_mfma_f32_16x16x32_bf16 v[192:195], v[80:83], a[104:107], v[192:195]
v_rcp_f32 v68, v68
v_mfma_f32_16x16x32_bf16 v[208:211], v[80:83], a[108:111], v[208:211]
ds_read_b64_tr_b16 v[120:121], v16 offset:39936
ds_read_b64_tr_b16 v[122:123], v16 offset:56320
v_mfma_f32_16x16x32_bf16 v[196:199], v[84:87], a[104:107], v[196:199]
v_rcp_f32 v69, v69
v_mfma_f32_16x16x32_bf16 v[212:215], v[84:87], a[108:111], v[212:215]
ds_read_b64_tr_b16 v[124:125], v17 offset:39936
ds_read_b64_tr_b16 v[126:127], v17 offset:56320
v_mfma_f32_16x16x32_bf16 v[200:203], v[88:91], a[104:107], v[200:203]
v_rcp_f32 v70, v70
v_mfma_f32_16x16x32_bf16 v[216:219], v[88:91], a[108:111], v[216:219]
v_rcp_f32 v71, v71
v_mfma_f32_16x16x32_bf16 v[204:207], v[92:95], a[104:107], v[204:207]
v_mul_f32 v136, v136, v68
v_mul_f32 v137, v137, v69
v_mfma_f32_16x16x32_bf16 v[220:223], v[92:95], a[108:111], v[220:223]
v_mul_f32 v138, v138, v70
s_waitcnt lgkmcnt(2)
v_mfma_f32_16x16x32_bf16 v[192:195], v[96:99], a[112:115], v[192:195]
s_waitcnt vmcnt(18) lgkmcnt(0)
s_barrier
v_mfma_f32_16x16x32_bf16 v[208:211], v[96:99], a[116:119], v[208:211]
ds_read_b64_tr_b16 v[80:81], v10 offset:0
ds_read_b64_tr_b16 v[82:83], v10 offset:16384
v_mfma_f32_16x16x32_bf16 v[196:199], v[100:103], a[112:115], v[196:199]
ds_read_b64_tr_b16 v[84:85], v11 offset:0
v_mul_f32 v139, v139, v71
v_mfma_f32_16x16x32_bf16 v[212:215], v[100:103], a[116:119], v[212:215]
ds_read_b64_tr_b16 v[86:87], v11 offset:16384
ds_read_b64_tr_b16 v[88:89], v12 offset:0
v_mfma_f32_16x16x32_bf16 v[200:203], v[104:107], a[112:115], v[200:203]
ds_read_b64_tr_b16 v[90:91], v12 offset:16384
v_mul_f32 v72, v60, v140
v_mfma_f32_16x16x32_bf16 v[216:219], v[104:107], a[116:119], v[216:219]
ds_read_b64_tr_b16 v[92:93], v13 offset:0
ds_read_b64_tr_b16 v[94:95], v13 offset:16384
v_mfma_f32_16x16x32_bf16 v[204:207], v[108:111], a[112:115], v[204:207]
ds_read_b64_tr_b16 v[96:97], v10 offset:1024
v_mul_f32 v73, v60, v141
v_mfma_f32_16x16x32_bf16 v[220:223], v[108:111], a[116:119], v[220:223]
ds_read_b64_tr_b16 v[98:99], v10 offset:17408
ds_read_b64_tr_b16 v[100:101], v11 offset:1024
v_mfma_f32_16x16x32_bf16 v[192:195], v[112:115], a[120:123], v[192:195]
ds_read_b64_tr_b16 v[102:103], v11 offset:17408
v_mul_f32 v74, v60, v142
v_mfma_f32_16x16x32_bf16 v[208:211], v[112:115], a[124:127], v[208:211]
ds_read_b64_tr_b16 v[104:105], v12 offset:1024
ds_read_b64_tr_b16 v[106:107], v12 offset:17408
v_mfma_f32_16x16x32_bf16 v[196:199], v[116:119], a[120:123], v[196:199]
ds_read_b64_tr_b16 v[108:109], v13 offset:1024
v_mul_f32 v75, v60, v143
v_mfma_f32_16x16x32_bf16 v[212:215], v[116:119], a[124:127], v[212:215]
v_exp_f32 v72, v72
v_mfma_f32_16x16x32_bf16 v[200:203], v[120:123], a[120:123], v[200:203]
ds_read_b64_tr_b16 v[110:111], v13 offset:17408
ds_read_b64_tr_b16 v[112:113], v10 offset:2048
v_mfma_f32_16x16x32_bf16 v[216:219], v[120:123], a[124:127], v[216:219]
v_exp_f32 v73, v73
v_mfma_f32_16x16x32_bf16 v[204:207], v[124:127], a[120:123], v[204:207]
ds_read_b64_tr_b16 v[114:115], v10 offset:18432
ds_read_b64_tr_b16 v[116:117], v11 offset:2048
v_mfma_f32_16x16x32_bf16 v[220:223], v[124:127], a[124:127], v[220:223]
ds_read_b64_tr_b16 v[118:119], v11 offset:18432
s_waitcnt lgkmcnt(6)
v_mfma_f32_16x16x32_bf16 v[192:195], v[80:83], a[128:131], v[192:195]
v_exp_f32 v74, v74
v_mfma_f32_16x16x32_bf16 v[208:211], v[80:83], a[132:135], v[208:211]
ds_read_b64_tr_b16 v[120:121], v12 offset:2048
ds_read_b64_tr_b16 v[122:123], v12 offset:18432
v_mfma_f32_16x16x32_bf16 v[196:199], v[84:87], a[128:131], v[196:199]
v_exp_f32 v75, v75
v_mfma_f32_16x16x32_bf16 v[212:215], v[84:87], a[132:135], v[212:215]
ds_read_b64_tr_b16 v[124:125], v13 offset:2048
ds_read_b64_tr_b16 v[126:127], v13 offset:18432
v_mfma_f32_16x16x32_bf16 v[200:203], v[88:91], a[128:131], v[200:203]
ds_read_b64_tr_b16 v[80:81], v10 offset:3072
v_fma_f32 v72, v72, v62, v62
v_mfma_f32_16x16x32_bf16 v[216:219], v[88:91], a[132:135], v[216:219]
ds_read_b64_tr_b16 v[82:83], v10 offset:19456
v_fma_f32 v73, v73, v62, v62
v_mfma_f32_16x16x32_bf16 v[204:207], v[92:95], a[128:131], v[204:207]
ds_read_b64_tr_b16 v[84:85], v11 offset:3072
v_fma_f32 v74, v74, v62, v62
v_mfma_f32_16x16x32_bf16 v[220:223], v[92:95], a[132:135], v[220:223]
ds_read_b64_tr_b16 v[86:87], v11 offset:19456
v_fma_f32 v75, v75, v62, v62
v_mfma_f32_16x16x32_bf16 v[192:195], v[96:99], a[136:139], v[192:195]
v_rcp_f32 v72, v72
v_mfma_f32_16x16x32_bf16 v[208:211], v[96:99], a[140:143], v[208:211]
ds_read_b64_tr_b16 v[88:89], v12 offset:3072
ds_read_b64_tr_b16 v[90:91], v12 offset:19456
v_mfma_f32_16x16x32_bf16 v[196:199], v[100:103], a[136:139], v[196:199]
v_rcp_f32 v73, v73
v_mfma_f32_16x16x32_bf16 v[212:215], v[100:103], a[140:143], v[212:215]
ds_read_b64_tr_b16 v[92:93], v13 offset:3072
ds_read_b64_tr_b16 v[94:95], v13 offset:19456
v_mfma_f32_16x16x32_bf16 v[200:203], v[104:107], a[136:139], v[200:203]
v_rcp_f32 v74, v74
v_mfma_f32_16x16x32_bf16 v[216:219], v[104:107], a[140:143], v[216:219]
ds_read_b64_tr_b16 v[96:97], v10 offset:4096
s_waitcnt lgkmcnt(5)
v_mfma_f32_16x16x32_bf16 v[204:207], v[108:111], a[136:139], v[204:207]
v_rcp_f32 v75, v75
v_mfma_f32_16x16x32_bf16 v[220:223], v[108:111], a[140:143], v[220:223]
ds_read_b64_tr_b16 v[98:99], v10 offset:20480
ds_read_b64_tr_b16 v[100:101], v11 offset:4096
v_mfma_f32_16x16x32_bf16 v[192:195], v[112:115], a[144:147], v[192:195]
ds_read_b64_tr_b16 v[102:103], v11 offset:20480
v_mul_f32 v140, v140, v72
v_mfma_f32_16x16x32_bf16 v[208:211], v[112:115], a[148:151], v[208:211]
ds_read_b64_tr_b16 v[104:105], v12 offset:4096
ds_read_b64_tr_b16 v[106:107], v12 offset:20480
v_mfma_f32_16x16x32_bf16 v[196:199], v[116:119], a[144:147], v[196:199]
ds_read_b64_tr_b16 v[108:109], v13 offset:4096
v_mul_f32 v141, v141, v73
v_mfma_f32_16x16x32_bf16 v[212:215], v[116:119], a[148:151], v[212:215]
ds_read_b64_tr_b16 v[110:111], v13 offset:20480
v_mul_f32 v142, v142, v74
v_mfma_f32_16x16x32_bf16 v[200:203], v[120:123], a[144:147], v[200:203]
ds_read_b64_tr_b16 v[112:113], v10 offset:5120
v_mul_f32 v143, v143, v75
v_mfma_f32_16x16x32_bf16 v[216:219], v[120:123], a[148:151], v[216:219]
ds_read_b64_tr_b16 v[114:115], v10 offset:21504
v_mul_f32 v68, v61, v144
v_mfma_f32_16x16x32_bf16 v[204:207], v[124:127], a[144:147], v[204:207]
ds_read_b64_tr_b16 v[116:117], v11 offset:5120
v_mul_f32 v69, v61, v145
v_mfma_f32_16x16x32_bf16 v[220:223], v[124:127], a[148:151], v[220:223]
ds_read_b64_tr_b16 v[118:119], v11 offset:21504
v_mul_f32 v70, v61, v146
v_mfma_f32_16x16x32_bf16 v[192:195], v[80:83], a[152:155], v[192:195]
ds_read_b64_tr_b16 v[120:121], v12 offset:5120
v_mul_f32 v71, v61, v147
v_mfma_f32_16x16x32_bf16 v[208:211], v[80:83], a[156:159], v[208:211]
v_exp_f32 v68, v68
v_mfma_f32_16x16x32_bf16 v[196:199], v[84:87], a[152:155], v[196:199]
ds_read_b64_tr_b16 v[122:123], v12 offset:21504
ds_read_b64_tr_b16 v[124:125], v13 offset:5120
v_mfma_f32_16x16x32_bf16 v[212:215], v[84:87], a[156:159], v[212:215]
ds_read_b64_tr_b16 v[126:127], v13 offset:21504
s_waitcnt lgkmcnt(6)
v_mfma_f32_16x16x32_bf16 v[200:203], v[88:91], a[152:155], v[200:203]
v_exp_f32 v69, v69
v_mfma_f32_16x16x32_bf16 v[216:219], v[88:91], a[156:159], v[216:219]
ds_read_b64_tr_b16 v[80:81], v10 offset:6144
ds_read_b64_tr_b16 v[82:83], v10 offset:22528
v_mfma_f32_16x16x32_bf16 v[204:207], v[92:95], a[152:155], v[204:207]
v_exp_f32 v70, v70
v_mfma_f32_16x16x32_bf16 v[220:223], v[92:95], a[156:159], v[220:223]
ds_read_b64_tr_b16 v[84:85], v11 offset:6144
ds_read_b64_tr_b16 v[86:87], v11 offset:22528
v_mfma_f32_16x16x32_bf16 v[192:195], v[96:99], a[160:163], v[192:195]
v_exp_f32 v71, v71
v_mfma_f32_16x16x32_bf16 v[208:211], v[96:99], a[164:167], v[208:211]
ds_read_b64_tr_b16 v[88:89], v12 offset:6144
ds_read_b64_tr_b16 v[90:91], v12 offset:22528
v_mfma_f32_16x16x32_bf16 v[196:199], v[100:103], a[160:163], v[196:199]
ds_read_b64_tr_b16 v[92:93], v13 offset:6144
s_add_u32 m0, s76, 98304
v_mfma_f32_16x16x32_bf16 v[212:215], v[100:103], a[164:167], v[212:215]
ds_read_b64_tr_b16 v[94:95], v13 offset:22528
s_add_u32 s77, s84, 0x0
v_mfma_f32_16x16x32_bf16 v[200:203], v[104:107], a[160:163], v[200:203]
buffer_load_dwordx4 v30, s[40:43], s77 offen offset:0 lds
v_mfma_f32_16x16x32_bf16 v[216:219], v[104:107], a[164:167], v[216:219]
ds_read_b64_tr_b16 v[96:97], v10 offset:7168
ds_read_b64_tr_b16 v[98:99], v10 offset:23552
v_mfma_f32_16x16x32_bf16 v[204:207], v[108:111], a[160:163], v[204:207]
ds_read_b64_tr_b16 v[100:101], v11 offset:7168
v_fma_f32 v68, v68, v63, v63
v_mfma_f32_16x16x32_bf16 v[220:223], v[108:111], a[164:167], v[220:223]
ds_read_b64_tr_b16 v[102:103], v11 offset:23552
v_fma_f32 v69, v69, v63, v63
v_mfma_f32_16x16x32_bf16 v[192:195], v[112:115], a[168:171], v[192:195]
buffer_load_dwordx4 v31, s[40:43], s77 offen offset:1024 lds
v_mfma_f32_16x16x32_bf16 v[208:211], v[112:115], a[172:175], v[208:211]
ds_read_b64_tr_b16 v[104:105], v12 offset:7168
s_waitcnt lgkmcnt(5)
v_mfma_f32_16x16x32_bf16 v[196:199], v[116:119], a[168:171], v[196:199]
ds_read_b64_tr_b16 v[106:107], v12 offset:23552
ds_read_b64_tr_b16 v[108:109], v13 offset:7168
v_mfma_f32_16x16x32_bf16 v[212:215], v[116:119], a[172:175], v[212:215]
ds_read_b64_tr_b16 v[110:111], v13 offset:23552
v_fma_f32 v70, v70, v63, v63
v_mfma_f32_16x16x32_bf16 v[200:203], v[120:123], a[168:171], v[200:203]
buffer_load_dwordx4 v32, s[40:43], s77 offen offset:2048 lds
v_mfma_f32_16x16x32_bf16 v[216:219], v[120:123], a[172:175], v[216:219]
v_fma_f32 v71, v71, v63, v63
v_mfma_f32_16x16x32_bf16 v[204:207], v[124:127], a[168:171], v[204:207]
v_rcp_f32 v68, v68
v_mfma_f32_16x16x32_bf16 v[220:223], v[124:127], a[172:175], v[220:223]
v_rcp_f32 v69, v69
v_mfma_f32_16x16x32_bf16 v[192:195], v[80:83], a[176:179], v[192:195]
s_waitcnt vmcnt(13) lgkmcnt(0)
s_barrier
v_mfma_f32_16x16x32_bf16 v[208:211], v[80:83], a[180:183], v[208:211]
ds_read_b64_tr_b16 v[112:113], v10 offset:32768
ds_read_b64_tr_b16 v[114:115], v10 offset:49152
v_mfma_f32_16x16x32_bf16 v[196:199], v[84:87], a[176:179], v[196:199]
ds_read_b64_tr_b16 v[116:117], v11 offset:32768
v_mfma_f32_16x16x32_bf16 v[212:215], v[84:87], a[180:183], v[212:215]
ds_read_b64_tr_b16 v[118:119], v11 offset:49152
ds_read_b64_tr_b16 v[120:121], v12 offset:32768
v_mfma_f32_16x16x32_bf16 v[200:203], v[88:91], a[176:179], v[200:203]
buffer_load_dwordx4 v33, s[40:43], s77 offen offset:3072 lds
v_mfma_f32_16x16x32_bf16 v[216:219], v[88:91], a[180:183], v[216:219]
ds_read_b64_tr_b16 v[122:123], v12 offset:49152
ds_read_b64_tr_b16 v[124:125], v13 offset:32768
v_mfma_f32_16x16x32_bf16 v[204:207], v[92:95], a[176:179], v[204:207]
v_rcp_f32 v70, v70
v_mfma_f32_16x16x32_bf16 v[220:223], v[92:95], a[180:183], v[220:223]
ds_read_b64_tr_b16 v[126:127], v13 offset:49152
ds_read_b64_tr_b16 v[80:81], v10 offset:33792
v_mfma_f32_16x16x32_bf16 v[192:195], v[96:99], a[184:187], v[192:195]
v_rcp_f32 v71, v71
v_mfma_f32_16x16x32_bf16 v[208:211], v[96:99], a[188:191], v[208:211]
ds_read_b64_tr_b16 v[82:83], v10 offset:50176
ds_read_b64_tr_b16 v[84:85], v11 offset:33792
v_mfma_f32_16x16x32_bf16 v[196:199], v[100:103], a[184:187], v[196:199]
ds_read_b64_tr_b16 v[86:87], v11 offset:50176
s_add_u32 m0, s76, 102400
v_mfma_f32_16x16x32_bf16 v[212:215], v[100:103], a[188:191], v[212:215]
ds_read_b64_tr_b16 v[88:89], v12 offset:33792
s_add_u32 s77, s84, 0xe0000
v_mfma_f32_16x16x32_bf16 v[200:203], v[104:107], a[184:187], v[200:203]
buffer_load_dwordx4 v30, s[40:43], s77 offen offset:0 lds
v_mfma_f32_16x16x32_bf16 v[216:219], v[104:107], a[188:191], v[216:219]
ds_read_b64_tr_b16 v[90:91], v12 offset:50176
ds_read_b64_tr_b16 v[92:93], v13 offset:33792
v_mfma_f32_16x16x32_bf16 v[204:207], v[108:111], a[184:187], v[204:207]
ds_read_b64_tr_b16 v[94:95], v13 offset:50176
v_mul_f32 v144, v144, v68
v_mfma_f32_16x16x32_bf16 v[220:223], v[108:111], a[188:191], v[220:223]
ds_read_b64_tr_b16 v[96:97], v10 offset:34816
s_waitcnt lgkmcnt(6)
v_mfma_f32_16x16x32_bf16 v[192:195], v[112:115], a[192:195], v[192:195]
buffer_load_dwordx4 v31, s[40:43], s77 offen offset:1024 lds
v_mfma_f32_16x16x32_bf16 v[208:211], v[112:115], a[196:199], v[208:211]
ds_read_b64_tr_b16 v[98:99], v10 offset:51200
ds_read_b64_tr_b16 v[100:101], v11 offset:34816
v_mfma_f32_16x16x32_bf16 v[196:199], v[116:119], a[192:195], v[196:199]
ds_read_b64_tr_b16 v[102:103], v11 offset:51200
v_mul_f32 v145, v145, v69
v_mfma_f32_16x16x32_bf16 v[212:215], v[116:119], a[196:199], v[212:215]
ds_read_b64_tr_b16 v[104:105], v12 offset:34816
ds_read_b64_tr_b16 v[106:107], v12 offset:51200
v_mfma_f32_16x16x32_bf16 v[200:203], v[120:123], a[192:195], v[200:203]
buffer_load_dwordx4 v32, s[40:43], s77 offen offset:2048 lds
v_mfma_f32_16x16x32_bf16 v[216:219], v[120:123], a[196:199], v[216:219]
ds_read_b64_tr_b16 v[108:109], v13 offset:34816
ds_read_b64_tr_b16 v[110:111], v13 offset:51200
v_mfma_f32_16x16x32_bf16 v[204:207], v[124:127], a[192:195], v[204:207]
ds_read_b64_tr_b16 v[112:113], v10 offset:35840
v_mul_f32 v146, v146, v70
v_mfma_f32_16x16x32_bf16 v[220:223], v[124:127], a[196:199], v[220:223]
ds_read_b64_tr_b16 v[114:115], v10 offset:52224
ds_read_b64_tr_b16 v[116:117], v11 offset:35840
v_mfma_f32_16x16x32_bf16 v[192:195], v[80:83], a[200:203], v[192:195]
buffer_load_dwordx4 v33, s[40:43], s77 offen offset:3072 lds
v_mfma_f32_16x16x32_bf16 v[208:211], v[80:83], a[204:207], v[208:211]
ds_read_b64_tr_b16 v[118:119], v11 offset:52224
s_waitcnt lgkmcnt(6)
v_mfma_f32_16x16x32_bf16 v[196:199], v[84:87], a[200:203], v[196:199]
ds_read_b64_tr_b16 v[120:121], v12 offset:35840
s_add_u32 m0, s76, 0
v_mfma_f32_16x16x32_bf16 v[212:215], v[84:87], a[204:207], v[212:215]
ds_read_b64_tr_b16 v[122:123], v12 offset:52224
s_add_u32 s77, s84, 0x1c0000
v_mfma_f32_16x16x32_bf16 v[200:203], v[88:91], a[200:203], v[200:203]
buffer_load_dwordx4 v30, s[40:43], s77 offen offset:0 lds
v_mfma_f32_16x16x32_bf16 v[216:219], v[88:91], a[204:207], v[216:219]
ds_read_b64_tr_b16 v[124:125], v13 offset:35840
ds_read_b64_tr_b16 v[126:127], v13 offset:52224
v_mfma_f32_16x16x32_bf16 v[204:207], v[92:95], a[200:203], v[204:207]
ds_read_b64_tr_b16 v[80:81], v10 offset:36864
v_mul_f32 v147, v147, v71
v_mfma_f32_16x16x32_bf16 v[220:223], v[92:95], a[204:207], v[220:223]
ds_read_b64_tr_b16 v[82:83], v10 offset:53248
ds_read_b64_tr_b16 v[84:85], v11 offset:36864
v_mfma_f32_16x16x32_bf16 v[192:195], v[96:99], a[208:211], v[192:195]
buffer_load_dwordx4 v31, s[40:43], s77 offen offset:1024 lds
v_mfma_f32_16x16x32_bf16 v[208:211], v[96:99], a[212:215], v[208:211]
ds_read_b64_tr_b16 v[86:87], v11 offset:53248
ds_read_b64_tr_b16 v[88:89], v12 offset:36864
v_mfma_f32_16x16x32_bf16 v[196:199], v[100:103], a[208:211], v[196:199]
ds_read_b64_tr_b16 v[90:91], v12 offset:53248
v_mul_f32 v72, v61, v148
v_mfma_f32_16x16x32_bf16 v[212:215], v[100:103], a[212:215], v[212:215]
ds_read_b64_tr_b16 v[92:93], v13 offset:36864
ds_read_b64_tr_b16 v[94:95], v13 offset:53248
v_mfma_f32_16x16x32_bf16 v[200:203], v[104:107], a[208:211], v[200:203]
buffer_load_dwordx4 v32, s[40:43], s77 offen offset:2048 lds
v_mfma_f32_16x16x32_bf16 v[216:219], v[104:107], a[212:215], v[216:219]
ds_read_b64_tr_b16 v[96:97], v10 offset:37888
s_waitcnt lgkmcnt(6)
v_mfma_f32_16x16x32_bf16 v[204:207], v[108:111], a[208:211], v[204:207]
ds_read_b64_tr_b16 v[98:99], v10 offset:54272
ds_read_b64_tr_b16 v[100:101], v11 offset:37888
v_mfma_f32_16x16x32_bf16 v[220:223], v[108:111], a[212:215], v[220:223]
ds_read_b64_tr_b16 v[102:103], v11 offset:54272
v_mul_f32 v73, v61, v149
v_mfma_f32_16x16x32_bf16 v[192:195], v[112:115], a[216:219], v[192:195]
buffer_load_dwordx4 v33, s[40:43], s77 offen offset:3072 lds
v_mfma_f32_16x16x32_bf16 v[208:211], v[112:115], a[220:223], v[208:211]
ds_read_b64_tr_b16 v[104:105], v12 offset:37888
ds_read_b64_tr_b16 v[106:107], v12 offset:54272
v_mfma_f32_16x16x32_bf16 v[196:199], v[116:119], a[216:219], v[196:199]
ds_read_b64_tr_b16 v[108:109], v13 offset:37888
s_add_u32 m0, s76, 4096
v_mfma_f32_16x16x32_bf16 v[212:215], v[116:119], a[220:223], v[212:215]
ds_read_b64_tr_b16 v[110:111], v13 offset:54272
s_add_u32 s77, s84, 0x2a0000
v_mfma_f32_16x16x32_bf16 v[200:203], v[120:123], a[216:219], v[200:203]
buffer_load_dwordx4 v30, s[40:43], s77 offen offset:0 lds
v_mfma_f32_16x16x32_bf16 v[216:219], v[120:123], a[220:223], v[216:219]
ds_read_b64_tr_b16 v[112:113], v10 offset:38912
ds_read_b64_tr_b16 v[114:115], v10 offset:55296
v_mfma_f32_16x16x32_bf16 v[204:207], v[124:127], a[216:219], v[204:207]
ds_read_b64_tr_b16 v[116:117], v11 offset:38912
v_mul_f32 v74, v61, v150
v_mfma_f32_16x16x32_bf16 v[220:223], v[124:127], a[220:223], v[220:223]
ds_read_b64_tr_b16 v[118:119], v11 offset:55296
v_mul_f32 v75, v61, v151
v_mfma_f32_16x16x32_bf16 v[192:195], v[80:83], a[224:227], v[192:195]
buffer_load_dwordx4 v31, s[40:43], s77 offen offset:1024 lds
v_mfma_f32_16x16x32_bf16 v[208:211], v[80:83], a[228:231], v[208:211]
ds_read_b64_tr_b16 v[120:121], v12 offset:38912
s_waitcnt lgkmcnt(5)
v_mfma_f32_16x16x32_bf16 v[196:199], v[84:87], a[224:227], v[196:199]
v_exp_f32 v72, v72
v_mfma_f32_16x16x32_bf16 v[212:215], v[84:87], a[228:231], v[212:215]
ds_read_b64_tr_b16 v[122:123], v12 offset:55296
ds_read_b64_tr_b16 v[124:125], v13 offset:38912
v_mfma_f32_16x16x32_bf16 v[200:203], v[88:91], a[224:227], v[200:203]
buffer_load_dwordx4 v32, s[40:43], s77 offen offset:2048 lds
v_mfma_f32_16x16x32_bf16 v[216:219], v[88:91], a[228:231], v[216:219]
ds_read_b64_tr_b16 v[126:127], v13 offset:55296
ds_read_b64_tr_b16 v[80:81], v10 offset:39936
v_mfma_f32_16x16x32_bf16 v[204:207], v[92:95], a[224:227], v[204:207]
v_exp_f32 v73, v73
v_mfma_f32_16x16x32_bf16 v[220:223], v[92:95], a[228:231], v[220:223]
ds_read_b64_tr_b16 v[82:83], v10 offset:56320
ds_read_b64_tr_b16 v[84:85], v11 offset:39936
v_mfma_f32_16x16x32_bf16 v[192:195], v[96:99], a[232:235], v[192:195]
buffer_load_dwordx4 v33, s[40:43], s77 offen offset:3072 lds
v_mfma_f32_16x16x32_bf16 v[208:211], v[96:99], a[236:239], v[208:211]
ds_read_b64_tr_b16 v[86:87], v11 offset:56320
ds_read_b64_tr_b16 v[88:89], v12 offset:39936
v_mfma_f32_16x16x32_bf16 v[196:199], v[100:103], a[232:235], v[196:199]
v_exp_f32 v74, v74
v_mfma_f32_16x16x32_bf16 v[212:215], v[100:103], a[236:239], v[212:215]
ds_read_b64_tr_b16 v[90:91], v12 offset:56320
ds_read_b64_tr_b16 v[92:93], v13 offset:39936
v_mfma_f32_16x16x32_bf16 v[200:203], v[104:107], a[232:235], v[200:203]
v_exp_f32 v75, v75
v_mfma_f32_16x16x32_bf16 v[216:219], v[104:107], a[236:239], v[216:219]
ds_read_b64_tr_b16 v[94:95], v13 offset:56320
v_fma_f32 v72, v72, v63, v63
v_mfma_f32_16x16x32_bf16 v[204:207], v[108:111], a[232:235], v[204:207]
v_fma_f32 v73, v73, v63, v63
v_fma_f32 v74, v74, v63, v63
v_mfma_f32_16x16x32_bf16 v[220:223], v[108:111], a[236:239], v[220:223]
v_fma_f32 v75, v75, v63, v63
s_waitcnt lgkmcnt(3)
v_mfma_f32_16x16x32_bf16 v[192:195], v[112:115], a[240:243], v[192:195]
v_rcp_f32 v72, v72
v_mfma_f32_16x16x32_bf16 v[208:211], v[112:115], a[244:247], v[208:211]
v_rcp_f32 v73, v73
v_mfma_f32_16x16x32_bf16 v[196:199], v[116:119], a[240:243], v[196:199]
s_waitcnt vmcnt(16) lgkmcnt(0)
s_barrier
v_mfma_f32_16x16x32_bf16 v[212:215], v[116:119], a[244:247], v[212:215]
ds_read_b64_tr_b16 v[96:97], v20 offset:0
ds_read_b64_tr_b16 v[98:99], v20 offset:8192
v_mfma_f32_16x16x32_bf16 v[200:203], v[120:123], a[240:243], v[200:203]
ds_read_b64_tr_b16 v[100:101], v21 offset:0
ds_read_b64_tr_b16 v[102:103], v21 offset:8192
v_mfma_f32_16x16x32_bf16 v[216:219], v[120:123], a[244:247], v[216:219]
ds_read_b64_tr_b16 v[104:105], v20 offset:16384
ds_read_b64_tr_b16 v[106:107], v20 offset:24576
v_mfma_f32_16x16x32_bf16 v[204:207], v[124:127], a[240:243], v[204:207]
ds_read_b64_tr_b16 v[108:109], v21 offset:16384
s_add_u32 m0, s76, 32768
v_mfma_f32_16x16x32_bf16 v[220:223], v[124:127], a[244:247], v[220:223]
ds_read_b64_tr_b16 v[110:111], v21 offset:24576
s_add_u32 s77, s84, 0x380000
v_mfma_f32_16x16x32_bf16 v[192:195], v[80:83], a[248:251], v[192:195]
ds_read_b64_tr_b16 v[112:113], v20 offset:1024
ds_read_b64_tr_b16 v[114:115], v20 offset:9216
v_mfma_f32_16x16x32_bf16 v[208:211], v[80:83], a[252:255], v[208:211]
buffer_load_dwordx4 v30, s[40:43], s77 offen offset:0 lds
v_mfma_f32_16x16x32_bf16 v[196:199], v[84:87], a[248:251], v[196:199]
ds_read_b64_tr_b16 v[116:117], v21 offset:1024
ds_read_b64_tr_b16 v[118:119], v21 offset:9216
v_mfma_f32_16x16x32_bf16 v[212:215], v[84:87], a[252:255], v[212:215]
v_rcp_f32 v74, v74
v_mfma_f32_16x16x32_bf16 v[200:203], v[88:91], a[248:251], v[200:203]
ds_read_b64_tr_b16 v[120:121], v20 offset:17408
ds_read_b64_tr_b16 v[122:123], v20 offset:25600
v_mfma_f32_16x16x32_bf16 v[216:219], v[88:91], a[252:255], v[216:219]
v_rcp_f32 v75, v75
v_mfma_f32_16x16x32_bf16 v[204:207], v[92:95], a[248:251], v[204:207]
ds_read_b64_tr_b16 v[124:125], v21 offset:17408
ds_read_b64_tr_b16 v[126:127], v21 offset:25600
v_mfma_f32_16x16x32_bf16 v[220:223], v[92:95], a[252:255], v[220:223]
buffer_load_dwordx4 v31, s[40:43], s77 offen offset:1024 lds
S_H1:
s_waitcnt lgkmcnt(6)
v_mfma_f32_16x16x32_bf16 v[224:227], v[96:99], a[64:67], v[224:227]
ds_read_b64_tr_b16 v[80:81], v20 offset:2048
ds_read_b64_tr_b16 v[82:83], v20 offset:10240
v_mfma_f32_16x16x32_bf16 v[240:243], v[96:99], a[68:71], v[240:243]
ds_read_b64_tr_b16 v[84:85], v21 offset:2048
v_mul_f32 v148, v148, v72
v_mfma_f32_16x16x32_bf16 v[228:231], v[100:103], a[64:67], v[228:231]
ds_read_b64_tr_b16 v[86:87], v21 offset:10240
ds_read_b64_tr_b16 v[88:89], v20 offset:18432
v_mfma_f32_16x16x32_bf16 v[244:247], v[100:103], a[68:71], v[244:247]
s_add_u32 s70, s0, S_H2 - K_pc + 0
s_addc_u32 s71, s1, 0
global_load_dword v57, v9, s[70:71]
v_mfma_f32_16x16x32_bf16 v[232:235], v[104:107], a[64:67], v[232:235]
ds_read_b64_tr_b16 v[90:91], v20 offset:26624
ds_read_b64_tr_b16 v[92:93], v21 offset:18432
v_mfma_f32_16x16x32_bf16 v[248:251], v[104:107], a[68:71], v[248:251]
buffer_load_dwordx4 v32, s[40:43], s77 offen offset:2048 lds
v_mfma_f32_16x16x32_bf16 v[236:239], v[108:111], a[64:67], v[236:239]
ds_read_b64_tr_b16 v[94:95], v21 offset:26624
ds_read_b64_tr_b16 v[96:97], v20 offset:3072
v_mfma_f32_16x16x32_bf16 v[252:255], v[108:111], a[68:71], v[252:255]
ds_read_b64_tr_b16 v[98:99], v20 offset:11264
s_mul_i32 s3, s101, 7168
v_mfma_f32_16x16x32_bf16 v[224:227], v[112:115], a[72:75], v[224:227]
ds_read_b64_tr_b16 v[100:101], v21 offset:3072
ds_read_b64_tr_b16 v[102:103], v21 offset:11264
v_mfma_f32_16x16x32_bf16 v[240:243], v[112:115], a[76:79], v[240:243]
ds_read_b64_tr_b16 v[104:105], v20 offset:19456
s_waitcnt lgkmcnt(8)
v_mfma_f32_16x16x32_bf16 v[228:231], v[116:119], a[72:75], v[228:231]
ds_read_b64_tr_b16 v[106:107], v20 offset:27648
ds_read_b64_tr_b16 v[108:109], v21 offset:19456
v_mfma_f32_16x16x32_bf16 v[244:247], v[116:119], a[76:79], v[244:247]
buffer_load_dwordx4 v33, s[40:43], s77 offen offset:3072 lds
v_mfma_f32_16x16x32_bf16 v[232:235], v[120:123], a[72:75], v[232:235]
ds_read_b64_tr_b16 v[110:111], v21 offset:27648
ds_read_b64_tr_b16 v[112:113], v20 offset:4096
v_mfma_f32_16x16x32_bf16 v[248:251], v[120:123], a[76:79], v[248:251]
ds_read_b64_tr_b16 v[114:115], v20 offset:12288
s_add_u32 s3, s3, 0x1000
v_mfma_f32_16x16x32_bf16 v[236:239], v[124:127], a[72:75], v[236:239]
ds_read_b64_tr_b16 v[116:117], v21 offset:4096
s_add_u32 m0, s76, 36864
v_mfma_f32_16x16x32_bf16 v[252:255], v[124:127], a[76:79], v[252:255]
ds_read_b64_tr_b16 v[118:119], v21 offset:12288
s_add_u32 s77, s84, 0x460000
v_mfma_f32_16x16x32_bf16 v[224:227], v[80:83], a[80:83], v[224:227]
ds_read_b64_tr_b16 v[120:121], v20 offset:20480
v_mul_f32 v149, v149, v73
v_mfma_f32_16x16x32_bf16 v[240:243], v[80:83], a[84:87], v[240:243]
buffer_load_dwordx4 v30, s[40:43], s77 offen offset:0 lds
v_mfma_f32_16x16x32_bf16 v[228:231], v[84:87], a[80:83], v[228:231]
ds_read_b64_tr_b16 v[122:123], v20 offset:28672
ds_read_b64_tr_b16 v[124:125], v21 offset:20480
v_mfma_f32_16x16x32_bf16 v[244:247], v[84:87], a[84:87], v[244:247]
ds_read_b64_tr_b16 v[126:127], v21 offset:28672
s_waitcnt lgkmcnt(6)
v_mfma_f32_16x16x32_bf16 v[232:235], v[88:91], a[80:83], v[232:235]
ds_read_b64_tr_b16 v[80:81], v20 offset:5120
v_mul_f32 v150, v150, v74
v_mfma_f32_16x16x32_bf16 v[248:251], v[88:91], a[84:87], v[248:251]
ds_read_b64_tr_b16 v[82:83], v20 offset:13312
v_mul_f32 v151, v151, v75
v_mfma_f32_16x16x32_bf16 v[236:239], v[92:95], a[80:83], v[236:239]
ds_read_b64_tr_b16 v[84:85], v21 offset:5120
v_mul_f32 v68, v61, v152
v_mfma_f32_16x16x32_bf16 v[252:255], v[92:95], a[84:87], v[252:255]
buffer_load_dwordx4 v31, s[40:43], s77 offen offset:1024 lds
v_mfma_f32_16x16x32_bf16 v[224:227], v[96:99], a[88:91], v[224:227]
ds_read_b64_tr_b16 v[86:87], v21 offset:13312
ds_read_b64_tr_b16 v[88:89], v20 offset:21504
v_mfma_f32_16x16x32_bf16 v[240:243], v[96:99], a[92:95], v[240:243]
ds_read_b64_tr_b16 v[90:91], v20 offset:29696
v_mul_f32 v69, v61, v153
v_mfma_f32_16x16x32_bf16 v[228:231], v[100:103], a[88:91], v[228:231]
ds_read_b64_tr_b16 v[92:93], v21 offset:21504
v_mul_f32 v70, v61, v154
v_mfma_f32_16x16x32_bf16 v[244:247], v[100:103], a[92:95], v[244:247]
ds_read_b64_tr_b16 v[94:95], v21 offset:29696
v_mul_f32 v71, v61, v155
v_mfma_f32_16x16x32_bf16 v[232:235], v[104:107], a[88:91], v[232:235]
v_exp_f32 v68, v68
v_mfma_f32_16x16x32_bf16 v[248:251], v[104:107], a[92:95], v[248:251]
ds_read_b64_tr_b16 v[96:97], v20 offset:6144
ds_read_b64_tr_b16 v[98:99], v20 offset:14336
v_mfma_f32_16x16x32_bf16 v[236:239], v[108:111], a[88:91], v[236:239]
buffer_load_dwordx4 v32, s[40:43], s77 offen offset:2048 lds
v_mfma_f32_16x16x32_bf16 v[252:255], v[108:111], a[92:95], v[252:255]
ds_read_b64_tr_b16 v[100:101], v21 offset:6144
ds_read_b64_tr_b16 v[102:103], v21 offset:14336
v_mfma_f32_16x16x32_bf16 v[224:227], v[112:115], a[96:99], v[224:227]
v_exp_f32 v69, v69
v_mfma_f32_16x16x32_bf16 v[240:243], v[112:115], a[100:103], v[240:243]
ds_read_b64_tr_b16 v[104:105], v20 offset:22528
s_waitcnt lgkmcnt(5)
v_mfma_f32_16x16x32_bf16 v[228:231], v[116:119], a[96:99], v[228:231]
v_exp_f32 v70, v70
v_mfma_f32_16x16x32_bf16 v[244:247], v[116:119], a[100:103], v[244:247]
ds_read_b64_tr_b16 v[106:107], v20 offset:30720
ds_read_b64_tr_b16 v[108:109], v21 offset:22528
v_mfma_f32_16x16x32_bf16 v[232:235], v[120:123], a[96:99], v[232:235]
buffer_load_dwordx4 v33, s[40:43], s77 offen offset:3072 lds
v_mfma_f32_16x16x32_bf16 v[248:251], v[120:123], a[100:103], v[248:251]
ds_read_b64_tr_b16 v[110:111], v21 offset:30720
ds_read_b64_tr_b16 v[112:113], v20 offset:7168
v_mfma_f32_16x16x32_bf16 v[236:239], v[124:127], a[96:99], v[236:239]
buffer_load_dword v57, v8, s[40:43], s3 offen
v_mfma_f32_16x16x32_bf16 v[252:255], v[124:127], a[100:103], v[252:255]
ds_read_b64_tr_b16 v[114:115], v20 offset:15360
ds_read_b64_tr_b16 v[116:117], v21 offset:7168
v_mfma_f32_16x16x32_bf16 v[224:227], v[80:83], a[104:107], v[224:227]
ds_read_b64_tr_b16 v[118:119], v21 offset:15360
s_mul_i32 s3, s101, 1024
v_mfma_f32_16x16x32_bf16 v[240:243], v[80:83], a[108:111], v[240:243]
ds_read_b64_tr_b16 v[120:121], v20 offset:23552
ds_read_b64_tr_b16 v[122:123], v20 offset:31744
v_mfma_f32_16x16x32_bf16 v[228:231], v[84:87], a[104:107], v[228:231]
ds_read_b64_tr_b16 v[124:125], v21 offset:23552
s_add_u32 s3, s3, 0x500000
v_mfma_f32_16x16x32_bf16 v[244:247], v[84:87], a[108:111], v[244:247]
buffer_load_dword v57, v50, s[48:51], s3 offen
v_mfma_f32_16x16x32_bf16 v[232:235], v[88:91], a[104:107], v[232:235]
ds_read_b64_tr_b16 v[126:127], v21 offset:31744
v_mfma_f32_16x16x32_bf16 v[248:251], v[88:91], a[108:111], v[248:251]
v_exp_f32 v71, v71
v_mfma_f32_16x16x32_bf16 v[236:239], v[92:95], a[104:107], v[236:239]
v_fma_f32 v68, v68, v63, v63
v_fma_f32 v69, v69, v63, v63
v_mfma_f32_16x16x32_bf16 v[252:255], v[92:95], a[108:111], v[252:255]
v_fma_f32 v70, v70, v63, v63
s_waitcnt lgkmcnt(2)
v_mfma_f32_16x16x32_bf16 v[224:227], v[96:99], a[112:115], v[224:227]
v_fma_f32 v71, v71, v63, v63
v_mfma_f32_16x16x32_bf16 v[240:243], v[96:99], a[116:119], v[240:243]
s_waitcnt vmcnt(19) lgkmcnt(0)
s_barrier
v_mfma_f32_16x16x32_bf16 v[228:231], v[100:103], a[112:115], v[228:231]
ds_read_b64_tr_b16 v[80:81], v14 offset:32768
ds_read_b64_tr_b16 v[82:83], v14 offset:49152
v_mfma_f32_16x16x32_bf16 v[244:247], v[100:103], a[116:119], v[244:247]
ds_read_b64_tr_b16 v[84:85], v15 offset:32768
ds_read_b64_tr_b16 v[86:87], v15 offset:49152
v_mfma_f32_16x16x32_bf16 v[232:235], v[104:107], a[112:115], v[232:235]
ds_read_b64_tr_b16 v[88:89], v16 offset:32768
s_add_u32 m0, s76, 65536
v_mfma_f32_16x16x32_bf16 v[248:251], v[104:107], a[116:119], v[248:251]
ds_read_b64_tr_b16 v[90:91], v16 offset:49152
s_add_u32 s77, s84, 0x540000
v_mfma_f32_16x16x32_bf16 v[236:239], v[108:111], a[112:115], v[236:239]
ds_read_b64_tr_b16 v[92:93], v17 offset:32768
ds_read_b64_tr_b16 v[94:95], v17 offset:49152
v_mfma_f32_16x16x32_bf16 v[252:255], v[108:111], a[116:119], v[252:255]
buffer_load_dwordx4 v30, s[40:43], s77 offen offset:0 lds
v_mfma_f32_16x16x32_bf16 v[224:227], v[112:115], a[120:123], v[224:227]
ds_read_b64_tr_b16 v[96:97], v14 offset:33792
ds_read_b64_tr_b16 v[98:99], v14 offset:50176
v_mfma_f32_16x16x32_bf16 v[240:243], v[112:115], a[124:127], v[240:243]
v_rcp_f32 v68, v68
v_mfma_f32_16x16x32_bf16 v[228:231], v[116:119], a[120:123], v[228:231]
ds_read_b64_tr_b16 v[100:101], v15 offset:33792
ds_read_b64_tr_b16 v[102:103], v15 offset:50176
v_mfma_f32_16x16x32_bf16 v[244:247], v[116:119], a[124:127], v[244:247]
v_rcp_f32 v69, v69
v_mfma_f32_16x16x32_bf16 v[232:235], v[120:123], a[120:123], v[232:235]
ds_read_b64_tr_b16 v[104:105], v16 offset:33792
ds_read_b64_tr_b16 v[106:107], v16 offset:50176
v_mfma_f32_16x16x32_bf16 v[248:251], v[120:123], a[124:127], v[248:251]
buffer_load_dwordx4 v31, s[40:43], s77 offen offset:1024 lds
v_mfma_f32_16x16x32_bf16 v[236:239], v[124:127], a[120:123], v[236:239]
ds_read_b64_tr_b16 v[108:109], v17 offset:33792
ds_read_b64_tr_b16 v[110:111], v17 offset:50176
v_mfma_f32_16x16x32_bf16 v[252:255], v[124:127], a[124:127], v[252:255]
ds_read_b64_tr_b16 v[112:113], v14 offset:34816
s_waitcnt lgkmcnt(7)
v_mfma_f32_16x16x32_bf16 v[160:163], v[80:83], a[0:3], 0
v_rcp_f32 v70, v70
v_mfma_f32_16x16x32_bf16 v[176:179], v[80:83], a[4:7], 0
ds_read_b64_tr_b16 v[114:115], v14 offset:51200
ds_read_b64_tr_b16 v[116:117], v15 offset:34816
v_mfma_f32_16x16x32_bf16 v[164:167], v[84:87], a[0:3], 0
v_rcp_f32 v71, v71
v_mfma_f32_16x16x32_bf16 v[180:183], v[84:87], a[4:7], 0
ds_read_b64_tr_b16 v[118:119], v15 offset:51200
ds_read_b64_tr_b16 v[120:121], v16 offset:34816
v_mfma_f32_16x16x32_bf16 v[168:171], v[88:91], a[0:3], 0
buffer_load_dwordx4 v32, s[40:43], s77 offen offset:2048 lds
v_mfma_f32_16x16x32_bf16 v[184:187], v[88:91], a[4:7], 0
ds_read_b64_tr_b16 v[122:123], v16 offset:51200
ds_read_b64_tr_b16 v[124:125], v17 offset:34816
v_mfma_f32_16x16x32_bf16 v[172:175], v[92:95], a[0:3], 0
ds_read_b64_tr_b16 v[126:127], v17 offset:51200
v_mul_f32 v152, v152, v68
v_mfma_f32_16x16x32_bf16 v[188:191], v[92:95], a[4:7], 0
ds_read_b64_tr_b16 v[80:81], v14 offset:35840
ds_read_b64_tr_b16 v[82:83], v14 offset:52224
v_mfma_f32_16x16x32_bf16 v[160:163], v[96:99], a[8:11], v[160:163]
ds_read_b64_tr_b16 v[84:85], v15 offset:35840
v_mul_f32 v153, v153, v69
v_mfma_f32_16x16x32_bf16 v[176:179], v[96:99], a[12:15], v[176:179]
ds_read_b64_tr_b16 v[86:87], v15 offset:52224
s_waitcnt lgkmcnt(7)
v_mfma_f32_16x16x32_bf16 v[164:167], v[100:103], a[8:11], v[164:167]
buffer_load_dwordx4 v33, s[40:43], s77 offen offset:3072 lds
v_mfma_f32_16x16x32_bf16 v[180:183], v[100:103], a[12:15], v[180:183]
ds_read_b64_tr_b16 v[88:89], v16 offset:35840
ds_read_b64_tr_b16 v[90:91], v16 offset:52224
v_mfma_f32_16x16x32_bf16 v[168:171], v[104:107], a[8:11], v[168:171]
ds_read_b64_tr_b16 v[92:93], v17 offset:35840
v_mul_f32 v154, v154, v70
v_mfma_f32_16x16x32_bf16 v[184:187], v[104:107], a[12:15], v[184:187]
ds_read_b64_tr_b16 v[94:95], v17 offset:52224
s_add_u32 m0, s76, 69632
v_mfma_f32_16x16x32_bf16 v[172:175], v[108:111], a[8:11], v[172:175]
ds_read_b64_tr_b16 v[96:97], v14 offset:36864
s_add_u32 s77, s84, 0x620000
v_mfma_f32_16x16x32_bf16 v[188:191], v[108:111], a[12:15], v[188:191]
ds_read_b64_tr_b16 v[98:99], v14 offset:53248
ds_read_b64_tr_b16 v[100:101], v15 offset:36864
v_mfma_f32_16x16x32_bf16 v[160:163], v[112:115], a[16:19], v[160:163]
buffer_load_dwordx4 v30, s[40:43], s77 offen offset:0 lds
v_mfma_f32_16x16x32_bf16 v[176:179], v[112:115], a[20:23], v[176:179]
ds_read_b64_tr_b16 v[102:103], v15 offset:53248
ds_read_b64_tr_b16 v[104:105], v16 offset:36864
v_mfma_f32_16x16x32_bf16 v[164:167], v[116:119], a[16:19], v[164:167]
ds_read_b64_tr_b16 v[106:107], v16 offset:53248
v_mul_f32 v155, v155, v71
v_mfma_f32_16x16x32_bf16 v[180:183], v[116:119], a[20:23], v[180:183]
ds_read_b64_tr_b16 v[108:109], v17 offset:36864
s_waitcnt lgkmcnt(7)
v_mfma_f32_16x16x32_bf16 v[168:171], v[120:123], a[16:19], v[168:171]
ds_read_b64_tr_b16 v[110:111], v17 offset:53248
ds_read_b64_tr_b16 v[112:113], v14 offset:37888
v_mfma_f32_16x16x32_bf16 v[184:187], v[120:123], a[20:23], v[184:187]
ds_read_b64_tr_b16 v[114:115], v14 offset:54272
v_mul_f32 v72, v61, v156
v_mfma_f32_16x16x32_bf16 v[172:175], v[124:127], a[16:19], v[172:175]
buffer_load_dwordx4 v31, s[40:43], s77 offen offset:1024 lds
v_mfma_f32_16x16x32_bf16 v[188:191], v[124:127], a[20:23], v[188:191]
ds_read_b64_tr_b16 v[116:117], v15 offset:37888
ds_read_b64_tr_b16 v[118:119], v15 offset:54272
v_mfma_f32_16x16x32_bf16 v[160:163], v[80:83], a[24:27], v[160:163]
ds_read_b64_tr_b16 v[120:121], v16 offset:37888
v_mul_f32 v73, v61, v157
v_mfma_f32_16x16x32_bf16 v[176:179], v[80:83], a[28:31], v[176:179]
ds_read_b64_tr_b16 v[122:123], v16 offset:54272
v_mul_f32 v74, v61, v158
v_mfma_f32_16x16x32_bf16 v[164:167], v[84:87], a[24:27], v[164:167]
ds_read_b64_tr_b16 v[124:125], v17 offset:37888
v_mul_f32 v75, v61, v159
v_mfma_f32_16x16x32_bf16 v[180:183], v[84:87], a[28:31], v[180:183]
v_exp_f32 v72, v72
v_mfma_f32_16x16x32_bf16 v[168:171], v[88:91], a[24:27], v[168:171]
ds_read_b64_tr_b16 v[126:127], v17 offset:54272
ds_read_b64_tr_b16 v[80:81], v14 offset:38912
v_mfma_f32_16x16x32_bf16 v[184:187], v[88:91], a[28:31], v[184:187]
buffer_load_dwordx4 v32, s[40:43], s77 offen offset:2048 lds
v_mfma_f32_16x16x32_bf16 v[172:175], v[92:95], a[24:27], v[172:175]
ds_read_b64_tr_b16 v[82:83], v14 offset:55296
ds_read_b64_tr_b16 v[84:85], v15 offset:38912
v_mfma_f32_16x16x32_bf16 v[188:191], v[92:95], a[28:31], v[188:191]
ds_read_b64_tr_b16 v[86:87], v15 offset:55296
s_waitcnt lgkmcnt(6)
v_mfma_f32_16x16x32_bf16 v[160:163], v[96:99], a[32:35], v[160:163]
v_exp_f32 v73, v73
v_mfma_f32_16x16x32_bf16 v[176:179], v[96:99], a[36:39], v[176:179]
ds_read_b64_tr_b16 v[88:89], v16 offset:38912
ds_read_b64_tr_b16 v[90:91], v16 offset:55296
v_mfma_f32_16x16x32_bf16 v[164:167], v[100:103], a[32:35], v[164:167]
v_exp_f32 v74, v74
v_mfma_f32_16x16x32_bf16 v[180:183], v[100:103], a[36:39], v[180:183]
ds_read_b64_tr_b16 v[92:93], v17 offset:38912
ds_read_b64_tr_b16 v[94:95], v17 offset:55296
v_mfma_f32_16x16x32_bf16 v[168:171], v[104:107], a[32:35], v[168:171]
buffer_load_dwordx4 v33, s[40:43], s77 offen offset:3072 lds
v_mfma_f32_16x16x32_bf16 v[184:187], v[104:107], a[36:39], v[184:187]
ds_read_b64_tr_b16 v[96:97], v14 offset:39936
ds_read_b64_tr_b16 v[98:99], v14 offset:56320
v_mfma_f32_16x16x32_bf16 v[172:175], v[108:111], a[32:35], v[172:175]
v_exp_f32 v75, v75
v_mfma_f32_16x16x32_bf16 v[188:191], v[108:111], a[36:39], v[188:191]
ds_read_b64_tr_b16 v[100:101], v15 offset:39936
ds_read_b64_tr_b16 v[102:103], v15 offset:56320
v_mfma_f32_16x16x32_bf16 v[160:163], v[112:115], a[40:43], v[160:163]
ds_read_b64_tr_b16 v[104:105], v16 offset:39936
v_fma_f32 v72, v72, v63, v63
v_mfma_f32_16x16x32_bf16 v[176:179], v[112:115], a[44:47], v[176:179]
ds_read_b64_tr_b16 v[106:107], v16 offset:56320
v_fma_f32 v73, v73, v63, v63
v_mfma_f32_16x16x32_bf16 v[164:167], v[116:119], a[40:43], v[164:167]
ds_read_b64_tr_b16 v[108:109], v17 offset:39936
v_fma_f32 v74, v74, v63, v63
v_mfma_f32_16x16x32_bf16 v[180:183], v[116:119], a[44:47], v[180:183]
ds_read_b64_tr_b16 v[110:111], v17 offset:56320
v_fma_f32 v75, v75, v63, v63
v_mfma_f32_16x16x32_bf16 v[168:171], v[120:123], a[40:43], v[168:171]
v_rcp_f32 v72, v72
v_mfma_f32_16x16x32_bf16 v[184:187], v[120:123], a[44:47], v[184:187]
s_waitcnt lgkmcnt(4)
v_mfma_f32_16x16x32_bf16 v[172:175], v[124:127], a[40:43], v[172:175]
v_rcp_f32 v73, v73
v_mfma_f32_16x16x32_bf16 v[188:191], v[124:127], a[44:47], v[188:191]
v_rcp_f32 v74, v74
v_mfma_f32_16x16x32_bf16 v[160:163], v[80:83], a[48:51], v[160:163]
s_waitcnt vmcnt(19) lgkmcnt(0)
s_barrier
v_mfma_f32_16x16x32_bf16 v[176:179], v[80:83], a[52:55], v[176:179]
ds_read_b64_tr_b16 v[112:113], v10 offset:0
ds_read_b64_tr_b16 v[114:115], v10 offset:16384
v_mfma_f32_16x16x32_bf16 v[164:167], v[84:87], a[48:51], v[164:167]
ds_read_b64_tr_b16 v[116:117], v11 offset:0
v_mfma_f32_16x16x32_bf16 v[180:183], v[84:87], a[52:55], v[180:183]
ds_read_b64_tr_b16 v[118:119], v11 offset:16384
ds_read_b64_tr_b16 v[120:121], v12 offset:0
v_mfma_f32_16x16x32_bf16 v[168:171], v[88:91], a[48:51], v[168:171]
v_rcp_f32 v75, v75
v_mfma_f32_16x16x32_bf16 v[184:187], v[88:91], a[52:55], v[184:187]
ds_read_b64_tr_b16 v[122:123], v12 offset:16384
ds_read_b64_tr_b16 v[124:125], v13 offset:0
v_mfma_f32_16x16x32_bf16 v[172:175], v[92:95], a[48:51], v[172:175]
ds_read_b64_tr_b16 v[126:127], v13 offset:16384
v_mul_f32 v156, v156, v72
v_mfma_f32_16x16x32_bf16 v[188:191], v[92:95], a[52:55], v[188:191]
ds_read_b64_tr_b16 v[80:81], v10 offset:1024
ds_read_b64_tr_b16 v[82:83], v10 offset:17408
v_mfma_f32_16x16x32_bf16 v[160:163], v[96:99], a[56:59], v[160:163]
ds_read_b64_tr_b16 v[84:85], v11 offset:1024
v_mul_f32 v157, v157, v73
v_mfma_f32_16x16x32_bf16 v[176:179], v[96:99], a[60:63], v[176:179]
ds_read_b64_tr_b16 v[86:87], v11 offset:17408
ds_read_b64_tr_b16 v[88:89], v12 offset:1024
v_mfma_f32_16x16x32_bf16 v[164:167], v[100:103], a[56:59], v[164:167]
ds_read_b64_tr_b16 v[90:91], v12 offset:17408
v_mul_f32 v158, v158, v74
v_mfma_f32_16x16x32_bf16 v[180:183], v[100:103], a[60:63], v[180:183]
ds_read_b64_tr_b16 v[92:93], v13 offset:1024
ds_read_b64_tr_b16 v[94:95], v13 offset:17408
v_mfma_f32_16x16x32_bf16 v[168:171], v[104:107], a[56:59], v[168:171]
ds_read_b64_tr_b16 v[96:97], v10 offset:2048
v_mul_f32 v159, v159, v75
v_mfma_f32_16x16x32_bf16 v[184:187], v[104:107], a[60:63], v[184:187]
ds_read_b64_tr_b16 v[98:99], v10 offset:18432
ds_read_b64_tr_b16 v[100:101], v11 offset:2048
v_mfma_f32_16x16x32_bf16 v[172:175], v[108:111], a[56:59], v[172:175]
ds_read_b64_tr_b16 v[102:103], v11 offset:18432
v_mfma_f32_16x16x32_bf16 v[188:191], v[108:111], a[60:63], v[188:191]
ds_read_b64_tr_b16 v[104:105], v12 offset:2048
s_waitcnt lgkmcnt(8)
v_mfma_f32_16x16x32_bf16 v[160:163], v[112:115], a[64:67], v[160:163]
ds_read_b64_tr_b16 v[106:107], v12 offset:18432
s_lshl_b32 s7, s82, 5
v_mfma_f32_16x16x32_bf16 v[176:179], v[112:115], a[68:71], v[176:179]
ds_read_b64_tr_b16 v[108:109], v13 offset:2048
s_add_u32 s7, s7, s4
v_mfma_f32_16x16x32_bf16 v[164:167], v[116:119], a[64:67], v[164:167]
ds_read_b64_tr_b16 v[110:111], v13 offset:18432
v_mul_f32 v192, v192, v128
v_mfma_f32_16x16x32_bf16 v[180:183], v[116:119], a[68:71], v[180:183]
ds_read_b64_tr_b16 v[112:113], v10 offset:3072
v_mul_f32 v193, v193, v129
v_mfma_f32_16x16x32_bf16 v[168:171], v[120:123], a[64:67], v[168:171]
ds_read_b64_tr_b16 v[114:115], v10 offset:19456
v_mul_f32 v194, v194, v130
v_mfma_f32_16x16x32_bf16 v[184:187], v[120:123], a[68:71], v[184:187]
ds_read_b64_tr_b16 v[116:117], v11 offset:3072
v_mul_f32 v195, v195, v131
v_mfma_f32_16x16x32_bf16 v[172:175], v[124:127], a[64:67], v[172:175]
ds_read_b64_tr_b16 v[118:119], v11 offset:19456
v_mul_f32 v196, v196, v132
v_mfma_f32_16x16x32_bf16 v[188:191], v[124:127], a[68:71], v[188:191]
ds_read_b64_tr_b16 v[120:121], v12 offset:3072
v_mul_f32 v197, v197, v133
v_mfma_f32_16x16x32_bf16 v[160:163], v[80:83], a[72:75], v[160:163]
ds_read_b64_tr_b16 v[122:123], v12 offset:19456
v_mul_f32 v198, v198, v134
v_mfma_f32_16x16x32_bf16 v[176:179], v[80:83], a[76:79], v[176:179]
ds_read_b64_tr_b16 v[124:125], v13 offset:3072
v_mul_f32 v199, v199, v135
v_mfma_f32_16x16x32_bf16 v[164:167], v[84:87], a[72:75], v[164:167]
ds_read_b64_tr_b16 v[126:127], v13 offset:19456
v_cvt_pk_bf16_f32 v192, v192, v193
v_mfma_f32_16x16x32_bf16 v[180:183], v[84:87], a[76:79], v[180:183]
ds_read_b64_tr_b16 v[80:81], v10 offset:4096
s_waitcnt lgkmcnt(6)
v_mfma_f32_16x16x32_bf16 v[168:171], v[88:91], a[72:75], v[168:171]
ds_read_b64_tr_b16 v[82:83], v10 offset:20480
v_cvt_pk_bf16_f32 v193, v194, v195
v_mfma_f32_16x16x32_bf16 v[184:187], v[88:91], a[76:79], v[184:187]
ds_read_b64_tr_b16 v[84:85], v11 offset:4096
v_cvt_pk_bf16_f32 v194, v196, v197
v_mfma_f32_16x16x32_bf16 v[172:175], v[92:95], a[72:75], v[172:175]
ds_read_b64_tr_b16 v[86:87], v11 offset:20480
v_cvt_pk_bf16_f32 v195, v198, v199
v_mfma_f32_16x16x32_bf16 v[188:191], v[92:95], a[76:79], v[188:191]
buffer_store_dwordx4 v[192:195], v46, s[60:63], s7 offen offset:0 sc1
v_mfma_f32_16x16x32_bf16 v[160:163], v[96:99], a[80:83], v[160:163]
ds_read_b64_tr_b16 v[88:89], v12 offset:4096
v_mul_f32 v200, v200, v136
v_mfma_f32_16x16x32_bf16 v[176:179], v[96:99], a[84:87], v[176:179]
ds_read_b64_tr_b16 v[90:91], v12 offset:20480
v_mul_f32 v201, v201, v137
v_mfma_f32_16x16x32_bf16 v[164:167], v[100:103], a[80:83], v[164:167]
ds_read_b64_tr_b16 v[92:93], v13 offset:4096
v_mul_f32 v202, v202, v138
v_mfma_f32_16x16x32_bf16 v[180:183], v[100:103], a[84:87], v[180:183]
ds_read_b64_tr_b16 v[94:95], v13 offset:20480
v_mul_f32 v203, v203, v139
v_mfma_f32_16x16x32_bf16 v[168:171], v[104:107], a[80:83], v[168:171]
ds_read_b64_tr_b16 v[96:97], v10 offset:5120
v_mul_f32 v204, v204, v140
v_mfma_f32_16x16x32_bf16 v[184:187], v[104:107], a[84:87], v[184:187]
ds_read_b64_tr_b16 v[98:99], v10 offset:21504
v_mul_f32 v205, v205, v141
v_mfma_f32_16x16x32_bf16 v[172:175], v[108:111], a[80:83], v[172:175]
ds_read_b64_tr_b16 v[100:101], v11 offset:5120
v_mul_f32 v206, v206, v142
v_mfma_f32_16x16x32_bf16 v[188:191], v[108:111], a[84:87], v[188:191]
ds_read_b64_tr_b16 v[102:103], v11 offset:21504
v_mul_f32 v207, v207, v143
v_mfma_f32_16x16x32_bf16 v[160:163], v[112:115], a[88:91], v[160:163]
ds_read_b64_tr_b16 v[104:105], v12 offset:5120
v_cvt_pk_bf16_f32 v200, v200, v201
v_mfma_f32_16x16x32_bf16 v[176:179], v[112:115], a[92:95], v[176:179]
ds_read_b64_tr_b16 v[106:107], v12 offset:21504
s_waitcnt lgkmcnt(6)
v_mfma_f32_16x16x32_bf16 v[164:167], v[116:119], a[88:91], v[164:167]
ds_read_b64_tr_b16 v[108:109], v13 offset:5120
v_cvt_pk_bf16_f32 v201, v202, v203
v_mfma_f32_16x16x32_bf16 v[180:183], v[116:119], a[92:95], v[180:183]
ds_read_b64_tr_b16 v[110:111], v13 offset:21504
v_cvt_pk_bf16_f32 v202, v204, v205
v_mfma_f32_16x16x32_bf16 v[168:171], v[120:123], a[88:91], v[168:171]
ds_read_b64_tr_b16 v[112:113], v10 offset:6144
v_cvt_pk_bf16_f32 v203, v206, v207
v_mfma_f32_16x16x32_bf16 v[184:187], v[120:123], a[92:95], v[184:187]
buffer_store_dwordx4 v[200:203], v46, s[60:63], s7 offen offset:2048 sc1
v_mfma_f32_16x16x32_bf16 v[172:175], v[124:127], a[88:91], v[172:175]
ds_read_b64_tr_b16 v[114:115], v10 offset:22528
ds_read_b64_tr_b16 v[116:117], v11 offset:6144
v_mfma_f32_16x16x32_bf16 v[188:191], v[124:127], a[92:95], v[188:191]
ds_read_b64_tr_b16 v[118:119], v11 offset:22528
v_mul_f32 v208, v208, v144
v_mfma_f32_16x16x32_bf16 v[160:163], v[80:83], a[96:99], v[160:163]
ds_read_b64_tr_b16 v[120:121], v12 offset:6144
v_mul_f32 v209, v209, v145
v_mfma_f32_16x16x32_bf16 v[176:179], v[80:83], a[100:103], v[176:179]
ds_read_b64_tr_b16 v[122:123], v12 offset:22528
v_mul_f32 v210, v210, v146
v_mfma_f32_16x16x32_bf16 v[164:167], v[84:87], a[96:99], v[164:167]
ds_read_b64_tr_b16 v[124:125], v13 offset:6144
v_mul_f32 v211, v211, v147
v_mfma_f32_16x16x32_bf16 v[180:183], v[84:87], a[100:103], v[180:183]
ds_read_b64_tr_b16 v[126:127], v13 offset:22528
v_mul_f32 v212, v212, v148
v_mfma_f32_16x16x32_bf16 v[168:171], v[88:91], a[96:99], v[168:171]
ds_read_b64_tr_b16 v[80:81], v10 offset:7168
v_mul_f32 v213, v213, v149
v_mfma_f32_16x16x32_bf16 v[184:187], v[88:91], a[100:103], v[184:187]
ds_read_b64_tr_b16 v[82:83], v10 offset:23552
v_mul_f32 v214, v214, v150
v_mfma_f32_16x16x32_bf16 v[172:175], v[92:95], a[96:99], v[172:175]
ds_read_b64_tr_b16 v[84:85], v11 offset:7168
v_mul_f32 v215, v215, v151
v_mfma_f32_16x16x32_bf16 v[188:191], v[92:95], a[100:103], v[188:191]
ds_read_b64_tr_b16 v[86:87], v11 offset:23552
s_waitcnt lgkmcnt(6)
v_mfma_f32_16x16x32_bf16 v[160:163], v[96:99], a[104:107], v[160:163]
ds_read_b64_tr_b16 v[88:89], v12 offset:7168
s_add_u32 m0, s76, 98304
v_mfma_f32_16x16x32_bf16 v[176:179], v[96:99], a[108:111], v[176:179]
ds_read_b64_tr_b16 v[90:91], v12 offset:23552
s_add_u32 s77, s85, 0x380000
v_mfma_f32_16x16x32_bf16 v[164:167], v[100:103], a[104:107], v[164:167]
buffer_load_dwordx4 v34, s[52:55], s77 offen offset:0 lds
v_mfma_f32_16x16x32_bf16 v[180:183], v[100:103], a[108:111], v[180:183]
ds_read_b64_tr_b16 v[92:93], v13 offset:7168
ds_read_b64_tr_b16 v[94:95], v13 offset:23552
v_mfma_f32_16x16x32_bf16 v[168:171], v[104:107], a[104:107], v[168:171]
v_cvt_pk_bf16_f32 v208, v208, v209
v_cvt_pk_bf16_f32 v209, v210, v211
v_mfma_f32_16x16x32_bf16 v[184:187], v[104:107], a[108:111], v[184:187]
v_cvt_pk_bf16_f32 v210, v212, v213
v_cvt_pk_bf16_f32 v211, v214, v215
v_mfma_f32_16x16x32_bf16 v[172:175], v[108:111], a[104:107], v[172:175]
buffer_load_dwordx4 v35, s[52:55], s77 offen offset:1024 lds
v_mfma_f32_16x16x32_bf16 v[188:191], v[108:111], a[108:111], v[188:191]
v_mfma_f32_16x16x32_bf16 v[160:163], v[112:115], a[112:115], v[160:163]
s_waitcnt vmcnt(14) lgkmcnt(0)
s_barrier
v_mfma_f32_16x16x32_bf16 v[176:179], v[112:115], a[116:119], v[176:179]
ds_read_b64_tr_b16 v[96:97], v10 offset:32768
ds_read_b64_tr_b16 v[98:99], v10 offset:49152
v_mfma_f32_16x16x32_bf16 v[164:167], v[116:119], a[112:115], v[164:167]
ds_read_b64_tr_b16 v[100:101], v11 offset:32768
v_mfma_f32_16x16x32_bf16 v[180:183], v[116:119], a[116:119], v[180:183]
ds_read_b64_tr_b16 v[102:103], v11 offset:49152
ds_read_b64_tr_b16 v[104:105], v12 offset:32768
v_mfma_f32_16x16x32_bf16 v[168:171], v[120:123], a[112:115], v[168:171]
buffer_load_dwordx4 v36, s[52:55], s77 offen offset:2048 lds
v_mfma_f32_16x16x32_bf16 v[184:187], v[120:123], a[116:119], v[184:187]
ds_read_b64_tr_b16 v[106:107], v12 offset:49152
ds_read_b64_tr_b16 v[108:109], v13 offset:32768
v_mfma_f32_16x16x32_bf16 v[172:175], v[124:127], a[112:115], v[172:175]
buffer_store_dwordx4 v[208:211], v46, s[60:63], s7 offen offset:1024 sc1
v_mfma_f32_16x16x32_bf16 v[188:191], v[124:127], a[116:119], v[188:191]
ds_read_b64_tr_b16 v[110:111], v13 offset:49152
ds_read_b64_tr_b16 v[112:113], v10 offset:33792
v_mfma_f32_16x16x32_bf16 v[160:163], v[80:83], a[120:123], v[160:163]
buffer_load_dwordx4 v37, s[52:55], s77 offen offset:3072 lds
v_mfma_f32_16x16x32_bf16 v[176:179], v[80:83], a[124:127], v[176:179]
ds_read_b64_tr_b16 v[114:115], v10 offset:50176
ds_read_b64_tr_b16 v[116:117], v11 offset:33792
v_mfma_f32_16x16x32_bf16 v[164:167], v[84:87], a[120:123], v[164:167]
ds_read_b64_tr_b16 v[118:119], v11 offset:50176
s_add_u32 m0, s76, 102400
v_mfma_f32_16x16x32_bf16 v[180:183], v[84:87], a[124:127], v[180:183]
ds_read_b64_tr_b16 v[120:121], v12 offset:33792
s_add_u32 s77, s85, 0x460000
v_mfma_f32_16x16x32_bf16 v[168:171], v[88:91], a[120:123], v[168:171]
buffer_load_dwordx4 v34, s[52:55], s77 offen offset:0 lds
v_mfma_f32_16x16x32_bf16 v[184:187], v[88:91], a[124:127], v[184:187]
ds_read_b64_tr_b16 v[122:123], v12 offset:50176
ds_read_b64_tr_b16 v[124:125], v13 offset:33792
v_mfma_f32_16x16x32_bf16 v[172:175], v[92:95], a[120:123], v[172:175]
ds_read_b64_tr_b16 v[126:127], v13 offset:50176
v_mul_f32 v216, v216, v152
v_mfma_f32_16x16x32_bf16 v[188:191], v[92:95], a[124:127], v[188:191]
ds_read_b64_tr_b16 v[80:81], v10 offset:34816
s_waitcnt lgkmcnt(6)
v_mfma_f32_16x16x32_bf16 v[160:163], v[96:99], a[128:131], v[160:163]
buffer_load_dwordx4 v35, s[52:55], s77 offen offset:1024 lds
v_mfma_f32_16x16x32_bf16 v[176:179], v[96:99], a[132:135], v[176:179]
ds_read_b64_tr_b16 v[82:83], v10 offset:51200
ds_read_b64_tr_b16 v[84:85], v11 offset:34816
v_mfma_f32_16x16x32_bf16 v[164:167], v[100:103], a[128:131], v[164:167]
ds_read_b64_tr_b16 v[86:87], v11 offset:51200
v_mul_f32 v217, v217, v153
v_mfma_f32_16x16x32_bf16 v[180:183], v[100:103], a[132:135], v[180:183]
ds_read_b64_tr_b16 v[88:89], v12 offset:34816
ds_read_b64_tr_b16 v[90:91], v12 offset:51200
v_mfma_f32_16x16x32_bf16 v[168:171], v[104:107], a[128:131], v[168:171]
buffer_load_dwordx4 v36, s[52:55], s77 offen offset:2048 lds
v_mfma_f32_16x16x32_bf16 v[184:187], v[104:107], a[132:135], v[184:187]
ds_read_b64_tr_b16 v[92:93], v13 offset:34816
ds_read_b64_tr_b16 v[94:95], v13 offset:51200
v_mfma_f32_16x16x32_bf16 v[172:175], v[108:111], a[128:131], v[172:175]
ds_read_b64_tr_b16 v[96:97], v10 offset:35840
v_mul_f32 v218, v218, v154
v_mfma_f32_16x16x32_bf16 v[188:191], v[108:111], a[132:135], v[188:191]
ds_read_b64_tr_b16 v[98:99], v10 offset:52224
ds_read_b64_tr_b16 v[100:101], v11 offset:35840
v_mfma_f32_16x16x32_bf16 v[160:163], v[112:115], a[136:139], v[160:163]
buffer_load_dwordx4 v37, s[52:55], s77 offen offset:3072 lds
v_mfma_f32_16x16x32_bf16 v[176:179], v[112:115], a[140:143], v[176:179]
ds_read_b64_tr_b16 v[102:103], v11 offset:52224
s_waitcnt lgkmcnt(6)
v_mfma_f32_16x16x32_bf16 v[164:167], v[116:119], a[136:139], v[164:167]
ds_read_b64_tr_b16 v[104:105], v12 offset:35840
s_add_u32 m0, s76, 0
v_mfma_f32_16x16x32_bf16 v[180:183], v[116:119], a[140:143], v[180:183]
ds_read_b64_tr_b16 v[106:107], v12 offset:52224
s_add_u32 s77, s84, 0x0
v_mfma_f32_16x16x32_bf16 v[168:171], v[120:123], a[136:139], v[168:171]
buffer_load_dwordx4 v30, s[44:47], s77 offen offset:0 lds
v_mfma_f32_16x16x32_bf16 v[184:187], v[120:123], a[140:143], v[184:187]
ds_read_b64_tr_b16 v[108:109], v13 offset:35840
ds_read_b64_tr_b16 v[110:111], v13 offset:52224
v_mfma_f32_16x16x32_bf16 v[172:175], v[124:127], a[136:139], v[172:175]
ds_read_b64_tr_b16 v[112:113], v10 offset:36864
v_mul_f32 v219, v219, v155
v_mfma_f32_16x16x32_bf16 v[188:191], v[124:127], a[140:143], v[188:191]
ds_read_b64_tr_b16 v[114:115], v10 offset:53248
ds_read_b64_tr_b16 v[116:117], v11 offset:36864
v_mfma_f32_16x16x32_bf16 v[160:163], v[80:83], a[144:147], v[160:163]
buffer_load_dwordx4 v31, s[44:47], s77 offen offset:1024 lds
v_mfma_f32_16x16x32_bf16 v[176:179], v[80:83], a[148:151], v[176:179]
ds_read_b64_tr_b16 v[118:119], v11 offset:53248
ds_read_b64_tr_b16 v[120:121], v12 offset:36864
v_mfma_f32_16x16x32_bf16 v[164:167], v[84:87], a[144:147], v[164:167]
ds_read_b64_tr_b16 v[122:123], v12 offset:53248
v_mul_f32 v220, v220, v156
v_mfma_f32_16x16x32_bf16 v[180:183], v[84:87], a[148:151], v[180:183]
ds_read_b64_tr_b16 v[124:125], v13 offset:36864
ds_read_b64_tr_b16 v[126:127], v13 offset:53248
v_mfma_f32_16x16x32_bf16 v[168:171], v[88:91], a[144:147], v[168:171]
buffer_load_dwordx4 v32, s[44:47], s77 offen offset:2048 lds
v_mfma_f32_16x16x32_bf16 v[184:187], v[88:91], a[148:151], v[184:187]
ds_read_b64_tr_b16 v[80:81], v10 offset:37888
s_waitcnt lgkmcnt(6)
v_mfma_f32_16x16x32_bf16 v[172:175], v[92:95], a[144:147], v[172:175]
ds_read_b64_tr_b16 v[82:83], v10 offset:54272
ds_read_b64_tr_b16 v[84:85], v11 offset:37888
v_mfma_f32_16x16x32_bf16 v[188:191], v[92:95], a[148:151], v[188:191]
ds_read_b64_tr_b16 v[86:87], v11 offset:54272
v_mul_f32 v221, v221, v157
v_mfma_f32_16x16x32_bf16 v[160:163], v[96:99], a[152:155], v[160:163]
buffer_load_dwordx4 v33, s[44:47], s77 offen offset:3072 lds
v_mfma_f32_16x16x32_bf16 v[176:179], v[96:99], a[156:159], v[176:179]
ds_read_b64_tr_b16 v[88:89], v12 offset:37888
ds_read_b64_tr_b16 v[90:91], v12 offset:54272
v_mfma_f32_16x16x32_bf16 v[164:167], v[100:103], a[152:155], v[164:167]
ds_read_b64_tr_b16 v[92:93], v13 offset:37888
s_add_u32 m0, s76, 4096
v_mfma_f32_16x16x32_bf16 v[180:183], v[100:103], a[156:159], v[180:183]
ds_read_b64_tr_b16 v[94:95], v13 offset:54272
s_add_u32 s77, s84, 0xe0000
v_mfma_f32_16x16x32_bf16 v[168:171], v[104:107], a[152:155], v[168:171]
buffer_load_dwordx4 v30, s[44:47], s77 offen offset:0 lds
v_mfma_f32_16x16x32_bf16 v[184:187], v[104:107], a[156:159], v[184:187]
ds_read_b64_tr_b16 v[96:97], v10 offset:38912
ds_read_b64_tr_b16 v[98:99], v10 offset:55296
v_mfma_f32_16x16x32_bf16 v[172:175], v[108:111], a[152:155], v[172:175]
ds_read_b64_tr_b16 v[100:101], v11 offset:38912
v_mul_f32 v222, v222, v158
v_mfma_f32_16x16x32_bf16 v[188:191], v[108:111], a[156:159], v[188:191]
ds_read_b64_tr_b16 v[102:103], v11 offset:55296
v_mul_f32 v223, v223, v159
v_mfma_f32_16x16x32_bf16 v[160:163], v[112:115], a[160:163], v[160:163]
buffer_load_dwordx4 v31, s[44:47], s77 offen offset:1024 lds
v_mfma_f32_16x16x32_bf16 v[176:179], v[112:115], a[164:167], v[176:179]
ds_read_b64_tr_b16 v[104:105], v12 offset:38912
s_waitcnt lgkmcnt(5)
v_mfma_f32_16x16x32_bf16 v[164:167], v[116:119], a[160:163], v[164:167]
ds_read_b64_tr_b16 v[106:107], v12 offset:55296
ds_read_b64_tr_b16 v[108:109], v13 offset:38912
v_mfma_f32_16x16x32_bf16 v[180:183], v[116:119], a[164:167], v[180:183]
ds_read_b64_tr_b16 v[110:111], v13 offset:55296
v_cvt_pk_bf16_f32 v216, v216, v217
v_mfma_f32_16x16x32_bf16 v[168:171], v[120:123], a[160:163], v[168:171]
buffer_load_dwordx4 v32, s[44:47], s77 offen offset:2048 lds
v_mfma_f32_16x16x32_bf16 v[184:187], v[120:123], a[164:167], v[184:187]
ds_read_b64_tr_b16 v[112:113], v10 offset:39936
ds_read_b64_tr_b16 v[114:115], v10 offset:56320
v_mfma_f32_16x16x32_bf16 v[172:175], v[124:127], a[160:163], v[172:175]
ds_read_b64_tr_b16 v[116:117], v11 offset:39936
v_cvt_pk_bf16_f32 v217, v218, v219
v_mfma_f32_16x16x32_bf16 v[188:191], v[124:127], a[164:167], v[188:191]
ds_read_b64_tr_b16 v[118:119], v11 offset:56320
v_cvt_pk_bf16_f32 v218, v220, v221
v_mfma_f32_16x16x32_bf16 v[160:163], v[80:83], a[168:171], v[160:163]
buffer_load_dwordx4 v33, s[44:47], s77 offen offset:3072 lds
v_mfma_f32_16x16x32_bf16 v[176:179], v[80:83], a[172:175], v[176:179]
ds_read_b64_tr_b16 v[120:121], v12 offset:39936
ds_read_b64_tr_b16 v[122:123], v12 offset:56320
v_mfma_f32_16x16x32_bf16 v[164:167], v[84:87], a[168:171], v[164:167]
ds_read_b64_tr_b16 v[124:125], v13 offset:39936
v_cvt_pk_bf16_f32 v219, v222, v223
v_mfma_f32_16x16x32_bf16 v[180:183], v[84:87], a[172:175], v[180:183]
buffer_store_dwordx4 v[216:219], v46, s[60:63], s7 offen offset:3072 sc1
v_mfma_f32_16x16x32_bf16 v[168:171], v[88:91], a[168:171], v[168:171]
ds_read_b64_tr_b16 v[126:127], v13 offset:56320
v_mfma_f32_16x16x32_bf16 v[184:187], v[88:91], a[172:175], v[184:187]
v_mfma_f32_16x16x32_bf16 v[172:175], v[92:95], a[168:171], v[172:175]
v_mfma_f32_16x16x32_bf16 v[188:191], v[92:95], a[172:175], v[188:191]
s_waitcnt lgkmcnt(2)
v_mfma_f32_16x16x32_bf16 v[160:163], v[96:99], a[176:179], v[160:163]
v_mfma_f32_16x16x32_bf16 v[176:179], v[96:99], a[180:183], v[176:179]
s_waitcnt vmcnt(20) lgkmcnt(0)
s_barrier
v_mfma_f32_16x16x32_bf16 v[164:167], v[100:103], a[176:179], v[164:167]
ds_read_b64_tr_b16 v[80:81], v14 offset:0
ds_read_b64_tr_b16 v[82:83], v14 offset:16384
v_mfma_f32_16x16x32_bf16 v[180:183], v[100:103], a[180:183], v[180:183]
ds_read_b64_tr_b16 v[84:85], v15 offset:0
ds_read_b64_tr_b16 v[86:87], v15 offset:16384
v_mfma_f32_16x16x32_bf16 v[168:171], v[104:107], a[176:179], v[168:171]
ds_read_b64_tr_b16 v[88:89], v16 offset:0
s_add_u32 m0, s76, 32768
v_mfma_f32_16x16x32_bf16 v[184:187], v[104:107], a[180:183], v[184:187]
ds_read_b64_tr_b16 v[90:91], v16 offset:16384
s_add_u32 s77, s84, 0x1c0000
v_mfma_f32_16x16x32_bf16 v[172:175], v[108:111], a[176:179], v[172:175]
ds_read_b64_tr_b16 v[92:93], v17 offset:0
ds_read_b64_tr_b16 v[94:95], v17 offset:16384
v_mfma_f32_16x16x32_bf16 v[188:191], v[108:111], a[180:183], v[188:191]
buffer_load_dwordx4 v30, s[44:47], s77 offen offset:0 lds
v_mfma_f32_16x16x32_bf16 v[160:163], v[112:115], a[184:187], v[160:163]
ds_read_b64_tr_b16 v[96:97], v14 offset:1024
ds_read_b64_tr_b16 v[98:99], v14 offset:17408
v_mfma_f32_16x16x32_bf16 v[176:179], v[112:115], a[188:191], v[176:179]
ds_read_b64_tr_b16 v[100:101], v15 offset:1024
v_mfma_f32_16x16x32_bf16 v[164:167], v[116:119], a[184:187], v[164:167]
ds_read_b64_tr_b16 v[102:103], v15 offset:17408
ds_read_b64_tr_b16 v[104:105], v16 offset:1024
v_mfma_f32_16x16x32_bf16 v[180:183], v[116:119], a[188:191], v[180:183]
ds_read_b64_tr_b16 v[106:107], v16 offset:17408
v_mfma_f32_16x16x32_bf16 v[168:171], v[120:123], a[184:187], v[168:171]
ds_read_b64_tr_b16 v[108:109], v17 offset:1024
ds_read_b64_tr_b16 v[110:111], v17 offset:17408
v_mfma_f32_16x16x32_bf16 v[184:187], v[120:123], a[188:191], v[184:187]
buffer_load_dwordx4 v31, s[44:47], s77 offen offset:1024 lds
v_mfma_f32_16x16x32_bf16 v[172:175], v[124:127], a[184:187], v[172:175]
ds_read_b64_tr_b16 v[112:113], v14 offset:2048
ds_read_b64_tr_b16 v[114:115], v14 offset:18432
v_mfma_f32_16x16x32_bf16 v[188:191], v[124:127], a[188:191], v[188:191]
ds_read_b64_tr_b16 v[116:117], v15 offset:2048
s_waitcnt lgkmcnt(8)
v_mfma_f32_16x16x32_bf16 v[160:163], v[80:83], a[192:195], v[160:163]
ds_read_b64_tr_b16 v[118:119], v15 offset:18432
ds_read_b64_tr_b16 v[120:121], v16 offset:2048
v_mfma_f32_16x16x32_bf16 v[176:179], v[80:83], a[196:199], v[176:179]
ds_read_b64_tr_b16 v[122:123], v16 offset:18432
v_mfma_f32_16x16x32_bf16 v[164:167], v[84:87], a[192:195], v[164:167]
ds_read_b64_tr_b16 v[124:125], v17 offset:2048
ds_read_b64_tr_b16 v[126:127], v17 offset:18432
v_mfma_f32_16x16x32_bf16 v[180:183], v[84:87], a[196:199], v[180:183]
buffer_load_dwordx4 v32, s[44:47], s77 offen offset:2048 lds
v_mfma_f32_16x16x32_bf16 v[168:171], v[88:91], a[192:195], v[168:171]
ds_read_b64_tr_b16 v[80:81], v14 offset:3072
ds_read_b64_tr_b16 v[82:83], v14 offset:19456
v_mfma_f32_16x16x32_bf16 v[184:187], v[88:91], a[196:199], v[184:187]
ds_read_b64_tr_b16 v[84:85], v15 offset:3072
v_mfma_f32_16x16x32_bf16 v[172:175], v[92:95], a[192:195], v[172:175]
ds_read_b64_tr_b16 v[86:87], v15 offset:19456
ds_read_b64_tr_b16 v[88:89], v16 offset:3072
v_mfma_f32_16x16x32_bf16 v[188:191], v[92:95], a[196:199], v[188:191]
ds_read_b64_tr_b16 v[90:91], v16 offset:19456
v_mfma_f32_16x16x32_bf16 v[160:163], v[96:99], a[200:203], v[160:163]
ds_read_b64_tr_b16 v[92:93], v17 offset:3072
v_mfma_f32_16x16x32_bf16 v[176:179], v[96:99], a[204:207], v[176:179]
ds_read_b64_tr_b16 v[94:95], v17 offset:19456
s_waitcnt lgkmcnt(8)
v_mfma_f32_16x16x32_bf16 v[164:167], v[100:103], a[200:203], v[164:167]
buffer_load_dwordx4 v33, s[44:47], s77 offen offset:3072 lds
v_mfma_f32_16x16x32_bf16 v[180:183], v[100:103], a[204:207], v[180:183]
ds_read_b64_tr_b16 v[96:97], v14 offset:4096
ds_read_b64_tr_b16 v[98:99], v14 offset:20480
v_mfma_f32_16x16x32_bf16 v[168:171], v[104:107], a[200:203], v[168:171]
ds_read_b64_tr_b16 v[100:101], v15 offset:4096
v_mfma_f32_16x16x32_bf16 v[184:187], v[104:107], a[204:207], v[184:187]
ds_read_b64_tr_b16 v[102:103], v15 offset:20480
s_add_u32 m0, s76, 36864
v_mfma_f32_16x16x32_bf16 v[172:175], v[108:111], a[200:203], v[172:175]
ds_read_b64_tr_b16 v[104:105], v16 offset:4096
s_add_u32 s77, s84, 0x2a0000
v_mfma_f32_16x16x32_bf16 v[188:191], v[108:111], a[204:207], v[188:191]
ds_read_b64_tr_b16 v[106:107], v16 offset:20480
v_mfma_f32_16x16x32_bf16 v[160:163], v[112:115], a[208:211], v[160:163]
buffer_load_dwordx4 v30, s[44:47], s77 offen offset:0 lds
v_mfma_f32_16x16x32_bf16 v[176:179], v[112:115], a[212:215], v[176:179]
ds_read_b64_tr_b16 v[108:109], v17 offset:4096
ds_read_b64_tr_b16 v[110:111], v17 offset:20480
v_mfma_f32_16x16x32_bf16 v[164:167], v[116:119], a[208:211], v[164:167]
ds_read_b64_tr_b16 v[112:113], v14 offset:5120
v_mfma_f32_16x16x32_bf16 v[180:183], v[116:119], a[212:215], v[180:183]
ds_read_b64_tr_b16 v[114:115], v14 offset:21504
v_mfma_f32_16x16x32_bf16 v[168:171], v[120:123], a[208:211], v[168:171]
ds_read_b64_tr_b16 v[116:117], v15 offset:5120
v_mfma_f32_16x16x32_bf16 v[184:187], v[120:123], a[212:215], v[184:187]
ds_read_b64_tr_b16 v[118:119], v15 offset:21504
v_mfma_f32_16x16x32_bf16 v[172:175], v[124:127], a[208:211], v[172:175]
buffer_load_dwordx4 v31, s[44:47], s77 offen offset:1024 lds
v_mfma_f32_16x16x32_bf16 v[188:191], v[124:127], a[212:215], v[188:191]
ds_read_b64_tr_b16 v[120:121], v16 offset:5120
s_waitcnt lgkmcnt(5)
v_mfma_f32_16x16x32_bf16 v[160:163], v[80:83], a[216:219], v[160:163]
ds_read_b64_tr_b16 v[122:123], v16 offset:21504
ds_read_b64_tr_b16 v[124:125], v17 offset:5120
v_mfma_f32_16x16x32_bf16 v[176:179], v[80:83], a[220:223], v[176:179]
ds_read_b64_tr_b16 v[126:127], v17 offset:21504
v_mfma_f32_16x16x32_bf16 v[164:167], v[84:87], a[216:219], v[164:167]
ds_read_b64_tr_b16 v[80:81], v14 offset:6144
v_mfma_f32_16x16x32_bf16 v[180:183], v[84:87], a[220:223], v[180:183]
ds_read_b64_tr_b16 v[82:83], v14 offset:22528
v_mfma_f32_16x16x32_bf16 v[168:171], v[88:91], a[216:219], v[168:171]
buffer_load_dwordx4 v32, s[44:47], s77 offen offset:2048 lds
v_mfma_f32_16x16x32_bf16 v[184:187], v[88:91], a[220:223], v[184:187]
ds_read_b64_tr_b16 v[84:85], v15 offset:6144
ds_read_b64_tr_b16 v[86:87], v15 offset:22528
v_mfma_f32_16x16x32_bf16 v[172:175], v[92:95], a[216:219], v[172:175]
ds_read_b64_tr_b16 v[88:89], v16 offset:6144
v_mfma_f32_16x16x32_bf16 v[188:191], v[92:95], a[220:223], v[188:191]
ds_read_b64_tr_b16 v[90:91], v16 offset:22528
v_mfma_f32_16x16x32_bf16 v[160:163], v[96:99], a[224:227], v[160:163]
ds_read_b64_tr_b16 v[92:93], v17 offset:6144
v_mfma_f32_16x16x32_bf16 v[176:179], v[96:99], a[228:231], v[176:179]
ds_read_b64_tr_b16 v[94:95], v17 offset:22528
v_mfma_f32_16x16x32_bf16 v[164:167], v[100:103], a[224:227], v[164:167]
buffer_load_dwordx4 v33, s[44:47], s77 offen offset:3072 lds
v_mfma_f32_16x16x32_bf16 v[180:183], v[100:103], a[228:231], v[180:183]
ds_read_b64_tr_b16 v[96:97], v14 offset:7168
ds_read_b64_tr_b16 v[98:99], v14 offset:23552
v_mfma_f32_16x16x32_bf16 v[168:171], v[104:107], a[224:227], v[168:171]
ds_read_b64_tr_b16 v[100:101], v15 offset:7168
v_mfma_f32_16x16x32_bf16 v[184:187], v[104:107], a[228:231], v[184:187]
ds_read_b64_tr_b16 v[102:103], v15 offset:23552
v_mfma_f32_16x16x32_bf16 v[172:175], v[108:111], a[224:227], v[172:175]
ds_read_b64_tr_b16 v[104:105], v16 offset:7168
v_mfma_f32_16x16x32_bf16 v[188:191], v[108:111], a[228:231], v[188:191]
ds_read_b64_tr_b16 v[106:107], v16 offset:23552
s_waitcnt lgkmcnt(6)
v_mfma_f32_16x16x32_bf16 v[160:163], v[112:115], a[232:235], v[160:163]
ds_read_b64_tr_b16 v[108:109], v17 offset:7168
v_mfma_f32_16x16x32_bf16 v[176:179], v[112:115], a[236:239], v[176:179]
ds_read_b64_tr_b16 v[110:111], v17 offset:23552
v_mfma_f32_16x16x32_bf16 v[164:167], v[116:119], a[232:235], v[164:167]
v_mfma_f32_16x16x32_bf16 v[180:183], v[116:119], a[236:239], v[180:183]
v_mfma_f32_16x16x32_bf16 v[168:171], v[120:123], a[232:235], v[168:171]
v_mfma_f32_16x16x32_bf16 v[184:187], v[120:123], a[236:239], v[184:187]
v_mfma_f32_16x16x32_bf16 v[172:175], v[124:127], a[232:235], v[172:175]
s_waitcnt vmcnt(17) lgkmcnt(0)
s_barrier
v_mfma_f32_16x16x32_bf16 v[188:191], v[124:127], a[236:239], v[188:191]
ds_read_b64_tr_b16 v[112:113], v20 offset:32768
ds_read_b64_tr_b16 v[114:115], v20 offset:40960
v_mfma_f32_16x16x32_bf16 v[160:163], v[80:83], a[240:243], v[160:163]
ds_read_b64_tr_b16 v[116:117], v21 offset:32768
s_add_u32 m0, s76, 65536
v_mfma_f32_16x16x32_bf16 v[176:179], v[80:83], a[244:247], v[176:179]
ds_read_b64_tr_b16 v[118:119], v21 offset:40960
s_add_u32 s77, s84, 0x380000
v_mfma_f32_16x16x32_bf16 v[164:167], v[84:87], a[240:243], v[164:167]
buffer_load_dwordx4 v30, s[44:47], s77 offen offset:0 lds
v_mfma_f32_16x16x32_bf16 v[180:183], v[84:87], a[244:247], v[180:183]
ds_read_b64_tr_b16 v[120:121], v20 offset:49152
ds_read_b64_tr_b16 v[122:123], v20 offset:57344
v_mfma_f32_16x16x32_bf16 v[168:171], v[88:91], a[240:243], v[168:171]
ds_read_b64_tr_b16 v[124:125], v21 offset:49152
v_mfma_f32_16x16x32_bf16 v[184:187], v[88:91], a[244:247], v[184:187]
ds_read_b64_tr_b16 v[126:127], v21 offset:57344
ds_read_b64_tr_b16 v[80:81], v20 offset:33792
v_mfma_f32_16x16x32_bf16 v[172:175], v[92:95], a[240:243], v[172:175]
ds_read_b64_tr_b16 v[82:83], v20 offset:41984
v_mfma_f32_16x16x32_bf16 v[188:191], v[92:95], a[244:247], v[188:191]
ds_read_b64_tr_b16 v[84:85], v21 offset:33792
ds_read_b64_tr_b16 v[86:87], v21 offset:41984
v_mfma_f32_16x16x32_bf16 v[160:163], v[96:99], a[248:251], v[160:163]
buffer_load_dwordx4 v31, s[44:47], s77 offen offset:1024 lds
v_mfma_f32_16x16x32_bf16 v[176:179], v[96:99], a[252:255], v[176:179]
ds_read_b64_tr_b16 v[88:89], v20 offset:50176
ds_read_b64_tr_b16 v[90:91], v20 offset:58368
v_mfma_f32_16x16x32_bf16 v[164:167], v[100:103], a[248:251], v[164:167]
ds_read_b64_tr_b16 v[92:93], v21 offset:50176
v_mfma_f32_16x16x32_bf16 v[180:183], v[100:103], a[252:255], v[180:183]
ds_read_b64_tr_b16 v[94:95], v21 offset:58368
ds_read_b64_tr_b16 v[96:97], v20 offset:34816
v_mfma_f32_16x16x32_bf16 v[168:171], v[104:107], a[248:251], v[168:171]
ds_read_b64_tr_b16 v[98:99], v20 offset:43008
v_mfma_f32_16x16x32_bf16 v[184:187], v[104:107], a[252:255], v[184:187]
ds_read_b64_tr_b16 v[100:101], v21 offset:34816
ds_read_b64_tr_b16 v[102:103], v21 offset:43008
v_mfma_f32_16x16x32_bf16 v[172:175], v[108:111], a[248:251], v[172:175]
buffer_load_dwordx4 v32, s[44:47], s77 offen offset:2048 lds
v_mfma_f32_16x16x32_bf16 v[188:191], v[108:111], a[252:255], v[188:191]
ds_read_b64_tr_b16 v[104:105], v20 offset:51200
ds_read_b64_tr_b16 v[106:107], v20 offset:59392
S_H2:
s_waitcnt lgkmcnt(8)
v_mfma_f32_16x16x32_bf16 v[224:227], v[112:115], a[128:131], v[224:227]
ds_read_b64_tr_b16 v[108:109], v21 offset:51200
v_mfma_f32_16x16x32_bf16 v[240:243], v[112:115], a[132:135], v[240:243]
ds_read_b64_tr_b16 v[110:111], v21 offset:59392
v_mfma_f32_16x16x32_bf16 v[228:231], v[116:119], a[128:131], v[228:231]
ds_read_b64_tr_b16 v[112:113], v20 offset:35840
v_mfma_f32_16x16x32_bf16 v[244:247], v[116:119], a[132:135], v[244:247]
s_add_u32 s70, s0, S_H3 - K_pc + 0
s_addc_u32 s71, s1, 0
global_load_dword v57, v9, s[70:71]
v_mfma_f32_16x16x32_bf16 v[232:235], v[120:123], a[128:131], v[232:235]
ds_read_b64_tr_b16 v[114:115], v20 offset:44032
v_mul_f32 v68, v60, v160
v_mfma_f32_16x16x32_bf16 v[248:251], v[120:123], a[132:135], v[248:251]
buffer_load_dwordx4 v33, s[44:47], s77 offen offset:3072 lds
v_mfma_f32_16x16x32_bf16 v[236:239], v[124:127], a[128:131], v[236:239]
ds_read_b64_tr_b16 v[116:117], v21 offset:35840
v_mul_f32 v69, v60, v161
v_mfma_f32_16x16x32_bf16 v[252:255], v[124:127], a[132:135], v[252:255]
ds_read_b64_tr_b16 v[118:119], v21 offset:44032
s_mul_i32 s3, s101, 7168
v_mfma_f32_16x16x32_bf16 v[224:227], v[80:83], a[136:139], v[224:227]
ds_read_b64_tr_b16 v[120:121], v20 offset:52224
s_add_u32 m0, s76, 69632
v_mfma_f32_16x16x32_bf16 v[240:243], v[80:83], a[140:143], v[240:243]
ds_read_b64_tr_b16 v[122:123], v20 offset:60416
s_add_u32 s77, s84, 0x460000
v_mfma_f32_16x16x32_bf16 v[228:231], v[84:87], a[136:139], v[228:231]
ds_read_b64_tr_b16 v[124:125], v21 offset:52224
s_add_u32 s3, s3, 0x1000
v_mfma_f32_16x16x32_bf16 v[244:247], v[84:87], a[140:143], v[244:247]
buffer_load_dwordx4 v30, s[44:47], s77 offen offset:0 lds
v_mfma_f32_16x16x32_bf16 v[232:235], v[88:91], a[136:139], v[232:235]
ds_read_b64_tr_b16 v[126:127], v21 offset:60416
ds_read_b64_tr_b16 v[80:81], v20 offset:36864
v_mfma_f32_16x16x32_bf16 v[248:251], v[88:91], a[140:143], v[248:251]
ds_read_b64_tr_b16 v[82:83], v20 offset:45056
s_waitcnt lgkmcnt(6)
v_mfma_f32_16x16x32_bf16 v[236:239], v[92:95], a[136:139], v[236:239]
ds_read_b64_tr_b16 v[84:85], v21 offset:36864
v_mul_f32 v70, v60, v162
v_mfma_f32_16x16x32_bf16 v[252:255], v[92:95], a[140:143], v[252:255]
ds_read_b64_tr_b16 v[86:87], v21 offset:45056
v_mul_f32 v71, v60, v163
v_mfma_f32_16x16x32_bf16 v[224:227], v[96:99], a[144:147], v[224:227]
v_exp_f32 v68, v68
v_mfma_f32_16x16x32_bf16 v[240:243], v[96:99], a[148:151], v[240:243]
ds_read_b64_tr_b16 v[88:89], v20 offset:53248
ds_read_b64_tr_b16 v[90:91], v20 offset:61440
v_mfma_f32_16x16x32_bf16 v[228:231], v[100:103], a[144:147], v[228:231]
buffer_load_dwordx4 v31, s[44:47], s77 offen offset:1024 lds
v_mfma_f32_16x16x32_bf16 v[244:247], v[100:103], a[148:151], v[244:247]
ds_read_b64_tr_b16 v[92:93], v21 offset:53248
ds_read_b64_tr_b16 v[94:95], v21 offset:61440
v_mfma_f32_16x16x32_bf16 v[232:235], v[104:107], a[144:147], v[232:235]
v_exp_f32 v69, v69
v_mfma_f32_16x16x32_bf16 v[248:251], v[104:107], a[148:151], v[248:251]
ds_read_b64_tr_b16 v[96:97], v20 offset:37888
ds_read_b64_tr_b16 v[98:99], v20 offset:46080
v_mfma_f32_16x16x32_bf16 v[236:239], v[108:111], a[144:147], v[236:239]
v_exp_f32 v70, v70
v_mfma_f32_16x16x32_bf16 v[252:255], v[108:111], a[148:151], v[252:255]
ds_read_b64_tr_b16 v[100:101], v21 offset:37888
ds_read_b64_tr_b16 v[102:103], v21 offset:46080
v_mfma_f32_16x16x32_bf16 v[224:227], v[112:115], a[152:155], v[224:227]
buffer_load_dwordx4 v32, s[44:47], s77 offen offset:2048 lds
v_mfma_f32_16x16x32_bf16 v[240:243], v[112:115], a[156:159], v[240:243]
ds_read_b64_tr_b16 v[104:105], v20 offset:54272
ds_read_b64_tr_b16 v[106:107], v20 offset:62464
v_mfma_f32_16x16x32_bf16 v[228:231], v[116:119], a[152:155], v[228:231]
v_exp_f32 v71, v71
v_mfma_f32_16x16x32_bf16 v[244:247], v[116:119], a[156:159], v[244:247]
ds_read_b64_tr_b16 v[108:109], v21 offset:54272
s_waitcnt lgkmcnt(5)
v_mfma_f32_16x16x32_bf16 v[232:235], v[120:123], a[152:155], v[232:235]
ds_read_b64_tr_b16 v[110:111], v21 offset:62464
ds_read_b64_tr_b16 v[112:113], v20 offset:38912
v_mfma_f32_16x16x32_bf16 v[248:251], v[120:123], a[156:159], v[248:251]
ds_read_b64_tr_b16 v[114:115], v20 offset:47104
v_fma_f32 v68, v68, v62, v62
v_mfma_f32_16x16x32_bf16 v[236:239], v[124:127], a[152:155], v[236:239]
buffer_load_dwordx4 v33, s[44:47], s77 offen offset:3072 lds
v_mfma_f32_16x16x32_bf16 v[252:255], v[124:127], a[156:159], v[252:255]
ds_read_b64_tr_b16 v[116:117], v21 offset:38912
ds_read_b64_tr_b16 v[118:119], v21 offset:47104
v_mfma_f32_16x16x32_bf16 v[224:227], v[80:83], a[160:163], v[224:227]
buffer_load_dword v57, v8, s[44:47], s3 offen
v_mfma_f32_16x16x32_bf16 v[240:243], v[80:83], a[164:167], v[240:243]
ds_read_b64_tr_b16 v[120:121], v20 offset:55296
ds_read_b64_tr_b16 v[122:123], v20 offset:63488
v_mfma_f32_16x16x32_bf16 v[228:231], v[84:87], a[160:163], v[228:231]
ds_read_b64_tr_b16 v[124:125], v21 offset:55296
s_mul_i32 s3, s101, 1024
v_mfma_f32_16x16x32_bf16 v[244:247], v[84:87], a[164:167], v[244:247]
ds_read_b64_tr_b16 v[126:127], v21 offset:63488
s_add_u32 s3, s3, 0x600000
v_mfma_f32_16x16x32_bf16 v[232:235], v[88:91], a[160:163], v[232:235]
buffer_load_dword v57, v50, s[48:51], s3 offen
v_mfma_f32_16x16x32_bf16 v[248:251], v[88:91], a[164:167], v[248:251]
ds_read_b64_tr_b16 v[80:81], v20 offset:39936
ds_read_b64_tr_b16 v[82:83], v20 offset:48128
v_mfma_f32_16x16x32_bf16 v[236:239], v[92:95], a[160:163], v[236:239]
ds_read_b64_tr_b16 v[84:85], v21 offset:39936
v_fma_f32 v69, v69, v62, v62
v_mfma_f32_16x16x32_bf16 v[252:255], v[92:95], a[164:167], v[252:255]
ds_read_b64_tr_b16 v[86:87], v21 offset:48128
v_fma_f32 v70, v70, v62, v62
v_mfma_f32_16x16x32_bf16 v[224:227], v[96:99], a[168:171], v[224:227]
ds_read_b64_tr_b16 v[88:89], v20 offset:56320
v_fma_f32 v71, v71, v62, v62
v_mfma_f32_16x16x32_bf16 v[240:243], v[96:99], a[172:175], v[240:243]
ds_read_b64_tr_b16 v[90:91], v20 offset:64512
s_waitcnt lgkmcnt(6)
v_mfma_f32_16x16x32_bf16 v[228:231], v[100:103], a[168:171], v[228:231]
v_rcp_f32 v68, v68
v_mfma_f32_16x16x32_bf16 v[244:247], v[100:103], a[172:175], v[244:247]
ds_read_b64_tr_b16 v[92:93], v21 offset:56320
ds_read_b64_tr_b16 v[94:95], v21 offset:64512
v_mfma_f32_16x16x32_bf16 v[232:235], v[104:107], a[168:171], v[232:235]
v_rcp_f32 v69, v69
v_mfma_f32_16x16x32_bf16 v[248:251], v[104:107], a[172:175], v[248:251]
v_rcp_f32 v70, v70
v_mfma_f32_16x16x32_bf16 v[236:239], v[108:111], a[168:171], v[236:239]
v_rcp_f32 v71, v71
v_mfma_f32_16x16x32_bf16 v[252:255], v[108:111], a[172:175], v[252:255]
v_mul_f32 v160, v160, v68
v_mul_f32 v161, v161, v69
v_mfma_f32_16x16x32_bf16 v[224:227], v[112:115], a[176:179], v[224:227]
s_waitcnt vmcnt(20) lgkmcnt(0)
s_barrier
v_mfma_f32_16x16x32_bf16 v[240:243], v[112:115], a[180:183], v[240:243]
ds_read_b64_tr_b16 v[96:97], v10 offset:0
ds_read_b64_tr_b16 v[98:99], v10 offset:16384
v_mfma_f32_16x16x32_bf16 v[228:231], v[116:119], a[176:179], v[228:231]
ds_read_b64_tr_b16 v[100:101], v11 offset:0
s_add_u32 m0, s76, 98304
v_mfma_f32_16x16x32_bf16 v[244:247], v[116:119], a[180:183], v[244:247]
ds_read_b64_tr_b16 v[102:103], v11 offset:16384
s_add_u32 s77, s84, 0x540000
v_mfma_f32_16x16x32_bf16 v[232:235], v[120:123], a[176:179], v[232:235]
ds_read_b64_tr_b16 v[104:105], v12 offset:0
ds_read_b64_tr_b16 v[106:107], v12 offset:16384
v_mfma_f32_16x16x32_bf16 v[248:251], v[120:123], a[180:183], v[248:251]
buffer_load_dwordx4 v30, s[44:47], s77 offen offset:0 lds
v_mfma_f32_16x16x32_bf16 v[236:239], v[124:127], a[176:179], v[236:239]
ds_read_b64_tr_b16 v[108:109], v13 offset:0
ds_read_b64_tr_b16 v[110:111], v13 offset:16384
v_mfma_f32_16x16x32_bf16 v[252:255], v[124:127], a[180:183], v[252:255]
ds_read_b64_tr_b16 v[112:113], v10 offset:1024
v_mul_f32 v162, v162, v70
v_mfma_f32_16x16x32_bf16 v[224:227], v[80:83], a[184:187], v[224:227]
ds_read_b64_tr_b16 v[114:115], v10 offset:17408
ds_read_b64_tr_b16 v[116:117], v11 offset:1024
v_mfma_f32_16x16x32_bf16 v[240:243], v[80:83], a[188:191], v[240:243]
ds_read_b64_tr_b16 v[118:119], v11 offset:17408
v_mul_f32 v163, v163, v71
v_mfma_f32_16x16x32_bf16 v[228:231], v[84:87], a[184:187], v[228:231]
ds_read_b64_tr_b16 v[120:121], v12 offset:1024
ds_read_b64_tr_b16 v[122:123], v12 offset:17408
v_mfma_f32_16x16x32_bf16 v[244:247], v[84:87], a[188:191], v[244:247]
buffer_load_dwordx4 v31, s[44:47], s77 offen offset:1024 lds
v_mfma_f32_16x16x32_bf16 v[232:235], v[88:91], a[184:187], v[232:235]
ds_read_b64_tr_b16 v[124:125], v13 offset:1024
ds_read_b64_tr_b16 v[126:127], v13 offset:17408
v_mfma_f32_16x16x32_bf16 v[248:251], v[88:91], a[188:191], v[248:251]
ds_read_b64_tr_b16 v[80:81], v10 offset:2048
v_mul_f32 v72, v60, v164
v_mfma_f32_16x16x32_bf16 v[236:239], v[92:95], a[184:187], v[236:239]
ds_read_b64_tr_b16 v[82:83], v10 offset:18432
ds_read_b64_tr_b16 v[84:85], v11 offset:2048
v_mfma_f32_16x16x32_bf16 v[252:255], v[92:95], a[188:191], v[252:255]
ds_read_b64_tr_b16 v[86:87], v11 offset:18432
s_waitcnt lgkmcnt(8)
v_mfma_f32_16x16x32_bf16 v[192:195], v[96:99], a[0:3], 0
ds_read_b64_tr_b16 v[88:89], v12 offset:2048
v_mul_f32 v73, v60, v165
v_mfma_f32_16x16x32_bf16 v[208:211], v[96:99], a[4:7], 0
buffer_load_dwordx4 v32, s[44:47], s77 offen offset:2048 lds
v_mfma_f32_16x16x32_bf16 v[196:199], v[100:103], a[0:3], 0
ds_read_b64_tr_b16 v[90:91], v12 offset:18432
ds_read_b64_tr_b16 v[92:93], v13 offset:2048
v_mfma_f32_16x16x32_bf16 v[212:215], v[100:103], a[4:7], 0
ds_read_b64_tr_b16 v[94:95], v13 offset:18432
v_mul_f32 v74, v60, v166
v_mfma_f32_16x16x32_bf16 v[200:203], v[104:107], a[0:3], 0
ds_read_b64_tr_b16 v[96:97], v10 offset:3072
v_mul_f32 v75, v60, v167
v_mfma_f32_16x16x32_bf16 v[216:219], v[104:107], a[4:7], 0
v_exp_f32 v72, v72
v_mfma_f32_16x16x32_bf16 v[204:207], v[108:111], a[0:3], 0
ds_read_b64_tr_b16 v[98:99], v10 offset:19456
ds_read_b64_tr_b16 v[100:101], v11 offset:3072
v_mfma_f32_16x16x32_bf16 v[220:223], v[108:111], a[4:7], 0
buffer_load_dwordx4 v33, s[44:47], s77 offen offset:3072 lds
v_mfma_f32_16x16x32_bf16 v[192:195], v[112:115], a[8:11], v[192:195]
ds_read_b64_tr_b16 v[102:103], v11 offset:19456
ds_read_b64_tr_b16 v[104:105], v12 offset:3072
v_mfma_f32_16x16x32_bf16 v[208:211], v[112:115], a[12:15], v[208:211]
v_exp_f32 v73, v73
v_mfma_f32_16x16x32_bf16 v[196:199], v[116:119], a[8:11], v[196:199]
ds_read_b64_tr_b16 v[106:107], v12 offset:19456
ds_read_b64_tr_b16 v[108:109], v13 offset:3072
v_mfma_f32_16x16x32_bf16 v[212:215], v[116:119], a[12:15], v[212:215]
ds_read_b64_tr_b16 v[110:111], v13 offset:19456
s_waitcnt lgkmcnt(7)
v_mfma_f32_16x16x32_bf16 v[200:203], v[120:123], a[8:11], v[200:203]
v_exp_f32 v74, v74
v_mfma_f32_16x16x32_bf16 v[216:219], v[120:123], a[12:15], v[216:219]
ds_read_b64_tr_b16 v[112:113], v10 offset:4096
ds_read_b64_tr_b16 v[114:115], v10 offset:20480
v_mfma_f32_16x16x32_bf16 v[204:207], v[124:127], a[8:11], v[204:207]
v_exp_f32 v75, v75
v_mfma_f32_16x16x32_bf16 v[220:223], v[124:127], a[12:15], v[220:223]
ds_read_b64_tr_b16 v[116:117], v11 offset:4096
ds_read_b64_tr_b16 v[118:119], v11 offset:20480
v_mfma_f32_16x16x32_bf16 v[192:195], v[80:83], a[16:19], v[192:195]
ds_read_b64_tr_b16 v[120:121], v12 offset:4096
s_add_u32 m0, s76, 102400
v_mfma_f32_16x16x32_bf16 v[208:211], v[80:83], a[20:23], v[208:211]
ds_read_b64_tr_b16 v[122:123], v12 offset:20480
s_add_u32 s77, s84, 0x620000
v_mfma_f32_16x16x32_bf16 v[196:199], v[84:87], a[16:19], v[196:199]
buffer_load_dwordx4 v30, s[44:47], s77 offen offset:0 lds
v_mfma_f32_16x16x32_bf16 v[212:215], v[84:87], a[20:23], v[212:215]
ds_read_b64_tr_b16 v[124:125], v13 offset:4096
ds_read_b64_tr_b16 v[126:127], v13 offset:20480
v_mfma_f32_16x16x32_bf16 v[200:203], v[88:91], a[16:19], v[200:203]
ds_read_b64_tr_b16 v[80:81], v10 offset:5120
v_fma_f32 v72, v72, v62, v62
v_mfma_f32_16x16x32_bf16 v[216:219], v[88:91], a[20:23], v[216:219]
ds_read_b64_tr_b16 v[82:83], v10 offset:21504
v_fma_f32 v73, v73, v62, v62
v_mfma_f32_16x16x32_bf16 v[204:207], v[92:95], a[16:19], v[204:207]
ds_read_b64_tr_b16 v[84:85], v11 offset:5120
v_fma_f32 v74, v74, v62, v62
v_mfma_f32_16x16x32_bf16 v[220:223], v[92:95], a[20:23], v[220:223]
ds_read_b64_tr_b16 v[86:87], v11 offset:21504
s_waitcnt lgkmcnt(6)
v_mfma_f32_16x16x32_bf16 v[192:195], v[96:99], a[24:27], v[192:195]
buffer_load_dwordx4 v31, s[44:47], s77 offen offset:1024 lds
v_mfma_f32_16x16x32_bf16 v[208:211], v[96:99], a[28:31], v[208:211]
ds_read_b64_tr_b16 v[88:89], v12 offset:5120
ds_read_b64_tr_b16 v[90:91], v12 offset:21504
v_mfma_f32_16x16x32_bf16 v[196:199], v[100:103], a[24:27], v[196:199]
ds_read_b64_tr_b16 v[92:93], v13 offset:5120
v_fma_f32 v75, v75, v62, v62
v_mfma_f32_16x16x32_bf16 v[212:215], v[100:103], a[28:31], v[212:215]
v_rcp_f32 v72, v72
v_mfma_f32_16x16x32_bf16 v[200:203], v[104:107], a[24:27], v[200:203]
ds_read_b64_tr_b16 v[94:95], v13 offset:21504
ds_read_b64_tr_b16 v[96:97], v10 offset:6144
v_mfma_f32_16x16x32_bf16 v[216:219], v[104:107], a[28:31], v[216:219]
v_rcp_f32 v73, v73
v_mfma_f32_16x16x32_bf16 v[204:207], v[108:111], a[24:27], v[204:207]
ds_read_b64_tr_b16 v[98:99], v10 offset:22528
ds_read_b64_tr_b16 v[100:101], v11 offset:6144
v_mfma_f32_16x16x32_bf16 v[220:223], v[108:111], a[28:31], v[220:223]
buffer_load_dwordx4 v32, s[44:47], s77 offen offset:2048 lds
v_mfma_f32_16x16x32_bf16 v[192:195], v[112:115], a[32:35], v[192:195]
ds_read_b64_tr_b16 v[102:103], v11 offset:22528
ds_read_b64_tr_b16 v[104:105], v12 offset:6144
v_mfma_f32_16x16x32_bf16 v[208:211], v[112:115], a[36:39], v[208:211]
v_rcp_f32 v74, v74
v_mfma_f32_16x16x32_bf16 v[196:199], v[116:119], a[32:35], v[196:199]
ds_read_b64_tr_b16 v[106:107], v12 offset:22528
ds_read_b64_tr_b16 v[108:109], v13 offset:6144
v_mfma_f32_16x16x32_bf16 v[212:215], v[116:119], a[36:39], v[212:215]
v_rcp_f32 v75, v75
v_mfma_f32_16x16x32_bf16 v[200:203], v[120:123], a[32:35], v[200:203]
ds_read_b64_tr_b16 v[110:111], v13 offset:22528
ds_read_b64_tr_b16 v[112:113], v10 offset:7168
v_mfma_f32_16x16x32_bf16 v[216:219], v[120:123], a[36:39], v[216:219]
ds_read_b64_tr_b16 v[114:115], v10 offset:23552
s_waitcnt lgkmcnt(7)
v_mfma_f32_16x16x32_bf16 v[204:207], v[124:127], a[32:35], v[204:207]
buffer_load_dwordx4 v33, s[44:47], s77 offen offset:3072 lds
v_mfma_f32_16x16x32_bf16 v[220:223], v[124:127], a[36:39], v[220:223]
ds_read_b64_tr_b16 v[116:117], v11 offset:7168
ds_read_b64_tr_b16 v[118:119], v11 offset:23552
v_mfma_f32_16x16x32_bf16 v[192:195], v[80:83], a[40:43], v[192:195]
ds_read_b64_tr_b16 v[120:121], v12 offset:7168
v_mul_f32 v164, v164, v72
v_mfma_f32_16x16x32_bf16 v[208:211], v[80:83], a[44:47], v[208:211]
ds_read_b64_tr_b16 v[122:123], v12 offset:23552
v_mul_f32 v165, v165, v73
v_mfma_f32_16x16x32_bf16 v[196:199], v[84:87], a[40:43], v[196:199]
ds_read_b64_tr_b16 v[124:125], v13 offset:7168
v_mul_f32 v166, v166, v74
v_mfma_f32_16x16x32_bf16 v[212:215], v[84:87], a[44:47], v[212:215]
ds_read_b64_tr_b16 v[126:127], v13 offset:23552
v_mul_f32 v167, v167, v75
v_mfma_f32_16x16x32_bf16 v[200:203], v[88:91], a[40:43], v[200:203]
v_mul_f32 v68, v60, v168
v_mul_f32 v69, v60, v169
v_mfma_f32_16x16x32_bf16 v[216:219], v[88:91], a[44:47], v[216:219]
v_mul_f32 v70, v60, v170
v_mul_f32 v71, v60, v171
v_mfma_f32_16x16x32_bf16 v[204:207], v[92:95], a[40:43], v[204:207]
v_exp_f32 v68, v68
v_mfma_f32_16x16x32_bf16 v[220:223], v[92:95], a[44:47], v[220:223]
v_exp_f32 v69, v69
v_mfma_f32_16x16x32_bf16 v[192:195], v[96:99], a[48:51], v[192:195]
s_waitcnt vmcnt(19) lgkmcnt(0)
s_barrier
v_mfma_f32_16x16x32_bf16 v[208:211], v[96:99], a[52:55], v[208:211]
ds_read_b64_tr_b16 v[80:81], v10 offset:32768
ds_read_b64_tr_b16 v[82:83], v10 offset:49152
v_mfma_f32_16x16x32_bf16 v[196:199], v[100:103], a[48:51], v[196:199]
ds_read_b64_tr_b16 v[84:85], v11 offset:32768
v_mfma_f32_16x16x32_bf16 v[212:215], v[100:103], a[52:55], v[212:215]
ds_read_b64_tr_b16 v[86:87], v11 offset:49152
ds_read_b64_tr_b16 v[88:89], v12 offset:32768
v_mfma_f32_16x16x32_bf16 v[200:203], v[104:107], a[48:51], v[200:203]
v_exp_f32 v70, v70
v_mfma_f32_16x16x32_bf16 v[216:219], v[104:107], a[52:55], v[216:219]
ds_read_b64_tr_b16 v[90:91], v12 offset:49152
ds_read_b64_tr_b16 v[92:93], v13 offset:32768
v_mfma_f32_16x16x32_bf16 v[204:207], v[108:111], a[48:51], v[204:207]
v_exp_f32 v71, v71
v_mfma_f32_16x16x32_bf16 v[220:223], v[108:111], a[52:55], v[220:223]
ds_read_b64_tr_b16 v[94:95], v13 offset:49152
ds_read_b64_tr_b16 v[96:97], v10 offset:33792
v_mfma_f32_16x16x32_bf16 v[192:195], v[112:115], a[56:59], v[192:195]
ds_read_b64_tr_b16 v[98:99], v10 offset:50176
v_fma_f32 v68, v68, v62, v62
v_mfma_f32_16x16x32_bf16 v[208:211], v[112:115], a[60:63], v[208:211]
ds_read_b64_tr_b16 v[100:101], v11 offset:33792
ds_read_b64_tr_b16 v[102:103], v11 offset:50176
v_mfma_f32_16x16x32_bf16 v[196:199], v[116:119], a[56:59], v[196:199]
ds_read_b64_tr_b16 v[104:105], v12 offset:33792
v_fma_f32 v69, v69, v62, v62
v_mfma_f32_16x16x32_bf16 v[212:215], v[116:119], a[60:63], v[212:215]
ds_read_b64_tr_b16 v[106:107], v12 offset:50176
ds_read_b64_tr_b16 v[108:109], v13 offset:33792
v_mfma_f32_16x16x32_bf16 v[200:203], v[120:123], a[56:59], v[200:203]
ds_read_b64_tr_b16 v[110:111], v13 offset:50176
v_fma_f32 v70, v70, v62, v62
v_mfma_f32_16x16x32_bf16 v[216:219], v[120:123], a[60:63], v[216:219]
ds_read_b64_tr_b16 v[112:113], v10 offset:34816
ds_read_b64_tr_b16 v[114:115], v10 offset:51200
v_mfma_f32_16x16x32_bf16 v[204:207], v[124:127], a[56:59], v[204:207]
ds_read_b64_tr_b16 v[116:117], v11 offset:34816
v_fma_f32 v71, v71, v62, v62
v_mfma_f32_16x16x32_bf16 v[220:223], v[124:127], a[60:63], v[220:223]
ds_read_b64_tr_b16 v[118:119], v11 offset:51200
s_waitcnt lgkmcnt(8)
v_mfma_f32_16x16x32_bf16 v[192:195], v[80:83], a[64:67], v[192:195]
v_rcp_f32 v68, v68
v_mfma_f32_16x16x32_bf16 v[208:211], v[80:83], a[68:71], v[208:211]
ds_read_b64_tr_b16 v[120:121], v12 offset:34816
ds_read_b64_tr_b16 v[122:123], v12 offset:51200
v_mfma_f32_16x16x32_bf16 v[196:199], v[84:87], a[64:67], v[196:199]
v_rcp_f32 v69, v69
v_mfma_f32_16x16x32_bf16 v[212:215], v[84:87], a[68:71], v[212:215]
ds_read_b64_tr_b16 v[124:125], v13 offset:34816
ds_read_b64_tr_b16 v[126:127], v13 offset:51200
v_mfma_f32_16x16x32_bf16 v[200:203], v[88:91], a[64:67], v[200:203]
v_rcp_f32 v70, v70
v_mfma_f32_16x16x32_bf16 v[216:219], v[88:91], a[68:71], v[216:219]
ds_read_b64_tr_b16 v[80:81], v10 offset:35840
ds_read_b64_tr_b16 v[82:83], v10 offset:52224
v_mfma_f32_16x16x32_bf16 v[204:207], v[92:95], a[64:67], v[204:207]
v_rcp_f32 v71, v71
v_mfma_f32_16x16x32_bf16 v[220:223], v[92:95], a[68:71], v[220:223]
ds_read_b64_tr_b16 v[84:85], v11 offset:35840
ds_read_b64_tr_b16 v[86:87], v11 offset:52224
v_mfma_f32_16x16x32_bf16 v[192:195], v[96:99], a[72:75], v[192:195]
ds_read_b64_tr_b16 v[88:89], v12 offset:35840
v_mul_f32 v168, v168, v68
v_mfma_f32_16x16x32_bf16 v[208:211], v[96:99], a[76:79], v[208:211]
ds_read_b64_tr_b16 v[90:91], v12 offset:52224
v_mul_f32 v169, v169, v69
v_mfma_f32_16x16x32_bf16 v[196:199], v[100:103], a[72:75], v[196:199]
ds_read_b64_tr_b16 v[92:93], v13 offset:35840
v_mul_f32 v170, v170, v70
v_mfma_f32_16x16x32_bf16 v[212:215], v[100:103], a[76:79], v[212:215]
ds_read_b64_tr_b16 v[94:95], v13 offset:52224
s_waitcnt lgkmcnt(6)
v_mfma_f32_16x16x32_bf16 v[200:203], v[104:107], a[72:75], v[200:203]
ds_read_b64_tr_b16 v[96:97], v10 offset:36864
v_mul_f32 v171, v171, v71
v_mfma_f32_16x16x32_bf16 v[216:219], v[104:107], a[76:79], v[216:219]
ds_read_b64_tr_b16 v[98:99], v10 offset:53248
v_mul_f32 v72, v60, v172
v_mfma_f32_16x16x32_bf16 v[204:207], v[108:111], a[72:75], v[204:207]
ds_read_b64_tr_b16 v[100:101], v11 offset:36864
v_mul_f32 v73, v60, v173
v_mfma_f32_16x16x32_bf16 v[220:223], v[108:111], a[76:79], v[220:223]
ds_read_b64_tr_b16 v[102:103], v11 offset:53248
v_mul_f32 v74, v60, v174
v_mfma_f32_16x16x32_bf16 v[192:195], v[112:115], a[80:83], v[192:195]
ds_read_b64_tr_b16 v[104:105], v12 offset:36864
v_mul_f32 v75, v60, v175
v_mfma_f32_16x16x32_bf16 v[208:211], v[112:115], a[84:87], v[208:211]
v_exp_f32 v72, v72
v_mfma_f32_16x16x32_bf16 v[196:199], v[116:119], a[80:83], v[196:199]
ds_read_b64_tr_b16 v[106:107], v12 offset:53248
ds_read_b64_tr_b16 v[108:109], v13 offset:36864
v_mfma_f32_16x16x32_bf16 v[212:215], v[116:119], a[84:87], v[212:215]
v_exp_f32 v73, v73
v_mfma_f32_16x16x32_bf16 v[200:203], v[120:123], a[80:83], v[200:203]
ds_read_b64_tr_b16 v[110:111], v13 offset:53248
ds_read_b64_tr_b16 v[112:113], v10 offset:37888
v_mfma_f32_16x16x32_bf16 v[216:219], v[120:123], a[84:87], v[216:219]
v_exp_f32 v74, v74
v_mfma_f32_16x16x32_bf16 v[204:207], v[124:127], a[80:83], v[204:207]
ds_read_b64_tr_b16 v[114:115], v10 offset:54272
ds_read_b64_tr_b16 v[116:117], v11 offset:37888
v_mfma_f32_16x16x32_bf16 v[220:223], v[124:127], a[84:87], v[220:223]
v_exp_f32 v75, v75
v_mfma_f32_16x16x32_bf16 v[192:195], v[80:83], a[88:91], v[192:195]
ds_read_b64_tr_b16 v[118:119], v11 offset:54272
ds_read_b64_tr_b16 v[120:121], v12 offset:37888
v_mfma_f32_16x16x32_bf16 v[208:211], v[80:83], a[92:95], v[208:211]
ds_read_b64_tr_b16 v[122:123], v12 offset:54272
s_waitcnt lgkmcnt(7)
v_mfma_f32_16x16x32_bf16 v[196:199], v[84:87], a[88:91], v[196:199]
ds_read_b64_tr_b16 v[124:125], v13 offset:37888
v_fma_f32 v72, v72, v62, v62
v_mfma_f32_16x16x32_bf16 v[212:215], v[84:87], a[92:95], v[212:215]
ds_read_b64_tr_b16 v[126:127], v13 offset:54272
v_fma_f32 v73, v73, v62, v62
v_mfma_f32_16x16x32_bf16 v[200:203], v[88:91], a[88:91], v[200:203]
ds_read_b64_tr_b16 v[80:81], v10 offset:38912
v_fma_f32 v74, v74, v62, v62
v_mfma_f32_16x16x32_bf16 v[216:219], v[88:91], a[92:95], v[216:219]
ds_read_b64_tr_b16 v[82:83], v10 offset:55296
v_fma_f32 v75, v75, v62, v62
v_mfma_f32_16x16x32_bf16 v[204:207], v[92:95], a[88:91], v[204:207]
v_rcp_f32 v72, v72
v_mfma_f32_16x16x32_bf16 v[220:223], v[92:95], a[92:95], v[220:223]
ds_read_b64_tr_b16 v[84:85], v11 offset:38912
ds_read_b64_tr_b16 v[86:87], v11 offset:55296
v_mfma_f32_16x16x32_bf16 v[192:195], v[96:99], a[96:99], v[192:195]
v_rcp_f32 v73, v73
v_mfma_f32_16x16x32_bf16 v[208:211], v[96:99], a[100:103], v[208:211]
ds_read_b64_tr_b16 v[88:89], v12 offset:38912
ds_read_b64_tr_b16 v[90:91], v12 offset:55296
v_mfma_f32_16x16x32_bf16 v[196:199], v[100:103], a[96:99], v[196:199]
v_rcp_f32 v74, v74
v_mfma_f32_16x16x32_bf16 v[212:215], v[100:103], a[100:103], v[212:215]
ds_read_b64_tr_b16 v[92:93], v13 offset:38912
ds_read_b64_tr_b16 v[94:95], v13 offset:55296
v_mfma_f32_16x16x32_bf16 v[200:203], v[104:107], a[96:99], v[200:203]
v_rcp_f32 v75, v75
v_mfma_f32_16x16x32_bf16 v[216:219], v[104:107], a[100:103], v[216:219]
ds_read_b64_tr_b16 v[96:97], v10 offset:39936
s_waitcnt lgkmcnt(5)
v_mfma_f32_16x16x32_bf16 v[204:207], v[108:111], a[96:99], v[204:207]
ds_read_b64_tr_b16 v[98:99], v10 offset:56320
s_add_u32 m0, s76, 0
v_mfma_f32_16x16x32_bf16 v[220:223], v[108:111], a[100:103], v[220:223]
ds_read_b64_tr_b16 v[100:101], v11 offset:39936
s_add_u32 s77, s85, 0x540000
v_mfma_f32_16x16x32_bf16 v[192:195], v[112:115], a[104:107], v[192:195]
buffer_load_dwordx4 v34, s[52:55], s77 offen offset:0 lds
v_mfma_f32_16x16x32_bf16 v[208:211], v[112:115], a[108:111], v[208:211]
ds_read_b64_tr_b16 v[102:103], v11 offset:56320
ds_read_b64_tr_b16 v[104:105], v12 offset:39936
v_mfma_f32_16x16x32_bf16 v[196:199], v[116:119], a[104:107], v[196:199]
ds_read_b64_tr_b16 v[106:107], v12 offset:56320
v_mul_f32 v172, v172, v72
v_mfma_f32_16x16x32_bf16 v[212:215], v[116:119], a[108:111], v[212:215]
ds_read_b64_tr_b16 v[108:109], v13 offset:39936
ds_read_b64_tr_b16 v[110:111], v13 offset:56320
v_mfma_f32_16x16x32_bf16 v[200:203], v[120:123], a[104:107], v[200:203]
buffer_load_dwordx4 v35, s[52:55], s77 offen offset:1024 lds
v_mfma_f32_16x16x32_bf16 v[216:219], v[120:123], a[108:111], v[216:219]
v_mul_f32 v173, v173, v73
v_mul_f32 v174, v174, v74
v_mfma_f32_16x16x32_bf16 v[204:207], v[124:127], a[104:107], v[204:207]
v_mul_f32 v175, v175, v75
v_mul_f32 v68, v61, v176
v_mfma_f32_16x16x32_bf16 v[220:223], v[124:127], a[108:111], v[220:223]
v_mul_f32 v69, v61, v177
v_mul_f32 v70, v61, v178
v_mfma_f32_16x16x32_bf16 v[192:195], v[80:83], a[112:115], v[192:195]
s_waitcnt vmcnt(12) lgkmcnt(0)
s_barrier
v_mfma_f32_16x16x32_bf16 v[208:211], v[80:83], a[116:119], v[208:211]
ds_read_b64_tr_b16 v[112:113], v14 offset:0
ds_read_b64_tr_b16 v[114:115], v14 offset:16384
v_mfma_f32_16x16x32_bf16 v[196:199], v[84:87], a[112:115], v[196:199]
ds_read_b64_tr_b16 v[116:117], v15 offset:0
v_mul_f32 v71, v61, v179
v_mfma_f32_16x16x32_bf16 v[212:215], v[84:87], a[116:119], v[212:215]
ds_read_b64_tr_b16 v[118:119], v15 offset:16384
ds_read_b64_tr_b16 v[120:121], v16 offset:0
v_mfma_f32_16x16x32_bf16 v[200:203], v[88:91], a[112:115], v[200:203]
buffer_load_dwordx4 v36, s[52:55], s77 offen offset:2048 lds
v_mfma_f32_16x16x32_bf16 v[216:219], v[88:91], a[116:119], v[216:219]
ds_read_b64_tr_b16 v[122:123], v16 offset:16384
ds_read_b64_tr_b16 v[124:125], v17 offset:0
v_mfma_f32_16x16x32_bf16 v[204:207], v[92:95], a[112:115], v[204:207]
v_exp_f32 v68, v68
v_mfma_f32_16x16x32_bf16 v[220:223], v[92:95], a[116:119], v[220:223]
ds_read_b64_tr_b16 v[126:127], v17 offset:16384
ds_read_b64_tr_b16 v[80:81], v14 offset:1024
v_mfma_f32_16x16x32_bf16 v[192:195], v[96:99], a[120:123], v[192:195]
buffer_load_dwordx4 v37, s[52:55], s77 offen offset:3072 lds
v_mfma_f32_16x16x32_bf16 v[208:211], v[96:99], a[124:127], v[208:211]
ds_read_b64_tr_b16 v[82:83], v14 offset:17408
ds_read_b64_tr_b16 v[84:85], v15 offset:1024
v_mfma_f32_16x16x32_bf16 v[196:199], v[100:103], a[120:123], v[196:199]
v_exp_f32 v69, v69
v_mfma_f32_16x16x32_bf16 v[212:215], v[100:103], a[124:127], v[212:215]
ds_read_b64_tr_b16 v[86:87], v15 offset:17408
ds_read_b64_tr_b16 v[88:89], v16 offset:1024
v_mfma_f32_16x16x32_bf16 v[200:203], v[104:107], a[120:123], v[200:203]
v_exp_f32 v70, v70
v_mfma_f32_16x16x32_bf16 v[216:219], v[104:107], a[124:127], v[216:219]
ds_read_b64_tr_b16 v[90:91], v16 offset:17408
ds_read_b64_tr_b16 v[92:93], v17 offset:1024
v_mfma_f32_16x16x32_bf16 v[204:207], v[108:111], a[120:123], v[204:207]
v_exp_f32 v71, v71
v_mfma_f32_16x16x32_bf16 v[220:223], v[108:111], a[124:127], v[220:223]
ds_read_b64_tr_b16 v[94:95], v17 offset:17408
s_waitcnt lgkmcnt(5)
v_mfma_f32_16x16x32_bf16 v[192:195], v[112:115], a[128:131], v[192:195]
ds_read_b64_tr_b16 v[96:97], v14 offset:2048
s_add_u32 m0, s76, 4096
v_mfma_f32_16x16x32_bf16 v[208:211], v[112:115], a[132:135], v[208:211]
ds_read_b64_tr_b16 v[98:99], v14 offset:18432
s_add_u32 s77, s85, 0x620000
v_mfma_f32_16x16x32_bf16 v[196:199], v[116:119], a[128:131], v[196:199]
ds_read_b64_tr_b16 v[100:101], v15 offset:2048
ds_read_b64_tr_b16 v[102:103], v15 offset:18432
v_mfma_f32_16x16x32_bf16 v[212:215], v[116:119], a[132:135], v[212:215]
buffer_load_dwordx4 v34, s[52:55], s77 offen offset:0 lds
v_mfma_f32_16x16x32_bf16 v[200:203], v[120:123], a[128:131], v[200:203]
ds_read_b64_tr_b16 v[104:105], v16 offset:2048
ds_read_b64_tr_b16 v[106:107], v16 offset:18432
v_mfma_f32_16x16x32_bf16 v[216:219], v[120:123], a[132:135], v[216:219]
ds_read_b64_tr_b16 v[108:109], v17 offset:2048
v_fma_f32 v68, v68, v63, v63
v_mfma_f32_16x16x32_bf16 v[204:207], v[124:127], a[128:131], v[204:207]
ds_read_b64_tr_b16 v[110:111], v17 offset:18432
ds_read_b64_tr_b16 v[112:113], v14 offset:3072
v_mfma_f32_16x16x32_bf16 v[220:223], v[124:127], a[132:135], v[220:223]
buffer_load_dwordx4 v35, s[52:55], s77 offen offset:1024 lds
v_mfma_f32_16x16x32_bf16 v[192:195], v[80:83], a[136:139], v[192:195]
ds_read_b64_tr_b16 v[114:115], v14 offset:19456
ds_read_b64_tr_b16 v[116:117], v15 offset:3072
v_mfma_f32_16x16x32_bf16 v[208:211], v[80:83], a[140:143], v[208:211]
ds_read_b64_tr_b16 v[118:119], v15 offset:19456
s_waitcnt lgkmcnt(8)
v_mfma_f32_16x16x32_bf16 v[196:199], v[84:87], a[136:139], v[196:199]
ds_read_b64_tr_b16 v[120:121], v16 offset:3072
ds_read_b64_tr_b16 v[122:123], v16 offset:19456
v_mfma_f32_16x16x32_bf16 v[212:215], v[84:87], a[140:143], v[212:215]
buffer_load_dwordx4 v36, s[52:55], s77 offen offset:2048 lds
v_mfma_f32_16x16x32_bf16 v[200:203], v[88:91], a[136:139], v[200:203]
ds_read_b64_tr_b16 v[124:125], v17 offset:3072
ds_read_b64_tr_b16 v[126:127], v17 offset:19456
v_mfma_f32_16x16x32_bf16 v[216:219], v[88:91], a[140:143], v[216:219]
ds_read_b64_tr_b16 v[80:81], v14 offset:4096
v_fma_f32 v69, v69, v63, v63
v_mfma_f32_16x16x32_bf16 v[204:207], v[92:95], a[136:139], v[204:207]
ds_read_b64_tr_b16 v[82:83], v14 offset:20480
ds_read_b64_tr_b16 v[84:85], v15 offset:4096
v_mfma_f32_16x16x32_bf16 v[220:223], v[92:95], a[140:143], v[220:223]
buffer_load_dwordx4 v37, s[52:55], s77 offen offset:3072 lds
v_mfma_f32_16x16x32_bf16 v[192:195], v[96:99], a[144:147], v[192:195]
ds_read_b64_tr_b16 v[86:87], v15 offset:20480
ds_read_b64_tr_b16 v[88:89], v16 offset:4096
v_mfma_f32_16x16x32_bf16 v[208:211], v[96:99], a[148:151], v[208:211]
ds_read_b64_tr_b16 v[90:91], v16 offset:20480
s_add_u32 m0, s76, 32768
v_mfma_f32_16x16x32_bf16 v[196:199], v[100:103], a[144:147], v[196:199]
ds_read_b64_tr_b16 v[92:93], v17 offset:4096
s_add_u32 s77, s25, 0x0
v_mfma_f32_16x16x32_bf16 v[212:215], v[100:103], a[148:151], v[212:215]
ds_read_b64_tr_b16 v[94:95], v17 offset:20480
s_waitcnt lgkmcnt(7)
v_mfma_f32_16x16x32_bf16 v[200:203], v[104:107], a[144:147], v[200:203]
buffer_load_dwordx4 v30, s[40:43], s77 offen offset:0 lds
v_mfma_f32_16x16x32_bf16 v[216:219], v[104:107], a[148:151], v[216:219]
ds_read_b64_tr_b16 v[96:97], v14 offset:5120
ds_read_b64_tr_b16 v[98:99], v14 offset:21504
v_mfma_f32_16x16x32_bf16 v[204:207], v[108:111], a[144:147], v[204:207]
ds_read_b64_tr_b16 v[100:101], v15 offset:5120
v_fma_f32 v70, v70, v63, v63
v_mfma_f32_16x16x32_bf16 v[220:223], v[108:111], a[148:151], v[220:223]
ds_read_b64_tr_b16 v[102:103], v15 offset:21504
v_fma_f32 v71, v71, v63, v63
v_mfma_f32_16x16x32_bf16 v[192:195], v[112:115], a[152:155], v[192:195]
buffer_load_dwordx4 v31, s[40:43], s77 offen offset:1024 lds
v_mfma_f32_16x16x32_bf16 v[208:211], v[112:115], a[156:159], v[208:211]
ds_read_b64_tr_b16 v[104:105], v16 offset:5120
ds_read_b64_tr_b16 v[106:107], v16 offset:21504
v_mfma_f32_16x16x32_bf16 v[196:199], v[116:119], a[152:155], v[196:199]
v_rcp_f32 v68, v68
v_mfma_f32_16x16x32_bf16 v[212:215], v[116:119], a[156:159], v[212:215]
ds_read_b64_tr_b16 v[108:109], v17 offset:5120
ds_read_b64_tr_b16 v[110:111], v17 offset:21504
v_mfma_f32_16x16x32_bf16 v[200:203], v[120:123], a[152:155], v[200:203]
buffer_load_dwordx4 v32, s[40:43], s77 offen offset:2048 lds
v_mfma_f32_16x16x32_bf16 v[216:219], v[120:123], a[156:159], v[216:219]
ds_read_b64_tr_b16 v[112:113], v14 offset:6144
ds_read_b64_tr_b16 v[114:115], v14 offset:22528
v_mfma_f32_16x16x32_bf16 v[204:207], v[124:127], a[152:155], v[204:207]
v_rcp_f32 v69, v69
v_mfma_f32_16x16x32_bf16 v[220:223], v[124:127], a[156:159], v[220:223]
ds_read_b64_tr_b16 v[116:117], v15 offset:6144
s_waitcnt lgkmcnt(5)
v_mfma_f32_16x16x32_bf16 v[192:195], v[80:83], a[160:163], v[192:195]
buffer_load_dwordx4 v33, s[40:43], s77 offen offset:3072 lds
v_mfma_f32_16x16x32_bf16 v[208:211], v[80:83], a[164:167], v[208:211]
ds_read_b64_tr_b16 v[118:119], v15 offset:22528
ds_read_b64_tr_b16 v[120:121], v16 offset:6144
v_mfma_f32_16x16x32_bf16 v[196:199], v[84:87], a[160:163], v[196:199]
v_rcp_f32 v70, v70
v_mfma_f32_16x16x32_bf16 v[212:215], v[84:87], a[164:167], v[212:215]
ds_read_b64_tr_b16 v[122:123], v16 offset:22528
ds_read_b64_tr_b16 v[124:125], v17 offset:6144
v_mfma_f32_16x16x32_bf16 v[200:203], v[88:91], a[160:163], v[200:203]
v_rcp_f32 v71, v71
v_mfma_f32_16x16x32_bf16 v[216:219], v[88:91], a[164:167], v[216:219]
ds_read_b64_tr_b16 v[126:127], v17 offset:22528
ds_read_b64_tr_b16 v[80:81], v14 offset:7168
v_mfma_f32_16x16x32_bf16 v[204:207], v[92:95], a[160:163], v[204:207]
ds_read_b64_tr_b16 v[82:83], v14 offset:23552
s_add_u32 m0, s76, 36864
v_mfma_f32_16x16x32_bf16 v[220:223], v[92:95], a[164:167], v[220:223]
ds_read_b64_tr_b16 v[84:85], v15 offset:7168
s_add_u32 s77, s25, 0xe0000
v_mfma_f32_16x16x32_bf16 v[192:195], v[96:99], a[168:171], v[192:195]
buffer_load_dwordx4 v30, s[40:43], s77 offen offset:0 lds
v_mfma_f32_16x16x32_bf16 v[208:211], v[96:99], a[172:175], v[208:211]
ds_read_b64_tr_b16 v[86:87], v15 offset:23552
ds_read_b64_tr_b16 v[88:89], v16 offset:7168
v_mfma_f32_16x16x32_bf16 v[196:199], v[100:103], a[168:171], v[196:199]
ds_read_b64_tr_b16 v[90:91], v16 offset:23552
v_mul_f32 v176, v176, v68
v_mfma_f32_16x16x32_bf16 v[212:215], v[100:103], a[172:175], v[212:215]
ds_read_b64_tr_b16 v[92:93], v17 offset:7168
ds_read_b64_tr_b16 v[94:95], v17 offset:23552
v_mfma_f32_16x16x32_bf16 v[200:203], v[104:107], a[168:171], v[200:203]
buffer_load_dwordx4 v31, s[40:43], s77 offen offset:1024 lds
v_mfma_f32_16x16x32_bf16 v[216:219], v[104:107], a[172:175], v[216:219]
v_mul_f32 v177, v177, v69
s_waitcnt lgkmcnt(5)
v_mfma_f32_16x16x32_bf16 v[204:207], v[108:111], a[168:171], v[204:207]
v_mul_f32 v178, v178, v70
v_mul_f32 v179, v179, v71
v_mfma_f32_16x16x32_bf16 v[220:223], v[108:111], a[172:175], v[220:223]
v_mul_f32 v72, v61, v180
v_mul_f32 v73, v61, v181
v_mfma_f32_16x16x32_bf16 v[192:195], v[112:115], a[176:179], v[192:195]
s_waitcnt vmcnt(14) lgkmcnt(0)
s_barrier
v_mfma_f32_16x16x32_bf16 v[208:211], v[112:115], a[180:183], v[208:211]
ds_read_b64_tr_b16 v[96:97], v14 offset:32768
ds_read_b64_tr_b16 v[98:99], v14 offset:49152
v_mfma_f32_16x16x32_bf16 v[196:199], v[116:119], a[176:179], v[196:199]
ds_read_b64_tr_b16 v[100:101], v15 offset:32768
v_mul_f32 v74, v61, v182
v_mfma_f32_16x16x32_bf16 v[212:215], v[116:119], a[180:183], v[212:215]
ds_read_b64_tr_b16 v[102:103], v15 offset:49152
ds_read_b64_tr_b16 v[104:105], v16 offset:32768
v_mfma_f32_16x16x32_bf16 v[200:203], v[120:123], a[176:179], v[200:203]
buffer_load_dwordx4 v32, s[40:43], s77 offen offset:2048 lds
v_mfma_f32_16x16x32_bf16 v[216:219], v[120:123], a[180:183], v[216:219]
ds_read_b64_tr_b16 v[106:107], v16 offset:49152
ds_read_b64_tr_b16 v[108:109], v17 offset:32768
v_mfma_f32_16x16x32_bf16 v[204:207], v[124:127], a[176:179], v[204:207]
ds_read_b64_tr_b16 v[110:111], v17 offset:49152
v_mul_f32 v75, v61, v183
v_mfma_f32_16x16x32_bf16 v[220:223], v[124:127], a[180:183], v[220:223]
v_exp_f32 v72, v72
v_mfma_f32_16x16x32_bf16 v[192:195], v[80:83], a[184:187], v[192:195]
ds_read_b64_tr_b16 v[112:113], v14 offset:33792
ds_read_b64_tr_b16 v[114:115], v14 offset:50176
v_mfma_f32_16x16x32_bf16 v[208:211], v[80:83], a[188:191], v[208:211]
buffer_load_dwordx4 v33, s[40:43], s77 offen offset:3072 lds
v_mfma_f32_16x16x32_bf16 v[196:199], v[84:87], a[184:187], v[196:199]
ds_read_b64_tr_b16 v[116:117], v15 offset:33792
ds_read_b64_tr_b16 v[118:119], v15 offset:50176
v_mfma_f32_16x16x32_bf16 v[212:215], v[84:87], a[188:191], v[212:215]
v_exp_f32 v73, v73
v_mfma_f32_16x16x32_bf16 v[200:203], v[88:91], a[184:187], v[200:203]
ds_read_b64_tr_b16 v[120:121], v16 offset:33792
ds_read_b64_tr_b16 v[122:123], v16 offset:50176
v_mfma_f32_16x16x32_bf16 v[216:219], v[88:91], a[188:191], v[216:219]
v_exp_f32 v74, v74
v_mfma_f32_16x16x32_bf16 v[204:207], v[92:95], a[184:187], v[204:207]
ds_read_b64_tr_b16 v[124:125], v17 offset:33792
ds_read_b64_tr_b16 v[126:127], v17 offset:50176
v_mfma_f32_16x16x32_bf16 v[220:223], v[92:95], a[188:191], v[220:223]
ds_read_b64_tr_b16 v[80:81], v14 offset:34816
s_waitcnt lgkmcnt(7)
v_mfma_f32_16x16x32_bf16 v[192:195], v[96:99], a[192:195], v[192:195]
v_exp_f32 v75, v75
v_mfma_f32_16x16x32_bf16 v[208:211], v[96:99], a[196:199], v[208:211]
ds_read_b64_tr_b16 v[82:83], v14 offset:51200
ds_read_b64_tr_b16 v[84:85], v15 offset:34816
v_mfma_f32_16x16x32_bf16 v[196:199], v[100:103], a[192:195], v[196:199]
ds_read_b64_tr_b16 v[86:87], v15 offset:51200
s_add_u32 m0, s76, 65536
v_mfma_f32_16x16x32_bf16 v[212:215], v[100:103], a[196:199], v[212:215]
ds_read_b64_tr_b16 v[88:89], v16 offset:34816
s_add_u32 s77, s25, 0x1c0000
v_mfma_f32_16x16x32_bf16 v[200:203], v[104:107], a[192:195], v[200:203]
buffer_load_dwordx4 v30, s[40:43], s77 offen offset:0 lds
v_mfma_f32_16x16x32_bf16 v[216:219], v[104:107], a[196:199], v[216:219]
ds_read_b64_tr_b16 v[90:91], v16 offset:51200
ds_read_b64_tr_b16 v[92:93], v17 offset:34816
v_mfma_f32_16x16x32_bf16 v[204:207], v[108:111], a[192:195], v[204:207]
ds_read_b64_tr_b16 v[94:95], v17 offset:51200
v_fma_f32 v72, v72, v63, v63
v_mfma_f32_16x16x32_bf16 v[220:223], v[108:111], a[196:199], v[220:223]
ds_read_b64_tr_b16 v[96:97], v14 offset:35840
ds_read_b64_tr_b16 v[98:99], v14 offset:52224
v_mfma_f32_16x16x32_bf16 v[192:195], v[112:115], a[200:203], v[192:195]
buffer_load_dwordx4 v31, s[40:43], s77 offen offset:1024 lds
v_mfma_f32_16x16x32_bf16 v[208:211], v[112:115], a[204:207], v[208:211]
ds_read_b64_tr_b16 v[100:101], v15 offset:35840
s_waitcnt lgkmcnt(6)
v_mfma_f32_16x16x32_bf16 v[196:199], v[116:119], a[200:203], v[196:199]
ds_read_b64_tr_b16 v[102:103], v15 offset:52224
ds_read_b64_tr_b16 v[104:105], v16 offset:35840
v_mfma_f32_16x16x32_bf16 v[212:215], v[116:119], a[204:207], v[212:215]
ds_read_b64_tr_b16 v[106:107], v16 offset:52224
v_fma_f32 v73, v73, v63, v63
v_mfma_f32_16x16x32_bf16 v[200:203], v[120:123], a[200:203], v[200:203]
buffer_load_dwordx4 v32, s[40:43], s77 offen offset:2048 lds
v_mfma_f32_16x16x32_bf16 v[216:219], v[120:123], a[204:207], v[216:219]
ds_read_b64_tr_b16 v[108:109], v17 offset:35840
ds_read_b64_tr_b16 v[110:111], v17 offset:52224
v_mfma_f32_16x16x32_bf16 v[204:207], v[124:127], a[200:203], v[204:207]
ds_read_b64_tr_b16 v[112:113], v14 offset:36864
v_fma_f32 v74, v74, v63, v63
v_mfma_f32_16x16x32_bf16 v[220:223], v[124:127], a[204:207], v[220:223]
ds_read_b64_tr_b16 v[114:115], v14 offset:53248
ds_read_b64_tr_b16 v[116:117], v15 offset:36864
v_mfma_f32_16x16x32_bf16 v[192:195], v[80:83], a[208:211], v[192:195]
buffer_load_dwordx4 v33, s[40:43], s77 offen offset:3072 lds
v_mfma_f32_16x16x32_bf16 v[208:211], v[80:83], a[212:215], v[208:211]
ds_read_b64_tr_b16 v[118:119], v15 offset:53248
ds_read_b64_tr_b16 v[120:121], v16 offset:36864
v_mfma_f32_16x16x32_bf16 v[196:199], v[84:87], a[208:211], v[196:199]
ds_read_b64_tr_b16 v[122:123], v16 offset:53248
s_add_u32 m0, s76, 69632
v_mfma_f32_16x16x32_bf16 v[212:215], v[84:87], a[212:215], v[212:215]
ds_read_b64_tr_b16 v[124:125], v17 offset:36864
s_waitcnt lgkmcnt(7)
v_mfma_f32_16x16x32_bf16 v[200:203], v[88:91], a[208:211], v[200:203]
ds_read_b64_tr_b16 v[126:127], v17 offset:53248
s_add_u32 s77, s25, 0x2a0000
v_mfma_f32_16x16x32_bf16 v[216:219], v[88:91], a[212:215], v[216:219]
buffer_load_dwordx4 v30, s[40:43], s77 offen offset:0 lds
v_mfma_f32_16x16x32_bf16 v[204:207], v[92:95], a[208:211], v[204:207]
ds_read_b64_tr_b16 v[80:81], v14 offset:37888
ds_read_b64_tr_b16 v[82:83], v14 offset:54272
v_mfma_f32_16x16x32_bf16 v[220:223], v[92:95], a[212:215], v[220:223]
ds_read_b64_tr_b16 v[84:85], v15 offset:37888
v_fma_f32 v75, v75, v63, v63
v_mfma_f32_16x16x32_bf16 v[192:195], v[96:99], a[216:219], v[192:195]
v_rcp_f32 v72, v72
v_mfma_f32_16x16x32_bf16 v[208:211], v[96:99], a[220:223], v[208:211]
ds_read_b64_tr_b16 v[86:87], v15 offset:54272
ds_read_b64_tr_b16 v[88:89], v16 offset:37888
v_mfma_f32_16x16x32_bf16 v[196:199], v[100:103], a[216:219], v[196:199]
buffer_load_dwordx4 v31, s[40:43], s77 offen offset:1024 lds
v_mfma_f32_16x16x32_bf16 v[212:215], v[100:103], a[220:223], v[212:215]
ds_read_b64_tr_b16 v[90:91], v16 offset:54272
ds_read_b64_tr_b16 v[92:93], v17 offset:37888
v_mfma_f32_16x16x32_bf16 v[200:203], v[104:107], a[216:219], v[200:203]
v_rcp_f32 v73, v73
v_mfma_f32_16x16x32_bf16 v[216:219], v[104:107], a[220:223], v[216:219]
ds_read_b64_tr_b16 v[94:95], v17 offset:54272
ds_read_b64_tr_b16 v[96:97], v14 offset:38912
v_mfma_f32_16x16x32_bf16 v[204:207], v[108:111], a[216:219], v[204:207]
buffer_load_dwordx4 v32, s[40:43], s77 offen offset:2048 lds
v_mfma_f32_16x16x32_bf16 v[220:223], v[108:111], a[220:223], v[220:223]
ds_read_b64_tr_b16 v[98:99], v14 offset:55296
s_waitcnt lgkmcnt(5)
v_mfma_f32_16x16x32_bf16 v[192:195], v[112:115], a[224:227], v[192:195]
v_rcp_f32 v74, v74
v_mfma_f32_16x16x32_bf16 v[208:211], v[112:115], a[228:231], v[208:211]
ds_read_b64_tr_b16 v[100:101], v15 offset:38912
ds_read_b64_tr_b16 v[102:103], v15 offset:55296
v_mfma_f32_16x16x32_bf16 v[196:199], v[116:119], a[224:227], v[196:199]
buffer_load_dwordx4 v33, s[40:43], s77 offen offset:3072 lds
v_mfma_f32_16x16x32_bf16 v[212:215], v[116:119], a[228:231], v[212:215]
ds_read_b64_tr_b16 v[104:105], v16 offset:38912
ds_read_b64_tr_b16 v[106:107], v16 offset:55296
v_mfma_f32_16x16x32_bf16 v[200:203], v[120:123], a[224:227], v[200:203]
v_rcp_f32 v75, v75
v_mfma_f32_16x16x32_bf16 v[216:219], v[120:123], a[228:231], v[216:219]
ds_read_b64_tr_b16 v[108:109], v17 offset:38912
ds_read_b64_tr_b16 v[110:111], v17 offset:55296
v_mfma_f32_16x16x32_bf16 v[204:207], v[124:127], a[224:227], v[204:207]
ds_read_b64_tr_b16 v[112:113], v14 offset:39936
v_mul_f32 v180, v180, v72
v_mfma_f32_16x16x32_bf16 v[220:223], v[124:127], a[228:231], v[220:223]
ds_read_b64_tr_b16 v[114:115], v14 offset:56320
ds_read_b64_tr_b16 v[116:117], v15 offset:39936
v_mfma_f32_16x16x32_bf16 v[192:195], v[80:83], a[232:235], v[192:195]
ds_read_b64_tr_b16 v[118:119], v15 offset:56320
v_mul_f32 v181, v181, v73
v_mfma_f32_16x16x32_bf16 v[208:211], v[80:83], a[236:239], v[208:211]
ds_read_b64_tr_b16 v[120:121], v16 offset:39936
ds_read_b64_tr_b16 v[122:123], v16 offset:56320
v_mfma_f32_16x16x32_bf16 v[196:199], v[84:87], a[232:235], v[196:199]
ds_read_b64_tr_b16 v[124:125], v17 offset:39936
v_mul_f32 v182, v182, v74
v_mfma_f32_16x16x32_bf16 v[212:215], v[84:87], a[236:239], v[212:215]
ds_read_b64_tr_b16 v[126:127], v17 offset:56320
s_waitcnt lgkmcnt(8)
v_mfma_f32_16x16x32_bf16 v[200:203], v[88:91], a[232:235], v[200:203]
v_mul_f32 v183, v183, v75
v_mul_f32 v68, v61, v184
v_mfma_f32_16x16x32_bf16 v[216:219], v[88:91], a[236:239], v[216:219]
v_mul_f32 v69, v61, v185
v_mul_f32 v70, v61, v186
v_mfma_f32_16x16x32_bf16 v[204:207], v[92:95], a[232:235], v[204:207]
v_mul_f32 v71, v61, v187
v_mfma_f32_16x16x32_bf16 v[220:223], v[92:95], a[236:239], v[220:223]
v_exp_f32 v68, v68
v_mfma_f32_16x16x32_bf16 v[192:195], v[96:99], a[240:243], v[192:195]
s_waitcnt vmcnt(16) lgkmcnt(0)
s_barrier
v_mfma_f32_16x16x32_bf16 v[208:211], v[96:99], a[244:247], v[208:211]
ds_read_b64_tr_b16 v[80:81], v18 offset:0
ds_read_b64_tr_b16 v[82:83], v18 offset:8192
v_mfma_f32_16x16x32_bf16 v[196:199], v[100:103], a[240:243], v[196:199]
ds_read_b64_tr_b16 v[84:85], v19 offset:0
s_add_u32 m0, s76, 98304
v_mfma_f32_16x16x32_bf16 v[212:215], v[100:103], a[244:247], v[212:215]
ds_read_b64_tr_b16 v[86:87], v19 offset:8192
s_add_u32 s77, s25, 0x380000
v_mfma_f32_16x16x32_bf16 v[200:203], v[104:107], a[240:243], v[200:203]
ds_read_b64_tr_b16 v[88:89], v18 offset:16384
ds_read_b64_tr_b16 v[90:91], v18 offset:24576
v_mfma_f32_16x16x32_bf16 v[216:219], v[104:107], a[244:247], v[216:219]
buffer_load_dwordx4 v30, s[40:43], s77 offen offset:0 lds
v_mfma_f32_16x16x32_bf16 v[204:207], v[108:111], a[240:243], v[204:207]
ds_read_b64_tr_b16 v[92:93], v19 offset:16384
ds_read_b64_tr_b16 v[94:95], v19 offset:24576
v_mfma_f32_16x16x32_bf16 v[220:223], v[108:111], a[244:247], v[220:223]
v_exp_f32 v69, v69
v_mfma_f32_16x16x32_bf16 v[192:195], v[112:115], a[248:251], v[192:195]
ds_read_b64_tr_b16 v[96:97], v18 offset:1024
ds_read_b64_tr_b16 v[98:99], v18 offset:9216
v_mfma_f32_16x16x32_bf16 v[208:211], v[112:115], a[252:255], v[208:211]
v_exp_f32 v70, v70
v_mfma_f32_16x16x32_bf16 v[196:199], v[116:119], a[248:251], v[196:199]
ds_read_b64_tr_b16 v[100:101], v19 offset:1024
ds_read_b64_tr_b16 v[102:103], v19 offset:9216
v_mfma_f32_16x16x32_bf16 v[212:215], v[116:119], a[252:255], v[212:215]
buffer_load_dwordx4 v31, s[40:43], s77 offen offset:1024 lds
v_mfma_f32_16x16x32_bf16 v[200:203], v[120:123], a[248:251], v[200:203]
ds_read_b64_tr_b16 v[104:105], v18 offset:17408
ds_read_b64_tr_b16 v[106:107], v18 offset:25600
v_mfma_f32_16x16x32_bf16 v[216:219], v[120:123], a[252:255], v[216:219]
v_exp_f32 v71, v71
v_mfma_f32_16x16x32_bf16 v[204:207], v[124:127], a[248:251], v[204:207]
ds_read_b64_tr_b16 v[108:109], v19 offset:17408
ds_read_b64_tr_b16 v[110:111], v19 offset:25600
v_mfma_f32_16x16x32_bf16 v[220:223], v[124:127], a[252:255], v[220:223]
ds_read_b64_tr_b16 v[112:113], v18 offset:2048
v_fma_f32 v68, v68, v63, v63
S_H3:
s_waitcnt lgkmcnt(7)
v_mfma_f32_16x16x32_bf16 v[224:227], v[80:83], a[192:195], v[224:227]
ds_read_b64_tr_b16 v[114:115], v18 offset:10240
ds_read_b64_tr_b16 v[116:117], v19 offset:2048
ds_read_b64_tr_b16 v[118:119], v19 offset:10240
v_mfma_f32_16x16x32_bf16 v[240:243], v[80:83], a[196:199], v[240:243]
buffer_load_dwordx4 v32, s[40:43], s77 offen offset:2048 lds
ds_read_b64_tr_b16 v[120:121], v18 offset:18432
v_mfma_f32_16x16x32_bf16 v[228:231], v[84:87], a[192:195], v[228:231]
ds_read_b64_tr_b16 v[122:123], v18 offset:26624
ds_read_b64_tr_b16 v[124:125], v19 offset:18432
v_fma_f32 v69, v69, v63, v63
v_mfma_f32_16x16x32_bf16 v[244:247], v[84:87], a[196:199], v[244:247]
s_add_u32 s70, s0, S_U2 - K_pc + 0
s_addc_u32 s71, s1, 0
global_load_dword v57, v9, s[70:71]
v_mfma_f32_16x16x32_bf16 v[232:235], v[88:91], a[192:195], v[232:235]
ds_read_b64_tr_b16 v[126:127], v19 offset:26624
ds_read_b64_tr_b16 v[80:81], v18 offset:3072
v_fma_f32 v70, v70, v63, v63
v_mfma_f32_16x16x32_bf16 v[248:251], v[88:91], a[196:199], v[248:251]
ds_read_b64_tr_b16 v[82:83], v18 offset:11264
v_fma_f32 v71, v71, v63, v63
v_mfma_f32_16x16x32_bf16 v[236:239], v[92:95], a[192:195], v[236:239]
v_rcp_f32 v68, v68
ds_read_b64_tr_b16 v[84:85], v19 offset:3072
v_mfma_f32_16x16x32_bf16 v[252:255], v[92:95], a[196:199], v[252:255]
buffer_load_dwordx4 v33, s[40:43], s77 offen offset:3072 lds
ds_read_b64_tr_b16 v[86:87], v19 offset:11264
v_mfma_f32_16x16x32_bf16 v[224:227], v[96:99], a[200:203], v[224:227]
v_rcp_f32 v69, v69
ds_read_b64_tr_b16 v[88:89], v18 offset:19456
v_mfma_f32_16x16x32_bf16 v[240:243], v[96:99], a[204:207], v[240:243]
v_rcp_f32 v70, v70
s_waitcnt lgkmcnt(6)
v_mfma_f32_16x16x32_bf16 v[228:231], v[100:103], a[200:203], v[228:231]
ds_read_b64_tr_b16 v[90:91], v18 offset:27648
ds_read_b64_tr_b16 v[92:93], v19 offset:19456
s_add_u32 m0, s76, 102400
v_mfma_f32_16x16x32_bf16 v[244:247], v[100:103], a[204:207], v[244:247]
v_rcp_f32 v71, v71
s_add_u32 s77, s25, 0x460000
v_mfma_f32_16x16x32_bf16 v[232:235], v[104:107], a[200:203], v[232:235]
ds_read_b64_tr_b16 v[94:95], v19 offset:27648
ds_read_b64_tr_b16 v[96:97], v18 offset:4096
v_mul_f32 v184, v184, v68
v_mfma_f32_16x16x32_bf16 v[248:251], v[104:107], a[204:207], v[248:251]
buffer_load_dwordx4 v30, s[40:43], s77 offen offset:0 lds
ds_read_b64_tr_b16 v[98:99], v18 offset:12288
v_mfma_f32_16x16x32_bf16 v[236:239], v[108:111], a[200:203], v[236:239]
ds_read_b64_tr_b16 v[100:101], v19 offset:4096
v_mul_f32 v185, v185, v69
v_mul_f32 v186, v186, v70
v_mfma_f32_16x16x32_bf16 v[252:255], v[108:111], a[204:207], v[252:255]
ds_read_b64_tr_b16 v[102:103], v19 offset:12288
v_mul_f32 v187, v187, v71
v_mul_f32 v72, v61, v188
v_mfma_f32_16x16x32_bf16 v[224:227], v[112:115], a[208:211], v[224:227]
ds_read_b64_tr_b16 v[104:105], v18 offset:20480
v_mul_f32 v73, v61, v189
v_mul_f32 v74, v61, v190
v_mfma_f32_16x16x32_bf16 v[240:243], v[112:115], a[212:215], v[240:243]
ds_read_b64_tr_b16 v[106:107], v18 offset:28672
v_mul_f32 v75, v61, v191
ds_read_b64_tr_b16 v[108:109], v19 offset:20480
v_mfma_f32_16x16x32_bf16 v[228:231], v[116:119], a[208:211], v[228:231]
v_exp_f32 v72, v72
ds_read_b64_tr_b16 v[110:111], v19 offset:28672
v_mfma_f32_16x16x32_bf16 v[244:247], v[116:119], a[212:215], v[244:247]
buffer_load_dwordx4 v31, s[40:43], s77 offen offset:1024 lds
ds_read_b64_tr_b16 v[112:113], v18 offset:5120
v_mfma_f32_16x16x32_bf16 v[232:235], v[120:123], a[208:211], v[232:235]
v_exp_f32 v73, v73
ds_read_b64_tr_b16 v[114:115], v18 offset:13312
v_mfma_f32_16x16x32_bf16 v[248:251], v[120:123], a[212:215], v[248:251]
v_exp_f32 v74, v74
s_waitcnt lgkmcnt(6)
v_mfma_f32_16x16x32_bf16 v[236:239], v[124:127], a[208:211], v[236:239]
ds_read_b64_tr_b16 v[116:117], v19 offset:5120
v_exp_f32 v75, v75
v_mfma_f32_16x16x32_bf16 v[252:255], v[124:127], a[212:215], v[252:255]
ds_read_b64_tr_b16 v[118:119], v19 offset:13312
v_fma_f32 v72, v72, v63, v63
v_fma_f32 v73, v73, v63, v63
v_mfma_f32_16x16x32_bf16 v[224:227], v[80:83], a[216:219], v[224:227]
ds_read_b64_tr_b16 v[120:121], v18 offset:21504
v_fma_f32 v74, v74, v63, v63
v_fma_f32 v75, v75, v63, v63
v_mfma_f32_16x16x32_bf16 v[240:243], v[80:83], a[220:223], v[240:243]
buffer_load_dwordx4 v32, s[40:43], s77 offen offset:2048 lds
ds_read_b64_tr_b16 v[122:123], v18 offset:29696
v_mfma_f32_16x16x32_bf16 v[228:231], v[84:87], a[216:219], v[228:231]
v_rcp_f32 v72, v72
ds_read_b64_tr_b16 v[124:125], v19 offset:21504
v_mfma_f32_16x16x32_bf16 v[244:247], v[84:87], a[220:223], v[244:247]
v_rcp_f32 v73, v73
ds_read_b64_tr_b16 v[126:127], v19 offset:29696
v_mfma_f32_16x16x32_bf16 v[232:235], v[88:91], a[216:219], v[232:235]
v_rcp_f32 v74, v74
ds_read_b64_tr_b16 v[80:81], v18 offset:6144
v_mfma_f32_16x16x32_bf16 v[248:251], v[88:91], a[220:223], v[248:251]
v_rcp_f32 v75, v75
ds_read_b64_tr_b16 v[82:83], v18 offset:14336
v_mfma_f32_16x16x32_bf16 v[236:239], v[92:95], a[216:219], v[236:239]
ds_read_b64_tr_b16 v[84:85], v19 offset:6144
v_mul_f32 v188, v188, v72
v_mul_f32 v189, v189, v73
v_mfma_f32_16x16x32_bf16 v[252:255], v[92:95], a[220:223], v[252:255]
buffer_load_dwordx4 v33, s[40:43], s77 offen offset:3072 lds
ds_read_b64_tr_b16 v[86:87], v19 offset:14336
v_mfma_f32_16x16x32_bf16 v[224:227], v[96:99], a[224:227], v[224:227]
ds_read_b64_tr_b16 v[88:89], v18 offset:22528
v_mul_f32 v190, v190, v74
v_mul_f32 v191, v191, v75
v_mfma_f32_16x16x32_bf16 v[240:243], v[96:99], a[228:231], v[240:243]
ds_read_b64_tr_b16 v[90:91], v18 offset:30720
ds_read_b64_tr_b16 v[92:93], v19 offset:22528
ds_read_b64_tr_b16 v[94:95], v19 offset:30720
v_mfma_f32_16x16x32_bf16 v[228:231], v[100:103], a[224:227], v[228:231]
ds_read_b64_tr_b16 v[96:97], v18 offset:7168
v_mfma_f32_16x16x32_bf16 v[244:247], v[100:103], a[228:231], v[244:247]
ds_read_b64_tr_b16 v[98:99], v18 offset:15360
s_lshl_b32 s7, s84, 5
s_waitcnt lgkmcnt(8)
v_mfma_f32_16x16x32_bf16 v[232:235], v[104:107], a[224:227], v[232:235]
ds_read_b64_tr_b16 v[100:101], v19 offset:7168
s_add_u32 s7, s7, s4
v_mul_f32 v192, v192, v160
v_mfma_f32_16x16x32_bf16 v[248:251], v[104:107], a[228:231], v[248:251]
ds_read_b64_tr_b16 v[102:103], v19 offset:15360
v_mul_f32 v193, v193, v161
v_mul_f32 v194, v194, v162
v_mfma_f32_16x16x32_bf16 v[236:239], v[108:111], a[224:227], v[236:239]
ds_read_b64_tr_b16 v[104:105], v18 offset:23552
v_mul_f32 v195, v195, v163
v_mul_f32 v196, v196, v164
v_mfma_f32_16x16x32_bf16 v[252:255], v[108:111], a[228:231], v[252:255]
ds_read_b64_tr_b16 v[106:107], v18 offset:31744
v_mul_f32 v197, v197, v165
v_mul_f32 v198, v198, v166
v_mfma_f32_16x16x32_bf16 v[224:227], v[112:115], a[232:235], v[224:227]
ds_read_b64_tr_b16 v[108:109], v19 offset:23552
v_mul_f32 v199, v199, v167
v_cvt_pk_bf16_f32 v192, v192, v193
v_mfma_f32_16x16x32_bf16 v[240:243], v[112:115], a[236:239], v[240:243]
ds_read_b64_tr_b16 v[110:111], v19 offset:31744
v_cvt_pk_bf16_f32 v193, v194, v195
v_cvt_pk_bf16_f32 v194, v196, v197
v_mfma_f32_16x16x32_bf16 v[228:231], v[116:119], a[232:235], v[228:231]
v_cvt_pk_bf16_f32 v195, v198, v199
buffer_store_dwordx4 v[192:195], v46, s[60:63], s7 offen offset:0 sc1
v_mfma_f32_16x16x32_bf16 v[244:247], v[116:119], a[236:239], v[244:247]
v_mul_f32 v200, v200, v168
v_mul_f32 v201, v201, v169
v_mul_f32 v202, v202, v170
v_mfma_f32_16x16x32_bf16 v[232:235], v[120:123], a[232:235], v[232:235]
v_mul_f32 v203, v203, v171
v_mul_f32 v204, v204, v172
v_mul_f32 v205, v205, v173
v_mfma_f32_16x16x32_bf16 v[248:251], v[120:123], a[236:239], v[248:251]
v_mul_f32 v206, v206, v174
v_mul_f32 v207, v207, v175
v_cvt_pk_bf16_f32 v200, v200, v201
v_mfma_f32_16x16x32_bf16 v[236:239], v[124:127], a[232:235], v[236:239]
s_waitcnt vmcnt(18) lgkmcnt(0)
s_barrier
ds_read_b64_tr_b16 v[112:113], v10 offset:32768
v_mfma_f32_16x16x32_bf16 v[252:255], v[124:127], a[236:239], v[252:255]
ds_read_b64_tr_b16 v[114:115], v10 offset:49152
s_add_u32 m0, s76, 0
s_add_u32 s77, s25, 0x540000
v_mfma_f32_16x16x32_bf16 v[224:227], v[80:83], a[240:243], v[224:227]
buffer_load_dwordx4 v30, s[40:43], s77 offen offset:0 lds
ds_read_b64_tr_b16 v[116:117], v11 offset:32768
v_mfma_f32_16x16x32_bf16 v[240:243], v[80:83], a[244:247], v[240:243]
ds_read_b64_tr_b16 v[118:119], v11 offset:49152
ds_read_b64_tr_b16 v[120:121], v12 offset:32768
ds_read_b64_tr_b16 v[122:123], v12 offset:49152
v_mfma_f32_16x16x32_bf16 v[228:231], v[84:87], a[240:243], v[228:231]
ds_read_b64_tr_b16 v[124:125], v13 offset:32768
v_cvt_pk_bf16_f32 v201, v202, v203
v_cvt_pk_bf16_f32 v202, v204, v205
v_mfma_f32_16x16x32_bf16 v[244:247], v[84:87], a[244:247], v[244:247]
ds_read_b64_tr_b16 v[126:127], v13 offset:49152
v_cvt_pk_bf16_f32 v203, v206, v207
ds_read_b64_tr_b16 v[80:81], v10 offset:33792
v_mfma_f32_16x16x32_bf16 v[232:235], v[88:91], a[240:243], v[232:235]
buffer_store_dwordx4 v[200:203], v46, s[60:63], s7 offen offset:2048 sc1
ds_read_b64_tr_b16 v[82:83], v10 offset:50176
v_mfma_f32_16x16x32_bf16 v[248:251], v[88:91], a[244:247], v[248:251]
ds_read_b64_tr_b16 v[84:85], v11 offset:33792
v_mul_f32 v208, v208, v176
v_mul_f32 v209, v209, v177
v_mfma_f32_16x16x32_bf16 v[236:239], v[92:95], a[240:243], v[236:239]
buffer_load_dwordx4 v31, s[40:43], s77 offen offset:1024 lds
ds_read_b64_tr_b16 v[86:87], v11 offset:50176
v_mfma_f32_16x16x32_bf16 v[252:255], v[92:95], a[244:247], v[252:255]
ds_read_b64_tr_b16 v[88:89], v12 offset:33792
v_mul_f32 v210, v210, v178
v_mul_f32 v211, v211, v179
v_mfma_f32_16x16x32_bf16 v[224:227], v[96:99], a[248:251], v[224:227]
ds_read_b64_tr_b16 v[90:91], v12 offset:50176
v_mul_f32 v212, v212, v180
v_mul_f32 v213, v213, v181
v_mfma_f32_16x16x32_bf16 v[240:243], v[96:99], a[252:255], v[240:243]
ds_read_b64_tr_b16 v[92:93], v13 offset:33792
v_mul_f32 v214, v214, v182
v_mul_f32 v215, v215, v183
v_mfma_f32_16x16x32_bf16 v[228:231], v[100:103], a[248:251], v[228:231]
ds_read_b64_tr_b16 v[94:95], v13 offset:50176
v_cvt_pk_bf16_f32 v208, v208, v209
v_cvt_pk_bf16_f32 v209, v210, v211
v_mfma_f32_16x16x32_bf16 v[244:247], v[100:103], a[252:255], v[244:247]
ds_read_b64_tr_b16 v[96:97], v10 offset:34816
v_cvt_pk_bf16_f32 v210, v212, v213
v_cvt_pk_bf16_f32 v211, v214, v215
v_mfma_f32_16x16x32_bf16 v[232:235], v[104:107], a[248:251], v[232:235]
buffer_load_dwordx4 v32, s[40:43], s77 offen offset:2048 lds
ds_read_b64_tr_b16 v[98:99], v10 offset:51200
v_mfma_f32_16x16x32_bf16 v[248:251], v[104:107], a[252:255], v[248:251]
ds_read_b64_tr_b16 v[100:101], v11 offset:34816
ds_read_b64_tr_b16 v[102:103], v11 offset:51200
v_mfma_f32_16x16x32_bf16 v[236:239], v[108:111], a[248:251], v[236:239]
buffer_store_dwordx4 v[208:211], v46, s[60:63], s7 offen offset:1024 sc1
ds_read_b64_tr_b16 v[104:105], v12 offset:34816
v_mfma_f32_16x16x32_bf16 v[252:255], v[108:111], a[252:255], v[252:255]
ds_read_b64_tr_b16 v[106:107], v12 offset:51200
v_mul_f32 v216, v216, v184
s_waitcnt lgkmcnt(7)
v_mfma_f32_16x16x32_bf16 v[128:131], v[112:115], a[0:3], 0
ds_read_b64_tr_b16 v[108:109], v13 offset:34816
v_mul_f32 v217, v217, v185
v_mul_f32 v218, v218, v186
v_mfma_f32_16x16x32_bf16 v[144:147], v[112:115], a[4:7], 0
ds_read_b64_tr_b16 v[110:111], v13 offset:51200
v_mul_f32 v219, v219, v187
v_mul_f32 v220, v220, v188
v_mfma_f32_16x16x32_bf16 v[132:135], v[116:119], a[0:3], 0
buffer_load_dwordx4 v33, s[40:43], s77 offen offset:3072 lds
ds_read_b64_tr_b16 v[112:113], v10 offset:35840
v_mfma_f32_16x16x32_bf16 v[148:151], v[116:119], a[4:7], 0
ds_read_b64_tr_b16 v[114:115], v10 offset:52224
v_mul_f32 v221, v221, v189
v_mul_f32 v222, v222, v190
v_mfma_f32_16x16x32_bf16 v[136:139], v[120:123], a[0:3], 0
ds_read_b64_tr_b16 v[116:117], v11 offset:35840
v_mul_f32 v223, v223, v191
v_cvt_pk_bf16_f32 v216, v216, v217
v_mfma_f32_16x16x32_bf16 v[152:155], v[120:123], a[4:7], 0
ds_read_b64_tr_b16 v[118:119], v11 offset:52224
s_add_u32 m0, s76, 4096
s_add_u32 s77, s25, 0x620000
v_mfma_f32_16x16x32_bf16 v[140:143], v[124:127], a[0:3], 0
ds_read_b64_tr_b16 v[120:121], v12 offset:35840
v_cvt_pk_bf16_f32 v217, v218, v219
v_cvt_pk_bf16_f32 v218, v220, v221
v_mfma_f32_16x16x32_bf16 v[156:159], v[124:127], a[4:7], 0
ds_read_b64_tr_b16 v[122:123], v12 offset:52224
v_cvt_pk_bf16_f32 v219, v222, v223
v_mfma_f32_16x16x32_bf16 v[128:131], v[80:83], a[8:11], v[128:131]
buffer_load_dwordx4 v30, s[40:43], s77 offen offset:0 lds
ds_read_b64_tr_b16 v[124:125], v13 offset:35840
v_mfma_f32_16x16x32_bf16 v[144:147], v[80:83], a[12:15], v[144:147]
ds_read_b64_tr_b16 v[126:127], v13 offset:52224
v_mfma_f32_16x16x32_bf16 v[132:135], v[84:87], a[8:11], v[132:135]
buffer_store_dwordx4 v[216:219], v46, s[60:63], s7 offen offset:3072 sc1
ds_read_b64_tr_b16 v[80:81], v10 offset:36864
v_mfma_f32_16x16x32_bf16 v[148:151], v[84:87], a[12:15], v[148:151]
ds_read_b64_tr_b16 v[82:83], v10 offset:53248
v_mul_f32 v68, v60, v224
v_mul_f32 v69, v60, v225
v_mfma_f32_16x16x32_bf16 v[136:139], v[88:91], a[8:11], v[136:139]
ds_read_b64_tr_b16 v[84:85], v11 offset:36864
v_mul_f32 v70, v60, v226
v_mul_f32 v71, v60, v227
v_mfma_f32_16x16x32_bf16 v[152:155], v[88:91], a[12:15], v[152:155]
v_exp_f32 v68, v68
s_waitcnt lgkmcnt(5)
v_mfma_f32_16x16x32_bf16 v[140:143], v[92:95], a[8:11], v[140:143]
buffer_load_dwordx4 v31, s[40:43], s77 offen offset:1024 lds
ds_read_b64_tr_b16 v[86:87], v11 offset:53248
v_mfma_f32_16x16x32_bf16 v[156:159], v[92:95], a[12:15], v[156:159]
v_exp_f32 v69, v69
ds_read_b64_tr_b16 v[88:89], v12 offset:36864
v_mfma_f32_16x16x32_bf16 v[128:131], v[96:99], a[16:19], v[128:131]
v_exp_f32 v70, v70
ds_read_b64_tr_b16 v[90:91], v12 offset:53248
v_mfma_f32_16x16x32_bf16 v[144:147], v[96:99], a[20:23], v[144:147]
v_exp_f32 v71, v71
ds_read_b64_tr_b16 v[92:93], v13 offset:36864
v_mfma_f32_16x16x32_bf16 v[132:135], v[100:103], a[16:19], v[132:135]
ds_read_b64_tr_b16 v[94:95], v13 offset:53248
v_fma_f32 v68, v68, v62, v62
v_fma_f32 v69, v69, v62, v62
v_mfma_f32_16x16x32_bf16 v[148:151], v[100:103], a[20:23], v[148:151]
ds_read_b64_tr_b16 v[96:97], v10 offset:37888
v_fma_f32 v70, v70, v62, v62
v_fma_f32 v71, v71, v62, v62
v_mfma_f32_16x16x32_bf16 v[136:139], v[104:107], a[16:19], v[136:139]
buffer_load_dwordx4 v32, s[40:43], s77 offen offset:2048 lds
ds_read_b64_tr_b16 v[98:99], v10 offset:54272
v_mfma_f32_16x16x32_bf16 v[152:155], v[104:107], a[20:23], v[152:155]
v_rcp_f32 v68, v68
ds_read_b64_tr_b16 v[100:101], v11 offset:37888
v_mfma_f32_16x16x32_bf16 v[140:143], v[108:111], a[16:19], v[140:143]
v_rcp_f32 v69, v69
v_mfma_f32_16x16x32_bf16 v[156:159], v[108:111], a[20:23], v[156:159]
ds_read_b64_tr_b16 v[102:103], v11 offset:54272
ds_read_b64_tr_b16 v[104:105], v12 offset:37888
v_mfma_f32_16x16x32_bf16 v[128:131], v[112:115], a[24:27], v[128:131]
v_rcp_f32 v70, v70
v_mfma_f32_16x16x32_bf16 v[144:147], v[112:115], a[28:31], v[144:147]
ds_read_b64_tr_b16 v[106:107], v12 offset:54272
ds_read_b64_tr_b16 v[108:109], v13 offset:37888
v_mfma_f32_16x16x32_bf16 v[132:135], v[116:119], a[24:27], v[132:135]
buffer_load_dwordx4 v33, s[40:43], s77 offen offset:3072 lds
v_mfma_f32_16x16x32_bf16 v[148:151], v[116:119], a[28:31], v[148:151]
ds_read_b64_tr_b16 v[110:111], v13 offset:54272
ds_read_b64_tr_b16 v[112:113], v10 offset:38912
v_mfma_f32_16x16x32_bf16 v[136:139], v[120:123], a[24:27], v[136:139]
v_rcp_f32 v71, v71
v_mfma_f32_16x16x32_bf16 v[152:155], v[120:123], a[28:31], v[152:155]
ds_read_b64_tr_b16 v[114:115], v10 offset:55296
s_waitcnt lgkmcnt(5)
v_mfma_f32_16x16x32_bf16 v[140:143], v[124:127], a[24:27], v[140:143]
ds_read_b64_tr_b16 v[116:117], v11 offset:38912
v_mul_f32 v224, v224, v68
v_mfma_f32_16x16x32_bf16 v[156:159], v[124:127], a[28:31], v[156:159]
ds_read_b64_tr_b16 v[118:119], v11 offset:55296
v_mul_f32 v225, v225, v69
v_mfma_f32_16x16x32_bf16 v[128:131], v[80:83], a[32:35], v[128:131]
ds_read_b64_tr_b16 v[120:121], v12 offset:38912
v_mul_f32 v226, v226, v70
v_mfma_f32_16x16x32_bf16 v[144:147], v[80:83], a[36:39], v[144:147]
ds_read_b64_tr_b16 v[122:123], v12 offset:55296
v_mul_f32 v227, v227, v71
v_mfma_f32_16x16x32_bf16 v[132:135], v[84:87], a[32:35], v[132:135]
ds_read_b64_tr_b16 v[124:125], v13 offset:38912
v_mul_f32 v72, v60, v228
v_mfma_f32_16x16x32_bf16 v[148:151], v[84:87], a[36:39], v[148:151]
ds_read_b64_tr_b16 v[126:127], v13 offset:55296
v_mul_f32 v73, v60, v229
v_mfma_f32_16x16x32_bf16 v[136:139], v[88:91], a[32:35], v[136:139]
ds_read_b64_tr_b16 v[80:81], v10 offset:39936
v_mul_f32 v74, v60, v230
v_mfma_f32_16x16x32_bf16 v[152:155], v[88:91], a[36:39], v[152:155]
ds_read_b64_tr_b16 v[82:83], v10 offset:56320
v_mul_f32 v75, v60, v231
v_mfma_f32_16x16x32_bf16 v[140:143], v[92:95], a[32:35], v[140:143]
v_exp_f32 v72, v72
v_mfma_f32_16x16x32_bf16 v[156:159], v[92:95], a[36:39], v[156:159]
ds_read_b64_tr_b16 v[84:85], v11 offset:39936
ds_read_b64_tr_b16 v[86:87], v11 offset:56320
v_mfma_f32_16x16x32_bf16 v[128:131], v[96:99], a[40:43], v[128:131]
v_exp_f32 v73, v73
v_mfma_f32_16x16x32_bf16 v[144:147], v[96:99], a[44:47], v[144:147]
ds_read_b64_tr_b16 v[88:89], v12 offset:39936
ds_read_b64_tr_b16 v[90:91], v12 offset:56320
v_mfma_f32_16x16x32_bf16 v[132:135], v[100:103], a[40:43], v[132:135]
v_exp_f32 v74, v74
v_mfma_f32_16x16x32_bf16 v[148:151], v[100:103], a[44:47], v[148:151]
ds_read_b64_tr_b16 v[92:93], v13 offset:39936
s_waitcnt lgkmcnt(5)
v_mfma_f32_16x16x32_bf16 v[136:139], v[104:107], a[40:43], v[136:139]
v_exp_f32 v75, v75
v_mfma_f32_16x16x32_bf16 v[152:155], v[104:107], a[44:47], v[152:155]
ds_read_b64_tr_b16 v[94:95], v13 offset:56320
v_fma_f32 v72, v72, v62, v62
v_mfma_f32_16x16x32_bf16 v[140:143], v[108:111], a[40:43], v[140:143]
v_fma_f32 v73, v73, v62, v62
v_fma_f32 v74, v74, v62, v62
v_mfma_f32_16x16x32_bf16 v[156:159], v[108:111], a[44:47], v[156:159]
v_fma_f32 v75, v75, v62, v62
v_mfma_f32_16x16x32_bf16 v[128:131], v[112:115], a[48:51], v[128:131]
v_rcp_f32 v72, v72
v_mfma_f32_16x16x32_bf16 v[144:147], v[112:115], a[52:55], v[144:147]
v_rcp_f32 v73, v73
v_mfma_f32_16x16x32_bf16 v[132:135], v[116:119], a[48:51], v[132:135]
s_waitcnt vmcnt(21) lgkmcnt(0)
s_barrier
v_mfma_f32_16x16x32_bf16 v[148:151], v[116:119], a[52:55], v[148:151]
ds_read_b64_tr_b16 v[96:97], v14 offset:0
ds_read_b64_tr_b16 v[98:99], v14 offset:16384
v_mfma_f32_16x16x32_bf16 v[136:139], v[120:123], a[48:51], v[136:139]
ds_read_b64_tr_b16 v[100:101], v15 offset:0
ds_read_b64_tr_b16 v[102:103], v15 offset:16384
v_mfma_f32_16x16x32_bf16 v[152:155], v[120:123], a[52:55], v[152:155]
ds_read_b64_tr_b16 v[104:105], v16 offset:0
ds_read_b64_tr_b16 v[106:107], v16 offset:16384
v_mfma_f32_16x16x32_bf16 v[140:143], v[124:127], a[48:51], v[140:143]
ds_read_b64_tr_b16 v[108:109], v17 offset:0
s_add_u32 m0, s76, 32768
v_mfma_f32_16x16x32_bf16 v[156:159], v[124:127], a[52:55], v[156:159]
ds_read_b64_tr_b16 v[110:111], v17 offset:16384
s_add_u32 s77, s25, 0x0
v_mfma_f32_16x16x32_bf16 v[128:131], v[80:83], a[56:59], v[128:131]
ds_read_b64_tr_b16 v[112:113], v14 offset:1024
ds_read_b64_tr_b16 v[114:115], v14 offset:17408
v_mfma_f32_16x16x32_bf16 v[144:147], v[80:83], a[60:63], v[144:147]
buffer_load_dwordx4 v30, s[44:47], s77 offen offset:0 lds
v_mfma_f32_16x16x32_bf16 v[132:135], v[84:87], a[56:59], v[132:135]
ds_read_b64_tr_b16 v[116:117], v15 offset:1024
ds_read_b64_tr_b16 v[118:119], v15 offset:17408
v_mfma_f32_16x16x32_bf16 v[148:151], v[84:87], a[60:63], v[148:151]
v_rcp_f32 v74, v74
v_mfma_f32_16x16x32_bf16 v[136:139], v[88:91], a[56:59], v[136:139]
ds_read_b64_tr_b16 v[120:121], v16 offset:1024
ds_read_b64_tr_b16 v[122:123], v16 offset:17408
v_mfma_f32_16x16x32_bf16 v[152:155], v[88:91], a[60:63], v[152:155]
v_rcp_f32 v75, v75
v_mfma_f32_16x16x32_bf16 v[140:143], v[92:95], a[56:59], v[140:143]
ds_read_b64_tr_b16 v[124:125], v17 offset:1024
ds_read_b64_tr_b16 v[126:127], v17 offset:17408
v_mfma_f32_16x16x32_bf16 v[156:159], v[92:95], a[60:63], v[156:159]
ds_read_b64_tr_b16 v[80:81], v14 offset:2048
s_waitcnt lgkmcnt(7)
v_mfma_f32_16x16x32_bf16 v[128:131], v[96:99], a[64:67], v[128:131]
buffer_load_dwordx4 v31, s[44:47], s77 offen offset:1024 lds
v_mfma_f32_16x16x32_bf16 v[144:147], v[96:99], a[68:71], v[144:147]
ds_read_b64_tr_b16 v[82:83], v14 offset:18432
ds_read_b64_tr_b16 v[84:85], v15 offset:2048
v_mfma_f32_16x16x32_bf16 v[132:135], v[100:103], a[64:67], v[132:135]
ds_read_b64_tr_b16 v[86:87], v15 offset:18432
v_mul_f32 v228, v228, v72
v_mfma_f32_16x16x32_bf16 v[148:151], v[100:103], a[68:71], v[148:151]
ds_read_b64_tr_b16 v[88:89], v16 offset:2048
ds_read_b64_tr_b16 v[90:91], v16 offset:18432
v_mfma_f32_16x16x32_bf16 v[136:139], v[104:107], a[64:67], v[136:139]
ds_read_b64_tr_b16 v[92:93], v17 offset:2048
v_mul_f32 v229, v229, v73
v_mfma_f32_16x16x32_bf16 v[152:155], v[104:107], a[68:71], v[152:155]
ds_read_b64_tr_b16 v[94:95], v17 offset:18432
ds_read_b64_tr_b16 v[96:97], v14 offset:3072
v_mfma_f32_16x16x32_bf16 v[140:143], v[108:111], a[64:67], v[140:143]
buffer_load_dwordx4 v32, s[44:47], s77 offen offset:2048 lds
v_mfma_f32_16x16x32_bf16 v[156:159], v[108:111], a[68:71], v[156:159]
ds_read_b64_tr_b16 v[98:99], v14 offset:19456
ds_read_b64_tr_b16 v[100:101], v15 offset:3072
v_mfma_f32_16x16x32_bf16 v[128:131], v[112:115], a[72:75], v[128:131]
ds_read_b64_tr_b16 v[102:103], v15 offset:19456
v_mul_f32 v230, v230, v74
v_mfma_f32_16x16x32_bf16 v[144:147], v[112:115], a[76:79], v[144:147]
ds_read_b64_tr_b16 v[104:105], v16 offset:3072
s_waitcnt lgkmcnt(7)
v_mfma_f32_16x16x32_bf16 v[132:135], v[116:119], a[72:75], v[132:135]
ds_read_b64_tr_b16 v[106:107], v16 offset:19456
ds_read_b64_tr_b16 v[108:109], v17 offset:3072
v_mfma_f32_16x16x32_bf16 v[148:151], v[116:119], a[76:79], v[148:151]
ds_read_b64_tr_b16 v[110:111], v17 offset:19456
v_mul_f32 v231, v231, v75
v_mfma_f32_16x16x32_bf16 v[136:139], v[120:123], a[72:75], v[136:139]
buffer_load_dwordx4 v33, s[44:47], s77 offen offset:3072 lds
v_mfma_f32_16x16x32_bf16 v[152:155], v[120:123], a[76:79], v[152:155]
ds_read_b64_tr_b16 v[112:113], v14 offset:4096
ds_read_b64_tr_b16 v[114:115], v14 offset:20480
v_mfma_f32_16x16x32_bf16 v[140:143], v[124:127], a[72:75], v[140:143]
ds_read_b64_tr_b16 v[116:117], v15 offset:4096
v_mul_f32 v68, v61, v240
v_mfma_f32_16x16x32_bf16 v[156:159], v[124:127], a[76:79], v[156:159]
ds_read_b64_tr_b16 v[118:119], v15 offset:20480
s_add_u32 m0, s76, 36864
v_mfma_f32_16x16x32_bf16 v[128:131], v[80:83], a[80:83], v[128:131]
ds_read_b64_tr_b16 v[120:121], v16 offset:4096
s_add_u32 s77, s25, 0xe0000
v_mfma_f32_16x16x32_bf16 v[144:147], v[80:83], a[84:87], v[144:147]
ds_read_b64_tr_b16 v[122:123], v16 offset:20480
v_mul_f32 v69, v61, v241
v_mfma_f32_16x16x32_bf16 v[132:135], v[84:87], a[80:83], v[132:135]
buffer_load_dwordx4 v30, s[44:47], s77 offen offset:0 lds
v_mfma_f32_16x16x32_bf16 v[148:151], v[84:87], a[84:87], v[148:151]
ds_read_b64_tr_b16 v[124:125], v17 offset:4096
ds_read_b64_tr_b16 v[126:127], v17 offset:20480
v_mfma_f32_16x16x32_bf16 v[136:139], v[88:91], a[80:83], v[136:139]
ds_read_b64_tr_b16 v[80:81], v14 offset:5120
v_mul_f32 v70, v61, v242
v_mfma_f32_16x16x32_bf16 v[152:155], v[88:91], a[84:87], v[152:155]
ds_read_b64_tr_b16 v[82:83], v14 offset:21504
s_waitcnt lgkmcnt(6)
v_mfma_f32_16x16x32_bf16 v[140:143], v[92:95], a[80:83], v[140:143]
ds_read_b64_tr_b16 v[84:85], v15 offset:5120
v_mul_f32 v71, v61, v243
v_mfma_f32_16x16x32_bf16 v[156:159], v[92:95], a[84:87], v[156:159]
v_exp_f32 v68, v68
v_mfma_f32_16x16x32_bf16 v[128:131], v[96:99], a[88:91], v[128:131]
ds_read_b64_tr_b16 v[86:87], v15 offset:21504
ds_read_b64_tr_b16 v[88:89], v16 offset:5120
v_mfma_f32_16x16x32_bf16 v[144:147], v[96:99], a[92:95], v[144:147]
buffer_load_dwordx4 v31, s[44:47], s77 offen offset:1024 lds
v_mfma_f32_16x16x32_bf16 v[132:135], v[100:103], a[88:91], v[132:135]
ds_read_b64_tr_b16 v[90:91], v16 offset:21504
ds_read_b64_tr_b16 v[92:93], v17 offset:5120
v_mfma_f32_16x16x32_bf16 v[148:151], v[100:103], a[92:95], v[148:151]
v_exp_f32 v69, v69
v_mfma_f32_16x16x32_bf16 v[136:139], v[104:107], a[88:91], v[136:139]
ds_read_b64_tr_b16 v[94:95], v17 offset:21504
ds_read_b64_tr_b16 v[96:97], v14 offset:6144
v_mfma_f32_16x16x32_bf16 v[152:155], v[104:107], a[92:95], v[152:155]
v_exp_f32 v70, v70
v_mfma_f32_16x16x32_bf16 v[140:143], v[108:111], a[88:91], v[140:143]
ds_read_b64_tr_b16 v[98:99], v14 offset:22528
ds_read_b64_tr_b16 v[100:101], v15 offset:6144
v_mfma_f32_16x16x32_bf16 v[156:159], v[108:111], a[92:95], v[156:159]
buffer_load_dwordx4 v32, s[44:47], s77 offen offset:2048 lds
v_mfma_f32_16x16x32_bf16 v[128:131], v[112:115], a[96:99], v[128:131]
ds_read_b64_tr_b16 v[102:103], v15 offset:22528
ds_read_b64_tr_b16 v[104:105], v16 offset:6144
v_mfma_f32_16x16x32_bf16 v[144:147], v[112:115], a[100:103], v[144:147]
v_exp_f32 v71, v71
v_mfma_f32_16x16x32_bf16 v[132:135], v[116:119], a[96:99], v[132:135]
ds_read_b64_tr_b16 v[106:107], v16 offset:22528
ds_read_b64_tr_b16 v[108:109], v17 offset:6144
v_mfma_f32_16x16x32_bf16 v[148:151], v[116:119], a[100:103], v[148:151]
ds_read_b64_tr_b16 v[110:111], v17 offset:22528
s_waitcnt lgkmcnt(7)
v_mfma_f32_16x16x32_bf16 v[136:139], v[120:123], a[96:99], v[136:139]
ds_read_b64_tr_b16 v[112:113], v14 offset:7168
v_fma_f32 v68, v68, v63, v63
v_mfma_f32_16x16x32_bf16 v[152:155], v[120:123], a[100:103], v[152:155]
buffer_load_dwordx4 v33, s[44:47], s77 offen offset:3072 lds
v_mfma_f32_16x16x32_bf16 v[140:143], v[124:127], a[96:99], v[140:143]
ds_read_b64_tr_b16 v[114:115], v14 offset:23552
ds_read_b64_tr_b16 v[116:117], v15 offset:7168
v_mfma_f32_16x16x32_bf16 v[156:159], v[124:127], a[100:103], v[156:159]
ds_read_b64_tr_b16 v[118:119], v15 offset:23552
v_fma_f32 v69, v69, v63, v63
v_mfma_f32_16x16x32_bf16 v[128:131], v[80:83], a[104:107], v[128:131]
ds_read_b64_tr_b16 v[120:121], v16 offset:7168
v_fma_f32 v70, v70, v63, v63
v_mfma_f32_16x16x32_bf16 v[144:147], v[80:83], a[108:111], v[144:147]
ds_read_b64_tr_b16 v[122:123], v16 offset:23552
v_fma_f32 v71, v71, v63, v63
v_mfma_f32_16x16x32_bf16 v[132:135], v[84:87], a[104:107], v[132:135]
v_rcp_f32 v68, v68
v_mfma_f32_16x16x32_bf16 v[148:151], v[84:87], a[108:111], v[148:151]
ds_read_b64_tr_b16 v[124:125], v17 offset:7168
ds_read_b64_tr_b16 v[126:127], v17 offset:23552
v_mfma_f32_16x16x32_bf16 v[136:139], v[88:91], a[104:107], v[136:139]
v_rcp_f32 v69, v69
v_mfma_f32_16x16x32_bf16 v[152:155], v[88:91], a[108:111], v[152:155]
v_rcp_f32 v70, v70
v_mfma_f32_16x16x32_bf16 v[140:143], v[92:95], a[104:107], v[140:143]
v_rcp_f32 v71, v71
v_mfma_f32_16x16x32_bf16 v[156:159], v[92:95], a[108:111], v[156:159]
v_mul_f32 v240, v240, v68
s_waitcnt lgkmcnt(2)
v_mfma_f32_16x16x32_bf16 v[128:131], v[96:99], a[112:115], v[128:131]
s_waitcnt vmcnt(20) lgkmcnt(0)
s_barrier
v_mfma_f32_16x16x32_bf16 v[144:147], v[96:99], a[116:119], v[144:147]
ds_read_b64_tr_b16 v[80:81], v14 offset:32768
ds_read_b64_tr_b16 v[82:83], v14 offset:49152
v_mfma_f32_16x16x32_bf16 v[132:135], v[100:103], a[112:115], v[132:135]
ds_read_b64_tr_b16 v[84:85], v15 offset:32768
s_add_u32 m0, s76, 65536
v_mfma_f32_16x16x32_bf16 v[148:151], v[100:103], a[116:119], v[148:151]
ds_read_b64_tr_b16 v[86:87], v15 offset:49152
s_add_u32 s77, s25, 0x1c0000
v_mfma_f32_16x16x32_bf16 v[136:139], v[104:107], a[112:115], v[136:139]
ds_read_b64_tr_b16 v[88:89], v16 offset:32768
ds_read_b64_tr_b16 v[90:91], v16 offset:49152
v_mfma_f32_16x16x32_bf16 v[152:155], v[104:107], a[116:119], v[152:155]
buffer_load_dwordx4 v30, s[44:47], s77 offen offset:0 lds
v_mfma_f32_16x16x32_bf16 v[140:143], v[108:111], a[112:115], v[140:143]
ds_read_b64_tr_b16 v[92:93], v17 offset:32768
ds_read_b64_tr_b16 v[94:95], v17 offset:49152
v_mfma_f32_16x16x32_bf16 v[156:159], v[108:111], a[116:119], v[156:159]
ds_read_b64_tr_b16 v[96:97], v14 offset:33792
v_mul_f32 v241, v241, v69
v_mfma_f32_16x16x32_bf16 v[128:131], v[112:115], a[120:123], v[128:131]
ds_read_b64_tr_b16 v[98:99], v14 offset:50176
ds_read_b64_tr_b16 v[100:101], v15 offset:33792
v_mfma_f32_16x16x32_bf16 v[144:147], v[112:115], a[124:127], v[144:147]
ds_read_b64_tr_b16 v[102:103], v15 offset:50176
v_mul_f32 v242, v242, v70
v_mfma_f32_16x16x32_bf16 v[132:135], v[116:119], a[120:123], v[132:135]
ds_read_b64_tr_b16 v[104:105], v16 offset:33792
ds_read_b64_tr_b16 v[106:107], v16 offset:50176
v_mfma_f32_16x16x32_bf16 v[148:151], v[116:119], a[124:127], v[148:151]
buffer_load_dwordx4 v31, s[44:47], s77 offen offset:1024 lds
v_mfma_f32_16x16x32_bf16 v[136:139], v[120:123], a[120:123], v[136:139]
ds_read_b64_tr_b16 v[108:109], v17 offset:33792
ds_read_b64_tr_b16 v[110:111], v17 offset:50176
v_mfma_f32_16x16x32_bf16 v[152:155], v[120:123], a[124:127], v[152:155]
ds_read_b64_tr_b16 v[112:113], v14 offset:34816
v_mul_f32 v243, v243, v71
v_mfma_f32_16x16x32_bf16 v[140:143], v[124:127], a[120:123], v[140:143]
ds_read_b64_tr_b16 v[114:115], v14 offset:51200
ds_read_b64_tr_b16 v[116:117], v15 offset:34816
v_mfma_f32_16x16x32_bf16 v[156:159], v[124:127], a[124:127], v[156:159]
ds_read_b64_tr_b16 v[118:119], v15 offset:51200
s_waitcnt lgkmcnt(8)
v_mfma_f32_16x16x32_bf16 v[128:131], v[80:83], a[128:131], v[128:131]
ds_read_b64_tr_b16 v[120:121], v16 offset:34816
v_mul_f32 v72, v61, v244
v_mfma_f32_16x16x32_bf16 v[144:147], v[80:83], a[132:135], v[144:147]
buffer_load_dwordx4 v32, s[44:47], s77 offen offset:2048 lds
v_mfma_f32_16x16x32_bf16 v[132:135], v[84:87], a[128:131], v[132:135]
ds_read_b64_tr_b16 v[122:123], v16 offset:51200
ds_read_b64_tr_b16 v[124:125], v17 offset:34816
v_mfma_f32_16x16x32_bf16 v[148:151], v[84:87], a[132:135], v[148:151]
ds_read_b64_tr_b16 v[126:127], v17 offset:51200
v_mul_f32 v73, v61, v245
v_mfma_f32_16x16x32_bf16 v[136:139], v[88:91], a[128:131], v[136:139]
ds_read_b64_tr_b16 v[80:81], v14 offset:35840
v_mul_f32 v74, v61, v246
v_mfma_f32_16x16x32_bf16 v[152:155], v[88:91], a[132:135], v[152:155]
ds_read_b64_tr_b16 v[82:83], v14 offset:52224
v_mul_f32 v75, v61, v247
v_mfma_f32_16x16x32_bf16 v[140:143], v[92:95], a[128:131], v[140:143]
v_exp_f32 v72, v72
v_mfma_f32_16x16x32_bf16 v[156:159], v[92:95], a[132:135], v[156:159]
ds_read_b64_tr_b16 v[84:85], v15 offset:35840
ds_read_b64_tr_b16 v[86:87], v15 offset:52224
v_mfma_f32_16x16x32_bf16 v[128:131], v[96:99], a[136:139], v[128:131]
buffer_load_dwordx4 v33, s[44:47], s77 offen offset:3072 lds
v_mfma_f32_16x16x32_bf16 v[144:147], v[96:99], a[140:143], v[144:147]
ds_read_b64_tr_b16 v[88:89], v16 offset:35840
ds_read_b64_tr_b16 v[90:91], v16 offset:52224
v_mfma_f32_16x16x32_bf16 v[132:135], v[100:103], a[136:139], v[132:135]
v_exp_f32 v73, v73
v_mfma_f32_16x16x32_bf16 v[148:151], v[100:103], a[140:143], v[148:151]
ds_read_b64_tr_b16 v[92:93], v17 offset:35840
s_waitcnt lgkmcnt(5)
v_mfma_f32_16x16x32_bf16 v[136:139], v[104:107], a[136:139], v[136:139]
v_exp_f32 v74, v74
v_mfma_f32_16x16x32_bf16 v[152:155], v[104:107], a[140:143], v[152:155]
ds_read_b64_tr_b16 v[94:95], v17 offset:52224
ds_read_b64_tr_b16 v[96:97], v14 offset:36864
v_mfma_f32_16x16x32_bf16 v[140:143], v[108:111], a[136:139], v[140:143]
v_exp_f32 v75, v75
v_mfma_f32_16x16x32_bf16 v[156:159], v[108:111], a[140:143], v[156:159]
ds_read_b64_tr_b16 v[98:99], v14 offset:53248
ds_read_b64_tr_b16 v[100:101], v15 offset:36864
v_mfma_f32_16x16x32_bf16 v[128:131], v[112:115], a[144:147], v[128:131]
ds_read_b64_tr_b16 v[102:103], v15 offset:53248
s_add_u32 m0, s76, 69632
v_mfma_f32_16x16x32_bf16 v[144:147], v[112:115], a[148:151], v[144:147]
ds_read_b64_tr_b16 v[104:105], v16 offset:36864
s_add_u32 s77, s25, 0x2a0000
v_mfma_f32_16x16x32_bf16 v[132:135], v[116:119], a[144:147], v[132:135]
buffer_load_dwordx4 v30, s[44:47], s77 offen offset:0 lds
v_mfma_f32_16x16x32_bf16 v[148:151], v[116:119], a[148:151], v[148:151]
ds_read_b64_tr_b16 v[106:107], v16 offset:53248
ds_read_b64_tr_b16 v[108:109], v17 offset:36864
v_mfma_f32_16x16x32_bf16 v[136:139], v[120:123], a[144:147], v[136:139]
ds_read_b64_tr_b16 v[110:111], v17 offset:53248
v_fma_f32 v72, v72, v63, v63
v_mfma_f32_16x16x32_bf16 v[152:155], v[120:123], a[148:151], v[152:155]
ds_read_b64_tr_b16 v[112:113], v14 offset:37888
ds_read_b64_tr_b16 v[114:115], v14 offset:54272
v_mfma_f32_16x16x32_bf16 v[140:143], v[124:127], a[144:147], v[140:143]
ds_read_b64_tr_b16 v[116:117], v15 offset:37888
v_fma_f32 v73, v73, v63, v63
v_mfma_f32_16x16x32_bf16 v[156:159], v[124:127], a[148:151], v[156:159]
ds_read_b64_tr_b16 v[118:119], v15 offset:54272
v_fma_f32 v74, v74, v63, v63
v_mfma_f32_16x16x32_bf16 v[128:131], v[80:83], a[152:155], v[128:131]
buffer_load_dwordx4 v31, s[44:47], s77 offen offset:1024 lds
v_mfma_f32_16x16x32_bf16 v[144:147], v[80:83], a[156:159], v[144:147]
ds_read_b64_tr_b16 v[120:121], v16 offset:37888
s_waitcnt lgkmcnt(6)
v_mfma_f32_16x16x32_bf16 v[132:135], v[84:87], a[152:155], v[132:135]
ds_read_b64_tr_b16 v[122:123], v16 offset:54272
ds_read_b64_tr_b16 v[124:125], v17 offset:37888
v_mfma_f32_16x16x32_bf16 v[148:151], v[84:87], a[156:159], v[148:151]
ds_read_b64_tr_b16 v[126:127], v17 offset:54272
v_fma_f32 v75, v75, v63, v63
v_mfma_f32_16x16x32_bf16 v[136:139], v[88:91], a[152:155], v[136:139]
v_rcp_f32 v72, v72
v_mfma_f32_16x16x32_bf16 v[152:155], v[88:91], a[156:159], v[152:155]
ds_read_b64_tr_b16 v[80:81], v14 offset:38912
ds_read_b64_tr_b16 v[82:83], v14 offset:55296
v_mfma_f32_16x16x32_bf16 v[140:143], v[92:95], a[152:155], v[140:143]
buffer_load_dwordx4 v32, s[44:47], s77 offen offset:2048 lds
v_mfma_f32_16x16x32_bf16 v[156:159], v[92:95], a[156:159], v[156:159]
ds_read_b64_tr_b16 v[84:85], v15 offset:38912
ds_read_b64_tr_b16 v[86:87], v15 offset:55296
v_mfma_f32_16x16x32_bf16 v[128:131], v[96:99], a[160:163], v[128:131]
v_rcp_f32 v73, v73
v_mfma_f32_16x16x32_bf16 v[144:147], v[96:99], a[164:167], v[144:147]
ds_read_b64_tr_b16 v[88:89], v16 offset:38912
ds_read_b64_tr_b16 v[90:91], v16 offset:55296
v_mfma_f32_16x16x32_bf16 v[132:135], v[100:103], a[160:163], v[132:135]
v_rcp_f32 v74, v74
v_mfma_f32_16x16x32_bf16 v[148:151], v[100:103], a[164:167], v[148:151]
ds_read_b64_tr_b16 v[92:93], v17 offset:38912
ds_read_b64_tr_b16 v[94:95], v17 offset:55296
v_mfma_f32_16x16x32_bf16 v[136:139], v[104:107], a[160:163], v[136:139]
buffer_load_dwordx4 v33, s[44:47], s77 offen offset:3072 lds
v_mfma_f32_16x16x32_bf16 v[152:155], v[104:107], a[164:167], v[152:155]
ds_read_b64_tr_b16 v[96:97], v14 offset:39936
s_waitcnt lgkmcnt(5)
v_mfma_f32_16x16x32_bf16 v[140:143], v[108:111], a[160:163], v[140:143]
v_rcp_f32 v75, v75
v_mfma_f32_16x16x32_bf16 v[156:159], v[108:111], a[164:167], v[156:159]
ds_read_b64_tr_b16 v[98:99], v14 offset:56320
ds_read_b64_tr_b16 v[100:101], v15 offset:39936
v_mfma_f32_16x16x32_bf16 v[128:131], v[112:115], a[168:171], v[128:131]
ds_read_b64_tr_b16 v[102:103], v15 offset:56320
v_mul_f32 v244, v244, v72
v_mfma_f32_16x16x32_bf16 v[144:147], v[112:115], a[172:175], v[144:147]
ds_read_b64_tr_b16 v[104:105], v16 offset:39936
ds_read_b64_tr_b16 v[106:107], v16 offset:56320
v_mfma_f32_16x16x32_bf16 v[132:135], v[116:119], a[168:171], v[132:135]
ds_read_b64_tr_b16 v[108:109], v17 offset:39936
v_mul_f32 v245, v245, v73
v_mfma_f32_16x16x32_bf16 v[148:151], v[116:119], a[172:175], v[148:151]
ds_read_b64_tr_b16 v[110:111], v17 offset:56320
v_mul_f32 v246, v246, v74
v_mfma_f32_16x16x32_bf16 v[136:139], v[120:123], a[168:171], v[136:139]
v_mul_f32 v247, v247, v75
v_mul_f32 v232, v232, v224
v_mfma_f32_16x16x32_bf16 v[152:155], v[120:123], a[172:175], v[152:155]
v_mul_f32 v233, v233, v225
v_mul_f32 v234, v234, v226
v_mfma_f32_16x16x32_bf16 v[140:143], v[124:127], a[168:171], v[140:143]
v_mul_f32 v235, v235, v227
v_mul_f32 v236, v236, v228
v_mfma_f32_16x16x32_bf16 v[156:159], v[124:127], a[172:175], v[156:159]
v_mul_f32 v237, v237, v229
v_mul_f32 v238, v238, v230
v_mfma_f32_16x16x32_bf16 v[128:131], v[80:83], a[176:179], v[128:131]
s_waitcnt vmcnt(16) lgkmcnt(0)
s_barrier
v_mfma_f32_16x16x32_bf16 v[144:147], v[80:83], a[180:183], v[144:147]
ds_read_b64_tr_b16 v[112:113], v10 offset:0
ds_read_b64_tr_b16 v[114:115], v10 offset:16384
v_mfma_f32_16x16x32_bf16 v[132:135], v[84:87], a[176:179], v[132:135]
ds_read_b64_tr_b16 v[116:117], v11 offset:0
s_add_u32 m0, s76, 98304
v_mfma_f32_16x16x32_bf16 v[148:151], v[84:87], a[180:183], v[148:151]
ds_read_b64_tr_b16 v[118:119], v11 offset:16384
s_add_u32 s77, s25, 0x380000
v_mfma_f32_16x16x32_bf16 v[136:139], v[88:91], a[176:179], v[136:139]
ds_read_b64_tr_b16 v[120:121], v12 offset:0
ds_read_b64_tr_b16 v[122:123], v12 offset:16384
v_mfma_f32_16x16x32_bf16 v[152:155], v[88:91], a[180:183], v[152:155]
buffer_load_dwordx4 v30, s[44:47], s77 offen offset:0 lds
v_mfma_f32_16x16x32_bf16 v[140:143], v[92:95], a[176:179], v[140:143]
ds_read_b64_tr_b16 v[124:125], v13 offset:0
ds_read_b64_tr_b16 v[126:127], v13 offset:16384
v_mfma_f32_16x16x32_bf16 v[156:159], v[92:95], a[180:183], v[156:159]
ds_read_b64_tr_b16 v[80:81], v10 offset:1024
v_mul_f32 v239, v239, v231
v_mfma_f32_16x16x32_bf16 v[128:131], v[96:99], a[184:187], v[128:131]
ds_read_b64_tr_b16 v[82:83], v10 offset:17408
ds_read_b64_tr_b16 v[84:85], v11 offset:1024
v_mfma_f32_16x16x32_bf16 v[144:147], v[96:99], a[188:191], v[144:147]
ds_read_b64_tr_b16 v[86:87], v11 offset:17408
v_cvt_pk_bf16_f32 v232, v232, v233
v_mfma_f32_16x16x32_bf16 v[132:135], v[100:103], a[184:187], v[132:135]
ds_read_b64_tr_b16 v[88:89], v12 offset:1024
ds_read_b64_tr_b16 v[90:91], v12 offset:17408
v_mfma_f32_16x16x32_bf16 v[148:151], v[100:103], a[188:191], v[148:151]
buffer_load_dwordx4 v31, s[44:47], s77 offen offset:1024 lds
v_mfma_f32_16x16x32_bf16 v[136:139], v[104:107], a[184:187], v[136:139]
ds_read_b64_tr_b16 v[92:93], v13 offset:1024
ds_read_b64_tr_b16 v[94:95], v13 offset:17408
v_mfma_f32_16x16x32_bf16 v[152:155], v[104:107], a[188:191], v[152:155]
ds_read_b64_tr_b16 v[96:97], v10 offset:2048
v_cvt_pk_bf16_f32 v233, v234, v235
v_mfma_f32_16x16x32_bf16 v[140:143], v[108:111], a[184:187], v[140:143]
ds_read_b64_tr_b16 v[98:99], v10 offset:18432
ds_read_b64_tr_b16 v[100:101], v11 offset:2048
v_mfma_f32_16x16x32_bf16 v[156:159], v[108:111], a[188:191], v[156:159]
ds_read_b64_tr_b16 v[102:103], v11 offset:18432
s_waitcnt lgkmcnt(8)
v_mfma_f32_16x16x32_bf16 v[128:131], v[112:115], a[192:195], v[128:131]
ds_read_b64_tr_b16 v[104:105], v12 offset:2048
v_cvt_pk_bf16_f32 v234, v236, v237
v_mfma_f32_16x16x32_bf16 v[144:147], v[112:115], a[196:199], v[144:147]
buffer_load_dwordx4 v32, s[44:47], s77 offen offset:2048 lds
v_mfma_f32_16x16x32_bf16 v[132:135], v[116:119], a[192:195], v[132:135]
ds_read_b64_tr_b16 v[106:107], v12 offset:18432
ds_read_b64_tr_b16 v[108:109], v13 offset:2048
v_mfma_f32_16x16x32_bf16 v[148:151], v[116:119], a[196:199], v[148:151]
ds_read_b64_tr_b16 v[110:111], v13 offset:18432
v_cvt_pk_bf16_f32 v235, v238, v239
v_mfma_f32_16x16x32_bf16 v[136:139], v[120:123], a[192:195], v[136:139]
buffer_store_dwordx4 v[232:235], v46, s[60:63], s5 offen offset:0 sc1
v_mfma_f32_16x16x32_bf16 v[152:155], v[120:123], a[196:199], v[152:155]
ds_read_b64_tr_b16 v[112:113], v10 offset:3072
ds_read_b64_tr_b16 v[114:115], v10 offset:19456
v_mfma_f32_16x16x32_bf16 v[140:143], v[124:127], a[192:195], v[140:143]
ds_read_b64_tr_b16 v[116:117], v11 offset:3072
v_mul_f32 v248, v248, v240
v_mfma_f32_16x16x32_bf16 v[156:159], v[124:127], a[196:199], v[156:159]
buffer_load_dwordx4 v33, s[44:47], s77 offen offset:3072 lds
v_mfma_f32_16x16x32_bf16 v[128:131], v[80:83], a[200:203], v[128:131]
ds_read_b64_tr_b16 v[118:119], v11 offset:19456
ds_read_b64_tr_b16 v[120:121], v12 offset:3072
v_mfma_f32_16x16x32_bf16 v[144:147], v[80:83], a[204:207], v[144:147]
ds_read_b64_tr_b16 v[122:123], v12 offset:19456
v_mul_f32 v249, v249, v241
v_mfma_f32_16x16x32_bf16 v[132:135], v[84:87], a[200:203], v[132:135]
ds_read_b64_tr_b16 v[124:125], v13 offset:3072
s_add_u32 m0, s76, 102400
v_mfma_f32_16x16x32_bf16 v[148:151], v[84:87], a[204:207], v[148:151]
ds_read_b64_tr_b16 v[126:127], v13 offset:19456
s_waitcnt lgkmcnt(6)
v_mfma_f32_16x16x32_bf16 v[136:139], v[88:91], a[200:203], v[136:139]
ds_read_b64_tr_b16 v[80:81], v10 offset:4096
s_add_u32 s77, s25, 0x460000
v_mfma_f32_16x16x32_bf16 v[152:155], v[88:91], a[204:207], v[152:155]
buffer_load_dwordx4 v30, s[44:47], s77 offen offset:0 lds
v_mfma_f32_16x16x32_bf16 v[140:143], v[92:95], a[200:203], v[140:143]
ds_read_b64_tr_b16 v[82:83], v10 offset:20480
ds_read_b64_tr_b16 v[84:85], v11 offset:4096
v_mfma_f32_16x16x32_bf16 v[156:159], v[92:95], a[204:207], v[156:159]
ds_read_b64_tr_b16 v[86:87], v11 offset:20480
v_mul_f32 v250, v250, v242
v_mfma_f32_16x16x32_bf16 v[128:131], v[96:99], a[208:211], v[128:131]
ds_read_b64_tr_b16 v[88:89], v12 offset:4096
v_mul_f32 v251, v251, v243
v_mfma_f32_16x16x32_bf16 v[144:147], v[96:99], a[212:215], v[144:147]
ds_read_b64_tr_b16 v[90:91], v12 offset:20480
v_mul_f32 v252, v252, v244
v_mfma_f32_16x16x32_bf16 v[132:135], v[100:103], a[208:211], v[132:135]
ds_read_b64_tr_b16 v[92:93], v13 offset:4096
v_mul_f32 v253, v253, v245
v_mfma_f32_16x16x32_bf16 v[148:151], v[100:103], a[212:215], v[148:151]
buffer_load_dwordx4 v31, s[44:47], s77 offen offset:1024 lds
v_mfma_f32_16x16x32_bf16 v[136:139], v[104:107], a[208:211], v[136:139]
ds_read_b64_tr_b16 v[94:95], v13 offset:20480
ds_read_b64_tr_b16 v[96:97], v10 offset:5120
v_mfma_f32_16x16x32_bf16 v[152:155], v[104:107], a[212:215], v[152:155]
ds_read_b64_tr_b16 v[98:99], v10 offset:21504
v_mul_f32 v254, v254, v246
v_mfma_f32_16x16x32_bf16 v[140:143], v[108:111], a[208:211], v[140:143]
ds_read_b64_tr_b16 v[100:101], v11 offset:5120
v_mul_f32 v255, v255, v247
v_mfma_f32_16x16x32_bf16 v[156:159], v[108:111], a[212:215], v[156:159]
ds_read_b64_tr_b16 v[102:103], v11 offset:21504
v_cvt_pk_bf16_f32 v248, v248, v249
v_mfma_f32_16x16x32_bf16 v[128:131], v[112:115], a[216:219], v[128:131]
ds_read_b64_tr_b16 v[104:105], v12 offset:5120
v_cvt_pk_bf16_f32 v249, v250, v251
v_mfma_f32_16x16x32_bf16 v[144:147], v[112:115], a[220:223], v[144:147]
ds_read_b64_tr_b16 v[106:107], v12 offset:21504
s_waitcnt lgkmcnt(7)
v_mfma_f32_16x16x32_bf16 v[132:135], v[116:119], a[216:219], v[132:135]
buffer_load_dwordx4 v32, s[44:47], s77 offen offset:2048 lds
v_mfma_f32_16x16x32_bf16 v[148:151], v[116:119], a[220:223], v[148:151]
ds_read_b64_tr_b16 v[108:109], v13 offset:5120
ds_read_b64_tr_b16 v[110:111], v13 offset:21504
v_mfma_f32_16x16x32_bf16 v[136:139], v[120:123], a[216:219], v[136:139]
ds_read_b64_tr_b16 v[112:113], v10 offset:6144
v_cvt_pk_bf16_f32 v250, v252, v253
v_mfma_f32_16x16x32_bf16 v[152:155], v[120:123], a[220:223], v[152:155]
ds_read_b64_tr_b16 v[114:115], v10 offset:22528
v_cvt_pk_bf16_f32 v251, v254, v255
v_mfma_f32_16x16x32_bf16 v[140:143], v[124:127], a[216:219], v[140:143]
buffer_store_dwordx4 v[248:251], v46, s[60:63], s5 offen offset:1024 sc1
v_mfma_f32_16x16x32_bf16 v[156:159], v[124:127], a[220:223], v[156:159]
ds_read_b64_tr_b16 v[116:117], v11 offset:6144
ds_read_b64_tr_b16 v[118:119], v11 offset:22528
v_mfma_f32_16x16x32_bf16 v[128:131], v[80:83], a[224:227], v[128:131]
buffer_load_dwordx4 v33, s[44:47], s77 offen offset:3072 lds
v_mfma_f32_16x16x32_bf16 v[144:147], v[80:83], a[228:231], v[144:147]
ds_read_b64_tr_b16 v[120:121], v12 offset:6144
ds_read_b64_tr_b16 v[122:123], v12 offset:22528
v_mfma_f32_16x16x32_bf16 v[132:135], v[84:87], a[224:227], v[132:135]
ds_read_b64_tr_b16 v[124:125], v13 offset:6144
v_mfma_f32_16x16x32_bf16 v[148:151], v[84:87], a[228:231], v[148:151]
ds_read_b64_tr_b16 v[126:127], v13 offset:22528
ds_read_b64_tr_b16 v[80:81], v10 offset:7168
v_mfma_f32_16x16x32_bf16 v[136:139], v[88:91], a[224:227], v[136:139]
ds_read_b64_tr_b16 v[82:83], v10 offset:23552
v_mfma_f32_16x16x32_bf16 v[152:155], v[88:91], a[228:231], v[152:155]
ds_read_b64_tr_b16 v[84:85], v11 offset:7168
s_waitcnt lgkmcnt(7)
v_mfma_f32_16x16x32_bf16 v[140:143], v[92:95], a[224:227], v[140:143]
ds_read_b64_tr_b16 v[86:87], v11 offset:23552
ds_read_b64_tr_b16 v[88:89], v12 offset:7168
v_mfma_f32_16x16x32_bf16 v[156:159], v[92:95], a[228:231], v[156:159]
ds_read_b64_tr_b16 v[90:91], v12 offset:23552
v_mfma_f32_16x16x32_bf16 v[128:131], v[96:99], a[232:235], v[128:131]
ds_read_b64_tr_b16 v[92:93], v13 offset:7168
v_mfma_f32_16x16x32_bf16 v[144:147], v[96:99], a[236:239], v[144:147]
ds_read_b64_tr_b16 v[94:95], v13 offset:23552
v_mfma_f32_16x16x32_bf16 v[132:135], v[100:103], a[232:235], v[132:135]
v_mfma_f32_16x16x32_bf16 v[148:151], v[100:103], a[236:239], v[148:151]
v_mfma_f32_16x16x32_bf16 v[136:139], v[104:107], a[232:235], v[136:139]
v_mfma_f32_16x16x32_bf16 v[152:155], v[104:107], a[236:239], v[152:155]
v_mfma_f32_16x16x32_bf16 v[140:143], v[108:111], a[232:235], v[140:143]
s_waitcnt vmcnt(18) lgkmcnt(0)
s_barrier
v_mfma_f32_16x16x32_bf16 v[156:159], v[108:111], a[236:239], v[156:159]
ds_read_b64_tr_b16 v[96:97], v10 offset:32768
ds_read_b64_tr_b16 v[98:99], v10 offset:49152
v_mfma_f32_16x16x32_bf16 v[128:131], v[112:115], a[240:243], v[128:131]
ds_read_b64_tr_b16 v[100:101], v11 offset:32768
s_add_u32 m0, s76, 0
v_mfma_f32_16x16x32_bf16 v[144:147], v[112:115], a[244:247], v[144:147]
ds_read_b64_tr_b16 v[102:103], v11 offset:49152
s_add_u32 s77, s25, 0x540000
v_mfma_f32_16x16x32_bf16 v[132:135], v[116:119], a[240:243], v[132:135]
buffer_load_dwordx4 v30, s[44:47], s77 offen offset:0 lds
v_mfma_f32_16x16x32_bf16 v[148:151], v[116:119], a[244:247], v[148:151]
ds_read_b64_tr_b16 v[104:105], v12 offset:32768
ds_read_b64_tr_b16 v[106:107], v12 offset:49152
v_mfma_f32_16x16x32_bf16 v[136:139], v[120:123], a[240:243], v[136:139]
ds_read_b64_tr_b16 v[108:109], v13 offset:32768
v_mfma_f32_16x16x32_bf16 v[152:155], v[120:123], a[244:247], v[152:155]
ds_read_b64_tr_b16 v[110:111], v13 offset:49152
ds_read_b64_tr_b16 v[112:113], v10 offset:33792
v_mfma_f32_16x16x32_bf16 v[140:143], v[124:127], a[240:243], v[140:143]
ds_read_b64_tr_b16 v[114:115], v10 offset:50176
v_mfma_f32_16x16x32_bf16 v[156:159], v[124:127], a[244:247], v[156:159]
ds_read_b64_tr_b16 v[116:117], v11 offset:33792
ds_read_b64_tr_b16 v[118:119], v11 offset:50176
v_mfma_f32_16x16x32_bf16 v[128:131], v[80:83], a[248:251], v[128:131]
buffer_load_dwordx4 v31, s[44:47], s77 offen offset:1024 lds
v_mfma_f32_16x16x32_bf16 v[144:147], v[80:83], a[252:255], v[144:147]
ds_read_b64_tr_b16 v[120:121], v12 offset:33792
ds_read_b64_tr_b16 v[122:123], v12 offset:50176
v_mfma_f32_16x16x32_bf16 v[132:135], v[84:87], a[248:251], v[132:135]
ds_read_b64_tr_b16 v[124:125], v13 offset:33792
v_mfma_f32_16x16x32_bf16 v[148:151], v[84:87], a[252:255], v[148:151]
ds_read_b64_tr_b16 v[126:127], v13 offset:50176
ds_read_b64_tr_b16 v[80:81], v10 offset:34816
v_mfma_f32_16x16x32_bf16 v[136:139], v[88:91], a[248:251], v[136:139]
ds_read_b64_tr_b16 v[82:83], v10 offset:51200
v_mfma_f32_16x16x32_bf16 v[152:155], v[88:91], a[252:255], v[152:155]
ds_read_b64_tr_b16 v[84:85], v11 offset:34816
ds_read_b64_tr_b16 v[86:87], v11 offset:51200
v_mfma_f32_16x16x32_bf16 v[140:143], v[92:95], a[248:251], v[140:143]
buffer_load_dwordx4 v32, s[44:47], s77 offen offset:2048 lds
v_mfma_f32_16x16x32_bf16 v[156:159], v[92:95], a[252:255], v[156:159]
ds_read_b64_tr_b16 v[88:89], v12 offset:34816
ds_read_b64_tr_b16 v[90:91], v12 offset:51200
S_U2:
s_waitcnt lgkmcnt(8)
v_mfma_f32_16x16x32_bf16 v[192:195], v[96:99], a[0:3], 0
ds_read_b64_tr_b16 v[92:93], v13 offset:34816
v_mfma_f32_16x16x32_bf16 v[208:211], v[96:99], a[4:7], 0
ds_read_b64_tr_b16 v[94:95], v13 offset:51200
v_mfma_f32_16x16x32_bf16 v[196:199], v[100:103], a[0:3], 0
ds_read_b64_tr_b16 v[96:97], v10 offset:35840
v_mfma_f32_16x16x32_bf16 v[212:215], v[100:103], a[4:7], 0
s_add_u32 s70, s0, S_DA - K_pc + 0
s_addc_u32 s71, s1, 0
global_load_dword v57, v9, s[70:71]
v_mfma_f32_16x16x32_bf16 v[200:203], v[104:107], a[0:3], 0
ds_read_b64_tr_b16 v[98:99], v10 offset:52224
v_mul_f32 v68, v60, v128
v_mfma_f32_16x16x32_bf16 v[216:219], v[104:107], a[4:7], 0
buffer_load_dwordx4 v33, s[44:47], s77 offen offset:3072 lds
v_mfma_f32_16x16x32_bf16 v[204:207], v[108:111], a[0:3], 0
s_waitcnt vmcnt(6)
s_atomic_add s69, s[60:61], s24 offset:768
v_mfma_f32_16x16x32_bf16 v[220:223], v[108:111], a[4:7], 0
ds_read_b64_tr_b16 v[100:101], v11 offset:35840
ds_read_b64_tr_b16 v[102:103], v11 offset:52224
v_mfma_f32_16x16x32_bf16 v[192:195], v[112:115], a[8:11], v[192:195]
s_add_u32 s70, s0, S_DA - K_pc + 8192
s_addc_u32 s71, s1, 0
global_load_dword v57, v9, s[70:71]
v_mfma_f32_16x16x32_bf16 v[208:211], v[112:115], a[12:15], v[208:211]
ds_read_b64_tr_b16 v[104:105], v12 offset:35840
ds_read_b64_tr_b16 v[106:107], v12 offset:52224
v_mfma_f32_16x16x32_bf16 v[196:199], v[116:119], a[8:11], v[196:199]
ds_read_b64_tr_b16 v[108:109], v13 offset:35840
s_add_u32 m0, s76, 4096
v_mfma_f32_16x16x32_bf16 v[212:215], v[116:119], a[12:15], v[212:215]
ds_read_b64_tr_b16 v[110:111], v13 offset:52224
s_add_u32 s77, s25, 0x620000
v_mfma_f32_16x16x32_bf16 v[200:203], v[120:123], a[8:11], v[200:203]
buffer_load_dwordx4 v30, s[44:47], s77 offen offset:0 lds
v_mfma_f32_16x16x32_bf16 v[216:219], v[120:123], a[12:15], v[216:219]
ds_read_b64_tr_b16 v[112:113], v10 offset:36864
s_waitcnt lgkmcnt(5)
v_mfma_f32_16x16x32_bf16 v[204:207], v[124:127], a[8:11], v[204:207]
ds_read_b64_tr_b16 v[114:115], v10 offset:53248
ds_read_b64_tr_b16 v[116:117], v11 offset:36864
v_mfma_f32_16x16x32_bf16 v[220:223], v[124:127], a[12:15], v[220:223]
ds_read_b64_tr_b16 v[118:119], v11 offset:53248
v_mul_f32 v69, v60, v129
v_mfma_f32_16x16x32_bf16 v[192:195], v[80:83], a[16:19], v[192:195]
ds_read_b64_tr_b16 v[120:121], v12 offset:36864
v_mul_f32 v70, v60, v130
v_mfma_f32_16x16x32_bf16 v[208:211], v[80:83], a[20:23], v[208:211]
ds_read_b64_tr_b16 v[122:123], v12 offset:53248
v_mul_f32 v71, v60, v131
v_mfma_f32_16x16x32_bf16 v[196:199], v[84:87], a[16:19], v[196:199]
buffer_load_dwordx4 v31, s[44:47], s77 offen offset:1024 lds
v_mfma_f32_16x16x32_bf16 v[212:215], v[84:87], a[20:23], v[212:215]
ds_read_b64_tr_b16 v[124:125], v13 offset:36864
ds_read_b64_tr_b16 v[126:127], v13 offset:53248
v_mfma_f32_16x16x32_bf16 v[200:203], v[88:91], a[16:19], v[200:203]
v_exp_f32 v68, v68
v_mfma_f32_16x16x32_bf16 v[216:219], v[88:91], a[20:23], v[216:219]
ds_read_b64_tr_b16 v[80:81], v10 offset:37888
ds_read_b64_tr_b16 v[82:83], v10 offset:54272
v_mfma_f32_16x16x32_bf16 v[204:207], v[92:95], a[16:19], v[204:207]
v_exp_f32 v69, v69
v_mfma_f32_16x16x32_bf16 v[220:223], v[92:95], a[20:23], v[220:223]
ds_read_b64_tr_b16 v[84:85], v11 offset:37888
ds_read_b64_tr_b16 v[86:87], v11 offset:54272
v_mfma_f32_16x16x32_bf16 v[192:195], v[96:99], a[24:27], v[192:195]
buffer_load_dwordx4 v32, s[44:47], s77 offen offset:2048 lds
v_mfma_f32_16x16x32_bf16 v[208:211], v[96:99], a[28:31], v[208:211]
ds_read_b64_tr_b16 v[88:89], v12 offset:37888
ds_read_b64_tr_b16 v[90:91], v12 offset:54272
v_mfma_f32_16x16x32_bf16 v[196:199], v[100:103], a[24:27], v[196:199]
v_exp_f32 v70, v70
v_mfma_f32_16x16x32_bf16 v[212:215], v[100:103], a[28:31], v[212:215]
ds_read_b64_tr_b16 v[92:93], v13 offset:37888
s_waitcnt lgkmcnt(5)
v_mfma_f32_16x16x32_bf16 v[200:203], v[104:107], a[24:27], v[200:203]
v_exp_f32 v71, v71
v_mfma_f32_16x16x32_bf16 v[216:219], v[104:107], a[28:31], v[216:219]
ds_read_b64_tr_b16 v[94:95], v13 offset:54272
ds_read_b64_tr_b16 v[96:97], v10 offset:38912
v_mfma_f32_16x16x32_bf16 v[204:207], v[108:111], a[24:27], v[204:207]
buffer_load_dwordx4 v33, s[44:47], s77 offen offset:3072 lds
v_mfma_f32_16x16x32_bf16 v[220:223], v[108:111], a[28:31], v[220:223]
ds_read_b64_tr_b16 v[98:99], v10 offset:55296
ds_read_b64_tr_b16 v[100:101], v11 offset:38912
v_mfma_f32_16x16x32_bf16 v[192:195], v[112:115], a[32:35], v[192:195]
ds_read_b64_tr_b16 v[102:103], v11 offset:55296
v_fma_f32 v68, v68, v62, v62
v_mfma_f32_16x16x32_bf16 v[208:211], v[112:115], a[36:39], v[208:211]
ds_read_b64_tr_b16 v[104:105], v12 offset:38912
ds_read_b64_tr_b16 v[106:107], v12 offset:55296
v_mfma_f32_16x16x32_bf16 v[196:199], v[116:119], a[32:35], v[196:199]
ds_read_b64_tr_b16 v[108:109], v13 offset:38912
v_fma_f32 v69, v69, v62, v62
v_mfma_f32_16x16x32_bf16 v[212:215], v[116:119], a[36:39], v[212:215]
ds_read_b64_tr_b16 v[110:111], v13 offset:55296
v_fma_f32 v70, v70, v62, v62
v_mfma_f32_16x16x32_bf16 v[200:203], v[120:123], a[32:35], v[200:203]
ds_read_b64_tr_b16 v[112:113], v10 offset:39936
v_fma_f32 v71, v71, v62, v62
v_mfma_f32_16x16x32_bf16 v[216:219], v[120:123], a[36:39], v[216:219]
v_rcp_f32 v68, v68
v_mfma_f32_16x16x32_bf16 v[204:207], v[124:127], a[32:35], v[204:207]
ds_read_b64_tr_b16 v[114:115], v10 offset:56320
ds_read_b64_tr_b16 v[116:117], v11 offset:39936
v_mfma_f32_16x16x32_bf16 v[220:223], v[124:127], a[36:39], v[220:223]
v_rcp_f32 v69, v69
v_mfma_f32_16x16x32_bf16 v[192:195], v[80:83], a[40:43], v[192:195]
ds_read_b64_tr_b16 v[118:119], v11 offset:56320
ds_read_b64_tr_b16 v[120:121], v12 offset:39936
v_mfma_f32_16x16x32_bf16 v[208:211], v[80:83], a[44:47], v[208:211]
ds_read_b64_tr_b16 v[122:123], v12 offset:56320
s_waitcnt lgkmcnt(6)
v_mfma_f32_16x16x32_bf16 v[196:199], v[84:87], a[40:43], v[196:199]
v_rcp_f32 v70, v70
v_mfma_f32_16x16x32_bf16 v[212:215], v[84:87], a[44:47], v[212:215]
ds_read_b64_tr_b16 v[124:125], v13 offset:39936
ds_read_b64_tr_b16 v[126:127], v13 offset:56320
v_mfma_f32_16x16x32_bf16 v[200:203], v[88:91], a[40:43], v[200:203]
v_rcp_f32 v71, v71
v_mfma_f32_16x16x32_bf16 v[216:219], v[88:91], a[44:47], v[216:219]
v_mul_f32 v128, v128, v68
v_mul_f32 v129, v129, v69
v_mfma_f32_16x16x32_bf16 v[204:207], v[92:95], a[40:43], v[204:207]
v_mul_f32 v130, v130, v70
v_mul_f32 v131, v131, v71
v_mfma_f32_16x16x32_bf16 v[220:223], v[92:95], a[44:47], v[220:223]
v_mul_f32 v72, v60, v132
v_mul_f32 v73, v60, v133
v_mfma_f32_16x16x32_bf16 v[192:195], v[96:99], a[48:51], v[192:195]
s_waitcnt lgkmcnt(0)
s_barrier
v_mfma_f32_16x16x32_bf16 v[208:211], v[96:99], a[52:55], v[208:211]
ds_read_b64_tr_b16 v[80:81], v14 offset:0
ds_read_b64_tr_b16 v[82:83], v14 offset:16384
v_mfma_f32_16x16x32_bf16 v[196:199], v[100:103], a[48:51], v[196:199]
ds_read_b64_tr_b16 v[84:85], v15 offset:0
s_add_u32 m0, s76, 32768
v_mfma_f32_16x16x32_bf16 v[212:215], v[100:103], a[52:55], v[212:215]
ds_read_b64_tr_b16 v[86:87], v15 offset:16384
s_add_u32 s77, s97, 0x0
v_mfma_f32_16x16x32_bf16 v[200:203], v[104:107], a[48:51], v[200:203]
ds_read_b64_tr_b16 v[88:89], v16 offset:0
ds_read_b64_tr_b16 v[90:91], v16 offset:16384
v_mfma_f32_16x16x32_bf16 v[216:219], v[104:107], a[52:55], v[216:219]
buffer_load_dwordx4 v38, s[48:51], s77 offen offset:0 lds
v_mfma_f32_16x16x32_bf16 v[204:207], v[108:111], a[48:51], v[204:207]
ds_read_b64_tr_b16 v[92:93], v17 offset:0
ds_read_b64_tr_b16 v[94:95], v17 offset:16384
v_mfma_f32_16x16x32_bf16 v[220:223], v[108:111], a[52:55], v[220:223]
ds_read_b64_tr_b16 v[96:97], v14 offset:1024
v_mul_f32 v74, v60, v134
v_mfma_f32_16x16x32_bf16 v[192:195], v[112:115], a[56:59], v[192:195]
ds_read_b64_tr_b16 v[98:99], v14 offset:17408
ds_read_b64_tr_b16 v[100:101], v15 offset:1024
v_mfma_f32_16x16x32_bf16 v[208:211], v[112:115], a[60:63], v[208:211]
ds_read_b64_tr_b16 v[102:103], v15 offset:17408
v_mul_f32 v75, v60, v135
v_mfma_f32_16x16x32_bf16 v[196:199], v[116:119], a[56:59], v[196:199]
v_exp_f32 v72, v72
v_mfma_f32_16x16x32_bf16 v[212:215], v[116:119], a[60:63], v[212:215]
ds_read_b64_tr_b16 v[104:105], v16 offset:1024
ds_read_b64_tr_b16 v[106:107], v16 offset:17408
v_mfma_f32_16x16x32_bf16 v[200:203], v[120:123], a[56:59], v[200:203]
buffer_load_dwordx4 v39, s[48:51], s77 offen offset:1024 lds
v_mfma_f32_16x16x32_bf16 v[216:219], v[120:123], a[60:63], v[216:219]
ds_read_b64_tr_b16 v[108:109], v17 offset:1024
ds_read_b64_tr_b16 v[110:111], v17 offset:17408
v_mfma_f32_16x16x32_bf16 v[204:207], v[124:127], a[56:59], v[204:207]
v_exp_f32 v73, v73
v_mfma_f32_16x16x32_bf16 v[220:223], v[124:127], a[60:63], v[220:223]
ds_read_b64_tr_b16 v[112:113], v14 offset:2048
s_waitcnt lgkmcnt(5)
v_mfma_f32_16x16x32_bf16 v[192:195], v[80:83], a[64:67], v[192:195]
v_exp_f32 v74, v74
v_mfma_f32_16x16x32_bf16 v[208:211], v[80:83], a[68:71], v[208:211]
ds_read_b64_tr_b16 v[114:115], v14 offset:18432
ds_read_b64_tr_b16 v[116:117], v15 offset:2048
v_mfma_f32_16x16x32_bf16 v[196:199], v[84:87], a[64:67], v[196:199]
buffer_load_dwordx4 v40, s[48:51], s77 offen offset:2048 lds
v_mfma_f32_16x16x32_bf16 v[212:215], v[84:87], a[68:71], v[212:215]
ds_read_b64_tr_b16 v[118:119], v15 offset:18432
ds_read_b64_tr_b16 v[120:121], v16 offset:2048
v_mfma_f32_16x16x32_bf16 v[200:203], v[88:91], a[64:67], v[200:203]
v_exp_f32 v75, v75
v_mfma_f32_16x16x32_bf16 v[216:219], v[88:91], a[68:71], v[216:219]
ds_read_b64_tr_b16 v[122:123], v16 offset:18432
ds_read_b64_tr_b16 v[124:125], v17 offset:2048
v_mfma_f32_16x16x32_bf16 v[204:207], v[92:95], a[64:67], v[204:207]
ds_read_b64_tr_b16 v[126:127], v17 offset:18432
v_fma_f32 v72, v72, v62, v62
v_mfma_f32_16x16x32_bf16 v[220:223], v[92:95], a[68:71], v[220:223]
ds_read_b64_tr_b16 v[80:81], v14 offset:3072
ds_read_b64_tr_b16 v[82:83], v14 offset:19456
v_mfma_f32_16x16x32_bf16 v[192:195], v[96:99], a[72:75], v[192:195]
buffer_load_dwordx4 v41, s[48:51], s77 offen offset:3072 lds
v_mfma_f32_16x16x32_bf16 v[208:211], v[96:99], a[76:79], v[208:211]
ds_read_b64_tr_b16 v[84:85], v15 offset:3072
ds_read_b64_tr_b16 v[86:87], v15 offset:19456
v_mfma_f32_16x16x32_bf16 v[196:199], v[100:103], a[72:75], v[196:199]
ds_read_b64_tr_b16 v[88:89], v16 offset:3072
v_fma_f32 v73, v73, v62, v62
v_mfma_f32_16x16x32_bf16 v[212:215], v[100:103], a[76:79], v[212:215]
ds_read_b64_tr_b16 v[90:91], v16 offset:19456
s_waitcnt lgkmcnt(7)
v_mfma_f32_16x16x32_bf16 v[200:203], v[104:107], a[72:75], v[200:203]
ds_read_b64_tr_b16 v[92:93], v17 offset:3072
s_add_u32 m0, s76, 36864
v_mfma_f32_16x16x32_bf16 v[216:219], v[104:107], a[76:79], v[216:219]
ds_read_b64_tr_b16 v[94:95], v17 offset:19456
s_add_u32 s77, s98, 0x0
v_mfma_f32_16x16x32_bf16 v[204:207], v[108:111], a[72:75], v[204:207]
buffer_load_dwordx4 v38, s[48:51], s77 offen offset:0 lds
v_mfma_f32_16x16x32_bf16 v[220:223], v[108:111], a[76:79], v[220:223]
ds_read_b64_tr_b16 v[96:97], v14 offset:4096
ds_read_b64_tr_b16 v[98:99], v14 offset:20480
v_mfma_f32_16x16x32_bf16 v[192:195], v[112:115], a[80:83], v[192:195]
ds_read_b64_tr_b16 v[100:101], v15 offset:4096
v_fma_f32 v74, v74, v62, v62
v_mfma_f32_16x16x32_bf16 v[208:211], v[112:115], a[84:87], v[208:211]
ds_read_b64_tr_b16 v[102:103], v15 offset:20480
ds_read_b64_tr_b16 v[104:105], v16 offset:4096
v_mfma_f32_16x16x32_bf16 v[196:199], v[116:119], a[80:83], v[196:199]
ds_read_b64_tr_b16 v[106:107], v16 offset:20480
v_fma_f32 v75, v75, v62, v62
v_mfma_f32_16x16x32_bf16 v[212:215], v[116:119], a[84:87], v[212:215]
v_rcp_f32 v72, v72
v_mfma_f32_16x16x32_bf16 v[200:203], v[120:123], a[80:83], v[200:203]
ds_read_b64_tr_b16 v[108:109], v17 offset:4096
ds_read_b64_tr_b16 v[110:111], v17 offset:20480
v_mfma_f32_16x16x32_bf16 v[216:219], v[120:123], a[84:87], v[216:219]
ds_read_b64_tr_b16 v[112:113], v14 offset:5120
s_waitcnt lgkmcnt(7)
v_mfma_f32_16x16x32_bf16 v[204:207], v[124:127], a[80:83], v[204:207]
buffer_load_dwordx4 v39, s[48:51], s77 offen offset:1024 lds
v_mfma_f32_16x16x32_bf16 v[220:223], v[124:127], a[84:87], v[220:223]
ds_read_b64_tr_b16 v[114:115], v14 offset:21504
ds_read_b64_tr_b16 v[116:117], v15 offset:5120
v_mfma_f32_16x16x32_bf16 v[192:195], v[80:83], a[88:91], v[192:195]
v_rcp_f32 v73, v73
v_mfma_f32_16x16x32_bf16 v[208:211], v[80:83], a[92:95], v[208:211]
ds_read_b64_tr_b16 v[118:119], v15 offset:21504
ds_read_b64_tr_b16 v[120:121], v16 offset:5120
v_mfma_f32_16x16x32_bf16 v[196:199], v[84:87], a[88:91], v[196:199]
v_rcp_f32 v74, v74
v_mfma_f32_16x16x32_bf16 v[212:215], v[84:87], a[92:95], v[212:215]
ds_read_b64_tr_b16 v[122:123], v16 offset:21504
ds_read_b64_tr_b16 v[124:125], v17 offset:5120
v_mfma_f32_16x16x32_bf16 v[200:203], v[88:91], a[88:91], v[200:203]
buffer_load_dwordx4 v40, s[48:51], s77 offen offset:2048 lds
v_mfma_f32_16x16x32_bf16 v[216:219], v[88:91], a[92:95], v[216:219]
ds_read_b64_tr_b16 v[126:127], v17 offset:21504
ds_read_b64_tr_b16 v[80:81], v14 offset:6144
v_mfma_f32_16x16x32_bf16 v[204:207], v[92:95], a[88:91], v[204:207]
v_rcp_f32 v75, v75
v_mfma_f32_16x16x32_bf16 v[220:223], v[92:95], a[92:95], v[220:223]
ds_read_b64_tr_b16 v[82:83], v14 offset:22528
ds_read_b64_tr_b16 v[84:85], v15 offset:6144
v_mfma_f32_16x16x32_bf16 v[192:195], v[96:99], a[96:99], v[192:195]
ds_read_b64_tr_b16 v[86:87], v15 offset:22528
v_mul_f32 v132, v132, v72
v_mfma_f32_16x16x32_bf16 v[208:211], v[96:99], a[100:103], v[208:211]
ds_read_b64_tr_b16 v[88:89], v16 offset:6144
s_waitcnt lgkmcnt(6)
v_mfma_f32_16x16x32_bf16 v[196:199], v[100:103], a[96:99], v[196:199]
buffer_load_dwordx4 v41, s[48:51], s77 offen offset:3072 lds
v_mfma_f32_16x16x32_bf16 v[212:215], v[100:103], a[100:103], v[212:215]
ds_read_b64_tr_b16 v[90:91], v16 offset:22528
ds_read_b64_tr_b16 v[92:93], v17 offset:6144
v_mfma_f32_16x16x32_bf16 v[200:203], v[104:107], a[96:99], v[200:203]
ds_read_b64_tr_b16 v[94:95], v17 offset:22528
v_mul_f32 v133, v133, v73
v_mfma_f32_16x16x32_bf16 v[216:219], v[104:107], a[100:103], v[216:219]
ds_read_b64_tr_b16 v[96:97], v14 offset:7168
ds_read_b64_tr_b16 v[98:99], v14 offset:23552
v_mfma_f32_16x16x32_bf16 v[204:207], v[108:111], a[96:99], v[204:207]
ds_read_b64_tr_b16 v[100:101], v15 offset:7168
v_mul_f32 v134, v134, v74
v_mfma_f32_16x16x32_bf16 v[220:223], v[108:111], a[100:103], v[220:223]
ds_read_b64_tr_b16 v[102:103], v15 offset:23552
v_mul_f32 v135, v135, v75
v_mfma_f32_16x16x32_bf16 v[192:195], v[112:115], a[104:107], v[192:195]
ds_read_b64_tr_b16 v[104:105], v16 offset:7168
v_mul_f32 v68, v60, v136
v_mfma_f32_16x16x32_bf16 v[208:211], v[112:115], a[108:111], v[208:211]
ds_read_b64_tr_b16 v[106:107], v16 offset:23552
v_mul_f32 v69, v60, v137
v_mfma_f32_16x16x32_bf16 v[196:199], v[116:119], a[104:107], v[196:199]
ds_read_b64_tr_b16 v[108:109], v17 offset:7168
v_mul_f32 v70, v60, v138
v_mfma_f32_16x16x32_bf16 v[212:215], v[116:119], a[108:111], v[212:215]
ds_read_b64_tr_b16 v[110:111], v17 offset:23552
v_mul_f32 v71, v60, v139
v_mfma_f32_16x16x32_bf16 v[200:203], v[120:123], a[104:107], v[200:203]
v_exp_f32 v68, v68
v_mfma_f32_16x16x32_bf16 v[216:219], v[120:123], a[108:111], v[216:219]
s_waitcnt lgkmcnt(4)
v_mfma_f32_16x16x32_bf16 v[204:207], v[124:127], a[104:107], v[204:207]
v_exp_f32 v69, v69
v_mfma_f32_16x16x32_bf16 v[220:223], v[124:127], a[108:111], v[220:223]
v_exp_f32 v70, v70
v_mfma_f32_16x16x32_bf16 v[192:195], v[80:83], a[112:115], v[192:195]
s_waitcnt vmcnt(18) lgkmcnt(0)
s_barrier
s_mov_b32 s87, 0
s_atomic_add s87, s[60:61], s24 offset:768 glc
v_mfma_f32_16x16x32_bf16 v[208:211], v[80:83], a[116:119], v[208:211]
ds_read_b64_tr_b16 v[112:113], v14 offset:32768
ds_read_b64_tr_b16 v[114:115], v14 offset:49152
v_mfma_f32_16x16x32_bf16 v[196:199], v[84:87], a[112:115], v[196:199]
ds_read_b64_tr_b16 v[116:117], v15 offset:32768
s_add_u32 m0, s76, 65536
v_mfma_f32_16x16x32_bf16 v[212:215], v[84:87], a[116:119], v[212:215]
ds_read_b64_tr_b16 v[118:119], v15 offset:49152
s_add_u32 s77, s99, 0x0
v_mfma_f32_16x16x32_bf16 v[200:203], v[88:91], a[112:115], v[200:203]
ds_read_b64_tr_b16 v[120:121], v16 offset:32768
ds_read_b64_tr_b16 v[122:123], v16 offset:49152
v_mfma_f32_16x16x32_bf16 v[216:219], v[88:91], a[116:119], v[216:219]
buffer_load_dwordx4 v38, s[48:51], s77 offen offset:0 lds
v_mfma_f32_16x16x32_bf16 v[204:207], v[92:95], a[112:115], v[204:207]
ds_read_b64_tr_b16 v[124:125], v17 offset:32768
ds_read_b64_tr_b16 v[126:127], v17 offset:49152
v_mfma_f32_16x16x32_bf16 v[220:223], v[92:95], a[116:119], v[220:223]
v_exp_f32 v71, v71
v_mfma_f32_16x16x32_bf16 v[192:195], v[96:99], a[120:123], v[192:195]
ds_read_b64_tr_b16 v[80:81], v14 offset:33792
ds_read_b64_tr_b16 v[82:83], v14 offset:50176
v_mfma_f32_16x16x32_bf16 v[208:211], v[96:99], a[124:127], v[208:211]
ds_read_b64_tr_b16 v[84:85], v15 offset:33792
v_fma_f32 v68, v68, v62, v62
v_mfma_f32_16x16x32_bf16 v[196:199], v[100:103], a[120:123], v[196:199]
ds_read_b64_tr_b16 v[86:87], v15 offset:50176
ds_read_b64_tr_b16 v[88:89], v16 offset:33792
v_mfma_f32_16x16x32_bf16 v[212:215], v[100:103], a[124:127], v[212:215]
buffer_load_dwordx4 v39, s[48:51], s77 offen offset:1024 lds
v_mfma_f32_16x16x32_bf16 v[200:203], v[104:107], a[120:123], v[200:203]
ds_read_b64_tr_b16 v[90:91], v16 offset:50176
ds_read_b64_tr_b16 v[92:93], v17 offset:33792
v_mfma_f32_16x16x32_bf16 v[216:219], v[104:107], a[124:127], v[216:219]
ds_read_b64_tr_b16 v[94:95], v17 offset:50176
v_fma_f32 v69, v69, v62, v62
v_mfma_f32_16x16x32_bf16 v[204:207], v[108:111], a[120:123], v[204:207]
ds_read_b64_tr_b16 v[96:97], v14 offset:34816
ds_read_b64_tr_b16 v[98:99], v14 offset:51200
v_mfma_f32_16x16x32_bf16 v[220:223], v[108:111], a[124:127], v[220:223]
ds_read_b64_tr_b16 v[100:101], v15 offset:34816
s_waitcnt lgkmcnt(8)
v_mfma_f32_16x16x32_bf16 v[192:195], v[112:115], a[128:131], v[192:195]
ds_read_b64_tr_b16 v[102:103], v15 offset:51200
ds_read_b64_tr_b16 v[104:105], v16 offset:34816
v_mfma_f32_16x16x32_bf16 v[208:211], v[112:115], a[132:135], v[208:211]
buffer_load_dwordx4 v40, s[48:51], s77 offen offset:2048 lds
v_mfma_f32_16x16x32_bf16 v[196:199], v[116:119], a[128:131], v[196:199]
ds_read_b64_tr_b16 v[106:107], v16 offset:51200
ds_read_b64_tr_b16 v[108:109], v17 offset:34816
v_mfma_f32_16x16x32_bf16 v[212:215], v[116:119], a[132:135], v[212:215]
ds_read_b64_tr_b16 v[110:111], v17 offset:51200
v_fma_f32 v70, v70, v62, v62
v_mfma_f32_16x16x32_bf16 v[200:203], v[120:123], a[128:131], v[200:203]
ds_read_b64_tr_b16 v[112:113], v14 offset:35840
v_fma_f32 v71, v71, v62, v62
v_mfma_f32_16x16x32_bf16 v[216:219], v[120:123], a[132:135], v[216:219]
v_rcp_f32 v68, v68
v_mfma_f32_16x16x32_bf16 v[204:207], v[124:127], a[128:131], v[204:207]
ds_read_b64_tr_b16 v[114:115], v14 offset:52224
ds_read_b64_tr_b16 v[116:117], v15 offset:35840
v_mfma_f32_16x16x32_bf16 v[220:223], v[124:127], a[132:135], v[220:223]
buffer_load_dwordx4 v41, s[48:51], s77 offen offset:3072 lds
v_mfma_f32_16x16x32_bf16 v[192:195], v[80:83], a[136:139], v[192:195]
ds_read_b64_tr_b16 v[118:119], v15 offset:52224
ds_read_b64_tr_b16 v[120:121], v16 offset:35840
v_mfma_f32_16x16x32_bf16 v[208:211], v[80:83], a[140:143], v[208:211]
ds_read_b64_tr_b16 v[122:123], v16 offset:52224
s_waitcnt lgkmcnt(6)
v_mfma_f32_16x16x32_bf16 v[196:199], v[84:87], a[136:139], v[196:199]
v_rcp_f32 v69, v69
v_mfma_f32_16x16x32_bf16 v[212:215], v[84:87], a[140:143], v[212:215]
ds_read_b64_tr_b16 v[124:125], v17 offset:35840
ds_read_b64_tr_b16 v[126:127], v17 offset:52224
v_mfma_f32_16x16x32_bf16 v[200:203], v[88:91], a[136:139], v[200:203]
v_rcp_f32 v70, v70
v_mfma_f32_16x16x32_bf16 v[216:219], v[88:91], a[140:143], v[216:219]
ds_read_b64_tr_b16 v[80:81], v14 offset:36864
ds_read_b64_tr_b16 v[82:83], v14 offset:53248
v_mfma_f32_16x16x32_bf16 v[204:207], v[92:95], a[136:139], v[204:207]
v_rcp_f32 v71, v71
v_mfma_f32_16x16x32_bf16 v[220:223], v[92:95], a[140:143], v[220:223]
ds_read_b64_tr_b16 v[84:85], v15 offset:36864
ds_read_b64_tr_b16 v[86:87], v15 offset:53248
v_mfma_f32_16x16x32_bf16 v[192:195], v[96:99], a[144:147], v[192:195]
ds_read_b64_tr_b16 v[88:89], v16 offset:36864
s_add_u32 m0, s76, 69632
v_mfma_f32_16x16x32_bf16 v[208:211], v[96:99], a[148:151], v[208:211]
ds_read_b64_tr_b16 v[90:91], v16 offset:53248
s_add_u32 s77, s97, 0x40000
v_mfma_f32_16x16x32_bf16 v[196:199], v[100:103], a[144:147], v[196:199]
buffer_load_dwordx4 v38, s[48:51], s77 offen offset:0 lds
v_mfma_f32_16x16x32_bf16 v[212:215], v[100:103], a[148:151], v[212:215]
ds_read_b64_tr_b16 v[92:93], v17 offset:36864
ds_read_b64_tr_b16 v[94:95], v17 offset:53248
v_mfma_f32_16x16x32_bf16 v[200:203], v[104:107], a[144:147], v[200:203]
ds_read_b64_tr_b16 v[96:97], v14 offset:37888
v_mul_f32 v136, v136, v68
v_mfma_f32_16x16x32_bf16 v[216:219], v[104:107], a[148:151], v[216:219]
ds_read_b64_tr_b16 v[98:99], v14 offset:54272
v_mul_f32 v137, v137, v69
v_mfma_f32_16x16x32_bf16 v[204:207], v[108:111], a[144:147], v[204:207]
ds_read_b64_tr_b16 v[100:101], v15 offset:37888
v_mul_f32 v138, v138, v70
v_mfma_f32_16x16x32_bf16 v[220:223], v[108:111], a[148:151], v[220:223]
ds_read_b64_tr_b16 v[102:103], v15 offset:54272
s_waitcnt lgkmcnt(6)
v_mfma_f32_16x16x32_bf16 v[192:195], v[112:115], a[152:155], v[192:195]
buffer_load_dwordx4 v39, s[48:51], s77 offen offset:1024 lds
v_mfma_f32_16x16x32_bf16 v[208:211], v[112:115], a[156:159], v[208:211]
ds_read_b64_tr_b16 v[104:105], v16 offset:37888
ds_read_b64_tr_b16 v[106:107], v16 offset:54272
v_mfma_f32_16x16x32_bf16 v[196:199], v[116:119], a[152:155], v[196:199]
ds_read_b64_tr_b16 v[108:109], v17 offset:37888
v_mul_f32 v139, v139, v71
v_mfma_f32_16x16x32_bf16 v[212:215], v[116:119], a[156:159], v[212:215]
ds_read_b64_tr_b16 v[110:111], v17 offset:54272
v_mul_f32 v72, v60, v140
v_mfma_f32_16x16x32_bf16 v[200:203], v[120:123], a[152:155], v[200:203]
ds_read_b64_tr_b16 v[112:113], v14 offset:38912
v_mul_f32 v73, v60, v141
v_mfma_f32_16x16x32_bf16 v[216:219], v[120:123], a[156:159], v[216:219]
ds_read_b64_tr_b16 v[114:115], v14 offset:55296
v_mul_f32 v74, v60, v142
v_mfma_f32_16x16x32_bf16 v[204:207], v[124:127], a[152:155], v[204:207]
buffer_load_dwordx4 v40, s[48:51], s77 offen offset:2048 lds
v_mfma_f32_16x16x32_bf16 v[220:223], v[124:127], a[156:159], v[220:223]
ds_read_b64_tr_b16 v[116:117], v15 offset:38912
ds_read_b64_tr_b16 v[118:119], v15 offset:55296
v_mfma_f32_16x16x32_bf16 v[192:195], v[80:83], a[160:163], v[192:195]
ds_read_b64_tr_b16 v[120:121], v16 offset:38912
v_mul_f32 v75, v60, v143
v_mfma_f32_16x16x32_bf16 v[208:211], v[80:83], a[164:167], v[208:211]
v_exp_f32 v72, v72
v_mfma_f32_16x16x32_bf16 v[196:199], v[84:87], a[160:163], v[196:199]
ds_read_b64_tr_b16 v[122:123], v16 offset:55296
ds_read_b64_tr_b16 v[124:125], v17 offset:38912
v_mfma_f32_16x16x32_bf16 v[212:215], v[84:87], a[164:167], v[212:215]
v_exp_f32 v73, v73
v_mfma_f32_16x16x32_bf16 v[200:203], v[88:91], a[160:163], v[200:203]
ds_read_b64_tr_b16 v[126:127], v17 offset:55296
ds_read_b64_tr_b16 v[80:81], v14 offset:39936
v_mfma_f32_16x16x32_bf16 v[216:219], v[88:91], a[164:167], v[216:219]
ds_read_b64_tr_b16 v[82:83], v14 offset:56320
s_waitcnt lgkmcnt(6)
v_mfma_f32_16x16x32_bf16 v[204:207], v[92:95], a[160:163], v[204:207]
buffer_load_dwordx4 v41, s[48:51], s77 offen offset:3072 lds
v_mfma_f32_16x16x32_bf16 v[220:223], v[92:95], a[164:167], v[220:223]
ds_read_b64_tr_b16 v[84:85], v15 offset:39936
ds_read_b64_tr_b16 v[86:87], v15 offset:56320
v_mfma_f32_16x16x32_bf16 v[192:195], v[96:99], a[168:171], v[192:195]
v_exp_f32 v74, v74
v_mfma_f32_16x16x32_bf16 v[208:211], v[96:99], a[172:175], v[208:211]
ds_read_b64_tr_b16 v[88:89], v16 offset:39936
ds_read_b64_tr_b16 v[90:91], v16 offset:56320
v_mfma_f32_16x16x32_bf16 v[196:199], v[100:103], a[168:171], v[196:199]
v_exp_f32 v75, v75
v_mfma_f32_16x16x32_bf16 v[212:215], v[100:103], a[172:175], v[212:215]
ds_read_b64_tr_b16 v[92:93], v17 offset:39936
ds_read_b64_tr_b16 v[94:95], v17 offset:56320
v_mfma_f32_16x16x32_bf16 v[200:203], v[104:107], a[168:171], v[200:203]
v_fma_f32 v72, v72, v62, v62
v_fma_f32 v73, v73, v62, v62
v_mfma_f32_16x16x32_bf16 v[216:219], v[104:107], a[172:175], v[216:219]
v_fma_f32 v74, v74, v62, v62
v_fma_f32 v75, v75, v62, v62
v_mfma_f32_16x16x32_bf16 v[204:207], v[108:111], a[168:171], v[204:207]
v_rcp_f32 v72, v72
v_mfma_f32_16x16x32_bf16 v[220:223], v[108:111], a[172:175], v[220:223]
v_rcp_f32 v73, v73
v_mfma_f32_16x16x32_bf16 v[192:195], v[112:115], a[176:179], v[192:195]
s_waitcnt vmcnt(16) lgkmcnt(0)
s_barrier
s_cmp_lt_u32 s87, 4
s_cbranch_scc1 pl_5_slow
pl_5_ok:
v_mfma_f32_16x16x32_bf16 v[208:211], v[112:115], a[180:183], v[208:211]
ds_read_b64_tr_b16 v[96:97], v10 offset:0
ds_read_b64_tr_b16 v[98:99], v10 offset:16384
v_mfma_f32_16x16x32_bf16 v[196:199], v[116:119], a[176:179], v[196:199]
ds_read_b64_tr_b16 v[100:101], v11 offset:0
s_add_u32 m0, s76, 98304
v_mfma_f32_16x16x32_bf16 v[212:215], v[116:119], a[180:183], v[212:215]
ds_read_b64_tr_b16 v[102:103], v11 offset:16384
s_add_u32 s77, s98, 0x40000
v_mfma_f32_16x16x32_bf16 v[200:203], v[120:123], a[176:179], v[200:203]
ds_read_b64_tr_b16 v[104:105], v12 offset:0
ds_read_b64_tr_b16 v[106:107], v12 offset:16384
v_mfma_f32_16x16x32_bf16 v[216:219], v[120:123], a[180:183], v[216:219]
buffer_load_dwordx4 v38, s[48:51], s77 offen offset:0 lds
v_mfma_f32_16x16x32_bf16 v[204:207], v[124:127], a[176:179], v[204:207]
ds_read_b64_tr_b16 v[108:109], v13 offset:0
ds_read_b64_tr_b16 v[110:111], v13 offset:16384
v_mfma_f32_16x16x32_bf16 v[220:223], v[124:127], a[180:183], v[220:223]
ds_read_b64_tr_b16 v[112:113], v10 offset:1024
s_add_u32 s91, s6, 0
v_mfma_f32_16x16x32_bf16 v[192:195], v[80:83], a[184:187], v[192:195]
buffer_load_dwordx4 a[0:3], v46, s[60:63], s91 offen offset:0 sc1
v_mfma_f32_16x16x32_bf16 v[208:211], v[80:83], a[188:191], v[208:211]
ds_read_b64_tr_b16 v[114:115], v10 offset:17408
ds_read_b64_tr_b16 v[116:117], v11 offset:1024
v_mfma_f32_16x16x32_bf16 v[196:199], v[84:87], a[184:187], v[196:199]
buffer_load_dwordx4 a[4:7], v46, s[60:63], s91 offen offset:1024 sc1
v_mfma_f32_16x16x32_bf16 v[212:215], v[84:87], a[188:191], v[212:215]
ds_read_b64_tr_b16 v[118:119], v11 offset:17408
ds_read_b64_tr_b16 v[120:121], v12 offset:1024
v_mfma_f32_16x16x32_bf16 v[200:203], v[88:91], a[184:187], v[200:203]
buffer_load_dwordx4 v39, s[48:51], s77 offen offset:1024 lds
v_mfma_f32_16x16x32_bf16 v[216:219], v[88:91], a[188:191], v[216:219]
ds_read_b64_tr_b16 v[122:123], v12 offset:17408
ds_read_b64_tr_b16 v[124:125], v13 offset:1024
v_mfma_f32_16x16x32_bf16 v[204:207], v[92:95], a[184:187], v[204:207]
buffer_load_dwordx4 a[8:11], v46, s[60:63], s91 offen offset:2048 sc1
v_mfma_f32_16x16x32_bf16 v[220:223], v[92:95], a[188:191], v[220:223]
ds_read_b64_tr_b16 v[126:127], v13 offset:17408
s_waitcnt lgkmcnt(5)
v_mfma_f32_16x16x32_bf16 v[192:195], v[96:99], a[192:195], v[192:195]
ds_read_b64_tr_b16 v[80:81], v10 offset:2048
ds_read_b64_tr_b16 v[82:83], v10 offset:18432
v_mfma_f32_16x16x32_bf16 v[208:211], v[96:99], a[196:199], v[208:211]
buffer_load_dwordx4 a[12:15], v46, s[60:63], s91 offen offset:3072 sc1
v_mfma_f32_16x16x32_bf16 v[196:199], v[100:103], a[192:195], v[196:199]
ds_read_b64_tr_b16 v[84:85], v11 offset:2048
ds_read_b64_tr_b16 v[86:87], v11 offset:18432
v_mfma_f32_16x16x32_bf16 v[212:215], v[100:103], a[196:199], v[212:215]
buffer_load_dwordx4 v40, s[48:51], s77 offen offset:2048 lds
v_mfma_f32_16x16x32_bf16 v[200:203], v[104:107], a[192:195], v[200:203]
ds_read_b64_tr_b16 v[88:89], v12 offset:2048
ds_read_b64_tr_b16 v[90:91], v12 offset:18432
v_mfma_f32_16x16x32_bf16 v[216:219], v[104:107], a[196:199], v[216:219]
ds_read_b64_tr_b16 v[92:93], v13 offset:2048
s_add_u32 s91, s6, 4096
v_mfma_f32_16x16x32_bf16 v[204:207], v[108:111], a[192:195], v[204:207]
buffer_load_dwordx4 a[16:19], v46, s[60:63], s91 offen offset:0 sc1
v_mfma_f32_16x16x32_bf16 v[220:223], v[108:111], a[196:199], v[220:223]
ds_read_b64_tr_b16 v[94:95], v13 offset:18432
ds_read_b64_tr_b16 v[96:97], v10 offset:3072
v_mfma_f32_16x16x32_bf16 v[192:195], v[112:115], a[200:203], v[192:195]
buffer_load_dwordx4 a[20:23], v46, s[60:63], s91 offen offset:1024 sc1
v_mfma_f32_16x16x32_bf16 v[208:211], v[112:115], a[204:207], v[208:211]
ds_read_b64_tr_b16 v[98:99], v10 offset:19456
s_waitcnt lgkmcnt(6)
v_mfma_f32_16x16x32_bf16 v[196:199], v[116:119], a[200:203], v[196:199]
ds_read_b64_tr_b16 v[100:101], v11 offset:3072
ds_read_b64_tr_b16 v[102:103], v11 offset:19456
v_mfma_f32_16x16x32_bf16 v[212:215], v[116:119], a[204:207], v[212:215]
buffer_load_dwordx4 v41, s[48:51], s77 offen offset:3072 lds
v_mfma_f32_16x16x32_bf16 v[200:203], v[120:123], a[200:203], v[200:203]
ds_read_b64_tr_b16 v[104:105], v12 offset:3072
ds_read_b64_tr_b16 v[106:107], v12 offset:19456
v_mfma_f32_16x16x32_bf16 v[216:219], v[120:123], a[204:207], v[216:219]
buffer_load_dwordx4 a[24:27], v46, s[60:63], s91 offen offset:2048 sc1
v_mfma_f32_16x16x32_bf16 v[204:207], v[124:127], a[200:203], v[204:207]
ds_read_b64_tr_b16 v[108:109], v13 offset:3072
ds_read_b64_tr_b16 v[110:111], v13 offset:19456
v_mfma_f32_16x16x32_bf16 v[220:223], v[124:127], a[204:207], v[220:223]
buffer_load_dwordx4 a[28:31], v46, s[60:63], s91 offen offset:3072 sc1
v_mfma_f32_16x16x32_bf16 v[192:195], v[80:83], a[208:211], v[192:195]
ds_read_b64_tr_b16 v[112:113], v10 offset:4096
ds_read_b64_tr_b16 v[114:115], v10 offset:20480
v_mfma_f32_16x16x32_bf16 v[208:211], v[80:83], a[212:215], v[208:211]
v_rcp_f32 v74, v74
v_mfma_f32_16x16x32_bf16 v[196:199], v[84:87], a[208:211], v[196:199]
ds_read_b64_tr_b16 v[116:117], v11 offset:4096
ds_read_b64_tr_b16 v[118:119], v11 offset:20480
v_mfma_f32_16x16x32_bf16 v[212:215], v[84:87], a[212:215], v[212:215]
ds_read_b64_tr_b16 v[120:121], v12 offset:4096
s_waitcnt lgkmcnt(7)
v_mfma_f32_16x16x32_bf16 v[200:203], v[88:91], a[208:211], v[200:203]
ds_read_b64_tr_b16 v[122:123], v12 offset:20480
s_add_u32 m0, s76, 102400
v_mfma_f32_16x16x32_bf16 v[216:219], v[88:91], a[212:215], v[216:219]
ds_read_b64_tr_b16 v[124:125], v13 offset:4096
s_add_u32 s77, s99, 0x40000
v_mfma_f32_16x16x32_bf16 v[204:207], v[92:95], a[208:211], v[204:207]
buffer_load_dwordx4 v38, s[48:51], s77 offen offset:0 lds
v_mfma_f32_16x16x32_bf16 v[220:223], v[92:95], a[212:215], v[220:223]
ds_read_b64_tr_b16 v[126:127], v13 offset:20480
ds_read_b64_tr_b16 v[80:81], v10 offset:5120
v_mfma_f32_16x16x32_bf16 v[192:195], v[96:99], a[216:219], v[192:195]
ds_read_b64_tr_b16 v[82:83], v10 offset:21504
s_add_u32 s91, s6, 8192
v_mfma_f32_16x16x32_bf16 v[208:211], v[96:99], a[220:223], v[208:211]
buffer_load_dwordx4 a[32:35], v46, s[60:63], s91 offen offset:0 sc1
v_mfma_f32_16x16x32_bf16 v[196:199], v[100:103], a[216:219], v[196:199]
ds_read_b64_tr_b16 v[84:85], v11 offset:5120
ds_read_b64_tr_b16 v[86:87], v11 offset:21504
v_mfma_f32_16x16x32_bf16 v[212:215], v[100:103], a[220:223], v[212:215]
buffer_load_dwordx4 a[36:39], v46, s[60:63], s91 offen offset:1024 sc1
v_mfma_f32_16x16x32_bf16 v[200:203], v[104:107], a[216:219], v[200:203]
ds_read_b64_tr_b16 v[88:89], v12 offset:5120
ds_read_b64_tr_b16 v[90:91], v12 offset:21504
v_mfma_f32_16x16x32_bf16 v[216:219], v[104:107], a[220:223], v[216:219]
ds_read_b64_tr_b16 v[92:93], v13 offset:5120
s_waitcnt lgkmcnt(6)
v_mfma_f32_16x16x32_bf16 v[204:207], v[108:111], a[216:219], v[204:207]
buffer_load_dwordx4 v39, s[48:51], s77 offen offset:1024 lds
v_mfma_f32_16x16x32_bf16 v[220:223], v[108:111], a[220:223], v[220:223]
ds_read_b64_tr_b16 v[94:95], v13 offset:21504
ds_read_b64_tr_b16 v[96:97], v10 offset:6144
v_mfma_f32_16x16x32_bf16 v[192:195], v[112:115], a[224:227], v[192:195]
buffer_load_dwordx4 a[40:43], v46, s[60:63], s91 offen offset:2048 sc1
v_mfma_f32_16x16x32_bf16 v[208:211], v[112:115], a[228:231], v[208:211]
ds_read_b64_tr_b16 v[98:99], v10 offset:22528
ds_read_b64_tr_b16 v[100:101], v11 offset:6144
v_mfma_f32_16x16x32_bf16 v[196:199], v[116:119], a[224:227], v[196:199]
buffer_load_dwordx4 a[44:47], v46, s[60:63], s91 offen offset:3072 sc1
v_mfma_f32_16x16x32_bf16 v[212:215], v[116:119], a[228:231], v[212:215]
ds_read_b64_tr_b16 v[102:103], v11 offset:22528
ds_read_b64_tr_b16 v[104:105], v12 offset:6144
v_mfma_f32_16x16x32_bf16 v[200:203], v[120:123], a[224:227], v[200:203]
buffer_load_dwordx4 v40, s[48:51], s77 offen offset:2048 lds
v_mfma_f32_16x16x32_bf16 v[216:219], v[120:123], a[228:231], v[216:219]
ds_read_b64_tr_b16 v[106:107], v12 offset:22528
ds_read_b64_tr_b16 v[108:109], v13 offset:6144
v_mfma_f32_16x16x32_bf16 v[204:207], v[124:127], a[224:227], v[204:207]
ds_read_b64_tr_b16 v[110:111], v13 offset:22528
s_add_u32 s91, s6, 12288
v_mfma_f32_16x16x32_bf16 v[220:223], v[124:127], a[228:231], v[220:223]
ds_read_b64_tr_b16 v[112:113], v10 offset:7168
s_waitcnt lgkmcnt(6)
v_mfma_f32_16x16x32_bf16 v[192:195], v[80:83], a[232:235], v[192:195]
buffer_load_dwordx4 a[48:51], v46, s[60:63], s91 offen offset:0 sc1
v_mfma_f32_16x16x32_bf16 v[208:211], v[80:83], a[236:239], v[208:211]
ds_read_b64_tr_b16 v[114:115], v10 offset:23552
ds_read_b64_tr_b16 v[116:117], v11 offset:7168
v_mfma_f32_16x16x32_bf16 v[196:199], v[84:87], a[232:235], v[196:199]
buffer_load_dwordx4 v41, s[48:51], s77 offen offset:3072 lds
v_mfma_f32_16x16x32_bf16 v[212:215], v[84:87], a[236:239], v[212:215]
ds_read_b64_tr_b16 v[118:119], v11 offset:23552
ds_read_b64_tr_b16 v[120:121], v12 offset:7168
v_mfma_f32_16x16x32_bf16 v[200:203], v[88:91], a[232:235], v[200:203]
buffer_load_dwordx4 a[52:55], v46, s[60:63], s91 offen offset:1024 sc1
v_mfma_f32_16x16x32_bf16 v[216:219], v[88:91], a[236:239], v[216:219]
ds_read_b64_tr_b16 v[122:123], v12 offset:23552
ds_read_b64_tr_b16 v[124:125], v13 offset:7168
v_mfma_f32_16x16x32_bf16 v[204:207], v[92:95], a[232:235], v[204:207]
v_rcp_f32 v75, v75
v_mfma_f32_16x16x32_bf16 v[220:223], v[92:95], a[236:239], v[220:223]
ds_read_b64_tr_b16 v[126:127], v13 offset:23552
v_mul_f32 v140, v140, v72
v_mfma_f32_16x16x32_bf16 v[192:195], v[96:99], a[240:243], v[192:195]
buffer_load_dwordx4 a[56:59], v46, s[60:63], s91 offen offset:2048 sc1
v_mfma_f32_16x16x32_bf16 v[208:211], v[96:99], a[244:247], v[208:211]
v_mul_f32 v141, v141, v73
s_waitcnt lgkmcnt(3)
v_mfma_f32_16x16x32_bf16 v[196:199], v[100:103], a[240:243], v[196:199]
buffer_load_dwordx4 a[60:63], v46, s[60:63], s91 offen offset:3072 sc1
v_mfma_f32_16x16x32_bf16 v[212:215], v[100:103], a[244:247], v[212:215]
v_mul_f32 v142, v142, v74
v_mul_f32 v143, v143, v75
v_mfma_f32_16x16x32_bf16 v[200:203], v[104:107], a[240:243], v[200:203]
s_waitcnt vmcnt(32) lgkmcnt(0)
s_barrier
v_mfma_f32_16x16x32_bf16 v[216:219], v[104:107], a[244:247], v[216:219]
ds_read_b64_tr_b16 v[80:81], v10 offset:32768
ds_read_b64_tr_b16 v[82:83], v10 offset:49152
v_mfma_f32_16x16x32_bf16 v[204:207], v[108:111], a[240:243], v[204:207]
ds_read_b64_tr_b16 v[84:85], v11 offset:32768
ds_read_b64_tr_b16 v[86:87], v11 offset:49152
v_mfma_f32_16x16x32_bf16 v[220:223], v[108:111], a[244:247], v[220:223]
ds_read_b64_tr_b16 v[88:89], v12 offset:32768
ds_read_b64_tr_b16 v[90:91], v12 offset:49152
v_mfma_f32_16x16x32_bf16 v[192:195], v[112:115], a[248:251], v[192:195]
ds_read_b64_tr_b16 v[92:93], v13 offset:32768
ds_read_b64_tr_b16 v[94:95], v13 offset:49152
v_mfma_f32_16x16x32_bf16 v[208:211], v[112:115], a[252:255], v[208:211]
ds_read_b64_tr_b16 v[96:97], v10 offset:33792
ds_read_b64_tr_b16 v[98:99], v10 offset:50176
v_mfma_f32_16x16x32_bf16 v[196:199], v[116:119], a[248:251], v[196:199]
ds_read_b64_tr_b16 v[100:101], v11 offset:33792
s_add_u32 m0, s76, 0
v_mfma_f32_16x16x32_bf16 v[212:215], v[116:119], a[252:255], v[212:215]
ds_read_b64_tr_b16 v[102:103], v11 offset:50176
s_add_u32 s77, s97, 0x200000
v_mfma_f32_16x16x32_bf16 v[200:203], v[120:123], a[248:251], v[200:203]
ds_read_b64_tr_b16 v[104:105], v12 offset:33792
ds_read_b64_tr_b16 v[106:107], v12 offset:50176
v_mfma_f32_16x16x32_bf16 v[216:219], v[120:123], a[252:255], v[216:219]
buffer_load_dwordx4 v38, s[48:51], s77 offen offset:0 lds
v_mfma_f32_16x16x32_bf16 v[204:207], v[124:127], a[248:251], v[204:207]
ds_read_b64_tr_b16 v[108:109], v13 offset:33792
ds_read_b64_tr_b16 v[110:111], v13 offset:50176
v_mfma_f32_16x16x32_bf16 v[220:223], v[124:127], a[252:255], v[220:223]
ds_read_b64_tr_b16 v[112:113], v10 offset:34816
v_mul_f32 v68, v61, v144
S_DA:
s_waitcnt vmcnt(14) lgkmcnt(7)
v_mfma_f32_16x16x32_bf16 v[160:163], v[80:83], a[0:3], 0
ds_read_b64_tr_b16 v[114:115], v10 offset:51200
ds_read_b64_tr_b16 v[116:117], v11 offset:34816
ds_read_b64_tr_b16 v[118:119], v11 offset:51200
v_mfma_f32_16x16x32_bf16 v[176:179], v[80:83], a[4:7], 0
ds_read_b64_tr_b16 v[120:121], v12 offset:34816
s_add_u32 s91, s6, 65536
v_mul_f32 v69, v61, v145
v_mfma_f32_16x16x32_bf16 v[164:167], v[84:87], a[0:3], 0
buffer_load_dwordx4 a[64:67], v46, s[60:63], s91 offen offset:0 sc1
ds_read_b64_tr_b16 v[122:123], v12 offset:51200
v_mfma_f32_16x16x32_bf16 v[180:183], v[84:87], a[4:7], 0
ds_read_b64_tr_b16 v[124:125], v13 offset:34816
ds_read_b64_tr_b16 v[126:127], v13 offset:51200
v_mul_f32 v70, v61, v146
v_mfma_f32_16x16x32_bf16 v[168:171], v[88:91], a[0:3], 0
buffer_load_dwordx4 v39, s[48:51], s77 offen offset:1024 lds
ds_read_b64_tr_b16 v[80:81], v10 offset:35840
v_mfma_f32_16x16x32_bf16 v[184:187], v[88:91], a[4:7], 0
ds_read_b64_tr_b16 v[82:83], v10 offset:52224
v_mul_f32 v71, v61, v147
ds_read_b64_tr_b16 v[84:85], v11 offset:35840
v_mfma_f32_16x16x32_bf16 v[172:175], v[92:95], a[0:3], 0
buffer_load_dwordx4 a[68:71], v46, s[60:63], s91 offen offset:1024 sc1
ds_read_b64_tr_b16 v[86:87], v11 offset:52224
v_mfma_f32_16x16x32_bf16 v[188:191], v[92:95], a[4:7], 0
v_exp_f32 v68, v68
ds_read_b64_tr_b16 v[88:89], v12 offset:35840
v_mfma_f32_16x16x32_bf16 v[160:163], v[96:99], a[8:11], v[160:163]
v_exp_f32 v69, v69
ds_read_b64_tr_b16 v[90:91], v12 offset:52224
v_mfma_f32_16x16x32_bf16 v[176:179], v[96:99], a[12:15], v[176:179]
v_exp_f32 v70, v70
s_waitcnt lgkmcnt(6)
v_mfma_f32_16x16x32_bf16 v[164:167], v[100:103], a[8:11], v[164:167]
ds_read_b64_tr_b16 v[92:93], v13 offset:35840
buffer_load_dwordx4 v40, s[48:51], s77 offen offset:2048 lds
v_mfma_f32_16x16x32_bf16 v[180:183], v[100:103], a[12:15], v[180:183]
v_exp_f32 v71, v71
ds_read_b64_tr_b16 v[94:95], v13 offset:52224
v_mfma_f32_16x16x32_bf16 v[168:171], v[104:107], a[8:11], v[168:171]
ds_read_b64_tr_b16 v[96:97], v10 offset:36864
v_fma_f32 v68, v68, v63, v63
v_fma_f32 v69, v69, v63, v63
v_mfma_f32_16x16x32_bf16 v[184:187], v[104:107], a[12:15], v[184:187]
ds_read_b64_tr_b16 v[98:99], v10 offset:53248
v_fma_f32 v70, v70, v63, v63
v_fma_f32 v71, v71, v63, v63
v_mfma_f32_16x16x32_bf16 v[172:175], v[108:111], a[8:11], v[172:175]
v_rcp_f32 v68, v68
ds_read_b64_tr_b16 v[100:101], v11 offset:36864
v_mfma_f32_16x16x32_bf16 v[188:191], v[108:111], a[12:15], v[188:191]
v_rcp_f32 v69, v69
ds_read_b64_tr_b16 v[102:103], v11 offset:53248
v_mfma_f32_16x16x32_bf16 v[160:163], v[112:115], a[16:19], v[160:163]
buffer_load_dwordx4 v41, s[48:51], s77 offen offset:3072 lds
ds_read_b64_tr_b16 v[104:105], v12 offset:36864
v_mfma_f32_16x16x32_bf16 v[176:179], v[112:115], a[20:23], v[176:179]
v_rcp_f32 v70, v70
ds_read_b64_tr_b16 v[106:107], v12 offset:53248
v_mfma_f32_16x16x32_bf16 v[164:167], v[116:119], a[16:19], v[164:167]
v_rcp_f32 v71, v71
ds_read_b64_tr_b16 v[108:109], v13 offset:36864
v_mfma_f32_16x16x32_bf16 v[180:183], v[116:119], a[20:23], v[180:183]
ds_read_b64_tr_b16 v[110:111], v13 offset:53248
s_add_u32 m0, s76, 4096
s_add_u32 s77, s98, 0x200000
v_mfma_f32_16x16x32_bf16 v[168:171], v[120:123], a[16:19], v[168:171]
ds_read_b64_tr_b16 v[112:113], v10 offset:37888
v_mul_f32 v144, v144, v68
v_mul_f32 v145, v145, v69
v_mfma_f32_16x16x32_bf16 v[184:187], v[120:123], a[20:23], v[184:187]
ds_read_b64_tr_b16 v[114:115], v10 offset:54272
v_mul_f32 v146, v146, v70
v_mul_f32 v147, v147, v71
v_mfma_f32_16x16x32_bf16 v[172:175], v[124:127], a[16:19], v[172:175]
buffer_load_dwordx4 v38, s[48:51], s77 offen offset:0 lds
ds_read_b64_tr_b16 v[116:117], v11 offset:37888
v_mfma_f32_16x16x32_bf16 v[188:191], v[124:127], a[20:23], v[188:191]
ds_read_b64_tr_b16 v[118:119], v11 offset:54272
v_mul_f32 v72, v61, v148
s_waitcnt lgkmcnt(6)
v_mfma_f32_16x16x32_bf16 v[160:163], v[80:83], a[24:27], v[160:163]
buffer_load_dwordx4 a[72:75], v46, s[60:63], s91 offen offset:2048 sc1
s_waitcnt vmcnt(14)
v_mfma_f32_16x16x32_bf16 v[176:179], v[80:83], a[28:31], v[176:179]
ds_read_b64_tr_b16 v[120:121], v12 offset:37888
ds_read_b64_tr_b16 v[122:123], v12 offset:54272
v_mul_f32 v73, v61, v149
v_mfma_f32_16x16x32_bf16 v[164:167], v[84:87], a[24:27], v[164:167]
buffer_load_dwordx4 a[76:79], v46, s[60:63], s91 offen offset:3072 sc1
ds_read_b64_tr_b16 v[124:125], v13 offset:37888
v_mfma_f32_16x16x32_bf16 v[180:183], v[84:87], a[28:31], v[180:183]
ds_read_b64_tr_b16 v[126:127], v13 offset:54272
v_mul_f32 v74, v61, v150
v_mul_f32 v75, v61, v151
v_mfma_f32_16x16x32_bf16 v[168:171], v[88:91], a[24:27], v[168:171]
buffer_load_dwordx4 v39, s[48:51], s77 offen offset:1024 lds
ds_read_b64_tr_b16 v[80:81], v10 offset:38912
v_mfma_f32_16x16x32_bf16 v[184:187], v[88:91], a[28:31], v[184:187]
v_exp_f32 v72, v72
ds_read_b64_tr_b16 v[82:83], v10 offset:55296
v_mfma_f32_16x16x32_bf16 v[172:175], v[92:95], a[24:27], v[172:175]
v_exp_f32 v73, v73
ds_read_b64_tr_b16 v[84:85], v11 offset:38912
v_mfma_f32_16x16x32_bf16 v[188:191], v[92:95], a[28:31], v[188:191]
v_exp_f32 v74, v74
ds_read_b64_tr_b16 v[86:87], v11 offset:55296
v_mfma_f32_16x16x32_bf16 a[224:227], v[96:99], a[0:3], 0
v_exp_f32 v75, v75
ds_read_b64_tr_b16 v[88:89], v12 offset:38912
v_mfma_f32_16x16x32_bf16 a[240:243], v[96:99], a[4:7], 0
ds_read_b64_tr_b16 v[90:91], v12 offset:55296
v_fma_f32 v72, v72, v63, v63
v_fma_f32 v73, v73, v63, v63
v_mfma_f32_16x16x32_bf16 a[228:231], v[100:103], a[0:3], 0
buffer_load_dwordx4 v40, s[48:51], s77 offen offset:2048 lds
ds_read_b64_tr_b16 v[92:93], v13 offset:38912
v_mfma_f32_16x16x32_bf16 a[244:247], v[100:103], a[4:7], 0
ds_read_b64_tr_b16 v[94:95], v13 offset:55296
v_fma_f32 v74, v74, v63, v63
v_fma_f32 v75, v75, v63, v63
v_mfma_f32_16x16x32_bf16 a[232:235], v[104:107], a[0:3], 0
v_rcp_f32 v72, v72
ds_read_b64_tr_b16 v[96:97], v10 offset:39936
v_mfma_f32_16x16x32_bf16 a[248:251], v[104:107], a[4:7], 0
v_rcp_f32 v73, v73
s_waitcnt lgkmcnt(5)
v_mfma_f32_16x16x32_bf16 a[236:239], v[108:111], a[0:3], 0
ds_read_b64_tr_b16 v[98:99], v10 offset:56320
ds_read_b64_tr_b16 v[100:101], v11 offset:39936
ds_read_b64_tr_b16 v[102:103], v11 offset:56320
v_mfma_f32_16x16x32_bf16 a[252:255], v[108:111], a[4:7], 0
v_rcp_f32 v74, v74
ds_read_b64_tr_b16 v[104:105], v12 offset:39936
v_mfma_f32_16x16x32_bf16 a[224:227], v[112:115], a[8:11], a[224:227]
buffer_load_dwordx4 v41, s[48:51], s77 offen offset:3072 lds
ds_read_b64_tr_b16 v[106:107], v12 offset:56320
v_mfma_f32_16x16x32_bf16 a[240:243], v[112:115], a[12:15], a[240:243]
v_rcp_f32 v75, v75
ds_read_b64_tr_b16 v[108:109], v13 offset:39936
v_mfma_f32_16x16x32_bf16 a[228:231], v[116:119], a[8:11], a[228:231]
ds_read_b64_tr_b16 v[110:111], v13 offset:56320
v_mul_f32 v148, v148, v72
v_mul_f32 v149, v149, v73
v_mfma_f32_16x16x32_bf16 a[244:247], v[116:119], a[12:15], a[244:247]
v_mul_f32 v150, v150, v74
v_mul_f32 v151, v151, v75
v_mul_f32 v68, v61, v152
v_mfma_f32_16x16x32_bf16 a[232:235], v[120:123], a[8:11], a[232:235]
v_mul_f32 v69, v61, v153
v_mul_f32 v70, v61, v154
v_mul_f32 v71, v61, v155
v_mfma_f32_16x16x32_bf16 a[248:251], v[120:123], a[12:15], a[248:251]
v_exp_f32 v68, v68
v_mfma_f32_16x16x32_bf16 a[236:239], v[124:127], a[8:11], a[236:239]
v_exp_f32 v69, v69
v_mfma_f32_16x16x32_bf16 a[252:255], v[124:127], a[12:15], a[252:255]
s_waitcnt lgkmcnt(0)
s_barrier
ds_read_b64_tr_b16 v[112:113], v14 offset:0
v_mfma_f32_16x16x32_bf16 a[224:227], v[80:83], a[16:19], a[224:227]
ds_read_b64_tr_b16 v[114:115], v14 offset:16384
s_add_u32 m0, s76, 32768
s_add_u32 s77, s99, 0x200000
v_mfma_f32_16x16x32_bf16 a[240:243], v[80:83], a[20:23], a[240:243]
buffer_load_dwordx4 v38, s[48:51], s77 offen offset:0 lds
ds_read_b64_tr_b16 v[116:117], v15 offset:0
v_mfma_f32_16x16x32_bf16 a[228:231], v[84:87], a[16:19], a[228:231]
ds_read_b64_tr_b16 v[118:119], v15 offset:16384
ds_read_b64_tr_b16 v[120:121], v16 offset:0
ds_read_b64_tr_b16 v[122:123], v16 offset:16384
v_mfma_f32_16x16x32_bf16 a[244:247], v[84:87], a[20:23], a[244:247]
ds_read_b64_tr_b16 v[124:125], v17 offset:0
s_add_u32 s91, s6, 69632
v_mfma_f32_16x16x32_bf16 a[232:235], v[88:91], a[16:19], a[232:235]
buffer_load_dwordx4 a[80:83], v46, s[60:63], s91 offen offset:0 sc1
ds_read_b64_tr_b16 v[126:127], v17 offset:16384
v_mfma_f32_16x16x32_bf16 a[248:251], v[88:91], a[20:23], a[248:251]
ds_read_b64_tr_b16 v[80:81], v14 offset:1024
ds_read_b64_tr_b16 v[82:83], v14 offset:17408
ds_read_b64_tr_b16 v[84:85], v15 offset:1024
v_mfma_f32_16x16x32_bf16 a[236:239], v[92:95], a[16:19], a[236:239]
buffer_load_dwordx4 a[84:87], v46, s[60:63], s91 offen offset:1024 sc1
ds_read_b64_tr_b16 v[86:87], v15 offset:17408
v_mfma_f32_16x16x32_bf16 a[252:255], v[92:95], a[20:23], a[252:255]
v_exp_f32 v70, v70
ds_read_b64_tr_b16 v[88:89], v16 offset:1024
v_mfma_f32_16x16x32_bf16 a[224:227], v[96:99], a[24:27], a[224:227]
buffer_load_dwordx4 v39, s[48:51], s77 offen offset:1024 lds
ds_read_b64_tr_b16 v[90:91], v16 offset:17408
v_mfma_f32_16x16x32_bf16 a[240:243], v[96:99], a[28:31], a[240:243]
v_exp_f32 v71, v71
ds_read_b64_tr_b16 v[92:93], v17 offset:1024
v_mfma_f32_16x16x32_bf16 a[228:231], v[100:103], a[24:27], a[228:231]
ds_read_b64_tr_b16 v[94:95], v17 offset:17408
v_fma_f32 v68, v68, v63, v63
v_fma_f32 v69, v69, v63, v63
v_mfma_f32_16x16x32_bf16 a[244:247], v[100:103], a[28:31], a[244:247]
ds_read_b64_tr_b16 v[96:97], v14 offset:2048
v_fma_f32 v70, v70, v63, v63
v_fma_f32 v71, v71, v63, v63
v_mfma_f32_16x16x32_bf16 a[232:235], v[104:107], a[24:27], a[232:235]
v_rcp_f32 v68, v68
ds_read_b64_tr_b16 v[98:99], v14 offset:18432
v_mfma_f32_16x16x32_bf16 a[248:251], v[104:107], a[28:31], a[248:251]
v_rcp_f32 v69, v69
ds_read_b64_tr_b16 v[100:101], v15 offset:2048
v_mfma_f32_16x16x32_bf16 a[236:239], v[108:111], a[24:27], a[236:239]
buffer_load_dwordx4 v40, s[48:51], s77 offen offset:2048 lds
ds_read_b64_tr_b16 v[102:103], v15 offset:18432
v_mfma_f32_16x16x32_bf16 a[252:255], v[108:111], a[28:31], a[252:255]
v_rcp_f32 v70, v70
s_waitcnt lgkmcnt(5)
v_mfma_f32_16x16x32_bf16 v[224:227], v[112:115], a[0:3], 0
ds_read_b64_tr_b16 v[104:105], v16 offset:2048
v_rcp_f32 v71, v71
v_mfma_f32_16x16x32_bf16 v[240:243], v[112:115], a[4:7], 0
ds_read_b64_tr_b16 v[106:107], v16 offset:18432
v_mul_f32 v152, v152, v68
v_mul_f32 v153, v153, v69
v_mfma_f32_16x16x32_bf16 v[228:231], v[116:119], a[0:3], 0
ds_read_b64_tr_b16 v[108:109], v17 offset:2048
v_mul_f32 v154, v154, v70
v_mul_f32 v155, v155, v71
v_mfma_f32_16x16x32_bf16 v[244:247], v[116:119], a[4:7], 0
ds_read_b64_tr_b16 v[110:111], v17 offset:18432
v_mul_f32 v72, v61, v156
v_mul_f32 v73, v61, v157
v_mfma_f32_16x16x32_bf16 v[232:235], v[120:123], a[0:3], 0
buffer_load_dwordx4 v41, s[48:51], s77 offen offset:3072 lds
ds_read_b64_tr_b16 v[112:113], v14 offset:3072
v_mfma_f32_16x16x32_bf16 v[248:251], v[120:123], a[4:7], 0
ds_read_b64_tr_b16 v[114:115], v14 offset:19456
v_mul_f32 v74, v61, v158
v_mul_f32 v75, v61, v159
v_mfma_f32_16x16x32_bf16 v[236:239], v[124:127], a[0:3], 0
v_exp_f32 v72, v72
ds_read_b64_tr_b16 v[116:117], v15 offset:3072
v_mfma_f32_16x16x32_bf16 v[252:255], v[124:127], a[4:7], 0
buffer_load_dwordx4 a[88:91], v46, s[60:63], s91 offen offset:2048 sc1
s_add_u32 m0, s76, 36864
v_mfma_f32_16x16x32_bf16 v[224:227], v[80:83], a[8:11], v[224:227]
ds_read_b64_tr_b16 v[118:119], v15 offset:19456
ds_read_b64_tr_b16 v[120:121], v16 offset:3072
s_add_u32 s77, s97, 0x240000
v_mfma_f32_16x16x32_bf16 v[240:243], v[80:83], a[12:15], v[240:243]
buffer_load_dwordx4 a[92:95], v46, s[60:63], s91 offen offset:3072 sc1
ds_read_b64_tr_b16 v[122:123], v16 offset:19456
v_mfma_f32_16x16x32_bf16 v[228:231], v[84:87], a[8:11], v[228:231]
v_exp_f32 v73, v73
ds_read_b64_tr_b16 v[124:125], v17 offset:3072
v_mfma_f32_16x16x32_bf16 v[244:247], v[84:87], a[12:15], v[244:247]
buffer_load_dwordx4 v38, s[48:51], s77 offen offset:0 lds
ds_read_b64_tr_b16 v[126:127], v17 offset:19456
v_mfma_f32_16x16x32_bf16 v[232:235], v[88:91], a[8:11], v[232:235]
v_exp_f32 v74, v74
ds_read_b64_tr_b16 v[80:81], v14 offset:4096
v_mfma_f32_16x16x32_bf16 v[248:251], v[88:91], a[12:15], v[248:251]
v_exp_f32 v75, v75
s_waitcnt lgkmcnt(6)
v_mfma_f32_16x16x32_bf16 v[236:239], v[92:95], a[8:11], v[236:239]
ds_read_b64_tr_b16 v[82:83], v14 offset:20480
ds_read_b64_tr_b16 v[84:85], v15 offset:4096
v_fma_f32 v72, v72, v63, v63
v_mfma_f32_16x16x32_bf16 v[252:255], v[92:95], a[12:15], v[252:255]
ds_read_b64_tr_b16 v[86:87], v15 offset:20480
v_fma_f32 v73, v73, v63, v63
v_fma_f32 v74, v74, v63, v63
v_mfma_f32_16x16x32_bf16 v[224:227], v[96:99], a[16:19], v[224:227]
ds_read_b64_tr_b16 v[88:89], v16 offset:4096
v_fma_f32 v75, v75, v63, v63
ds_read_b64_tr_b16 v[90:91], v16 offset:20480
v_mfma_f32_16x16x32_bf16 v[240:243], v[96:99], a[20:23], v[240:243]
buffer_load_dwordx4 v39, s[48:51], s77 offen offset:1024 lds
ds_read_b64_tr_b16 v[92:93], v17 offset:4096
v_mfma_f32_16x16x32_bf16 v[228:231], v[100:103], a[16:19], v[228:231]
v_rcp_f32 v72, v72
ds_read_b64_tr_b16 v[94:95], v17 offset:20480
v_mfma_f32_16x16x32_bf16 v[244:247], v[100:103], a[20:23], v[244:247]
v_rcp_f32 v73, v73
ds_read_b64_tr_b16 v[96:97], v14 offset:5120
v_mfma_f32_16x16x32_bf16 v[232:235], v[104:107], a[16:19], v[232:235]
v_rcp_f32 v74, v74
v_mfma_f32_16x16x32_bf16 v[248:251], v[104:107], a[20:23], v[248:251]
ds_read_b64_tr_b16 v[98:99], v14 offset:21504
ds_read_b64_tr_b16 v[100:101], v15 offset:5120
v_mfma_f32_16x16x32_bf16 v[236:239], v[108:111], a[16:19], v[236:239]
v_rcp_f32 v75, v75
v_mfma_f32_16x16x32_bf16 v[252:255], v[108:111], a[20:23], v[252:255]
ds_read_b64_tr_b16 v[102:103], v15 offset:21504
v_mul_f32 v156, v156, v72
v_mfma_f32_16x16x32_bf16 v[224:227], v[112:115], a[24:27], v[224:227]
buffer_load_dwordx4 v40, s[48:51], s77 offen offset:2048 lds
v_mfma_f32_16x16x32_bf16 v[240:243], v[112:115], a[28:31], v[240:243]
ds_read_b64_tr_b16 v[104:105], v16 offset:5120
s_waitcnt lgkmcnt(4)
v_mfma_f32_16x16x32_bf16 v[228:231], v[116:119], a[24:27], v[228:231]
ds_read_b64_tr_b16 v[106:107], v16 offset:21504
ds_read_b64_tr_b16 v[108:109], v17 offset:5120
v_mfma_f32_16x16x32_bf16 v[244:247], v[116:119], a[28:31], v[244:247]
ds_read_b64_tr_b16 v[110:111], v17 offset:21504
v_mul_f32 v157, v157, v73
v_mfma_f32_16x16x32_bf16 v[232:235], v[120:123], a[24:27], v[232:235]
ds_read_b64_tr_b16 v[112:113], v14 offset:6144
v_mul_f32 v158, v158, v74
v_mfma_f32_16x16x32_bf16 v[248:251], v[120:123], a[28:31], v[248:251]
ds_read_b64_tr_b16 v[114:115], v14 offset:22528
v_mul_f32 v159, v159, v75
v_mfma_f32_16x16x32_bf16 v[236:239], v[124:127], a[24:27], v[236:239]
buffer_load_dwordx4 v41, s[48:51], s77 offen offset:3072 lds
v_mfma_f32_16x16x32_bf16 v[252:255], v[124:127], a[28:31], v[252:255]
ds_read_b64_tr_b16 v[116:117], v15 offset:6144
ds_read_b64_tr_b16 v[118:119], v15 offset:22528
v_mfma_f32_16x16x32_bf16 v[160:163], v[80:83], a[32:35], v[160:163]
ds_read_b64_tr_b16 v[120:121], v16 offset:6144
s_add_u32 s91, s6, 73728
v_mfma_f32_16x16x32_bf16 v[176:179], v[80:83], a[36:39], v[176:179]
buffer_load_dwordx4 a[96:99], v46, s[60:63], s91 offen offset:0 sc1
v_mfma_f32_16x16x32_bf16 v[164:167], v[84:87], a[32:35], v[164:167]
ds_read_b64_tr_b16 v[122:123], v16 offset:22528
ds_read_b64_tr_b16 v[124:125], v17 offset:6144
v_mfma_f32_16x16x32_bf16 v[180:183], v[84:87], a[36:39], v[180:183]
buffer_load_dwordx4 a[100:103], v46, s[60:63], s91 offen offset:1024 sc1
v_mfma_f32_16x16x32_bf16 v[168:171], v[88:91], a[32:35], v[168:171]
ds_read_b64_tr_b16 v[126:127], v17 offset:22528
ds_read_b64_tr_b16 v[80:81], v14 offset:7168
v_mfma_f32_16x16x32_bf16 v[184:187], v[88:91], a[36:39], v[184:187]
ds_read_b64_tr_b16 v[82:83], v14 offset:23552
s_lshl_b32 s7, s25, 5
v_mfma_f32_16x16x32_bf16 v[172:175], v[92:95], a[32:35], v[172:175]
ds_read_b64_tr_b16 v[84:85], v15 offset:7168
s_add_u32 s7, s7, s4
v_mfma_f32_16x16x32_bf16 v[188:191], v[92:95], a[36:39], v[188:191]
ds_read_b64_tr_b16 v[86:87], v15 offset:23552
s_waitcnt lgkmcnt(7)
v_mfma_f32_16x16x32_bf16 v[160:163], v[96:99], a[40:43], v[160:163]
ds_read_b64_tr_b16 v[88:89], v16 offset:7168
v_mul_f32 v192, v192, v128
v_mfma_f32_16x16x32_bf16 v[176:179], v[96:99], a[44:47], v[176:179]
ds_read_b64_tr_b16 v[90:91], v16 offset:23552
v_mul_f32 v193, v193, v129
v_mfma_f32_16x16x32_bf16 v[164:167], v[100:103], a[40:43], v[164:167]
ds_read_b64_tr_b16 v[92:93], v17 offset:7168
v_mul_f32 v194, v194, v130
v_mfma_f32_16x16x32_bf16 v[180:183], v[100:103], a[44:47], v[180:183]
ds_read_b64_tr_b16 v[94:95], v17 offset:23552
v_mul_f32 v195, v195, v131
v_mfma_f32_16x16x32_bf16 v[168:171], v[104:107], a[40:43], v[168:171]
v_mul_f32 v196, v196, v132
v_mul_f32 v197, v197, v133
v_mfma_f32_16x16x32_bf16 v[184:187], v[104:107], a[44:47], v[184:187]
v_mul_f32 v198, v198, v134
v_mul_f32 v199, v199, v135
v_mfma_f32_16x16x32_bf16 v[172:175], v[108:111], a[40:43], v[172:175]
v_cvt_pk_bf16_f32 v192, v192, v193
v_cvt_pk_bf16_f32 v193, v194, v195
v_mfma_f32_16x16x32_bf16 v[188:191], v[108:111], a[44:47], v[188:191]
v_cvt_pk_bf16_f32 v194, v196, v197
s_waitcnt vmcnt(11)
v_mfma_f32_16x16x32_bf16 v[160:163], v[112:115], a[48:51], v[160:163]
s_waitcnt lgkmcnt(0)
s_barrier
v_mfma_f32_16x16x32_bf16 v[176:179], v[112:115], a[52:55], v[176:179]
ds_read_b64_tr_b16 v[96:97], v14 offset:32768
ds_read_b64_tr_b16 v[98:99], v14 offset:49152
v_mfma_f32_16x16x32_bf16 v[164:167], v[116:119], a[48:51], v[164:167]
ds_read_b64_tr_b16 v[100:101], v15 offset:32768
s_add_u32 m0, s76, 65536
v_mfma_f32_16x16x32_bf16 v[180:183], v[116:119], a[52:55], v[180:183]
ds_read_b64_tr_b16 v[102:103], v15 offset:49152
s_add_u32 s77, s98, 0x240000
v_mfma_f32_16x16x32_bf16 v[168:171], v[120:123], a[48:51], v[168:171]
ds_read_b64_tr_b16 v[104:105], v16 offset:32768
ds_read_b64_tr_b16 v[106:107], v16 offset:49152
v_mfma_f32_16x16x32_bf16 v[184:187], v[120:123], a[52:55], v[184:187]
buffer_load_dwordx4 v38, s[48:51], s77 offen offset:0 lds
v_mfma_f32_16x16x32_bf16 v[172:175], v[124:127], a[48:51], v[172:175]
ds_read_b64_tr_b16 v[108:109], v17 offset:32768
ds_read_b64_tr_b16 v[110:111], v17 offset:49152
v_mfma_f32_16x16x32_bf16 v[188:191], v[124:127], a[52:55], v[188:191]
buffer_load_dwordx4 a[104:107], v46, s[60:63], s91 offen offset:2048 sc1
v_mfma_f32_16x16x32_bf16 v[160:163], v[80:83], a[56:59], v[160:163]
ds_read_b64_tr_b16 v[112:113], v14 offset:33792
ds_read_b64_tr_b16 v[114:115], v14 offset:50176
v_mfma_f32_16x16x32_bf16 v[176:179], v[80:83], a[60:63], v[176:179]
buffer_load_dwordx4 a[108:111], v46, s[60:63], s91 offen offset:3072 sc1
v_mfma_f32_16x16x32_bf16 v[164:167], v[84:87], a[56:59], v[164:167]
ds_read_b64_tr_b16 v[116:117], v15 offset:33792
ds_read_b64_tr_b16 v[118:119], v15 offset:50176
v_mfma_f32_16x16x32_bf16 v[180:183], v[84:87], a[60:63], v[180:183]
buffer_load_dwordx4 v39, s[48:51], s77 offen offset:1024 lds
v_mfma_f32_16x16x32_bf16 v[168:171], v[88:91], a[56:59], v[168:171]
ds_read_b64_tr_b16 v[120:121], v16 offset:33792
ds_read_b64_tr_b16 v[122:123], v16 offset:50176
v_mfma_f32_16x16x32_bf16 v[184:187], v[88:91], a[60:63], v[184:187]
ds_read_b64_tr_b16 v[124:125], v17 offset:33792
v_cvt_pk_bf16_f32 v195, v198, v199
v_mfma_f32_16x16x32_bf16 v[172:175], v[92:95], a[56:59], v[172:175]
buffer_store_dwordx4 v[192:195], v46, s[60:63], s7 offen offset:0 sc1
v_mfma_f32_16x16x32_bf16 v[188:191], v[92:95], a[60:63], v[188:191]
ds_read_b64_tr_b16 v[126:127], v17 offset:50176
s_waitcnt lgkmcnt(6)
v_mfma_f32_16x16x32_bf16 a[224:227], v[96:99], a[32:35], a[224:227]
ds_read_b64_tr_b16 v[80:81], v14 offset:34816
ds_read_b64_tr_b16 v[82:83], v14 offset:51200
v_mfma_f32_16x16x32_bf16 a[240:243], v[96:99], a[36:39], a[240:243]
buffer_load_dwordx4 v40, s[48:51], s77 offen offset:2048 lds
v_mfma_f32_16x16x32_bf16 a[228:231], v[100:103], a[32:35], a[228:231]
ds_read_b64_tr_b16 v[84:85], v15 offset:34816
ds_read_b64_tr_b16 v[86:87], v15 offset:51200
v_mfma_f32_16x16x32_bf16 a[244:247], v[100:103], a[36:39], a[244:247]
ds_read_b64_tr_b16 v[88:89], v16 offset:34816
v_mul_f32 v200, v200, v136
v_mfma_f32_16x16x32_bf16 a[232:235], v[104:107], a[32:35], a[232:235]
ds_read_b64_tr_b16 v[90:91], v16 offset:51200
ds_read_b64_tr_b16 v[92:93], v17 offset:34816
v_mfma_f32_16x16x32_bf16 a[248:251], v[104:107], a[36:39], a[248:251]
ds_read_b64_tr_b16 v[94:95], v17 offset:51200
v_mul_f32 v201, v201, v137
v_mfma_f32_16x16x32_bf16 a[236:239], v[108:111], a[32:35], a[236:239]
ds_read_b64_tr_b16 v[96:97], v14 offset:35840
ds_read_b64_tr_b16 v[98:99], v14 offset:52224
v_mfma_f32_16x16x32_bf16 a[252:255], v[108:111], a[36:39], a[252:255]
buffer_load_dwordx4 v41, s[48:51], s77 offen offset:3072 lds
v_mfma_f32_16x16x32_bf16 a[224:227], v[112:115], a[40:43], a[224:227]
ds_read_b64_tr_b16 v[100:101], v15 offset:35840
ds_read_b64_tr_b16 v[102:103], v15 offset:52224
v_mfma_f32_16x16x32_bf16 a[240:243], v[112:115], a[44:47], a[240:243]
ds_read_b64_tr_b16 v[104:105], v16 offset:35840
s_waitcnt lgkmcnt(8)
v_mfma_f32_16x16x32_bf16 a[228:231], v[116:119], a[40:43], a[228:231]
ds_read_b64_tr_b16 v[106:107], v16 offset:52224
s_add_u32 m0, s76, 69632
v_mfma_f32_16x16x32_bf16 a[244:247], v[116:119], a[44:47], a[244:247]
ds_read_b64_tr_b16 v[108:109], v17 offset:35840
s_add_u32 s77, s99, 0x240000
v_mfma_f32_16x16x32_bf16 a[232:235], v[120:123], a[40:43], a[232:235]
ds_read_b64_tr_b16 v[110:111], v17 offset:52224
ds_read_b64_tr_b16 v[112:113], v14 offset:36864
v_mfma_f32_16x16x32_bf16 a[248:251], v[120:123], a[44:47], a[248:251]
buffer_load_dwordx4 v38, s[48:51], s77 offen offset:0 lds
v_mfma_f32_16x16x32_bf16 a[236:239], v[124:127], a[40:43], a[236:239]
ds_read_b64_tr_b16 v[114:115], v14 offset:53248
ds_read_b64_tr_b16 v[116:117], v15 offset:36864
v_mfma_f32_16x16x32_bf16 a[252:255], v[124:127], a[44:47], a[252:255]
ds_read_b64_tr_b16 v[118:119], v15 offset:53248
s_add_u32 s91, s6, 77824
v_mfma_f32_16x16x32_bf16 a[224:227], v[80:83], a[48:51], a[224:227]
buffer_load_dwordx4 a[112:115], v46, s[60:63], s91 offen offset:0 sc1
v_mfma_f32_16x16x32_bf16 a[240:243], v[80:83], a[52:55], a[240:243]
ds_read_b64_tr_b16 v[120:121], v16 offset:36864
ds_read_b64_tr_b16 v[122:123], v16 offset:53248
v_mfma_f32_16x16x32_bf16 a[228:231], v[84:87], a[48:51], a[228:231]
buffer_load_dwordx4 a[116:119], v46, s[60:63], s91 offen offset:1024 sc1
v_mfma_f32_16x16x32_bf16 a[244:247], v[84:87], a[52:55], a[244:247]
ds_read_b64_tr_b16 v[124:125], v17 offset:36864
s_waitcnt lgkmcnt(6)
v_mfma_f32_16x16x32_bf16 a[232:235], v[88:91], a[48:51], a[232:235]
buffer_load_dwordx4 v39, s[48:51], s77 offen offset:1024 lds
v_mfma_f32_16x16x32_bf16 a[248:251], v[88:91], a[52:55], a[248:251]
ds_read_b64_tr_b16 v[126:127], v17 offset:53248
ds_read_b64_tr_b16 v[80:81], v14 offset:37888
v_mfma_f32_16x16x32_bf16 a[236:239], v[92:95], a[48:51], a[236:239]
ds_read_b64_tr_b16 v[82:83], v14 offset:54272
v_mul_f32 v202, v202, v138
v_mfma_f32_16x16x32_bf16 a[252:255], v[92:95], a[52:55], a[252:255]
ds_read_b64_tr_b16 v[84:85], v15 offset:37888
ds_read_b64_tr_b16 v[86:87], v15 offset:54272
v_mfma_f32_16x16x32_bf16 a[224:227], v[96:99], a[56:59], a[224:227]
ds_read_b64_tr_b16 v[88:89], v16 offset:37888
v_mul_f32 v203, v203, v139
v_mfma_f32_16x16x32_bf16 a[240:243], v[96:99], a[60:63], a[240:243]
ds_read_b64_tr_b16 v[90:91], v16 offset:54272
v_mul_f32 v204, v204, v140
v_mfma_f32_16x16x32_bf16 a[228:231], v[100:103], a[56:59], a[228:231]
buffer_load_dwordx4 v40, s[48:51], s77 offen offset:2048 lds
v_mfma_f32_16x16x32_bf16 a[244:247], v[100:103], a[60:63], a[244:247]
ds_read_b64_tr_b16 v[92:93], v17 offset:37888
ds_read_b64_tr_b16 v[94:95], v17 offset:54272
v_mfma_f32_16x16x32_bf16 a[232:235], v[104:107], a[56:59], a[232:235]
ds_read_b64_tr_b16 v[96:97], v14 offset:38912
v_mul_f32 v205, v205, v141
v_mfma_f32_16x16x32_bf16 a[248:251], v[104:107], a[60:63], a[248:251]
ds_read_b64_tr_b16 v[98:99], v14 offset:55296
v_mul_f32 v206, v206, v142
v_mfma_f32_16x16x32_bf16 a[236:239], v[108:111], a[56:59], a[236:239]
ds_read_b64_tr_b16 v[100:101], v15 offset:38912
v_mul_f32 v207, v207, v143
v_mfma_f32_16x16x32_bf16 a[252:255], v[108:111], a[60:63], a[252:255]
ds_read_b64_tr_b16 v[102:103], v15 offset:55296
s_waitcnt lgkmcnt(6)
v_mfma_f32_16x16x32_bf16 v[224:227], v[112:115], a[32:35], v[224:227]
buffer_load_dwordx4 v41, s[48:51], s77 offen offset:3072 lds
v_mfma_f32_16x16x32_bf16 v[240:243], v[112:115], a[36:39], v[240:243]
ds_read_b64_tr_b16 v[104:105], v16 offset:38912
ds_read_b64_tr_b16 v[106:107], v16 offset:55296
v_mfma_f32_16x16x32_bf16 v[228:231], v[116:119], a[32:35], v[228:231]
ds_read_b64_tr_b16 v[108:109], v17 offset:38912
v_cvt_pk_bf16_f32 v200, v200, v201
v_mfma_f32_16x16x32_bf16 v[244:247], v[116:119], a[36:39], v[244:247]
ds_read_b64_tr_b16 v[110:111], v17 offset:55296
v_cvt_pk_bf16_f32 v201, v202, v203
v_mfma_f32_16x16x32_bf16 v[232:235], v[120:123], a[32:35], v[232:235]
ds_read_b64_tr_b16 v[112:113], v14 offset:39936
v_cvt_pk_bf16_f32 v202, v204, v205
v_mfma_f32_16x16x32_bf16 v[248:251], v[120:123], a[36:39], v[248:251]
ds_read_b64_tr_b16 v[114:115], v14 offset:56320
v_cvt_pk_bf16_f32 v203, v206, v207
v_mfma_f32_16x16x32_bf16 v[236:239], v[124:127], a[32:35], v[236:239]
buffer_store_dwordx4 v[200:203], v46, s[60:63], s7 offen offset:2048 sc1
v_mfma_f32_16x16x32_bf16 v[252:255], v[124:127], a[36:39], v[252:255]
ds_read_b64_tr_b16 v[116:117], v15 offset:39936
ds_read_b64_tr_b16 v[118:119], v15 offset:56320
v_mfma_f32_16x16x32_bf16 v[224:227], v[80:83], a[40:43], v[224:227]
buffer_load_dwordx4 a[120:123], v46, s[60:63], s91 offen offset:2048 sc1
v_mfma_f32_16x16x32_bf16 v[240:243], v[80:83], a[44:47], v[240:243]
ds_read_b64_tr_b16 v[120:121], v16 offset:39936
ds_read_b64_tr_b16 v[122:123], v16 offset:56320
v_mfma_f32_16x16x32_bf16 v[228:231], v[84:87], a[40:43], v[228:231]
buffer_load_dwordx4 a[124:127], v46, s[60:63], s91 offen offset:3072 sc1
v_mfma_f32_16x16x32_bf16 v[244:247], v[84:87], a[44:47], v[244:247]
ds_read_b64_tr_b16 v[124:125], v17 offset:39936
ds_read_b64_tr_b16 v[126:127], v17 offset:56320
v_mfma_f32_16x16x32_bf16 v[232:235], v[88:91], a[40:43], v[232:235]
v_mul_f32 v208, v208, v144
v_mul_f32 v209, v209, v145
v_mfma_f32_16x16x32_bf16 v[248:251], v[88:91], a[44:47], v[248:251]
v_mul_f32 v210, v210, v146
s_waitcnt lgkmcnt(4)
v_mfma_f32_16x16x32_bf16 v[236:239], v[92:95], a[40:43], v[236:239]
v_mul_f32 v211, v211, v147
v_mul_f32 v212, v212, v148
v_mfma_f32_16x16x32_bf16 v[252:255], v[92:95], a[44:47], v[252:255]
v_mul_f32 v213, v213, v149
v_mul_f32 v214, v214, v150
v_mfma_f32_16x16x32_bf16 v[224:227], v[96:99], a[48:51], v[224:227]
s_waitcnt lgkmcnt(0)
s_barrier
v_mfma_f32_16x16x32_bf16 v[240:243], v[96:99], a[52:55], v[240:243]
ds_read_b64_tr_b16 v[80:81], v10 offset:0
ds_read_b64_tr_b16 v[82:83], v10 offset:16384
v_mfma_f32_16x16x32_bf16 v[228:231], v[100:103], a[48:51], v[228:231]
ds_read_b64_tr_b16 v[84:85], v11 offset:0
s_add_u32 m0, s76, 98304
v_mfma_f32_16x16x32_bf16 v[244:247], v[100:103], a[52:55], v[244:247]
ds_read_b64_tr_b16 v[86:87], v11 offset:16384
s_add_u32 s77, s97, 0x600000
v_mfma_f32_16x16x32_bf16 v[232:235], v[104:107], a[48:51], v[232:235]
ds_read_b64_tr_b16 v[88:89], v12 offset:0
ds_read_b64_tr_b16 v[90:91], v12 offset:16384
v_mfma_f32_16x16x32_bf16 v[248:251], v[104:107], a[52:55], v[248:251]
buffer_load_dwordx4 v26, s[48:51], s77 offen offset:0 lds
v_mfma_f32_16x16x32_bf16 v[236:239], v[108:111], a[48:51], v[236:239]
ds_read_b64_tr_b16 v[92:93], v13 offset:0
ds_read_b64_tr_b16 v[94:95], v13 offset:16384
v_mfma_f32_16x16x32_bf16 v[252:255], v[108:111], a[52:55], v[252:255]
ds_read_b64_tr_b16 v[96:97], v10 offset:1024
v_mul_f32 v215, v215, v151
v_mfma_f32_16x16x32_bf16 v[224:227], v[112:115], a[56:59], v[224:227]
ds_read_b64_tr_b16 v[98:99], v10 offset:17408
ds_read_b64_tr_b16 v[100:101], v11 offset:1024
v_mfma_f32_16x16x32_bf16 v[240:243], v[112:115], a[60:63], v[240:243]
ds_read_b64_tr_b16 v[102:103], v11 offset:17408
v_cvt_pk_bf16_f32 v208, v208, v209
v_mfma_f32_16x16x32_bf16 v[228:231], v[116:119], a[56:59], v[228:231]
ds_read_b64_tr_b16 v[104:105], v12 offset:1024
ds_read_b64_tr_b16 v[106:107], v12 offset:17408
v_mfma_f32_16x16x32_bf16 v[244:247], v[116:119], a[60:63], v[244:247]
buffer_load_dwordx4 v27, s[48:51], s77 offen offset:1024 lds
v_mfma_f32_16x16x32_bf16 v[232:235], v[120:123], a[56:59], v[232:235]
ds_read_b64_tr_b16 v[108:109], v13 offset:1024
ds_read_b64_tr_b16 v[110:111], v13 offset:17408
v_mfma_f32_16x16x32_bf16 v[248:251], v[120:123], a[60:63], v[248:251]
ds_read_b64_tr_b16 v[112:113], v10 offset:2048
v_cvt_pk_bf16_f32 v209, v210, v211
v_mfma_f32_16x16x32_bf16 v[236:239], v[124:127], a[56:59], v[236:239]
ds_read_b64_tr_b16 v[114:115], v10 offset:18432
ds_read_b64_tr_b16 v[116:117], v11 offset:2048
v_mfma_f32_16x16x32_bf16 v[252:255], v[124:127], a[60:63], v[252:255]
ds_read_b64_tr_b16 v[118:119], v11 offset:18432
s_waitcnt lgkmcnt(8)
v_mfma_f32_16x16x32_bf16 v[160:163], v[80:83], a[64:67], v[160:163]
ds_read_b64_tr_b16 v[120:121], v12 offset:2048
s_add_u32 s91, s26, 0
v_mfma_f32_16x16x32_bf16 v[176:179], v[80:83], a[68:71], v[176:179]
buffer_load_dwordx4 v28, s[48:51], s77 offen offset:2048 lds
v_mfma_f32_16x16x32_bf16 v[164:167], v[84:87], a[64:67], v[164:167]
ds_read_b64_tr_b16 v[122:123], v12 offset:18432
ds_read_b64_tr_b16 v[124:125], v13 offset:2048
v_mfma_f32_16x16x32_bf16 v[180:183], v[84:87], a[68:71], v[180:183]
buffer_load_dwordx4 a[128:131], v46, s[60:63], s91 offen offset:0 sc1
v_mfma_f32_16x16x32_bf16 v[168:171], v[88:91], a[64:67], v[168:171]
ds_read_b64_tr_b16 v[126:127], v13 offset:18432
ds_read_b64_tr_b16 v[80:81], v10 offset:3072
v_mfma_f32_16x16x32_bf16 v[184:187], v[88:91], a[68:71], v[184:187]
buffer_load_dwordx4 a[132:135], v46, s[60:63], s91 offen offset:1024 sc1
v_mfma_f32_16x16x32_bf16 v[172:175], v[92:95], a[64:67], v[172:175]
ds_read_b64_tr_b16 v[82:83], v10 offset:19456
ds_read_b64_tr_b16 v[84:85], v11 offset:3072
v_mfma_f32_16x16x32_bf16 v[188:191], v[92:95], a[68:71], v[188:191]
buffer_load_dwordx4 v29, s[48:51], s77 offen offset:3072 lds
v_mfma_f32_16x16x32_bf16 v[160:163], v[96:99], a[72:75], v[160:163]
ds_read_b64_tr_b16 v[86:87], v11 offset:19456
ds_read_b64_tr_b16 v[88:89], v12 offset:3072
v_mfma_f32_16x16x32_bf16 v[176:179], v[96:99], a[76:79], v[176:179]
ds_read_b64_tr_b16 v[90:91], v12 offset:19456
v_cvt_pk_bf16_f32 v210, v212, v213
v_mfma_f32_16x16x32_bf16 v[164:167], v[100:103], a[72:75], v[164:167]
ds_read_b64_tr_b16 v[92:93], v13 offset:3072
s_add_u32 m0, s76, 102400
v_mfma_f32_16x16x32_bf16 v[180:183], v[100:103], a[76:79], v[180:183]
ds_read_b64_tr_b16 v[94:95], v13 offset:19456
s_waitcnt lgkmcnt(7)
v_mfma_f32_16x16x32_bf16 v[168:171], v[104:107], a[72:75], v[168:171]
ds_read_b64_tr_b16 v[96:97], v10 offset:4096
s_add_u32 s77, s98, 0x600000
v_mfma_f32_16x16x32_bf16 v[184:187], v[104:107], a[76:79], v[184:187]
buffer_load_dwordx4 v26, s[48:51], s77 offen offset:0 lds
v_mfma_f32_16x16x32_bf16 v[172:175], v[108:111], a[72:75], v[172:175]
ds_read_b64_tr_b16 v[98:99], v10 offset:20480
ds_read_b64_tr_b16 v[100:101], v11 offset:4096
v_mfma_f32_16x16x32_bf16 v[188:191], v[108:111], a[76:79], v[188:191]
ds_read_b64_tr_b16 v[102:103], v11 offset:20480
v_cvt_pk_bf16_f32 v211, v214, v215
v_mfma_f32_16x16x32_bf16 v[160:163], v[112:115], a[80:83], v[160:163]
buffer_store_dwordx4 v[208:211], v46, s[60:63], s7 offen offset:1024 sc1
v_mfma_f32_16x16x32_bf16 v[176:179], v[112:115], a[84:87], v[176:179]
ds_read_b64_tr_b16 v[104:105], v12 offset:4096
ds_read_b64_tr_b16 v[106:107], v12 offset:20480
v_mfma_f32_16x16x32_bf16 v[164:167], v[116:119], a[80:83], v[164:167]
ds_read_b64_tr_b16 v[108:109], v13 offset:4096
v_mul_f32 v216, v216, v152
v_mfma_f32_16x16x32_bf16 v[180:183], v[116:119], a[84:87], v[180:183]
buffer_load_dwordx4 v27, s[48:51], s77 offen offset:1024 lds
v_mfma_f32_16x16x32_bf16 v[168:171], v[120:123], a[80:83], v[168:171]
ds_read_b64_tr_b16 v[110:111], v13 offset:20480
ds_read_b64_tr_b16 v[112:113], v10 offset:5120
v_mfma_f32_16x16x32_bf16 v[184:187], v[120:123], a[84:87], v[184:187]
ds_read_b64_tr_b16 v[114:115], v10 offset:21504
v_mul_f32 v217, v217, v153
v_mfma_f32_16x16x32_bf16 v[172:175], v[124:127], a[80:83], v[172:175]
ds_read_b64_tr_b16 v[116:117], v11 offset:5120
v_mul_f32 v218, v218, v154
v_mfma_f32_16x16x32_bf16 v[188:191], v[124:127], a[84:87], v[188:191]
ds_read_b64_tr_b16 v[118:119], v11 offset:21504
s_waitcnt vmcnt(15) lgkmcnt(6)
v_mfma_f32_16x16x32_bf16 v[160:163], v[80:83], a[88:91], v[160:163]
buffer_load_dwordx4 a[136:139], v46, s[60:63], s91 offen offset:2048 sc1
v_mfma_f32_16x16x32_bf16 v[176:179], v[80:83], a[92:95], v[176:179]
ds_read_b64_tr_b16 v[120:121], v12 offset:5120
ds_read_b64_tr_b16 v[122:123], v12 offset:21504
v_mfma_f32_16x16x32_bf16 v[164:167], v[84:87], a[88:91], v[164:167]
buffer_load_dwordx4 v28, s[48:51], s77 offen offset:2048 lds
v_mfma_f32_16x16x32_bf16 v[180:183], v[84:87], a[92:95], v[180:183]
ds_read_b64_tr_b16 v[124:125], v13 offset:5120
ds_read_b64_tr_b16 v[126:127], v13 offset:21504
v_mfma_f32_16x16x32_bf16 v[168:171], v[88:91], a[88:91], v[168:171]
buffer_load_dwordx4 a[140:143], v46, s[60:63], s91 offen offset:3072 sc1
v_mfma_f32_16x16x32_bf16 v[184:187], v[88:91], a[92:95], v[184:187]
ds_read_b64_tr_b16 v[80:81], v10 offset:6144
ds_read_b64_tr_b16 v[82:83], v10 offset:22528
v_mfma_f32_16x16x32_bf16 v[172:175], v[92:95], a[88:91], v[172:175]
ds_read_b64_tr_b16 v[84:85], v11 offset:6144
v_mul_f32 v219, v219, v155
v_mfma_f32_16x16x32_bf16 v[188:191], v[92:95], a[92:95], v[188:191]
ds_read_b64_tr_b16 v[86:87], v11 offset:22528
v_mul_f32 v220, v220, v156
v_mfma_f32_16x16x32_bf16 a[224:227], v[96:99], a[64:67], a[224:227]
buffer_load_dwordx4 v29, s[48:51], s77 offen offset:3072 lds
v_mfma_f32_16x16x32_bf16 a[240:243], v[96:99], a[68:71], a[240:243]
ds_read_b64_tr_b16 v[88:89], v12 offset:6144
ds_read_b64_tr_b16 v[90:91], v12 offset:22528
v_mfma_f32_16x16x32_bf16 a[228:231], v[100:103], a[64:67], a[228:231]
ds_read_b64_tr_b16 v[92:93], v13 offset:6144
v_mul_f32 v221, v221, v157
v_mfma_f32_16x16x32_bf16 a[244:247], v[100:103], a[68:71], a[244:247]
ds_read_b64_tr_b16 v[94:95], v13 offset:22528
v_mul_f32 v222, v222, v158
v_mfma_f32_16x16x32_bf16 a[232:235], v[104:107], a[64:67], a[232:235]
ds_read_b64_tr_b16 v[96:97], v10 offset:7168
v_mul_f32 v223, v223, v159
v_mfma_f32_16x16x32_bf16 a[248:251], v[104:107], a[68:71], a[248:251]
ds_read_b64_tr_b16 v[98:99], v10 offset:23552
s_waitcnt lgkmcnt(6)
v_mfma_f32_16x16x32_bf16 a[236:239], v[108:111], a[64:67], a[236:239]
ds_read_b64_tr_b16 v[100:101], v11 offset:7168
v_cvt_pk_bf16_f32 v216, v216, v217
v_mfma_f32_16x16x32_bf16 a[252:255], v[108:111], a[68:71], a[252:255]
ds_read_b64_tr_b16 v[102:103], v11 offset:23552
v_cvt_pk_bf16_f32 v217, v218, v219
v_mfma_f32_16x16x32_bf16 a[224:227], v[112:115], a[72:75], a[224:227]
ds_read_b64_tr_b16 v[104:105], v12 offset:7168
v_cvt_pk_bf16_f32 v218, v220, v221
v_mfma_f32_16x16x32_bf16 a[240:243], v[112:115], a[76:79], a[240:243]
ds_read_b64_tr_b16 v[106:107], v12 offset:23552
v_cvt_pk_bf16_f32 v219, v222, v223
v_mfma_f32_16x16x32_bf16 a[228:231], v[116:119], a[72:75], a[228:231]
buffer_store_dwordx4 v[216:219], v46, s[60:63], s7 offen offset:3072 sc1
v_mfma_f32_16x16x32_bf16 a[244:247], v[116:119], a[76:79], a[244:247]
ds_read_b64_tr_b16 v[108:109], v13 offset:7168
ds_read_b64_tr_b16 v[110:111], v13 offset:23552
v_mfma_f32_16x16x32_bf16 a[232:235], v[120:123], a[72:75], a[232:235]
v_mfma_f32_16x16x32_bf16 a[248:251], v[120:123], a[76:79], a[248:251]
v_mfma_f32_16x16x32_bf16 a[236:239], v[124:127], a[72:75], a[236:239]
v_mfma_f32_16x16x32_bf16 a[252:255], v[124:127], a[76:79], a[252:255]
s_add_u32 s91, s26, 4096
v_mfma_f32_16x16x32_bf16 a[224:227], v[80:83], a[80:83], a[224:227]
s_waitcnt lgkmcnt(0)
s_barrier
v_mfma_f32_16x16x32_bf16 a[240:243], v[80:83], a[84:87], a[240:243]
ds_read_b64_tr_b16 v[112:113], v10 offset:32768
ds_read_b64_tr_b16 v[114:115], v10 offset:49152
v_mfma_f32_16x16x32_bf16 a[228:231], v[84:87], a[80:83], a[228:231]
ds_read_b64_tr_b16 v[116:117], v11 offset:32768
s_add_u32 m0, s76, 0
v_mfma_f32_16x16x32_bf16 a[244:247], v[84:87], a[84:87], a[244:247]
ds_read_b64_tr_b16 v[118:119], v11 offset:49152
s_add_u32 s77, s99, 0x600000
v_mfma_f32_16x16x32_bf16 a[232:235], v[88:91], a[80:83], a[232:235]
ds_read_b64_tr_b16 v[120:121], v12 offset:32768
ds_read_b64_tr_b16 v[122:123], v12 offset:49152
v_mfma_f32_16x16x32_bf16 a[248:251], v[88:91], a[84:87], a[248:251]
buffer_load_dwordx4 v26, s[48:51], s77 offen offset:0 lds
v_mfma_f32_16x16x32_bf16 a[236:239], v[92:95], a[80:83], a[236:239]
ds_read_b64_tr_b16 v[124:125], v13 offset:32768
ds_read_b64_tr_b16 v[126:127], v13 offset:49152
v_mfma_f32_16x16x32_bf16 a[252:255], v[92:95], a[84:87], a[252:255]
buffer_load_dwordx4 a[144:147], v46, s[60:63], s91 offen offset:0 sc1
v_mfma_f32_16x16x32_bf16 a[224:227], v[96:99], a[88:91], a[224:227]
ds_read_b64_tr_b16 v[80:81], v10 offset:33792
ds_read_b64_tr_b16 v[82:83], v10 offset:50176
v_mfma_f32_16x16x32_bf16 a[240:243], v[96:99], a[92:95], a[240:243]
buffer_load_dwordx4 a[148:151], v46, s[60:63], s91 offen offset:1024 sc1
v_mfma_f32_16x16x32_bf16 a[228:231], v[100:103], a[88:91], a[228:231]
ds_read_b64_tr_b16 v[84:85], v11 offset:33792
ds_read_b64_tr_b16 v[86:87], v11 offset:50176
v_mfma_f32_16x16x32_bf16 a[244:247], v[100:103], a[92:95], a[244:247]
buffer_load_dwordx4 v27, s[48:51], s77 offen offset:1024 lds
v_mfma_f32_16x16x32_bf16 a[232:235], v[104:107], a[88:91], a[232:235]
ds_read_b64_tr_b16 v[88:89], v12 offset:33792
ds_read_b64_tr_b16 v[90:91], v12 offset:50176
v_mfma_f32_16x16x32_bf16 a[248:251], v[104:107], a[92:95], a[248:251]
ds_read_b64_tr_b16 v[92:93], v13 offset:33792
v_mfma_f32_16x16x32_bf16 a[236:239], v[108:111], a[88:91], a[236:239]
ds_read_b64_tr_b16 v[94:95], v13 offset:50176
ds_read_b64_tr_b16 v[96:97], v10 offset:34816
v_mfma_f32_16x16x32_bf16 a[252:255], v[108:111], a[92:95], a[252:255]
ds_read_b64_tr_b16 v[98:99], v10 offset:51200
s_waitcnt lgkmcnt(8)
v_mfma_f32_16x16x32_bf16 v[224:227], v[112:115], a[64:67], v[224:227]
ds_read_b64_tr_b16 v[100:101], v11 offset:34816
ds_read_b64_tr_b16 v[102:103], v11 offset:51200
v_mfma_f32_16x16x32_bf16 v[240:243], v[112:115], a[68:71], v[240:243]
buffer_load_dwordx4 v28, s[48:51], s77 offen offset:2048 lds
v_mfma_f32_16x16x32_bf16 v[228:231], v[116:119], a[64:67], v[228:231]
ds_read_b64_tr_b16 v[104:105], v12 offset:34816
ds_read_b64_tr_b16 v[106:107], v12 offset:51200
v_mfma_f32_16x16x32_bf16 v[244:247], v[116:119], a[68:71], v[244:247]
ds_read_b64_tr_b16 v[108:109], v13 offset:34816
v_mfma_f32_16x16x32_bf16 v[232:235], v[120:123], a[64:67], v[232:235]
ds_read_b64_tr_b16 v[110:111], v13 offset:51200
ds_read_b64_tr_b16 v[112:113], v10 offset:35840
v_mfma_f32_16x16x32_bf16 v[248:251], v[120:123], a[68:71], v[248:251]
ds_read_b64_tr_b16 v[114:115], v10 offset:52224
v_mfma_f32_16x16x32_bf16 v[236:239], v[124:127], a[64:67], v[236:239]
ds_read_b64_tr_b16 v[116:117], v11 offset:35840
ds_read_b64_tr_b16 v[118:119], v11 offset:52224
v_mfma_f32_16x16x32_bf16 v[252:255], v[124:127], a[68:71], v[252:255]
buffer_load_dwordx4 v29, s[48:51], s77 offen offset:3072 lds
v_mfma_f32_16x16x32_bf16 v[224:227], v[80:83], a[72:75], v[224:227]
ds_read_b64_tr_b16 v[120:121], v12 offset:35840
ds_read_b128 v[60:63], v56 offset:256
v_mfma_f32_16x16x32_bf16 v[240:243], v[80:83], a[76:79], v[240:243]
ds_read_b64_tr_b16 v[122:123], v12 offset:52224
s_waitcnt lgkmcnt(8)
v_mfma_f32_16x16x32_bf16 v[228:231], v[84:87], a[72:75], v[228:231]
buffer_load_dwordx4 a[152:155], v46, s[60:63], s91 offen offset:2048 sc1
v_mfma_f32_16x16x32_bf16 v[244:247], v[84:87], a[76:79], v[244:247]
ds_read_b64_tr_b16 v[124:125], v13 offset:35840
ds_read_b64_tr_b16 v[126:127], v13 offset:52224
v_mfma_f32_16x16x32_bf16 v[232:235], v[88:91], a[72:75], v[232:235]
buffer_load_dwordx4 a[156:159], v46, s[60:63], s91 offen offset:3072 sc1
v_mfma_f32_16x16x32_bf16 v[248:251], v[88:91], a[76:79], v[248:251]
ds_read_b64_tr_b16 v[80:81], v10 offset:36864
ds_read_b64_tr_b16 v[82:83], v10 offset:53248
v_mfma_f32_16x16x32_bf16 v[236:239], v[92:95], a[72:75], v[236:239]
ds_read_b64_tr_b16 v[84:85], v11 offset:36864
s_add_u32 m0, s76, 4096
v_mfma_f32_16x16x32_bf16 v[252:255], v[92:95], a[76:79], v[252:255]
ds_read_b64_tr_b16 v[86:87], v11 offset:53248
s_add_u32 s77, s97, 0x400000
v_mfma_f32_16x16x32_bf16 v[224:227], v[96:99], a[80:83], v[224:227]
buffer_load_dwordx4 v38, s[48:51], s77 offen offset:0 lds
v_mfma_f32_16x16x32_bf16 v[240:243], v[96:99], a[84:87], v[240:243]
ds_read_b64_tr_b16 v[88:89], v12 offset:36864
ds_read_b64_tr_b16 v[90:91], v12 offset:53248
v_mfma_f32_16x16x32_bf16 v[228:231], v[100:103], a[80:83], v[228:231]
ds_read_b64_tr_b16 v[92:93], v13 offset:36864
ds_read_b128 v[64:67], v56 offset:320
v_mfma_f32_16x16x32_bf16 v[244:247], v[100:103], a[84:87], v[244:247]
ds_read_b64_tr_b16 v[94:95], v13 offset:53248
ds_read_b128 v[68:71], v56 offset:384
v_mfma_f32_16x16x32_bf16 v[232:235], v[104:107], a[80:83], v[232:235]
ds_read_b64_tr_b16 v[96:97], v10 offset:37888
ds_read_b128 v[72:75], v56 offset:448
v_mfma_f32_16x16x32_bf16 v[248:251], v[104:107], a[84:87], v[248:251]
ds_read_b64_tr_b16 v[98:99], v10 offset:54272
s_waitcnt lgkmcnt(9)
v_mfma_f32_16x16x32_bf16 v[236:239], v[108:111], a[80:83], v[236:239]
buffer_load_dwordx4 v39, s[48:51], s77 offen offset:1024 lds
v_mfma_f32_16x16x32_bf16 v[252:255], v[108:111], a[84:87], v[252:255]
ds_read_b64_tr_b16 v[100:101], v11 offset:37888
ds_read_b64_tr_b16 v[102:103], v11 offset:54272
v_mfma_f32_16x16x32_bf16 v[224:227], v[112:115], a[88:91], v[224:227]
ds_read_b64_tr_b16 v[104:105], v12 offset:37888
v_and_b32 v2, 15, v1
v_mfma_f32_16x16x32_bf16 v[240:243], v[112:115], a[92:95], v[240:243]
ds_read_b64_tr_b16 v[106:107], v12 offset:54272
v_lshrrev_b32 v3, 2, v2
v_mfma_f32_16x16x32_bf16 v[228:231], v[116:119], a[88:91], v[228:231]
ds_read_b64_tr_b16 v[108:109], v13 offset:37888
v_lshrrev_b32 v4, 4, v1
v_mfma_f32_16x16x32_bf16 v[244:247], v[116:119], a[92:95], v[244:247]
ds_read_b64_tr_b16 v[110:111], v13 offset:54272
v_and_b32 v5, 1, v1
v_mfma_f32_16x16x32_bf16 v[232:235], v[120:123], a[88:91], v[232:235]
buffer_load_dwordx4 v40, s[48:51], s77 offen offset:2048 lds
v_mfma_f32_16x16x32_bf16 v[248:251], v[120:123], a[92:95], v[248:251]
ds_read_b64_tr_b16 v[112:113], v10 offset:38912
ds_read_b64_tr_b16 v[114:115], v10 offset:55296
v_mfma_f32_16x16x32_bf16 v[236:239], v[124:127], a[88:91], v[236:239]
ds_read_b64_tr_b16 v[116:117], v11 offset:38912
v_lshlrev_b32 v5, 4, v5
v_mfma_f32_16x16x32_bf16 v[252:255], v[124:127], a[92:95], v[252:255]
ds_read_b64_tr_b16 v[118:119], v11 offset:55296
v_mov_b32 v6, 0x3f80
v_mfma_f32_16x16x32_bf16 v[160:163], v[80:83], a[96:99], v[160:163]
ds_read_b64_tr_b16 v[120:121], v12 offset:38912
v_lshlrev_b32 v5, v5, v6
v_mfma_f32_16x16x32_bf16 v[176:179], v[80:83], a[100:103], v[176:179]
v_cmp_eq_u32 vcc, v3, v4
s_nop 1
v_cndmask_b32 v5, 0, v5, vcc
v_mfma_f32_16x16x32_bf16 v[164:167], v[84:87], a[96:99], v[164:167]
ds_read_b64_tr_b16 v[122:123], v12 offset:55296
ds_read_b64_tr_b16 v[124:125], v13 offset:38912
v_mfma_f32_16x16x32_bf16 v[180:183], v[84:87], a[100:103], v[180:183]
ds_read_b64_tr_b16 v[126:127], v13 offset:55296
s_waitcnt lgkmcnt(6)
v_mfma_f32_16x16x32_bf16 v[168:171], v[88:91], a[96:99], v[168:171]
buffer_load_dwordx4 v41, s[48:51], s77 offen offset:3072 lds
v_mfma_f32_16x16x32_bf16 v[184:187], v[88:91], a[100:103], v[184:187]
ds_read_b64_tr_b16 v[80:81], v10 offset:39936
ds_read_b64_tr_b16 v[82:83], v10 offset:56320
v_mfma_f32_16x16x32_bf16 v[172:175], v[92:95], a[96:99], v[172:175]
ds_read_b64_tr_b16 v[84:85], v11 offset:39936
v_and_b32 v6, 2, v1
v_mfma_f32_16x16x32_bf16 v[188:191], v[92:95], a[100:103], v[188:191]
v_cmp_eq_u32 vcc, 0, v6
s_nop 1
v_cndmask_b32 v76, 0, v5, vcc
v_mfma_f32_16x16x32_bf16 v[160:163], v[96:99], a[104:107], v[160:163]
ds_read_b64_tr_b16 v[86:87], v11 offset:56320
ds_read_b64_tr_b16 v[88:89], v12 offset:39936
v_mfma_f32_16x16x32_bf16 v[176:179], v[96:99], a[108:111], v[176:179]
ds_read_b64_tr_b16 v[90:91], v12 offset:56320
v_sub_u32 v77, v5, v76
v_mfma_f32_16x16x32_bf16 v[164:167], v[100:103], a[104:107], v[164:167]
ds_read_b64_tr_b16 v[92:93], v13 offset:39936
v_lshlrev_b32 v2, 11, v2
v_mfma_f32_16x16x32_bf16 v[180:183], v[100:103], a[108:111], v[180:183]
s_add_u32 s70, s0, S_D3 - K_pc + 0
s_addc_u32 s71, s1, 0
global_load_dword v57, v9, s[70:71]
v_mfma_f32_16x16x32_bf16 v[168:171], v[104:107], a[104:107], v[168:171]
ds_read_b64_tr_b16 v[94:95], v13 offset:56320
v_bfe_u32 v3, v1, 4, 1
v_mfma_f32_16x16x32_bf16 v[184:187], v[104:107], a[108:111], v[184:187]
v_lshl_add_u32 v2, v3, 5, v2
v_bfe_u32 v3, v1, 5, 1
v_mfma_f32_16x16x32_bf16 v[172:175], v[108:111], a[104:107], v[172:175]
v_lshl_add_u32 v2, v3, 4, v2
s_add_u32 s12, s88, s83
v_mfma_f32_16x16x32_bf16 v[188:191], v[108:111], a[108:111], v[188:191]
s_add_u32 s13, s12, 32768
s_add_u32 s14, s11, 4096
v_mfma_f32_16x16x32_bf16 v[160:163], v[112:115], a[112:115], v[160:163]
s_add_u32 s15, s11, 8192
v_mfma_f32_16x16x32_bf16 v[176:179], v[112:115], a[116:119], v[176:179]
s_waitcnt vmcnt(30) lgkmcnt(0)
s_barrier
s_waitcnt vmcnt(13)
s_atomic_add s69, s[60:61], s24 offset:896
v_mfma_f32_16x16x32_bf16 v[164:167], v[116:119], a[112:115], v[164:167]
ds_read_b64_tr_b16 v[96:97], v14 offset:0
ds_read_b64_tr_b16 v[98:99], v14 offset:16384
v_mfma_f32_16x16x32_bf16 v[180:183], v[116:119], a[116:119], v[180:183]
ds_read_b64_tr_b16 v[100:101], v15 offset:0
ds_read_b64_tr_b16 v[102:103], v15 offset:16384
v_mfma_f32_16x16x32_bf16 v[168:171], v[120:123], a[112:115], v[168:171]
ds_read_b64_tr_b16 v[104:105], v16 offset:0
s_add_u32 m0, s76, 32768
v_mfma_f32_16x16x32_bf16 v[184:187], v[120:123], a[116:119], v[184:187]
ds_read_b64_tr_b16 v[106:107], v16 offset:16384
s_add_u32 s77, s98, 0x400000
v_mfma_f32_16x16x32_bf16 v[172:175], v[124:127], a[112:115], v[172:175]
ds_read_b64_tr_b16 v[108:109], v17 offset:0
ds_read_b64_tr_b16 v[110:111], v17 offset:16384
v_mfma_f32_16x16x32_bf16 v[188:191], v[124:127], a[116:119], v[188:191]
buffer_load_dwordx4 v38, s[48:51], s77 offen offset:0 lds
v_mfma_f32_16x16x32_bf16 v[160:163], v[80:83], a[120:123], v[160:163]
ds_read_b64_tr_b16 v[112:113], v14 offset:1024
ds_read_b64_tr_b16 v[114:115], v14 offset:17408
v_mfma_f32_16x16x32_bf16 v[176:179], v[80:83], a[124:127], v[176:179]
buffer_load_dwordx4 v[128:131], v46, s[60:63], s27 offen offset:0 sc1
v_mfma_f32_16x16x32_bf16 v[164:167], v[84:87], a[120:123], v[164:167]
ds_read_b64_tr_b16 v[116:117], v15 offset:1024
ds_read_b64_tr_b16 v[118:119], v15 offset:17408
v_mfma_f32_16x16x32_bf16 v[180:183], v[84:87], a[124:127], v[180:183]
buffer_load_dwordx4 v[132:135], v46, s[60:63], s27 offen offset:2048 sc1
v_mfma_f32_16x16x32_bf16 v[168:171], v[88:91], a[120:123], v[168:171]
ds_read_b64_tr_b16 v[120:121], v16 offset:1024
ds_read_b64_tr_b16 v[122:123], v16 offset:17408
v_mfma_f32_16x16x32_bf16 v[184:187], v[88:91], a[124:127], v[184:187]
buffer_load_dwordx4 v39, s[48:51], s77 offen offset:1024 lds
v_mfma_f32_16x16x32_bf16 v[172:175], v[92:95], a[120:123], v[172:175]
ds_read_b64_tr_b16 v[124:125], v17 offset:1024
ds_read_b64_tr_b16 v[126:127], v17 offset:17408
v_mfma_f32_16x16x32_bf16 v[188:191], v[92:95], a[124:127], v[188:191]
ds_read_b64_tr_b16 v[80:81], v14 offset:2048
s_waitcnt lgkmcnt(7)
v_mfma_f32_16x16x32_bf16 a[224:227], v[96:99], a[96:99], a[224:227]
buffer_load_dwordx4 v[136:139], v46, s[60:63], s27 offen offset:1024 sc1
v_mfma_f32_16x16x32_bf16 a[240:243], v[96:99], a[100:103], a[240:243]
ds_read_b64_tr_b16 v[82:83], v14 offset:18432
ds_read_b64_tr_b16 v[84:85], v15 offset:2048
v_mfma_f32_16x16x32_bf16 a[228:231], v[100:103], a[96:99], a[228:231]
buffer_load_dwordx4 v[140:143], v46, s[60:63], s27 offen offset:3072 sc1
v_mfma_f32_16x16x32_bf16 a[244:247], v[100:103], a[100:103], a[244:247]
ds_read_b64_tr_b16 v[86:87], v15 offset:18432
ds_read_b64_tr_b16 v[88:89], v16 offset:2048
v_mfma_f32_16x16x32_bf16 a[232:235], v[104:107], a[96:99], a[232:235]
buffer_load_dwordx4 v40, s[48:51], s77 offen offset:2048 lds
v_mfma_f32_16x16x32_bf16 a[248:251], v[104:107], a[100:103], a[248:251]
ds_read_b64_tr_b16 v[90:91], v16 offset:18432
ds_read_b64_tr_b16 v[92:93], v17 offset:2048
v_mfma_f32_16x16x32_bf16 a[236:239], v[108:111], a[96:99], a[236:239]
ds_read_b64_tr_b16 v[94:95], v17 offset:18432
v_mfma_f32_16x16x32_bf16 a[252:255], v[108:111], a[100:103], a[252:255]
ds_read_b64_tr_b16 v[96:97], v14 offset:3072
ds_read_b64_tr_b16 v[98:99], v14 offset:19456
v_mfma_f32_16x16x32_bf16 a[224:227], v[112:115], a[104:107], a[224:227]
ds_read_b64_tr_b16 v[100:101], v15 offset:3072
v_mfma_f32_16x16x32_bf16 a[240:243], v[112:115], a[108:111], a[240:243]
ds_read_b64_tr_b16 v[102:103], v15 offset:19456
s_waitcnt lgkmcnt(7)
v_mfma_f32_16x16x32_bf16 a[228:231], v[116:119], a[104:107], a[228:231]
buffer_load_dwordx4 v41, s[48:51], s77 offen offset:3072 lds
v_mfma_f32_16x16x32_bf16 a[244:247], v[116:119], a[108:111], a[244:247]
ds_read_b64_tr_b16 v[104:105], v16 offset:3072
ds_read_b64_tr_b16 v[106:107], v16 offset:19456
v_mfma_f32_16x16x32_bf16 a[232:235], v[120:123], a[104:107], a[232:235]
ds_read_b64_tr_b16 v[108:109], v17 offset:3072
v_mfma_f32_16x16x32_bf16 a[248:251], v[120:123], a[108:111], a[248:251]
ds_read_b64_tr_b16 v[110:111], v17 offset:19456
s_add_u32 m0, s76, 36864
v_mfma_f32_16x16x32_bf16 a[236:239], v[124:127], a[104:107], a[236:239]
ds_read_b64_tr_b16 v[112:113], v14 offset:4096
s_add_u32 s77, s97, 0x440000
v_mfma_f32_16x16x32_bf16 a[252:255], v[124:127], a[108:111], a[252:255]
ds_read_b64_tr_b16 v[114:115], v14 offset:20480
ds_read_b64_tr_b16 v[116:117], v15 offset:4096
v_mfma_f32_16x16x32_bf16 a[224:227], v[80:83], a[112:115], a[224:227]
buffer_load_dwordx4 v38, s[48:51], s77 offen offset:0 lds
v_mfma_f32_16x16x32_bf16 a[240:243], v[80:83], a[116:119], a[240:243]
ds_read_b64_tr_b16 v[118:119], v15 offset:20480
ds_read_b64_tr_b16 v[120:121], v16 offset:4096
v_mfma_f32_16x16x32_bf16 a[228:231], v[84:87], a[112:115], a[228:231]
ds_read_b64_tr_b16 v[122:123], v16 offset:20480
v_mfma_f32_16x16x32_bf16 a[244:247], v[84:87], a[116:119], a[244:247]
ds_read_b64_tr_b16 v[124:125], v17 offset:4096
s_waitcnt lgkmcnt(7)
v_mfma_f32_16x16x32_bf16 a[232:235], v[88:91], a[112:115], a[232:235]
ds_read_b64_tr_b16 v[126:127], v17 offset:20480
ds_read_b64_tr_b16 v[80:81], v14 offset:5120
v_mfma_f32_16x16x32_bf16 a[248:251], v[88:91], a[116:119], a[248:251]
ds_read_b64_tr_b16 v[82:83], v14 offset:21504
v_mfma_f32_16x16x32_bf16 a[236:239], v[92:95], a[112:115], a[236:239]
buffer_load_dwordx4 v39, s[48:51], s77 offen offset:1024 lds
v_mfma_f32_16x16x32_bf16 a[252:255], v[92:95], a[116:119], a[252:255]
ds_read_b64_tr_b16 v[84:85], v15 offset:5120
ds_read_b64_tr_b16 v[86:87], v15 offset:21504
v_mfma_f32_16x16x32_bf16 a[224:227], v[96:99], a[120:123], a[224:227]
ds_read_b64_tr_b16 v[88:89], v16 offset:5120
v_mfma_f32_16x16x32_bf16 a[240:243], v[96:99], a[124:127], a[240:243]
ds_read_b64_tr_b16 v[90:91], v16 offset:21504
ds_read_b64_tr_b16 v[92:93], v17 offset:5120
v_mfma_f32_16x16x32_bf16 a[228:231], v[100:103], a[120:123], a[228:231]
ds_read_b64_tr_b16 v[94:95], v17 offset:21504
v_mfma_f32_16x16x32_bf16 a[244:247], v[100:103], a[124:127], a[244:247]
ds_read_b64_tr_b16 v[96:97], v14 offset:6144
ds_read_b64_tr_b16 v[98:99], v14 offset:22528
v_mfma_f32_16x16x32_bf16 a[232:235], v[104:107], a[120:123], a[232:235]
buffer_load_dwordx4 v40, s[48:51], s77 offen offset:2048 lds
v_mfma_f32_16x16x32_bf16 a[248:251], v[104:107], a[124:127], a[248:251]
ds_read_b64_tr_b16 v[100:101], v15 offset:6144
ds_read_b64_tr_b16 v[102:103], v15 offset:22528
v_mfma_f32_16x16x32_bf16 a[236:239], v[108:111], a[120:123], a[236:239]
ds_read_b64_tr_b16 v[104:105], v16 offset:6144
v_mfma_f32_16x16x32_bf16 a[252:255], v[108:111], a[124:127], a[252:255]
ds_read_b64_tr_b16 v[106:107], v16 offset:22528
s_waitcnt lgkmcnt(7)
v_mfma_f32_16x16x32_bf16 v[224:227], v[112:115], a[96:99], v[224:227]
ds_read_b64_tr_b16 v[108:109], v17 offset:6144
v_mfma_f32_16x16x32_bf16 v[240:243], v[112:115], a[100:103], v[240:243]
ds_read_b64_tr_b16 v[110:111], v17 offset:22528
v_mfma_f32_16x16x32_bf16 v[228:231], v[116:119], a[96:99], v[228:231]
buffer_load_dwordx4 v41, s[48:51], s77 offen offset:3072 lds
v_mfma_f32_16x16x32_bf16 v[244:247], v[116:119], a[100:103], v[244:247]
ds_read_b64_tr_b16 v[112:113], v14 offset:7168
ds_read_b64_tr_b16 v[114:115], v14 offset:23552
v_mfma_f32_16x16x32_bf16 v[232:235], v[120:123], a[96:99], v[232:235]
ds_read_b64_tr_b16 v[116:117], v15 offset:7168
v_mfma_f32_16x16x32_bf16 v[248:251], v[120:123], a[100:103], v[248:251]
ds_read_b64_tr_b16 v[118:119], v15 offset:23552
v_mfma_f32_16x16x32_bf16 v[236:239], v[124:127], a[96:99], v[236:239]
ds_read_b64_tr_b16 v[120:121], v16 offset:7168
v_mfma_f32_16x16x32_bf16 v[252:255], v[124:127], a[100:103], v[252:255]
ds_read_b64_tr_b16 v[122:123], v16 offset:23552
v_mfma_f32_16x16x32_bf16 v[224:227], v[80:83], a[104:107], v[224:227]
ds_read_b64_tr_b16 v[124:125], v17 offset:7168
v_mfma_f32_16x16x32_bf16 v[240:243], v[80:83], a[108:111], v[240:243]
ds_read_b64_tr_b16 v[126:127], v17 offset:23552
v_mfma_f32_16x16x32_bf16 v[228:231], v[84:87], a[104:107], v[228:231]
v_mfma_f32_16x16x32_bf16 v[244:247], v[84:87], a[108:111], v[244:247]
v_mfma_f32_16x16x32_bf16 v[232:235], v[88:91], a[104:107], v[232:235]
v_mfma_f32_16x16x32_bf16 v[248:251], v[88:91], a[108:111], v[248:251]
s_waitcnt lgkmcnt(2)
v_mfma_f32_16x16x32_bf16 v[236:239], v[92:95], a[104:107], v[236:239]
s_waitcnt lgkmcnt(0)
s_barrier
s_mov_b32 s87, 0
s_atomic_add s87, s[60:61], s24 offset:896 glc
v_mfma_f32_16x16x32_bf16 v[252:255], v[92:95], a[108:111], v[252:255]
ds_read_b64_tr_b16 v[80:81], v14 offset:32768
ds_read_b64_tr_b16 v[82:83], v14 offset:49152
v_mfma_f32_16x16x32_bf16 v[224:227], v[96:99], a[112:115], v[224:227]
ds_read_b64_tr_b16 v[84:85], v15 offset:32768
s_add_u32 m0, s76, 65536
v_mfma_f32_16x16x32_bf16 v[240:243], v[96:99], a[116:119], v[240:243]
ds_read_b64_tr_b16 v[86:87], v15 offset:49152
s_add_u32 s77, s98, 0x440000
v_mfma_f32_16x16x32_bf16 v[228:231], v[100:103], a[112:115], v[228:231]
buffer_load_dwordx4 v38, s[48:51], s77 offen offset:0 lds
v_mfma_f32_16x16x32_bf16 v[244:247], v[100:103], a[116:119], v[244:247]
ds_read_b64_tr_b16 v[88:89], v16 offset:32768
ds_read_b64_tr_b16 v[90:91], v16 offset:49152
v_mfma_f32_16x16x32_bf16 v[232:235], v[104:107], a[112:115], v[232:235]
ds_read_b64_tr_b16 v[92:93], v17 offset:32768
v_mfma_f32_16x16x32_bf16 v[248:251], v[104:107], a[116:119], v[248:251]
ds_read_b64_tr_b16 v[94:95], v17 offset:49152
ds_read_b64_tr_b16 v[96:97], v14 offset:33792
v_mfma_f32_16x16x32_bf16 v[236:239], v[108:111], a[112:115], v[236:239]
ds_read_b64_tr_b16 v[98:99], v14 offset:50176
v_mfma_f32_16x16x32_bf16 v[252:255], v[108:111], a[116:119], v[252:255]
ds_read_b64_tr_b16 v[100:101], v15 offset:33792
ds_read_b64_tr_b16 v[102:103], v15 offset:50176
v_mfma_f32_16x16x32_bf16 v[224:227], v[112:115], a[120:123], v[224:227]
buffer_load_dwordx4 v39, s[48:51], s77 offen offset:1024 lds
v_mfma_f32_16x16x32_bf16 v[240:243], v[112:115], a[124:127], v[240:243]
ds_read_b64_tr_b16 v[104:105], v16 offset:33792
ds_read_b64_tr_b16 v[106:107], v16 offset:50176
v_mfma_f32_16x16x32_bf16 v[228:231], v[116:119], a[120:123], v[228:231]
ds_read_b64_tr_b16 v[108:109], v17 offset:33792
v_mfma_f32_16x16x32_bf16 v[244:247], v[116:119], a[124:127], v[244:247]
ds_read_b64_tr_b16 v[110:111], v17 offset:50176
ds_read_b64_tr_b16 v[112:113], v14 offset:34816
v_mfma_f32_16x16x32_bf16 v[232:235], v[120:123], a[120:123], v[232:235]
ds_read_b64_tr_b16 v[114:115], v14 offset:51200
v_mfma_f32_16x16x32_bf16 v[248:251], v[120:123], a[124:127], v[248:251]
ds_read_b64_tr_b16 v[116:117], v15 offset:34816
ds_read_b64_tr_b16 v[118:119], v15 offset:51200
v_mfma_f32_16x16x32_bf16 v[236:239], v[124:127], a[120:123], v[236:239]
buffer_load_dwordx4 v40, s[48:51], s77 offen offset:2048 lds
v_mfma_f32_16x16x32_bf16 v[252:255], v[124:127], a[124:127], v[252:255]
ds_read_b64_tr_b16 v[120:121], v16 offset:34816
s_waitcnt lgkmcnt(7)
v_mfma_f32_16x16x32_bf16 v[160:163], v[80:83], a[128:131], v[160:163]
ds_read_b64_tr_b16 v[122:123], v16 offset:51200
s_waitcnt vmcnt(9)
v_lshlrev_b32 v192, 16, v128
v_mfma_f32_16x16x32_bf16 v[176:179], v[80:83], a[132:135], v[176:179]
ds_read_b64_tr_b16 v[124:125], v17 offset:34816
v_and_b32 v193, 0xffff0000, v128
v_mfma_f32_16x16x32_bf16 v[164:167], v[84:87], a[128:131], v[164:167]
ds_read_b64_tr_b16 v[126:127], v17 offset:51200
v_lshlrev_b32 v194, 16, v129
v_mfma_f32_16x16x32_bf16 v[180:183], v[84:87], a[132:135], v[180:183]
ds_read_b64_tr_b16 v[80:81], v14 offset:35840
v_and_b32 v195, 0xffff0000, v129
v_mfma_f32_16x16x32_bf16 v[168:171], v[88:91], a[128:131], v[168:171]
buffer_load_dwordx4 v41, s[48:51], s77 offen offset:3072 lds
v_mfma_f32_16x16x32_bf16 v[184:187], v[88:91], a[132:135], v[184:187]
ds_read_b64_tr_b16 v[82:83], v14 offset:52224
v_lshlrev_b32 v196, 16, v130
v_mfma_f32_16x16x32_bf16 v[172:175], v[92:95], a[128:131], v[172:175]
ds_read_b64_tr_b16 v[84:85], v15 offset:35840
v_and_b32 v197, 0xffff0000, v130
v_mfma_f32_16x16x32_bf16 v[188:191], v[92:95], a[132:135], v[188:191]
ds_read_b64_tr_b16 v[86:87], v15 offset:52224
s_add_u32 m0, s76, 69632
v_mfma_f32_16x16x32_bf16 v[160:163], v[96:99], a[136:139], v[160:163]
ds_read_b64_tr_b16 v[88:89], v16 offset:35840
s_add_u32 s77, s99, 0x400000
v_mfma_f32_16x16x32_bf16 v[176:179], v[96:99], a[140:143], v[176:179]
ds_read_b64_tr_b16 v[90:91], v16 offset:52224
v_lshlrev_b32 v198, 16, v131
v_mfma_f32_16x16x32_bf16 v[164:167], v[100:103], a[136:139], v[164:167]
buffer_load_dwordx4 v38, s[48:51], s77 offen offset:0 lds
v_mfma_f32_16x16x32_bf16 v[180:183], v[100:103], a[140:143], v[180:183]
ds_read_b64_tr_b16 v[92:93], v17 offset:35840
ds_read_b64_tr_b16 v[94:95], v17 offset:52224
v_mfma_f32_16x16x32_bf16 v[168:171], v[104:107], a[136:139], v[168:171]
ds_read_b64_tr_b16 v[96:97], v14 offset:36864
v_and_b32 v199, 0xffff0000, v131
v_mfma_f32_16x16x32_bf16 v[184:187], v[104:107], a[140:143], v[184:187]
ds_read_b64_tr_b16 v[98:99], v14 offset:53248
s_waitcnt lgkmcnt(6)
v_mfma_f32_16x16x32_bf16 v[172:175], v[108:111], a[136:139], v[172:175]
ds_read_b64_tr_b16 v[100:101], v15 offset:36864
v_lshlrev_b32 v200, 16, v132
v_mfma_f32_16x16x32_bf16 v[188:191], v[108:111], a[140:143], v[188:191]
ds_read_b64_tr_b16 v[102:103], v15 offset:53248
v_and_b32 v201, 0xffff0000, v132
v_mfma_f32_16x16x32_bf16 v[160:163], v[112:115], a[144:147], v[160:163]
buffer_load_dwordx4 v39, s[48:51], s77 offen offset:1024 lds
v_mfma_f32_16x16x32_bf16 v[176:179], v[112:115], a[148:151], v[176:179]
ds_read_b64_tr_b16 v[104:105], v16 offset:36864
ds_read_b64_tr_b16 v[106:107], v16 offset:53248
v_mfma_f32_16x16x32_bf16 v[164:167], v[116:119], a[144:147], v[164:167]
ds_read_b64_tr_b16 v[108:109], v17 offset:36864
v_lshlrev_b32 v202, 16, v133
v_mfma_f32_16x16x32_bf16 v[180:183], v[116:119], a[148:151], v[180:183]
ds_read_b64_tr_b16 v[110:111], v17 offset:53248
v_and_b32 v203, 0xffff0000, v133
v_mfma_f32_16x16x32_bf16 v[168:171], v[120:123], a[144:147], v[168:171]
ds_read_b64_tr_b16 v[112:113], v14 offset:37888
v_lshlrev_b32 v204, 16, v134
v_mfma_f32_16x16x32_bf16 v[184:187], v[120:123], a[148:151], v[184:187]
ds_read_b64_tr_b16 v[114:115], v14 offset:54272
v_and_b32 v205, 0xffff0000, v134
v_mfma_f32_16x16x32_bf16 v[172:175], v[124:127], a[144:147], v[172:175]
buffer_load_dwordx4 v40, s[48:51], s77 offen offset:2048 lds
v_mfma_f32_16x16x32_bf16 v[188:191], v[124:127], a[148:151], v[188:191]
ds_read_b64_tr_b16 v[116:117], v15 offset:37888
ds_read_b64_tr_b16 v[118:119], v15 offset:54272
v_mfma_f32_16x16x32_bf16 v[160:163], v[80:83], a[152:155], v[160:163]
ds_read_b64_tr_b16 v[120:121], v16 offset:37888
v_lshlrev_b32 v206, 16, v135
v_mfma_f32_16x16x32_bf16 v[176:179], v[80:83], a[156:159], v[176:179]
ds_read_b64_tr_b16 v[122:123], v16 offset:54272
v_and_b32 v207, 0xffff0000, v135
v_mfma_f32_16x16x32_bf16 v[164:167], v[84:87], a[152:155], v[164:167]
ds_read_b64_tr_b16 v[124:125], v17 offset:37888
v_lshlrev_b32 v208, 16, v136
v_mfma_f32_16x16x32_bf16 v[180:183], v[84:87], a[156:159], v[180:183]
ds_read_b64_tr_b16 v[126:127], v17 offset:54272
s_waitcnt lgkmcnt(6)
v_mfma_f32_16x16x32_bf16 v[168:171], v[88:91], a[152:155], v[168:171]
buffer_load_dwordx4 v41, s[48:51], s77 offen offset:3072 lds
v_mfma_f32_16x16x32_bf16 v[184:187], v[88:91], a[156:159], v[184:187]
ds_read_b64_tr_b16 v[80:81], v14 offset:38912
ds_read_b64_tr_b16 v[82:83], v14 offset:55296
v_mfma_f32_16x16x32_bf16 v[172:175], v[92:95], a[152:155], v[172:175]
ds_read_b64_tr_b16 v[84:85], v15 offset:38912
v_and_b32 v209, 0xffff0000, v136
v_mfma_f32_16x16x32_bf16 v[188:191], v[92:95], a[156:159], v[188:191]
ds_read_b64_tr_b16 v[86:87], v15 offset:55296
v_lshlrev_b32 v210, 16, v137
v_mfma_f32_16x16x32_bf16 a[224:227], v[96:99], a[128:131], a[224:227]
ds_read_b64_tr_b16 v[88:89], v16 offset:38912
v_and_b32 v211, 0xffff0000, v137
v_mfma_f32_16x16x32_bf16 a[240:243], v[96:99], a[132:135], a[240:243]
ds_read_b64_tr_b16 v[90:91], v16 offset:55296
v_lshlrev_b32 v212, 16, v138
v_mfma_f32_16x16x32_bf16 a[228:231], v[100:103], a[128:131], a[228:231]
ds_read_b64_tr_b16 v[92:93], v17 offset:38912
v_and_b32 v213, 0xffff0000, v138
v_mfma_f32_16x16x32_bf16 a[244:247], v[100:103], a[132:135], a[244:247]
ds_read_b64_tr_b16 v[94:95], v17 offset:55296
v_lshlrev_b32 v214, 16, v139
v_mfma_f32_16x16x32_bf16 a[232:235], v[104:107], a[128:131], a[232:235]
ds_read_b64_tr_b16 v[96:97], v14 offset:39936
v_and_b32 v215, 0xffff0000, v139
v_mfma_f32_16x16x32_bf16 a[248:251], v[104:107], a[132:135], a[248:251]
ds_read_b64_tr_b16 v[98:99], v14 offset:56320
v_lshlrev_b32 v216, 16, v140
v_mfma_f32_16x16x32_bf16 a[236:239], v[108:111], a[128:131], a[236:239]
ds_read_b64_tr_b16 v[100:101], v15 offset:39936
v_and_b32 v217, 0xffff0000, v140
v_mfma_f32_16x16x32_bf16 a[252:255], v[108:111], a[132:135], a[252:255]
ds_read_b64_tr_b16 v[102:103], v15 offset:56320
v_lshlrev_b32 v218, 16, v141
v_mfma_f32_16x16x32_bf16 a[224:227], v[112:115], a[136:139], a[224:227]
ds_read_b64_tr_b16 v[104:105], v16 offset:39936
v_and_b32 v219, 0xffff0000, v141
v_mfma_f32_16x16x32_bf16 a[240:243], v[112:115], a[140:143], a[240:243]
ds_read_b64_tr_b16 v[106:107], v16 offset:56320
s_waitcnt lgkmcnt(6)
v_mfma_f32_16x16x32_bf16 a[228:231], v[116:119], a[136:139], a[228:231]
ds_read_b64_tr_b16 v[108:109], v17 offset:39936
v_lshlrev_b32 v220, 16, v142
v_mfma_f32_16x16x32_bf16 a[244:247], v[116:119], a[140:143], a[244:247]
ds_read_b64_tr_b16 v[110:111], v17 offset:56320
v_and_b32 v221, 0xffff0000, v142
v_mfma_f32_16x16x32_bf16 a[232:235], v[120:123], a[136:139], a[232:235]
v_lshlrev_b32 v222, 16, v143
v_and_b32 v223, 0xffff0000, v143
v_mfma_f32_16x16x32_bf16 a[248:251], v[120:123], a[140:143], a[248:251]
v_mfma_f32_16x16x32_bf16 a[236:239], v[124:127], a[136:139], a[236:239]
v_mfma_f32_16x16x32_bf16 a[252:255], v[124:127], a[140:143], a[252:255]
v_mfma_f32_16x16x32_bf16 a[224:227], v[80:83], a[144:147], a[224:227]
s_waitcnt lgkmcnt(0)
s_barrier
s_cmp_lt_u32 s87, 4
s_cbranch_scc1 pl_6_slow
pl_6_ok:
v_mfma_f32_16x16x32_bf16 a[240:243], v[80:83], a[148:151], a[240:243]
ds_read_b64_tr_b16 v[112:113], v10 offset:0
ds_read_b64_tr_b16 v[114:115], v10 offset:16384
v_mfma_f32_16x16x32_bf16 a[228:231], v[84:87], a[144:147], a[228:231]
ds_read_b64_tr_b16 v[116:117], v11 offset:0
s_add_u32 m0, s76, 98304
v_mfma_f32_16x16x32_bf16 a[244:247], v[84:87], a[148:151], a[244:247]
ds_read_b64_tr_b16 v[118:119], v11 offset:16384
s_add_u32 s77, s99, 0x440000
ds_read_b64_tr_b16 v[120:121], v12 offset:0
v_mfma_f32_16x16x32_bf16 a[232:235], v[88:91], a[144:147], a[232:235]
buffer_load_dwordx4 v38, s[48:51], s77 offen offset:0 lds
ds_read_b64_tr_b16 v[122:123], v12 offset:16384
v_mfma_f32_16x16x32_bf16 a[248:251], v[88:91], a[148:151], a[248:251]
ds_read_b64_tr_b16 v[124:125], v13 offset:0
ds_read_b64_tr_b16 v[126:127], v13 offset:16384
ds_read_b64_tr_b16 v[80:81], v10 offset:1024
v_mfma_f32_16x16x32_bf16 a[236:239], v[92:95], a[144:147], a[236:239]
ds_read_b64_tr_b16 v[82:83], v10 offset:17408
s_add_u32 s91, s6, 131072
v_mfma_f32_16x16x32_bf16 a[252:255], v[92:95], a[148:151], a[252:255]
buffer_load_dwordx4 a[160:163], v46, s[60:63], s91 offen offset:0 sc1
ds_read_b64_tr_b16 v[84:85], v11 offset:1024
v_mfma_f32_16x16x32_bf16 a[224:227], v[96:99], a[152:155], a[224:227]
ds_read_b64_tr_b16 v[86:87], v11 offset:17408
ds_read_b64_tr_b16 v[88:89], v12 offset:1024
v_mfma_f32_16x16x32_bf16 a[240:243], v[96:99], a[156:159], a[240:243]
buffer_load_dwordx4 a[164:167], v46, s[60:63], s91 offen offset:1024 sc1
ds_read_b64_tr_b16 v[90:91], v12 offset:17408
v_mfma_f32_16x16x32_bf16 a[228:231], v[100:103], a[152:155], a[228:231]
ds_read_b64_tr_b16 v[92:93], v13 offset:1024
ds_read_b64_tr_b16 v[94:95], v13 offset:17408
v_mfma_f32_16x16x32_bf16 a[244:247], v[100:103], a[156:159], a[244:247]
buffer_load_dwordx4 v39, s[48:51], s77 offen offset:1024 lds
v_mfma_f32_16x16x32_bf16 a[232:235], v[104:107], a[152:155], a[232:235]
ds_read_b64_tr_b16 v[96:97], v10 offset:2048
ds_read_b64_tr_b16 v[98:99], v10 offset:18432
v_mfma_f32_16x16x32_bf16 a[248:251], v[104:107], a[156:159], a[248:251]
buffer_load_dwordx4 a[168:171], v46, s[60:63], s91 offen offset:2048 sc1
ds_read_b64_tr_b16 v[100:101], v11 offset:2048
v_mfma_f32_16x16x32_bf16 a[236:239], v[108:111], a[152:155], a[236:239]
ds_read_b64_tr_b16 v[102:103], v11 offset:18432
ds_read_b64_tr_b16 v[104:105], v12 offset:2048
v_mfma_f32_16x16x32_bf16 a[252:255], v[108:111], a[156:159], a[252:255]
ds_read_b64_tr_b16 v[106:107], v12 offset:18432
s_waitcnt lgkmcnt(8)
v_mfma_f32_16x16x32_bf16 v[224:227], v[112:115], a[128:131], v[224:227]
buffer_load_dwordx4 a[172:175], v46, s[60:63], s91 offen offset:3072 sc1
v_mfma_f32_16x16x32_bf16 v[240:243], v[112:115], a[132:135], v[240:243]
ds_read_b64_tr_b16 v[108:109], v13 offset:2048
s_add_u32 s91, s6, 135168
v_mfma_f32_16x16x32_bf16 v[228:231], v[116:119], a[128:131], v[228:231]
buffer_load_dwordx4 v40, s[48:51], s77 offen offset:2048 lds
v_mfma_f32_16x16x32_bf16 v[244:247], v[116:119], a[132:135], v[244:247]
ds_read_b64_tr_b16 v[110:111], v13 offset:18432
ds_read_b64_tr_b16 v[112:113], v10 offset:3072
v_mfma_f32_16x16x32_bf16 v[232:235], v[120:123], a[128:131], v[232:235]
buffer_load_dwordx4 a[176:179], v46, s[60:63], s91 offen offset:0 sc1
v_mfma_f32_16x16x32_bf16 v[248:251], v[120:123], a[132:135], v[248:251]
ds_read_b64_tr_b16 v[114:115], v10 offset:19456
ds_read_b64_tr_b16 v[116:117], v11 offset:3072
v_mfma_f32_16x16x32_bf16 v[236:239], v[124:127], a[128:131], v[236:239]
buffer_load_dwordx4 a[180:183], v46, s[60:63], s91 offen offset:1024 sc1
v_mfma_f32_16x16x32_bf16 v[252:255], v[124:127], a[132:135], v[252:255]
ds_read_b64_tr_b16 v[118:119], v11 offset:19456
ds_read_b64_tr_b16 v[120:121], v12 offset:3072
v_mfma_f32_16x16x32_bf16 v[224:227], v[80:83], a[136:139], v[224:227]
buffer_load_dwordx4 v41, s[48:51], s77 offen offset:3072 lds
v_mfma_f32_16x16x32_bf16 v[240:243], v[80:83], a[140:143], v[240:243]
ds_read_b64_tr_b16 v[122:123], v12 offset:19456
ds_read_b64_tr_b16 v[124:125], v13 offset:3072
v_mfma_f32_16x16x32_bf16 v[228:231], v[84:87], a[136:139], v[228:231]
buffer_load_dwordx4 a[184:187], v46, s[60:63], s91 offen offset:2048 sc1
v_mfma_f32_16x16x32_bf16 v[244:247], v[84:87], a[140:143], v[244:247]
ds_read_b64_tr_b16 v[126:127], v13 offset:19456
s_add_u32 m0, s76, 102400
v_mfma_f32_16x16x32_bf16 v[232:235], v[88:91], a[136:139], v[232:235]
buffer_load_dwordx4 a[188:191], v46, s[60:63], s91 offen offset:3072 sc1
v_mfma_f32_16x16x32_bf16 v[248:251], v[88:91], a[140:143], v[248:251]
ds_read_b64_tr_b16 v[80:81], v10 offset:4096
s_waitcnt lgkmcnt(4)
v_mfma_f32_16x16x32_bf16 v[236:239], v[92:95], a[136:139], v[236:239]
ds_read_b64_tr_b16 v[82:83], v10 offset:20480
s_add_u32 s77, s100, 0x0
v_mfma_f32_16x16x32_bf16 v[252:255], v[92:95], a[140:143], v[252:255]
buffer_load_dwordx4 v38, s[48:51], s77 offen offset:0 lds
v_mfma_f32_16x16x32_bf16 v[224:227], v[96:99], a[144:147], v[224:227]
ds_read_b64_tr_b16 v[84:85], v11 offset:4096
ds_read_b64_tr_b16 v[86:87], v11 offset:20480
v_mfma_f32_16x16x32_bf16 v[240:243], v[96:99], a[148:151], v[240:243]
ds_read_b64_tr_b16 v[88:89], v12 offset:4096
s_add_u32 s91, s6, 139264
v_mfma_f32_16x16x32_bf16 v[228:231], v[100:103], a[144:147], v[228:231]
buffer_load_dwordx4 a[192:195], v46, s[60:63], s91 offen offset:0 sc1
v_mfma_f32_16x16x32_bf16 v[244:247], v[100:103], a[148:151], v[244:247]
ds_read_b64_tr_b16 v[90:91], v12 offset:20480
ds_read_b64_tr_b16 v[92:93], v13 offset:4096
v_mfma_f32_16x16x32_bf16 v[232:235], v[104:107], a[144:147], v[232:235]
buffer_load_dwordx4 a[196:199], v46, s[60:63], s91 offen offset:1024 sc1
v_mfma_f32_16x16x32_bf16 v[248:251], v[104:107], a[148:151], v[248:251]
ds_read_b64_tr_b16 v[94:95], v13 offset:20480
ds_read_b64_tr_b16 v[96:97], v10 offset:5120
v_mfma_f32_16x16x32_bf16 v[236:239], v[108:111], a[144:147], v[236:239]
buffer_load_dwordx4 v39, s[48:51], s77 offen offset:1024 lds
v_mfma_f32_16x16x32_bf16 v[252:255], v[108:111], a[148:151], v[252:255]
ds_read_b64_tr_b16 v[98:99], v10 offset:21504
ds_read_b64_tr_b16 v[100:101], v11 offset:5120
v_mfma_f32_16x16x32_bf16 v[224:227], v[112:115], a[152:155], v[224:227]
buffer_load_dwordx4 a[200:203], v46, s[60:63], s91 offen offset:2048 sc1
v_mfma_f32_16x16x32_bf16 v[240:243], v[112:115], a[156:159], v[240:243]
ds_read_b64_tr_b16 v[102:103], v11 offset:21504
ds_read_b64_tr_b16 v[104:105], v12 offset:5120
v_mfma_f32_16x16x32_bf16 v[228:231], v[116:119], a[152:155], v[228:231]
buffer_load_dwordx4 a[204:207], v46, s[60:63], s91 offen offset:3072 sc1
v_mfma_f32_16x16x32_bf16 v[244:247], v[116:119], a[156:159], v[244:247]
ds_read_b64_tr_b16 v[106:107], v12 offset:21504
s_waitcnt lgkmcnt(5)
v_mfma_f32_16x16x32_bf16 v[232:235], v[120:123], a[152:155], v[232:235]
buffer_load_dwordx4 v40, s[48:51], s77 offen offset:2048 lds
v_mfma_f32_16x16x32_bf16 v[248:251], v[120:123], a[156:159], v[248:251]
ds_read_b64_tr_b16 v[108:109], v13 offset:5120
ds_read_b64_tr_b16 v[110:111], v13 offset:21504
v_mfma_f32_16x16x32_bf16 v[236:239], v[124:127], a[152:155], v[236:239]
ds_read_b64_tr_b16 v[112:113], v10 offset:6144
s_add_u32 s91, s6, 143360
v_mfma_f32_16x16x32_bf16 v[252:255], v[124:127], a[156:159], v[252:255]
ds_read_b64_tr_b16 v[114:115], v10 offset:22528
s_waitcnt vmcnt(17)
v_mfma_f32_16x16x32_bf16 v[160:163], v[80:83], a[160:163], v[160:163]
ds_read_b64_tr_b16 v[116:117], v11 offset:6144
s_waitcnt vmcnt(16)
v_mfma_f32_16x16x32_bf16 v[176:179], v[80:83], a[164:167], v[176:179]
buffer_load_dwordx4 a[208:211], v46, s[60:63], s91 offen offset:0 sc1
v_mfma_f32_16x16x32_bf16 v[164:167], v[84:87], a[160:163], v[164:167]
ds_read_b64_tr_b16 v[118:119], v11 offset:22528
ds_read_b64_tr_b16 v[120:121], v12 offset:6144
v_mfma_f32_16x16x32_bf16 v[180:183], v[84:87], a[164:167], v[180:183]
buffer_load_dwordx4 v41, s[48:51], s77 offen offset:3072 lds
v_mfma_f32_16x16x32_bf16 v[168:171], v[88:91], a[160:163], v[168:171]
ds_read_b64_tr_b16 v[122:123], v12 offset:22528
ds_read_b64_tr_b16 v[124:125], v13 offset:6144
v_mfma_f32_16x16x32_bf16 v[184:187], v[88:91], a[164:167], v[184:187]
buffer_load_dwordx4 a[212:215], v46, s[60:63], s91 offen offset:1024 sc1
v_mfma_f32_16x16x32_bf16 v[172:175], v[92:95], a[160:163], v[172:175]
ds_read_b64_tr_b16 v[126:127], v13 offset:22528
ds_read_b64_tr_b16 v[80:81], v10 offset:7168
v_mfma_f32_16x16x32_bf16 v[188:191], v[92:95], a[164:167], v[188:191]
ds_read_b64_tr_b16 v[82:83], v10 offset:23552
s_waitcnt vmcnt(17) lgkmcnt(7)
v_mfma_f32_16x16x32_bf16 v[160:163], v[96:99], a[168:171], v[160:163]
ds_read_b64_tr_b16 v[84:85], v11 offset:7168
s_waitcnt vmcnt(16)
v_mfma_f32_16x16x32_bf16 v[176:179], v[96:99], a[172:175], v[176:179]
buffer_load_dwordx4 a[216:219], v46, s[60:63], s91 offen offset:2048 sc1
v_mfma_f32_16x16x32_bf16 v[164:167], v[100:103], a[168:171], v[164:167]
ds_read_b64_tr_b16 v[86:87], v11 offset:23552
ds_read_b64_tr_b16 v[88:89], v12 offset:7168
v_mfma_f32_16x16x32_bf16 v[180:183], v[100:103], a[172:175], v[180:183]
buffer_load_dwordx4 a[220:223], v46, s[60:63], s91 offen offset:3072 sc1
v_mfma_f32_16x16x32_bf16 v[168:171], v[104:107], a[168:171], v[168:171]
ds_read_b64_tr_b16 v[90:91], v12 offset:23552
ds_read_b64_tr_b16 v[92:93], v13 offset:7168
v_mfma_f32_16x16x32_bf16 v[184:187], v[104:107], a[172:175], v[184:187]
ds_read_b64_tr_b16 v[94:95], v13 offset:23552
v_mfma_f32_16x16x32_bf16 v[172:175], v[108:111], a[168:171], v[172:175]
v_mfma_f32_16x16x32_bf16 v[188:191], v[108:111], a[172:175], v[188:191]
s_waitcnt vmcnt(16)
v_mfma_f32_16x16x32_bf16 v[160:163], v[112:115], a[176:179], v[160:163]
s_waitcnt vmcnt(15)
v_mfma_f32_16x16x32_bf16 v[176:179], v[112:115], a[180:183], v[176:179]
s_waitcnt lgkmcnt(3)
v_mfma_f32_16x16x32_bf16 v[164:167], v[116:119], a[176:179], v[164:167]
s_waitcnt lgkmcnt(0)
s_barrier
v_mfma_f32_16x16x32_bf16 v[180:183], v[116:119], a[180:183], v[180:183]
ds_read_b64_tr_b16 v[96:97], v10 offset:32768
ds_read_b64_tr_b16 v[98:99], v10 offset:49152
v_mfma_f32_16x16x32_bf16 v[168:171], v[120:123], a[176:179], v[168:171]
ds_read_b64_tr_b16 v[100:101], v11 offset:32768
ds_read_b64_tr_b16 v[102:103], v11 offset:49152
v_mfma_f32_16x16x32_bf16 v[184:187], v[120:123], a[180:183], v[184:187]
ds_read_b64_tr_b16 v[104:105], v12 offset:32768
ds_read_b64_tr_b16 v[106:107], v12 offset:49152
v_mfma_f32_16x16x32_bf16 v[172:175], v[124:127], a[176:179], v[172:175]
ds_read_b64_tr_b16 v[108:109], v13 offset:32768
s_add_u32 m0, s76, 0
v_mfma_f32_16x16x32_bf16 v[188:191], v[124:127], a[180:183], v[188:191]
ds_read_b64_tr_b16 v[110:111], v13 offset:49152
s_waitcnt vmcnt(13)
v_mfma_f32_16x16x32_bf16 v[160:163], v[80:83], a[184:187], v[160:163]
ds_read_b64_tr_b16 v[112:113], v10 offset:33792
s_waitcnt vmcnt(12)
v_mfma_f32_16x16x32_bf16 v[176:179], v[80:83], a[188:191], v[176:179]
ds_read_b64_tr_b16 v[114:115], v10 offset:50176
s_add_u32 s77, s100, 0x40000
v_mfma_f32_16x16x32_bf16 v[164:167], v[84:87], a[184:187], v[164:167]
ds_read_b64_tr_b16 v[116:117], v11 offset:33792
ds_read_b64_tr_b16 v[118:119], v11 offset:50176
v_mfma_f32_16x16x32_bf16 v[180:183], v[84:87], a[188:191], v[180:183]
buffer_load_dwordx4 v38, s[48:51], s77 offen offset:0 lds
v_mfma_f32_16x16x32_bf16 v[168:171], v[88:91], a[184:187], v[168:171]
ds_read_b64_tr_b16 v[120:121], v12 offset:33792
ds_read_b64_tr_b16 v[122:123], v12 offset:50176
v_mfma_f32_16x16x32_bf16 v[184:187], v[88:91], a[188:191], v[184:187]
ds_read_b64_tr_b16 v[124:125], v13 offset:33792
v_mfma_f32_16x16x32_bf16 v[172:175], v[92:95], a[184:187], v[172:175]
ds_read_b64_tr_b16 v[126:127], v13 offset:50176
ds_read_b64_tr_b16 v[80:81], v10 offset:34816
v_mfma_f32_16x16x32_bf16 v[188:191], v[92:95], a[188:191], v[188:191]
ds_read_b64_tr_b16 v[82:83], v10 offset:51200
s_waitcnt lgkmcnt(8)
v_mfma_f32_16x16x32_bf16 a[224:227], v[96:99], a[160:163], a[224:227]
ds_read_b64_tr_b16 v[84:85], v11 offset:34816
ds_read_b64_tr_b16 v[86:87], v11 offset:51200
v_mfma_f32_16x16x32_bf16 a[240:243], v[96:99], a[164:167], a[240:243]
buffer_load_dwordx4 v39, s[48:51], s77 offen offset:1024 lds
v_mfma_f32_16x16x32_bf16 a[228:231], v[100:103], a[160:163], a[228:231]
ds_read_b64_tr_b16 v[88:89], v12 offset:34816
ds_read_b64_tr_b16 v[90:91], v12 offset:51200
v_mfma_f32_16x16x32_bf16 a[244:247], v[100:103], a[164:167], a[244:247]
ds_read_b64_tr_b16 v[92:93], v13 offset:34816
v_mfma_f32_16x16x32_bf16 a[232:235], v[104:107], a[160:163], a[232:235]
ds_read_b64_tr_b16 v[94:95], v13 offset:51200
ds_read_b64_tr_b16 v[96:97], v10 offset:35840
v_mfma_f32_16x16x32_bf16 a[248:251], v[104:107], a[164:167], a[248:251]
ds_read_b64_tr_b16 v[98:99], v10 offset:52224
v_mfma_f32_16x16x32_bf16 a[236:239], v[108:111], a[160:163], a[236:239]
ds_read_b64_tr_b16 v[100:101], v11 offset:35840
ds_read_b64_tr_b16 v[102:103], v11 offset:52224
v_mfma_f32_16x16x32_bf16 a[252:255], v[108:111], a[164:167], a[252:255]
buffer_load_dwordx4 v40, s[48:51], s77 offen offset:2048 lds
v_mfma_f32_16x16x32_bf16 a[224:227], v[112:115], a[168:171], a[224:227]
ds_read_b64_tr_b16 v[104:105], v12 offset:35840
ds_read_b64_tr_b16 v[106:107], v12 offset:52224
v_mfma_f32_16x16x32_bf16 a[240:243], v[112:115], a[172:175], a[240:243]
ds_read_b64_tr_b16 v[108:109], v13 offset:35840
s_waitcnt lgkmcnt(8)
v_mfma_f32_16x16x32_bf16 a[228:231], v[116:119], a[168:171], a[228:231]
ds_read_b64_tr_b16 v[110:111], v13 offset:52224
ds_read_b64_tr_b16 v[112:113], v10 offset:36864
v_mfma_f32_16x16x32_bf16 a[244:247], v[116:119], a[172:175], a[244:247]
ds_read_b64_tr_b16 v[114:115], v10 offset:53248
v_mfma_f32_16x16x32_bf16 a[232:235], v[120:123], a[168:171], a[232:235]
ds_read_b64_tr_b16 v[116:117], v11 offset:36864
v_mfma_f32_16x16x32_bf16 a[248:251], v[120:123], a[172:175], a[248:251]
buffer_load_dwordx4 v41, s[48:51], s77 offen offset:3072 lds
v_mfma_f32_16x16x32_bf16 a[236:239], v[124:127], a[168:171], a[236:239]
ds_read_b64_tr_b16 v[118:119], v11 offset:53248
ds_read_b64_tr_b16 v[120:121], v12 offset:36864
v_mfma_f32_16x16x32_bf16 a[252:255], v[124:127], a[172:175], a[252:255]
ds_read_b64_tr_b16 v[122:123], v12 offset:53248
v_mfma_f32_16x16x32_bf16 a[224:227], v[80:83], a[176:179], a[224:227]
ds_read_b64_tr_b16 v[124:125], v13 offset:36864
s_add_u32 m0, s76, 4096
v_mfma_f32_16x16x32_bf16 a[240:243], v[80:83], a[180:183], a[240:243]
ds_read_b64_tr_b16 v[126:127], v13 offset:53248
s_add_u32 s77, s100, 0x200000
v_mfma_f32_16x16x32_bf16 a[228:231], v[84:87], a[176:179], a[228:231]
ds_read_b64_tr_b16 v[80:81], v10 offset:37888
v_mfma_f32_16x16x32_bf16 a[244:247], v[84:87], a[180:183], a[244:247]
buffer_load_dwordx4 v38, s[48:51], s77 offen offset:0 lds
v_mfma_f32_16x16x32_bf16 a[232:235], v[88:91], a[176:179], a[232:235]
ds_read_b64_tr_b16 v[82:83], v10 offset:54272
ds_read_b64_tr_b16 v[84:85], v11 offset:37888
v_mfma_f32_16x16x32_bf16 a[248:251], v[88:91], a[180:183], a[248:251]
ds_read_b64_tr_b16 v[86:87], v11 offset:54272
s_waitcnt lgkmcnt(6)
v_mfma_f32_16x16x32_bf16 a[236:239], v[92:95], a[176:179], a[236:239]
ds_read_b64_tr_b16 v[88:89], v12 offset:37888
v_mfma_f32_16x16x32_bf16 a[252:255], v[92:95], a[180:183], a[252:255]
ds_read_b64_tr_b16 v[90:91], v12 offset:54272
v_mfma_f32_16x16x32_bf16 a[224:227], v[96:99], a[184:187], a[224:227]
ds_read_b64_tr_b16 v[92:93], v13 offset:37888
v_mfma_f32_16x16x32_bf16 a[240:243], v[96:99], a[188:191], a[240:243]
buffer_load_dwordx4 v39, s[48:51], s77 offen offset:1024 lds
v_mfma_f32_16x16x32_bf16 a[228:231], v[100:103], a[184:187], a[228:231]
ds_read_b64_tr_b16 v[94:95], v13 offset:54272
ds_read_b64_tr_b16 v[96:97], v10 offset:38912
v_mfma_f32_16x16x32_bf16 a[244:247], v[100:103], a[188:191], a[244:247]
ds_read_b64_tr_b16 v[98:99], v10 offset:55296
v_mfma_f32_16x16x32_bf16 a[232:235], v[104:107], a[184:187], a[232:235]
ds_read_b64_tr_b16 v[100:101], v11 offset:38912
v_mfma_f32_16x16x32_bf16 a[248:251], v[104:107], a[188:191], a[248:251]
ds_read_b64_tr_b16 v[102:103], v11 offset:55296
v_mfma_f32_16x16x32_bf16 a[236:239], v[108:111], a[184:187], a[236:239]
ds_read_b64_tr_b16 v[104:105], v12 offset:38912
v_mfma_f32_16x16x32_bf16 a[252:255], v[108:111], a[188:191], a[252:255]
ds_read_b64_tr_b16 v[106:107], v12 offset:55296
s_waitcnt vmcnt(6)
v_mfma_f32_16x16x32_bf16 v[160:163], v[112:115], a[192:195], v[160:163]
buffer_load_dwordx4 v40, s[48:51], s77 offen offset:2048 lds
v_mfma_f32_16x16x32_bf16 v[176:179], v[112:115], a[196:199], v[176:179]
ds_read_b64_tr_b16 v[108:109], v13 offset:38912
ds_read_b64_tr_b16 v[110:111], v13 offset:55296
v_mfma_f32_16x16x32_bf16 v[164:167], v[116:119], a[192:195], v[164:167]
ds_read_b64_tr_b16 v[112:113], v10 offset:39936
v_mfma_f32_16x16x32_bf16 v[180:183], v[116:119], a[196:199], v[180:183]
ds_read_b64_tr_b16 v[114:115], v10 offset:56320
v_mfma_f32_16x16x32_bf16 v[168:171], v[120:123], a[192:195], v[168:171]
ds_read_b64_tr_b16 v[116:117], v11 offset:39936
v_mfma_f32_16x16x32_bf16 v[184:187], v[120:123], a[196:199], v[184:187]
ds_read_b64_tr_b16 v[118:119], v11 offset:56320
s_waitcnt lgkmcnt(6)
v_mfma_f32_16x16x32_bf16 v[172:175], v[124:127], a[192:195], v[172:175]
buffer_load_dwordx4 v41, s[48:51], s77 offen offset:3072 lds
v_mfma_f32_16x16x32_bf16 v[188:191], v[124:127], a[196:199], v[188:191]
ds_read_b64_tr_b16 v[120:121], v12 offset:39936
ds_read_b64_tr_b16 v[122:123], v12 offset:56320
v_mfma_f32_16x16x32_bf16 v[160:163], v[80:83], a[200:203], v[160:163]
ds_read_b64_tr_b16 v[124:125], v13 offset:39936
v_mfma_f32_16x16x32_bf16 v[176:179], v[80:83], a[204:207], v[176:179]
ds_read_b64_tr_b16 v[126:127], v13 offset:56320
v_mfma_f32_16x16x32_bf16 v[164:167], v[84:87], a[200:203], v[164:167]
v_mfma_f32_16x16x32_bf16 v[180:183], v[84:87], a[204:207], v[180:183]
v_mfma_f32_16x16x32_bf16 v[168:171], v[88:91], a[200:203], v[168:171]
v_mfma_f32_16x16x32_bf16 v[184:187], v[88:91], a[204:207], v[184:187]
v_mfma_f32_16x16x32_bf16 v[172:175], v[92:95], a[200:203], v[172:175]
s_waitcnt lgkmcnt(0)
s_barrier
v_mfma_f32_16x16x32_bf16 v[188:191], v[92:95], a[204:207], v[188:191]
ds_read_b64_tr_b16 v[80:81], v14 offset:0
ds_read_b64_tr_b16 v[82:83], v14 offset:16384
v_mfma_f32_16x16x32_bf16 v[160:163], v[96:99], a[208:211], v[160:163]
ds_read_b64_tr_b16 v[84:85], v15 offset:0
s_add_u32 m0, s76, 32768
v_mfma_f32_16x16x32_bf16 v[176:179], v[96:99], a[212:215], v[176:179]
ds_read_b64_tr_b16 v[86:87], v15 offset:16384
s_add_u32 s77, s100, 0x240000
v_mfma_f32_16x16x32_bf16 v[164:167], v[100:103], a[208:211], v[164:167]
buffer_load_dwordx4 v38, s[48:51], s77 offen offset:0 lds
v_mfma_f32_16x16x32_bf16 v[180:183], v[100:103], a[212:215], v[180:183]
ds_read_b64_tr_b16 v[88:89], v16 offset:0
ds_read_b64_tr_b16 v[90:91], v16 offset:16384
v_mfma_f32_16x16x32_bf16 v[168:171], v[104:107], a[208:211], v[168:171]
ds_read_b64_tr_b16 v[92:93], v17 offset:0
v_mfma_f32_16x16x32_bf16 v[184:187], v[104:107], a[212:215], v[184:187]
ds_read_b64_tr_b16 v[94:95], v17 offset:16384
ds_read_b64_tr_b16 v[96:97], v14 offset:1024
v_mfma_f32_16x16x32_bf16 v[172:175], v[108:111], a[208:211], v[172:175]
ds_read_b64_tr_b16 v[98:99], v14 offset:17408
v_mfma_f32_16x16x32_bf16 v[188:191], v[108:111], a[212:215], v[188:191]
ds_read_b64_tr_b16 v[100:101], v15 offset:1024
ds_read_b64_tr_b16 v[102:103], v15 offset:17408
v_mfma_f32_16x16x32_bf16 v[160:163], v[112:115], a[216:219], v[160:163]
buffer_load_dwordx4 v39, s[48:51], s77 offen offset:1024 lds
v_mfma_f32_16x16x32_bf16 v[176:179], v[112:115], a[220:223], v[176:179]
ds_read_b64_tr_b16 v[104:105], v16 offset:1024
ds_read_b64_tr_b16 v[106:107], v16 offset:17408
v_mfma_f32_16x16x32_bf16 v[164:167], v[116:119], a[216:219], v[164:167]
ds_read_b64_tr_b16 v[108:109], v17 offset:1024
v_mfma_f32_16x16x32_bf16 v[180:183], v[116:119], a[220:223], v[180:183]
ds_read_b64_tr_b16 v[110:111], v17 offset:17408
ds_read_b64_tr_b16 v[112:113], v14 offset:2048
v_mfma_f32_16x16x32_bf16 v[168:171], v[120:123], a[216:219], v[168:171]
ds_read_b64_tr_b16 v[114:115], v14 offset:18432
v_mfma_f32_16x16x32_bf16 v[184:187], v[120:123], a[220:223], v[184:187]
ds_read_b64_tr_b16 v[116:117], v15 offset:2048
ds_read_b64_tr_b16 v[118:119], v15 offset:18432
v_mfma_f32_16x16x32_bf16 v[172:175], v[124:127], a[216:219], v[172:175]
buffer_load_dwordx4 v40, s[48:51], s77 offen offset:2048 lds
v_mfma_f32_16x16x32_bf16 v[188:191], v[124:127], a[220:223], v[188:191]
ds_read_b64_tr_b16 v[120:121], v16 offset:2048
s_waitcnt lgkmcnt(7)
v_mfma_f32_16x16x32_bf16 a[224:227], v[80:83], a[192:195], a[224:227]
ds_read_b64_tr_b16 v[122:123], v16 offset:18432
ds_read_b64_tr_b16 v[124:125], v17 offset:2048
v_mfma_f32_16x16x32_bf16 a[240:243], v[80:83], a[196:199], a[240:243]
ds_read_b64_tr_b16 v[126:127], v17 offset:18432
v_mfma_f32_16x16x32_bf16 a[228:231], v[84:87], a[192:195], a[228:231]
ds_read_b64_tr_b16 v[80:81], v14 offset:3072
v_mfma_f32_16x16x32_bf16 a[244:247], v[84:87], a[196:199], a[244:247]
ds_read_b64_tr_b16 v[82:83], v14 offset:19456
v_cvt_pk_bf16_f32 v160, v160, v161
v_mfma_f32_16x16x32_bf16 a[232:235], v[88:91], a[192:195], a[232:235]
buffer_load_dwordx4 v41, s[48:51], s77 offen offset:3072 lds
v_mfma_f32_16x16x32_bf16 a[248:251], v[88:91], a[196:199], a[248:251]
ds_read_b64_tr_b16 v[84:85], v15 offset:3072
v_cvt_pk_bf16_f32 v161, v162, v163
v_mfma_f32_16x16x32_bf16 a[236:239], v[92:95], a[192:195], a[236:239]
ds_read_b64_tr_b16 v[86:87], v15 offset:19456
v_cvt_pk_bf16_f32 v162, v164, v165
v_mfma_f32_16x16x32_bf16 a[252:255], v[92:95], a[196:199], a[252:255]
ds_read_b64_tr_b16 v[88:89], v16 offset:3072
s_add_u32 m0, s76, 36864
v_mfma_f32_16x16x32_bf16 a[224:227], v[96:99], a[200:203], a[224:227]
ds_read_b64_tr_b16 v[90:91], v16 offset:19456
s_add_u32 s77, s100, 0x600000
v_mfma_f32_16x16x32_bf16 a[240:243], v[96:99], a[204:207], a[240:243]
ds_read_b64_tr_b16 v[92:93], v17 offset:3072
v_cvt_pk_bf16_f32 v163, v166, v167
v_mfma_f32_16x16x32_bf16 a[228:231], v[100:103], a[200:203], a[228:231]
buffer_load_dwordx4 v26, s[48:51], s77 offen offset:0 lds
v_mfma_f32_16x16x32_bf16 a[244:247], v[100:103], a[204:207], a[244:247]
ds_read_b64_tr_b16 v[94:95], v17 offset:19456
ds_read_b64_tr_b16 v[96:97], v14 offset:4096
v_mfma_f32_16x16x32_bf16 a[232:235], v[104:107], a[200:203], a[232:235]
buffer_store_dwordx4 v[160:163], v46, s[60:63], s8 offen offset:0 sc1
v_mfma_f32_16x16x32_bf16 a[248:251], v[104:107], a[204:207], a[248:251]
ds_read_b64_tr_b16 v[98:99], v14 offset:20480
s_waitcnt lgkmcnt(5)
v_mfma_f32_16x16x32_bf16 a[236:239], v[108:111], a[200:203], a[236:239]
ds_read_b64_tr_b16 v[100:101], v15 offset:4096
v_cvt_pk_bf16_f32 v168, v168, v169
v_mfma_f32_16x16x32_bf16 a[252:255], v[108:111], a[204:207], a[252:255]
ds_read_b64_tr_b16 v[102:103], v15 offset:20480
v_cvt_pk_bf16_f32 v169, v170, v171
v_mfma_f32_16x16x32_bf16 a[224:227], v[112:115], a[208:211], a[224:227]
buffer_load_dwordx4 v27, s[48:51], s77 offen offset:1024 lds
v_mfma_f32_16x16x32_bf16 a[240:243], v[112:115], a[212:215], a[240:243]
ds_read_b64_tr_b16 v[104:105], v16 offset:4096
ds_read_b64_tr_b16 v[106:107], v16 offset:20480
v_mfma_f32_16x16x32_bf16 a[228:231], v[116:119], a[208:211], a[228:231]
ds_read_b64_tr_b16 v[108:109], v17 offset:4096
v_cvt_pk_bf16_f32 v170, v172, v173
v_mfma_f32_16x16x32_bf16 a[244:247], v[116:119], a[212:215], a[244:247]
ds_read_b64_tr_b16 v[110:111], v17 offset:20480
v_cvt_pk_bf16_f32 v171, v174, v175
v_mfma_f32_16x16x32_bf16 a[232:235], v[120:123], a[208:211], a[232:235]
buffer_store_dwordx4 v[168:171], v46, s[60:63], s8 offen offset:1024 sc1
v_mfma_f32_16x16x32_bf16 a[248:251], v[120:123], a[212:215], a[248:251]
ds_read_b64_tr_b16 v[112:113], v14 offset:5120
ds_read_b64_tr_b16 v[114:115], v14 offset:21504
v_mfma_f32_16x16x32_bf16 a[236:239], v[124:127], a[208:211], a[236:239]
buffer_load_dwordx4 v28, s[48:51], s77 offen offset:2048 lds
v_mfma_f32_16x16x32_bf16 a[252:255], v[124:127], a[212:215], a[252:255]
ds_read_b64_tr_b16 v[116:117], v15 offset:5120
ds_read_b64_tr_b16 v[118:119], v15 offset:21504
v_mfma_f32_16x16x32_bf16 a[224:227], v[80:83], a[216:219], a[224:227]
ds_read_b64_tr_b16 v[120:121], v16 offset:5120
v_cvt_pk_bf16_f32 v176, v176, v177
v_mfma_f32_16x16x32_bf16 a[240:243], v[80:83], a[220:223], a[240:243]
ds_read_b64_tr_b16 v[122:123], v16 offset:21504
v_cvt_pk_bf16_f32 v177, v178, v179
v_mfma_f32_16x16x32_bf16 a[228:231], v[84:87], a[216:219], a[228:231]
ds_read_b64_tr_b16 v[124:125], v17 offset:5120
v_cvt_pk_bf16_f32 v178, v180, v181
v_mfma_f32_16x16x32_bf16 a[244:247], v[84:87], a[220:223], a[244:247]
ds_read_b64_tr_b16 v[126:127], v17 offset:21504
s_waitcnt lgkmcnt(6)
v_mfma_f32_16x16x32_bf16 a[232:235], v[88:91], a[216:219], a[232:235]
buffer_load_dwordx4 v29, s[48:51], s77 offen offset:3072 lds
v_mfma_f32_16x16x32_bf16 a[248:251], v[88:91], a[220:223], a[248:251]
ds_read_b64_tr_b16 v[80:81], v14 offset:6144
ds_read_b64_tr_b16 v[82:83], v14 offset:22528
v_mfma_f32_16x16x32_bf16 a[236:239], v[92:95], a[216:219], a[236:239]
ds_read_b64_tr_b16 v[84:85], v15 offset:6144
v_cvt_pk_bf16_f32 v179, v182, v183
v_mfma_f32_16x16x32_bf16 a[252:255], v[92:95], a[220:223], a[252:255]
buffer_store_dwordx4 v[176:179], v46, s[60:63], s8 offen offset:2048 sc1
v_mfma_f32_16x16x32_bf16 v[224:227], v[96:99], a[160:163], v[224:227]
ds_read_b64_tr_b16 v[86:87], v15 offset:22528
ds_read_b64_tr_b16 v[88:89], v16 offset:6144
v_mfma_f32_16x16x32_bf16 v[240:243], v[96:99], a[164:167], v[240:243]
ds_read_b64_tr_b16 v[90:91], v16 offset:22528
v_cvt_pk_bf16_f32 v184, v184, v185
v_mfma_f32_16x16x32_bf16 v[228:231], v[100:103], a[160:163], v[228:231]
ds_read_b64_tr_b16 v[92:93], v17 offset:6144
v_cvt_pk_bf16_f32 v185, v186, v187
v_mfma_f32_16x16x32_bf16 v[244:247], v[100:103], a[164:167], v[244:247]
ds_read_b64_tr_b16 v[94:95], v17 offset:22528
v_cvt_pk_bf16_f32 v186, v188, v189
v_mfma_f32_16x16x32_bf16 v[232:235], v[104:107], a[160:163], v[232:235]
ds_read_b64_tr_b16 v[96:97], v14 offset:7168
v_cvt_pk_bf16_f32 v187, v190, v191
v_mfma_f32_16x16x32_bf16 v[248:251], v[104:107], a[164:167], v[248:251]
buffer_store_dwordx4 v[184:187], v46, s[60:63], s8 offen offset:3072 sc1
v_mfma_f32_16x16x32_bf16 v[236:239], v[108:111], a[160:163], v[236:239]
ds_read_b64_tr_b16 v[98:99], v14 offset:23552
ds_read_b64_tr_b16 v[100:101], v15 offset:7168
v_mfma_f32_16x16x32_bf16 v[252:255], v[108:111], a[164:167], v[252:255]
ds_read_b64_tr_b16 v[102:103], v15 offset:23552
v_accvgpr_read_b32 v160, a224
v_mfma_f32_16x16x32_bf16 v[224:227], v[112:115], a[168:171], v[224:227]
ds_read_b64_tr_b16 v[104:105], v16 offset:7168
v_accvgpr_read_b32 v161, a225
v_mfma_f32_16x16x32_bf16 v[240:243], v[112:115], a[172:175], v[240:243]
ds_read_b64_tr_b16 v[106:107], v16 offset:23552
s_waitcnt lgkmcnt(6)
v_mfma_f32_16x16x32_bf16 v[228:231], v[116:119], a[168:171], v[228:231]
ds_read_b64_tr_b16 v[108:109], v17 offset:7168
v_accvgpr_read_b32 v162, a226
v_mfma_f32_16x16x32_bf16 v[244:247], v[116:119], a[172:175], v[244:247]
ds_read_b64_tr_b16 v[110:111], v17 offset:23552
v_accvgpr_read_b32 v163, a227
v_mfma_f32_16x16x32_bf16 v[232:235], v[120:123], a[168:171], v[232:235]
v_accvgpr_read_b32 v164, a228
v_accvgpr_read_b32 v165, a229
v_mfma_f32_16x16x32_bf16 v[248:251], v[120:123], a[172:175], v[248:251]
v_accvgpr_read_b32 v166, a230
v_accvgpr_read_b32 v167, a231
v_mfma_f32_16x16x32_bf16 v[236:239], v[124:127], a[168:171], v[236:239]
v_cvt_pk_bf16_f32 v160, v160, v161
v_cvt_pk_bf16_f32 v161, v162, v163
v_mfma_f32_16x16x32_bf16 v[252:255], v[124:127], a[172:175], v[252:255]
v_cvt_pk_bf16_f32 v162, v164, v165
v_cvt_pk_bf16_f32 v163, v166, v167
v_mfma_f32_16x16x32_bf16 v[224:227], v[80:83], a[176:179], v[224:227]
s_waitcnt lgkmcnt(0)
s_barrier
v_mfma_f32_16x16x32_bf16 v[240:243], v[80:83], a[180:183], v[240:243]
ds_read_b64_tr_b16 v[112:113], v14 offset:32768
ds_read_b64_tr_b16 v[114:115], v14 offset:49152
v_mfma_f32_16x16x32_bf16 v[228:231], v[84:87], a[176:179], v[228:231]
ds_read_b64_tr_b16 v[116:117], v15 offset:32768
s_add_u32 m0, s76, 65536
v_mfma_f32_16x16x32_bf16 v[244:247], v[84:87], a[180:183], v[244:247]
ds_read_b64_tr_b16 v[118:119], v15 offset:49152
s_add_u32 s77, s100, 0x400000
v_mfma_f32_16x16x32_bf16 v[232:235], v[88:91], a[176:179], v[232:235]
ds_read_b64_tr_b16 v[120:121], v16 offset:32768
ds_read_b64_tr_b16 v[122:123], v16 offset:49152
v_mfma_f32_16x16x32_bf16 v[248:251], v[88:91], a[180:183], v[248:251]
buffer_load_dwordx4 v38, s[48:51], s77 offen offset:0 lds
v_mfma_f32_16x16x32_bf16 v[236:239], v[92:95], a[176:179], v[236:239]
ds_read_b64_tr_b16 v[124:125], v17 offset:32768
ds_read_b64_tr_b16 v[126:127], v17 offset:49152
v_mfma_f32_16x16x32_bf16 v[252:255], v[92:95], a[180:183], v[252:255]
buffer_store_dwordx4 v[160:163], v46, s[60:63], s9 offen offset:0 sc1
v_mfma_f32_16x16x32_bf16 v[224:227], v[96:99], a[184:187], v[224:227]
ds_read_b64_tr_b16 v[80:81], v14 offset:33792
ds_read_b64_tr_b16 v[82:83], v14 offset:50176
v_mfma_f32_16x16x32_bf16 v[240:243], v[96:99], a[188:191], v[240:243]
ds_read_b64_tr_b16 v[84:85], v15 offset:33792
v_accvgpr_read_b32 v168, a232
v_mfma_f32_16x16x32_bf16 v[228:231], v[100:103], a[184:187], v[228:231]
ds_read_b64_tr_b16 v[86:87], v15 offset:50176
ds_read_b64_tr_b16 v[88:89], v16 offset:33792
v_mfma_f32_16x16x32_bf16 v[244:247], v[100:103], a[188:191], v[244:247]
buffer_load_dwordx4 v39, s[48:51], s77 offen offset:1024 lds
v_mfma_f32_16x16x32_bf16 v[232:235], v[104:107], a[184:187], v[232:235]
ds_read_b64_tr_b16 v[90:91], v16 offset:50176
ds_read_b64_tr_b16 v[92:93], v17 offset:33792
v_mfma_f32_16x16x32_bf16 v[248:251], v[104:107], a[188:191], v[248:251]
ds_read_b64_tr_b16 v[94:95], v17 offset:50176
v_accvgpr_read_b32 v169, a233
v_mfma_f32_16x16x32_bf16 v[236:239], v[108:111], a[184:187], v[236:239]
ds_read_b64_tr_b16 v[96:97], v14 offset:34816
ds_read_b64_tr_b16 v[98:99], v14 offset:51200
v_mfma_f32_16x16x32_bf16 v[252:255], v[108:111], a[188:191], v[252:255]
ds_read_b64_tr_b16 v[100:101], v15 offset:34816
s_waitcnt lgkmcnt(8)
v_mfma_f32_16x16x32_bf16 v[224:227], v[112:115], a[192:195], v[224:227]
ds_read_b64_tr_b16 v[102:103], v15 offset:51200
ds_read_b64_tr_b16 v[104:105], v16 offset:34816
v_mfma_f32_16x16x32_bf16 v[240:243], v[112:115], a[196:199], v[240:243]
buffer_load_dwordx4 v40, s[48:51], s77 offen offset:2048 lds
v_mfma_f32_16x16x32_bf16 v[228:231], v[116:119], a[192:195], v[228:231]
ds_read_b64_tr_b16 v[106:107], v16 offset:51200
ds_read_b64_tr_b16 v[108:109], v17 offset:34816
v_mfma_f32_16x16x32_bf16 v[244:247], v[116:119], a[196:199], v[244:247]
ds_read_b64_tr_b16 v[110:111], v17 offset:51200
v_accvgpr_read_b32 v170, a234
v_mfma_f32_16x16x32_bf16 v[232:235], v[120:123], a[192:195], v[232:235]
ds_read_b64_tr_b16 v[112:113], v14 offset:35840
v_accvgpr_read_b32 v171, a235
v_mfma_f32_16x16x32_bf16 v[248:251], v[120:123], a[196:199], v[248:251]
ds_read_b64_tr_b16 v[114:115], v14 offset:52224
v_accvgpr_read_b32 v172, a236
v_mfma_f32_16x16x32_bf16 v[236:239], v[124:127], a[192:195], v[236:239]
ds_read_b64_tr_b16 v[116:117], v15 offset:35840
v_accvgpr_read_b32 v173, a237
v_mfma_f32_16x16x32_bf16 v[252:255], v[124:127], a[196:199], v[252:255]
buffer_load_dwordx4 v41, s[48:51], s77 offen offset:3072 lds
v_mfma_f32_16x16x32_bf16 v[224:227], v[80:83], a[200:203], v[224:227]
ds_read_b64_tr_b16 v[118:119], v15 offset:52224
ds_read_b64_tr_b16 v[120:121], v16 offset:35840
v_mfma_f32_16x16x32_bf16 v[240:243], v[80:83], a[204:207], v[240:243]
ds_read_b64_tr_b16 v[122:123], v16 offset:52224
s_waitcnt lgkmcnt(6)
v_mfma_f32_16x16x32_bf16 v[228:231], v[84:87], a[200:203], v[228:231]
ds_read_b64_tr_b16 v[124:125], v17 offset:35840
s_add_u32 m0, s76, 69632
v_mfma_f32_16x16x32_bf16 v[244:247], v[84:87], a[204:207], v[244:247]
ds_read_b64_tr_b16 v[126:127], v17 offset:52224
s_add_u32 s77, s100, 0x440000
v_mfma_f32_16x16x32_bf16 v[232:235], v[88:91], a[200:203], v[232:235]
ds_read_b64_tr_b16 v[80:81], v14 offset:36864
v_accvgpr_read_b32 v174, a238
v_mfma_f32_16x16x32_bf16 v[248:251], v[88:91], a[204:207], v[248:251]
buffer_load_dwordx4 v38, s[48:51], s77 offen offset:0 lds
v_mfma_f32_16x16x32_bf16 v[236:239], v[92:95], a[200:203], v[236:239]
ds_read_b64_tr_b16 v[82:83], v14 offset:53248
ds_read_b64_tr_b16 v[84:85], v15 offset:36864
v_mfma_f32_16x16x32_bf16 v[252:255], v[92:95], a[204:207], v[252:255]
ds_read_b64_tr_b16 v[86:87], v15 offset:53248
v_accvgpr_read_b32 v175, a239
v_mfma_f32_16x16x32_bf16 v[224:227], v[96:99], a[208:211], v[224:227]
ds_read_b64_tr_b16 v[88:89], v16 offset:36864
v_cvt_pk_bf16_f32 v168, v168, v169
v_mfma_f32_16x16x32_bf16 v[240:243], v[96:99], a[212:215], v[240:243]
ds_read_b64_tr_b16 v[90:91], v16 offset:53248
v_cvt_pk_bf16_f32 v169, v170, v171
v_mfma_f32_16x16x32_bf16 v[228:231], v[100:103], a[208:211], v[228:231]
ds_read_b64_tr_b16 v[92:93], v17 offset:36864
v_cvt_pk_bf16_f32 v170, v172, v173
v_mfma_f32_16x16x32_bf16 v[244:247], v[100:103], a[212:215], v[244:247]
buffer_load_dwordx4 v39, s[48:51], s77 offen offset:1024 lds
v_mfma_f32_16x16x32_bf16 v[232:235], v[104:107], a[208:211], v[232:235]
ds_read_b64_tr_b16 v[94:95], v17 offset:53248
ds_read_b64_tr_b16 v[96:97], v14 offset:37888
v_mfma_f32_16x16x32_bf16 v[248:251], v[104:107], a[212:215], v[248:251]
ds_read_b64_tr_b16 v[98:99], v14 offset:54272
v_cvt_pk_bf16_f32 v171, v174, v175
v_mfma_f32_16x16x32_bf16 v[236:239], v[108:111], a[208:211], v[236:239]
buffer_store_dwordx4 v[168:171], v46, s[60:63], s9 offen offset:1024 sc1
v_mfma_f32_16x16x32_bf16 v[252:255], v[108:111], a[212:215], v[252:255]
ds_read_b64_tr_b16 v[100:101], v15 offset:37888
s_waitcnt lgkmcnt(5)
v_mfma_f32_16x16x32_bf16 v[224:227], v[112:115], a[216:219], v[224:227]
ds_read_b64_tr_b16 v[102:103], v15 offset:54272
ds_read_b64_tr_b16 v[104:105], v16 offset:37888
v_mfma_f32_16x16x32_bf16 v[240:243], v[112:115], a[220:223], v[240:243]
buffer_load_dwordx4 v40, s[48:51], s77 offen offset:2048 lds
v_mfma_f32_16x16x32_bf16 v[228:231], v[116:119], a[216:219], v[228:231]
ds_read_b64_tr_b16 v[106:107], v16 offset:54272
ds_read_b64_tr_b16 v[108:109], v17 offset:37888
v_mfma_f32_16x16x32_bf16 v[244:247], v[116:119], a[220:223], v[244:247]
ds_read_b64_tr_b16 v[110:111], v17 offset:54272
v_accvgpr_read_b32 v176, a240
v_mfma_f32_16x16x32_bf16 v[232:235], v[120:123], a[216:219], v[232:235]
ds_read_b64_tr_b16 v[112:113], v14 offset:38912
v_accvgpr_read_b32 v177, a241
v_mfma_f32_16x16x32_bf16 v[248:251], v[120:123], a[220:223], v[248:251]
ds_read_b64_tr_b16 v[114:115], v14 offset:55296
v_accvgpr_read_b32 v178, a242
v_mfma_f32_16x16x32_bf16 v[236:239], v[124:127], a[216:219], v[236:239]
ds_read_b64_tr_b16 v[116:117], v15 offset:38912
v_accvgpr_read_b32 v179, a243
v_mfma_f32_16x16x32_bf16 v[252:255], v[124:127], a[220:223], v[252:255]
buffer_load_dwordx4 v41, s[48:51], s77 offen offset:3072 lds
S_D3:
v_mfma_f32_16x16x32_bf16 v[128:131], v[80:83], a[0:3], 0
ds_read_b64_tr_b16 v[118:119], v15 offset:55296
ds_read_b64_tr_b16 v[120:121], v16 offset:38912
v_mfma_f32_16x16x32_bf16 v[144:147], v[80:83], a[4:7], 0
ds_read_b64_tr_b16 v[122:123], v16 offset:55296
v_accvgpr_read_b32 v180, a244
v_mfma_f32_16x16x32_bf16 v[132:135], v[84:87], a[0:3], 0
ds_read_b64_tr_b16 v[124:125], v17 offset:38912
v_accvgpr_read_b32 v181, a245
v_mfma_f32_16x16x32_bf16 v[148:151], v[84:87], a[4:7], 0
ds_read_b64_tr_b16 v[126:127], v17 offset:55296
v_accvgpr_read_b32 v182, a246
v_mfma_f32_16x16x32_bf16 v[136:139], v[88:91], a[0:3], 0
ds_read_b64_tr_b16 v[80:81], v14 offset:39936
v_accvgpr_read_b32 v183, a247
v_mfma_f32_16x16x32_bf16 v[152:155], v[88:91], a[4:7], 0
ds_read_b64_tr_b16 v[82:83], v14 offset:56320
s_waitcnt lgkmcnt(7)
v_mfma_f32_16x16x32_bf16 v[140:143], v[92:95], a[0:3], 0
ds_read_b64_tr_b16 v[84:85], v15 offset:39936
v_cvt_pk_bf16_f32 v176, v176, v177
v_mfma_f32_16x16x32_bf16 v[156:159], v[92:95], a[4:7], 0
ds_read_b64_tr_b16 v[86:87], v15 offset:56320
v_cvt_pk_bf16_f32 v177, v178, v179
v_mfma_f32_16x16x32_bf16 v[128:131], v[96:99], a[8:11], v[128:131]
ds_read_b64_tr_b16 v[88:89], v16 offset:39936
v_cvt_pk_bf16_f32 v178, v180, v181
v_mfma_f32_16x16x32_bf16 v[144:147], v[96:99], a[12:15], v[144:147]
ds_read_b64_tr_b16 v[90:91], v16 offset:56320
v_cvt_pk_bf16_f32 v179, v182, v183
v_mfma_f32_16x16x32_bf16 v[132:135], v[100:103], a[8:11], v[132:135]
buffer_store_dwordx4 v[176:179], v46, s[60:63], s9 offen offset:2048 sc1
v_mfma_f32_16x16x32_bf16 v[148:151], v[100:103], a[12:15], v[148:151]
ds_read_b64_tr_b16 v[92:93], v17 offset:39936
ds_read_b64_tr_b16 v[94:95], v17 offset:56320
v_mfma_f32_16x16x32_bf16 v[136:139], v[104:107], a[8:11], v[136:139]
v_accvgpr_read_b32 v184, a248
v_accvgpr_read_b32 v185, a249
v_mfma_f32_16x16x32_bf16 v[152:155], v[104:107], a[12:15], v[152:155]
v_accvgpr_read_b32 v186, a250
v_accvgpr_read_b32 v187, a251
v_mfma_f32_16x16x32_bf16 v[140:143], v[108:111], a[8:11], v[140:143]
v_accvgpr_read_b32 v188, a252
v_accvgpr_read_b32 v189, a253
v_mfma_f32_16x16x32_bf16 v[156:159], v[108:111], a[12:15], v[156:159]
v_accvgpr_read_b32 v190, a254
v_accvgpr_read_b32 v191, a255
v_mfma_f32_16x16x32_bf16 v[128:131], v[112:115], a[16:19], v[128:131]
s_waitcnt vmcnt(23) lgkmcnt(0)
s_barrier
v_mfma_f32_16x16x32_bf16 v[144:147], v[112:115], a[20:23], v[144:147]
ds_read_b64_tr_b16 v[96:97], v10 offset:0
ds_read_b64_tr_b16 v[98:99], v10 offset:16384
v_mfma_f32_16x16x32_bf16 v[132:135], v[116:119], a[16:19], v[132:135]
ds_read_b64_tr_b16 v[100:101], v11 offset:0
v_cvt_pk_bf16_f32 v184, v184, v185
v_mfma_f32_16x16x32_bf16 v[148:151], v[116:119], a[20:23], v[148:151]
ds_read_b64_tr_b16 v[102:103], v11 offset:16384
ds_read_b64_tr_b16 v[104:105], v12 offset:0
v_mfma_f32_16x16x32_bf16 v[136:139], v[120:123], a[16:19], v[136:139]
ds_read_b64_tr_b16 v[106:107], v12 offset:16384
v_cvt_pk_bf16_f32 v185, v186, v187
v_mfma_f32_16x16x32_bf16 v[152:155], v[120:123], a[20:23], v[152:155]
ds_read_b64_tr_b16 v[108:109], v13 offset:0
ds_read_b64_tr_b16 v[110:111], v13 offset:16384
v_mfma_f32_16x16x32_bf16 v[140:143], v[124:127], a[16:19], v[140:143]
ds_read_b64_tr_b16 v[112:113], v10 offset:1024
v_cvt_pk_bf16_f32 v186, v188, v189
v_mfma_f32_16x16x32_bf16 v[156:159], v[124:127], a[20:23], v[156:159]
ds_read_b64_tr_b16 v[114:115], v10 offset:17408
ds_read_b64_tr_b16 v[116:117], v11 offset:1024
v_mfma_f32_16x16x32_bf16 v[128:131], v[80:83], a[24:27], v[128:131]
ds_read_b64_tr_b16 v[118:119], v11 offset:17408
v_cvt_pk_bf16_f32 v187, v190, v191
v_mfma_f32_16x16x32_bf16 v[144:147], v[80:83], a[28:31], v[144:147]
buffer_store_dwordx4 v[184:187], v46, s[60:63], s9 offen offset:3072 sc1
v_mfma_f32_16x16x32_bf16 v[132:135], v[84:87], a[24:27], v[132:135]
ds_read_b64_tr_b16 v[120:121], v12 offset:1024
ds_read_b64_tr_b16 v[122:123], v12 offset:17408
v_mfma_f32_16x16x32_bf16 v[148:151], v[84:87], a[28:31], v[148:151]
ds_read_b64_tr_b16 v[124:125], v13 offset:1024
v_mfma_f32_16x16x32_bf16 v[136:139], v[88:91], a[24:27], v[136:139]
ds_read_b64_tr_b16 v[126:127], v13 offset:17408
ds_read_b64_tr_b16 v[80:81], v10 offset:2048
v_mfma_f32_16x16x32_bf16 v[152:155], v[88:91], a[28:31], v[152:155]
ds_read_b64_tr_b16 v[82:83], v10 offset:18432
v_cvt_pk_bf16_f32 v224, v224, v225
v_mfma_f32_16x16x32_bf16 v[140:143], v[92:95], a[24:27], v[140:143]
ds_read_b64_tr_b16 v[84:85], v11 offset:2048
v_cvt_pk_bf16_f32 v225, v226, v227
v_mfma_f32_16x16x32_bf16 v[156:159], v[92:95], a[28:31], v[156:159]
ds_read_b64_tr_b16 v[86:87], v11 offset:18432
s_waitcnt lgkmcnt(8)
v_mfma_f32_16x16x32_bf16 v[128:131], v[96:99], a[32:35], v[128:131]
ds_read_b64_tr_b16 v[88:89], v12 offset:2048
v_cvt_pk_bf16_f32 v226, v228, v229
v_mfma_f32_16x16x32_bf16 v[144:147], v[96:99], a[36:39], v[144:147]
ds_read_b64_tr_b16 v[90:91], v12 offset:18432
v_cvt_pk_bf16_f32 v227, v230, v231
v_mfma_f32_16x16x32_bf16 v[132:135], v[100:103], a[32:35], v[132:135]
buffer_store_dwordx4 v[224:227], v46, s[60:63], s10 offen offset:0 sc1
v_mfma_f32_16x16x32_bf16 v[148:151], v[100:103], a[36:39], v[148:151]
ds_read_b64_tr_b16 v[92:93], v13 offset:2048
ds_read_b64_tr_b16 v[94:95], v13 offset:18432
v_mfma_f32_16x16x32_bf16 v[136:139], v[104:107], a[32:35], v[136:139]
ds_read_b64_tr_b16 v[96:97], v10 offset:3072
v_cvt_pk_bf16_f32 v232, v232, v233
v_mfma_f32_16x16x32_bf16 v[152:155], v[104:107], a[36:39], v[152:155]
ds_read_b64_tr_b16 v[98:99], v10 offset:19456
v_cvt_pk_bf16_f32 v233, v234, v235
v_mfma_f32_16x16x32_bf16 v[140:143], v[108:111], a[32:35], v[140:143]
ds_read_b64_tr_b16 v[100:101], v11 offset:3072
v_cvt_pk_bf16_f32 v234, v236, v237
v_mfma_f32_16x16x32_bf16 v[156:159], v[108:111], a[36:39], v[156:159]
ds_read_b64_tr_b16 v[102:103], v11 offset:19456
v_cvt_pk_bf16_f32 v235, v238, v239
v_mfma_f32_16x16x32_bf16 v[128:131], v[112:115], a[40:43], v[128:131]
buffer_store_dwordx4 v[232:235], v46, s[60:63], s10 offen offset:1024 sc1
v_mfma_f32_16x16x32_bf16 v[144:147], v[112:115], a[44:47], v[144:147]
ds_read_b64_tr_b16 v[104:105], v12 offset:3072
ds_read_b64_tr_b16 v[106:107], v12 offset:19456
v_mfma_f32_16x16x32_bf16 v[132:135], v[116:119], a[40:43], v[132:135]
ds_read_b64_tr_b16 v[108:109], v13 offset:3072
v_cvt_pk_bf16_f32 v240, v240, v241
v_mfma_f32_16x16x32_bf16 v[148:151], v[116:119], a[44:47], v[148:151]
ds_read_b64_tr_b16 v[110:111], v13 offset:19456
s_waitcnt lgkmcnt(6)
v_mfma_f32_16x16x32_bf16 v[136:139], v[120:123], a[40:43], v[136:139]
ds_read_b64_tr_b16 v[112:113], v10 offset:4096
v_cvt_pk_bf16_f32 v241, v242, v243
v_mfma_f32_16x16x32_bf16 v[152:155], v[120:123], a[44:47], v[152:155]
ds_read_b64_tr_b16 v[114:115], v10 offset:20480
v_cvt_pk_bf16_f32 v242, v244, v245
v_mfma_f32_16x16x32_bf16 v[140:143], v[124:127], a[40:43], v[140:143]
ds_read_b64_tr_b16 v[116:117], v11 offset:4096
v_cvt_pk_bf16_f32 v243, v246, v247
v_mfma_f32_16x16x32_bf16 v[156:159], v[124:127], a[44:47], v[156:159]
buffer_store_dwordx4 v[240:243], v46, s[60:63], s10 offen offset:2048 sc1
v_mfma_f32_16x16x32_bf16 v[128:131], v[80:83], a[48:51], v[128:131]
ds_read_b64_tr_b16 v[118:119], v11 offset:20480
ds_read_b64_tr_b16 v[120:121], v12 offset:4096
v_mfma_f32_16x16x32_bf16 v[144:147], v[80:83], a[52:55], v[144:147]
ds_read_b64_tr_b16 v[122:123], v12 offset:20480
v_cvt_pk_bf16_f32 v248, v248, v249
v_mfma_f32_16x16x32_bf16 v[132:135], v[84:87], a[48:51], v[132:135]
ds_read_b64_tr_b16 v[124:125], v13 offset:4096
v_cvt_pk_bf16_f32 v249, v250, v251
v_mfma_f32_16x16x32_bf16 v[148:151], v[84:87], a[52:55], v[148:151]
ds_read_b64_tr_b16 v[126:127], v13 offset:20480
v_cvt_pk_bf16_f32 v250, v252, v253
v_mfma_f32_16x16x32_bf16 v[136:139], v[88:91], a[48:51], v[136:139]
ds_read_b64_tr_b16 v[80:81], v10 offset:5120
v_cvt_pk_bf16_f32 v251, v254, v255
v_mfma_f32_16x16x32_bf16 v[152:155], v[88:91], a[52:55], v[152:155]
buffer_store_dwordx4 v[248:251], v46, s[60:63], s10 offen offset:3072 sc1
v_mfma_f32_16x16x32_bf16 v[140:143], v[92:95], a[48:51], v[140:143]
ds_read_b64_tr_b16 v[82:83], v10 offset:21504
ds_read_b64_tr_b16 v[84:85], v11 offset:5120
v_mfma_f32_16x16x32_bf16 v[156:159], v[92:95], a[52:55], v[156:159]
ds_read_b64_tr_b16 v[86:87], v11 offset:21504
v_mfma_f32_16x16x32_bf16 v[128:131], v[96:99], a[56:59], v[128:131]
ds_read_b64_tr_b16 v[88:89], v12 offset:5120
ds_read_b64_tr_b16 v[90:91], v12 offset:21504
v_mfma_f32_16x16x32_bf16 v[144:147], v[96:99], a[60:63], v[144:147]
ds_read_b64_tr_b16 v[92:93], v13 offset:5120
s_waitcnt lgkmcnt(7)
v_mfma_f32_16x16x32_bf16 v[132:135], v[100:103], a[56:59], v[132:135]
ds_read_b64_tr_b16 v[94:95], v13 offset:21504
ds_read_b64_tr_b16 v[96:97], v10 offset:6144
v_mfma_f32_16x16x32_bf16 v[148:151], v[100:103], a[60:63], v[148:151]
ds_read_b64_tr_b16 v[98:99], v10 offset:22528
v_mfma_f32_16x16x32_bf16 v[136:139], v[104:107], a[56:59], v[136:139]
ds_read_b64_tr_b16 v[100:101], v11 offset:6144
v_mfma_f32_16x16x32_bf16 v[152:155], v[104:107], a[60:63], v[152:155]
ds_read_b64_tr_b16 v[102:103], v11 offset:22528
v_mfma_f32_16x16x32_bf16 v[140:143], v[108:111], a[56:59], v[140:143]
ds_read_b64_tr_b16 v[104:105], v12 offset:6144
v_mfma_f32_16x16x32_bf16 v[156:159], v[108:111], a[60:63], v[156:159]
ds_read_b64_tr_b16 v[106:107], v12 offset:22528
v_mfma_f32_16x16x32_bf16 v[128:131], v[112:115], a[64:67], v[128:131]
ds_read_b64_tr_b16 v[108:109], v13 offset:6144
v_mfma_f32_16x16x32_bf16 v[144:147], v[112:115], a[68:71], v[144:147]
ds_read_b64_tr_b16 v[110:111], v13 offset:22528
v_mfma_f32_16x16x32_bf16 v[132:135], v[116:119], a[64:67], v[132:135]
ds_read_b64_tr_b16 v[112:113], v10 offset:7168
v_mfma_f32_16x16x32_bf16 v[148:151], v[116:119], a[68:71], v[148:151]
ds_read_b64_tr_b16 v[114:115], v10 offset:23552
v_mfma_f32_16x16x32_bf16 v[136:139], v[120:123], a[64:67], v[136:139]
ds_read_b64_tr_b16 v[116:117], v11 offset:7168
v_mfma_f32_16x16x32_bf16 v[152:155], v[120:123], a[68:71], v[152:155]
ds_read_b64_tr_b16 v[118:119], v11 offset:23552
v_mfma_f32_16x16x32_bf16 v[140:143], v[124:127], a[64:67], v[140:143]
ds_read_b64_tr_b16 v[120:121], v12 offset:7168
v_mfma_f32_16x16x32_bf16 v[156:159], v[124:127], a[68:71], v[156:159]
ds_read_b64_tr_b16 v[122:123], v12 offset:23552
s_waitcnt lgkmcnt(6)
v_mfma_f32_16x16x32_bf16 v[128:131], v[80:83], a[72:75], v[128:131]
ds_read_b64_tr_b16 v[124:125], v13 offset:7168
v_mfma_f32_16x16x32_bf16 v[144:147], v[80:83], a[76:79], v[144:147]
ds_read_b64_tr_b16 v[126:127], v13 offset:23552
v_mfma_f32_16x16x32_bf16 v[132:135], v[84:87], a[72:75], v[132:135]
v_mfma_f32_16x16x32_bf16 v[148:151], v[84:87], a[76:79], v[148:151]
v_mfma_f32_16x16x32_bf16 v[136:139], v[88:91], a[72:75], v[136:139]
v_mfma_f32_16x16x32_bf16 v[152:155], v[88:91], a[76:79], v[152:155]
v_mfma_f32_16x16x32_bf16 v[140:143], v[92:95], a[72:75], v[140:143]
s_waitcnt vmcnt(18) lgkmcnt(0)
s_barrier
v_mfma_f32_16x16x32_bf16 v[156:159], v[92:95], a[76:79], v[156:159]
ds_read_b64_tr_b16 v[80:81], v10 offset:32768
ds_read_b64_tr_b16 v[82:83], v10 offset:49152
v_mfma_f32_16x16x32_bf16 v[128:131], v[96:99], a[80:83], v[128:131]
ds_read_b64_tr_b16 v[84:85], v11 offset:32768
v_mfma_f32_16x16x32_bf16 v[144:147], v[96:99], a[84:87], v[144:147]
ds_read_b64_tr_b16 v[86:87], v11 offset:49152
ds_read_b64_tr_b16 v[88:89], v12 offset:32768
v_mfma_f32_16x16x32_bf16 v[132:135], v[100:103], a[80:83], v[132:135]
ds_read_b64_tr_b16 v[90:91], v12 offset:49152
v_mfma_f32_16x16x32_bf16 v[148:151], v[100:103], a[84:87], v[148:151]
ds_read_b64_tr_b16 v[92:93], v13 offset:32768
ds_read_b64_tr_b16 v[94:95], v13 offset:49152
v_mfma_f32_16x16x32_bf16 v[136:139], v[104:107], a[80:83], v[136:139]
ds_read_b64_tr_b16 v[96:97], v10 offset:33792
v_mfma_f32_16x16x32_bf16 v[152:155], v[104:107], a[84:87], v[152:155]
ds_read_b64_tr_b16 v[98:99], v10 offset:50176
ds_read_b64_tr_b16 v[100:101], v11 offset:33792
v_mfma_f32_16x16x32_bf16 v[140:143], v[108:111], a[80:83], v[140:143]
ds_read_b64_tr_b16 v[102:103], v11 offset:50176
v_mfma_f32_16x16x32_bf16 v[156:159], v[108:111], a[84:87], v[156:159]
ds_read_b64_tr_b16 v[104:105], v12 offset:33792
ds_read_b64_tr_b16 v[106:107], v12 offset:50176
v_mfma_f32_16x16x32_bf16 v[128:131], v[112:115], a[88:91], v[128:131]
ds_read_b64_tr_b16 v[108:109], v13 offset:33792
v_mfma_f32_16x16x32_bf16 v[144:147], v[112:115], a[92:95], v[144:147]
s_waitcnt vmcnt(0)
s_atomic_add s69, s[60:61], s20 offset:128
s_atomic_add s69, s[60:61], s21 offset:128
s_atomic_add s69, s[60:61], s22 offset:128
v_mfma_f32_16x16x32_bf16 v[132:135], v[116:119], a[88:91], v[132:135]
ds_read_b64_tr_b16 v[110:111], v13 offset:50176
ds_read_b64_tr_b16 v[112:113], v10 offset:34816
v_mfma_f32_16x16x32_bf16 v[148:151], v[116:119], a[92:95], v[148:151]
ds_read_b64_tr_b16 v[114:115], v10 offset:51200
v_mfma_f32_16x16x32_bf16 v[136:139], v[120:123], a[88:91], v[136:139]
ds_read_b64_tr_b16 v[116:117], v11 offset:34816
v_mfma_f32_16x16x32_bf16 v[152:155], v[120:123], a[92:95], v[152:155]
ds_read_b64_tr_b16 v[118:119], v11 offset:51200
v_mfma_f32_16x16x32_bf16 v[140:143], v[124:127], a[88:91], v[140:143]
ds_read_b64_tr_b16 v[120:121], v12 offset:34816
v_mfma_f32_16x16x32_bf16 v[156:159], v[124:127], a[92:95], v[156:159]
ds_read_b64_tr_b16 v[122:123], v12 offset:51200
s_waitcnt lgkmcnt(7)
v_mfma_f32_16x16x32_bf16 v[128:131], v[80:83], a[96:99], v[128:131]
ds_read_b64_tr_b16 v[124:125], v13 offset:34816
v_mfma_f32_16x16x32_bf16 v[144:147], v[80:83], a[100:103], v[144:147]
ds_read_b64_tr_b16 v[126:127], v13 offset:51200
v_mfma_f32_16x16x32_bf16 v[132:135], v[84:87], a[96:99], v[132:135]
ds_read_b64_tr_b16 v[80:81], v10 offset:35840
v_mfma_f32_16x16x32_bf16 v[148:151], v[84:87], a[100:103], v[148:151]
ds_read_b64_tr_b16 v[82:83], v10 offset:52224
v_mfma_f32_16x16x32_bf16 v[136:139], v[88:91], a[96:99], v[136:139]
ds_read_b64_tr_b16 v[84:85], v11 offset:35840
v_mfma_f32_16x16x32_bf16 v[152:155], v[88:91], a[100:103], v[152:155]
ds_read_b64_tr_b16 v[86:87], v11 offset:52224
v_mfma_f32_16x16x32_bf16 v[140:143], v[92:95], a[96:99], v[140:143]
ds_read_b64_tr_b16 v[88:89], v12 offset:35840
v_mfma_f32_16x16x32_bf16 v[156:159], v[92:95], a[100:103], v[156:159]
ds_read_b64_tr_b16 v[90:91], v12 offset:52224
v_mfma_f32_16x16x32_bf16 v[128:131], v[96:99], a[104:107], v[128:131]
ds_read_b64_tr_b16 v[92:93], v13 offset:35840
v_mfma_f32_16x16x32_bf16 v[144:147], v[96:99], a[108:111], v[144:147]
ds_read_b64_tr_b16 v[94:95], v13 offset:52224
v_mfma_f32_16x16x32_bf16 v[132:135], v[100:103], a[104:107], v[132:135]
ds_read_b64_tr_b16 v[96:97], v10 offset:36864
v_mfma_f32_16x16x32_bf16 v[148:151], v[100:103], a[108:111], v[148:151]
ds_read_b64_tr_b16 v[98:99], v10 offset:53248
v_mfma_f32_16x16x32_bf16 v[136:139], v[104:107], a[104:107], v[136:139]
ds_read_b64_tr_b16 v[100:101], v11 offset:36864
v_mfma_f32_16x16x32_bf16 v[152:155], v[104:107], a[108:111], v[152:155]
s_mov_b32 s87, 0
s_atomic_add s87, s[60:61], s23 offset:128 glc
s_waitcnt lgkmcnt(5)
v_mfma_f32_16x16x32_bf16 v[140:143], v[108:111], a[104:107], v[140:143]
ds_read_b64_tr_b16 v[102:103], v11 offset:53248
ds_read_b64_tr_b16 v[104:105], v12 offset:36864
v_mfma_f32_16x16x32_bf16 v[156:159], v[108:111], a[108:111], v[156:159]
ds_read_b64_tr_b16 v[106:107], v12 offset:53248
v_mfma_f32_16x16x32_bf16 v[128:131], v[112:115], a[112:115], v[128:131]
ds_read_b64_tr_b16 v[108:109], v13 offset:36864
v_mfma_f32_16x16x32_bf16 v[144:147], v[112:115], a[116:119], v[144:147]
ds_read_b64_tr_b16 v[110:111], v13 offset:53248
v_mfma_f32_16x16x32_bf16 v[132:135], v[116:119], a[112:115], v[132:135]
ds_read_b64_tr_b16 v[112:113], v10 offset:37888
v_mfma_f32_16x16x32_bf16 v[148:151], v[116:119], a[116:119], v[148:151]
ds_read_b64_tr_b16 v[114:115], v10 offset:54272
v_mfma_f32_16x16x32_bf16 v[136:139], v[120:123], a[112:115], v[136:139]
ds_read_b64_tr_b16 v[116:117], v11 offset:37888
v_mfma_f32_16x16x32_bf16 v[152:155], v[120:123], a[116:119], v[152:155]
ds_read_b64_tr_b16 v[118:119], v11 offset:54272
v_mfma_f32_16x16x32_bf16 v[140:143], v[124:127], a[112:115], v[140:143]
ds_read_b64_tr_b16 v[120:121], v12 offset:37888
v_mfma_f32_16x16x32_bf16 v[156:159], v[124:127], a[116:119], v[156:159]
ds_read_b64_tr_b16 v[122:123], v12 offset:54272
v_mfma_f32_16x16x32_bf16 v[128:131], v[80:83], a[120:123], v[128:131]
ds_read_b64_tr_b16 v[124:125], v13 offset:37888
v_mfma_f32_16x16x32_bf16 v[144:147], v[80:83], a[124:127], v[144:147]
ds_read_b64_tr_b16 v[126:127], v13 offset:54272
v_mfma_f32_16x16x32_bf16 v[132:135], v[84:87], a[120:123], v[132:135]
ds_read_b64_tr_b16 v[80:81], v10 offset:38912
v_mfma_f32_16x16x32_bf16 v[148:151], v[84:87], a[124:127], v[148:151]
ds_read_b64_tr_b16 v[82:83], v10 offset:55296
v_mfma_f32_16x16x32_bf16 v[136:139], v[88:91], a[120:123], v[136:139]
ds_read_b64_tr_b16 v[84:85], v11 offset:38912
v_mfma_f32_16x16x32_bf16 v[152:155], v[88:91], a[124:127], v[152:155]
ds_read_b64_tr_b16 v[86:87], v11 offset:55296
s_waitcnt lgkmcnt(6)
v_mfma_f32_16x16x32_bf16 v[140:143], v[92:95], a[120:123], v[140:143]
ds_read_b64_tr_b16 v[88:89], v12 offset:38912
v_mfma_f32_16x16x32_bf16 v[156:159], v[92:95], a[124:127], v[156:159]
ds_read_b64_tr_b16 v[90:91], v12 offset:55296
v_mfma_f32_16x16x32_bf16 v[128:131], v[96:99], a[128:131], v[128:131]
ds_read_b64_tr_b16 v[92:93], v13 offset:38912
v_mfma_f32_16x16x32_bf16 v[144:147], v[96:99], a[132:135], v[144:147]
ds_read_b64_tr_b16 v[94:95], v13 offset:55296
v_mfma_f32_16x16x32_bf16 v[132:135], v[100:103], a[128:131], v[132:135]
ds_read_b64_tr_b16 v[96:97], v10 offset:39936
v_mfma_f32_16x16x32_bf16 v[148:151], v[100:103], a[132:135], v[148:151]
ds_read_b64_tr_b16 v[98:99], v10 offset:56320
v_mfma_f32_16x16x32_bf16 v[136:139], v[104:107], a[128:131], v[136:139]
ds_read_b64_tr_b16 v[100:101], v11 offset:39936
v_mfma_f32_16x16x32_bf16 v[152:155], v[104:107], a[132:135], v[152:155]
ds_read_b64_tr_b16 v[102:103], v11 offset:56320
v_mfma_f32_16x16x32_bf16 v[140:143], v[108:111], a[128:131], v[140:143]
ds_read_b64_tr_b16 v[104:105], v12 offset:39936
v_mfma_f32_16x16x32_bf16 v[156:159], v[108:111], a[132:135], v[156:159]
ds_read_b64_tr_b16 v[106:107], v12 offset:56320
v_mfma_f32_16x16x32_bf16 v[128:131], v[112:115], a[136:139], v[128:131]
ds_read_b64_tr_b16 v[108:109], v13 offset:39936
v_mfma_f32_16x16x32_bf16 v[144:147], v[112:115], a[140:143], v[144:147]
ds_read_b64_tr_b16 v[110:111], v13 offset:56320
v_mfma_f32_16x16x32_bf16 v[132:135], v[116:119], a[136:139], v[132:135]
v_mfma_f32_16x16x32_bf16 v[148:151], v[116:119], a[140:143], v[148:151]
v_mfma_f32_16x16x32_bf16 v[136:139], v[120:123], a[136:139], v[136:139]
v_mfma_f32_16x16x32_bf16 v[152:155], v[120:123], a[140:143], v[152:155]
s_waitcnt lgkmcnt(2)
v_mfma_f32_16x16x32_bf16 v[140:143], v[124:127], a[136:139], v[140:143]
s_waitcnt lgkmcnt(0)
s_barrier
v_mfma_f32_16x16x32_bf16 v[156:159], v[124:127], a[140:143], v[156:159]
s_cmp_lt_u32 s87, 3
s_cbranch_scc1 pl_7_slow
pl_7_ok:
v_mfma_f32_16x16x32_bf16 v[128:131], v[80:83], a[144:147], v[128:131]
ds_read_b64_tr_b16 v[112:113], v14 offset:0
ds_read_b64_tr_b16 v[114:115], v14 offset:16384
v_mfma_f32_16x16x32_bf16 v[144:147], v[80:83], a[148:151], v[144:147]
buffer_load_dwordx4 a[224:227], v46, s[60:63], s11 offen offset:0 sc1
v_mfma_f32_16x16x32_bf16 v[132:135], v[84:87], a[144:147], v[132:135]
ds_read_b64_tr_b16 v[116:117], v15 offset:0
ds_read_b64_tr_b16 v[118:119], v15 offset:16384
v_mfma_f32_16x16x32_bf16 v[148:151], v[84:87], a[148:151], v[148:151]
buffer_load_dwordx4 a[228:231], v46, s[60:63], s11 offen offset:1024 sc1
v_mfma_f32_16x16x32_bf16 v[136:139], v[88:91], a[144:147], v[136:139]
ds_read_b64_tr_b16 v[120:121], v16 offset:0
ds_read_b64_tr_b16 v[122:123], v16 offset:16384
v_mfma_f32_16x16x32_bf16 v[152:155], v[88:91], a[148:151], v[152:155]
buffer_load_dwordx4 a[232:235], v46, s[60:63], s11 offen offset:2048 sc1
v_mfma_f32_16x16x32_bf16 v[140:143], v[92:95], a[144:147], v[140:143]
ds_read_b64_tr_b16 v[124:125], v17 offset:0
ds_read_b64_tr_b16 v[126:127], v17 offset:16384
v_mfma_f32_16x16x32_bf16 v[156:159], v[92:95], a[148:151], v[156:159]
buffer_load_dwordx4 a[236:239], v46, s[60:63], s11 offen offset:3072 sc1
v_mfma_f32_16x16x32_bf16 v[128:131], v[96:99], a[152:155], v[128:131]
ds_read_b64_tr_b16 v[80:81], v14 offset:1024
ds_read_b64_tr_b16 v[82:83], v14 offset:17408
v_mfma_f32_16x16x32_bf16 v[144:147], v[96:99], a[156:159], v[144:147]
buffer_load_dwordx4 a[240:243], v46, s[60:63], s14 offen offset:0 sc1
v_mfma_f32_16x16x32_bf16 v[132:135], v[100:103], a[152:155], v[132:135]
ds_read_b64_tr_b16 v[84:85], v15 offset:1024
ds_read_b64_tr_b16 v[86:87], v15 offset:17408
v_mfma_f32_16x16x32_bf16 v[148:151], v[100:103], a[156:159], v[148:151]
buffer_load_dwordx4 a[244:247], v46, s[60:63], s14 offen offset:1024 sc1
v_mfma_f32_16x16x32_bf16 v[136:139], v[104:107], a[152:155], v[136:139]
ds_read_b64_tr_b16 v[88:89], v16 offset:1024
ds_read_b64_tr_b16 v[90:91], v16 offset:17408
v_mfma_f32_16x16x32_bf16 v[152:155], v[104:107], a[156:159], v[152:155]
buffer_load_dwordx4 a[248:251], v46, s[60:63], s14 offen offset:2048 sc1
v_mfma_f32_16x16x32_bf16 v[140:143], v[108:111], a[152:155], v[140:143]
ds_read_b64_tr_b16 v[92:93], v17 offset:1024
ds_read_b64_tr_b16 v[94:95], v17 offset:17408
v_mfma_f32_16x16x32_bf16 v[156:159], v[108:111], a[156:159], v[156:159]
ds_read_b64_tr_b16 v[96:97], v14 offset:2048
s_waitcnt lgkmcnt(7)
v_mfma_f32_16x16x32_bf16 v[128:131], v[112:115], a[160:163], v[128:131]
buffer_load_dwordx4 a[252:255], v46, s[60:63], s14 offen offset:3072 sc1
v_mfma_f32_16x16x32_bf16 v[144:147], v[112:115], a[164:167], v[144:147]
ds_read_b64_tr_b16 v[98:99], v14 offset:18432
ds_read_b64_tr_b16 v[100:101], v15 offset:2048
v_mfma_f32_16x16x32_bf16 v[132:135], v[116:119], a[160:163], v[132:135]
buffer_load_dwordx4 v[160:163], v46, s[60:63], s15 offen offset:0 sc1
v_mfma_f32_16x16x32_bf16 v[148:151], v[116:119], a[164:167], v[148:151]
ds_read_b64_tr_b16 v[102:103], v15 offset:18432
ds_read_b64_tr_b16 v[104:105], v16 offset:2048
v_mfma_f32_16x16x32_bf16 v[136:139], v[120:123], a[160:163], v[136:139]
buffer_load_dwordx4 v[164:167], v46, s[60:63], s15 offen offset:1024 sc1
v_mfma_f32_16x16x32_bf16 v[152:155], v[120:123], a[164:167], v[152:155]
ds_read_b64_tr_b16 v[106:107], v16 offset:18432
ds_read_b64_tr_b16 v[108:109], v17 offset:2048
v_mfma_f32_16x16x32_bf16 v[140:143], v[124:127], a[160:163], v[140:143]
buffer_load_dwordx4 v[168:171], v46, s[60:63], s15 offen offset:2048 sc1
v_mfma_f32_16x16x32_bf16 v[156:159], v[124:127], a[164:167], v[156:159]
ds_read_b64_tr_b16 v[110:111], v17 offset:18432
ds_read_b64_tr_b16 v[112:113], v14 offset:3072
v_mfma_f32_16x16x32_bf16 v[128:131], v[80:83], a[168:171], v[128:131]
buffer_load_dwordx4 v[172:175], v46, s[60:63], s15 offen offset:3072 sc1
v_mfma_f32_16x16x32_bf16 v[144:147], v[80:83], a[172:175], v[144:147]
ds_read_b64_tr_b16 v[114:115], v14 offset:19456
s_waitcnt lgkmcnt(5)
v_mfma_f32_16x16x32_bf16 v[132:135], v[84:87], a[168:171], v[132:135]
ds_read_b64_tr_b16 v[116:117], v15 offset:3072
ds_read_b64_tr_b16 v[118:119], v15 offset:19456
v_mfma_f32_16x16x32_bf16 v[148:151], v[84:87], a[172:175], v[148:151]
ds_read_b64_tr_b16 v[120:121], v16 offset:3072
v_mfma_f32_16x16x32_bf16 v[136:139], v[88:91], a[168:171], v[136:139]
ds_read_b64_tr_b16 v[122:123], v16 offset:19456
ds_read_b64_tr_b16 v[124:125], v17 offset:3072
v_mfma_f32_16x16x32_bf16 v[152:155], v[88:91], a[172:175], v[152:155]
ds_read_b64_tr_b16 v[126:127], v17 offset:19456
v_mfma_f32_16x16x32_bf16 v[140:143], v[92:95], a[168:171], v[140:143]
ds_read_b64_tr_b16 v[80:81], v14 offset:4096
ds_read_b64_tr_b16 v[82:83], v14 offset:20480
v_mfma_f32_16x16x32_bf16 v[156:159], v[92:95], a[172:175], v[156:159]
ds_read_b64_tr_b16 v[84:85], v15 offset:4096
v_mfma_f32_16x16x32_bf16 v[128:131], v[96:99], a[176:179], v[128:131]
ds_read_b64_tr_b16 v[86:87], v15 offset:20480
ds_read_b64_tr_b16 v[88:89], v16 offset:4096
v_mfma_f32_16x16x32_bf16 v[144:147], v[96:99], a[180:183], v[144:147]
ds_read_b64_tr_b16 v[90:91], v16 offset:20480
v_mfma_f32_16x16x32_bf16 v[132:135], v[100:103], a[176:179], v[132:135]
ds_read_b64_tr_b16 v[92:93], v17 offset:4096
ds_read_b64_tr_b16 v[94:95], v17 offset:20480
v_mfma_f32_16x16x32_bf16 v[148:151], v[100:103], a[180:183], v[148:151]
ds_read_b64_tr_b16 v[96:97], v14 offset:5120
s_waitcnt lgkmcnt(9)
v_mfma_f32_16x16x32_bf16 v[136:139], v[104:107], a[176:179], v[136:139]
ds_read_b64_tr_b16 v[98:99], v14 offset:21504
ds_read_b64_tr_b16 v[100:101], v15 offset:5120
v_mfma_f32_16x16x32_bf16 v[152:155], v[104:107], a[180:183], v[152:155]
ds_read_b64_tr_b16 v[102:103], v15 offset:21504
v_mfma_f32_16x16x32_bf16 v[140:143], v[108:111], a[176:179], v[140:143]
ds_read_b64_tr_b16 v[104:105], v16 offset:5120
v_mfma_f32_16x16x32_bf16 v[156:159], v[108:111], a[180:183], v[156:159]
ds_read_b64_tr_b16 v[106:107], v16 offset:21504
v_mfma_f32_16x16x32_bf16 v[128:131], v[112:115], a[184:187], v[128:131]
ds_read_b64_tr_b16 v[108:109], v17 offset:5120
v_mfma_f32_16x16x32_bf16 v[144:147], v[112:115], a[188:191], v[144:147]
ds_read_b64_tr_b16 v[110:111], v17 offset:21504
v_mfma_f32_16x16x32_bf16 v[132:135], v[116:119], a[184:187], v[132:135]
ds_read_b64_tr_b16 v[112:113], v14 offset:6144
v_mfma_f32_16x16x32_bf16 v[148:151], v[116:119], a[188:191], v[148:151]
ds_read_b64_tr_b16 v[114:115], v14 offset:22528
v_mfma_f32_16x16x32_bf16 v[136:139], v[120:123], a[184:187], v[136:139]
ds_read_b64_tr_b16 v[116:117], v15 offset:6144
v_mfma_f32_16x16x32_bf16 v[152:155], v[120:123], a[188:191], v[152:155]
ds_read_b64_tr_b16 v[118:119], v15 offset:22528
v_mfma_f32_16x16x32_bf16 v[140:143], v[124:127], a[184:187], v[140:143]
ds_read_b64_tr_b16 v[120:121], v16 offset:6144
v_mfma_f32_16x16x32_bf16 v[156:159], v[124:127], a[188:191], v[156:159]
ds_read_b64_tr_b16 v[122:123], v16 offset:22528
s_waitcnt lgkmcnt(6)
v_mfma_f32_16x16x32_bf16 v[128:131], v[80:83], a[192:195], v[128:131]
ds_read_b64_tr_b16 v[124:125], v17 offset:6144
v_mfma_f32_16x16x32_bf16 v[144:147], v[80:83], a[196:199], v[144:147]
ds_read_b64_tr_b16 v[126:127], v17 offset:22528
v_mfma_f32_16x16x32_bf16 v[132:135], v[84:87], a[192:195], v[132:135]
ds_read_b64_tr_b16 v[80:81], v14 offset:7168
v_mfma_f32_16x16x32_bf16 v[148:151], v[84:87], a[196:199], v[148:151]
ds_read_b64_tr_b16 v[82:83], v14 offset:23552
v_mfma_f32_16x16x32_bf16 v[136:139], v[88:91], a[192:195], v[136:139]
ds_read_b64_tr_b16 v[84:85], v15 offset:7168
v_mfma_f32_16x16x32_bf16 v[152:155], v[88:91], a[196:199], v[152:155]
ds_read_b64_tr_b16 v[86:87], v15 offset:23552
v_mfma_f32_16x16x32_bf16 v[140:143], v[92:95], a[192:195], v[140:143]
ds_read_b64_tr_b16 v[88:89], v16 offset:7168
v_mfma_f32_16x16x32_bf16 v[156:159], v[92:95], a[196:199], v[156:159]
ds_read_b64_tr_b16 v[90:91], v16 offset:23552
v_mfma_f32_16x16x32_bf16 v[128:131], v[96:99], a[200:203], v[128:131]
ds_read_b64_tr_b16 v[92:93], v17 offset:7168
v_mfma_f32_16x16x32_bf16 v[144:147], v[96:99], a[204:207], v[144:147]
ds_read_b64_tr_b16 v[94:95], v17 offset:23552
v_mfma_f32_16x16x32_bf16 v[132:135], v[100:103], a[200:203], v[132:135]
v_mfma_f32_16x16x32_bf16 v[148:151], v[100:103], a[204:207], v[148:151]
v_mfma_f32_16x16x32_bf16 v[136:139], v[104:107], a[200:203], v[136:139]
v_mfma_f32_16x16x32_bf16 v[152:155], v[104:107], a[204:207], v[152:155]
v_mfma_f32_16x16x32_bf16 v[140:143], v[108:111], a[200:203], v[140:143]
v_mfma_f32_16x16x32_bf16 v[156:159], v[108:111], a[204:207], v[156:159]
s_waitcnt lgkmcnt(0)
v_mfma_f32_16x16x32_bf16 v[128:131], v[112:115], a[208:211], v[128:131]
v_mfma_f32_16x16x32_bf16 v[144:147], v[112:115], a[212:215], v[144:147]
v_mfma_f32_16x16x32_bf16 v[132:135], v[116:119], a[208:211], v[132:135]
v_mfma_f32_16x16x32_bf16 v[148:151], v[116:119], a[212:215], v[148:151]
v_mfma_f32_16x16x32_bf16 v[136:139], v[120:123], a[208:211], v[136:139]
v_mfma_f32_16x16x32_bf16 v[152:155], v[120:123], a[212:215], v[152:155]
v_mfma_f32_16x16x32_bf16 v[140:143], v[124:127], a[208:211], v[140:143]
v_mfma_f32_16x16x32_bf16 v[156:159], v[124:127], a[212:215], v[156:159]
v_mfma_f32_16x16x32_bf16 v[128:131], v[80:83], a[216:219], v[128:131]
v_mfma_f32_16x16x32_bf16 v[144:147], v[80:83], a[220:223], v[144:147]
v_mfma_f32_16x16x32_bf16 v[132:135], v[84:87], a[216:219], v[132:135]
v_mfma_f32_16x16x32_bf16 v[148:151], v[84:87], a[220:223], v[148:151]
v_mfma_f32_16x16x32_bf16 v[136:139], v[88:91], a[216:219], v[136:139]
v_mfma_f32_16x16x32_bf16 v[152:155], v[88:91], a[220:223], v[152:155]
v_mfma_f32_16x16x32_bf16 v[140:143], v[92:95], a[216:219], v[140:143]
v_mfma_f32_16x16x32_bf16 v[156:159], v[92:95], a[220:223], v[156:159]
s_waitcnt vmcnt(0)
v_mfma_f32_16x16x16_bf16 v[128:131], v[76:77], a[224:225], v[128:131]
v_mfma_f32_16x16x16_bf16 v[132:135], v[76:77], a[226:227], v[132:135]
v_mfma_f32_16x16x16_bf16 v[136:139], v[76:77], a[228:229], v[136:139]
s_nop 0
v_mfma_f32_16x16x16_bf16 v[140:143], v[76:77], a[230:231], v[140:143]
v_mfma_f32_16x16x16_bf16 v[144:147], v[76:77], a[232:233], v[144:147]
v_mfma_f32_16x16x16_bf16 v[148:151], v[76:77], a[234:235], v[148:151]
v_mfma_f32_16x16x16_bf16 v[152:155], v[76:77], a[236:237], v[152:155]
v_mfma_f32_16x16x16_bf16 v[156:159], v[76:77], a[238:239], v[156:159]
v_mfma_f32_16x16x16_bf16 v[128:131], v[76:77], a[240:241], v[128:131]
v_mfma_f32_16x16x16_bf16 v[132:135], v[76:77], a[242:243], v[132:135]
v_mfma_f32_16x16x16_bf16 v[136:139], v[76:77], a[244:245], v[136:139]
v_mfma_f32_16x16x16_bf16 v[140:143], v[76:77], a[246:247], v[140:143]
v_mfma_f32_16x16x16_bf16 v[144:147], v[76:77], a[248:249], v[144:147]
v_mfma_f32_16x16x16_bf16 v[148:151], v[76:77], a[250:251], v[148:151]
v_mfma_f32_16x16x16_bf16 v[152:155], v[76:77], a[252:253], v[152:155]
v_mfma_f32_16x16x16_bf16 v[156:159], v[76:77], a[254:255], v[156:159]
v_mfma_f32_16x16x16_bf16 v[128:131], v[76:77], v[160:161], v[128:131]
v_mfma_f32_16x16x16_bf16 v[132:135], v[76:77], v[162:163], v[132:135]
v_mfma_f32_16x16x16_bf16 v[136:139], v[76:77], v[164:165], v[136:139]
v_mfma_f32_16x16x16_bf16 v[140:143], v[76:77], v[166:167], v[140:143]
v_mfma_f32_16x16x16_bf16 v[144:147], v[76:77], v[168:169], v[144:147]
v_mfma_f32_16x16x16_bf16 v[148:151], v[76:77], v[170:171], v[148:151]
v_mfma_f32_16x16x16_bf16 v[152:155], v[76:77], v[172:173], v[152:155]
v_mfma_f32_16x16x16_bf16 v[156:159], v[76:77], v[174:175], v[156:159]
s_nop 0
v_pk_fma_f32 v[128:129], v[128:129], v[60:61], v[192:193]
v_pk_fma_f32 v[130:131], v[130:131], v[62:63], v[194:195]
v_pk_fma_f32 v[132:133], v[132:133], v[64:65], v[196:197]
v_pk_fma_f32 v[134:135], v[134:135], v[66:67], v[198:199]
v_cvt_pk_bf16_f32 v128, v128, v129
v_cvt_pk_bf16_f32 v129, v130, v131
v_cvt_pk_bf16_f32 v130, v132, v133
v_cvt_pk_bf16_f32 v131, v134, v135
s_nop 0
v_permlane16_swap_b32 v128, v130
v_permlane16_swap_b32 v129, v131
buffer_store_dwordx4 v[128:131], v2, s[64:67], s12 offen offset:0
v_pk_fma_f32 v[136:137], v[136:137], v[68:69], v[200:201]
v_pk_fma_f32 v[138:139], v[138:139], v[70:71], v[202:203]
v_pk_fma_f32 v[140:141], v[140:141], v[72:73], v[204:205]
v_pk_fma_f32 v[142:143], v[142:143], v[74:75], v[206:207]
v_cvt_pk_bf16_f32 v136, v136, v137
v_cvt_pk_bf16_f32 v137, v138, v139
v_cvt_pk_bf16_f32 v138, v140, v141
v_cvt_pk_bf16_f32 v139, v142, v143
s_nop 0
v_permlane16_swap_b32 v136, v138
v_permlane16_swap_b32 v137, v139
buffer_store_dwordx4 v[136:139], v2, s[64:67], s12 offen offset:64
v_pk_fma_f32 v[144:145], v[144:145], v[60:61], v[208:209]
v_pk_fma_f32 v[146:147], v[146:147], v[62:63], v[210:211]
v_pk_fma_f32 v[148:149], v[148:149], v[64:65], v[212:213]
v_pk_fma_f32 v[150:151], v[150:151], v[66:67], v[214:215]
v_cvt_pk_bf16_f32 v144, v144, v145
v_cvt_pk_bf16_f32 v145, v146, v147
v_cvt_pk_bf16_f32 v146, v148, v149
v_cvt_pk_bf16_f32 v147, v150, v151
s_nop 0
v_permlane16_swap_b32 v144, v146
v_permlane16_swap_b32 v145, v147
buffer_store_dwordx4 v[144:147], v2, s[64:67], s13 offen offset:0
v_pk_fma_f32 v[152:153], v[152:153], v[68:69], v[216:217]
v_pk_fma_f32 v[154:155], v[154:155], v[70:71], v[218:219]
v_pk_fma_f32 v[156:157], v[156:157], v[72:73], v[220:221]
v_pk_fma_f32 v[158:159], v[158:159], v[74:75], v[222:223]
v_cvt_pk_bf16_f32 v152, v152, v153
v_cvt_pk_bf16_f32 v153, v154, v155
v_cvt_pk_bf16_f32 v154, v156, v157
v_cvt_pk_bf16_f32 v155, v158, v159
s_nop 0
v_permlane16_swap_b32 v152, v154
v_permlane16_swap_b32 v153, v155
buffer_store_dwordx4 v[152:155], v2, s[64:67], s13 offen offset:64
K_fin:
K_end:
s_endpgm
pl_1_slow:
s_mov_b32 s81, 0
pl_1_loop:
s_mov_b32 s87, 0
s_atomic_add s87, s[60:61], s98 glc
s_add_u32 s81, s81, 1
s_waitcnt lgkmcnt(0)
s_cmp_ge_u32 s87, s99
s_cbranch_scc1 pl_1_ok
s_cmp_lt_u32 s81, 0x400000
s_cbranch_scc1 pl_1_loop
s_branch pl_1_ok
pl_2_slow:
s_mov_b32 s81, 0
pl_2_loop:
s_mov_b32 s87, 0
s_atomic_add s87, s[60:61], s98 glc
s_add_u32 s81, s81, 1
s_waitcnt lgkmcnt(0)
s_cmp_ge_u32 s87, s99
s_cbranch_scc1 pl_2_ok
s_cmp_lt_u32 s81, 0x400000
s_cbranch_scc1 pl_2_loop
s_branch pl_2_ok
pl_3_slow:
s_mov_b32 s81, 0
pl_3_loop:
s_mov_b32 s87, 0
s_atomic_add s87, s[60:61], s90 glc
s_add_u32 s81, s81, 1
s_waitcnt lgkmcnt(0)
s_cmp_ge_u32 s87, 16
s_cbranch_scc1 pl_3_ok
s_cmp_lt_u32 s81, 0x400000
s_cbranch_scc1 pl_3_loop
s_branch pl_3_ok
pl_4_slow:
s_mov_b32 s81, 0
pl_4_loop:
s_mov_b32 s87, 0
s_atomic_add s87, s[60:61], s90 offset:4096 glc
s_add_u32 s81, s81, 1
s_waitcnt lgkmcnt(0)
s_cmp_ge_u32 s87, 16
s_cbranch_scc1 pl_4_ok
s_cmp_lt_u32 s81, 0x400000
s_cbranch_scc1 pl_4_loop
s_branch pl_4_ok
pl_5_slow:
s_mov_b32 s81, 0
pl_5_loop:
s_mov_b32 s87, 0
s_atomic_add s87, s[60:61], s24 offset:768 glc
s_add_u32 s81, s81, 1
s_waitcnt lgkmcnt(0)
s_cmp_ge_u32 s87, 4
s_cbranch_scc1 pl_5_ok
s_cmp_lt_u32 s81, 0x400000
s_cbranch_scc1 pl_5_loop
s_branch pl_5_ok
pl_6_slow:
s_mov_b32 s81, 0
pl_6_loop:
s_mov_b32 s87, 0
s_atomic_add s87, s[60:61], s24 offset:896 glc
s_add_u32 s81, s81, 1
s_waitcnt lgkmcnt(0)
s_cmp_ge_u32 s87, 4
s_cbranch_scc1 pl_6_ok
s_cmp_lt_u32 s81, 0x400000
s_cbranch_scc1 pl_6_loop
s_branch pl_6_ok
pl_7_slow:
s_mov_b32 s81, 0
pl_7_loop:
s_mov_b32 s87, 0
s_atomic_add s87, s[60:61], s23 offset:128 glc
s_add_u32 s81, s81, 1
s_waitcnt lgkmcnt(0)
s_cmp_ge_u32 s87, 3
s_cbranch_scc1 pl_7_ok
s_cmp_lt_u32 s81, 0x400000
s_cbranch_scc1 pl_7_loop
s_branch pl_7_ok
K_last:
.fill 4096, 4, 0xbf800000
.section .rodata,"a"
.p2align 6
.amdhsa_kernel adaLN_cond__sliding_local_dilated__glu_gated_swiglu__prompt_kernel
  .amdhsa_next_free_vgpr 512
  .amdhsa_next_free_sgpr 102
  .amdhsa_accum_offset 256
  .amdhsa_group_segment_fixed_size 0
  .amdhsa_kernarg_size 96
  .amdhsa_user_sgpr_count 2
  .amdhsa_user_sgpr_kernarg_segment_ptr 1
  .amdhsa_system_sgpr_workgroup_id_x 1
  .amdhsa_float_denorm_mode_32 3
.end_amdhsa_kernel
```

```asm
; @launch grid=(256,1,1) block=(256,1,1) lds=163840
.amdgcn_target "amdgcn-amd-amdhsa--gfx950"
.text
.globl adaLN_cond__sliding_local_dilated__glu_gated_swiglu__prompt_kernel
.p2align 8
.type adaLN_cond__sliding_local_dilated__glu_gated_swiglu__prompt_kernel,@function
adaLN_cond__sliding_local_dilated__glu_gated_swiglu__prompt_kernel:
s_cmp_ge_u32 s2, 256
s_cbranch_scc1 K_end
s_load_dwordx16 s[12:27], s[0:1], 32
s_load_dwordx4 s[4:7], s[0:1], 0
s_load_dwordx2 s[8:9], s[0:1], 16
v_lshrrev_b32 v2, 6, v0
v_and_b32 v1, 63, v0
v_readfirstlane_b32 s72, v2
s_and_b32 s3, s2, 7
s_lshr_b32 s78, s2, 3
s_and_b32 s74, s3, 1
s_lshl_b32 s74, s74, 3
s_and_b32 s79, s78, 7
s_add_u32 s74, s74, s79
s_lshr_b32 s73, s3, 1
s_lshl_b32 s73, s73, 2
s_lshr_b32 s79, s78, 3
s_add_u32 s73, s73, s79
s_mov_b32 s96, 0x7ffffff0
v_lshlrev_b32 v46, 4, v1
v_mov_b32 v52, 1
s_lshl_b32 s76, s72, 13
s_mov_b32 s69, 1
v_mov_b32 v3, 0
s_lshl_b32 s79, s73, 2
s_add_u32 s79, s79, s72
s_lshl_b32 s88, s79, 16
s_mul_i32 s89, s79, 229376
s_lshl_b32 s101, s2, 2
s_add_u32 s101, s101, s72
v_lshlrev_b32 v4, 7, v1
v_lshlrev_b32 v7, 8, v1
s_lshr_b32 s78, s74, 3
s_lshl_b32 s78, s78, 7
v_and_b32 v7, 0x1fff, v7
v_add_u32 v7, s78, v7
s_and_b32 s78, s74, 7
s_lshl_b32 s78, s78, 15
s_lshl_b32 s91, s73, 18
s_add_u32 s78, s78, s91
s_add_u32 s80, s78, s76
s_lshr_b32 s78, s2, 3
s_lshl_b32 s78, s78, 2
s_add_u32 s78, s78, s72
s_lshl_b32 s78, s78, 10
v_lshl_add_u32 v5, v1, 4, s78
v_min_u32 v5, K_last - K_pc, v5
s_lshr_b32 s78, s2, 6
s_lshl_b32 s78, s78, 9
v_lshl_add_u32 v6, v1, 3, s78
s_waitcnt lgkmcnt(0)
s_getpc_b64 s[0:1]
K_pc:
s_mov_b32 s60, s26
s_mov_b32 s61, s27
s_mov_b32 s62, 0x4800000
s_mov_b32 s63, 0x20000
s_mov_b32 s28, s4
s_mov_b32 s29, s5
s_mov_b32 s30, 0x400000
s_mov_b32 s31, 0x20000
s_cmp_lg_u32 s101, 1
s_cbranch_scc1 K_nz
s_movk_i32 s78, 8192
buffer_store_dword v3, v4, s[60:63], 0 offen sc1
buffer_store_dword v3, v4, s[60:63], s78 offen sc1
s_waitcnt vmcnt(0)
s_atomic_add s69, s[24:25], 0
K_nz:
global_load_dwordx2 v[132:133], v6, s[18:19]
global_load_dword v57, v5, s[0:1]
s_mov_b32 s56, s20
s_mov_b32 s57, s21
s_mov_b32 s58, 0xc00000
s_mov_b32 s59, 0x20000
s_cmp_lg_u32 s72, 0
s_cbranch_scc1 K_g1d
s_bfe_u32 s78, s2, 0x10003
s_and_b32 s79, s2, 7
s_lshl_b32 s79, s79, 1
s_or_b32 s78, s78, s79
s_and_b32 s79, s2, 0x30
s_or_b32 s87, s78, s79
s_lshr_b32 s81, s2, 6
v_lshrrev_b32 v136, 2, v1
s_movk_i32 s79, 12288
v_mul_u32_u24 v136, s79, v136
v_bfe_u32 v137, v1, 4, 1
v_lshlrev_b32 v137, 1, v137
v_and_b32 v138, 3, v1
v_xor_b32 v137, v137, v138
v_lshl_add_u32 v128, v137, 4, v136
v_add_u32 v129, 195584, v128
v_add_u32 v130, 391168, v128
v_add_u32 v131, 586752, v128
s_mul_i32 s78, s81, 3145728
s_lshl_b32 s79, s87, 6
s_add_u32 s78, s78, s79
s_mov_b32 m0, 147456
s_nop 0
buffer_load_dwordx4 v128, s[56:59], s78 offen offset:0 lds
buffer_load_dwordx4 v129, s[56:59], s78 offen offset:1024 lds
buffer_load_dwordx4 v130, s[56:59], s78 offen offset:2048 lds
buffer_load_dwordx4 v131, s[56:59], s78 offen offset:3072 lds
s_mov_b32 m0, 151552
s_add_u32 s78, s78, 786432
buffer_load_dwordx4 v128, s[56:59], s78 offen offset:0 lds
buffer_load_dwordx4 v129, s[56:59], s78 offen offset:1024 lds
buffer_load_dwordx4 v130, s[56:59], s78 offen offset:2048 lds
buffer_load_dwordx4 v131, s[56:59], s78 offen offset:3072 lds
s_mov_b32 m0, 155648
s_add_u32 s78, s78, 786432
buffer_load_dwordx4 v128, s[56:59], s78 offen offset:0 lds
buffer_load_dwordx4 v129, s[56:59], s78 offen offset:1024 lds
buffer_load_dwordx4 v130, s[56:59], s78 offen offset:2048 lds
buffer_load_dwordx4 v131, s[56:59], s78 offen offset:3072 lds
s_mov_b32 m0, 159744
s_add_u32 s78, s78, 786432
buffer_load_dwordx4 v128, s[56:59], s78 offen offset:0 lds
buffer_load_dwordx4 v129, s[56:59], s78 offen offset:1024 lds
buffer_load_dwordx4 v130, s[56:59], s78 offen offset:2048 lds
buffer_load_dwordx4 v131, s[56:59], s78 offen offset:3072 lds
K_g1d:
s_nop 4
buffer_load_dword v57, v7, s[28:31], s80 offen
v_lshrrev_b32 v2, 3, v1
v_lshlrev_b32 v2, 11, v2
v_add_u32 v2, s91, v2
v_and_b32 v3, 7, v1
v_lshrrev_b32 v4, 4, v1
v_xor_b32 v3, v3, v4
v_lshl_add_u32 v192, v3, 4, v2
v_xor_b32 v193, 64, v192
v_add_u32 v194, 30720, v192
v_add_u32 v195, 46080, v193
v_add_u32 v193, 15360, v193
s_mov_b32 s32, s6
s_mov_b32 s33, s7
s_mov_b32 s34, 0x600000
s_mov_b32 s35, 0x20000
s_mov_b32 s36, s8
s_mov_b32 s37, s9
s_mov_b32 s38, 0x200000
s_mov_b32 s39, 0x20000
s_mov_b32 s40, s12
s_mov_b32 s41, s13
s_mov_b32 s42, 0x700000
s_mov_b32 s43, 0x20000
s_mov_b32 s44, s14
s_mov_b32 s45, s15
s_mov_b32 s46, 0x700000
s_mov_b32 s47, 0x20000
s_mov_b32 s48, s16
s_mov_b32 s49, s17
s_mov_b32 s50, 0x700000
s_mov_b32 s51, 0x20000
s_mov_b32 s64, s22
s_mov_b32 s65, s23
s_mov_b32 s66, 0x400000
s_mov_b32 s67, 0x20000
s_cmp_ge_u32 s72, 2
s_cselect_b32 s52, s14, s12
s_cselect_b32 s53, s15, s13
s_mov_b32 s54, 0x700000
s_mov_b32 s55, 0x20000
v_bfe_u32 v2, v1, 2, 3
v_and_b32 v3, 6, v2
v_bfe_u32 v4, v1, 1, 1
v_xor_b32 v3, v3, v4
v_lshlrev_b32 v3, 4, v3
v_lshl_add_u32 v3, v2, 7, v3
v_and_b32 v4, 1, v1
v_lshl_add_u32 v3, v4, 3, v3
v_lshrrev_b32 v4, 5, v1
v_lshl_add_u32 v10, v4, 13, v3
v_xor_b32 v11, 32, v10
v_xor_b32 v12, 64, v10
v_xor_b32 v13, 96, v10
v_add_u32 v14, 0x10000, v10
v_add_u32 v15, 0x10000, v11
v_add_u32 v16, 0x10000, v12
v_add_u32 v17, 0x10000, v13
v_lshrrev_b32 v2, 2, v1
v_lshlrev_b32 v2, 6, v2
v_bfe_u32 v3, v1, 1, 1
v_bfe_u32 v4, v1, 4, 1
v_lshl_or_b32 v3, v4, 1, v3
v_lshl_add_u32 v2, v3, 4, v2
v_and_b32 v3, 1, v1
v_lshl_add_u32 v18, v3, 3, v2
v_xor_b32 v19, 32, v18
v_add_u32 v20, 0x10000, v18
v_add_u32 v21, 0x10000, v19
v_lshrrev_b32 v2, 3, v1
v_and_b32 v3, 6, v2
v_and_b32 v4, 7, v1
v_xor_b32 v3, v3, v4
v_lshlrev_b32 v3, 4, v3
s_lshl_b32 s78, s72, 3
v_add_u32 v4, s78, v2
s_movk_i32 s79, 2048
v_mad_u32_u24 v26, v4, s79, v3
v_add_u32 v27, 64512, v26
v_add_u32 v28, 129024, v26
v_add_u32 v29, 193536, v26
s_movk_i32 s79, 12288
v_mad_u32_u24 v38, v4, s79, v3
v_add_u32 v39, 392192, v38
v_add_u32 v40, 784384, v38
v_add_u32 v41, 1176576, v38
s_and_b32 s78, s72, 1
s_lshl_b32 s78, s78, 4
s_lshr_b32 s79, s72, 1
s_lshl_b32 s79, s79, 2
s_add_u32 s79, s78, s79
v_and_b32 v4, 4, v2
v_add3_u32 v4, v4, v2, s79
s_movk_i32 s79, 6144
v_mad_u32_u24 v22, v4, s79, v3
v_add_u32 v23, 195584, v22
v_add_u32 v24, 391168, v22
v_add_u32 v25, 586752, v22
s_lshl_b32 s82, s74, 7
s_and_b32 s78, s74, 3
s_lshl_b32 s75, s78, 2
s_lshr_b32 s79, s74, 2
s_add_u32 s75, s75, s79
s_lshl_b32 s83, s75, 7
s_lshr_b32 s78, s2, 6
s_mul_i32 s86, s78, 3145728
s_and_b32 s78, s2, 63
s_lshl_b32 s78, s78, 7
s_add_u32 s86, s86, s78
s_add_u32 s86, s86, 4096
v_mov_b32 v152, s96
v_mov_b32 v153, s96
s_lshl_b32 s78, s72, 11
v_lshl_add_u32 v9, v1, 5, s78
v_cmp_gt_u32 vcc, 16, v1
v_mov_b32 v3, s96
v_lshlrev_b32 v2, 7, v1
v_cndmask_b32 v8, v3, v2, vcc
v_cmp_gt_u32 vcc, 8, v1
s_lshr_b32 s100, s2, 4
s_nop 0
v_cndmask_b32 v50, v3, v2, vcc
s_lshl_b32 s100, s100, 7
s_lshl_b32 s90, s73, 4
s_add_u32 s90, s90, s72
s_lshl_b32 s90, s90, 10
s_add_u32 s90, s90, 33408
s_lshr_b32 s78, s2, 3
s_lshl_b32 s78, s78, 2
s_add_u32 s78, s78, s72
s_mul_i32 s78, s78, 49152
s_and_b32 s79, s74, 8
s_lshl_b32 s79, s79, 7
s_add_u32 s78, s78, s79
s_add_u32 s78, s78, 384
v_and_b32 v2, 7, v1
v_mul_u32_u24 v2, 6144, v2
v_add_u32 v2, s78, v2
v_cndmask_b32 v56, v3, v2, vcc
s_lshr_b32 s78, s2, 3
s_lshl_b32 s78, s78, 15
s_add_u32 s78, s78, s76
v_lshl_add_u32 v2, v1, 10, s78
v_add_u32 v49, v2, v56
v_and_b32 v2, 31, v0
v_mul_u32_u24 v2, 272, v2
v_add_u32 v2, 131328, v2
v_mov_b32 v4, 0
v_mov_b32 v5, 0
v_mov_b32 v6, 0
v_mov_b32 v7, 0
ds_write_b128 v2, v[4:7]
s_waitcnt lgkmcnt(0)
s_mul_i32 s20, s72, 24576
s_lshl_b32 s21, s72, 16
v_and_b32 v2, 15, v1
v_lshrrev_b32 v3, 4, v1
v_lshlrev_b32 v3, 2, v3
v_sub_u32 v3, v2, v3
s_mov_b32 s78, 0x80000001
v_mov_b32 v5, 0xf149f2ca
v_sub_u32 v4, -2, v3
v_and_b32 v4, s78, v4
v_cmp_ne_u32 vcc, 0, v4
s_nop 1
v_cndmask_b32 v30, 0, v5, vcc
v_subrev_u32 v4, 0, v3
v_and_b32 v4, s78, v4
v_cmp_ne_u32 vcc, 0, v4
s_nop 1
v_cndmask_b32 v42, 0, v5, vcc
v_sub_u32 v4, -1, v3
v_and_b32 v4, s78, v4
v_cmp_ne_u32 vcc, 0, v4
s_nop 1
v_cndmask_b32 v31, 0, v5, vcc
v_subrev_u32 v4, 1, v3
v_and_b32 v4, s78, v4
v_cmp_ne_u32 vcc, 0, v4
s_nop 1
v_cndmask_b32 v43, 0, v5, vcc
v_sub_u32 v4, 0, v3
v_and_b32 v4, s78, v4
v_cmp_ne_u32 vcc, 0, v4
s_nop 1
v_cndmask_b32 v32, 0, v5, vcc
v_subrev_u32 v4, 2, v3
v_and_b32 v4, s78, v4
v_cmp_ne_u32 vcc, 0, v4
s_nop 1
v_cndmask_b32 v44, 0, v5, vcc
v_sub_u32 v4, 1, v3
v_and_b32 v4, s78, v4
v_cmp_ne_u32 vcc, 0, v4
s_nop 1
v_cndmask_b32 v33, 0, v5, vcc
v_subrev_u32 v4, 3, v3
v_and_b32 v4, s78, v4
v_cmp_ne_u32 vcc, 0, v4
s_nop 1
v_cndmask_b32 v45, 0, v5, vcc
s_cmp_eq_u32 s88, 0
s_cselect_b32 s78, 0xf149f2ca, 0
v_min_f32 v34, s78, v30
v_min_f32 v35, s78, v31
v_min_f32 v36, s78, v32
v_min_f32 v37, s78, v33
s_lshl_b32 s78, s72, 5
v_xor_b32 v55, s78, v14
v_and_b32 v71, 48, v1
v_add_u32 v71, 143872, v71
s_lshr_b32 s78, s2, 6
s_lshl_b32 s78, s78, 14
s_and_b32 s79, s2, 63
s_lshl_b32 s79, s79, 8
s_add_u32 s78, s78, s79
s_lshl_b32 s79, s72, 6
s_add_u32 s78, s78, s79
s_add_u32 s78, s78, 589824
v_add_u32 v69, s78, v1
v_mov_b32 v6, s96
v_and_b32 v5, 15, v1
v_cmp_eq_u32 vcc, 0, v5
s_nop 1
v_cndmask_b32 v69, v6, v69, vcc
s_and_b32 s78, s2, 7
s_lshl_b32 s78, s78, 11
s_add_u32 s78, s78, 16384
v_lshl_add_u32 v70, v1, 7, s78
v_cmp_gt_u32 vcc, 16, v0
s_nop 1
v_cndmask_b32 v70, v6, v70, vcc
s_lshl_b32 s80, s73, 4
s_add_u32 s80, s80, s74
v_lshrrev_b32 v5, 1, v46
s_lshl_b32 s78, s72, 12
s_add_u32 s78, s78, 147456
v_add_u32 v74, s78, v46
v_add_u32 v75, s78, v5
v_add_u32 v53, 4096, v74
v_add_u32 v72, 4096, v75
s_lshl_b32 s78, s80, 12
s_add_u32 s78, s78, 0x100000
s_cmp_eq_u32 s72, 3
s_cselect_b32 s79, s78, s96
v_add_u32 v54, s79, v46
v_add_u32 v73, s79, v5
s_sub_u32 s78, s78, 65536
s_cmp_eq_u32 s72, 0
s_cselect_b32 s79, s73, 0
s_cselect_b32 s68, 0, 16384
s_add_u32 s68, s68, 147456
s_cmp_lg_u32 s79, 0
s_cselect_b32 s78, s78, s96
v_add_u32 v68, s78, v46
s_lshl_b32 s80, s80, 10
s_add_u32 s80, s80, 32768
s_cmp_lg_u32 s79, 0
s_cselect_b32 s98, s80, s90
s_cselect_b32 s99, 1, 0
s_add_u32 s80, s80, 16384
s_cmp_eq_u32 s72, 3
s_cselect_b32 s78, s73, 15
s_cmp_lt_u32 s78, 15
s_cselect_b32 s97, s80, s90
s_cselect_b32 s85, 1, 0
v_and_b32 v2, 15, v1
v_lshrrev_b32 v3, 2, v2
v_lshrrev_b32 v4, 4, v1
v_cmp_eq_u32 vcc, v3, v4
v_lshl_add_u32 v5, v3, 4, v2
v_lshlrev_b32 v206, 2, v5
v_lshlrev_b32 v3, 4, v2
v_mov_b32 v4, 256
v_cndmask_b32 v3, v4, v3, vcc
v_add_u32 v204, 131072, v3
v_lshlrev_b32 v2, 3, v2
v_add_u32 v205, 139776, v2
v_and_b32 v2, 3, v1
v_cmp_eq_u32 s[12:13], 1, v2
v_cmp_eq_u32 s[14:15], 2, v2
v_cmp_eq_u32 s[16:17], 3, v2
v_cmp_gt_u32 s[18:19], 16, v1
v_mov_b32 v61, 0
v_mov_b32 v62, 0
v_mov_b32 v65, 0
v_mov_b32 v66, 0
s_cmp_lg_u32 s72, 0
s_cbranch_scc1 K_g1a
s_lshl_b32 s78, s73, 4
s_add_u32 s78, s78, s74
s_lshl_b32 s78, s78, 10
s_add_u32 s78, s78, 32768
v_lshl_add_u32 v5, v1, 7, s78
v_cmp_gt_u32 vcc, 8, v1
v_mov_b32 v6, s96
s_nop 0
v_cndmask_b32 v5, v6, v5, vcc
s_and_b32 s78, s2, 127
s_lshl_b32 s78, s78, 7
s_add_u32 s78, s78, 16384
v_writelane_b32 v5, s78, 8
v_mov_b32 v6, 0
v_mov_b32 v7, 0
buffer_store_dwordx2 v[6:7], v5, s[60:63], 0 offen sc1
s_waitcnt vmcnt(19)
v_lshlrev_b32 v136, 16, v132
v_and_b32 v137, 0xffff0000, v132
v_lshlrev_b32 v138, 16, v133
v_and_b32 v139, 0xffff0000, v133
v_mul_f32 v140, 0xbfb8aa3b, v136
v_mul_f32 v141, 0xbfb8aa3b, v137
v_mul_f32 v142, 0xbfb8aa3b, v138
v_mul_f32 v143, 0xbfb8aa3b, v139
v_exp_f32 v140, v140
v_exp_f32 v141, v141
v_exp_f32 v142, v142
v_exp_f32 v143, v143
v_add_f32 v140, 1.0, v140
v_add_f32 v141, 1.0, v141
v_add_f32 v142, 1.0, v142
v_add_f32 v143, 1.0, v143
v_rcp_f32 v140, v140
v_rcp_f32 v141, v141
v_rcp_f32 v142, v142
v_rcp_f32 v143, v143
v_mul_f32 v136, v136, v140
v_mul_f32 v137, v137, v141
v_mul_f32 v138, v138, v142
v_mul_f32 v139, v139, v143
v_cvt_pk_bf16_f32 v140, v136, v137
v_cvt_pk_bf16_f32 v141, v138, v139
v_lshrrev_b32 v2, 3, v1
v_lshlrev_b32 v2, 6, v2
v_and_b32 v3, 3, v1
v_lshl_add_u32 v2, v3, 4, v2
v_bfe_u32 v3, v1, 2, 1
v_lshl_add_u32 v2, v3, 3, v2
v_add_u32 v2, 143872, v2
ds_write_b64 v2, v[140:141]
v_and_b32 v5, 48, v1
v_add_u32 v5, 143872, v5
s_waitcnt lgkmcnt(0)
ds_read_b128 v[224:227], v5 offset:0
ds_read_b128 v[228:231], v5 offset:64
ds_read_b128 v[232:235], v5 offset:128
ds_read_b128 v[236:239], v5 offset:192
ds_read_b128 v[240:243], v5 offset:256
ds_read_b128 v[244:247], v5 offset:320
ds_read_b128 v[248:251], v5 offset:384
ds_read_b128 v[252:255], v5 offset:448
v_add_u32 v154, 147456, v18
v_add_u32 v155, 147456, v19
s_lshl_b32 s78, s81, 13
s_lshl_b32 s79, s87, 7
s_add_u32 s78, s78, s79
s_add_u32 s78, s78, 524288
v_and_b32 v2, 15, v1
v_and_b32 v3, 48, v1
v_lshl_add_u32 v3, v2, 6, v3
v_add_u32 v3, s78, v3
v_cmp_gt_u32 vcc, 2, v2
v_mov_b32 v4, s96
s_nop 0
v_cndmask_b32 v152, v4, v3, vcc
s_and_b32 s78, s2, 7
s_lshl_b32 s78, s78, 11
v_lshl_add_u32 v3, v1, 7, s78
v_cmp_gt_u32 vcc, 16, v1
s_nop 1
v_cndmask_b32 v153, v4, v3, vcc
s_waitcnt vmcnt(2)
v_and_b32 v2, 15, v1
v_cmp_eq_u32 vcc, 1, v2
ds_read_b64_tr_b16 v[80:81], v154 offset:0
ds_read_b64_tr_b16 v[82:83], v154 offset:1024
ds_read_b64_tr_b16 v[84:85], v155 offset:0
ds_read_b64_tr_b16 v[86:87], v155 offset:1024
ds_read_b64_tr_b16 v[88:89], v154 offset:2048
ds_read_b64_tr_b16 v[90:91], v154 offset:3072
ds_read_b64_tr_b16 v[92:93], v155 offset:2048
ds_read_b64_tr_b16 v[94:95], v155 offset:3072
ds_read_b64_tr_b16 v[96:97], v154 offset:4096
ds_read_b64_tr_b16 v[98:99], v154 offset:5120
ds_read_b64_tr_b16 v[100:101], v155 offset:4096
ds_read_b64_tr_b16 v[102:103], v155 offset:5120
ds_read_b64_tr_b16 v[104:105], v154 offset:6144
ds_read_b64_tr_b16 v[106:107], v154 offset:7168
ds_read_b64_tr_b16 v[108:109], v155 offset:6144
ds_read_b64_tr_b16 v[110:111], v155 offset:7168
ds_read_b64_tr_b16 v[112:113], v154 offset:8192
ds_read_b64_tr_b16 v[114:115], v154 offset:9216
ds_read_b64_tr_b16 v[116:117], v155 offset:8192
ds_read_b64_tr_b16 v[118:119], v155 offset:9216
ds_read_b64_tr_b16 v[120:121], v154 offset:10240
ds_read_b64_tr_b16 v[122:123], v154 offset:11264
ds_read_b64_tr_b16 v[124:125], v155 offset:10240
ds_read_b64_tr_b16 v[126:127], v155 offset:11264
ds_read_b64_tr_b16 v[128:129], v154 offset:12288
ds_read_b64_tr_b16 v[130:131], v154 offset:13312
ds_read_b64_tr_b16 v[132:133], v155 offset:12288
ds_read_b64_tr_b16 v[134:135], v155 offset:13312
ds_read_b64_tr_b16 v[136:137], v154 offset:14336
ds_read_b64_tr_b16 v[138:139], v154 offset:15360
ds_read_b64_tr_b16 v[140:141], v155 offset:14336
ds_read_b64_tr_b16 v[142:143], v155 offset:15360
s_waitcnt lgkmcnt(15)
v_mfma_f32_16x16x32_bf16 v[144:147], v[80:83], v[224:227], 0
v_mfma_f32_16x16x32_bf16 v[148:151], v[84:87], v[224:227], 0
v_mfma_f32_16x16x32_bf16 v[144:147], v[88:91], v[228:231], v[144:147]
v_mfma_f32_16x16x32_bf16 v[148:151], v[92:95], v[228:231], v[148:151]
v_mfma_f32_16x16x32_bf16 v[144:147], v[96:99], v[232:235], v[144:147]
v_mfma_f32_16x16x32_bf16 v[148:151], v[100:103], v[232:235], v[148:151]
v_mfma_f32_16x16x32_bf16 v[144:147], v[104:107], v[236:239], v[144:147]
v_mfma_f32_16x16x32_bf16 v[148:151], v[108:111], v[236:239], v[148:151]
s_waitcnt lgkmcnt(14)
v_mfma_f32_16x16x32_bf16 v[144:147], v[112:115], v[240:243], v[144:147]
s_waitcnt lgkmcnt(12)
v_mfma_f32_16x16x32_bf16 v[148:151], v[116:119], v[240:243], v[148:151]
s_waitcnt lgkmcnt(10)
v_mfma_f32_16x16x32_bf16 v[144:147], v[120:123], v[244:247], v[144:147]
s_waitcnt lgkmcnt(8)
v_mfma_f32_16x16x32_bf16 v[148:151], v[124:127], v[244:247], v[148:151]
s_waitcnt lgkmcnt(6)
v_mfma_f32_16x16x32_bf16 v[144:147], v[128:131], v[248:251], v[144:147]
s_waitcnt lgkmcnt(4)
v_mfma_f32_16x16x32_bf16 v[148:151], v[132:135], v[248:251], v[148:151]
s_waitcnt lgkmcnt(2)
v_mfma_f32_16x16x32_bf16 v[144:147], v[136:139], v[252:255], v[144:147]
s_waitcnt lgkmcnt(0)
v_mfma_f32_16x16x32_bf16 v[148:151], v[140:143], v[252:255], v[148:151]
s_nop 7
v_cndmask_b32 v144, v144, v148, vcc
v_cndmask_b32 v145, v145, v149, vcc
v_cndmask_b32 v146, v146, v150, vcc
v_cndmask_b32 v147, v147, v151, vcc
buffer_store_dwordx4 v[144:147], v152, s[60:63], 0 offen sc1
s_load_dword s87, s[24:25], 0
K_g1a:
s_nop 4
s_add_u32 m0, s20, 0
s_add_u32 s77, s21, 0
buffer_load_dwordx4 v192, s[28:31], s77 offen offset:0 lds
buffer_load_dwordx4 v193, s[28:31], s77 offen offset:1024 lds
buffer_load_dwordx4 v194, s[28:31], s77 offen offset:2048 lds
buffer_load_dwordx4 v195, s[28:31], s77 offen offset:3072 lds
s_add_u32 m0, s20, 4096
s_add_u32 s77, s21, 128
buffer_load_dwordx4 v192, s[28:31], s77 offen offset:0 lds
buffer_load_dwordx4 v193, s[28:31], s77 offen offset:1024 lds
buffer_load_dwordx4 v194, s[28:31], s77 offen offset:2048 lds
buffer_load_dwordx4 v195, s[28:31], s77 offen offset:3072 lds
s_add_u32 m0, s20, 8192
s_add_u32 s77, s21, 256
buffer_load_dwordx4 v192, s[28:31], s77 offen offset:0 lds
buffer_load_dwordx4 v193, s[28:31], s77 offen offset:1024 lds
buffer_load_dwordx4 v194, s[28:31], s77 offen offset:2048 lds
buffer_load_dwordx4 v195, s[28:31], s77 offen offset:3072 lds
s_add_u32 m0, s20, 12288
s_add_u32 s77, s21, 384
buffer_load_dwordx4 v192, s[28:31], s77 offen offset:0 lds
buffer_load_dwordx4 v193, s[28:31], s77 offen offset:1024 lds
buffer_load_dwordx4 v194, s[28:31], s77 offen offset:2048 lds
buffer_load_dwordx4 v195, s[28:31], s77 offen offset:3072 lds
s_cmp_lg_u32 s72, 0
s_cbranch_scc1 K_g1s
s_waitcnt vmcnt(16) lgkmcnt(0)
s_mov_b32 s81, 0
K_dbgchk:
s_cmp_lg_u32 s87, 0
s_cbranch_scc1 K_dbgok
v_mov_b32 v2, 0
s_sleep 4
global_load_dword v3, v2, s[24:25] sc1
s_add_u32 s81, s81, 1
s_waitcnt vmcnt(0)
v_readfirstlane_b32 s87, v3
s_cmp_lt_u32 s81, 0x400000
s_nop 3
s_cbranch_scc1 K_dbgchk
K_dbgok:
buffer_atomic_add v52, v153, s[60:63], 0 offen sc1
K_g1s:
s_nop 4
v_and_b32 v2, 15, v1
v_lshrrev_b32 v3, 1, v2
v_lshrrev_b32 v4, 4, v1
v_xor_b32 v5, v3, v4
v_lshlrev_b32 v5, 4, v5
v_lshl_add_u32 v2, v2, 7, s20
v_add_u32 v196, v2, v5
v_xor_b32 v197, 64, v196
v_lshrrev_b32 v5, 5, v1
v_xor_b32 v5, v5, v3
v_lshl_add_u32 v2, v5, 4, v2
v_and_b32 v4, 1, v4
v_lshl_add_u32 v128, v4, 3, v2
v_xor_b32 v129, 32, v128
v_xor_b32 v130, 64, v128
v_xor_b32 v131, 96, v128
v_mov_b32 v200, 0x3f803f80
v_mov_b32 v201, 0x3f803f80
v_mov_b32 v202, 0x3f803f80
v_mov_b32 v203, 0x3f803f80
s_waitcnt vmcnt(12)
ds_read_b128 a[0:3], v196 offset:0
ds_read_b128 a[4:7], v196 offset:2048
ds_read_b128 a[8:11], v197 offset:0
ds_read_b128 a[12:15], v197 offset:2048
s_add_u32 m0, s20, 16384
s_add_u32 s77, s21, 512
buffer_load_dwordx4 v192, s[28:31], s77 offen offset:0 lds
buffer_load_dwordx4 v193, s[28:31], s77 offen offset:1024 lds
buffer_load_dwordx4 v194, s[28:31], s77 offen offset:2048 lds
buffer_load_dwordx4 v195, s[28:31], s77 offen offset:3072 lds
s_waitcnt vmcnt(12)
ds_read_b128 a[16:19], v196 offset:4096
ds_read_b128 a[20:23], v196 offset:6144
ds_read_b128 a[24:27], v197 offset:4096
ds_read_b128 a[28:31], v197 offset:6144
s_add_u32 m0, s20, 20480
s_add_u32 s77, s21, 640
buffer_load_dwordx4 v192, s[28:31], s77 offen offset:0 lds
buffer_load_dwordx4 v193, s[28:31], s77 offen offset:1024 lds
buffer_load_dwordx4 v194, s[28:31], s77 offen offset:2048 lds
buffer_load_dwordx4 v195, s[28:31], s77 offen offset:3072 lds
s_waitcnt lgkmcnt(7)
v_mfma_f32_16x16x32_bf16 v[132:135], v[200:203], a[0:3], 0
v_mfma_f32_16x16x32_bf16 v[140:143], a[0:3], a[0:3], 0
s_waitcnt lgkmcnt(6)
v_mfma_f32_16x16x32_bf16 v[136:139], v[200:203], a[4:7], 0
v_mfma_f32_16x16x32_bf16 v[144:147], a[4:7], a[4:7], 0
s_waitcnt lgkmcnt(5)
v_mfma_f32_16x16x32_bf16 v[132:135], v[200:203], a[8:11], v[132:135]
v_mfma_f32_16x16x32_bf16 v[140:143], a[8:11], a[8:11], v[140:143]
s_waitcnt lgkmcnt(4)
v_mfma_f32_16x16x32_bf16 v[136:139], v[200:203], a[12:15], v[136:139]
v_mfma_f32_16x16x32_bf16 v[144:147], a[12:15], a[12:15], v[144:147]
s_waitcnt vmcnt(12)
ds_read_b128 a[32:35], v196 offset:8192
ds_read_b128 a[36:39], v196 offset:10240
ds_read_b128 a[40:43], v197 offset:8192
ds_read_b128 a[44:47], v197 offset:10240
s_add_u32 m0, s20, 0
s_add_u32 s77, s21, 768
buffer_load_dwordx4 v192, s[28:31], s77 offen offset:0 lds
buffer_load_dwordx4 v193, s[28:31], s77 offen offset:1024 lds
buffer_load_dwordx4 v194, s[28:31], s77 offen offset:2048 lds
buffer_load_dwordx4 v195, s[28:31], s77 offen offset:3072 lds
s_waitcnt lgkmcnt(7)
v_mfma_f32_16x16x32_bf16 v[132:135], v[200:203], a[16:19], v[132:135]
v_mfma_f32_16x16x32_bf16 v[140:143], a[16:19], a[16:19], v[140:143]
s_waitcnt lgkmcnt(6)
v_mfma_f32_16x16x32_bf16 v[136:139], v[200:203], a[20:23], v[136:139]
v_mfma_f32_16x16x32_bf16 v[144:147], a[20:23], a[20:23], v[144:147]
s_waitcnt lgkmcnt(5)
v_mfma_f32_16x16x32_bf16 v[132:135], v[200:203], a[24:27], v[132:135]
v_mfma_f32_16x16x32_bf16 v[140:143], a[24:27], a[24:27], v[140:143]
s_waitcnt lgkmcnt(4)
v_mfma_f32_16x16x32_bf16 v[136:139], v[200:203], a[28:31], v[136:139]
v_mfma_f32_16x16x32_bf16 v[144:147], a[28:31], a[28:31], v[144:147]
s_waitcnt vmcnt(12)
ds_read_b128 a[48:51], v196 offset:12288
ds_read_b128 a[52:55], v196 offset:14336
ds_read_b128 a[56:59], v197 offset:12288
ds_read_b128 a[60:63], v197 offset:14336
s_add_u32 m0, s20, 4096
s_add_u32 s77, s21, 896
buffer_load_dwordx4 v192, s[28:31], s77 offen offset:0 lds
buffer_load_dwordx4 v193, s[28:31], s77 offen offset:1024 lds
buffer_load_dwordx4 v194, s[28:31], s77 offen offset:2048 lds
buffer_load_dwordx4 v195, s[28:31], s77 offen offset:3072 lds
s_waitcnt lgkmcnt(7)
v_mfma_f32_16x16x32_bf16 v[132:135], v[200:203], a[32:35], v[132:135]
v_mfma_f32_16x16x32_bf16 v[140:143], a[32:35], a[32:35], v[140:143]
s_waitcnt lgkmcnt(6)
v_mfma_f32_16x16x32_bf16 v[136:139], v[200:203], a[36:39], v[136:139]
v_mfma_f32_16x16x32_bf16 v[144:147], a[36:39], a[36:39], v[144:147]
s_waitcnt lgkmcnt(5)
v_mfma_f32_16x16x32_bf16 v[132:135], v[200:203], a[40:43], v[132:135]
v_mfma_f32_16x16x32_bf16 v[140:143], a[40:43], a[40:43], v[140:143]
s_waitcnt lgkmcnt(4)
v_mfma_f32_16x16x32_bf16 v[136:139], v[200:203], a[44:47], v[136:139]
v_mfma_f32_16x16x32_bf16 v[144:147], a[44:47], a[44:47], v[144:147]
s_waitcnt vmcnt(12)
ds_read_b128 a[64:67], v196 offset:16384
ds_read_b128 a[68:71], v196 offset:18432
ds_read_b128 a[72:75], v197 offset:16384
ds_read_b128 a[76:79], v197 offset:18432
s_add_u32 m0, s20, 8192
s_add_u32 s77, s21, 1024
buffer_load_dwordx4 v192, s[28:31], s77 offen offset:0 lds
buffer_load_dwordx4 v193, s[28:31], s77 offen offset:1024 lds
buffer_load_dwordx4 v194, s[28:31], s77 offen offset:2048 lds
buffer_load_dwordx4 v195, s[28:31], s77 offen offset:3072 lds
s_waitcnt lgkmcnt(7)
v_mfma_f32_16x16x32_bf16 v[132:135], v[200:203], a[48:51], v[132:135]
v_mfma_f32_16x16x32_bf16 v[140:143], a[48:51], a[48:51], v[140:143]
s_waitcnt lgkmcnt(6)
v_mfma_f32_16x16x32_bf16 v[136:139], v[200:203], a[52:55], v[136:139]
v_mfma_f32_16x16x32_bf16 v[144:147], a[52:55], a[52:55], v[144:147]
s_waitcnt lgkmcnt(5)
v_mfma_f32_16x16x32_bf16 v[132:135], v[200:203], a[56:59], v[132:135]
v_mfma_f32_16x16x32_bf16 v[140:143], a[56:59], a[56:59], v[140:143]
s_waitcnt lgkmcnt(4)
v_mfma_f32_16x16x32_bf16 v[136:139], v[200:203], a[60:63], v[136:139]
v_mfma_f32_16x16x32_bf16 v[144:147], a[60:63], a[60:63], v[144:147]
s_waitcnt vmcnt(12)
ds_read_b128 a[80:83], v196 offset:20480
ds_read_b128 a[84:87], v196 offset:22528
ds_read_b128 a[88:91], v197 offset:20480
ds_read_b128 a[92:95], v197 offset:22528
s_add_u32 m0, s20, 12288
s_add_u32 s77, s21, 1152
buffer_load_dwordx4 v192, s[28:31], s77 offen offset:0 lds
buffer_load_dwordx4 v193, s[28:31], s77 offen offset:1024 lds
buffer_load_dwordx4 v194, s[28:31], s77 offen offset:2048 lds
buffer_load_dwordx4 v195, s[28:31], s77 offen offset:3072 lds
s_waitcnt lgkmcnt(7)
v_mfma_f32_16x16x32_bf16 v[132:135], v[200:203], a[64:67], v[132:135]
v_mfma_f32_16x16x32_bf16 v[140:143], a[64:67], a[64:67], v[140:143]
s_waitcnt lgkmcnt(6)
v_mfma_f32_16x16x32_bf16 v[136:139], v[200:203], a[68:71], v[136:139]
v_mfma_f32_16x16x32_bf16 v[144:147], a[68:71], a[68:71], v[144:147]
s_waitcnt lgkmcnt(5)
v_mfma_f32_16x16x32_bf16 v[132:135], v[200:203], a[72:75], v[132:135]
v_mfma_f32_16x16x32_bf16 v[140:143], a[72:75], a[72:75], v[140:143]
s_waitcnt lgkmcnt(4)
v_mfma_f32_16x16x32_bf16 v[136:139], v[200:203], a[76:79], v[136:139]
v_mfma_f32_16x16x32_bf16 v[144:147], a[76:79], a[76:79], v[144:147]
s_waitcnt vmcnt(12)
ds_read_b128 a[96:99], v196 offset:0
ds_read_b128 a[100:103], v196 offset:2048
ds_read_b128 a[104:107], v197 offset:0
ds_read_b128 a[108:111], v197 offset:2048
s_add_u32 m0, s20, 16384
s_add_u32 s77, s21, 1280
buffer_load_dwordx4 v192, s[28:31], s77 offen offset:0 lds
buffer_load_dwordx4 v193, s[28:31], s77 offen offset:1024 lds
buffer_load_dwordx4 v194, s[28:31], s77 offen offset:2048 lds
buffer_load_dwordx4 v195, s[28:31], s77 offen offset:3072 lds
s_waitcnt lgkmcnt(7)
v_mfma_f32_16x16x32_bf16 v[132:135], v[200:203], a[80:83], v[132:135]
v_mfma_f32_16x16x32_bf16 v[140:143], a[80:83], a[80:83], v[140:143]
s_waitcnt lgkmcnt(6)
v_mfma_f32_16x16x32_bf16 v[136:139], v[200:203], a[84:87], v[136:139]
v_mfma_f32_16x16x32_bf16 v[144:147], a[84:87], a[84:87], v[144:147]
s_waitcnt lgkmcnt(5)
v_mfma_f32_16x16x32_bf16 v[132:135], v[200:203], a[88:91], v[132:135]
v_mfma_f32_16x16x32_bf16 v[140:143], a[88:91], a[88:91], v[140:143]
s_waitcnt lgkmcnt(4)
v_mfma_f32_16x16x32_bf16 v[136:139], v[200:203], a[92:95], v[136:139]
v_mfma_f32_16x16x32_bf16 v[144:147], a[92:95], a[92:95], v[144:147]
s_waitcnt vmcnt(12)
ds_read_b128 a[112:115], v196 offset:4096
ds_read_b128 a[116:119], v196 offset:6144
ds_read_b128 a[120:123], v197 offset:4096
ds_read_b128 a[124:127], v197 offset:6144
s_add_u32 m0, s20, 20480
s_add_u32 s77, s21, 1408
buffer_load_dwordx4 v192, s[28:31], s77 offen offset:0 lds
buffer_load_dwordx4 v193, s[28:31], s77 offen offset:1024 lds
buffer_load_dwordx4 v194, s[28:31], s77 offen offset:2048 lds
buffer_load_dwordx4 v195, s[28:31], s77 offen offset:3072 lds
s_waitcnt lgkmcnt(7)
v_mfma_f32_16x16x32_bf16 v[132:135], v[200:203], a[96:99], v[132:135]
v_mfma_f32_16x16x32_bf16 v[140:143], a[96:99], a[96:99], v[140:143]
s_waitcnt lgkmcnt(6)
v_mfma_f32_16x16x32_bf16 v[136:139], v[200:203], a[100:103], v[136:139]
v_mfma_f32_16x16x32_bf16 v[144:147], a[100:103], a[100:103], v[144:147]
s_waitcnt lgkmcnt(5)
v_mfma_f32_16x16x32_bf16 v[132:135], v[200:203], a[104:107], v[132:135]
v_mfma_f32_16x16x32_bf16 v[140:143], a[104:107], a[104:107], v[140:143]
s_waitcnt lgkmcnt(4)
v_mfma_f32_16x16x32_bf16 v[136:139], v[200:203], a[108:111], v[136:139]
v_mfma_f32_16x16x32_bf16 v[144:147], a[108:111], a[108:111], v[144:147]
s_load_dword s87, s[24:25], 0
s_waitcnt vmcnt(12)
ds_read_b128 a[128:131], v196 offset:8192
ds_read_b128 a[132:135], v196 offset:10240
ds_read_b128 a[136:139], v197 offset:8192
ds_read_b128 a[140:143], v197 offset:10240
s_add_u32 m0, s20, 0
s_add_u32 s77, s21, 1536
buffer_load_dwordx4 v192, s[28:31], s77 offen offset:0 lds
buffer_load_dwordx4 v193, s[28:31], s77 offen offset:1024 lds
buffer_load_dwordx4 v194, s[28:31], s77 offen offset:2048 lds
buffer_load_dwordx4 v195, s[28:31], s77 offen offset:3072 lds
s_waitcnt lgkmcnt(7)
v_mfma_f32_16x16x32_bf16 v[132:135], v[200:203], a[112:115], v[132:135]
v_mfma_f32_16x16x32_bf16 v[140:143], a[112:115], a[112:115], v[140:143]
s_waitcnt lgkmcnt(6)
v_mfma_f32_16x16x32_bf16 v[136:139], v[200:203], a[116:119], v[136:139]
v_mfma_f32_16x16x32_bf16 v[144:147], a[116:119], a[116:119], v[144:147]
s_waitcnt lgkmcnt(5)
v_mfma_f32_16x16x32_bf16 v[132:135], v[200:203], a[120:123], v[132:135]
v_mfma_f32_16x16x32_bf16 v[140:143], a[120:123], a[120:123], v[140:143]
s_waitcnt lgkmcnt(4)
v_mfma_f32_16x16x32_bf16 v[136:139], v[200:203], a[124:127], v[136:139]
v_mfma_f32_16x16x32_bf16 v[144:147], a[124:127], a[124:127], v[144:147]
s_waitcnt vmcnt(12)
ds_read_b128 a[144:147], v196 offset:12288
ds_read_b128 a[148:151], v196 offset:14336
ds_read_b128 a[152:155], v197 offset:12288
ds_read_b128 a[156:159], v197 offset:14336
s_add_u32 m0, s20, 4096
s_add_u32 s77, s21, 1664
buffer_load_dwordx4 v192, s[28:31], s77 offen offset:0 lds
buffer_load_dwordx4 v193, s[28:31], s77 offen offset:1024 lds
buffer_load_dwordx4 v194, s[28:31], s77 offen offset:2048 lds
buffer_load_dwordx4 v195, s[28:31], s77 offen offset:3072 lds
s_waitcnt lgkmcnt(7)
v_mfma_f32_16x16x32_bf16 v[132:135], v[200:203], a[128:131], v[132:135]
v_mfma_f32_16x16x32_bf16 v[140:143], a[128:131], a[128:131], v[140:143]
s_waitcnt lgkmcnt(6)
v_mfma_f32_16x16x32_bf16 v[136:139], v[200:203], a[132:135], v[136:139]
v_mfma_f32_16x16x32_bf16 v[144:147], a[132:135], a[132:135], v[144:147]
s_waitcnt lgkmcnt(5)
v_mfma_f32_16x16x32_bf16 v[132:135], v[200:203], a[136:139], v[132:135]
v_mfma_f32_16x16x32_bf16 v[140:143], a[136:139], a[136:139], v[140:143]
s_waitcnt lgkmcnt(4)
v_mfma_f32_16x16x32_bf16 v[136:139], v[200:203], a[140:143], v[136:139]
v_mfma_f32_16x16x32_bf16 v[144:147], a[140:143], a[140:143], v[144:147]
s_waitcnt vmcnt(12)
ds_read_b128 a[160:163], v196 offset:16384
ds_read_b128 a[164:167], v196 offset:18432
ds_read_b128 a[168:171], v197 offset:16384
ds_read_b128 a[172:175], v197 offset:18432
s_add_u32 m0, s20, 8192
s_add_u32 s77, s21, 1792
buffer_load_dwordx4 v192, s[28:31], s77 offen offset:0 lds
buffer_load_dwordx4 v193, s[28:31], s77 offen offset:1024 lds
buffer_load_dwordx4 v194, s[28:31], s77 offen offset:2048 lds
buffer_load_dwordx4 v195, s[28:31], s77 offen offset:3072 lds
s_waitcnt lgkmcnt(7)
v_mfma_f32_16x16x32_bf16 v[132:135], v[200:203], a[144:147], v[132:135]
v_mfma_f32_16x16x32_bf16 v[140:143], a[144:147], a[144:147], v[140:143]
s_waitcnt lgkmcnt(6)
v_mfma_f32_16x16x32_bf16 v[136:139], v[200:203], a[148:151], v[136:139]
v_mfma_f32_16x16x32_bf16 v[144:147], a[148:151], a[148:151], v[144:147]
s_waitcnt lgkmcnt(5)
v_mfma_f32_16x16x32_bf16 v[132:135], v[200:203], a[152:155], v[132:135]
v_mfma_f32_16x16x32_bf16 v[140:143], a[152:155], a[152:155], v[140:143]
s_waitcnt lgkmcnt(4)
v_mfma_f32_16x16x32_bf16 v[136:139], v[200:203], a[156:159], v[136:139]
v_mfma_f32_16x16x32_bf16 v[144:147], a[156:159], a[156:159], v[144:147]
s_waitcnt vmcnt(12)
ds_read_b128 a[176:179], v196 offset:20480
ds_read_b128 a[180:183], v196 offset:22528
ds_read_b128 a[184:187], v197 offset:20480
ds_read_b128 a[188:191], v197 offset:22528
s_add_u32 m0, s20, 12288
s_add_u32 s77, s21, 1920
buffer_load_dwordx4 v192, s[28:31], s77 offen offset:0 lds
buffer_load_dwordx4 v193, s[28:31], s77 offen offset:1024 lds
buffer_load_dwordx4 v194, s[28:31], s77 offen offset:2048 lds
buffer_load_dwordx4 v195, s[28:31], s77 offen offset:3072 lds
s_waitcnt lgkmcnt(7)
v_mfma_f32_16x16x32_bf16 v[132:135], v[200:203], a[160:163], v[132:135]
v_mfma_f32_16x16x32_bf16 v[140:143], a[160:163], a[160:163], v[140:143]
s_waitcnt lgkmcnt(6)
v_mfma_f32_16x16x32_bf16 v[136:139], v[200:203], a[164:167], v[136:139]
v_mfma_f32_16x16x32_bf16 v[144:147], a[164:167], a[164:167], v[144:147]
s_waitcnt lgkmcnt(5)
v_mfma_f32_16x16x32_bf16 v[132:135], v[200:203], a[168:171], v[132:135]
v_mfma_f32_16x16x32_bf16 v[140:143], a[168:171], a[168:171], v[140:143]
s_waitcnt lgkmcnt(4)
v_mfma_f32_16x16x32_bf16 v[136:139], v[200:203], a[172:175], v[136:139]
v_mfma_f32_16x16x32_bf16 v[144:147], a[172:175], a[172:175], v[144:147]
s_cmp_lg_u32 s72, 3
s_cbranch_scc1 h0_noi
s_waitcnt lgkmcnt(0)
s_mov_b32 s81, 0
K_dbhchk:
s_cmp_lg_u32 s87, 0
s_cbranch_scc1 K_dbhok
v_mov_b32 v2, 0
s_sleep 4
global_load_dword v3, v2, s[24:25] sc1
s_add_u32 s81, s81, 1
s_waitcnt vmcnt(0)
v_readfirstlane_b32 s87, v3
s_cmp_lt_u32 s81, 0x400000
s_nop 3
s_cbranch_scc1 K_dbhchk
K_dbhok:
s_mov_b32 s4, 0
s_atomic_add s4, s[60:61], s100 glc
s_mov_b32 s5, 0
s_atomic_add s5, s[60:61], s100 offset:2048 glc
s_mov_b32 s6, 0
s_atomic_add s6, s[60:61], s100 offset:4096 glc
s_mov_b32 s7, 0
s_atomic_add s7, s[60:61], s100 offset:6144 glc
s_mov_b32 s8, 0
s_atomic_add s8, s[60:61], s100 offset:8192 glc
s_mov_b32 s9, 0
s_atomic_add s9, s[60:61], s100 offset:10240 glc
s_mov_b32 s10, 0
s_atomic_add s10, s[60:61], s100 offset:12288 glc
s_mov_b32 s11, 0
s_atomic_add s11, s[60:61], s100 offset:14336 glc
h0_noi:
s_waitcnt vmcnt(12)
ds_read_b128 a[192:195], v196 offset:0
ds_read_b128 a[196:199], v196 offset:2048
ds_read_b128 a[200:203], v197 offset:0
ds_read_b128 a[204:207], v197 offset:2048
s_add_u32 m0, s20, 16384
s_add_u32 s77, s21, s83
buffer_load_dwordx4 v192, s[28:31], s77 offen offset:0 lds
buffer_load_dwordx4 v193, s[28:31], s77 offen offset:1024 lds
buffer_load_dwordx4 v194, s[28:31], s77 offen offset:2048 lds
buffer_load_dwordx4 v195, s[28:31], s77 offen offset:3072 lds
s_waitcnt lgkmcnt(7)
v_mfma_f32_16x16x32_bf16 v[132:135], v[200:203], a[176:179], v[132:135]
v_mfma_f32_16x16x32_bf16 v[140:143], a[176:179], a[176:179], v[140:143]
s_waitcnt lgkmcnt(6)
v_mfma_f32_16x16x32_bf16 v[136:139], v[200:203], a[180:183], v[136:139]
v_mfma_f32_16x16x32_bf16 v[144:147], a[180:183], a[180:183], v[144:147]
s_waitcnt lgkmcnt(5)
v_mfma_f32_16x16x32_bf16 v[132:135], v[200:203], a[184:187], v[132:135]
v_mfma_f32_16x16x32_bf16 v[140:143], a[184:187], a[184:187], v[140:143]
s_waitcnt lgkmcnt(4)
v_mfma_f32_16x16x32_bf16 v[136:139], v[200:203], a[188:191], v[136:139]
v_mfma_f32_16x16x32_bf16 v[144:147], a[188:191], a[188:191], v[144:147]
s_waitcnt lgkmcnt(0)
s_cmp_lg_u32 s72, 3
s_cbranch_scc1 h0_done
s_mov_b32 s81, 0
h0_loop:
s_min_u32 s4, s4, s5
s_min_u32 s4, s4, s6
s_min_u32 s4, s4, s7
s_min_u32 s4, s4, s8
s_min_u32 s4, s4, s9
s_min_u32 s4, s4, s10
s_min_u32 s4, s4, s11
s_cmp_ge_u32 s4, 32
s_cbranch_scc1 h0_done
s_mov_b32 s4, 0
s_atomic_add s4, s[60:61], s100 glc
s_mov_b32 s5, 0
s_atomic_add s5, s[60:61], s100 offset:2048 glc
s_mov_b32 s6, 0
s_atomic_add s6, s[60:61], s100 offset:4096 glc
s_mov_b32 s7, 0
s_atomic_add s7, s[60:61], s100 offset:6144 glc
s_mov_b32 s8, 0
s_atomic_add s8, s[60:61], s100 offset:8192 glc
s_mov_b32 s9, 0
s_atomic_add s9, s[60:61], s100 offset:10240 glc
s_mov_b32 s10, 0
s_atomic_add s10, s[60:61], s100 offset:12288 glc
s_mov_b32 s11, 0
s_atomic_add s11, s[60:61], s100 offset:14336 glc
s_add_u32 s81, s81, 1
s_cmp_lt_u32 s81, 0x400000
s_waitcnt lgkmcnt(0)
s_cbranch_scc1 h0_loop
h0_done:
s_barrier
v_lshlrev_b32 v2, 4, v0
s_mov_b32 s78, 0x80000
buffer_load_dwordx4 v[80:83], v2, s[60:63], s78 offen sc1
s_mov_b32 s78, 0x82000
buffer_load_dwordx4 v[84:87], v2, s[60:63], s78 offen sc1
s_mov_b32 s78, 0x84000
buffer_load_dwordx4 v[88:91], v2, s[60:63], s78 offen sc1
s_mov_b32 s78, 0x86000
buffer_load_dwordx4 v[92:95], v2, s[60:63], s78 offen sc1
s_mov_b32 s78, 0x81000
buffer_load_dwordx4 v[96:99], v2, s[60:63], s78 offen sc1
s_mov_b32 s78, 0x83000
buffer_load_dwordx4 v[100:103], v2, s[60:63], s78 offen sc1
s_mov_b32 s78, 0x85000
buffer_load_dwordx4 v[104:107], v2, s[60:63], s78 offen sc1
s_mov_b32 s78, 0x87000
buffer_load_dwordx4 v[108:111], v2, s[60:63], s78 offen sc1
s_add_u32 s70, s0, R_mod - K_pc + 0
s_addc_u32 s71, s1, 0
global_load_dword v57, v9, s[70:71]
s_add_u32 s70, s0, R_mod - K_pc + 8192
s_addc_u32 s71, s1, 0
global_load_dword v57, v9, s[70:71]
s_mul_i32 s3, s101, 6144
s_add_u32 s3, s3, 0x800
buffer_load_dword v57, v8, s[32:35], s3 offen
s_movk_i32 s3, 2048
buffer_load_dword v57, v56, s[32:35], s3 offen
s_waitcnt vmcnt(24)
ds_read_b128 a[208:211], v196 offset:4096
ds_read_b128 a[212:215], v196 offset:6144
ds_read_b128 a[216:219], v197 offset:4096
ds_read_b128 a[220:223], v197 offset:6144
v_mfma_f32_16x16x32_bf16 v[132:135], v[200:203], a[192:195], v[132:135]
v_mfma_f32_16x16x32_bf16 v[140:143], a[192:195], a[192:195], v[140:143]
v_mfma_f32_16x16x32_bf16 v[136:139], v[200:203], a[196:199], v[136:139]
v_mfma_f32_16x16x32_bf16 v[144:147], a[196:199], a[196:199], v[144:147]
v_mfma_f32_16x16x32_bf16 v[132:135], v[200:203], a[200:203], v[132:135]
v_mfma_f32_16x16x32_bf16 v[140:143], a[200:203], a[200:203], v[140:143]
v_mfma_f32_16x16x32_bf16 v[136:139], v[200:203], a[204:207], v[136:139]
v_mfma_f32_16x16x32_bf16 v[144:147], a[204:207], a[204:207], v[144:147]
s_waitcnt vmcnt(20)
ds_read_b128 a[224:227], v196 offset:8192
ds_read_b128 a[228:231], v196 offset:10240
ds_read_b128 a[232:235], v197 offset:8192
ds_read_b128 a[236:239], v197 offset:10240
s_waitcnt lgkmcnt(7)
v_mfma_f32_16x16x32_bf16 v[132:135], v[200:203], a[208:211], v[132:135]
v_mfma_f32_16x16x32_bf16 v[140:143], a[208:211], a[208:211], v[140:143]
s_waitcnt lgkmcnt(6)
v_mfma_f32_16x16x32_bf16 v[136:139], v[200:203], a[212:215], v[136:139]
v_mfma_f32_16x16x32_bf16 v[144:147], a[212:215], a[212:215], v[144:147]
s_waitcnt lgkmcnt(5)
v_mfma_f32_16x16x32_bf16 v[132:135], v[200:203], a[216:219], v[132:135]
v_mfma_f32_16x16x32_bf16 v[140:143], a[216:219], a[216:219], v[140:143]
s_waitcnt lgkmcnt(4)
v_mfma_f32_16x16x32_bf16 v[136:139], v[200:203], a[220:223], v[136:139]
v_mfma_f32_16x16x32_bf16 v[144:147], a[220:223], a[220:223], v[144:147]
s_waitcnt vmcnt(16)
ds_read_b128 a[240:243], v196 offset:12288
ds_read_b128 a[244:247], v196 offset:14336
ds_read_b128 a[248:251], v197 offset:12288
ds_read_b128 a[252:255], v197 offset:14336
s_waitcnt lgkmcnt(7)
v_mfma_f32_16x16x32_bf16 v[132:135], v[200:203], a[224:227], v[132:135]
v_mfma_f32_16x16x32_bf16 v[140:143], a[224:227], a[224:227], v[140:143]
s_waitcnt lgkmcnt(6)
v_mfma_f32_16x16x32_bf16 v[136:139], v[200:203], a[228:231], v[136:139]
v_mfma_f32_16x16x32_bf16 v[144:147], a[228:231], a[228:231], v[144:147]
s_waitcnt lgkmcnt(5)
v_mfma_f32_16x16x32_bf16 v[132:135], v[200:203], a[232:235], v[132:135]
v_mfma_f32_16x16x32_bf16 v[140:143], a[232:235], a[232:235], v[140:143]
s_waitcnt lgkmcnt(4)
v_mfma_f32_16x16x32_bf16 v[136:139], v[200:203], a[236:239], v[136:139]
v_mfma_f32_16x16x32_bf16 v[144:147], a[236:239], a[236:239], v[144:147]
v_lshrrev_b32 v2, 3, v0
v_bfe_u32 v3, v0, 1, 2
v_and_b32 v4, 1, v0
v_mul_u32_u24 v5, 272, v2
v_lshl_add_u32 v5, v3, 6, v5
v_lshl_add_u32 v5, v4, 3, v5
v_add_u32 v5, 131072, v5
v_lshlrev_b32 v6, 7, v2
v_lshl_add_u32 v6, v3, 5, v6
v_lshl_add_u32 v6, v4, 2, v6
v_add_u32 v6, 139776, v6
v_mov_b32 v113, 0
v_mov_b32 v115, 0
v_mov_b32 v116, 0
v_mov_b32 v118, 0
s_waitcnt vmcnt(10)
v_pk_add_f32 v[80:81], v[80:81], v[84:85]
s_waitcnt vmcnt(8)
v_pk_add_f32 v[88:89], v[88:89], v[92:93]
v_pk_add_f32 v[82:83], v[82:83], v[86:87]
v_pk_add_f32 v[90:91], v[90:91], v[94:95]
v_pk_add_f32 v[80:81], v[80:81], v[88:89]
v_pk_add_f32 v[82:83], v[82:83], v[90:91]
s_waitcnt vmcnt(6)
v_pk_add_f32 v[96:97], v[96:97], v[100:101]
s_waitcnt vmcnt(4)
v_pk_add_f32 v[104:105], v[104:105], v[108:109]
v_pk_add_f32 v[98:99], v[98:99], v[102:103]
v_pk_add_f32 v[106:107], v[106:107], v[110:111]
v_pk_add_f32 v[96:97], v[96:97], v[104:105]
v_pk_add_f32 v[98:99], v[98:99], v[106:107]
v_cvt_pk_bf16_f32 v100, v96, v97
v_cvt_pk_bf16_f32 v102, v98, v99
v_lshlrev_b32 v96, 16, v100
v_and_b32 v97, 0xffff0000, v100
v_lshlrev_b32 v98, 16, v102
v_and_b32 v99, 0xffff0000, v102
v_add_f32 v96, 1.0, v96
v_add_f32 v97, 1.0, v97
v_add_f32 v98, 1.0, v98
v_add_f32 v99, 1.0, v99
v_cvt_pk_bf16_f32 v120, v80, v96
v_cvt_pk_bf16_f32 v121, v81, v97
v_cvt_pk_bf16_f32 v122, v82, v98
v_cvt_pk_bf16_f32 v123, v83, v99
v_lshrrev_b32 v112, 16, v120
v_and_b32 v114, 0xffff0000, v121
v_lshrrev_b32 v117, 16, v122
v_and_b32 v119, 0xffff0000, v123
ds_write_b64 v5, v[112:113] offset:0
ds_write_b64 v5, v[114:115] offset:16
ds_write_b64 v5, v[116:117] offset:32
ds_write_b64 v5, v[118:119] offset:48
ds_write2_b32 v6, v120, v121 offset0:0 offset1:2
ds_write2_b32 v6, v122, v123 offset0:4 offset1:6
ds_read_b64 v[216:217], v128 offset:16384
ds_read_b64 v[218:219], v129 offset:16384
ds_read_b64 v[220:221], v130 offset:16384
ds_read_b64 v[222:223], v131 offset:16384
ds_read_b64 v[248:249], v128 offset:18432
ds_read_b64 v[250:251], v129 offset:18432
ds_read_b64 v[252:253], v130 offset:18432
ds_read_b64 v[254:255], v131 offset:18432
s_waitcnt lgkmcnt(15)
v_mfma_f32_16x16x32_bf16 v[132:135], v[200:203], a[240:243], v[132:135]
v_mfma_f32_16x16x32_bf16 v[140:143], a[240:243], a[240:243], v[140:143]
v_mfma_f32_16x16x32_bf16 v[136:139], v[200:203], a[244:247], v[136:139]
v_mfma_f32_16x16x32_bf16 v[144:147], a[244:247], a[244:247], v[144:147]
v_mfma_f32_16x16x32_bf16 v[132:135], v[200:203], a[248:251], v[132:135]
v_mfma_f32_16x16x32_bf16 v[140:143], a[248:251], a[248:251], v[140:143]
s_waitcnt lgkmcnt(14)
v_mfma_f32_16x16x32_bf16 v[136:139], v[200:203], a[252:255], v[136:139]
v_mfma_f32_16x16x32_bf16 v[144:147], a[252:255], a[252:255], v[144:147]
s_waitcnt lgkmcnt(0)
s_barrier
ds_read_b128 v[160:163], v204 offset:0
ds_read_b64 v[164:165], v205 offset:0
ds_read_b128 v[168:171], v204 offset:272
ds_read_b64 v[172:173], v205 offset:128
ds_read_b128 v[176:179], v204 offset:544
ds_read_b64 v[180:181], v205 offset:256
ds_read_b128 v[184:187], v204 offset:816
ds_read_b64 v[188:189], v205 offset:384
s_add_u32 m0, s76, 98304
s_add_u32 s77, s82, 0x800
buffer_load_dwordx4 v22, s[32:35], s77 offen offset:0 lds
buffer_load_dwordx4 v23, s[32:35], s77 offen offset:1024 lds
buffer_load_dwordx4 v24, s[32:35], s77 offen offset:2048 lds
buffer_load_dwordx4 v25, s[32:35], s77 offen offset:3072 lds
v_cndmask_b32 v140, v140, v141, s[12:13]
v_cndmask_b32 v144, v144, v145, s[12:13]
v_cndmask_b32 v140, v140, v142, s[14:15]
v_cndmask_b32 v144, v144, v146, s[14:15]
v_cndmask_b32 v140, v140, v143, s[16:17]
v_cndmask_b32 v144, v144, v147, s[16:17]
ds_bpermute_b32 v141, v206, v140
ds_bpermute_b32 v145, v206, v144
v_mul_f32 v132, 0x3a800000, v132
v_mul_f32 v136, 0x3a800000, v136
v_mul_f32 v133, v132, v132
v_mul_f32 v137, v136, v136
s_waitcnt lgkmcnt(1)
v_mul_f32 v141, 0x3a800000, v141
s_waitcnt lgkmcnt(0)
v_mul_f32 v145, 0x3a800000, v145
v_sub_f32 v141, v141, v133
v_sub_f32 v145, v145, v137
v_max_f32 v141, 0, v141
v_max_f32 v145, 0, v145
v_cvt_pk_bf16_f32 v134, v141, v141
v_lshlrev_b32 v141, 16, v134
v_cvt_pk_bf16_f32 v138, v145, v145
v_lshlrev_b32 v145, 16, v138
v_add_f32 v141, 0x3727c5ac, v141
v_add_f32 v145, 0x3727c5ac, v145
v_cvt_pk_bf16_f32 v134, v141, v141
v_lshlrev_b32 v141, 16, v134
v_cvt_pk_bf16_f32 v138, v145, v145
v_lshlrev_b32 v145, 16, v138
v_sqrt_f32 v141, v141
v_sqrt_f32 v145, v145
v_sub_f32 v132, 0, v132
v_sub_f32 v136, 0, v136
v_cvt_pk_bf16_f32 v134, v141, v132
v_cvt_pk_bf16_f32 v138, v145, v136
v_lshlrev_b32 v76, 16, v134
v_lshlrev_b32 v77, 16, v138
v_cndmask_b32 v60, 0, v134, s[18:19]
v_cndmask_b32 v63, 0, v134, s[18:19]
v_cndmask_b32 v64, 0, v138, s[18:19]
v_cndmask_b32 v67, 0, v138, s[18:19]
v_rcp_f32 v58, v76
v_rcp_f32 v59, v77
R_mod:
v_mfma_f32_16x16x16_bf16 v[224:227], v[164:165], v[60:61], 0
v_mfma_f32_16x16x16_bf16 v[228:231], v[164:165], v[62:63], 0
v_mfma_f32_16x16x16_bf16 v[224:227], v[160:161], a[0:1], v[224:227]
v_mfma_f32_16x16x16_bf16 v[228:231], v[162:163], a[2:3], v[228:231]
v_mfma_f32_16x16x16_bf16 v[232:235], v[164:165], v[64:65], 0
v_mfma_f32_16x16x16_bf16 v[236:239], v[164:165], v[66:67], 0
v_mfma_f32_16x16x16_bf16 v[232:235], v[160:161], a[4:5], v[232:235]
v_mfma_f32_16x16x16_bf16 v[236:239], v[162:163], a[6:7], v[236:239]
s_add_u32 m0, s76, 102400
s_add_u32 s77, s82, 0xc0800
buffer_load_dwordx4 v22, s[32:35], s77 offen offset:0 lds
buffer_load_dwordx4 v23, s[32:35], s77 offen offset:1024 lds
buffer_load_dwordx4 v24, s[32:35], s77 offen offset:2048 lds
buffer_load_dwordx4 v25, s[32:35], s77 offen offset:3072 lds
v_mfma_f32_16x16x16_bf16 v[240:243], v[172:173], v[60:61], 0
v_cvt_pk_bf16_f32 v224, v224, v225
v_cvt_pk_bf16_f32 v225, v226, v227
v_mfma_f32_16x16x16_bf16 v[244:247], v[172:173], v[62:63], 0
v_cvt_pk_bf16_f32 v228, v228, v229
v_cvt_pk_bf16_f32 v229, v230, v231
ds_read_b128 v[160:163], v204 offset:1088
v_mfma_f32_16x16x16_bf16 v[240:243], v[168:169], a[8:9], v[240:243]
v_accvgpr_write_b32 a0, v224
v_accvgpr_write_b32 a1, v225
v_mfma_f32_16x16x16_bf16 v[244:247], v[170:171], a[10:11], v[244:247]
v_accvgpr_write_b32 a2, v228
v_accvgpr_write_b32 a3, v229
v_mfma_f32_16x16x16_bf16 v[208:211], v[172:173], v[64:65], 0
v_cvt_pk_bf16_f32 v232, v232, v233
v_cvt_pk_bf16_f32 v233, v234, v235
v_mfma_f32_16x16x16_bf16 v[212:215], v[172:173], v[66:67], 0
v_cvt_pk_bf16_f32 v236, v236, v237
v_cvt_pk_bf16_f32 v237, v238, v239
ds_read_b64 v[164:165], v205 offset:512
v_mfma_f32_16x16x16_bf16 v[208:211], v[168:169], a[12:13], v[208:211]
v_accvgpr_write_b32 a4, v232
v_accvgpr_write_b32 a5, v233
v_mfma_f32_16x16x16_bf16 v[212:215], v[170:171], a[14:15], v[212:215]
v_accvgpr_write_b32 a6, v236
v_accvgpr_write_b32 a7, v237
v_mfma_f32_16x16x16_bf16 v[224:227], v[180:181], v[60:61], 0
v_cvt_pk_bf16_f32 v240, v240, v241
v_cvt_pk_bf16_f32 v241, v242, v243
v_mfma_f32_16x16x16_bf16 v[228:231], v[180:181], v[62:63], 0
v_cvt_pk_bf16_f32 v244, v244, v245
v_cvt_pk_bf16_f32 v245, v246, v247
ds_read_b128 v[168:171], v204 offset:1360
v_mfma_f32_16x16x16_bf16 v[224:227], v[176:177], a[16:17], v[224:227]
v_accvgpr_write_b32 a8, v240
v_accvgpr_write_b32 a9, v241
v_mfma_f32_16x16x16_bf16 v[228:231], v[178:179], a[18:19], v[228:231]
v_accvgpr_write_b32 a10, v244
v_accvgpr_write_b32 a11, v245
v_mfma_f32_16x16x16_bf16 v[232:235], v[180:181], v[64:65], 0
v_cvt_pk_bf16_f32 v208, v208, v209
v_cvt_pk_bf16_f32 v209, v210, v211
v_mfma_f32_16x16x16_bf16 v[236:239], v[180:181], v[66:67], 0
v_cvt_pk_bf16_f32 v212, v212, v213
v_cvt_pk_bf16_f32 v213, v214, v215
ds_read_b64 v[172:173], v205 offset:640
v_mfma_f32_16x16x16_bf16 v[232:235], v[176:177], a[20:21], v[232:235]
v_accvgpr_write_b32 a12, v208
v_accvgpr_write_b32 a13, v209
v_mfma_f32_16x16x16_bf16 v[236:239], v[178:179], a[22:23], v[236:239]
v_accvgpr_write_b32 a14, v212
v_accvgpr_write_b32 a15, v213
s_add_u32 m0, s76, 0
s_add_u32 s77, s82, 0x180800
buffer_load_dwordx4 v22, s[32:35], s77 offen offset:0 lds
buffer_load_dwordx4 v23, s[32:35], s77 offen offset:1024 lds
buffer_load_dwordx4 v24, s[32:35], s77 offen offset:2048 lds
buffer_load_dwordx4 v25, s[32:35], s77 offen offset:3072 lds
v_mfma_f32_16x16x16_bf16 v[240:243], v[188:189], v[60:61], 0
v_cvt_pk_bf16_f32 v224, v224, v225
v_cvt_pk_bf16_f32 v225, v226, v227
v_mfma_f32_16x16x16_bf16 v[244:247], v[188:189], v[62:63], 0
v_cvt_pk_bf16_f32 v228, v228, v229
v_cvt_pk_bf16_f32 v229, v230, v231
ds_read_b128 v[176:179], v204 offset:1632
v_mfma_f32_16x16x16_bf16 v[240:243], v[184:185], a[24:25], v[240:243]
v_accvgpr_write_b32 a16, v224
v_accvgpr_write_b32 a17, v225
v_mfma_f32_16x16x16_bf16 v[244:247], v[186:187], a[26:27], v[244:247]
v_accvgpr_write_b32 a18, v228
v_accvgpr_write_b32 a19, v229
v_mfma_f32_16x16x16_bf16 v[208:211], v[188:189], v[64:65], 0
v_cvt_pk_bf16_f32 v232, v232, v233
v_cvt_pk_bf16_f32 v233, v234, v235
v_mfma_f32_16x16x16_bf16 v[212:215], v[188:189], v[66:67], 0
v_cvt_pk_bf16_f32 v236, v236, v237
v_cvt_pk_bf16_f32 v237, v238, v239
ds_read_b64 v[180:181], v205 offset:768
v_mfma_f32_16x16x16_bf16 v[208:211], v[184:185], a[28:29], v[208:211]
v_accvgpr_write_b32 a20, v232
v_accvgpr_write_b32 a21, v233
v_mfma_f32_16x16x16_bf16 v[212:215], v[186:187], a[30:31], v[212:215]
v_accvgpr_write_b32 a22, v236
v_accvgpr_write_b32 a23, v237
s_waitcnt lgkmcnt(4)
v_mfma_f32_16x16x16_bf16 v[224:227], v[164:165], v[60:61], 0
v_cvt_pk_bf16_f32 v240, v240, v241
v_cvt_pk_bf16_f32 v241, v242, v243
v_mfma_f32_16x16x16_bf16 v[228:231], v[164:165], v[62:63], 0
v_cvt_pk_bf16_f32 v244, v244, v245
v_cvt_pk_bf16_f32 v245, v246, v247
ds_read_b128 v[184:187], v204 offset:1904
v_mfma_f32_16x16x16_bf16 v[224:227], v[160:161], a[32:33], v[224:227]
v_accvgpr_write_b32 a24, v240
v_accvgpr_write_b32 a25, v241
v_mfma_f32_16x16x16_bf16 v[228:231], v[162:163], a[34:35], v[228:231]
v_accvgpr_write_b32 a26, v244
v_accvgpr_write_b32 a27, v245
v_mfma_f32_16x16x16_bf16 v[232:235], v[164:165], v[64:65], 0
v_cvt_pk_bf16_f32 v208, v208, v209
v_cvt_pk_bf16_f32 v209, v210, v211
v_mfma_f32_16x16x16_bf16 v[236:239], v[164:165], v[66:67], 0
v_cvt_pk_bf16_f32 v212, v212, v213
v_cvt_pk_bf16_f32 v213, v214, v215
ds_read_b64 v[188:189], v205 offset:896
v_mfma_f32_16x16x16_bf16 v[232:235], v[160:161], a[36:37], v[232:235]
v_accvgpr_write_b32 a28, v208
v_accvgpr_write_b32 a29, v209
v_mfma_f32_16x16x16_bf16 v[236:239], v[162:163], a[38:39], v[236:239]
v_accvgpr_write_b32 a30, v212
v_accvgpr_write_b32 a31, v213
s_add_u32 m0, s76, 4096
s_add_u32 s77, s82, 0x240800
buffer_load_dwordx4 v22, s[32:35], s77 offen offset:0 lds
buffer_load_dwordx4 v23, s[32:35], s77 offen offset:1024 lds
buffer_load_dwordx4 v24, s[32:35], s77 offen offset:2048 lds
buffer_load_dwordx4 v25, s[32:35], s77 offen offset:3072 lds
s_waitcnt lgkmcnt(4)
v_mfma_f32_16x16x16_bf16 v[240:243], v[172:173], v[60:61], 0
v_cvt_pk_bf16_f32 v224, v224, v225
v_cvt_pk_bf16_f32 v225, v226, v227
v_mfma_f32_16x16x16_bf16 v[244:247], v[172:173], v[62:63], 0
v_cvt_pk_bf16_f32 v228, v228, v229
v_cvt_pk_bf16_f32 v229, v230, v231
ds_read_b128 v[160:163], v204 offset:2176
v_mfma_f32_16x16x16_bf16 v[240:243], v[168:169], a[40:41], v[240:243]
v_accvgpr_write_b32 a32, v224
v_accvgpr_write_b32 a33, v225
v_mfma_f32_16x16x16_bf16 v[244:247], v[170:171], a[42:43], v[244:247]
v_accvgpr_write_b32 a34, v228
v_accvgpr_write_b32 a35, v229
v_mfma_f32_16x16x16_bf16 v[208:211], v[172:173], v[64:65], 0
v_cvt_pk_bf16_f32 v232, v232, v233
v_cvt_pk_bf16_f32 v233, v234, v235
v_mfma_f32_16x16x16_bf16 v[212:215], v[172:173], v[66:67], 0
v_cvt_pk_bf16_f32 v236, v236, v237
v_cvt_pk_bf16_f32 v237, v238, v239
ds_read_b64 v[164:165], v205 offset:1024
v_mfma_f32_16x16x16_bf16 v[208:211], v[168:169], a[44:45], v[208:211]
v_accvgpr_write_b32 a36, v232
v_accvgpr_write_b32 a37, v233
v_mfma_f32_16x16x16_bf16 v[212:215], v[170:171], a[46:47], v[212:215]
v_accvgpr_write_b32 a38, v236
v_accvgpr_write_b32 a39, v237
s_waitcnt vmcnt(8) lgkmcnt(0)
s_barrier
ds_read_b64_tr_b16 v[80:81], v14 offset:32768
ds_read_b64_tr_b16 v[82:83], v14 offset:49152
ds_read_b64_tr_b16 v[84:85], v15 offset:32768
ds_read_b64_tr_b16 v[86:87], v15 offset:49152
ds_read_b64_tr_b16 v[88:89], v16 offset:32768
ds_read_b64_tr_b16 v[90:91], v16 offset:49152
ds_read_b64_tr_b16 v[92:93], v17 offset:32768
ds_read_b64_tr_b16 v[94:95], v17 offset:49152
ds_read_b64_tr_b16 v[96:97], v14 offset:33792
ds_read_b64_tr_b16 v[98:99], v14 offset:50176
ds_read_b64_tr_b16 v[100:101], v15 offset:33792
ds_read_b64_tr_b16 v[102:103], v15 offset:50176
S_K:
s_waitcnt lgkmcnt(10)
v_mfma_f32_16x16x32_bf16 v[128:131], v[80:83], a[0:3], 0
ds_read_b64_tr_b16 v[104:105], v16 offset:33792
s_add_u32 m0, s76, 32768
v_mfma_f32_16x16x32_bf16 v[144:147], v[80:83], a[4:7], 0
ds_read_b64_tr_b16 v[106:107], v16 offset:50176
s_waitcnt lgkmcnt(10)
v_mfma_f32_16x16x32_bf16 v[132:135], v[84:87], a[0:3], 0
ds_read_b64_tr_b16 v[108:109], v17 offset:33792
s_add_u32 s77, s82, 0x300800
v_mfma_f32_16x16x32_bf16 v[148:151], v[84:87], a[4:7], 0
ds_read_b64_tr_b16 v[110:111], v17 offset:50176
s_waitcnt lgkmcnt(10)
v_mfma_f32_16x16x32_bf16 v[136:139], v[88:91], a[0:3], 0
buffer_load_dwordx4 v22, s[32:35], s77 offen offset:0 lds
v_mfma_f32_16x16x32_bf16 v[152:155], v[88:91], a[4:7], 0
ds_read_b64_tr_b16 v[112:113], v14 offset:34816
s_waitcnt lgkmcnt(5)
v_mfma_f32_16x16x32_bf16 v[140:143], v[92:95], a[0:3], 0
s_add_u32 s70, s0, S_V - K_pc + 0
s_addc_u32 s71, s1, 0
global_load_dword v57, v9, s[70:71]
v_mfma_f32_16x16x32_bf16 v[156:159], v[92:95], a[4:7], 0
ds_read_b64_tr_b16 v[114:115], v14 offset:51200
ds_read_b64_tr_b16 v[116:117], v15 offset:34816
v_mfma_f32_16x16x16_bf16 v[224:227], v[180:181], v[60:61], 0
ds_read_b64_tr_b16 v[118:119], v15 offset:51200
ds_read_b128 v[168:171], v204 offset:2448
v_mfma_f32_16x16x16_bf16 v[228:231], v[180:181], v[62:63], 0
ds_read_b64_tr_b16 v[120:121], v16 offset:34816
ds_read_b64 v[172:173], v205 offset:1152
v_mfma_f32_16x16x16_bf16 v[224:227], v[176:177], a[48:49], v[224:227]
buffer_load_dwordx4 v23, s[32:35], s77 offen offset:1024 lds
v_mfma_f32_16x16x16_bf16 v[228:231], v[178:179], a[50:51], v[228:231]
ds_read_b64_tr_b16 v[122:123], v16 offset:51200
v_cvt_pk_bf16_f32 v240, v240, v241
v_mfma_f32_16x16x16_bf16 v[232:235], v[180:181], v[64:65], 0
ds_read_b64_tr_b16 v[124:125], v17 offset:34816
v_cvt_pk_bf16_f32 v241, v242, v243
v_mfma_f32_16x16x16_bf16 v[236:239], v[180:181], v[66:67], 0
ds_read_b64_tr_b16 v[126:127], v17 offset:51200
v_cvt_pk_bf16_f32 v244, v244, v245
v_mfma_f32_16x16x16_bf16 v[232:235], v[176:177], a[52:53], v[232:235]
ds_read_b64_tr_b16 v[80:81], v14 offset:35840
v_cvt_pk_bf16_f32 v245, v246, v247
v_mfma_f32_16x16x16_bf16 v[236:239], v[178:179], a[54:55], v[236:239]
ds_read_b64_tr_b16 v[82:83], v14 offset:52224
v_accvgpr_write_b32 a40, v240
v_mfma_f32_16x16x32_bf16 v[128:131], v[96:99], a[8:11], v[128:131]
buffer_load_dwordx4 v24, s[32:35], s77 offen offset:2048 lds
v_mfma_f32_16x16x32_bf16 v[144:147], v[96:99], a[12:15], v[144:147]
ds_read_b64_tr_b16 v[84:85], v15 offset:35840
v_accvgpr_write_b32 a41, v241
v_mfma_f32_16x16x32_bf16 v[132:135], v[100:103], a[8:11], v[132:135]
ds_read_b64_tr_b16 v[86:87], v15 offset:52224
v_accvgpr_write_b32 a42, v244
v_mfma_f32_16x16x32_bf16 v[148:151], v[100:103], a[12:15], v[148:151]
ds_read_b64_tr_b16 v[88:89], v16 offset:35840
s_waitcnt lgkmcnt(5)
v_mfma_f32_16x16x32_bf16 v[136:139], v[104:107], a[8:11], v[136:139]
ds_read_b64_tr_b16 v[90:91], v16 offset:52224
v_accvgpr_write_b32 a43, v245
v_mfma_f32_16x16x32_bf16 v[152:155], v[104:107], a[12:15], v[152:155]
ds_read_b64_tr_b16 v[92:93], v17 offset:35840
v_cvt_pk_bf16_f32 v208, v208, v209
v_cvt_pk_bf16_f32 v209, v210, v211
v_cvt_pk_bf16_f32 v212, v212, v213
v_cvt_pk_bf16_f32 v213, v214, v215
v_accvgpr_write_b32 a44, v208
v_accvgpr_write_b32 a45, v209
v_accvgpr_write_b32 a46, v212
v_accvgpr_write_b32 a47, v213
v_mfma_f32_16x16x32_bf16 v[140:143], v[108:111], a[8:11], v[140:143]
buffer_load_dwordx4 v25, s[32:35], s77 offen offset:3072 lds
v_mfma_f32_16x16x32_bf16 v[156:159], v[108:111], a[12:15], v[156:159]
ds_read_b64_tr_b16 v[94:95], v17 offset:52224
ds_read_b128 v[176:179], v204 offset:2720
v_mfma_f32_16x16x16_bf16 v[240:243], v[188:189], v[60:61], 0
ds_read_b64_tr_b16 v[96:97], v14 offset:36864
ds_read_b64 v[180:181], v205 offset:1280
v_mfma_f32_16x16x16_bf16 v[244:247], v[188:189], v[62:63], 0
ds_read_b64_tr_b16 v[98:99], v14 offset:53248
s_add_u32 m0, s76, 36864
v_mfma_f32_16x16x16_bf16 v[240:243], v[184:185], a[56:57], v[240:243]
ds_read_b64_tr_b16 v[100:101], v15 offset:36864
s_add_u32 s77, s82, 0x3c0800
v_mfma_f32_16x16x16_bf16 v[244:247], v[186:187], a[58:59], v[244:247]
ds_read_b64_tr_b16 v[102:103], v15 offset:53248
v_cvt_pk_bf16_f32 v224, v224, v225
v_mfma_f32_16x16x16_bf16 v[208:211], v[188:189], v[64:65], 0
buffer_load_dwordx4 v22, s[32:35], s77 offen offset:0 lds
v_mfma_f32_16x16x16_bf16 v[212:215], v[188:189], v[66:67], 0
ds_read_b64_tr_b16 v[104:105], v16 offset:36864
v_cvt_pk_bf16_f32 v225, v226, v227
v_mfma_f32_16x16x16_bf16 v[208:211], v[184:185], a[60:61], v[208:211]
v_cvt_pk_bf16_f32 v228, v228, v229
v_cvt_pk_bf16_f32 v229, v230, v231
v_mfma_f32_16x16x16_bf16 v[212:215], v[186:187], a[62:63], v[212:215]
ds_read_b64_tr_b16 v[106:107], v16 offset:53248
v_accvgpr_write_b32 a48, v224
v_mfma_f32_16x16x32_bf16 v[128:131], v[112:115], a[16:19], v[128:131]
ds_read_b64_tr_b16 v[108:109], v17 offset:36864
v_accvgpr_write_b32 a49, v225
v_mfma_f32_16x16x32_bf16 v[144:147], v[112:115], a[20:23], v[144:147]
ds_read_b64_tr_b16 v[110:111], v17 offset:53248
v_accvgpr_write_b32 a50, v228
v_mfma_f32_16x16x32_bf16 v[132:135], v[116:119], a[16:19], v[132:135]
buffer_load_dwordx4 v23, s[32:35], s77 offen offset:1024 lds
v_mfma_f32_16x16x32_bf16 v[148:151], v[116:119], a[20:23], v[148:151]
ds_read_b64_tr_b16 v[112:113], v14 offset:37888
v_accvgpr_write_b32 a51, v229
v_mfma_f32_16x16x32_bf16 v[136:139], v[120:123], a[16:19], v[136:139]
ds_read_b64_tr_b16 v[114:115], v14 offset:54272
v_cvt_pk_bf16_f32 v232, v232, v233
v_mfma_f32_16x16x32_bf16 v[152:155], v[120:123], a[20:23], v[152:155]
ds_read_b64_tr_b16 v[116:117], v15 offset:37888
v_cvt_pk_bf16_f32 v233, v234, v235
v_cvt_pk_bf16_f32 v236, v236, v237
v_cvt_pk_bf16_f32 v237, v238, v239
v_accvgpr_write_b32 a52, v232
v_accvgpr_write_b32 a53, v233
v_accvgpr_write_b32 a54, v236
v_accvgpr_write_b32 a55, v237
v_mfma_f32_16x16x32_bf16 v[140:143], v[124:127], a[16:19], v[140:143]
ds_read_b64_tr_b16 v[118:119], v15 offset:54272
ds_read_b128 v[184:187], v204 offset:2992
v_mfma_f32_16x16x32_bf16 v[156:159], v[124:127], a[20:23], v[156:159]
ds_read_b64_tr_b16 v[120:121], v16 offset:37888
ds_read_b64 v[188:189], v205 offset:1408
v_mfma_f32_16x16x16_bf16 v[224:227], v[164:165], v[60:61], 0
buffer_load_dwordx4 v24, s[32:35], s77 offen offset:2048 lds
v_mfma_f32_16x16x16_bf16 v[228:231], v[164:165], v[62:63], 0
v_cvt_pk_bf16_f32 v240, v240, v241
v_cvt_pk_bf16_f32 v241, v242, v243
v_mfma_f32_16x16x16_bf16 v[224:227], v[160:161], a[64:65], v[224:227]
v_cvt_pk_bf16_f32 v244, v244, v245
v_cvt_pk_bf16_f32 v245, v246, v247
v_mfma_f32_16x16x16_bf16 v[228:231], v[162:163], a[66:67], v[228:231]
v_accvgpr_write_b32 a56, v240
v_accvgpr_write_b32 a57, v241
v_mfma_f32_16x16x16_bf16 v[232:235], v[164:165], v[64:65], 0
v_accvgpr_write_b32 a58, v244
v_accvgpr_write_b32 a59, v245
v_mfma_f32_16x16x16_bf16 v[236:239], v[164:165], v[66:67], 0
v_cvt_pk_bf16_f32 v208, v208, v209
v_cvt_pk_bf16_f32 v209, v210, v211
v_mfma_f32_16x16x16_bf16 v[232:235], v[160:161], a[68:69], v[232:235]
buffer_load_dwordx4 v25, s[32:35], s77 offen offset:3072 lds
v_mfma_f32_16x16x16_bf16 v[236:239], v[162:163], a[70:71], v[236:239]
ds_read_b64_tr_b16 v[122:123], v16 offset:54272
s_waitcnt lgkmcnt(1)
v_mfma_f32_16x16x32_bf16 v[128:131], v[80:83], a[24:27], v[128:131]
ds_read_b64_tr_b16 v[124:125], v17 offset:37888
v_cvt_pk_bf16_f32 v212, v212, v213
v_mfma_f32_16x16x32_bf16 v[144:147], v[80:83], a[28:31], v[144:147]
ds_read_b64_tr_b16 v[126:127], v17 offset:54272
v_cvt_pk_bf16_f32 v213, v214, v215
v_mfma_f32_16x16x32_bf16 v[132:135], v[84:87], a[24:27], v[132:135]
ds_read_b64_tr_b16 v[80:81], v14 offset:38912
v_accvgpr_write_b32 a60, v208
v_mfma_f32_16x16x32_bf16 v[148:151], v[84:87], a[28:31], v[148:151]
ds_read_b64_tr_b16 v[82:83], v14 offset:55296
s_add_u32 m0, s76, 65536
v_mfma_f32_16x16x32_bf16 v[136:139], v[88:91], a[24:27], v[136:139]
ds_read_b64_tr_b16 v[84:85], v15 offset:38912
s_add_u32 s77, s82, 0x480800
v_mfma_f32_16x16x32_bf16 v[152:155], v[88:91], a[28:31], v[152:155]
ds_read_b64_tr_b16 v[86:87], v15 offset:55296
v_accvgpr_write_b32 a61, v209
v_accvgpr_write_b32 a62, v212
v_accvgpr_write_b32 a63, v213
v_mfma_f32_16x16x32_bf16 v[140:143], v[92:95], a[24:27], v[140:143]
buffer_load_dwordx4 v22, s[32:35], s77 offen offset:0 lds
v_mfma_f32_16x16x32_bf16 v[156:159], v[92:95], a[28:31], v[156:159]
ds_read_b64_tr_b16 v[88:89], v16 offset:38912
ds_read_b128 v[160:163], v204 offset:3264
v_mfma_f32_16x16x16_bf16 v[240:243], v[172:173], v[60:61], 0
ds_read_b64 v[164:165], v205 offset:1536
v_cvt_pk_bf16_f32 v224, v224, v225
v_mfma_f32_16x16x16_bf16 v[244:247], v[172:173], v[62:63], 0
v_cvt_pk_bf16_f32 v225, v226, v227
v_cvt_pk_bf16_f32 v228, v228, v229
v_mfma_f32_16x16x16_bf16 v[240:243], v[168:169], a[72:73], v[240:243]
v_cvt_pk_bf16_f32 v229, v230, v231
v_accvgpr_write_b32 a64, v224
v_mfma_f32_16x16x16_bf16 v[244:247], v[170:171], a[74:75], v[244:247]
v_accvgpr_write_b32 a65, v225
v_accvgpr_write_b32 a66, v228
v_mfma_f32_16x16x16_bf16 v[208:211], v[172:173], v[64:65], 0
v_accvgpr_write_b32 a67, v229
v_cvt_pk_bf16_f32 v232, v232, v233
v_mfma_f32_16x16x16_bf16 v[212:215], v[172:173], v[66:67], 0
v_cvt_pk_bf16_f32 v233, v234, v235
v_cvt_pk_bf16_f32 v236, v236, v237
v_mfma_f32_16x16x16_bf16 v[208:211], v[168:169], a[76:77], v[208:211]
buffer_load_dwordx4 v23, s[32:35], s77 offen offset:1024 lds
v_mfma_f32_16x16x16_bf16 v[212:215], v[170:171], a[78:79], v[212:215]
ds_read_b64_tr_b16 v[90:91], v16 offset:55296
v_cvt_pk_bf16_f32 v237, v238, v239
v_mfma_f32_16x16x32_bf16 v[128:131], v[96:99], a[32:35], v[128:131]
ds_read_b64_tr_b16 v[92:93], v17 offset:38912
v_accvgpr_write_b32 a68, v232
v_mfma_f32_16x16x32_bf16 v[144:147], v[96:99], a[36:39], v[144:147]
ds_read_b64_tr_b16 v[94:95], v17 offset:55296
v_accvgpr_write_b32 a69, v233
v_mfma_f32_16x16x32_bf16 v[132:135], v[100:103], a[32:35], v[132:135]
ds_read_b64_tr_b16 v[96:97], v14 offset:39936
v_accvgpr_write_b32 a70, v236
v_mfma_f32_16x16x32_bf16 v[148:151], v[100:103], a[36:39], v[148:151]
ds_read_b64_tr_b16 v[98:99], v14 offset:56320
v_accvgpr_write_b32 a71, v237
v_mfma_f32_16x16x32_bf16 v[136:139], v[104:107], a[32:35], v[136:139]
ds_read_b64_tr_b16 v[100:101], v15 offset:39936
ds_read_b128 v[168:171], v204 offset:3536
v_mfma_f32_16x16x32_bf16 v[152:155], v[104:107], a[36:39], v[152:155]
ds_read_b64_tr_b16 v[102:103], v15 offset:56320
ds_read_b64 v[172:173], v205 offset:1664
v_mfma_f32_16x16x32_bf16 v[140:143], v[108:111], a[32:35], v[140:143]
buffer_load_dwordx4 v24, s[32:35], s77 offen offset:2048 lds
v_mfma_f32_16x16x32_bf16 v[156:159], v[108:111], a[36:39], v[156:159]
ds_read_b64_tr_b16 v[104:105], v16 offset:39936
v_cvt_pk_bf16_f32 v240, v240, v241
v_mfma_f32_16x16x16_bf16 v[224:227], v[180:181], v[60:61], 0
v_cvt_pk_bf16_f32 v241, v242, v243
v_cvt_pk_bf16_f32 v244, v244, v245
v_mfma_f32_16x16x16_bf16 v[228:231], v[180:181], v[62:63], 0
v_cvt_pk_bf16_f32 v245, v246, v247
v_accvgpr_write_b32 a72, v240
v_mfma_f32_16x16x16_bf16 v[224:227], v[176:177], a[80:81], v[224:227]
v_accvgpr_write_b32 a73, v241
v_accvgpr_write_b32 a74, v244
v_mfma_f32_16x16x16_bf16 v[228:231], v[178:179], a[82:83], v[228:231]
v_accvgpr_write_b32 a75, v245
v_cvt_pk_bf16_f32 v208, v208, v209
v_mfma_f32_16x16x16_bf16 v[232:235], v[180:181], v[64:65], 0
v_cvt_pk_bf16_f32 v209, v210, v211
v_cvt_pk_bf16_f32 v212, v212, v213
v_mfma_f32_16x16x16_bf16 v[236:239], v[180:181], v[66:67], 0
v_cvt_pk_bf16_f32 v213, v214, v215
v_accvgpr_write_b32 a76, v208
v_mfma_f32_16x16x16_bf16 v[232:235], v[176:177], a[84:85], v[232:235]
buffer_load_dwordx4 v25, s[32:35], s77 offen offset:3072 lds
v_mfma_f32_16x16x16_bf16 v[236:239], v[178:179], a[86:87], v[236:239]
ds_read_b64_tr_b16 v[106:107], v16 offset:56320
s_mul_i32 s3, s101, 6144
v_mfma_f32_16x16x32_bf16 v[128:131], v[112:115], a[40:43], v[128:131]
ds_read_b64_tr_b16 v[108:109], v17 offset:39936
s_add_u32 s3, s3, 0x1000
v_mfma_f32_16x16x32_bf16 v[144:147], v[112:115], a[44:47], v[144:147]
buffer_load_dword v57, v8, s[32:35], s3 offen
v_mfma_f32_16x16x32_bf16 v[132:135], v[116:119], a[40:43], v[132:135]
ds_read_b64_tr_b16 v[110:111], v17 offset:56320
s_movk_i32 s3, 4096
v_mfma_f32_16x16x32_bf16 v[148:151], v[116:119], a[44:47], v[148:151]
s_add_u32 m0, s76, 69632
s_waitcnt lgkmcnt(3)
v_mfma_f32_16x16x32_bf16 v[136:139], v[120:123], a[40:43], v[136:139]
s_add_u32 s77, s82, 0x540800
v_accvgpr_write_b32 a77, v209
v_mfma_f32_16x16x32_bf16 v[152:155], v[120:123], a[44:47], v[152:155]
buffer_load_dword v57, v56, s[32:35], s3 offen
v_accvgpr_write_b32 a78, v212
v_accvgpr_write_b32 a79, v213
v_mfma_f32_16x16x32_bf16 v[140:143], v[124:127], a[40:43], v[140:143]
v_mfma_f32_16x16x32_bf16 v[156:159], v[124:127], a[44:47], v[156:159]
s_waitcnt vmcnt(15) lgkmcnt(0)
s_barrier
v_mfma_f32_16x16x16_bf16 v[240:243], v[188:189], v[60:61], 0
buffer_load_dwordx4 v22, s[32:35], s77 offen offset:0 lds
v_mfma_f32_16x16x16_bf16 v[244:247], v[188:189], v[62:63], 0
ds_read_b64_tr_b16 v[112:113], v10 offset:0
ds_read_b128 v[176:179], v204 offset:3808
v_mfma_f32_16x16x16_bf16 v[240:243], v[184:185], a[88:89], v[240:243]
ds_read_b64_tr_b16 v[114:115], v10 offset:16384
ds_read_b64 v[180:181], v205 offset:1792
v_mfma_f32_16x16x16_bf16 v[244:247], v[186:187], a[90:91], v[244:247]
ds_read_b64_tr_b16 v[116:117], v11 offset:0
v_cvt_pk_bf16_f32 v224, v224, v225
v_mfma_f32_16x16x16_bf16 v[208:211], v[188:189], v[64:65], 0
ds_read_b64_tr_b16 v[118:119], v11 offset:16384
v_cvt_pk_bf16_f32 v225, v226, v227
v_mfma_f32_16x16x16_bf16 v[212:215], v[188:189], v[66:67], 0
ds_read_b64_tr_b16 v[120:121], v12 offset:0
v_cvt_pk_bf16_f32 v228, v228, v229
v_mfma_f32_16x16x16_bf16 v[208:211], v[184:185], a[92:93], v[208:211]
buffer_load_dwordx4 v23, s[32:35], s77 offen offset:1024 lds
v_mfma_f32_16x16x16_bf16 v[212:215], v[186:187], a[94:95], v[212:215]
ds_read_b64_tr_b16 v[122:123], v12 offset:16384
v_cvt_pk_bf16_f32 v229, v230, v231
v_mfma_f32_16x16x32_bf16 v[128:131], v[80:83], a[48:51], v[128:131]
ds_read_b64_tr_b16 v[124:125], v13 offset:0
v_accvgpr_write_b32 a80, v224
v_mfma_f32_16x16x32_bf16 v[144:147], v[80:83], a[52:55], v[144:147]
ds_read_b64_tr_b16 v[126:127], v13 offset:16384
v_accvgpr_write_b32 a81, v225
v_mfma_f32_16x16x32_bf16 v[132:135], v[84:87], a[48:51], v[132:135]
ds_read_b64_tr_b16 v[80:81], v10 offset:1024
v_accvgpr_write_b32 a82, v228
v_mfma_f32_16x16x32_bf16 v[148:151], v[84:87], a[52:55], v[148:151]
ds_read_b64_tr_b16 v[82:83], v10 offset:17408
v_accvgpr_write_b32 a83, v229
v_mfma_f32_16x16x32_bf16 v[136:139], v[88:91], a[48:51], v[136:139]
buffer_load_dwordx4 v24, s[32:35], s77 offen offset:2048 lds
v_mfma_f32_16x16x32_bf16 v[152:155], v[88:91], a[52:55], v[152:155]
ds_read_b64_tr_b16 v[84:85], v11 offset:1024
v_cvt_pk_bf16_f32 v232, v232, v233
v_cvt_pk_bf16_f32 v233, v234, v235
v_cvt_pk_bf16_f32 v236, v236, v237
v_cvt_pk_bf16_f32 v237, v238, v239
v_accvgpr_write_b32 a84, v232
v_accvgpr_write_b32 a85, v233
v_accvgpr_write_b32 a86, v236
v_accvgpr_write_b32 a87, v237
v_mfma_f32_16x16x32_bf16 v[140:143], v[92:95], a[48:51], v[140:143]
ds_read_b64_tr_b16 v[86:87], v11 offset:17408
ds_read_b128 v[184:187], v204 offset:4080
v_mfma_f32_16x16x32_bf16 v[156:159], v[92:95], a[52:55], v[156:159]
ds_read_b64_tr_b16 v[88:89], v12 offset:1024
ds_read_b64 v[188:189], v205 offset:1920
v_mfma_f32_16x16x16_bf16 v[224:227], v[164:165], v[60:61], 0
v_cvt_pk_bf16_f32 v240, v240, v241
v_cvt_pk_bf16_f32 v241, v242, v243
v_mfma_f32_16x16x16_bf16 v[228:231], v[164:165], v[62:63], 0
v_cvt_pk_bf16_f32 v244, v244, v245
v_cvt_pk_bf16_f32 v245, v246, v247
v_mfma_f32_16x16x16_bf16 v[224:227], v[160:161], a[96:97], v[224:227]
buffer_load_dwordx4 v25, s[32:35], s77 offen offset:3072 lds
v_mfma_f32_16x16x16_bf16 v[228:231], v[162:163], a[98:99], v[228:231]
v_accvgpr_write_b32 a88, v240
v_accvgpr_write_b32 a89, v241
v_mfma_f32_16x16x16_bf16 v[232:235], v[164:165], v[64:65], 0
v_accvgpr_write_b32 a90, v244
v_accvgpr_write_b32 a91, v245
v_mfma_f32_16x16x16_bf16 v[236:239], v[164:165], v[66:67], 0
v_cvt_pk_bf16_f32 v208, v208, v209
v_cvt_pk_bf16_f32 v209, v210, v211
v_mfma_f32_16x16x16_bf16 v[232:235], v[160:161], a[100:101], v[232:235]
v_cvt_pk_bf16_f32 v212, v212, v213
v_cvt_pk_bf16_f32 v213, v214, v215
v_mfma_f32_16x16x16_bf16 v[236:239], v[162:163], a[102:103], v[236:239]
ds_read_b64_tr_b16 v[90:91], v12 offset:17408
s_add_u32 m0, s76, 98304
v_mfma_f32_16x16x32_bf16 v[128:131], v[96:99], a[56:59], v[128:131]
ds_read_b64_tr_b16 v[92:93], v13 offset:1024
s_add_u32 s77, s86, 0x0
v_mfma_f32_16x16x32_bf16 v[144:147], v[96:99], a[60:63], v[144:147]
ds_read_b64_tr_b16 v[94:95], v13 offset:17408
v_accvgpr_write_b32 a92, v208
v_mfma_f32_16x16x32_bf16 v[132:135], v[100:103], a[56:59], v[132:135]
buffer_load_dwordx4 v38, s[56:59], s77 offen offset:0 lds
v_mfma_f32_16x16x32_bf16 v[148:151], v[100:103], a[60:63], v[148:151]
ds_read_b64_tr_b16 v[96:97], v10 offset:2048
v_accvgpr_write_b32 a93, v209
v_mfma_f32_16x16x32_bf16 v[136:139], v[104:107], a[56:59], v[136:139]
ds_read_b64_tr_b16 v[98:99], v10 offset:18432
v_accvgpr_write_b32 a94, v212
v_mfma_f32_16x16x32_bf16 v[152:155], v[104:107], a[60:63], v[152:155]
ds_read_b64_tr_b16 v[100:101], v11 offset:2048
v_accvgpr_write_b32 a95, v213
v_mfma_f32_16x16x32_bf16 v[140:143], v[108:111], a[56:59], v[140:143]
ds_read_b64_tr_b16 v[102:103], v11 offset:18432
ds_read_b128 v[160:163], v204 offset:4352
v_mfma_f32_16x16x32_bf16 v[156:159], v[108:111], a[60:63], v[156:159]
ds_read_b64_tr_b16 v[104:105], v12 offset:2048
ds_read_b64 v[164:165], v205 offset:2048
v_mfma_f32_16x16x16_bf16 v[240:243], v[172:173], v[60:61], 0
v_cvt_pk_bf16_f32 v224, v224, v225
v_cvt_pk_bf16_f32 v225, v226, v227
v_mfma_f32_16x16x16_bf16 v[244:247], v[172:173], v[62:63], 0
v_cvt_pk_bf16_f32 v228, v228, v229
v_cvt_pk_bf16_f32 v229, v230, v231
v_mfma_f32_16x16x16_bf16 v[240:243], v[168:169], a[104:105], v[240:243]
buffer_load_dwordx4 v39, s[56:59], s77 offen offset:1024 lds
v_mfma_f32_16x16x16_bf16 v[244:247], v[170:171], a[106:107], v[244:247]
v_accvgpr_write_b32 a96, v224
v_accvgpr_write_b32 a97, v225
v_mfma_f32_16x16x16_bf16 v[208:211], v[172:173], v[64:65], 0
v_accvgpr_write_b32 a98, v228
v_accvgpr_write_b32 a99, v229
v_mfma_f32_16x16x16_bf16 v[212:215], v[172:173], v[66:67], 0
v_cvt_pk_bf16_f32 v232, v232, v233
v_cvt_pk_bf16_f32 v233, v234, v235
v_mfma_f32_16x16x16_bf16 v[208:211], v[168:169], a[108:109], v[208:211]
v_cvt_pk_bf16_f32 v236, v236, v237
v_cvt_pk_bf16_f32 v237, v238, v239
v_mfma_f32_16x16x16_bf16 v[212:215], v[170:171], a[110:111], v[212:215]
ds_read_b64_tr_b16 v[106:107], v12 offset:18432
s_waitcnt lgkmcnt(1)
v_mfma_f32_16x16x32_bf16 v[128:131], v[112:115], a[64:67], v[128:131]
ds_read_b64_tr_b16 v[108:109], v13 offset:2048
v_accvgpr_write_b32 a100, v232
v_mfma_f32_16x16x32_bf16 v[144:147], v[112:115], a[68:71], v[144:147]
ds_read_b64_tr_b16 v[110:111], v13 offset:18432
v_accvgpr_write_b32 a101, v233
v_mfma_f32_16x16x32_bf16 v[132:135], v[116:119], a[64:67], v[132:135]
buffer_load_dwordx4 v40, s[56:59], s77 offen offset:2048 lds
v_mfma_f32_16x16x32_bf16 v[148:151], v[116:119], a[68:71], v[148:151]
ds_read_b64_tr_b16 v[112:113], v10 offset:3072
v_accvgpr_write_b32 a102, v236
v_mfma_f32_16x16x32_bf16 v[136:139], v[120:123], a[64:67], v[136:139]
ds_read_b64_tr_b16 v[114:115], v10 offset:19456
v_accvgpr_write_b32 a103, v237
v_mfma_f32_16x16x32_bf16 v[152:155], v[120:123], a[68:71], v[152:155]
ds_read_b64_tr_b16 v[116:117], v11 offset:3072
ds_read_b128 v[168:171], v204 offset:4624
v_mfma_f32_16x16x32_bf16 v[140:143], v[124:127], a[64:67], v[140:143]
ds_read_b64_tr_b16 v[118:119], v11 offset:19456
ds_read_b64 v[172:173], v205 offset:2176
v_mfma_f32_16x16x32_bf16 v[156:159], v[124:127], a[68:71], v[156:159]
ds_read_b64_tr_b16 v[120:121], v12 offset:3072
v_cvt_pk_bf16_f32 v240, v240, v241
v_mfma_f32_16x16x16_bf16 v[224:227], v[180:181], v[60:61], 0
v_cvt_pk_bf16_f32 v241, v242, v243
v_cvt_pk_bf16_f32 v244, v244, v245
v_mfma_f32_16x16x16_bf16 v[228:231], v[180:181], v[62:63], 0
v_cvt_pk_bf16_f32 v245, v246, v247
v_accvgpr_write_b32 a104, v240
v_mfma_f32_16x16x16_bf16 v[224:227], v[176:177], a[112:113], v[224:227]
buffer_load_dwordx4 v41, s[56:59], s77 offen offset:3072 lds
v_mfma_f32_16x16x16_bf16 v[228:231], v[178:179], a[114:115], v[228:231]
v_accvgpr_write_b32 a105, v241
v_accvgpr_write_b32 a106, v244
v_mfma_f32_16x16x16_bf16 v[232:235], v[180:181], v[64:65], 0
v_accvgpr_write_b32 a107, v245
v_cvt_pk_bf16_f32 v208, v208, v209
v_mfma_f32_16x16x16_bf16 v[236:239], v[180:181], v[66:67], 0
v_cvt_pk_bf16_f32 v209, v210, v211
v_cvt_pk_bf16_f32 v212, v212, v213
v_mfma_f32_16x16x16_bf16 v[232:235], v[176:177], a[116:117], v[232:235]
v_cvt_pk_bf16_f32 v213, v214, v215
v_accvgpr_write_b32 a108, v208
v_mfma_f32_16x16x16_bf16 v[236:239], v[178:179], a[118:119], v[236:239]
ds_read_b64_tr_b16 v[122:123], v12 offset:19456
s_add_u32 m0, s76, 102400
v_mfma_f32_16x16x32_bf16 v[128:131], v[80:83], a[72:75], v[128:131]
ds_read_b64_tr_b16 v[124:125], v13 offset:3072
s_add_u32 s77, s86, 0x180000
v_mfma_f32_16x16x32_bf16 v[144:147], v[80:83], a[76:79], v[144:147]
ds_read_b64_tr_b16 v[126:127], v13 offset:19456
v_accvgpr_write_b32 a109, v209
v_mfma_f32_16x16x32_bf16 v[132:135], v[84:87], a[72:75], v[132:135]
buffer_load_dwordx4 v38, s[56:59], s77 offen offset:0 lds
v_mfma_f32_16x16x32_bf16 v[148:151], v[84:87], a[76:79], v[148:151]
ds_read_b64_tr_b16 v[80:81], v10 offset:4096
v_accvgpr_write_b32 a110, v212
v_mfma_f32_16x16x32_bf16 v[136:139], v[88:91], a[72:75], v[136:139]
ds_read_b64_tr_b16 v[82:83], v10 offset:20480
v_accvgpr_write_b32 a111, v213
v_mfma_f32_16x16x32_bf16 v[152:155], v[88:91], a[76:79], v[152:155]
ds_read_b64_tr_b16 v[84:85], v11 offset:4096
ds_read_b128 v[176:179], v204 offset:4896
v_mfma_f32_16x16x32_bf16 v[140:143], v[92:95], a[72:75], v[140:143]
ds_read_b64_tr_b16 v[86:87], v11 offset:20480
ds_read_b64 v[180:181], v205 offset:2304
v_mfma_f32_16x16x32_bf16 v[156:159], v[92:95], a[76:79], v[156:159]
ds_read_b64_tr_b16 v[88:89], v12 offset:4096
v_cvt_pk_bf16_f32 v224, v224, v225
v_mfma_f32_16x16x16_bf16 v[240:243], v[188:189], v[60:61], 0
v_cvt_pk_bf16_f32 v225, v226, v227
v_cvt_pk_bf16_f32 v228, v228, v229
v_mfma_f32_16x16x16_bf16 v[244:247], v[188:189], v[62:63], 0
v_cvt_pk_bf16_f32 v229, v230, v231
v_accvgpr_write_b32 a112, v224
v_mfma_f32_16x16x16_bf16 v[240:243], v[184:185], a[120:121], v[240:243]
buffer_load_dwordx4 v39, s[56:59], s77 offen offset:1024 lds
v_mfma_f32_16x16x16_bf16 v[244:247], v[186:187], a[122:123], v[244:247]
v_accvgpr_write_b32 a113, v225
v_accvgpr_write_b32 a114, v228
v_mfma_f32_16x16x16_bf16 v[208:211], v[188:189], v[64:65], 0
v_accvgpr_write_b32 a115, v229
v_cvt_pk_bf16_f32 v232, v232, v233
v_mfma_f32_16x16x16_bf16 v[212:215], v[188:189], v[66:67], 0
v_cvt_pk_bf16_f32 v233, v234, v235
v_cvt_pk_bf16_f32 v236, v236, v237
v_mfma_f32_16x16x16_bf16 v[208:211], v[184:185], a[124:125], v[208:211]
v_cvt_pk_bf16_f32 v237, v238, v239
v_accvgpr_write_b32 a116, v232
v_mfma_f32_16x16x16_bf16 v[212:215], v[186:187], a[126:127], v[212:215]
ds_read_b64_tr_b16 v[90:91], v12 offset:20480
v_accvgpr_write_b32 a117, v233
v_mfma_f32_16x16x32_bf16 v[128:131], v[96:99], a[80:83], v[128:131]
ds_read_b64_tr_b16 v[92:93], v13 offset:4096
v_accvgpr_write_b32 a118, v236
v_mfma_f32_16x16x32_bf16 v[144:147], v[96:99], a[84:87], v[144:147]
ds_read_b64_tr_b16 v[94:95], v13 offset:20480
v_accvgpr_write_b32 a119, v237
v_mfma_f32_16x16x32_bf16 v[132:135], v[100:103], a[80:83], v[132:135]
buffer_load_dwordx4 v40, s[56:59], s77 offen offset:2048 lds
v_mfma_f32_16x16x32_bf16 v[148:151], v[100:103], a[84:87], v[148:151]
ds_read_b64_tr_b16 v[96:97], v10 offset:5120
s_waitcnt lgkmcnt(4)
v_mfma_f32_16x16x32_bf16 v[136:139], v[104:107], a[80:83], v[136:139]
ds_read_b64_tr_b16 v[98:99], v10 offset:21504
ds_read_b128 v[184:187], v204 offset:5168
v_mfma_f32_16x16x32_bf16 v[152:155], v[104:107], a[84:87], v[152:155]
ds_read_b64_tr_b16 v[100:101], v11 offset:5120
s_mul_i32 s3, s101, 6144
v_mfma_f32_16x16x32_bf16 v[140:143], v[108:111], a[80:83], v[140:143]
ds_read_b64_tr_b16 v[102:103], v11 offset:21504
s_add_u32 s3, s3, 0x0
v_mfma_f32_16x16x32_bf16 v[156:159], v[108:111], a[84:87], v[156:159]
buffer_load_dword v57, v8, s[32:35], s3 offen
v_mfma_f32_16x16x16_bf16 v[224:227], v[164:165], v[60:61], 0
ds_read_b64_tr_b16 v[104:105], v12 offset:5120
s_movk_i32 s3, 0
v_mfma_f32_16x16x16_bf16 v[228:231], v[164:165], v[62:63], 0
buffer_load_dword v57, v56, s[32:35], s3 offen
v_mfma_f32_16x16x16_bf16 v[224:227], v[160:161], a[128:129], v[224:227]
ds_read_b64 v[188:189], v205 offset:2432
v_cvt_pk_bf16_f32 v240, v240, v241
v_mfma_f32_16x16x16_bf16 v[228:231], v[162:163], a[130:131], v[228:231]
buffer_load_dwordx4 v41, s[56:59], s77 offen offset:3072 lds
v_mfma_f32_16x16x16_bf16 v[232:235], v[164:165], v[64:65], 0
v_cvt_pk_bf16_f32 v241, v242, v243
v_cvt_pk_bf16_f32 v244, v244, v245
v_mfma_f32_16x16x16_bf16 v[236:239], v[164:165], v[66:67], 0
v_cvt_pk_bf16_f32 v245, v246, v247
v_accvgpr_write_b32 a120, v240
v_mfma_f32_16x16x16_bf16 v[232:235], v[160:161], a[132:133], v[232:235]
v_accvgpr_write_b32 a121, v241
v_accvgpr_write_b32 a122, v244
v_mfma_f32_16x16x16_bf16 v[236:239], v[162:163], a[134:135], v[236:239]
ds_read_b64_tr_b16 v[106:107], v12 offset:21504
v_accvgpr_write_b32 a123, v245
v_mfma_f32_16x16x32_bf16 v[128:131], v[112:115], a[88:91], v[128:131]
ds_read_b64_tr_b16 v[108:109], v13 offset:5120
v_cvt_pk_bf16_f32 v208, v208, v209
v_mfma_f32_16x16x32_bf16 v[144:147], v[112:115], a[92:95], v[144:147]
ds_read_b64_tr_b16 v[110:111], v13 offset:21504
v_cvt_pk_bf16_f32 v209, v210, v211
v_mfma_f32_16x16x32_bf16 v[132:135], v[116:119], a[88:91], v[132:135]
ds_read_b64_tr_b16 v[112:113], v10 offset:6144
v_cvt_pk_bf16_f32 v212, v212, v213
v_mfma_f32_16x16x32_bf16 v[148:151], v[116:119], a[92:95], v[148:151]
ds_read_b64_tr_b16 v[114:115], v10 offset:22528
v_cvt_pk_bf16_f32 v213, v214, v215
v_mfma_f32_16x16x32_bf16 v[136:139], v[120:123], a[88:91], v[136:139]
ds_read_b64_tr_b16 v[116:117], v11 offset:6144
v_accvgpr_write_b32 a124, v208
v_mfma_f32_16x16x32_bf16 v[152:155], v[120:123], a[92:95], v[152:155]
ds_read_b64_tr_b16 v[118:119], v11 offset:22528
v_accvgpr_write_b32 a125, v209
v_accvgpr_write_b32 a126, v212
v_accvgpr_write_b32 a127, v213
v_mfma_f32_16x16x32_bf16 v[140:143], v[124:127], a[88:91], v[140:143]
ds_read_b64_tr_b16 v[120:121], v12 offset:6144
ds_read_b128 v[160:163], v204 offset:5440
v_mfma_f32_16x16x32_bf16 v[156:159], v[124:127], a[92:95], v[156:159]
ds_read_b64 v[164:165], v205 offset:2560
v_cvt_pk_bf16_f32 v224, v224, v225
v_mfma_f32_16x16x16_bf16 v[240:243], v[172:173], v[60:61], 0
v_cvt_pk_bf16_f32 v225, v226, v227
v_cvt_pk_bf16_f32 v228, v228, v229
v_mfma_f32_16x16x16_bf16 v[244:247], v[172:173], v[62:63], 0
v_cvt_pk_bf16_f32 v229, v230, v231
v_accvgpr_write_b32 a128, v224
v_mfma_f32_16x16x16_bf16 v[240:243], v[168:169], a[136:137], v[240:243]
v_accvgpr_write_b32 a129, v225
v_accvgpr_write_b32 a130, v228
v_mfma_f32_16x16x16_bf16 v[244:247], v[170:171], a[138:139], v[244:247]
v_accvgpr_write_b32 a131, v229
v_cvt_pk_bf16_f32 v232, v232, v233
v_mfma_f32_16x16x16_bf16 v[208:211], v[172:173], v[64:65], 0
v_cvt_pk_bf16_f32 v233, v234, v235
v_cvt_pk_bf16_f32 v236, v236, v237
v_mfma_f32_16x16x16_bf16 v[212:215], v[172:173], v[66:67], 0
v_cvt_pk_bf16_f32 v237, v238, v239
v_accvgpr_write_b32 a132, v232
v_mfma_f32_16x16x16_bf16 v[208:211], v[168:169], a[140:141], v[208:211]
v_accvgpr_write_b32 a133, v233
v_accvgpr_write_b32 a134, v236
v_mfma_f32_16x16x16_bf16 v[212:215], v[170:171], a[142:143], v[212:215]
ds_read_b64_tr_b16 v[122:123], v12 offset:22528
v_accvgpr_write_b32 a135, v237
v_mfma_f32_16x16x32_bf16 v[128:131], v[80:83], a[96:99], v[128:131]
ds_read_b64_tr_b16 v[124:125], v13 offset:6144
ds_read_b128 v[168:171], v204 offset:5712
v_mfma_f32_16x16x32_bf16 v[144:147], v[80:83], a[100:103], v[144:147]
ds_read_b64_tr_b16 v[126:127], v13 offset:22528
ds_read_b64 v[172:173], v205 offset:2688
v_mfma_f32_16x16x32_bf16 v[132:135], v[84:87], a[96:99], v[132:135]
ds_read_b64_tr_b16 v[80:81], v10 offset:7168
v_cvt_pk_bf16_f32 v240, v240, v241
v_mfma_f32_16x16x32_bf16 v[148:151], v[84:87], a[100:103], v[148:151]
ds_read_b64_tr_b16 v[82:83], v10 offset:23552
s_waitcnt lgkmcnt(7)
v_mfma_f32_16x16x32_bf16 v[136:139], v[88:91], a[96:99], v[136:139]
ds_read_b64_tr_b16 v[84:85], v11 offset:7168
v_cvt_pk_bf16_f32 v241, v242, v243
v_mfma_f32_16x16x32_bf16 v[152:155], v[88:91], a[100:103], v[152:155]
ds_read_b64_tr_b16 v[86:87], v11 offset:23552
v_cvt_pk_bf16_f32 v244, v244, v245
v_mfma_f32_16x16x32_bf16 v[140:143], v[92:95], a[96:99], v[140:143]
ds_read_b64_tr_b16 v[88:89], v12 offset:7168
v_cvt_pk_bf16_f32 v245, v246, v247
v_mfma_f32_16x16x32_bf16 v[156:159], v[92:95], a[100:103], v[156:159]
v_accvgpr_write_b32 a136, v240
v_accvgpr_write_b32 a137, v241
v_mfma_f32_16x16x16_bf16 v[224:227], v[180:181], v[60:61], 0
v_accvgpr_write_b32 a138, v244
v_accvgpr_write_b32 a139, v245
v_mfma_f32_16x16x16_bf16 v[228:231], v[180:181], v[62:63], 0
v_cvt_pk_bf16_f32 v208, v208, v209
v_cvt_pk_bf16_f32 v209, v210, v211
v_mfma_f32_16x16x16_bf16 v[224:227], v[176:177], a[144:145], v[224:227]
v_cvt_pk_bf16_f32 v212, v212, v213
v_cvt_pk_bf16_f32 v213, v214, v215
v_mfma_f32_16x16x16_bf16 v[228:231], v[178:179], a[146:147], v[228:231]
v_accvgpr_write_b32 a140, v208
v_accvgpr_write_b32 a141, v209
v_mfma_f32_16x16x16_bf16 v[232:235], v[180:181], v[64:65], 0
v_accvgpr_write_b32 a142, v212
v_accvgpr_write_b32 a143, v213
v_mfma_f32_16x16x16_bf16 v[236:239], v[180:181], v[66:67], 0
v_mfma_f32_16x16x16_bf16 v[232:235], v[176:177], a[148:149], v[232:235]
v_mfma_f32_16x16x16_bf16 v[236:239], v[178:179], a[150:151], v[236:239]
ds_read_b64_tr_b16 v[90:91], v12 offset:23552
ds_read_b128 v[176:179], v204 offset:5984
v_mfma_f32_16x16x32_bf16 v[128:131], v[96:99], a[104:107], v[128:131]
ds_read_b64_tr_b16 v[92:93], v13 offset:7168
ds_read_b64 v[180:181], v205 offset:2816
v_mfma_f32_16x16x32_bf16 v[144:147], v[96:99], a[108:111], v[144:147]
ds_read_b64_tr_b16 v[94:95], v13 offset:23552
v_cvt_pk_bf16_f32 v224, v224, v225
v_mfma_f32_16x16x32_bf16 v[132:135], v[100:103], a[104:107], v[132:135]
v_cvt_pk_bf16_f32 v225, v226, v227
v_cvt_pk_bf16_f32 v228, v228, v229
v_mfma_f32_16x16x32_bf16 v[148:151], v[100:103], a[108:111], v[148:151]
v_cvt_pk_bf16_f32 v229, v230, v231
v_accvgpr_write_b32 a144, v224
v_mfma_f32_16x16x32_bf16 v[136:139], v[104:107], a[104:107], v[136:139]
v_accvgpr_write_b32 a145, v225
v_accvgpr_write_b32 a146, v228
v_mfma_f32_16x16x32_bf16 v[152:155], v[104:107], a[108:111], v[152:155]
v_accvgpr_write_b32 a147, v229
v_cvt_pk_bf16_f32 v232, v232, v233
v_mfma_f32_16x16x32_bf16 v[140:143], v[108:111], a[104:107], v[140:143]
s_waitcnt vmcnt(20) lgkmcnt(0)
s_barrier
v_mfma_f32_16x16x32_bf16 v[156:159], v[108:111], a[108:111], v[156:159]
ds_read_b64_tr_b16 v[96:97], v10 offset:32768
s_add_u32 m0, s76, 0
v_mfma_f32_16x16x16_bf16 v[240:243], v[188:189], v[60:61], 0
ds_read_b64_tr_b16 v[98:99], v10 offset:49152
s_add_u32 s77, s82, 0x1000
v_mfma_f32_16x16x16_bf16 v[244:247], v[188:189], v[62:63], 0
buffer_load_dwordx4 v22, s[32:35], s77 offen offset:0 lds
v_mfma_f32_16x16x16_bf16 v[240:243], v[184:185], a[152:153], v[240:243]
ds_read_b64_tr_b16 v[100:101], v11 offset:32768
v_cvt_pk_bf16_f32 v233, v234, v235
v_mfma_f32_16x16x16_bf16 v[244:247], v[186:187], a[154:155], v[244:247]
ds_read_b64_tr_b16 v[102:103], v11 offset:49152
v_cvt_pk_bf16_f32 v236, v236, v237
v_mfma_f32_16x16x16_bf16 v[208:211], v[188:189], v[64:65], 0
ds_read_b64_tr_b16 v[104:105], v12 offset:32768
v_cvt_pk_bf16_f32 v237, v238, v239
v_mfma_f32_16x16x16_bf16 v[212:215], v[188:189], v[66:67], 0
v_accvgpr_write_b32 a148, v232
v_accvgpr_write_b32 a149, v233
v_mfma_f32_16x16x16_bf16 v[208:211], v[184:185], a[156:157], v[208:211]
v_accvgpr_write_b32 a150, v236
v_accvgpr_write_b32 a151, v237
v_mfma_f32_16x16x16_bf16 v[212:215], v[186:187], a[158:159], v[212:215]
ds_read_b64_tr_b16 v[106:107], v12 offset:49152
ds_read_b128 v[184:187], v204 offset:6256
v_mfma_f32_16x16x32_bf16 v[128:131], v[112:115], a[112:115], v[128:131]
ds_read_b64_tr_b16 v[108:109], v13 offset:32768
ds_read_b64 v[188:189], v205 offset:2944
v_mfma_f32_16x16x32_bf16 v[144:147], v[112:115], a[116:119], v[144:147]
buffer_load_dwordx4 v23, s[32:35], s77 offen offset:1024 lds
v_mfma_f32_16x16x32_bf16 v[132:135], v[116:119], a[112:115], v[132:135]
ds_read_b64_tr_b16 v[110:111], v13 offset:49152
v_cvt_pk_bf16_f32 v240, v240, v241
v_mfma_f32_16x16x32_bf16 v[148:151], v[116:119], a[116:119], v[148:151]
ds_read_b64_tr_b16 v[112:113], v10 offset:33792
v_cvt_pk_bf16_f32 v241, v242, v243
v_mfma_f32_16x16x32_bf16 v[136:139], v[120:123], a[112:115], v[136:139]
ds_read_b64_tr_b16 v[114:115], v10 offset:50176
v_cvt_pk_bf16_f32 v244, v244, v245
v_mfma_f32_16x16x32_bf16 v[152:155], v[120:123], a[116:119], v[152:155]
ds_read_b64_tr_b16 v[116:117], v11 offset:33792
v_cvt_pk_bf16_f32 v245, v246, v247
v_mfma_f32_16x16x32_bf16 v[140:143], v[124:127], a[112:115], v[140:143]
ds_read_b64_tr_b16 v[118:119], v11 offset:50176
v_accvgpr_write_b32 a152, v240
v_mfma_f32_16x16x32_bf16 v[156:159], v[124:127], a[116:119], v[156:159]
ds_read_b64_tr_b16 v[120:121], v12 offset:33792
v_accvgpr_write_b32 a153, v241
v_mfma_f32_16x16x16_bf16 v[224:227], v[164:165], v[60:61], 0
v_accvgpr_write_b32 a154, v244
v_accvgpr_write_b32 a155, v245
v_mfma_f32_16x16x16_bf16 v[228:231], v[164:165], v[62:63], 0
buffer_load_dwordx4 v24, s[32:35], s77 offen offset:2048 lds
v_mfma_f32_16x16x16_bf16 v[224:227], v[160:161], a[160:161], v[224:227]
v_cvt_pk_bf16_f32 v208, v208, v209
v_cvt_pk_bf16_f32 v209, v210, v211
v_mfma_f32_16x16x16_bf16 v[228:231], v[162:163], a[162:163], v[228:231]
v_cvt_pk_bf16_f32 v212, v212, v213
v_cvt_pk_bf16_f32 v213, v214, v215
v_mfma_f32_16x16x16_bf16 v[232:235], v[164:165], v[64:65], 0
v_accvgpr_write_b32 a156, v208
v_accvgpr_write_b32 a157, v209
v_mfma_f32_16x16x16_bf16 v[236:239], v[164:165], v[66:67], 0
v_accvgpr_write_b32 a158, v212
v_accvgpr_write_b32 a159, v213
v_mfma_f32_16x16x16_bf16 v[232:235], v[160:161], a[164:165], v[232:235]
v_mfma_f32_16x16x16_bf16 v[236:239], v[162:163], a[166:167], v[236:239]
ds_read_b64_tr_b16 v[122:123], v12 offset:50176
ds_read_b128 v[160:163], v204 offset:6528
v_mfma_f32_16x16x32_bf16 v[128:131], v[80:83], a[120:123], v[128:131]
ds_read_b64_tr_b16 v[124:125], v13 offset:33792
ds_read_b64 v[164:165], v205 offset:3072
v_mfma_f32_16x16x32_bf16 v[144:147], v[80:83], a[124:127], v[144:147]
buffer_load_dwordx4 v25, s[32:35], s77 offen offset:3072 lds
v_mfma_f32_16x16x32_bf16 v[132:135], v[84:87], a[120:123], v[132:135]
ds_read_b64_tr_b16 v[126:127], v13 offset:50176
v_cvt_pk_bf16_f32 v224, v224, v225
v_mfma_f32_16x16x32_bf16 v[148:151], v[84:87], a[124:127], v[148:151]
ds_read_b64_tr_b16 v[80:81], v10 offset:34816
v_cvt_pk_bf16_f32 v225, v226, v227
v_mfma_f32_16x16x32_bf16 v[136:139], v[88:91], a[120:123], v[136:139]
ds_read_b64_tr_b16 v[82:83], v10 offset:51200
v_cvt_pk_bf16_f32 v228, v228, v229
v_mfma_f32_16x16x32_bf16 v[152:155], v[88:91], a[124:127], v[152:155]
ds_read_b64_tr_b16 v[84:85], v11 offset:34816
v_cvt_pk_bf16_f32 v229, v230, v231
v_mfma_f32_16x16x32_bf16 v[140:143], v[92:95], a[120:123], v[140:143]
ds_read_b64_tr_b16 v[86:87], v11 offset:51200
s_add_u32 m0, s76, 4096
v_mfma_f32_16x16x32_bf16 v[156:159], v[92:95], a[124:127], v[156:159]
ds_read_b64_tr_b16 v[88:89], v12 offset:34816
s_add_u32 s77, s82, 0xc1000
v_mfma_f32_16x16x16_bf16 v[240:243], v[172:173], v[60:61], 0
v_accvgpr_write_b32 a160, v224
v_accvgpr_write_b32 a161, v225
v_mfma_f32_16x16x16_bf16 v[244:247], v[172:173], v[62:63], 0
buffer_load_dwordx4 v22, s[32:35], s77 offen offset:0 lds
v_mfma_f32_16x16x16_bf16 v[240:243], v[168:169], a[168:169], v[240:243]
v_accvgpr_write_b32 a162, v228
v_accvgpr_write_b32 a163, v229
v_mfma_f32_16x16x16_bf16 v[244:247], v[170:171], a[170:171], v[244:247]
v_cvt_pk_bf16_f32 v232, v232, v233
v_cvt_pk_bf16_f32 v233, v234, v235
v_mfma_f32_16x16x16_bf16 v[208:211], v[172:173], v[64:65], 0
v_cvt_pk_bf16_f32 v236, v236, v237
v_cvt_pk_bf16_f32 v237, v238, v239
v_mfma_f32_16x16x16_bf16 v[212:215], v[172:173], v[66:67], 0
v_accvgpr_write_b32 a164, v232
v_accvgpr_write_b32 a165, v233
v_mfma_f32_16x16x16_bf16 v[208:211], v[168:169], a[172:173], v[208:211]
v_accvgpr_write_b32 a166, v236
v_accvgpr_write_b32 a167, v237
v_mfma_f32_16x16x16_bf16 v[212:215], v[170:171], a[174:175], v[212:215]
ds_read_b64_tr_b16 v[90:91], v12 offset:51200
s_waitcnt lgkmcnt(1)
v_mfma_f32_16x16x32_bf16 v[128:131], v[96:99], a[128:131], v[128:131]
ds_read_b64_tr_b16 v[92:93], v13 offset:34816
ds_read_b128 v[168:171], v204 offset:6800
v_mfma_f32_16x16x32_bf16 v[144:147], v[96:99], a[132:135], v[144:147]
buffer_load_dwordx4 v23, s[32:35], s77 offen offset:1024 lds
v_mfma_f32_16x16x32_bf16 v[132:135], v[100:103], a[128:131], v[132:135]
ds_read_b64_tr_b16 v[94:95], v13 offset:51200
ds_read_b64 v[172:173], v205 offset:3200
v_mfma_f32_16x16x32_bf16 v[148:151], v[100:103], a[132:135], v[148:151]
ds_read_b64_tr_b16 v[96:97], v10 offset:35840
s_mul_i32 s3, s101, 2048
v_mfma_f32_16x16x32_bf16 v[136:139], v[104:107], a[128:131], v[136:139]
ds_read_b64_tr_b16 v[98:99], v10 offset:52224
s_add_u32 s3, s3, 0x0
v_mfma_f32_16x16x32_bf16 v[152:155], v[104:107], a[132:135], v[152:155]
buffer_load_dword v57, v8, s[36:39], s3 offen
v_mfma_f32_16x16x32_bf16 v[140:143], v[108:111], a[128:131], v[140:143]
ds_read_b64_tr_b16 v[100:101], v11 offset:35840
s_mul_i32 s3, s101, 7168
v_mfma_f32_16x16x32_bf16 v[156:159], v[108:111], a[132:135], v[156:159]
ds_read_b64_tr_b16 v[102:103], v11 offset:52224
s_add_u32 s3, s3, 0x800
v_mfma_f32_16x16x16_bf16 v[224:227], v[180:181], v[60:61], 0
buffer_load_dword v57, v8, s[40:43], s3 offen
v_mfma_f32_16x16x16_bf16 v[228:231], v[180:181], v[62:63], 0
ds_read_b64_tr_b16 v[104:105], v12 offset:35840
v_cvt_pk_bf16_f32 v240, v240, v241
v_mfma_f32_16x16x16_bf16 v[224:227], v[176:177], a[176:177], v[224:227]
buffer_load_dwordx4 v24, s[32:35], s77 offen offset:2048 lds
v_mfma_f32_16x16x16_bf16 v[228:231], v[178:179], a[178:179], v[228:231]
v_cvt_pk_bf16_f32 v241, v242, v243
v_cvt_pk_bf16_f32 v244, v244, v245
v_mfma_f32_16x16x16_bf16 v[232:235], v[180:181], v[64:65], 0
v_cvt_pk_bf16_f32 v245, v246, v247
v_accvgpr_write_b32 a168, v240
v_mfma_f32_16x16x16_bf16 v[236:239], v[180:181], v[66:67], 0
v_accvgpr_write_b32 a169, v241
v_accvgpr_write_b32 a170, v244
v_mfma_f32_16x16x16_bf16 v[232:235], v[176:177], a[180:181], v[232:235]
v_accvgpr_write_b32 a171, v245
v_cvt_pk_bf16_f32 v208, v208, v209
v_mfma_f32_16x16x16_bf16 v[236:239], v[178:179], a[182:183], v[236:239]
ds_read_b64_tr_b16 v[106:107], v12 offset:52224
v_cvt_pk_bf16_f32 v209, v210, v211
v_mfma_f32_16x16x32_bf16 v[128:131], v[112:115], a[136:139], v[128:131]
ds_read_b64_tr_b16 v[108:109], v13 offset:35840
v_cvt_pk_bf16_f32 v212, v212, v213
v_mfma_f32_16x16x32_bf16 v[144:147], v[112:115], a[140:143], v[144:147]
ds_read_b64_tr_b16 v[110:111], v13 offset:52224
v_cvt_pk_bf16_f32 v213, v214, v215
v_mfma_f32_16x16x32_bf16 v[132:135], v[116:119], a[136:139], v[132:135]
buffer_load_dwordx4 v25, s[32:35], s77 offen offset:3072 lds
v_mfma_f32_16x16x32_bf16 v[148:151], v[116:119], a[140:143], v[148:151]
ds_read_b64_tr_b16 v[112:113], v10 offset:36864
v_accvgpr_write_b32 a172, v208
v_mfma_f32_16x16x32_bf16 v[136:139], v[120:123], a[136:139], v[136:139]
ds_read_b64_tr_b16 v[114:115], v10 offset:53248
v_accvgpr_write_b32 a173, v209
v_mfma_f32_16x16x32_bf16 v[152:155], v[120:123], a[140:143], v[152:155]
ds_read_b64_tr_b16 v[116:117], v11 offset:36864
v_accvgpr_write_b32 a174, v212
v_accvgpr_write_b32 a175, v213
v_mfma_f32_16x16x32_bf16 v[140:143], v[124:127], a[136:139], v[140:143]
ds_read_b64_tr_b16 v[118:119], v11 offset:53248
ds_read_b128 v[176:179], v204 offset:7072
v_mfma_f32_16x16x32_bf16 v[156:159], v[124:127], a[140:143], v[156:159]
ds_read_b64_tr_b16 v[120:121], v12 offset:36864
ds_read_b64 v[180:181], v205 offset:3328
v_mfma_f32_16x16x16_bf16 v[240:243], v[188:189], v[60:61], 0
v_cvt_pk_bf16_f32 v224, v224, v225
v_cvt_pk_bf16_f32 v225, v226, v227
v_mfma_f32_16x16x16_bf16 v[244:247], v[188:189], v[62:63], 0
v_cvt_pk_bf16_f32 v228, v228, v229
v_cvt_pk_bf16_f32 v229, v230, v231
v_mfma_f32_16x16x16_bf16 v[240:243], v[184:185], a[184:185], v[240:243]
v_accvgpr_write_b32 a176, v224
v_accvgpr_write_b32 a177, v225
v_mfma_f32_16x16x16_bf16 v[244:247], v[186:187], a[186:187], v[244:247]
v_accvgpr_write_b32 a178, v228
v_accvgpr_write_b32 a179, v229
v_mfma_f32_16x16x16_bf16 v[208:211], v[188:189], v[64:65], 0
v_cvt_pk_bf16_f32 v232, v232, v233
v_cvt_pk_bf16_f32 v233, v234, v235
v_mfma_f32_16x16x16_bf16 v[212:215], v[188:189], v[66:67], 0
v_cvt_pk_bf16_f32 v236, v236, v237
v_cvt_pk_bf16_f32 v237, v238, v239
v_mfma_f32_16x16x16_bf16 v[208:211], v[184:185], a[188:189], v[208:211]
v_accvgpr_write_b32 a180, v232
v_accvgpr_write_b32 a181, v233
v_mfma_f32_16x16x16_bf16 v[212:215], v[186:187], a[190:191], v[212:215]
ds_read_b64_tr_b16 v[122:123], v12 offset:53248
v_accvgpr_write_b32 a182, v236
v_mfma_f32_16x16x32_bf16 v[128:131], v[80:83], a[144:147], v[128:131]
ds_read_b64_tr_b16 v[124:125], v13 offset:36864
v_accvgpr_write_b32 a183, v237
v_mfma_f32_16x16x32_bf16 v[144:147], v[80:83], a[148:151], v[144:147]
ds_read_b64_tr_b16 v[126:127], v13 offset:53248
ds_read_b128 v[184:187], v204 offset:7344
v_mfma_f32_16x16x32_bf16 v[132:135], v[84:87], a[144:147], v[132:135]
ds_read_b64_tr_b16 v[80:81], v10 offset:37888
ds_read_b64 v[188:189], v205 offset:3456
v_mfma_f32_16x16x32_bf16 v[148:151], v[84:87], a[148:151], v[148:151]
ds_read_b64_tr_b16 v[82:83], v10 offset:54272
s_waitcnt lgkmcnt(7)
v_mfma_f32_16x16x32_bf16 v[136:139], v[88:91], a[144:147], v[136:139]
ds_read_b64_tr_b16 v[84:85], v11 offset:37888
v_cvt_pk_bf16_f32 v240, v240, v241
v_mfma_f32_16x16x32_bf16 v[152:155], v[88:91], a[148:151], v[152:155]
ds_read_b64_tr_b16 v[86:87], v11 offset:54272
v_cvt_pk_bf16_f32 v241, v242, v243
v_mfma_f32_16x16x32_bf16 v[140:143], v[92:95], a[144:147], v[140:143]
ds_read_b64_tr_b16 v[88:89], v12 offset:37888
v_cvt_pk_bf16_f32 v244, v244, v245
v_mfma_f32_16x16x32_bf16 v[156:159], v[92:95], a[148:151], v[156:159]
v_cvt_pk_bf16_f32 v245, v246, v247
v_accvgpr_write_b32 a184, v240
v_mfma_f32_16x16x16_bf16 v[224:227], v[164:165], v[60:61], 0
v_accvgpr_write_b32 a185, v241
v_accvgpr_write_b32 a186, v244
v_mfma_f32_16x16x16_bf16 v[228:231], v[164:165], v[62:63], 0
v_accvgpr_write_b32 a187, v245
v_cvt_pk_bf16_f32 v208, v208, v209
v_mfma_f32_16x16x16_bf16 v[224:227], v[160:161], a[192:193], v[224:227]
v_cvt_pk_bf16_f32 v209, v210, v211
v_cvt_pk_bf16_f32 v212, v212, v213
v_mfma_f32_16x16x16_bf16 v[228:231], v[162:163], a[194:195], v[228:231]
v_cvt_pk_bf16_f32 v213, v214, v215
v_accvgpr_write_b32 a188, v208
v_mfma_f32_16x16x16_bf16 v[232:235], v[164:165], v[64:65], 0
v_accvgpr_write_b32 a189, v209
v_accvgpr_write_b32 a190, v212
v_mfma_f32_16x16x16_bf16 v[236:239], v[164:165], v[66:67], 0
v_accvgpr_write_b32 a191, v213
v_mfma_f32_16x16x16_bf16 v[232:235], v[160:161], a[196:197], v[232:235]
v_mfma_f32_16x16x16_bf16 v[236:239], v[162:163], a[198:199], v[236:239]
ds_read_b64_tr_b16 v[90:91], v12 offset:54272
ds_read_b128 v[160:163], v204 offset:7616
v_mfma_f32_16x16x32_bf16 v[128:131], v[96:99], a[152:155], v[128:131]
ds_read_b64_tr_b16 v[92:93], v13 offset:37888
ds_read_b64 v[164:165], v205 offset:3584
v_mfma_f32_16x16x32_bf16 v[144:147], v[96:99], a[156:159], v[144:147]
ds_read_b64_tr_b16 v[94:95], v13 offset:54272
v_cvt_pk_bf16_f32 v224, v224, v225
v_mfma_f32_16x16x32_bf16 v[132:135], v[100:103], a[152:155], v[132:135]
ds_read_b64_tr_b16 v[96:97], v10 offset:38912
v_cvt_pk_bf16_f32 v225, v226, v227
v_mfma_f32_16x16x32_bf16 v[148:151], v[100:103], a[156:159], v[148:151]
ds_read_b64_tr_b16 v[98:99], v10 offset:55296
v_cvt_pk_bf16_f32 v228, v228, v229
v_mfma_f32_16x16x32_bf16 v[136:139], v[104:107], a[152:155], v[136:139]
ds_read_b64_tr_b16 v[100:101], v11 offset:38912
v_cvt_pk_bf16_f32 v229, v230, v231
v_mfma_f32_16x16x32_bf16 v[152:155], v[104:107], a[156:159], v[152:155]
ds_read_b64_tr_b16 v[102:103], v11 offset:55296
v_accvgpr_write_b32 a192, v224
v_mfma_f32_16x16x32_bf16 v[140:143], v[108:111], a[152:155], v[140:143]
ds_read_b64_tr_b16 v[104:105], v12 offset:38912
v_accvgpr_write_b32 a193, v225
v_mfma_f32_16x16x32_bf16 v[156:159], v[108:111], a[156:159], v[156:159]
v_accvgpr_write_b32 a194, v228
v_accvgpr_write_b32 a195, v229
v_mfma_f32_16x16x16_bf16 v[240:243], v[172:173], v[60:61], 0
v_cvt_pk_bf16_f32 v232, v232, v233
v_cvt_pk_bf16_f32 v233, v234, v235
v_mfma_f32_16x16x16_bf16 v[244:247], v[172:173], v[62:63], 0
v_cvt_pk_bf16_f32 v236, v236, v237
v_cvt_pk_bf16_f32 v237, v238, v239
v_mfma_f32_16x16x16_bf16 v[240:243], v[168:169], a[200:201], v[240:243]
v_accvgpr_write_b32 a196, v232
v_accvgpr_write_b32 a197, v233
v_mfma_f32_16x16x16_bf16 v[244:247], v[170:171], a[202:203], v[244:247]
v_accvgpr_write_b32 a198, v236
v_accvgpr_write_b32 a199, v237
v_mfma_f32_16x16x16_bf16 v[208:211], v[172:173], v[64:65], 0
v_mfma_f32_16x16x16_bf16 v[212:215], v[172:173], v[66:67], 0
v_mfma_f32_16x16x16_bf16 v[208:211], v[168:169], a[204:205], v[208:211]
v_mfma_f32_16x16x16_bf16 v[212:215], v[170:171], a[206:207], v[212:215]
ds_read_b64_tr_b16 v[106:107], v12 offset:55296
ds_read_b128 v[168:171], v204 offset:7888
v_mfma_f32_16x16x32_bf16 v[128:131], v[112:115], a[160:163], v[128:131]
ds_read_b64_tr_b16 v[108:109], v13 offset:38912
ds_read_b64 v[172:173], v205 offset:3712
v_mfma_f32_16x16x32_bf16 v[144:147], v[112:115], a[164:167], v[144:147]
ds_read_b64_tr_b16 v[110:111], v13 offset:55296
v_cvt_pk_bf16_f32 v240, v240, v241
v_mfma_f32_16x16x32_bf16 v[132:135], v[116:119], a[160:163], v[132:135]
ds_read_b64_tr_b16 v[112:113], v10 offset:39936
v_cvt_pk_bf16_f32 v241, v242, v243
v_mfma_f32_16x16x32_bf16 v[148:151], v[116:119], a[164:167], v[148:151]
ds_read_b64_tr_b16 v[114:115], v10 offset:56320
s_waitcnt lgkmcnt(7)
v_mfma_f32_16x16x32_bf16 v[136:139], v[120:123], a[160:163], v[136:139]
ds_read_b64_tr_b16 v[116:117], v11 offset:39936
v_cvt_pk_bf16_f32 v244, v244, v245
v_mfma_f32_16x16x32_bf16 v[152:155], v[120:123], a[164:167], v[152:155]
ds_read_b64_tr_b16 v[118:119], v11 offset:56320
v_cvt_pk_bf16_f32 v245, v246, v247
v_mfma_f32_16x16x32_bf16 v[140:143], v[124:127], a[160:163], v[140:143]
ds_read_b64_tr_b16 v[120:121], v12 offset:39936
v_accvgpr_write_b32 a200, v240
v_mfma_f32_16x16x32_bf16 v[156:159], v[124:127], a[164:167], v[156:159]
v_accvgpr_write_b32 a201, v241
v_accvgpr_write_b32 a202, v244
v_mfma_f32_16x16x16_bf16 v[224:227], v[180:181], v[60:61], 0
v_accvgpr_write_b32 a203, v245
v_cvt_pk_bf16_f32 v208, v208, v209
v_mfma_f32_16x16x16_bf16 v[228:231], v[180:181], v[62:63], 0
v_cvt_pk_bf16_f32 v209, v210, v211
v_cvt_pk_bf16_f32 v212, v212, v213
v_mfma_f32_16x16x16_bf16 v[224:227], v[176:177], a[208:209], v[224:227]
v_cvt_pk_bf16_f32 v213, v214, v215
v_accvgpr_write_b32 a204, v208
v_mfma_f32_16x16x16_bf16 v[228:231], v[178:179], a[210:211], v[228:231]
v_accvgpr_write_b32 a205, v209
v_accvgpr_write_b32 a206, v212
v_mfma_f32_16x16x16_bf16 v[232:235], v[180:181], v[64:65], 0
v_accvgpr_write_b32 a207, v213
v_mfma_f32_16x16x16_bf16 v[236:239], v[180:181], v[66:67], 0
v_mfma_f32_16x16x16_bf16 v[232:235], v[176:177], a[212:213], v[232:235]
v_mfma_f32_16x16x16_bf16 v[236:239], v[178:179], a[214:215], v[236:239]
ds_read_b64_tr_b16 v[122:123], v12 offset:56320
ds_read_b128 v[176:179], v204 offset:8160
v_mfma_f32_16x16x32_bf16 v[128:131], v[80:83], a[168:171], v[128:131]
ds_read_b64_tr_b16 v[124:125], v13 offset:39936
ds_read_b64 v[180:181], v205 offset:3840
v_mfma_f32_16x16x32_bf16 v[144:147], v[80:83], a[172:175], v[144:147]
ds_read_b64_tr_b16 v[126:127], v13 offset:56320
v_cvt_pk_bf16_f32 v224, v224, v225
v_mfma_f32_16x16x32_bf16 v[132:135], v[84:87], a[168:171], v[132:135]
v_cvt_pk_bf16_f32 v225, v226, v227
v_cvt_pk_bf16_f32 v228, v228, v229
v_mfma_f32_16x16x32_bf16 v[148:151], v[84:87], a[172:175], v[148:151]
v_cvt_pk_bf16_f32 v229, v230, v231
v_accvgpr_write_b32 a208, v224
v_mfma_f32_16x16x32_bf16 v[136:139], v[88:91], a[168:171], v[136:139]
v_accvgpr_write_b32 a209, v225
v_accvgpr_write_b32 a210, v228
v_mfma_f32_16x16x32_bf16 v[152:155], v[88:91], a[172:175], v[152:155]
v_accvgpr_write_b32 a211, v229
v_cvt_pk_bf16_f32 v232, v232, v233
v_mfma_f32_16x16x32_bf16 v[140:143], v[92:95], a[168:171], v[140:143]
s_waitcnt vmcnt(20) lgkmcnt(0)
s_barrier
v_mfma_f32_16x16x32_bf16 v[156:159], v[92:95], a[172:175], v[156:159]
ds_read_b64_tr_b16 v[80:81], v14 offset:0
s_add_u32 m0, s76, 32768
v_mfma_f32_16x16x16_bf16 v[240:243], v[188:189], v[60:61], 0
ds_read_b64_tr_b16 v[82:83], v14 offset:16384
s_add_u32 s77, s82, 0x181000
v_mfma_f32_16x16x16_bf16 v[244:247], v[188:189], v[62:63], 0
buffer_load_dwordx4 v22, s[32:35], s77 offen offset:0 lds
v_mfma_f32_16x16x16_bf16 v[240:243], v[184:185], a[216:217], v[240:243]
ds_read_b64_tr_b16 v[84:85], v15 offset:0
v_cvt_pk_bf16_f32 v233, v234, v235
v_mfma_f32_16x16x16_bf16 v[244:247], v[186:187], a[218:219], v[244:247]
ds_read_b64_tr_b16 v[86:87], v15 offset:16384
v_cvt_pk_bf16_f32 v236, v236, v237
v_mfma_f32_16x16x16_bf16 v[208:211], v[188:189], v[64:65], 0
ds_read_b64_tr_b16 v[88:89], v16 offset:0
v_cvt_pk_bf16_f32 v237, v238, v239
v_mfma_f32_16x16x16_bf16 v[212:215], v[188:189], v[66:67], 0
v_accvgpr_write_b32 a212, v232
v_accvgpr_write_b32 a213, v233
v_mfma_f32_16x16x16_bf16 v[208:211], v[184:185], a[220:221], v[208:211]
v_accvgpr_write_b32 a214, v236
v_accvgpr_write_b32 a215, v237
v_mfma_f32_16x16x16_bf16 v[212:215], v[186:187], a[222:223], v[212:215]
ds_read_b64_tr_b16 v[90:91], v16 offset:16384
ds_read_b128 v[184:187], v204 offset:8432
v_mfma_f32_16x16x32_bf16 v[128:131], v[96:99], a[176:179], v[128:131]
ds_read_b64_tr_b16 v[92:93], v17 offset:0
ds_read_b64 v[188:189], v205 offset:3968
v_mfma_f32_16x16x32_bf16 v[144:147], v[96:99], a[180:183], v[144:147]
buffer_load_dwordx4 v23, s[32:35], s77 offen offset:1024 lds
v_mfma_f32_16x16x32_bf16 v[132:135], v[100:103], a[176:179], v[132:135]
ds_read_b64_tr_b16 v[94:95], v17 offset:16384
v_cvt_pk_bf16_f32 v240, v240, v241
v_mfma_f32_16x16x32_bf16 v[148:151], v[100:103], a[180:183], v[148:151]
ds_read_b64_tr_b16 v[96:97], v14 offset:1024
v_cvt_pk_bf16_f32 v241, v242, v243
v_mfma_f32_16x16x32_bf16 v[136:139], v[104:107], a[176:179], v[136:139]
ds_read_b64_tr_b16 v[98:99], v14 offset:17408
v_cvt_pk_bf16_f32 v244, v244, v245
v_mfma_f32_16x16x32_bf16 v[152:155], v[104:107], a[180:183], v[152:155]
ds_read_b64_tr_b16 v[100:101], v15 offset:1024
v_cvt_pk_bf16_f32 v245, v246, v247
v_mfma_f32_16x16x32_bf16 v[140:143], v[108:111], a[176:179], v[140:143]
ds_read_b64_tr_b16 v[102:103], v15 offset:17408
v_accvgpr_write_b32 a216, v240
v_mfma_f32_16x16x32_bf16 v[156:159], v[108:111], a[180:183], v[156:159]
ds_read_b64_tr_b16 v[104:105], v16 offset:1024
v_accvgpr_write_b32 a217, v241
v_mfma_f32_16x16x16_bf16 v[224:227], v[164:165], v[60:61], 0
v_accvgpr_write_b32 a218, v244
v_accvgpr_write_b32 a219, v245
v_mfma_f32_16x16x16_bf16 v[228:231], v[164:165], v[62:63], 0
buffer_load_dwordx4 v24, s[32:35], s77 offen offset:2048 lds
v_mfma_f32_16x16x16_bf16 v[224:227], v[160:161], a[224:225], v[224:227]
v_cvt_pk_bf16_f32 v208, v208, v209
v_cvt_pk_bf16_f32 v209, v210, v211
v_mfma_f32_16x16x16_bf16 v[228:231], v[162:163], a[226:227], v[228:231]
v_cvt_pk_bf16_f32 v212, v212, v213
v_cvt_pk_bf16_f32 v213, v214, v215
v_mfma_f32_16x16x16_bf16 v[232:235], v[164:165], v[64:65], 0
v_accvgpr_write_b32 a220, v208
v_accvgpr_write_b32 a221, v209
v_mfma_f32_16x16x16_bf16 v[236:239], v[164:165], v[66:67], 0
v_accvgpr_write_b32 a222, v212
v_accvgpr_write_b32 a223, v213
v_mfma_f32_16x16x16_bf16 v[232:235], v[160:161], a[228:229], v[232:235]
v_mfma_f32_16x16x16_bf16 v[236:239], v[162:163], a[230:231], v[236:239]
ds_read_b64_tr_b16 v[106:107], v16 offset:17408
v_cvt_pk_bf16_f32 v224, v224, v225
v_mfma_f32_16x16x32_bf16 v[128:131], v[112:115], a[184:187], v[128:131]
ds_read_b64_tr_b16 v[108:109], v17 offset:1024
v_cvt_pk_bf16_f32 v225, v226, v227
v_mfma_f32_16x16x32_bf16 v[144:147], v[112:115], a[188:191], v[144:147]
buffer_load_dwordx4 v25, s[32:35], s77 offen offset:3072 lds
v_mfma_f32_16x16x32_bf16 v[132:135], v[116:119], a[184:187], v[132:135]
ds_read_b64_tr_b16 v[110:111], v17 offset:17408
v_cvt_pk_bf16_f32 v228, v228, v229
v_mfma_f32_16x16x32_bf16 v[148:151], v[116:119], a[188:191], v[148:151]
ds_read_b64_tr_b16 v[112:113], v14 offset:2048
v_cvt_pk_bf16_f32 v229, v230, v231
v_mfma_f32_16x16x32_bf16 v[136:139], v[120:123], a[184:187], v[136:139]
ds_read_b64_tr_b16 v[114:115], v14 offset:18432
v_accvgpr_write_b32 a224, v224
v_mfma_f32_16x16x32_bf16 v[152:155], v[120:123], a[188:191], v[152:155]
ds_read_b64_tr_b16 v[116:117], v15 offset:2048
v_accvgpr_write_b32 a225, v225
v_mfma_f32_16x16x32_bf16 v[140:143], v[124:127], a[184:187], v[140:143]
ds_read_b64_tr_b16 v[118:119], v15 offset:18432
s_add_u32 m0, s76, 36864
v_mfma_f32_16x16x32_bf16 v[156:159], v[124:127], a[188:191], v[156:159]
ds_read_b64_tr_b16 v[120:121], v16 offset:2048
s_add_u32 s77, s82, 0x241000
v_mfma_f32_16x16x16_bf16 v[240:243], v[172:173], v[60:61], 0
v_accvgpr_write_b32 a226, v228
v_accvgpr_write_b32 a227, v229
v_mfma_f32_16x16x16_bf16 v[244:247], v[172:173], v[62:63], 0
buffer_load_dwordx4 v22, s[32:35], s77 offen offset:0 lds
v_mfma_f32_16x16x16_bf16 v[240:243], v[168:169], a[232:233], v[240:243]
v_cvt_pk_bf16_f32 v232, v232, v233
v_cvt_pk_bf16_f32 v233, v234, v235
v_mfma_f32_16x16x16_bf16 v[244:247], v[170:171], a[234:235], v[244:247]
v_cvt_pk_bf16_f32 v236, v236, v237
v_cvt_pk_bf16_f32 v237, v238, v239
v_mfma_f32_16x16x16_bf16 v[208:211], v[172:173], v[64:65], 0
v_accvgpr_write_b32 a228, v232
v_accvgpr_write_b32 a229, v233
v_mfma_f32_16x16x16_bf16 v[212:215], v[172:173], v[66:67], 0
v_accvgpr_write_b32 a230, v236
v_accvgpr_write_b32 a231, v237
v_mfma_f32_16x16x16_bf16 v[208:211], v[168:169], a[236:237], v[208:211]
v_mfma_f32_16x16x16_bf16 v[212:215], v[170:171], a[238:239], v[212:215]
ds_read_b64_tr_b16 v[122:123], v16 offset:18432
s_waitcnt lgkmcnt(1)
v_mfma_f32_16x16x32_bf16 v[128:131], v[80:83], a[192:195], v[128:131]
ds_read_b64_tr_b16 v[124:125], v17 offset:2048
v_cvt_pk_bf16_f32 v240, v240, v241
v_mfma_f32_16x16x32_bf16 v[144:147], v[80:83], a[196:199], v[144:147]
buffer_load_dwordx4 v23, s[32:35], s77 offen offset:1024 lds
v_mfma_f32_16x16x32_bf16 v[132:135], v[84:87], a[192:195], v[132:135]
ds_read_b64_tr_b16 v[126:127], v17 offset:18432
v_cvt_pk_bf16_f32 v241, v242, v243
v_mfma_f32_16x16x32_bf16 v[148:151], v[84:87], a[196:199], v[148:151]
ds_read_b64_tr_b16 v[80:81], v14 offset:3072
v_cvt_pk_bf16_f32 v244, v244, v245
v_mfma_f32_16x16x32_bf16 v[136:139], v[88:91], a[192:195], v[136:139]
ds_read_b64_tr_b16 v[82:83], v14 offset:19456
v_cvt_pk_bf16_f32 v245, v246, v247
v_mfma_f32_16x16x32_bf16 v[152:155], v[88:91], a[196:199], v[152:155]
ds_read_b64_tr_b16 v[84:85], v15 offset:3072
v_accvgpr_write_b32 a232, v240
v_mfma_f32_16x16x32_bf16 v[140:143], v[92:95], a[192:195], v[140:143]
ds_read_b64_tr_b16 v[86:87], v15 offset:19456
v_accvgpr_write_b32 a233, v241
v_mfma_f32_16x16x32_bf16 v[156:159], v[92:95], a[196:199], v[156:159]
ds_read_b64_tr_b16 v[88:89], v16 offset:3072
v_accvgpr_write_b32 a234, v244
v_mfma_f32_16x16x16_bf16 v[224:227], v[180:181], v[60:61], 0
v_accvgpr_write_b32 a235, v245
v_cvt_pk_bf16_f32 v208, v208, v209
v_mfma_f32_16x16x16_bf16 v[228:231], v[180:181], v[62:63], 0
buffer_load_dwordx4 v24, s[32:35], s77 offen offset:2048 lds
v_mfma_f32_16x16x16_bf16 v[224:227], v[176:177], a[240:241], v[224:227]
v_cvt_pk_bf16_f32 v209, v210, v211
v_cvt_pk_bf16_f32 v212, v212, v213
v_mfma_f32_16x16x16_bf16 v[228:231], v[178:179], a[242:243], v[228:231]
v_cvt_pk_bf16_f32 v213, v214, v215
v_accvgpr_write_b32 a236, v208
v_mfma_f32_16x16x16_bf16 v[232:235], v[180:181], v[64:65], 0
v_accvgpr_write_b32 a237, v209
v_accvgpr_write_b32 a238, v212
v_mfma_f32_16x16x16_bf16 v[236:239], v[180:181], v[66:67], 0
v_accvgpr_write_b32 a239, v213
v_mfma_f32_16x16x16_bf16 v[232:235], v[176:177], a[244:245], v[232:235]
v_mfma_f32_16x16x16_bf16 v[236:239], v[178:179], a[246:247], v[236:239]
ds_read_b64_tr_b16 v[90:91], v16 offset:19456
v_cvt_pk_bf16_f32 v224, v224, v225
S_K2:
v_mfma_f32_16x16x32_bf16 v[128:131], v[96:99], a[200:203], v[128:131]
buffer_load_dwordx4 v25, s[32:35], s77 offen offset:3072 lds
v_mfma_f32_16x16x32_bf16 v[144:147], v[96:99], a[204:207], v[144:147]
ds_read_b64_tr_b16 v[92:93], v17 offset:3072
v_cvt_pk_bf16_f32 v225, v226, v227
v_mfma_f32_16x16x32_bf16 v[132:135], v[100:103], a[200:203], v[132:135]
ds_read_b64_tr_b16 v[94:95], v17 offset:19456
v_cvt_pk_bf16_f32 v228, v228, v229
v_mfma_f32_16x16x32_bf16 v[148:151], v[100:103], a[204:207], v[148:151]
ds_read_b64_tr_b16 v[96:97], v14 offset:4096
v_cvt_pk_bf16_f32 v229, v230, v231
v_mfma_f32_16x16x32_bf16 v[136:139], v[104:107], a[200:203], v[136:139]
ds_read_b64_tr_b16 v[98:99], v14 offset:20480
v_accvgpr_write_b32 a240, v224
v_mfma_f32_16x16x32_bf16 v[152:155], v[104:107], a[204:207], v[152:155]
ds_read_b64_tr_b16 v[100:101], v15 offset:4096
v_accvgpr_write_b32 a241, v225
v_mfma_f32_16x16x32_bf16 v[140:143], v[108:111], a[200:203], v[140:143]
ds_read_b64_tr_b16 v[102:103], v15 offset:20480
v_accvgpr_write_b32 a242, v228
v_mfma_f32_16x16x32_bf16 v[156:159], v[108:111], a[204:207], v[156:159]
ds_read_b64_tr_b16 v[104:105], v16 offset:4096
v_accvgpr_write_b32 a243, v229
v_mfma_f32_16x16x16_bf16 v[240:243], v[188:189], v[60:61], 0
v_cvt_pk_bf16_f32 v232, v232, v233
v_cvt_pk_bf16_f32 v233, v234, v235
v_mfma_f32_16x16x16_bf16 v[244:247], v[188:189], v[62:63], 0
v_cvt_pk_bf16_f32 v236, v236, v237
v_cvt_pk_bf16_f32 v237, v238, v239
v_mfma_f32_16x16x16_bf16 v[240:243], v[184:185], a[248:249], v[240:243]
v_accvgpr_write_b32 a244, v232
v_accvgpr_write_b32 a245, v233
v_mfma_f32_16x16x16_bf16 v[244:247], v[186:187], a[250:251], v[244:247]
v_accvgpr_write_b32 a246, v236
v_accvgpr_write_b32 a247, v237
v_mfma_f32_16x16x16_bf16 v[208:211], v[188:189], v[64:65], 0
v_mfma_f32_16x16x16_bf16 v[212:215], v[188:189], v[66:67], 0
v_mfma_f32_16x16x16_bf16 v[208:211], v[184:185], a[252:253], v[208:211]
v_mfma_f32_16x16x16_bf16 v[212:215], v[186:187], a[254:255], v[212:215]
ds_read_b64_tr_b16 v[106:107], v16 offset:20480
v_cvt_pk_bf16_f32 v240, v240, v241
v_mfma_f32_16x16x32_bf16 v[128:131], v[112:115], a[208:211], v[128:131]
ds_read_b64_tr_b16 v[108:109], v17 offset:4096
v_cvt_pk_bf16_f32 v241, v242, v243
v_mfma_f32_16x16x32_bf16 v[144:147], v[112:115], a[212:215], v[144:147]
ds_read_b64_tr_b16 v[110:111], v17 offset:20480
v_cvt_pk_bf16_f32 v244, v244, v245
v_mfma_f32_16x16x32_bf16 v[132:135], v[116:119], a[208:211], v[132:135]
ds_read_b64_tr_b16 v[112:113], v14 offset:5120
v_cvt_pk_bf16_f32 v245, v246, v247
v_mfma_f32_16x16x32_bf16 v[148:151], v[116:119], a[212:215], v[148:151]
ds_read_b64_tr_b16 v[114:115], v14 offset:21504
s_waitcnt lgkmcnt(5)
v_mfma_f32_16x16x32_bf16 v[136:139], v[120:123], a[208:211], v[136:139]
ds_read_b64_tr_b16 v[116:117], v15 offset:5120
v_accvgpr_write_b32 a248, v240
v_mfma_f32_16x16x32_bf16 v[152:155], v[120:123], a[212:215], v[152:155]
ds_read_b64_tr_b16 v[118:119], v15 offset:21504
v_accvgpr_write_b32 a249, v241
v_mfma_f32_16x16x32_bf16 v[140:143], v[124:127], a[208:211], v[140:143]
ds_read_b64_tr_b16 v[120:121], v16 offset:5120
v_accvgpr_write_b32 a250, v244
v_mfma_f32_16x16x32_bf16 v[156:159], v[124:127], a[212:215], v[156:159]
ds_read_b64_tr_b16 v[122:123], v16 offset:21504
v_accvgpr_write_b32 a251, v245
v_mfma_f32_16x16x32_bf16 v[128:131], v[80:83], a[216:219], v[128:131]
ds_read_b64_tr_b16 v[124:125], v17 offset:5120
v_cvt_pk_bf16_f32 v208, v208, v209
v_mfma_f32_16x16x32_bf16 v[144:147], v[80:83], a[220:223], v[144:147]
ds_read_b64_tr_b16 v[126:127], v17 offset:21504
v_cvt_pk_bf16_f32 v209, v210, v211
v_mfma_f32_16x16x32_bf16 v[132:135], v[84:87], a[216:219], v[132:135]
ds_read_b64_tr_b16 v[80:81], v14 offset:6144
v_cvt_pk_bf16_f32 v212, v212, v213
v_mfma_f32_16x16x32_bf16 v[148:151], v[84:87], a[220:223], v[148:151]
ds_read_b64_tr_b16 v[82:83], v14 offset:22528
v_cvt_pk_bf16_f32 v213, v214, v215
v_mfma_f32_16x16x32_bf16 v[136:139], v[88:91], a[216:219], v[136:139]
ds_read_b64_tr_b16 v[84:85], v15 offset:6144
v_accvgpr_write_b32 a252, v208
v_mfma_f32_16x16x32_bf16 v[152:155], v[88:91], a[220:223], v[152:155]
ds_read_b64_tr_b16 v[86:87], v15 offset:22528
v_accvgpr_write_b32 a253, v209
v_accvgpr_write_b32 a254, v212
v_accvgpr_write_b32 a255, v213
v_mfma_f32_16x16x32_bf16 v[140:143], v[92:95], a[216:219], v[140:143]
ds_read_b64_tr_b16 v[88:89], v16 offset:6144
ds_read_b128 v[160:163], v71 offset:0
v_mfma_f32_16x16x32_bf16 v[156:159], v[92:95], a[220:223], v[156:159]
ds_read_b64_tr_b16 v[90:91], v16 offset:22528
ds_read_b128 v[164:167], v71 offset:64
v_mfma_f32_16x16x32_bf16 v[128:131], v[96:99], a[224:227], v[128:131]
ds_read_b64_tr_b16 v[92:93], v17 offset:6144
ds_read_b128 v[168:171], v71 offset:128
v_mfma_f32_16x16x32_bf16 v[144:147], v[96:99], a[228:231], v[144:147]
ds_read_b64_tr_b16 v[94:95], v17 offset:22528
ds_read_b128 v[172:175], v71 offset:192
v_mfma_f32_16x16x32_bf16 v[132:135], v[100:103], a[224:227], v[132:135]
ds_read_b64_tr_b16 v[96:97], v14 offset:7168
ds_read_b128 v[176:179], v71 offset:256
v_mfma_f32_16x16x32_bf16 v[148:151], v[100:103], a[228:231], v[148:151]
ds_read_b64_tr_b16 v[98:99], v14 offset:23552
s_waitcnt lgkmcnt(11)
v_mfma_f32_16x16x32_bf16 v[136:139], v[104:107], a[224:227], v[136:139]
ds_read_b64_tr_b16 v[100:101], v15 offset:7168
ds_read_b128 v[180:183], v71 offset:320
v_mfma_f32_16x16x32_bf16 v[152:155], v[104:107], a[228:231], v[152:155]
ds_read_b64_tr_b16 v[102:103], v15 offset:23552
ds_read_b128 v[184:187], v71 offset:384
v_mfma_f32_16x16x32_bf16 v[140:143], v[108:111], a[224:227], v[140:143]
ds_read_b64_tr_b16 v[104:105], v16 offset:7168
ds_read_b128 v[188:191], v71 offset:448
v_mfma_f32_16x16x32_bf16 v[156:159], v[108:111], a[228:231], v[156:159]
ds_read_b64_tr_b16 v[106:107], v16 offset:23552
v_mfma_f32_16x16x32_bf16 v[128:131], v[112:115], a[232:235], v[128:131]
ds_read_b64_tr_b16 v[108:109], v17 offset:7168
v_mfma_f32_16x16x32_bf16 v[144:147], v[112:115], a[236:239], v[144:147]
ds_read_b64_tr_b16 v[110:111], v17 offset:23552
v_mfma_f32_16x16x32_bf16 v[132:135], v[116:119], a[232:235], v[132:135]
v_mfma_f32_16x16x32_bf16 v[148:151], v[116:119], a[236:239], v[148:151]
v_mfma_f32_16x16x32_bf16 v[136:139], v[120:123], a[232:235], v[136:139]
v_mfma_f32_16x16x32_bf16 v[152:155], v[120:123], a[236:239], v[152:155]
v_mfma_f32_16x16x32_bf16 v[140:143], v[124:127], a[232:235], v[140:143]
s_waitcnt vmcnt(18) lgkmcnt(0)
s_barrier
v_mfma_f32_16x16x32_bf16 v[156:159], v[124:127], a[236:239], v[156:159]
ds_read_b64_tr_b16 v[112:113], v55 offset:32768
ds_read_b64_tr_b16 v[114:115], v55 offset:49152
v_mfma_f32_16x16x32_bf16 v[128:131], v[80:83], a[240:243], v[128:131]
ds_read_b64_tr_b16 v[116:117], v55 offset:33792
s_add_u32 m0, s76, 65536
v_mfma_f32_16x16x32_bf16 v[144:147], v[80:83], a[244:247], v[144:147]
ds_read_b64_tr_b16 v[118:119], v55 offset:50176
s_add_u32 s77, s82, 0x301000
v_mfma_f32_16x16x32_bf16 v[132:135], v[84:87], a[240:243], v[132:135]
buffer_load_dwordx4 v22, s[32:35], s77 offen offset:0 lds
v_mfma_f32_16x16x32_bf16 v[148:151], v[84:87], a[244:247], v[148:151]
ds_read_b64_tr_b16 v[120:121], v55 offset:34816
ds_read_b64_tr_b16 v[122:123], v55 offset:51200
v_mfma_f32_16x16x32_bf16 v[136:139], v[88:91], a[240:243], v[136:139]
ds_read_b64_tr_b16 v[124:125], v55 offset:35840
v_mfma_f32_16x16x32_bf16 v[152:155], v[88:91], a[244:247], v[152:155]
ds_read_b64_tr_b16 v[126:127], v55 offset:52224
ds_read_b64_tr_b16 v[80:81], v55 offset:36864
v_mfma_f32_16x16x32_bf16 v[140:143], v[92:95], a[240:243], v[140:143]
ds_read_b64_tr_b16 v[82:83], v55 offset:53248
v_mfma_f32_16x16x32_bf16 v[156:159], v[92:95], a[244:247], v[156:159]
ds_read_b64_tr_b16 v[84:85], v55 offset:37888
ds_read_b64_tr_b16 v[86:87], v55 offset:54272
v_mfma_f32_16x16x32_bf16 v[128:131], v[96:99], a[248:251], v[128:131]
buffer_load_dwordx4 v23, s[32:35], s77 offen offset:1024 lds
v_mfma_f32_16x16x32_bf16 v[144:147], v[96:99], a[252:255], v[144:147]
ds_read_b64_tr_b16 v[88:89], v55 offset:38912
ds_read_b64_tr_b16 v[90:91], v55 offset:55296
v_mfma_f32_16x16x32_bf16 v[132:135], v[100:103], a[248:251], v[132:135]
ds_read_b64_tr_b16 v[92:93], v55 offset:39936
v_mfma_f32_16x16x32_bf16 v[148:151], v[100:103], a[252:255], v[148:151]
ds_read_b64_tr_b16 v[94:95], v55 offset:56320
v_mfma_f32_16x16x32_bf16 v[136:139], v[104:107], a[248:251], v[136:139]
v_mfma_f32_16x16x32_bf16 v[152:155], v[104:107], a[252:255], v[152:155]
v_mfma_f32_16x16x32_bf16 v[140:143], v[108:111], a[248:251], v[140:143]
buffer_load_dwordx4 v24, s[32:35], s77 offen offset:2048 lds
v_mfma_f32_16x16x32_bf16 v[156:159], v[108:111], a[252:255], v[156:159]
s_waitcnt lgkmcnt(2)
v_mfma_f32_16x16x32_bf16 v[76:79], v[112:115], v[160:163], 0
s_waitcnt vmcnt(11) lgkmcnt(0)
s_barrier
v_mfma_f32_16x16x32_bf16 v[76:79], v[116:119], v[164:167], v[76:79]
ds_read_b64_tr_b16 v[96:97], v10 offset:0
ds_read_b64_tr_b16 v[98:99], v10 offset:16384
v_mfma_f32_16x16x32_bf16 v[76:79], v[120:123], v[168:171], v[76:79]
ds_read_b64_tr_b16 v[100:101], v11 offset:0
ds_read_b64_tr_b16 v[102:103], v11 offset:16384
v_mfma_f32_16x16x32_bf16 v[76:79], v[124:127], v[172:175], v[76:79]
ds_read_b64_tr_b16 v[104:105], v12 offset:0
ds_read_b64_tr_b16 v[106:107], v12 offset:16384
v_mfma_f32_16x16x32_bf16 v[76:79], v[80:83], v[176:179], v[76:79]
ds_read_b64_tr_b16 v[108:109], v13 offset:0
ds_read_b64_tr_b16 v[110:111], v13 offset:16384
v_mfma_f32_16x16x32_bf16 v[76:79], v[84:87], v[180:183], v[76:79]
ds_read_b64_tr_b16 v[112:113], v10 offset:1024
ds_read_b64_tr_b16 v[114:115], v10 offset:17408
v_mfma_f32_16x16x32_bf16 v[76:79], v[88:91], v[184:187], v[76:79]
ds_read_b64_tr_b16 v[116:117], v11 offset:1024
ds_read_b64_tr_b16 v[118:119], v11 offset:17408
v_mfma_f32_16x16x32_bf16 v[76:79], v[92:95], v[188:191], v[76:79]
ds_read_b64_tr_b16 v[120:121], v12 offset:1024
ds_read_b64_tr_b16 v[122:123], v12 offset:17408
S_V:
s_waitcnt lgkmcnt(12)
v_mfma_f32_16x16x32_bf16 v[160:163], a[0:3], v[96:99], 0
ds_read_b64_tr_b16 v[124:125], v13 offset:1024
ds_read_b64_tr_b16 v[126:127], v13 offset:17408
v_mfma_f32_16x16x32_bf16 v[176:179], a[4:7], v[96:99], 0
ds_read_b64_tr_b16 v[80:81], v10 offset:2048
s_waitcnt lgkmcnt(11)
v_mfma_f32_16x16x32_bf16 v[164:167], a[0:3], v[100:103], 0
ds_read_b64_tr_b16 v[82:83], v10 offset:18432
ds_read_b64_tr_b16 v[84:85], v11 offset:2048
v_mfma_f32_16x16x32_bf16 v[180:183], a[4:7], v[100:103], 0
ds_read_b64_tr_b16 v[86:87], v11 offset:18432
v_mul_f32 v144, v59, v144
v_mfma_f32_16x16x32_bf16 v[168:171], a[0:3], v[104:107], 0
ds_read_b64_tr_b16 v[88:89], v12 offset:2048
ds_read_b64_tr_b16 v[90:91], v12 offset:18432
v_mfma_f32_16x16x32_bf16 v[184:187], a[4:7], v[104:107], 0
ds_read_b64_tr_b16 v[92:93], v13 offset:2048
s_waitcnt lgkmcnt(9)
v_mfma_f32_16x16x32_bf16 v[172:175], a[0:3], v[108:111], 0
buffer_load_dwordx4 v25, s[32:35], s77 offen offset:3072 lds
v_mfma_f32_16x16x32_bf16 v[188:191], a[4:7], v[108:111], 0
ds_read_b64_tr_b16 v[94:95], v13 offset:18432
ds_read_b64_tr_b16 v[96:97], v10 offset:3072
v_mfma_f32_16x16x32_bf16 v[160:163], a[8:11], v[112:115], v[160:163]
s_add_u32 s70, s0, S_Q - K_pc + 0
s_addc_u32 s71, s1, 0
global_load_dword v57, v9, s[70:71]
v_mfma_f32_16x16x32_bf16 v[176:179], a[12:15], v[112:115], v[176:179]
ds_read_b64_tr_b16 v[98:99], v10 offset:19456
ds_read_b64_tr_b16 v[100:101], v11 offset:3072
v_mfma_f32_16x16x32_bf16 v[164:167], a[8:11], v[116:119], v[164:167]
buffer_store_dwordx4 v[76:79], v69, s[60:63], 0 offen sc1
v_mfma_f32_16x16x32_bf16 v[180:183], a[12:15], v[116:119], v[180:183]
ds_read_b64_tr_b16 v[102:103], v11 offset:19456
ds_read_b64_tr_b16 v[104:105], v12 offset:3072
v_mfma_f32_16x16x32_bf16 v[168:171], a[8:11], v[120:123], v[168:171]
ds_read_b64_tr_b16 v[106:107], v12 offset:19456
s_add_u32 m0, s76, 69632
v_mfma_f32_16x16x32_bf16 v[184:187], a[12:15], v[120:123], v[184:187]
ds_read_b64_tr_b16 v[108:109], v13 offset:3072
s_waitcnt lgkmcnt(6)
v_mfma_f32_16x16x32_bf16 v[172:175], a[8:11], v[124:127], v[172:175]
ds_read_b64_tr_b16 v[110:111], v13 offset:19456
s_add_u32 s77, s82, 0x3c1000
v_mfma_f32_16x16x32_bf16 v[188:191], a[12:15], v[124:127], v[188:191]
buffer_load_dwordx4 v22, s[32:35], s77 offen offset:0 lds
v_mfma_f32_16x16x32_bf16 v[160:163], a[16:19], v[80:83], v[160:163]
ds_read_b64_tr_b16 v[112:113], v10 offset:4096
ds_read_b64_tr_b16 v[114:115], v10 offset:20480
v_mfma_f32_16x16x32_bf16 v[176:179], a[20:23], v[80:83], v[176:179]
ds_read_b64_tr_b16 v[116:117], v11 offset:4096
v_mul_f32 v145, v59, v145
v_mfma_f32_16x16x32_bf16 v[164:167], a[16:19], v[84:87], v[164:167]
ds_read_b64_tr_b16 v[118:119], v11 offset:20480
ds_read_b64_tr_b16 v[120:121], v12 offset:4096
v_mfma_f32_16x16x32_bf16 v[180:183], a[20:23], v[84:87], v[180:183]
buffer_load_dwordx4 v23, s[32:35], s77 offen offset:1024 lds
v_mfma_f32_16x16x32_bf16 v[168:171], a[16:19], v[88:91], v[168:171]
ds_read_b64_tr_b16 v[122:123], v12 offset:20480
ds_read_b64_tr_b16 v[124:125], v13 offset:4096
v_mfma_f32_16x16x32_bf16 v[184:187], a[20:23], v[88:91], v[184:187]
ds_read_b64_tr_b16 v[126:127], v13 offset:20480
v_mul_f32 v146, v59, v146
v_mfma_f32_16x16x32_bf16 v[172:175], a[16:19], v[92:95], v[172:175]
ds_read_b64_tr_b16 v[80:81], v10 offset:5120
ds_read_b64_tr_b16 v[82:83], v10 offset:21504
v_mfma_f32_16x16x32_bf16 v[188:191], a[20:23], v[92:95], v[188:191]
ds_read_b64_tr_b16 v[84:85], v11 offset:5120
s_waitcnt lgkmcnt(8)
v_mfma_f32_16x16x32_bf16 v[160:163], a[24:27], v[96:99], v[160:163]
buffer_load_dwordx4 v24, s[32:35], s77 offen offset:2048 lds
v_mfma_f32_16x16x32_bf16 v[176:179], a[28:31], v[96:99], v[176:179]
ds_read_b64_tr_b16 v[86:87], v11 offset:21504
ds_read_b64_tr_b16 v[88:89], v12 offset:5120
v_mfma_f32_16x16x32_bf16 v[164:167], a[24:27], v[100:103], v[164:167]
ds_read_b64_tr_b16 v[90:91], v12 offset:21504
v_mul_f32 v147, v59, v147
v_mfma_f32_16x16x32_bf16 v[180:183], a[28:31], v[100:103], v[180:183]
ds_read_b64_tr_b16 v[92:93], v13 offset:5120
ds_read_b64_tr_b16 v[94:95], v13 offset:21504
v_mfma_f32_16x16x32_bf16 v[168:171], a[24:27], v[104:107], v[168:171]
buffer_load_dwordx4 v25, s[32:35], s77 offen offset:3072 lds
v_mfma_f32_16x16x32_bf16 v[184:187], a[28:31], v[104:107], v[184:187]
ds_read_b64_tr_b16 v[96:97], v10 offset:6144
ds_read_b64_tr_b16 v[98:99], v10 offset:22528
v_mfma_f32_16x16x32_bf16 v[172:175], a[24:27], v[108:111], v[172:175]
ds_read_b64_tr_b16 v[100:101], v11 offset:6144
v_mul_f32 v148, v59, v148
v_mfma_f32_16x16x32_bf16 v[188:191], a[28:31], v[108:111], v[188:191]
ds_read_b64_tr_b16 v[102:103], v11 offset:22528
s_add_u32 m0, s76, 98304
v_mfma_f32_16x16x32_bf16 v[160:163], a[32:35], v[112:115], v[160:163]
ds_read_b64_tr_b16 v[104:105], v12 offset:6144
s_add_u32 s77, s82, 0x481000
v_mfma_f32_16x16x32_bf16 v[176:179], a[36:39], v[112:115], v[176:179]
ds_read_b64_tr_b16 v[106:107], v12 offset:22528
s_waitcnt lgkmcnt(6)
v_mfma_f32_16x16x32_bf16 v[164:167], a[32:35], v[116:119], v[164:167]
buffer_load_dwordx4 v22, s[32:35], s77 offen offset:0 lds
v_mfma_f32_16x16x32_bf16 v[180:183], a[36:39], v[116:119], v[180:183]
ds_read_b64_tr_b16 v[108:109], v13 offset:6144
ds_read_b64_tr_b16 v[110:111], v13 offset:22528
v_mfma_f32_16x16x32_bf16 v[168:171], a[32:35], v[120:123], v[168:171]
ds_read_b64_tr_b16 v[112:113], v10 offset:7168
v_mul_f32 v149, v59, v149
v_mfma_f32_16x16x32_bf16 v[184:187], a[36:39], v[120:123], v[184:187]
ds_read_b64_tr_b16 v[114:115], v10 offset:23552
v_mul_f32 v150, v59, v150
v_mfma_f32_16x16x32_bf16 v[172:175], a[32:35], v[124:127], v[172:175]
ds_read_b64_tr_b16 v[116:117], v11 offset:7168
v_mul_f32 v151, v59, v151
v_mfma_f32_16x16x32_bf16 v[188:191], a[36:39], v[124:127], v[188:191]
ds_read_b64_tr_b16 v[118:119], v11 offset:23552
v_cvt_pk_bf16_f32 v200, v144, v145
v_mfma_f32_16x16x32_bf16 v[160:163], a[40:43], v[80:83], v[160:163]
buffer_load_dwordx4 v23, s[32:35], s77 offen offset:1024 lds
v_mfma_f32_16x16x32_bf16 v[176:179], a[44:47], v[80:83], v[176:179]
ds_read_b64_tr_b16 v[120:121], v12 offset:7168
ds_read_b64_tr_b16 v[122:123], v12 offset:23552
v_mfma_f32_16x16x32_bf16 v[164:167], a[40:43], v[84:87], v[164:167]
ds_read_b64_tr_b16 v[124:125], v13 offset:7168
v_cvt_pk_bf16_f32 v201, v146, v147
v_mfma_f32_16x16x32_bf16 v[180:183], a[44:47], v[84:87], v[180:183]
ds_read_b64_tr_b16 v[126:127], v13 offset:23552
v_cvt_pk_bf16_f32 v202, v148, v149
v_mfma_f32_16x16x32_bf16 v[168:171], a[40:43], v[88:91], v[168:171]
v_cvt_pk_bf16_f32 v203, v150, v151
v_mul_f32 v152, v59, v152
v_mfma_f32_16x16x32_bf16 v[184:187], a[44:47], v[88:91], v[184:187]
v_mul_f32 v153, v59, v153
v_mul_f32 v154, v59, v154
v_mfma_f32_16x16x32_bf16 v[172:175], a[40:43], v[92:95], v[172:175]
buffer_load_dwordx4 v24, s[32:35], s77 offen offset:2048 lds
v_mfma_f32_16x16x32_bf16 v[188:191], a[44:47], v[92:95], v[188:191]
v_mul_f32 v155, v59, v155
s_waitcnt lgkmcnt(2)
v_mfma_f32_16x16x32_bf16 v[160:163], a[48:51], v[96:99], v[160:163]
s_waitcnt vmcnt(13) lgkmcnt(0)
s_barrier
v_mfma_f32_16x16x32_bf16 v[176:179], a[52:55], v[96:99], v[176:179]
ds_read_b64_tr_b16 v[80:81], v10 offset:32768
ds_read_b64_tr_b16 v[82:83], v10 offset:49152
v_mfma_f32_16x16x32_bf16 v[164:167], a[48:51], v[100:103], v[164:167]
ds_read_b64_tr_b16 v[84:85], v11 offset:32768
v_mul_f32 v156, v59, v156
v_mfma_f32_16x16x32_bf16 v[180:183], a[52:55], v[100:103], v[180:183]
ds_read_b64_tr_b16 v[86:87], v11 offset:49152
ds_read_b64_tr_b16 v[88:89], v12 offset:32768
v_mfma_f32_16x16x32_bf16 v[168:171], a[48:51], v[104:107], v[168:171]
buffer_load_dwordx4 v25, s[32:35], s77 offen offset:3072 lds
v_mfma_f32_16x16x32_bf16 v[184:187], a[52:55], v[104:107], v[184:187]
ds_read_b64_tr_b16 v[90:91], v12 offset:49152
ds_read_b64_tr_b16 v[92:93], v13 offset:32768
v_mfma_f32_16x16x32_bf16 v[172:175], a[48:51], v[108:111], v[172:175]
ds_read_b64_tr_b16 v[94:95], v13 offset:49152
s_add_u32 m0, s76, 102400
v_mfma_f32_16x16x32_bf16 v[188:191], a[52:55], v[108:111], v[188:191]
ds_read_b64_tr_b16 v[96:97], v10 offset:33792
s_add_u32 s77, s82, 0x541000
v_mfma_f32_16x16x32_bf16 v[160:163], a[56:59], v[112:115], v[160:163]
buffer_load_dwordx4 v22, s[32:35], s77 offen offset:0 lds
v_mfma_f32_16x16x32_bf16 v[176:179], a[60:63], v[112:115], v[176:179]
ds_read_b64_tr_b16 v[98:99], v10 offset:50176
ds_read_b64_tr_b16 v[100:101], v11 offset:33792
v_mfma_f32_16x16x32_bf16 v[164:167], a[56:59], v[116:119], v[164:167]
ds_read_b64_tr_b16 v[102:103], v11 offset:50176
v_mul_f32 v157, v59, v157
v_mfma_f32_16x16x32_bf16 v[180:183], a[60:63], v[116:119], v[180:183]
ds_read_b64_tr_b16 v[104:105], v12 offset:33792
ds_read_b64_tr_b16 v[106:107], v12 offset:50176
v_mfma_f32_16x16x32_bf16 v[168:171], a[56:59], v[120:123], v[168:171]
buffer_load_dwordx4 v23, s[32:35], s77 offen offset:1024 lds
v_mfma_f32_16x16x32_bf16 v[184:187], a[60:63], v[120:123], v[184:187]
ds_read_b64_tr_b16 v[108:109], v13 offset:33792
ds_read_b64_tr_b16 v[110:111], v13 offset:50176
v_mfma_f32_16x16x32_bf16 v[172:175], a[56:59], v[124:127], v[172:175]
ds_read_b64_tr_b16 v[112:113], v10 offset:34816
s_mul_i32 s3, s101, 7168
v_mfma_f32_16x16x32_bf16 v[188:191], a[60:63], v[124:127], v[188:191]
ds_read_b64_tr_b16 v[114:115], v10 offset:51200
s_waitcnt lgkmcnt(7)
v_mfma_f32_16x16x32_bf16 v[160:163], a[64:67], v[80:83], v[160:163]
buffer_load_dwordx4 v24, s[32:35], s77 offen offset:2048 lds
v_mfma_f32_16x16x32_bf16 v[176:179], a[68:71], v[80:83], v[176:179]
ds_read_b64_tr_b16 v[116:117], v11 offset:34816
ds_read_b64_tr_b16 v[118:119], v11 offset:51200
v_mfma_f32_16x16x32_bf16 v[164:167], a[64:67], v[84:87], v[164:167]
ds_read_b64_tr_b16 v[120:121], v12 offset:34816
s_add_u32 s3, s3, 0x0
v_mfma_f32_16x16x32_bf16 v[180:183], a[68:71], v[84:87], v[180:183]
ds_read_b64_tr_b16 v[122:123], v12 offset:51200
ds_read_b64_tr_b16 v[124:125], v13 offset:34816
v_mfma_f32_16x16x32_bf16 v[168:171], a[64:67], v[88:91], v[168:171]
buffer_load_dwordx4 v25, s[32:35], s77 offen offset:3072 lds
v_mfma_f32_16x16x32_bf16 v[184:187], a[68:71], v[88:91], v[184:187]
ds_read_b64_tr_b16 v[126:127], v13 offset:51200
ds_read_b64_tr_b16 v[80:81], v10 offset:35840
v_mfma_f32_16x16x32_bf16 v[172:175], a[64:67], v[92:95], v[172:175]
ds_read_b64_tr_b16 v[82:83], v10 offset:52224
v_mul_f32 v158, v59, v158
v_mfma_f32_16x16x32_bf16 v[188:191], a[68:71], v[92:95], v[188:191]
ds_read_b64_tr_b16 v[84:85], v11 offset:35840
s_add_u32 m0, s76, 0
v_mfma_f32_16x16x32_bf16 v[160:163], a[72:75], v[96:99], v[160:163]
ds_read_b64_tr_b16 v[86:87], v11 offset:52224
s_add_u32 s77, s82, 0x0
v_mfma_f32_16x16x32_bf16 v[176:179], a[76:79], v[96:99], v[176:179]
ds_read_b64_tr_b16 v[88:89], v12 offset:35840
s_waitcnt lgkmcnt(6)
v_mfma_f32_16x16x32_bf16 v[164:167], a[72:75], v[100:103], v[164:167]
buffer_load_dwordx4 v22, s[32:35], s77 offen offset:0 lds
v_mfma_f32_16x16x32_bf16 v[180:183], a[76:79], v[100:103], v[180:183]
ds_read_b64_tr_b16 v[90:91], v12 offset:52224
ds_read_b64_tr_b16 v[92:93], v13 offset:35840
v_mfma_f32_16x16x32_bf16 v[168:171], a[72:75], v[104:107], v[168:171]
ds_read_b64_tr_b16 v[94:95], v13 offset:52224
v_mul_f32 v159, v59, v159
v_mfma_f32_16x16x32_bf16 v[184:187], a[76:79], v[104:107], v[184:187]
ds_read_b64_tr_b16 v[96:97], v10 offset:36864
ds_read_b64_tr_b16 v[98:99], v10 offset:53248
v_mfma_f32_16x16x32_bf16 v[172:175], a[72:75], v[108:111], v[172:175]
ds_read_b64_tr_b16 v[100:101], v11 offset:36864
v_cvt_pk_bf16_f32 v204, v152, v153
v_mfma_f32_16x16x32_bf16 v[188:191], a[76:79], v[108:111], v[188:191]
ds_read_b64_tr_b16 v[102:103], v11 offset:53248
v_cvt_pk_bf16_f32 v205, v154, v155
v_mfma_f32_16x16x32_bf16 v[160:163], a[80:83], v[112:115], v[160:163]
buffer_load_dwordx4 v23, s[32:35], s77 offen offset:1024 lds
v_mfma_f32_16x16x32_bf16 v[176:179], a[84:87], v[112:115], v[176:179]
ds_read_b64_tr_b16 v[104:105], v12 offset:36864
ds_read_b64_tr_b16 v[106:107], v12 offset:53248
v_mfma_f32_16x16x32_bf16 v[164:167], a[80:83], v[116:119], v[164:167]
ds_read_b64_tr_b16 v[108:109], v13 offset:36864
v_cvt_pk_bf16_f32 v206, v156, v157
v_mfma_f32_16x16x32_bf16 v[180:183], a[84:87], v[116:119], v[180:183]
ds_read_b64_tr_b16 v[110:111], v13 offset:53248
v_cvt_pk_bf16_f32 v207, v158, v159
v_mfma_f32_16x16x32_bf16 v[168:171], a[80:83], v[120:123], v[168:171]
buffer_store_dwordx4 v[200:203], v54, s[60:63], 0 offen offset:0 sc1
v_mfma_f32_16x16x32_bf16 v[184:187], a[84:87], v[120:123], v[184:187]
ds_read_b64_tr_b16 v[112:113], v10 offset:37888
s_waitcnt lgkmcnt(5)
v_mfma_f32_16x16x32_bf16 v[172:175], a[80:83], v[124:127], v[172:175]
buffer_load_dwordx4 v24, s[32:35], s77 offen offset:2048 lds
v_mfma_f32_16x16x32_bf16 v[188:191], a[84:87], v[124:127], v[188:191]
ds_read_b64_tr_b16 v[114:115], v10 offset:54272
ds_read_b64_tr_b16 v[116:117], v11 offset:37888
v_mfma_f32_16x16x32_bf16 v[160:163], a[88:91], v[80:83], v[160:163]
ds_write_b128 v53, v[200:203] offset:0
v_mfma_f32_16x16x32_bf16 v[176:179], a[92:95], v[80:83], v[176:179]
ds_read_b64_tr_b16 v[118:119], v11 offset:54272
ds_read_b64_tr_b16 v[120:121], v12 offset:37888
v_mfma_f32_16x16x32_bf16 v[164:167], a[88:91], v[84:87], v[164:167]
buffer_store_dwordx4 v[204:207], v54, s[60:63], 0 offen offset:1024 sc1
v_mfma_f32_16x16x32_bf16 v[180:183], a[92:95], v[84:87], v[180:183]
ds_read_b64_tr_b16 v[122:123], v12 offset:54272
ds_read_b64_tr_b16 v[124:125], v13 offset:37888
v_mfma_f32_16x16x32_bf16 v[168:171], a[88:91], v[88:91], v[168:171]
buffer_load_dwordx4 v25, s[32:35], s77 offen offset:3072 lds
v_mfma_f32_16x16x32_bf16 v[184:187], a[92:95], v[88:91], v[184:187]
ds_read_b64_tr_b16 v[126:127], v13 offset:54272
ds_read_b64_tr_b16 v[80:81], v10 offset:38912
v_mfma_f32_16x16x32_bf16 v[172:175], a[88:91], v[92:95], v[172:175]
ds_write_b128 v53, v[204:207] offset:1024
v_mfma_f32_16x16x32_bf16 v[188:191], a[92:95], v[92:95], v[188:191]
ds_read_b64_tr_b16 v[82:83], v10 offset:55296
ds_read_b64_tr_b16 v[84:85], v11 offset:38912
v_mfma_f32_16x16x32_bf16 v[160:163], a[96:99], v[96:99], v[160:163]
ds_read_b64_tr_b16 v[86:87], v11 offset:55296
s_add_u32 m0, s76, 4096
v_mfma_f32_16x16x32_bf16 v[176:179], a[100:103], v[96:99], v[176:179]
ds_read_b64_tr_b16 v[88:89], v12 offset:38912
s_add_u32 s77, s82, 0xc0000
v_mfma_f32_16x16x32_bf16 v[164:167], a[96:99], v[100:103], v[164:167]
buffer_load_dwordx4 v22, s[32:35], s77 offen offset:0 lds
v_mfma_f32_16x16x32_bf16 v[180:183], a[100:103], v[100:103], v[180:183]
ds_read_b64_tr_b16 v[90:91], v12 offset:55296
s_waitcnt lgkmcnt(6)
v_mfma_f32_16x16x32_bf16 v[168:171], a[96:99], v[104:107], v[168:171]
ds_read_b64_tr_b16 v[92:93], v13 offset:38912
ds_read_b64_tr_b16 v[94:95], v13 offset:55296
v_mfma_f32_16x16x32_bf16 v[184:187], a[100:103], v[104:107], v[184:187]
ds_read_b64_tr_b16 v[96:97], v10 offset:39936
v_mul_f32 v128, v58, v128
v_mfma_f32_16x16x32_bf16 v[172:175], a[96:99], v[108:111], v[172:175]
ds_read_b64_tr_b16 v[98:99], v10 offset:56320
ds_read_b64_tr_b16 v[100:101], v11 offset:39936
v_mfma_f32_16x16x32_bf16 v[188:191], a[100:103], v[108:111], v[188:191]
ds_read_b64_tr_b16 v[102:103], v11 offset:56320
v_mul_f32 v129, v58, v129
v_mfma_f32_16x16x32_bf16 v[160:163], a[104:107], v[112:115], v[160:163]
buffer_load_dwordx4 v23, s[32:35], s77 offen offset:1024 lds
v_mfma_f32_16x16x32_bf16 v[176:179], a[108:111], v[112:115], v[176:179]
ds_read_b64_tr_b16 v[104:105], v12 offset:39936
ds_read_b64_tr_b16 v[106:107], v12 offset:56320
v_mfma_f32_16x16x32_bf16 v[164:167], a[104:107], v[116:119], v[164:167]
ds_read_b64_tr_b16 v[108:109], v13 offset:39936
v_mul_f32 v130, v58, v130
v_mfma_f32_16x16x32_bf16 v[180:183], a[108:111], v[116:119], v[180:183]
ds_read_b64_tr_b16 v[110:111], v13 offset:56320
v_mul_f32 v131, v58, v131
v_mfma_f32_16x16x32_bf16 v[168:171], a[104:107], v[120:123], v[168:171]
v_mul_f32 v132, v58, v132
v_mul_f32 v133, v58, v133
v_mfma_f32_16x16x32_bf16 v[184:187], a[108:111], v[120:123], v[184:187]
v_mul_f32 v134, v58, v134
v_mul_f32 v135, v58, v135
v_mfma_f32_16x16x32_bf16 v[172:175], a[104:107], v[124:127], v[172:175]
buffer_load_dwordx4 v24, s[32:35], s77 offen offset:2048 lds
v_mfma_f32_16x16x32_bf16 v[188:191], a[108:111], v[124:127], v[188:191]
v_cvt_pk_bf16_f32 v192, v128, v129
s_waitcnt lgkmcnt(2)
v_mfma_f32_16x16x32_bf16 v[160:163], a[112:115], v[80:83], v[160:163]
s_waitcnt vmcnt(17) lgkmcnt(0)
s_barrier
v_mfma_f32_16x16x32_bf16 v[176:179], a[116:119], v[80:83], v[176:179]
ds_read_b64_tr_b16 v[112:113], v14 offset:0
ds_read_b64_tr_b16 v[114:115], v14 offset:16384
v_mfma_f32_16x16x32_bf16 v[164:167], a[112:115], v[84:87], v[164:167]
ds_read_b64_tr_b16 v[116:117], v15 offset:0
v_cvt_pk_bf16_f32 v193, v130, v131
v_mfma_f32_16x16x32_bf16 v[180:183], a[116:119], v[84:87], v[180:183]
ds_read_b64_tr_b16 v[118:119], v15 offset:16384
ds_read_b64_tr_b16 v[120:121], v16 offset:0
v_mfma_f32_16x16x32_bf16 v[168:171], a[112:115], v[88:91], v[168:171]
buffer_load_dwordx4 v25, s[32:35], s77 offen offset:3072 lds
v_mfma_f32_16x16x32_bf16 v[184:187], a[116:119], v[88:91], v[184:187]
ds_read_b64_tr_b16 v[122:123], v16 offset:16384
ds_read_b64_tr_b16 v[124:125], v17 offset:0
v_mfma_f32_16x16x32_bf16 v[172:175], a[112:115], v[92:95], v[172:175]
ds_read_b64_tr_b16 v[126:127], v17 offset:16384
v_cvt_pk_bf16_f32 v194, v132, v133
v_mfma_f32_16x16x32_bf16 v[188:191], a[116:119], v[92:95], v[188:191]
ds_read_b64_tr_b16 v[80:81], v14 offset:1024
s_add_u32 m0, s76, 32768
v_mfma_f32_16x16x32_bf16 v[160:163], a[120:123], v[96:99], v[160:163]
ds_read_b64_tr_b16 v[82:83], v14 offset:17408
s_add_u32 s77, s82, 0x180000
v_mfma_f32_16x16x32_bf16 v[176:179], a[124:127], v[96:99], v[176:179]
ds_read_b64_tr_b16 v[84:85], v15 offset:1024
ds_read_b64_tr_b16 v[86:87], v15 offset:17408
v_mfma_f32_16x16x32_bf16 v[164:167], a[120:123], v[100:103], v[164:167]
buffer_load_dwordx4 v22, s[32:35], s77 offen offset:0 lds
v_mfma_f32_16x16x32_bf16 v[180:183], a[124:127], v[100:103], v[180:183]
ds_read_b64_tr_b16 v[88:89], v16 offset:1024
ds_read_b64_tr_b16 v[90:91], v16 offset:17408
v_mfma_f32_16x16x32_bf16 v[168:171], a[120:123], v[104:107], v[168:171]
ds_read_b64_tr_b16 v[92:93], v17 offset:1024
v_cvt_pk_bf16_f32 v195, v134, v135
v_mfma_f32_16x16x32_bf16 v[184:187], a[124:127], v[104:107], v[184:187]
ds_read_b64_tr_b16 v[94:95], v17 offset:17408
ds_read_b64_tr_b16 v[96:97], v14 offset:2048
v_mfma_f32_16x16x32_bf16 v[172:175], a[120:123], v[108:111], v[172:175]
ds_read_b64_tr_b16 v[98:99], v14 offset:18432
v_mul_f32 v136, v58, v136
v_mfma_f32_16x16x32_bf16 v[188:191], a[124:127], v[108:111], v[188:191]
ds_read_b64_tr_b16 v[100:101], v15 offset:2048
s_waitcnt lgkmcnt(7)
v_mfma_f32_16x16x32_bf16 v[160:163], a[128:131], v[112:115], v[160:163]
buffer_load_dwordx4 v23, s[32:35], s77 offen offset:1024 lds
v_mfma_f32_16x16x32_bf16 v[176:179], a[132:135], v[112:115], v[176:179]
ds_read_b64_tr_b16 v[102:103], v15 offset:18432
ds_read_b64_tr_b16 v[104:105], v16 offset:2048
v_mfma_f32_16x16x32_bf16 v[164:167], a[128:131], v[116:119], v[164:167]
ds_read_b64_tr_b16 v[106:107], v16 offset:18432
v_mul_f32 v137, v58, v137
v_mfma_f32_16x16x32_bf16 v[180:183], a[132:135], v[116:119], v[180:183]
ds_read_b64_tr_b16 v[108:109], v17 offset:2048
ds_read_b64_tr_b16 v[110:111], v17 offset:18432
v_mfma_f32_16x16x32_bf16 v[168:171], a[128:131], v[120:123], v[168:171]
ds_read_b64_tr_b16 v[112:113], v14 offset:3072
v_mul_f32 v138, v58, v138
v_mfma_f32_16x16x32_bf16 v[184:187], a[132:135], v[120:123], v[184:187]
ds_read_b64_tr_b16 v[114:115], v14 offset:19456
v_mul_f32 v139, v58, v139
v_mfma_f32_16x16x32_bf16 v[172:175], a[128:131], v[124:127], v[172:175]
buffer_load_dwordx4 v24, s[32:35], s77 offen offset:2048 lds
v_mfma_f32_16x16x32_bf16 v[188:191], a[132:135], v[124:127], v[188:191]
ds_read_b64_tr_b16 v[116:117], v15 offset:3072
ds_read_b64_tr_b16 v[118:119], v15 offset:19456
v_mfma_f32_16x16x32_bf16 v[160:163], a[136:139], v[80:83], v[160:163]
ds_read_b64_tr_b16 v[120:121], v16 offset:3072
v_mul_f32 v140, v58, v140
v_mfma_f32_16x16x32_bf16 v[176:179], a[140:143], v[80:83], v[176:179]
ds_read_b64_tr_b16 v[122:123], v16 offset:19456
v_mul_f32 v141, v58, v141
v_mfma_f32_16x16x32_bf16 v[164:167], a[136:139], v[84:87], v[164:167]
ds_read_b64_tr_b16 v[124:125], v17 offset:3072
v_mul_f32 v142, v58, v142
v_mfma_f32_16x16x32_bf16 v[180:183], a[140:143], v[84:87], v[180:183]
ds_read_b64_tr_b16 v[126:127], v17 offset:19456
s_waitcnt lgkmcnt(6)
v_mfma_f32_16x16x32_bf16 v[168:171], a[136:139], v[88:91], v[168:171]
buffer_load_dwordx4 v25, s[32:35], s77 offen offset:3072 lds
v_mfma_f32_16x16x32_bf16 v[184:187], a[140:143], v[88:91], v[184:187]
ds_read_b64_tr_b16 v[80:81], v14 offset:4096
ds_read_b64_tr_b16 v[82:83], v14 offset:20480
v_mfma_f32_16x16x32_bf16 v[172:175], a[136:139], v[92:95], v[172:175]
ds_read_b64_tr_b16 v[84:85], v15 offset:4096
v_mul_f32 v143, v58, v143
v_mfma_f32_16x16x32_bf16 v[188:191], a[140:143], v[92:95], v[188:191]
ds_read_b64_tr_b16 v[86:87], v15 offset:20480
s_add_u32 m0, s76, 36864
v_mfma_f32_16x16x32_bf16 v[160:163], a[144:147], v[96:99], v[160:163]
ds_read_b64_tr_b16 v[88:89], v16 offset:4096
s_add_u32 s77, s82, 0x240000
v_mfma_f32_16x16x32_bf16 v[176:179], a[148:151], v[96:99], v[176:179]
ds_read_b64_tr_b16 v[90:91], v16 offset:20480
v_cvt_pk_bf16_f32 v196, v136, v137
v_mfma_f32_16x16x32_bf16 v[164:167], a[144:147], v[100:103], v[164:167]
buffer_load_dwordx4 v22, s[32:35], s77 offen offset:0 lds
v_mfma_f32_16x16x32_bf16 v[180:183], a[148:151], v[100:103], v[180:183]
ds_read_b64_tr_b16 v[92:93], v17 offset:4096
ds_read_b64_tr_b16 v[94:95], v17 offset:20480
v_mfma_f32_16x16x32_bf16 v[168:171], a[144:147], v[104:107], v[168:171]
ds_read_b64_tr_b16 v[96:97], v14 offset:5120
v_cvt_pk_bf16_f32 v197, v138, v139
v_mfma_f32_16x16x32_bf16 v[184:187], a[148:151], v[104:107], v[184:187]
ds_read_b64_tr_b16 v[98:99], v14 offset:21504
v_cvt_pk_bf16_f32 v198, v140, v141
v_mfma_f32_16x16x32_bf16 v[172:175], a[144:147], v[108:111], v[172:175]
ds_read_b64_tr_b16 v[100:101], v15 offset:5120
v_cvt_pk_bf16_f32 v199, v142, v143
v_mfma_f32_16x16x32_bf16 v[188:191], a[148:151], v[108:111], v[188:191]
ds_read_b64_tr_b16 v[102:103], v15 offset:21504
v_mov_b32 v2, 0x3f80
v_mfma_f32_16x16x32_bf16 v[160:163], a[152:155], v[112:115], v[160:163]
buffer_load_dwordx4 v23, s[32:35], s77 offen offset:1024 lds
v_mfma_f32_16x16x32_bf16 v[176:179], a[156:159], v[112:115], v[176:179]
ds_read_b64_tr_b16 v[104:105], v16 offset:5120
s_waitcnt lgkmcnt(5)
v_mfma_f32_16x16x32_bf16 v[164:167], a[152:155], v[116:119], v[164:167]
ds_read_b64_tr_b16 v[106:107], v16 offset:21504
ds_read_b64_tr_b16 v[108:109], v17 offset:5120
v_mfma_f32_16x16x32_bf16 v[180:183], a[156:159], v[116:119], v[180:183]
ds_read_b64_tr_b16 v[110:111], v17 offset:21504
v_mov_b32 v3, 0
v_mfma_f32_16x16x32_bf16 v[168:171], a[152:155], v[120:123], v[168:171]
ds_read_b64_tr_b16 v[112:113], v14 offset:6144
v_mov_b32 v4, 0
v_mfma_f32_16x16x32_bf16 v[184:187], a[156:159], v[120:123], v[184:187]
v_mfma_f32_16x16x16_bf16 v[208:211], v[60:61], v[2:3], 0
v_mfma_f32_16x16x16_bf16 v[212:215], v[64:65], v[2:3], 0
v_mfma_f32_16x16x32_bf16 v[172:175], a[152:155], v[124:127], v[172:175]
ds_read_b64_tr_b16 v[114:115], v14 offset:22528
ds_read_b64_tr_b16 v[116:117], v15 offset:6144
v_mfma_f32_16x16x32_bf16 v[188:191], a[156:159], v[124:127], v[188:191]
buffer_load_dwordx4 v24, s[32:35], s77 offen offset:2048 lds
v_mfma_f32_16x16x32_bf16 v[160:163], a[160:163], v[80:83], v[160:163]
ds_read_b64_tr_b16 v[118:119], v15 offset:22528
ds_read_b64_tr_b16 v[120:121], v16 offset:6144
v_mfma_f32_16x16x32_bf16 v[176:179], a[164:167], v[80:83], v[176:179]
v_rcp_f32 v60, v208
v_mfma_f32_16x16x32_bf16 v[164:167], a[160:163], v[84:87], v[164:167]
ds_read_b64_tr_b16 v[122:123], v16 offset:22528
ds_read_b64_tr_b16 v[124:125], v17 offset:6144
v_mfma_f32_16x16x32_bf16 v[180:183], a[164:167], v[84:87], v[180:183]
v_rcp_f32 v61, v209
v_mfma_f32_16x16x32_bf16 v[168:171], a[160:163], v[88:91], v[168:171]
ds_read_b64_tr_b16 v[126:127], v17 offset:22528
ds_read_b64_tr_b16 v[80:81], v14 offset:7168
v_mfma_f32_16x16x32_bf16 v[184:187], a[164:167], v[88:91], v[184:187]
buffer_load_dwordx4 v25, s[32:35], s77 offen offset:3072 lds
v_mfma_f32_16x16x32_bf16 v[172:175], a[160:163], v[92:95], v[172:175]
ds_read_b64_tr_b16 v[82:83], v14 offset:23552
ds_read_b64_tr_b16 v[84:85], v15 offset:7168
v_mfma_f32_16x16x32_bf16 v[188:191], a[164:167], v[92:95], v[188:191]
ds_read_b64_tr_b16 v[86:87], v15 offset:23552
s_waitcnt lgkmcnt(7)
v_mfma_f32_16x16x32_bf16 v[160:163], a[168:171], v[96:99], v[160:163]
buffer_load_dword v57, v8, s[40:43], s3 offen
v_mfma_f32_16x16x32_bf16 v[176:179], a[172:175], v[96:99], v[176:179]
ds_read_b64_tr_b16 v[88:89], v16 offset:7168
ds_read_b64_tr_b16 v[90:91], v16 offset:23552
v_mfma_f32_16x16x32_bf16 v[164:167], a[168:171], v[100:103], v[164:167]
ds_read_b64_tr_b16 v[92:93], v17 offset:7168
s_mul_i32 s3, s101, 7168
v_mfma_f32_16x16x32_bf16 v[180:183], a[172:175], v[100:103], v[180:183]
ds_read_b64_tr_b16 v[94:95], v17 offset:23552
s_add_u32 s3, s3, 0x0
v_mfma_f32_16x16x32_bf16 v[168:171], a[168:171], v[104:107], v[168:171]
buffer_load_dword v57, v8, s[44:47], s3 offen
v_mfma_f32_16x16x32_bf16 v[184:187], a[172:175], v[104:107], v[184:187]
v_rcp_f32 v62, v210
v_mfma_f32_16x16x32_bf16 v[172:175], a[168:171], v[108:111], v[172:175]
v_rcp_f32 v63, v211
v_mfma_f32_16x16x32_bf16 v[188:191], a[172:175], v[108:111], v[188:191]
v_rcp_f32 v64, v212
v_mfma_f32_16x16x32_bf16 v[160:163], a[176:179], v[112:115], v[160:163]
s_waitcnt vmcnt(20) lgkmcnt(0)
s_barrier
s_waitcnt vmcnt(15)
s_atomic_add s85, s[60:61], s97
v_mfma_f32_16x16x32_bf16 v[176:179], a[180:183], v[112:115], v[176:179]
ds_read_b64_tr_b16 v[96:97], v14 offset:32768
ds_read_b64_tr_b16 v[98:99], v14 offset:49152
v_mfma_f32_16x16x32_bf16 v[164:167], a[176:179], v[116:119], v[164:167]
ds_read_b64_tr_b16 v[100:101], v15 offset:32768
s_add_u32 m0, s76, 65536
v_mfma_f32_16x16x32_bf16 v[180:183], a[180:183], v[116:119], v[180:183]
ds_read_b64_tr_b16 v[102:103], v15 offset:49152
s_add_u32 s77, s82, 0x300000
v_mfma_f32_16x16x32_bf16 v[168:171], a[176:179], v[120:123], v[168:171]
ds_read_b64_tr_b16 v[104:105], v16 offset:32768
ds_read_b64_tr_b16 v[106:107], v16 offset:49152
v_mfma_f32_16x16x32_bf16 v[184:187], a[180:183], v[120:123], v[184:187]
buffer_load_dwordx4 v22, s[32:35], s77 offen offset:0 lds
v_mfma_f32_16x16x32_bf16 v[172:175], a[176:179], v[124:127], v[172:175]
ds_read_b64_tr_b16 v[108:109], v17 offset:32768
ds_read_b64_tr_b16 v[110:111], v17 offset:49152
v_mfma_f32_16x16x32_bf16 v[188:191], a[180:183], v[124:127], v[188:191]
v_rcp_f32 v65, v213
v_mfma_f32_16x16x32_bf16 v[160:163], a[184:187], v[80:83], v[160:163]
ds_read_b64_tr_b16 v[112:113], v14 offset:33792
ds_read_b64_tr_b16 v[114:115], v14 offset:50176
v_mfma_f32_16x16x32_bf16 v[176:179], a[188:191], v[80:83], v[176:179]
v_rcp_f32 v66, v214
v_mfma_f32_16x16x32_bf16 v[164:167], a[184:187], v[84:87], v[164:167]
ds_read_b64_tr_b16 v[116:117], v15 offset:33792
ds_read_b64_tr_b16 v[118:119], v15 offset:50176
v_mfma_f32_16x16x32_bf16 v[180:183], a[188:191], v[84:87], v[180:183]
buffer_load_dwordx4 v23, s[32:35], s77 offen offset:1024 lds
v_mfma_f32_16x16x32_bf16 v[168:171], a[184:187], v[88:91], v[168:171]
ds_read_b64_tr_b16 v[120:121], v16 offset:33792
ds_read_b64_tr_b16 v[122:123], v16 offset:50176
v_mfma_f32_16x16x32_bf16 v[184:187], a[188:191], v[88:91], v[184:187]
v_rcp_f32 v67, v215
v_mfma_f32_16x16x32_bf16 v[172:175], a[184:187], v[92:95], v[172:175]
ds_read_b64_tr_b16 v[124:125], v17 offset:33792
ds_read_b64_tr_b16 v[126:127], v17 offset:50176
v_mfma_f32_16x16x32_bf16 v[188:191], a[188:191], v[92:95], v[188:191]
ds_read_b64_tr_b16 v[80:81], v14 offset:34816
s_waitcnt lgkmcnt(7)
v_mfma_f32_16x16x32_bf16 v[160:163], a[192:195], v[96:99], v[160:163]
ds_read_b64_tr_b16 v[82:83], v14 offset:51200
ds_read_b64_tr_b16 v[84:85], v15 offset:34816
v_mfma_f32_16x16x32_bf16 v[176:179], a[196:199], v[96:99], v[176:179]
buffer_load_dwordx4 v24, s[32:35], s77 offen offset:2048 lds
v_mfma_f32_16x16x32_bf16 v[164:167], a[192:195], v[100:103], v[164:167]
ds_read_b64_tr_b16 v[86:87], v15 offset:51200
ds_read_b64_tr_b16 v[88:89], v16 offset:34816
v_mfma_f32_16x16x32_bf16 v[180:183], a[196:199], v[100:103], v[180:183]
ds_read_b64_tr_b16 v[90:91], v16 offset:51200
v_and_b32 v2, 1, v1
v_mfma_f32_16x16x32_bf16 v[168:171], a[192:195], v[104:107], v[168:171]
ds_read_b64_tr_b16 v[92:93], v17 offset:34816
ds_read_b64_tr_b16 v[94:95], v17 offset:51200
v_mfma_f32_16x16x32_bf16 v[184:187], a[196:199], v[104:107], v[184:187]
ds_read_b64_tr_b16 v[96:97], v14 offset:35840
v_lshlrev_b32 v2, 4, v2
v_mfma_f32_16x16x32_bf16 v[172:175], a[192:195], v[108:111], v[172:175]
ds_read_b64_tr_b16 v[98:99], v14 offset:52224
ds_read_b64_tr_b16 v[100:101], v15 offset:35840
v_mfma_f32_16x16x32_bf16 v[188:191], a[196:199], v[108:111], v[188:191]
buffer_load_dwordx4 v25, s[32:35], s77 offen offset:3072 lds
v_mfma_f32_16x16x32_bf16 v[160:163], a[200:203], v[112:115], v[160:163]
ds_read_b64_tr_b16 v[102:103], v15 offset:52224
ds_read_b64_tr_b16 v[104:105], v16 offset:35840
v_mfma_f32_16x16x32_bf16 v[176:179], a[204:207], v[112:115], v[176:179]
ds_read_b64_tr_b16 v[106:107], v16 offset:52224
s_waitcnt lgkmcnt(8)
v_mfma_f32_16x16x32_bf16 v[164:167], a[200:203], v[116:119], v[164:167]
ds_read_b64_tr_b16 v[108:109], v17 offset:35840
s_add_u32 m0, s76, 69632
v_mfma_f32_16x16x32_bf16 v[180:183], a[204:207], v[116:119], v[180:183]
ds_read_b64_tr_b16 v[110:111], v17 offset:52224
s_add_u32 s77, s82, 0x3c0000
v_mfma_f32_16x16x32_bf16 v[168:171], a[200:203], v[120:123], v[168:171]
ds_read_b64_tr_b16 v[112:113], v14 offset:36864
v_mov_b32 v3, 0x0c0c0100
v_mfma_f32_16x16x32_bf16 v[184:187], a[204:207], v[120:123], v[184:187]
buffer_load_dwordx4 v22, s[32:35], s77 offen offset:0 lds
v_mfma_f32_16x16x32_bf16 v[172:175], a[200:203], v[124:127], v[172:175]
ds_read_b64_tr_b16 v[114:115], v14 offset:53248
ds_read_b64_tr_b16 v[116:117], v15 offset:36864
v_mfma_f32_16x16x32_bf16 v[188:191], a[204:207], v[124:127], v[188:191]
ds_read_b64_tr_b16 v[118:119], v15 offset:53248
v_alignbit_b32 v51, v3, v3, v2
v_mfma_f32_16x16x32_bf16 v[160:163], a[208:211], v[80:83], v[160:163]
ds_read_b64_tr_b16 v[120:121], v16 offset:36864
v_mov_b32 v3, 0x0c0c0302
v_mfma_f32_16x16x32_bf16 v[176:179], a[212:215], v[80:83], v[176:179]
ds_read_b64_tr_b16 v[122:123], v16 offset:53248
v_alignbit_b32 v55, v3, v3, v2
v_mfma_f32_16x16x32_bf16 v[164:167], a[208:211], v[84:87], v[164:167]
ds_read_b64_tr_b16 v[124:125], v17 offset:36864
v_mul_f32 v4, 0x3e8293ee, v58
v_mfma_f32_16x16x32_bf16 v[180:183], a[212:215], v[84:87], v[180:183]
buffer_load_dwordx4 v23, s[32:35], s77 offen offset:1024 lds
v_mfma_f32_16x16x32_bf16 v[168:171], a[208:211], v[88:91], v[168:171]
ds_read_b64_tr_b16 v[126:127], v17 offset:53248
ds_read_b64_tr_b16 v[80:81], v14 offset:37888
v_mfma_f32_16x16x32_bf16 v[184:187], a[212:215], v[88:91], v[184:187]
ds_read_b64_tr_b16 v[82:83], v14 offset:54272
s_waitcnt lgkmcnt(6)
v_mfma_f32_16x16x32_bf16 v[172:175], a[208:211], v[92:95], v[172:175]
ds_read_b64_tr_b16 v[84:85], v15 offset:37888
v_mul_f32 v6, 0x3e8293ee, v59
v_mfma_f32_16x16x32_bf16 v[188:191], a[212:215], v[92:95], v[188:191]
ds_read_b64_tr_b16 v[86:87], v15 offset:54272
s_lshl_b32 s78, s74, 12
v_mfma_f32_16x16x32_bf16 v[160:163], a[216:219], v[96:99], v[160:163]
ds_read_b64_tr_b16 v[88:89], v16 offset:37888
s_add_u32 s78, s78, s88
v_mfma_f32_16x16x32_bf16 v[176:179], a[220:223], v[96:99], v[176:179]
buffer_load_dwordx4 v24, s[32:35], s77 offen offset:2048 lds
v_mfma_f32_16x16x32_bf16 v[164:167], a[216:219], v[100:103], v[164:167]
ds_read_b64_tr_b16 v[90:91], v16 offset:54272
ds_read_b64_tr_b16 v[92:93], v17 offset:37888
v_mfma_f32_16x16x32_bf16 v[180:183], a[220:223], v[100:103], v[180:183]
ds_read_b64_tr_b16 v[94:95], v17 offset:54272
s_add_u32 s91, s78, 0x200000
v_mfma_f32_16x16x32_bf16 v[168:171], a[216:219], v[104:107], v[168:171]
ds_read_b64_tr_b16 v[96:97], v14 offset:38912
ds_read_b64_tr_b16 v[98:99], v14 offset:55296
v_mfma_f32_16x16x32_bf16 v[184:187], a[220:223], v[104:107], v[184:187]
ds_read_b64_tr_b16 v[100:101], v15 offset:38912
v_mfma_f32_16x16x32_bf16 v[172:175], a[216:219], v[108:111], v[172:175]
ds_read_b64_tr_b16 v[102:103], v15 offset:55296
ds_read_b64_tr_b16 v[104:105], v16 offset:38912
v_mfma_f32_16x16x32_bf16 v[188:191], a[220:223], v[108:111], v[188:191]
buffer_load_dwordx4 v25, s[32:35], s77 offen offset:3072 lds
v_mfma_f32_16x16x32_bf16 v[160:163], a[224:227], v[112:115], v[160:163]
ds_read_b64_tr_b16 v[106:107], v16 offset:55296
ds_read_b64_tr_b16 v[108:109], v17 offset:38912
v_mfma_f32_16x16x32_bf16 v[176:179], a[228:231], v[112:115], v[176:179]
ds_read_b64_tr_b16 v[110:111], v17 offset:55296
v_mfma_f32_16x16x32_bf16 v[164:167], a[224:227], v[116:119], v[164:167]
ds_read_b64_tr_b16 v[112:113], v14 offset:39936
v_mfma_f32_16x16x32_bf16 v[180:183], a[228:231], v[116:119], v[180:183]
ds_read_b64_tr_b16 v[114:115], v14 offset:56320
s_waitcnt lgkmcnt(7)
v_mfma_f32_16x16x32_bf16 v[168:171], a[224:227], v[120:123], v[168:171]
ds_read_b64_tr_b16 v[116:117], v15 offset:39936
v_mfma_f32_16x16x32_bf16 v[184:187], a[228:231], v[120:123], v[184:187]
ds_read_b64_tr_b16 v[118:119], v15 offset:56320
v_mfma_f32_16x16x32_bf16 v[172:175], a[224:227], v[124:127], v[172:175]
ds_read_b64_tr_b16 v[120:121], v16 offset:39936
v_mfma_f32_16x16x32_bf16 v[188:191], a[228:231], v[124:127], v[188:191]
ds_read_b64_tr_b16 v[122:123], v16 offset:56320
v_mfma_f32_16x16x32_bf16 v[160:163], a[232:235], v[80:83], v[160:163]
ds_read_b64_tr_b16 v[124:125], v17 offset:39936
v_mfma_f32_16x16x32_bf16 v[176:179], a[236:239], v[80:83], v[176:179]
ds_read_b64_tr_b16 v[126:127], v17 offset:56320
v_mfma_f32_16x16x32_bf16 v[164:167], a[232:235], v[84:87], v[164:167]
v_mfma_f32_16x16x32_bf16 v[180:183], a[236:239], v[84:87], v[180:183]
v_mfma_f32_16x16x32_bf16 v[168:171], a[232:235], v[88:91], v[168:171]
v_mfma_f32_16x16x32_bf16 v[184:187], a[236:239], v[88:91], v[184:187]
v_mfma_f32_16x16x32_bf16 v[172:175], a[232:235], v[92:95], v[172:175]
s_waitcnt vmcnt(18) lgkmcnt(0)
s_barrier
buffer_atomic_add v52, v70, s[60:63], 0 offen sc1
v_mfma_f32_16x16x32_bf16 v[188:191], a[236:239], v[92:95], v[188:191]
ds_read_b64_tr_b16 v[80:81], v10 offset:0
ds_read_b64_tr_b16 v[82:83], v10 offset:16384
v_mfma_f32_16x16x32_bf16 v[160:163], a[240:243], v[96:99], v[160:163]
ds_read_b64_tr_b16 v[84:85], v11 offset:0
v_mfma_f32_16x16x32_bf16 v[176:179], a[244:247], v[96:99], v[176:179]
ds_read_b64_tr_b16 v[86:87], v11 offset:16384
ds_read_b64_tr_b16 v[88:89], v12 offset:0
v_mfma_f32_16x16x32_bf16 v[164:167], a[240:243], v[100:103], v[164:167]
ds_read_b64_tr_b16 v[90:91], v12 offset:16384
v_mfma_f32_16x16x32_bf16 v[180:183], a[244:247], v[100:103], v[180:183]
ds_read_b64_tr_b16 v[92:93], v13 offset:0
ds_read_b64_tr_b16 v[94:95], v13 offset:16384
v_mfma_f32_16x16x32_bf16 v[168:171], a[240:243], v[104:107], v[168:171]
ds_read_b64_tr_b16 v[96:97], v10 offset:1024
v_mfma_f32_16x16x32_bf16 v[184:187], a[244:247], v[104:107], v[184:187]
ds_read_b64_tr_b16 v[98:99], v10 offset:17408
ds_read_b64_tr_b16 v[100:101], v11 offset:1024
v_mfma_f32_16x16x32_bf16 v[172:175], a[240:243], v[108:111], v[172:175]
ds_read_b64_tr_b16 v[102:103], v11 offset:17408
v_mfma_f32_16x16x32_bf16 v[188:191], a[244:247], v[108:111], v[188:191]
ds_read_b64_tr_b16 v[104:105], v12 offset:1024
ds_read_b64_tr_b16 v[106:107], v12 offset:17408
v_mfma_f32_16x16x32_bf16 v[160:163], a[248:251], v[112:115], v[160:163]
ds_read_b64_tr_b16 v[108:109], v13 offset:1024
v_mfma_f32_16x16x32_bf16 v[176:179], a[252:255], v[112:115], v[176:179]
ds_read_b64_tr_b16 v[110:111], v13 offset:17408
v_mfma_f32_16x16x32_bf16 v[164:167], a[248:251], v[116:119], v[164:167]
ds_read_b64_tr_b16 v[112:113], v10 offset:2048
v_mfma_f32_16x16x32_bf16 v[180:183], a[252:255], v[116:119], v[180:183]
ds_read_b64_tr_b16 v[114:115], v10 offset:18432
v_mfma_f32_16x16x32_bf16 v[168:171], a[248:251], v[120:123], v[168:171]
ds_read_b64_tr_b16 v[116:117], v11 offset:2048
v_mfma_f32_16x16x32_bf16 v[184:187], a[252:255], v[120:123], v[184:187]
ds_read_b64_tr_b16 v[118:119], v11 offset:18432
v_mfma_f32_16x16x32_bf16 v[172:175], a[248:251], v[124:127], v[172:175]
ds_read_b64_tr_b16 v[120:121], v12 offset:2048
v_mfma_f32_16x16x32_bf16 v[188:191], a[252:255], v[124:127], v[188:191]
ds_read_b64_tr_b16 v[122:123], v12 offset:18432
S_Q:
s_waitcnt lgkmcnt(6)
v_mfma_f32_16x16x32_bf16 v[128:131], v[80:83], a[0:3], 0
ds_read_b64_tr_b16 v[124:125], v13 offset:2048
v_mfma_f32_16x16x32_bf16 v[144:147], v[80:83], a[4:7], 0
ds_read_b64_tr_b16 v[126:127], v13 offset:18432
v_mfma_f32_16x16x32_bf16 v[132:135], v[84:87], a[0:3], 0
ds_read_b64_tr_b16 v[80:81], v10 offset:3072
v_mfma_f32_16x16x32_bf16 v[148:151], v[84:87], a[4:7], 0
s_add_u32 s70, s0, T_attn - K_pc + 0
s_addc_u32 s71, s1, 0
global_load_dword v57, v9, s[70:71]
v_mfma_f32_16x16x32_bf16 v[136:139], v[88:91], a[0:3], 0
ds_read_b64_tr_b16 v[82:83], v10 offset:19456
v_mul_f32 v176, v64, v176
v_mfma_f32_16x16x32_bf16 v[152:155], v[88:91], a[4:7], 0
s_add_u32 s70, s0, T_attn - K_pc + 8192
s_addc_u32 s71, s1, 0
global_load_dword v57, v9, s[70:71]
v_mfma_f32_16x16x32_bf16 v[140:143], v[92:95], a[0:3], 0
ds_read_b64_tr_b16 v[84:85], v11 offset:3072
v_mul_f32 v177, v65, v177
v_mfma_f32_16x16x32_bf16 v[156:159], v[92:95], a[4:7], 0
ds_read_b64_tr_b16 v[86:87], v11 offset:19456
v_mul_f32 v178, v66, v178
v_mfma_f32_16x16x32_bf16 v[128:131], v[96:99], a[8:11], v[128:131]
ds_read_b64_tr_b16 v[88:89], v12 offset:3072
v_mul_f32 v179, v67, v179
v_mfma_f32_16x16x32_bf16 v[144:147], v[96:99], a[12:15], v[144:147]
ds_read_b64_tr_b16 v[90:91], v12 offset:19456
v_cvt_pk_bf16_f32 v228, v176, v177
v_mfma_f32_16x16x32_bf16 v[132:135], v[100:103], a[8:11], v[132:135]
ds_read_b64_tr_b16 v[92:93], v13 offset:3072
v_cvt_pk_bf16_f32 v229, v178, v179
v_mfma_f32_16x16x32_bf16 v[148:151], v[100:103], a[12:15], v[148:151]
ds_read_b64_tr_b16 v[94:95], v13 offset:19456
s_mul_i32 s3, s101, 7168
v_mfma_f32_16x16x32_bf16 v[136:139], v[104:107], a[8:11], v[136:139]
ds_read_b64_tr_b16 v[96:97], v10 offset:4096
s_add_u32 s3, s3, 0x1800
v_mfma_f32_16x16x32_bf16 v[152:155], v[104:107], a[12:15], v[152:155]
buffer_load_dword v57, v50, s[40:43], s3 offen
v_mfma_f32_16x16x32_bf16 v[140:143], v[108:111], a[8:11], v[140:143]
ds_read_b64_tr_b16 v[98:99], v10 offset:20480
ds_read_b64_tr_b16 v[100:101], v11 offset:4096
v_mfma_f32_16x16x32_bf16 v[156:159], v[108:111], a[12:15], v[156:159]
ds_read_b64_tr_b16 v[102:103], v11 offset:20480
s_waitcnt lgkmcnt(6)
v_mfma_f32_16x16x32_bf16 v[128:131], v[112:115], a[16:19], v[128:131]
buffer_load_dword v57, v50, s[44:47], s3 offen
v_mfma_f32_16x16x32_bf16 v[144:147], v[112:115], a[20:23], v[144:147]
ds_read_b64_tr_b16 v[104:105], v12 offset:4096
ds_read_b64_tr_b16 v[106:107], v12 offset:20480
v_mfma_f32_16x16x32_bf16 v[132:135], v[116:119], a[16:19], v[132:135]
ds_read_b64_tr_b16 v[108:109], v13 offset:4096
s_mul_i32 s3, s101, 1024
v_mfma_f32_16x16x32_bf16 v[148:151], v[116:119], a[20:23], v[148:151]
ds_read_b64_tr_b16 v[110:111], v13 offset:20480
s_add_u32 s3, s3, 0x0
v_mfma_f32_16x16x32_bf16 v[136:139], v[120:123], a[16:19], v[136:139]
buffer_load_dword v57, v50, s[48:51], s3 offen
v_mfma_f32_16x16x32_bf16 v[152:155], v[120:123], a[20:23], v[152:155]
ds_read_b64_tr_b16 v[112:113], v10 offset:5120
ds_read_b64_tr_b16 v[114:115], v10 offset:21504
v_mfma_f32_16x16x32_bf16 v[140:143], v[124:127], a[16:19], v[140:143]
ds_read_b64_tr_b16 v[116:117], v11 offset:5120
v_mul_f32 v180, v64, v180
v_mfma_f32_16x16x32_bf16 v[156:159], v[124:127], a[20:23], v[156:159]
ds_read_b64_tr_b16 v[118:119], v11 offset:21504
v_mul_f32 v181, v65, v181
v_mfma_f32_16x16x32_bf16 v[128:131], v[80:83], a[24:27], v[128:131]
ds_read_b64_tr_b16 v[120:121], v12 offset:5120
v_mul_f32 v182, v66, v182
v_mfma_f32_16x16x32_bf16 v[144:147], v[80:83], a[28:31], v[144:147]
ds_read_b64_tr_b16 v[122:123], v12 offset:21504
v_mul_f32 v183, v67, v183
v_mfma_f32_16x16x32_bf16 v[132:135], v[84:87], a[24:27], v[132:135]
ds_read_b64_tr_b16 v[124:125], v13 offset:5120
v_cvt_pk_bf16_f32 v234, v180, v181
v_mfma_f32_16x16x32_bf16 v[148:151], v[84:87], a[28:31], v[148:151]
ds_read_b64_tr_b16 v[126:127], v13 offset:21504
v_cvt_pk_bf16_f32 v235, v182, v183
v_mfma_f32_16x16x32_bf16 v[136:139], v[88:91], a[24:27], v[136:139]
ds_read_b64_tr_b16 v[80:81], v10 offset:6144
v_mul_f32 v184, v64, v184
v_mfma_f32_16x16x32_bf16 v[152:155], v[88:91], a[28:31], v[152:155]
ds_read_b64_tr_b16 v[82:83], v10 offset:22528
s_waitcnt lgkmcnt(6)
v_mfma_f32_16x16x32_bf16 v[140:143], v[92:95], a[24:27], v[140:143]
ds_read_b64_tr_b16 v[84:85], v11 offset:6144
v_mul_f32 v185, v65, v185
v_mfma_f32_16x16x32_bf16 v[156:159], v[92:95], a[28:31], v[156:159]
ds_read_b64_tr_b16 v[86:87], v11 offset:22528
v_mul_f32 v186, v66, v186
v_mfma_f32_16x16x32_bf16 v[128:131], v[96:99], a[32:35], v[128:131]
ds_read_b64_tr_b16 v[88:89], v12 offset:6144
v_mul_f32 v187, v67, v187
v_mfma_f32_16x16x32_bf16 v[144:147], v[96:99], a[36:39], v[144:147]
ds_read_b64_tr_b16 v[90:91], v12 offset:22528
v_cvt_pk_bf16_f32 v240, v184, v185
v_mfma_f32_16x16x32_bf16 v[132:135], v[100:103], a[32:35], v[132:135]
ds_read_b64_tr_b16 v[92:93], v13 offset:6144
v_cvt_pk_bf16_f32 v241, v186, v187
v_mfma_f32_16x16x32_bf16 v[148:151], v[100:103], a[36:39], v[148:151]
ds_read_b64_tr_b16 v[94:95], v13 offset:22528
v_mul_f32 v188, v64, v188
v_mfma_f32_16x16x32_bf16 v[136:139], v[104:107], a[32:35], v[136:139]
ds_read_b64_tr_b16 v[96:97], v10 offset:7168
v_mul_f32 v189, v65, v189
v_mfma_f32_16x16x32_bf16 v[152:155], v[104:107], a[36:39], v[152:155]
ds_read_b64_tr_b16 v[98:99], v10 offset:23552
v_mul_f32 v190, v66, v190
v_mfma_f32_16x16x32_bf16 v[140:143], v[108:111], a[32:35], v[140:143]
ds_read_b64_tr_b16 v[100:101], v11 offset:7168
v_mul_f32 v191, v67, v191
v_mfma_f32_16x16x32_bf16 v[156:159], v[108:111], a[36:39], v[156:159]
ds_read_b64_tr_b16 v[102:103], v11 offset:23552
v_cvt_pk_bf16_f32 v246, v188, v189
v_mfma_f32_16x16x32_bf16 v[128:131], v[112:115], a[40:43], v[128:131]
ds_read_b64_tr_b16 v[104:105], v12 offset:7168
v_cvt_pk_bf16_f32 v247, v190, v191
v_mfma_f32_16x16x32_bf16 v[144:147], v[112:115], a[44:47], v[144:147]
buffer_store_dwordx2 v[228:229], v73, s[60:63], 0 offen offset:2048 sc1
v_mfma_f32_16x16x32_bf16 v[132:135], v[116:119], a[40:43], v[132:135]
ds_read_b64_tr_b16 v[106:107], v12 offset:23552
ds_read_b64_tr_b16 v[108:109], v13 offset:7168
v_mfma_f32_16x16x32_bf16 v[148:151], v[116:119], a[44:47], v[148:151]
ds_read_b64_tr_b16 v[110:111], v13 offset:23552
s_waitcnt lgkmcnt(6)
v_mfma_f32_16x16x32_bf16 v[136:139], v[120:123], a[40:43], v[136:139]
s_add_u32 m0, s76, 98304
s_add_u32 s77, s82, 0x480000
v_mfma_f32_16x16x32_bf16 v[152:155], v[120:123], a[44:47], v[152:155]
buffer_load_dwordx4 v22, s[32:35], s77 offen offset:0 lds
v_mfma_f32_16x16x32_bf16 v[140:143], v[124:127], a[40:43], v[140:143]
v_mfma_f32_16x16x32_bf16 v[156:159], v[124:127], a[44:47], v[156:159]
v_mfma_f32_16x16x32_bf16 v[128:131], v[80:83], a[48:51], v[128:131]
s_waitcnt vmcnt(18) lgkmcnt(0)
s_barrier
v_mfma_f32_16x16x32_bf16 v[144:147], v[80:83], a[52:55], v[144:147]
ds_read_b64_tr_b16 v[112:113], v10 offset:32768
ds_read_b64_tr_b16 v[114:115], v10 offset:49152
v_mfma_f32_16x16x32_bf16 v[132:135], v[84:87], a[48:51], v[132:135]
ds_read_b64_tr_b16 v[116:117], v11 offset:32768
v_mfma_f32_16x16x32_bf16 v[148:151], v[84:87], a[52:55], v[148:151]
ds_read_b64_tr_b16 v[118:119], v11 offset:49152
ds_read_b64_tr_b16 v[120:121], v12 offset:32768
v_mfma_f32_16x16x32_bf16 v[136:139], v[88:91], a[48:51], v[136:139]
buffer_load_dwordx4 v23, s[32:35], s77 offen offset:1024 lds
v_mfma_f32_16x16x32_bf16 v[152:155], v[88:91], a[52:55], v[152:155]
ds_read_b64_tr_b16 v[122:123], v12 offset:49152
ds_read_b64_tr_b16 v[124:125], v13 offset:32768
v_mfma_f32_16x16x32_bf16 v[140:143], v[92:95], a[48:51], v[140:143]
ds_write_b64 v72, v[228:229] offset:2048
v_mfma_f32_16x16x32_bf16 v[156:159], v[92:95], a[52:55], v[156:159]
ds_read_b64_tr_b16 v[126:127], v13 offset:49152
ds_read_b64_tr_b16 v[80:81], v10 offset:33792
v_mfma_f32_16x16x32_bf16 v[128:131], v[96:99], a[56:59], v[128:131]
buffer_load_dwordx4 v24, s[32:35], s77 offen offset:2048 lds
v_mfma_f32_16x16x32_bf16 v[144:147], v[96:99], a[60:63], v[144:147]
ds_read_b64_tr_b16 v[82:83], v10 offset:50176
ds_read_b64_tr_b16 v[84:85], v11 offset:33792
v_mfma_f32_16x16x32_bf16 v[132:135], v[100:103], a[56:59], v[132:135]
buffer_store_dwordx2 v[234:235], v73, s[60:63], 0 offen offset:2560 sc1
v_mfma_f32_16x16x32_bf16 v[148:151], v[100:103], a[60:63], v[148:151]
ds_read_b64_tr_b16 v[86:87], v11 offset:50176
ds_read_b64_tr_b16 v[88:89], v12 offset:33792
v_mfma_f32_16x16x32_bf16 v[136:139], v[104:107], a[56:59], v[136:139]
buffer_load_dwordx4 v25, s[32:35], s77 offen offset:3072 lds
v_mfma_f32_16x16x32_bf16 v[152:155], v[104:107], a[60:63], v[152:155]
ds_read_b64_tr_b16 v[90:91], v12 offset:50176
ds_read_b64_tr_b16 v[92:93], v13 offset:33792
v_mfma_f32_16x16x32_bf16 v[140:143], v[108:111], a[56:59], v[140:143]
ds_write_b64 v72, v[234:235] offset:2560
v_mfma_f32_16x16x32_bf16 v[156:159], v[108:111], a[60:63], v[156:159]
ds_read_b64_tr_b16 v[94:95], v13 offset:50176
s_waitcnt lgkmcnt(6)
v_mfma_f32_16x16x32_bf16 v[128:131], v[112:115], a[64:67], v[128:131]
ds_read_b64_tr_b16 v[96:97], v10 offset:34816
s_add_u32 m0, s76, 102400
v_mfma_f32_16x16x32_bf16 v[144:147], v[112:115], a[68:71], v[144:147]
ds_read_b64_tr_b16 v[98:99], v10 offset:51200
s_add_u32 s77, s82, 0x540000
v_mfma_f32_16x16x32_bf16 v[132:135], v[116:119], a[64:67], v[132:135]
ds_read_b64_tr_b16 v[100:101], v11 offset:34816
ds_read_b64_tr_b16 v[102:103], v11 offset:51200
v_mfma_f32_16x16x32_bf16 v[148:151], v[116:119], a[68:71], v[148:151]
buffer_load_dwordx4 v22, s[32:35], s77 offen offset:0 lds
v_mfma_f32_16x16x32_bf16 v[136:139], v[120:123], a[64:67], v[136:139]
ds_read_b64_tr_b16 v[104:105], v12 offset:34816
ds_read_b64_tr_b16 v[106:107], v12 offset:51200
v_mfma_f32_16x16x32_bf16 v[152:155], v[120:123], a[68:71], v[152:155]
buffer_store_dwordx2 v[240:241], v73, s[60:63], 0 offen offset:3072 sc1
v_mfma_f32_16x16x32_bf16 v[140:143], v[124:127], a[64:67], v[140:143]
ds_read_b64_tr_b16 v[108:109], v13 offset:34816
ds_read_b64_tr_b16 v[110:111], v13 offset:51200
v_mfma_f32_16x16x32_bf16 v[156:159], v[124:127], a[68:71], v[156:159]
buffer_load_dwordx4 v23, s[32:35], s77 offen offset:1024 lds
v_mfma_f32_16x16x32_bf16 v[128:131], v[80:83], a[72:75], v[128:131]
ds_read_b64_tr_b16 v[112:113], v10 offset:35840
ds_read_b64_tr_b16 v[114:115], v10 offset:52224
v_mfma_f32_16x16x32_bf16 v[144:147], v[80:83], a[76:79], v[144:147]
ds_read_b64_tr_b16 v[116:117], v11 offset:35840
s_waitcnt lgkmcnt(7)
v_mfma_f32_16x16x32_bf16 v[132:135], v[84:87], a[72:75], v[132:135]
ds_write_b64 v72, v[240:241] offset:3072
v_mfma_f32_16x16x32_bf16 v[148:151], v[84:87], a[76:79], v[148:151]
ds_read_b64_tr_b16 v[118:119], v11 offset:52224
ds_read_b64_tr_b16 v[120:121], v12 offset:35840
v_mfma_f32_16x16x32_bf16 v[136:139], v[88:91], a[72:75], v[136:139]
buffer_load_dwordx4 v24, s[32:35], s77 offen offset:2048 lds
v_mfma_f32_16x16x32_bf16 v[152:155], v[88:91], a[76:79], v[152:155]
ds_read_b64_tr_b16 v[122:123], v12 offset:52224
ds_read_b64_tr_b16 v[124:125], v13 offset:35840
v_mfma_f32_16x16x32_bf16 v[140:143], v[92:95], a[72:75], v[140:143]
buffer_store_dwordx2 v[246:247], v73, s[60:63], 0 offen offset:3584 sc1
v_mfma_f32_16x16x32_bf16 v[156:159], v[92:95], a[76:79], v[156:159]
ds_read_b64_tr_b16 v[126:127], v13 offset:52224
ds_read_b64_tr_b16 v[80:81], v10 offset:36864
v_mfma_f32_16x16x32_bf16 v[128:131], v[96:99], a[80:83], v[128:131]
ds_write_b64 v72, v[246:247] offset:3584
v_mfma_f32_16x16x32_bf16 v[144:147], v[96:99], a[84:87], v[144:147]
ds_read_b64_tr_b16 v[82:83], v10 offset:53248
ds_read_b64_tr_b16 v[84:85], v11 offset:36864
v_mfma_f32_16x16x32_bf16 v[132:135], v[100:103], a[80:83], v[132:135]
ds_read_b64_tr_b16 v[86:87], v11 offset:53248
v_mul_f32 v160, v60, v160
v_mfma_f32_16x16x32_bf16 v[148:151], v[100:103], a[84:87], v[148:151]
ds_read_b64_tr_b16 v[88:89], v12 offset:36864
s_waitcnt lgkmcnt(7)
v_mfma_f32_16x16x32_bf16 v[136:139], v[104:107], a[80:83], v[136:139]
buffer_load_dwordx4 v25, s[32:35], s77 offen offset:3072 lds
v_mfma_f32_16x16x32_bf16 v[152:155], v[104:107], a[84:87], v[152:155]
ds_read_b64_tr_b16 v[90:91], v12 offset:53248
ds_read_b64_tr_b16 v[92:93], v13 offset:36864
v_mfma_f32_16x16x32_bf16 v[140:143], v[108:111], a[80:83], v[140:143]
ds_read_b64_tr_b16 v[94:95], v13 offset:53248
s_add_u32 m0, s76, 0
v_mfma_f32_16x16x32_bf16 v[156:159], v[108:111], a[84:87], v[156:159]
ds_read_b64_tr_b16 v[96:97], v10 offset:37888
s_add_u32 s77, s83, 0x0
v_mfma_f32_16x16x32_bf16 v[128:131], v[112:115], a[88:91], v[128:131]
buffer_load_dwordx4 v26, s[36:39], s77 offen offset:0 lds
v_mfma_f32_16x16x32_bf16 v[144:147], v[112:115], a[92:95], v[144:147]
ds_read_b64_tr_b16 v[98:99], v10 offset:54272
ds_read_b64_tr_b16 v[100:101], v11 offset:37888
v_mfma_f32_16x16x32_bf16 v[132:135], v[116:119], a[88:91], v[132:135]
ds_read_b64_tr_b16 v[102:103], v11 offset:54272
v_mul_f32 v161, v61, v161
v_mfma_f32_16x16x32_bf16 v[148:151], v[116:119], a[92:95], v[148:151]
ds_read_b64_tr_b16 v[104:105], v12 offset:37888
ds_read_b64_tr_b16 v[106:107], v12 offset:54272
v_mfma_f32_16x16x32_bf16 v[136:139], v[120:123], a[88:91], v[136:139]
buffer_load_dwordx4 v27, s[36:39], s77 offen offset:1024 lds
v_mfma_f32_16x16x32_bf16 v[152:155], v[120:123], a[92:95], v[152:155]
ds_read_b64_tr_b16 v[108:109], v13 offset:37888
s_waitcnt lgkmcnt(6)
v_mfma_f32_16x16x32_bf16 v[140:143], v[124:127], a[88:91], v[140:143]
ds_read_b64_tr_b16 v[110:111], v13 offset:54272
ds_read_b64_tr_b16 v[112:113], v10 offset:38912
v_mfma_f32_16x16x32_bf16 v[156:159], v[124:127], a[92:95], v[156:159]
ds_read_b64_tr_b16 v[114:115], v10 offset:55296
v_mul_f32 v162, v62, v162
v_mfma_f32_16x16x32_bf16 v[128:131], v[80:83], a[96:99], v[128:131]
buffer_load_dwordx4 v28, s[36:39], s77 offen offset:2048 lds
v_mfma_f32_16x16x32_bf16 v[144:147], v[80:83], a[100:103], v[144:147]
ds_read_b64_tr_b16 v[116:117], v11 offset:38912
ds_read_b64_tr_b16 v[118:119], v11 offset:55296
v_mfma_f32_16x16x32_bf16 v[132:135], v[84:87], a[96:99], v[132:135]
ds_read_b64_tr_b16 v[120:121], v12 offset:38912
v_mul_f32 v163, v63, v163
v_mfma_f32_16x16x32_bf16 v[148:151], v[84:87], a[100:103], v[148:151]
ds_read_b64_tr_b16 v[122:123], v12 offset:55296
ds_read_b64_tr_b16 v[124:125], v13 offset:38912
v_mfma_f32_16x16x32_bf16 v[136:139], v[88:91], a[96:99], v[136:139]
ds_read_b64_tr_b16 v[126:127], v13 offset:55296
v_cvt_pk_bf16_f32 v226, v160, v161
v_mfma_f32_16x16x32_bf16 v[152:155], v[88:91], a[100:103], v[152:155]
buffer_load_dwordx4 v29, s[36:39], s77 offen offset:3072 lds
v_mfma_f32_16x16x32_bf16 v[140:143], v[92:95], a[96:99], v[140:143]
ds_read_b64_tr_b16 v[80:81], v10 offset:39936
ds_read_b64_tr_b16 v[82:83], v10 offset:56320
v_mfma_f32_16x16x32_bf16 v[156:159], v[92:95], a[100:103], v[156:159]
ds_read_b64_tr_b16 v[84:85], v11 offset:39936
s_waitcnt lgkmcnt(7)
v_mfma_f32_16x16x32_bf16 v[128:131], v[96:99], a[104:107], v[128:131]
ds_read_b64_tr_b16 v[86:87], v11 offset:56320
s_add_u32 m0, s76, 4096
v_mfma_f32_16x16x32_bf16 v[144:147], v[96:99], a[108:111], v[144:147]
ds_read_b64_tr_b16 v[88:89], v12 offset:39936
s_add_u32 s77, s83, 0x40000
v_mfma_f32_16x16x32_bf16 v[132:135], v[100:103], a[104:107], v[132:135]
buffer_load_dwordx4 v26, s[36:39], s77 offen offset:0 lds
v_mfma_f32_16x16x32_bf16 v[148:151], v[100:103], a[108:111], v[148:151]
ds_read_b64_tr_b16 v[90:91], v12 offset:56320
ds_read_b64_tr_b16 v[92:93], v13 offset:39936
v_mfma_f32_16x16x32_bf16 v[136:139], v[104:107], a[104:107], v[136:139]
ds_read_b64_tr_b16 v[94:95], v13 offset:56320
v_cvt_pk_bf16_f32 v227, v162, v163
v_mfma_f32_16x16x32_bf16 v[152:155], v[104:107], a[108:111], v[152:155]
v_mul_f32 v164, v60, v164
v_mul_f32 v165, v61, v165
v_mfma_f32_16x16x32_bf16 v[140:143], v[108:111], a[104:107], v[140:143]
buffer_load_dwordx4 v27, s[36:39], s77 offen offset:1024 lds
v_mfma_f32_16x16x32_bf16 v[156:159], v[108:111], a[108:111], v[156:159]
v_mul_f32 v166, v62, v166
v_mul_f32 v167, v63, v167
v_mfma_f32_16x16x32_bf16 v[128:131], v[112:115], a[112:115], v[128:131]
v_cvt_pk_bf16_f32 v232, v164, v165
v_cvt_pk_bf16_f32 v233, v166, v167
v_mfma_f32_16x16x32_bf16 v[144:147], v[112:115], a[116:119], v[144:147]
s_waitcnt vmcnt(24) lgkmcnt(0)
s_barrier
s_mov_b32 s87, 0
s_atomic_add s87, s[60:61], s98 glc
v_mfma_f32_16x16x32_bf16 v[132:135], v[116:119], a[112:115], v[132:135]
ds_read_b64_tr_b16 v[96:97], v14 offset:0
ds_read_b64_tr_b16 v[98:99], v14 offset:16384
v_mfma_f32_16x16x32_bf16 v[148:151], v[116:119], a[116:119], v[148:151]
ds_read_b64_tr_b16 v[100:101], v15 offset:0
ds_read_b64_tr_b16 v[102:103], v15 offset:16384
v_mfma_f32_16x16x32_bf16 v[136:139], v[120:123], a[112:115], v[136:139]
ds_read_b64_tr_b16 v[104:105], v16 offset:0
v_mul_f32 v168, v60, v168
v_mfma_f32_16x16x32_bf16 v[152:155], v[120:123], a[116:119], v[152:155]
ds_read_b64_tr_b16 v[106:107], v16 offset:16384
ds_read_b64_tr_b16 v[108:109], v17 offset:0
v_mfma_f32_16x16x32_bf16 v[140:143], v[124:127], a[112:115], v[140:143]
buffer_load_dwordx4 v28, s[36:39], s77 offen offset:2048 lds
v_mfma_f32_16x16x32_bf16 v[156:159], v[124:127], a[116:119], v[156:159]
ds_read_b64_tr_b16 v[110:111], v17 offset:16384
ds_read_b64_tr_b16 v[112:113], v14 offset:1024
v_mfma_f32_16x16x32_bf16 v[128:131], v[80:83], a[120:123], v[128:131]
ds_read_b64_tr_b16 v[114:115], v14 offset:17408
v_mul_f32 v169, v61, v169
v_mfma_f32_16x16x32_bf16 v[144:147], v[80:83], a[124:127], v[144:147]
ds_read_b64_tr_b16 v[116:117], v15 offset:1024
ds_read_b64_tr_b16 v[118:119], v15 offset:17408
v_mfma_f32_16x16x32_bf16 v[132:135], v[84:87], a[120:123], v[132:135]
buffer_load_dwordx4 v29, s[36:39], s77 offen offset:3072 lds
v_mfma_f32_16x16x32_bf16 v[148:151], v[84:87], a[124:127], v[148:151]
ds_read_b64_tr_b16 v[120:121], v16 offset:1024
ds_read_b64_tr_b16 v[122:123], v16 offset:17408
v_mfma_f32_16x16x32_bf16 v[136:139], v[88:91], a[120:123], v[136:139]
ds_read_b64_tr_b16 v[124:125], v17 offset:1024
s_add_u32 m0, s76, 32768
v_mfma_f32_16x16x32_bf16 v[152:155], v[88:91], a[124:127], v[152:155]
ds_read_b64_tr_b16 v[126:127], v17 offset:17408
s_add_u32 s77, s83, 0x80000
v_mfma_f32_16x16x32_bf16 v[140:143], v[92:95], a[120:123], v[140:143]
buffer_load_dwordx4 v26, s[36:39], s77 offen offset:0 lds
v_mfma_f32_16x16x32_bf16 v[156:159], v[92:95], a[124:127], v[156:159]
ds_read_b64_tr_b16 v[80:81], v14 offset:2048
s_waitcnt lgkmcnt(5)
v_mfma_f32_16x16x32_bf16 v[128:131], v[96:99], a[128:131], v[128:131]
s_waitcnt vmcnt(10)
s_atomic_add s85, s[60:61], s97
v_mfma_f32_16x16x32_bf16 v[144:147], v[96:99], a[132:135], v[144:147]
ds_read_b64_tr_b16 v[82:83], v14 offset:18432
ds_read_b64_tr_b16 v[84:85], v15 offset:2048
v_mfma_f32_16x16x32_bf16 v[132:135], v[100:103], a[128:131], v[132:135]
buffer_load_dwordx4 v27, s[36:39], s77 offen offset:1024 lds
v_mfma_f32_16x16x32_bf16 v[148:151], v[100:103], a[132:135], v[148:151]
ds_read_b64_tr_b16 v[86:87], v15 offset:18432
ds_read_b64_tr_b16 v[88:89], v16 offset:2048
v_mfma_f32_16x16x32_bf16 v[136:139], v[104:107], a[128:131], v[136:139]
ds_read_b64_tr_b16 v[90:91], v16 offset:18432
v_mul_f32 v170, v62, v170
v_mfma_f32_16x16x32_bf16 v[152:155], v[104:107], a[132:135], v[152:155]
ds_read_b64_tr_b16 v[92:93], v17 offset:2048
ds_read_b64_tr_b16 v[94:95], v17 offset:18432
v_mfma_f32_16x16x32_bf16 v[140:143], v[108:111], a[128:131], v[140:143]
buffer_load_dwordx4 v28, s[36:39], s77 offen offset:2048 lds
v_mfma_f32_16x16x32_bf16 v[156:159], v[108:111], a[132:135], v[156:159]
ds_read_b64_tr_b16 v[96:97], v14 offset:3072
ds_read_b64_tr_b16 v[98:99], v14 offset:19456
v_mfma_f32_16x16x32_bf16 v[128:131], v[112:115], a[136:139], v[128:131]
ds_read_b64_tr_b16 v[100:101], v15 offset:3072
v_mul_f32 v171, v63, v171
v_mfma_f32_16x16x32_bf16 v[144:147], v[112:115], a[140:143], v[144:147]
ds_read_b64_tr_b16 v[102:103], v15 offset:19456
ds_read_b64_tr_b16 v[104:105], v16 offset:3072
v_mfma_f32_16x16x32_bf16 v[132:135], v[116:119], a[136:139], v[132:135]
buffer_load_dwordx4 v29, s[36:39], s77 offen offset:3072 lds
v_mfma_f32_16x16x32_bf16 v[148:151], v[116:119], a[140:143], v[148:151]
ds_read_b64_tr_b16 v[106:107], v16 offset:19456
s_waitcnt lgkmcnt(6)
v_mfma_f32_16x16x32_bf16 v[136:139], v[120:123], a[136:139], v[136:139]
ds_read_b64_tr_b16 v[108:109], v17 offset:3072
s_add_u32 m0, s76, 36864
v_mfma_f32_16x16x32_bf16 v[152:155], v[120:123], a[140:143], v[152:155]
ds_read_b64_tr_b16 v[110:111], v17 offset:19456
s_add_u32 s77, s83, 0xc0000
v_mfma_f32_16x16x32_bf16 v[140:143], v[124:127], a[136:139], v[140:143]
buffer_load_dwordx4 v26, s[36:39], s77 offen offset:0 lds
v_mfma_f32_16x16x32_bf16 v[156:159], v[124:127], a[140:143], v[156:159]
ds_read_b64_tr_b16 v[112:113], v14 offset:4096
ds_read_b64_tr_b16 v[114:115], v14 offset:20480
v_mfma_f32_16x16x32_bf16 v[128:131], v[80:83], a[144:147], v[128:131]
ds_read_b64_tr_b16 v[116:117], v15 offset:4096
v_cvt_pk_bf16_f32 v238, v168, v169
v_mfma_f32_16x16x32_bf16 v[144:147], v[80:83], a[148:151], v[144:147]
ds_read_b64_tr_b16 v[118:119], v15 offset:20480
ds_read_b64_tr_b16 v[120:121], v16 offset:4096
v_mfma_f32_16x16x32_bf16 v[132:135], v[84:87], a[144:147], v[132:135]
buffer_load_dwordx4 v27, s[36:39], s77 offen offset:1024 lds
v_mfma_f32_16x16x32_bf16 v[148:151], v[84:87], a[148:151], v[148:151]
ds_read_b64_tr_b16 v[122:123], v16 offset:20480
ds_read_b64_tr_b16 v[124:125], v17 offset:4096
v_mfma_f32_16x16x32_bf16 v[136:139], v[88:91], a[144:147], v[136:139]
ds_read_b64_tr_b16 v[126:127], v17 offset:20480
v_cvt_pk_bf16_f32 v239, v170, v171
v_mfma_f32_16x16x32_bf16 v[152:155], v[88:91], a[148:151], v[152:155]
ds_read_b64_tr_b16 v[80:81], v14 offset:5120
ds_read_b64_tr_b16 v[82:83], v14 offset:21504
v_mfma_f32_16x16x32_bf16 v[140:143], v[92:95], a[144:147], v[140:143]
buffer_load_dwordx4 v28, s[36:39], s77 offen offset:2048 lds
v_mfma_f32_16x16x32_bf16 v[156:159], v[92:95], a[148:151], v[156:159]
ds_read_b64_tr_b16 v[84:85], v15 offset:5120
s_waitcnt lgkmcnt(6)
v_mfma_f32_16x16x32_bf16 v[128:131], v[96:99], a[152:155], v[128:131]
ds_read_b64_tr_b16 v[86:87], v15 offset:21504
ds_read_b64_tr_b16 v[88:89], v16 offset:5120
v_mfma_f32_16x16x32_bf16 v[144:147], v[96:99], a[156:159], v[144:147]
ds_read_b64_tr_b16 v[90:91], v16 offset:21504
v_mul_f32 v172, v60, v172
v_mfma_f32_16x16x32_bf16 v[132:135], v[100:103], a[152:155], v[132:135]
ds_read_b64_tr_b16 v[92:93], v17 offset:5120
v_mul_f32 v173, v61, v173
v_mfma_f32_16x16x32_bf16 v[148:151], v[100:103], a[156:159], v[148:151]
buffer_load_dwordx4 v29, s[36:39], s77 offen offset:3072 lds
v_mfma_f32_16x16x32_bf16 v[136:139], v[104:107], a[152:155], v[136:139]
ds_read_b64_tr_b16 v[94:95], v17 offset:21504
ds_read_b64_tr_b16 v[96:97], v14 offset:6144
v_mfma_f32_16x16x32_bf16 v[152:155], v[104:107], a[156:159], v[152:155]
ds_read_b64_tr_b16 v[98:99], v14 offset:22528
v_mul_f32 v174, v62, v174
v_mfma_f32_16x16x32_bf16 v[140:143], v[108:111], a[152:155], v[140:143]
ds_read_b64_tr_b16 v[100:101], v15 offset:6144
v_mul_f32 v175, v63, v175
v_mfma_f32_16x16x32_bf16 v[156:159], v[108:111], a[156:159], v[156:159]
ds_read_b64_tr_b16 v[102:103], v15 offset:22528
v_cvt_pk_bf16_f32 v244, v172, v173
v_mfma_f32_16x16x32_bf16 v[128:131], v[112:115], a[160:163], v[128:131]
ds_read_b64_tr_b16 v[104:105], v16 offset:6144
v_cvt_pk_bf16_f32 v245, v174, v175
v_mfma_f32_16x16x32_bf16 v[144:147], v[112:115], a[164:167], v[144:147]
ds_read_b64_tr_b16 v[106:107], v16 offset:22528
v_mov_b32 v60, 0x3f803f80
v_mfma_f32_16x16x32_bf16 v[132:135], v[116:119], a[160:163], v[132:135]
ds_read_b64_tr_b16 v[108:109], v17 offset:6144
v_mov_b32 v61, 0x3f803f80
v_mfma_f32_16x16x32_bf16 v[148:151], v[116:119], a[164:167], v[148:151]
ds_read_b64_tr_b16 v[110:111], v17 offset:22528
s_waitcnt lgkmcnt(6)
v_mfma_f32_16x16x32_bf16 v[136:139], v[120:123], a[160:163], v[136:139]
ds_read_b64_tr_b16 v[112:113], v14 offset:7168
v_mov_b32 v62, 0x3f803f80
v_mfma_f32_16x16x32_bf16 v[152:155], v[120:123], a[164:167], v[152:155]
ds_read_b64_tr_b16 v[114:115], v14 offset:23552
v_mov_b32 v63, 0x3f803f80
v_mfma_f32_16x16x32_bf16 v[140:143], v[124:127], a[160:163], v[140:143]
ds_read_b64_tr_b16 v[116:117], v15 offset:7168
ds_read_b64_tr_b16 v[118:119], v15 offset:23552
v_mfma_f32_16x16x32_bf16 v[156:159], v[124:127], a[164:167], v[156:159]
ds_read_b64_tr_b16 v[120:121], v16 offset:7168
v_mfma_f32_16x16x32_bf16 v[128:131], v[80:83], a[168:171], v[128:131]
ds_read_b64_tr_b16 v[122:123], v16 offset:23552
ds_read_b64_tr_b16 v[124:125], v17 offset:7168
v_mfma_f32_16x16x32_bf16 v[144:147], v[80:83], a[172:175], v[144:147]
ds_read_b64_tr_b16 v[126:127], v17 offset:23552
v_mfma_f32_16x16x32_bf16 v[132:135], v[84:87], a[168:171], v[132:135]
v_mfma_f32_16x16x32_bf16 v[148:151], v[84:87], a[172:175], v[148:151]
v_mfma_f32_16x16x32_bf16 v[136:139], v[88:91], a[168:171], v[136:139]
v_mfma_f32_16x16x32_bf16 v[152:155], v[88:91], a[172:175], v[152:155]
v_mfma_f32_16x16x32_bf16 v[140:143], v[92:95], a[168:171], v[140:143]
s_waitcnt vmcnt(16) lgkmcnt(0)
s_barrier
s_cmp_lt_u32 s87, s99
s_cbranch_scc1 pl_1_slow
pl_1_ok:
s_mov_b32 m0, s68
s_nop 0
buffer_load_dwordx4 v68, s[60:63], 0 offen offset:0 sc1 lds
buffer_load_dwordx4 v68, s[60:63], 0 offen offset:1024 sc1 lds
v_mfma_f32_16x16x32_bf16 v[156:159], v[92:95], a[172:175], v[156:159]
ds_read_b64_tr_b16 v[80:81], v14 offset:32768
ds_read_b64_tr_b16 v[82:83], v14 offset:49152
v_mfma_f32_16x16x32_bf16 v[128:131], v[96:99], a[176:179], v[128:131]
ds_read_b64_tr_b16 v[84:85], v15 offset:32768
s_add_u32 m0, s76, 65536
v_mfma_f32_16x16x32_bf16 v[144:147], v[96:99], a[180:183], v[144:147]
ds_read_b64_tr_b16 v[86:87], v15 offset:49152
s_add_u32 s77, s83, 0x100000
v_mfma_f32_16x16x32_bf16 v[132:135], v[100:103], a[176:179], v[132:135]
buffer_load_dwordx4 v26, s[36:39], s77 offen offset:0 lds
v_mfma_f32_16x16x32_bf16 v[148:151], v[100:103], a[180:183], v[148:151]
ds_read_b64_tr_b16 v[88:89], v16 offset:32768
ds_read_b64_tr_b16 v[90:91], v16 offset:49152
v_mfma_f32_16x16x32_bf16 v[136:139], v[104:107], a[176:179], v[136:139]
ds_read_b64_tr_b16 v[92:93], v17 offset:32768
s_lshl_b32 s99, s99, 1
v_mfma_f32_16x16x32_bf16 v[152:155], v[104:107], a[180:183], v[152:155]
ds_read_b64_tr_b16 v[94:95], v17 offset:49152
ds_read_b64_tr_b16 v[96:97], v14 offset:33792
v_mfma_f32_16x16x32_bf16 v[140:143], v[108:111], a[176:179], v[140:143]
ds_read_b64_tr_b16 v[98:99], v14 offset:50176
v_mfma_f32_16x16x32_bf16 v[156:159], v[108:111], a[180:183], v[156:159]
ds_read_b64_tr_b16 v[100:101], v15 offset:33792
ds_read_b64_tr_b16 v[102:103], v15 offset:50176
v_mfma_f32_16x16x32_bf16 v[128:131], v[112:115], a[184:187], v[128:131]
buffer_load_dwordx4 v27, s[36:39], s77 offen offset:1024 lds
v_mfma_f32_16x16x32_bf16 v[144:147], v[112:115], a[188:191], v[144:147]
ds_read_b64_tr_b16 v[104:105], v16 offset:33792
ds_read_b64_tr_b16 v[106:107], v16 offset:50176
v_mfma_f32_16x16x32_bf16 v[132:135], v[116:119], a[184:187], v[132:135]
ds_read_b64_tr_b16 v[108:109], v17 offset:33792
v_mfma_f32_16x16x32_bf16 v[148:151], v[116:119], a[188:191], v[148:151]
ds_read_b64_tr_b16 v[110:111], v17 offset:50176
ds_read_b64_tr_b16 v[112:113], v14 offset:34816
v_mfma_f32_16x16x32_bf16 v[136:139], v[120:123], a[184:187], v[136:139]
ds_read_b64_tr_b16 v[114:115], v14 offset:51200
v_mfma_f32_16x16x32_bf16 v[152:155], v[120:123], a[188:191], v[152:155]
ds_read_b64_tr_b16 v[116:117], v15 offset:34816
ds_read_b64_tr_b16 v[118:119], v15 offset:51200
v_mfma_f32_16x16x32_bf16 v[140:143], v[124:127], a[184:187], v[140:143]
buffer_load_dwordx4 v28, s[36:39], s77 offen offset:2048 lds
v_mfma_f32_16x16x32_bf16 v[156:159], v[124:127], a[188:191], v[156:159]
ds_read_b64_tr_b16 v[120:121], v16 offset:34816
s_waitcnt lgkmcnt(7)
v_mfma_f32_16x16x32_bf16 v[128:131], v[80:83], a[192:195], v[128:131]
ds_read_b64_tr_b16 v[122:123], v16 offset:51200
ds_read_b64_tr_b16 v[124:125], v17 offset:34816
v_mfma_f32_16x16x32_bf16 v[144:147], v[80:83], a[196:199], v[144:147]
ds_read_b64_tr_b16 v[126:127], v17 offset:51200
v_mfma_f32_16x16x32_bf16 v[132:135], v[84:87], a[192:195], v[132:135]
ds_read_b64_tr_b16 v[80:81], v14 offset:35840
v_mfma_f32_16x16x32_bf16 v[148:151], v[84:87], a[196:199], v[148:151]
ds_read_b64_tr_b16 v[82:83], v14 offset:52224
v_mfma_f32_16x16x32_bf16 v[136:139], v[88:91], a[192:195], v[136:139]
buffer_load_dwordx4 v29, s[36:39], s77 offen offset:3072 lds
v_mfma_f32_16x16x32_bf16 v[152:155], v[88:91], a[196:199], v[152:155]
ds_read_b64_tr_b16 v[84:85], v15 offset:35840
ds_read_b64_tr_b16 v[86:87], v15 offset:52224
v_mfma_f32_16x16x32_bf16 v[140:143], v[92:95], a[192:195], v[140:143]
ds_read_b64_tr_b16 v[88:89], v16 offset:35840
v_mfma_f32_16x16x32_bf16 v[156:159], v[92:95], a[196:199], v[156:159]
ds_read_b64_tr_b16 v[90:91], v16 offset:52224
s_add_u32 m0, s76, 69632
v_mfma_f32_16x16x32_bf16 v[128:131], v[96:99], a[200:203], v[128:131]
ds_read_b64_tr_b16 v[92:93], v17 offset:35840
s_add_u32 s77, s83, 0x140000
v_mfma_f32_16x16x32_bf16 v[144:147], v[96:99], a[204:207], v[144:147]
ds_read_b64_tr_b16 v[94:95], v17 offset:52224
v_mfma_f32_16x16x32_bf16 v[132:135], v[100:103], a[200:203], v[132:135]
buffer_load_dwordx4 v26, s[36:39], s77 offen offset:0 lds
v_mfma_f32_16x16x32_bf16 v[148:151], v[100:103], a[204:207], v[148:151]
s_mov_b32 s87, 0
s_atomic_add s87, s[60:61], s98 glc
v_mfma_f32_16x16x32_bf16 v[136:139], v[104:107], a[200:203], v[136:139]
ds_read_b64_tr_b16 v[96:97], v14 offset:36864
ds_read_b64_tr_b16 v[98:99], v14 offset:53248
v_mfma_f32_16x16x32_bf16 v[152:155], v[104:107], a[204:207], v[152:155]
ds_read_b64_tr_b16 v[100:101], v15 offset:36864
s_waitcnt lgkmcnt(5)
v_mfma_f32_16x16x32_bf16 v[140:143], v[108:111], a[200:203], v[140:143]
ds_read_b64_tr_b16 v[102:103], v15 offset:53248
ds_read_b64_tr_b16 v[104:105], v16 offset:36864
v_mfma_f32_16x16x32_bf16 v[156:159], v[108:111], a[204:207], v[156:159]
ds_read_b64_tr_b16 v[106:107], v16 offset:53248
v_mfma_f32_16x16x32_bf16 v[128:131], v[112:115], a[208:211], v[128:131]
buffer_load_dwordx4 v27, s[36:39], s77 offen offset:1024 lds
v_mfma_f32_16x16x32_bf16 v[144:147], v[112:115], a[212:215], v[144:147]
ds_read_b64_tr_b16 v[108:109], v17 offset:36864
ds_read_b64_tr_b16 v[110:111], v17 offset:53248
v_mfma_f32_16x16x32_bf16 v[132:135], v[116:119], a[208:211], v[132:135]
ds_read_b64_tr_b16 v[112:113], v14 offset:37888
v_mfma_f32_16x16x32_bf16 v[148:151], v[116:119], a[212:215], v[148:151]
ds_read_b64_tr_b16 v[114:115], v14 offset:54272
v_mfma_f32_16x16x32_bf16 v[136:139], v[120:123], a[208:211], v[136:139]
ds_read_b64_tr_b16 v[116:117], v15 offset:37888
v_mfma_f32_16x16x32_bf16 v[152:155], v[120:123], a[212:215], v[152:155]
ds_read_b64_tr_b16 v[118:119], v15 offset:54272
v_mfma_f32_16x16x32_bf16 v[140:143], v[124:127], a[208:211], v[140:143]
buffer_load_dwordx4 v28, s[36:39], s77 offen offset:2048 lds
v_mfma_f32_16x16x32_bf16 v[156:159], v[124:127], a[212:215], v[156:159]
ds_read_b64_tr_b16 v[120:121], v16 offset:37888
ds_read_b64_tr_b16 v[122:123], v16 offset:54272
v_mfma_f32_16x16x32_bf16 v[128:131], v[80:83], a[216:219], v[128:131]
ds_read_b64_tr_b16 v[124:125], v17 offset:37888
v_mfma_f32_16x16x32_bf16 v[144:147], v[80:83], a[220:223], v[144:147]
ds_read_b64_tr_b16 v[126:127], v17 offset:54272
v_mfma_f32_16x16x32_bf16 v[132:135], v[84:87], a[216:219], v[132:135]
ds_read_b64_tr_b16 v[80:81], v14 offset:38912
v_mfma_f32_16x16x32_bf16 v[148:151], v[84:87], a[220:223], v[148:151]
ds_read_b64_tr_b16 v[82:83], v14 offset:55296
v_mfma_f32_16x16x32_bf16 v[136:139], v[88:91], a[216:219], v[136:139]
buffer_load_dwordx4 v29, s[36:39], s77 offen offset:3072 lds
v_mfma_f32_16x16x32_bf16 v[152:155], v[88:91], a[220:223], v[152:155]
ds_read_b64_tr_b16 v[84:85], v15 offset:38912
s_waitcnt lgkmcnt(5)
v_mfma_f32_16x16x32_bf16 v[140:143], v[92:95], a[216:219], v[140:143]
ds_read_b64_tr_b16 v[86:87], v15 offset:55296
ds_read_b64_tr_b16 v[88:89], v16 offset:38912
v_mfma_f32_16x16x32_bf16 v[156:159], v[92:95], a[220:223], v[156:159]
ds_read_b64_tr_b16 v[90:91], v16 offset:55296
v_mfma_f32_16x16x32_bf16 v[128:131], v[96:99], a[224:227], v[128:131]
ds_read_b64_tr_b16 v[92:93], v17 offset:38912
v_mfma_f32_16x16x32_bf16 v[144:147], v[96:99], a[228:231], v[144:147]
ds_read_b64_tr_b16 v[94:95], v17 offset:55296
v_mfma_f32_16x16x32_bf16 v[132:135], v[100:103], a[224:227], v[132:135]
ds_read_b64_tr_b16 v[96:97], v14 offset:39936
v_mfma_f32_16x16x32_bf16 v[148:151], v[100:103], a[228:231], v[148:151]
ds_read_b64_tr_b16 v[98:99], v14 offset:56320
v_mfma_f32_16x16x32_bf16 v[136:139], v[104:107], a[224:227], v[136:139]
ds_read_b64_tr_b16 v[100:101], v15 offset:39936
v_mfma_f32_16x16x32_bf16 v[152:155], v[104:107], a[228:231], v[152:155]
ds_read_b64_tr_b16 v[102:103], v15 offset:56320
v_mfma_f32_16x16x32_bf16 v[140:143], v[108:111], a[224:227], v[140:143]
ds_read_b64_tr_b16 v[104:105], v16 offset:39936
v_mfma_f32_16x16x32_bf16 v[156:159], v[108:111], a[228:231], v[156:159]
ds_read_b64_tr_b16 v[106:107], v16 offset:56320
v_mfma_f32_16x16x32_bf16 v[128:131], v[112:115], a[232:235], v[128:131]
ds_read_b64_tr_b16 v[108:109], v17 offset:39936
v_mfma_f32_16x16x32_bf16 v[144:147], v[112:115], a[236:239], v[144:147]
ds_read_b64_tr_b16 v[110:111], v17 offset:56320
v_mfma_f32_16x16x32_bf16 v[132:135], v[116:119], a[232:235], v[132:135]
v_mfma_f32_16x16x32_bf16 v[148:151], v[116:119], a[236:239], v[148:151]
v_mfma_f32_16x16x32_bf16 v[136:139], v[120:123], a[232:235], v[136:139]
v_mfma_f32_16x16x32_bf16 v[152:155], v[120:123], a[236:239], v[152:155]
s_waitcnt lgkmcnt(2)
v_mfma_f32_16x16x32_bf16 v[140:143], v[124:127], a[232:235], v[140:143]
s_waitcnt vmcnt(18) lgkmcnt(0)
s_barrier
s_waitcnt vmcnt(8)
s_cmp_lt_u32 s87, s99
s_cbranch_scc1 pl_2_slow
pl_2_ok:
s_mov_b32 m0, s68
s_nop 0
buffer_load_dwordx4 v68, s[60:63], 0 offen offset:2048 sc1 lds
buffer_load_dwordx4 v68, s[60:63], 0 offen offset:3072 sc1 lds
v_mfma_f32_16x16x32_bf16 v[156:159], v[124:127], a[236:239], v[156:159]
s_add_u32 m0, s76, 98304
s_add_u32 s77, s83, 0x180000
v_mfma_f32_16x16x32_bf16 v[128:131], v[80:83], a[240:243], v[128:131]
buffer_load_dwordx4 v26, s[36:39], s77 offen offset:0 lds
v_mfma_f32_16x16x32_bf16 v[144:147], v[80:83], a[244:247], v[144:147]
ds_read_b128 v[208:211], v74 offset:0
ds_read_b128 v[212:215], v74 offset:1024
v_mfma_f32_16x16x32_bf16 v[132:135], v[84:87], a[240:243], v[132:135]
v_mfma_f32_16x16x32_bf16 v[148:151], v[84:87], a[244:247], v[148:151]
v_mfma_f32_16x16x32_bf16 v[136:139], v[88:91], a[240:243], v[136:139]
buffer_load_dwordx4 v27, s[36:39], s77 offen offset:1024 lds
v_mfma_f32_16x16x32_bf16 v[152:155], v[88:91], a[244:247], v[152:155]
v_mfma_f32_16x16x32_bf16 v[140:143], v[92:95], a[240:243], v[140:143]
v_mfma_f32_16x16x32_bf16 v[156:159], v[92:95], a[244:247], v[156:159]
v_mfma_f32_16x16x32_bf16 v[128:131], v[96:99], a[248:251], v[128:131]
buffer_load_dwordx4 v28, s[36:39], s77 offen offset:2048 lds
v_mfma_f32_16x16x32_bf16 v[144:147], v[96:99], a[252:255], v[144:147]
v_mfma_f32_16x16x32_bf16 v[132:135], v[100:103], a[248:251], v[132:135]
v_mfma_f32_16x16x32_bf16 v[148:151], v[100:103], a[252:255], v[148:151]
v_mfma_f32_16x16x32_bf16 v[136:139], v[104:107], a[248:251], v[136:139]
buffer_load_dwordx4 v29, s[36:39], s77 offen offset:3072 lds
v_mfma_f32_16x16x32_bf16 v[152:155], v[104:107], a[252:255], v[152:155]
s_add_u32 m0, s76, 102400
s_add_u32 s77, s83, 0x1c0000
v_mfma_f32_16x16x32_bf16 v[140:143], v[108:111], a[248:251], v[140:143]
v_mfma_f32_16x16x32_bf16 v[156:159], v[108:111], a[252:255], v[156:159]
T_attn:
s_cmp_lg_u32 s72, 1
s_cbranch_scc1 h0b_noi
s_mov_b32 s4, 0
s_atomic_add s4, s[60:61], s100 offset:16384 glc
s_mov_b32 s5, 0
s_atomic_add s5, s[60:61], s100 offset:18432 glc
s_mov_b32 s6, 0
s_atomic_add s6, s[60:61], s100 offset:20480 glc
s_mov_b32 s7, 0
s_atomic_add s7, s[60:61], s100 offset:22528 glc
s_mov_b32 s8, 0
s_atomic_add s8, s[60:61], s100 offset:24576 glc
s_mov_b32 s9, 0
s_atomic_add s9, s[60:61], s100 offset:26624 glc
s_mov_b32 s10, 0
s_atomic_add s10, s[60:61], s100 offset:28672 glc
s_mov_b32 s11, 0
s_atomic_add s11, s[60:61], s100 offset:30720 glc
h0b_noi:
v_pk_mul_f32 v[128:129], v[128:129], v[4:5] op_sel_hi:[1,0]
v_pk_mul_f32 v[130:131], v[130:131], v[4:5] op_sel_hi:[1,0]
v_pk_mul_f32 v[132:133], v[132:133], v[4:5] op_sel_hi:[1,0]
v_pk_mul_f32 v[134:135], v[134:135], v[4:5] op_sel_hi:[1,0]
v_pk_mul_f32 v[136:137], v[136:137], v[4:5] op_sel_hi:[1,0]
v_pk_mul_f32 v[138:139], v[138:139], v[4:5] op_sel_hi:[1,0]
v_pk_mul_f32 v[140:141], v[140:141], v[4:5] op_sel_hi:[1,0]
v_pk_mul_f32 v[142:143], v[142:143], v[4:5] op_sel_hi:[1,0]
v_pk_mul_f32 v[144:145], v[144:145], v[6:7] op_sel_hi:[1,0]
v_pk_mul_f32 v[146:147], v[146:147], v[6:7] op_sel_hi:[1,0]
v_pk_mul_f32 v[148:149], v[148:149], v[6:7] op_sel_hi:[1,0]
v_pk_mul_f32 v[150:151], v[150:151], v[6:7] op_sel_hi:[1,0]
v_pk_mul_f32 v[152:153], v[152:153], v[6:7] op_sel_hi:[1,0]
v_pk_mul_f32 v[154:155], v[154:155], v[6:7] op_sel_hi:[1,0]
v_pk_mul_f32 v[156:157], v[156:157], v[6:7] op_sel_hi:[1,0]
v_pk_mul_f32 v[158:159], v[158:159], v[6:7] op_sel_hi:[1,0]
buffer_load_dwordx4 v26, s[36:39], s77 offen offset:0 lds
v_cvt_pk_bf16_f32 v80, v128, v129
v_cvt_pk_bf16_f32 v81, v130, v131
v_cvt_pk_bf16_f32 v82, v132, v133
v_cvt_pk_bf16_f32 v83, v134, v135
v_cvt_pk_bf16_f32 v84, v136, v137
v_cvt_pk_bf16_f32 v85, v138, v139
v_cvt_pk_bf16_f32 v86, v140, v141
v_cvt_pk_bf16_f32 v87, v142, v143
v_mfma_f32_16x16x32_bf16 v[164:167], v[192:195], v[80:83], v[42:45]
s_waitcnt lgkmcnt(1)
v_mfma_f32_16x16x32_bf16 v[160:163], v[208:211], v[80:83], v[34:37]
v_cvt_pk_bf16_f32 v88, v144, v145
v_cvt_pk_bf16_f32 v89, v146, v147
v_cvt_pk_bf16_f32 v90, v148, v149
v_cvt_pk_bf16_f32 v91, v150, v151
v_mfma_f32_16x16x32_bf16 v[172:175], v[196:199], v[84:87], v[42:45]
s_waitcnt lgkmcnt(0)
v_mfma_f32_16x16x32_bf16 v[168:171], v[212:215], v[84:87], v[34:37]
v_cvt_pk_bf16_f32 v92, v152, v153
v_cvt_pk_bf16_f32 v93, v154, v155
v_cvt_pk_bf16_f32 v94, v156, v157
v_cvt_pk_bf16_f32 v95, v158, v159
v_mfma_f32_16x16x32_bf16 v[180:183], v[200:203], v[88:91], v[42:45]
v_mfma_f32_16x16x32_bf16 v[176:179], v[192:195], v[88:91], v[30:33]
buffer_load_dwordx4 v27, s[36:39], s77 offen offset:1024 lds
v_mfma_f32_16x16x32_bf16 v[188:191], v[204:207], v[92:95], v[42:45]
v_mfma_f32_16x16x32_bf16 v[184:187], v[196:199], v[92:95], v[30:33]
v_max_f32 v160, v160, v161
v_max_f32 v161, v162, v163
v_max_f32 v162, v164, v165
v_max_f32 v163, v166, v167
v_max3_f32 v112, v160, v161, v162
v_max_f32 v112, v112, v163
v_max_f32 v168, v168, v169
v_max_f32 v169, v170, v171
v_max_f32 v170, v172, v173
v_max_f32 v171, v174, v175
v_max3_f32 v114, v168, v169, v170
v_max_f32 v114, v114, v171
v_max_f32 v176, v176, v177
v_max_f32 v177, v178, v179
v_max_f32 v178, v180, v181
v_max_f32 v179, v182, v183
v_max3_f32 v116, v176, v177, v178
v_max_f32 v116, v116, v179
v_max_f32 v184, v184, v185
v_max_f32 v185, v186, v187
v_max_f32 v186, v188, v189
v_max_f32 v187, v190, v191
v_max3_f32 v118, v184, v185, v186
v_max_f32 v118, v118, v187
buffer_load_dwordx4 v28, s[36:39], s77 offen offset:2048 lds
v_permlane32_swap_b32 v112, v114
v_permlane32_swap_b32 v116, v118
v_max_f32 v112, v112, v114
v_max_f32 v116, v116, v118
s_nop 1
v_permlane16_swap_b32 v112, v116
v_max_f32 v112, v112, v116
v_mov_b32 v116, v112
s_nop 1
v_permlane16_swap_b32 v112, v116
v_mov_b32 v114, v112
v_mov_b32 v118, v116
s_nop 0
v_permlane32_swap_b32 v112, v114
v_permlane32_swap_b32 v116, v118
buffer_load_dwordx4 v29, s[36:39], s77 offen offset:3072 lds
v_pk_add_f32 v[160:161], v[160:161], v[112:113] op_sel_hi:[1,0] neg_lo:[0,1] neg_hi:[0,1]
v_pk_add_f32 v[162:163], v[162:163], v[112:113] op_sel_hi:[1,0] neg_lo:[0,1] neg_hi:[0,1]
v_pk_add_f32 v[168:169], v[168:169], v[114:115] op_sel_hi:[1,0] neg_lo:[0,1] neg_hi:[0,1]
v_pk_add_f32 v[170:171], v[170:171], v[114:115] op_sel_hi:[1,0] neg_lo:[0,1] neg_hi:[0,1]
v_pk_add_f32 v[176:177], v[176:177], v[116:117] op_sel_hi:[1,0] neg_lo:[0,1] neg_hi:[0,1]
v_pk_add_f32 v[178:179], v[178:179], v[116:117] op_sel_hi:[1,0] neg_lo:[0,1] neg_hi:[0,1]
v_pk_add_f32 v[184:185], v[184:185], v[118:119] op_sel_hi:[1,0] neg_lo:[0,1] neg_hi:[0,1]
v_pk_add_f32 v[186:187], v[186:187], v[118:119] op_sel_hi:[1,0] neg_lo:[0,1] neg_hi:[0,1]
v_exp_f32 v160, v160
v_exp_f32 v161, v161
v_exp_f32 v162, v162
v_exp_f32 v163, v163
v_exp_f32 v168, v168
v_exp_f32 v169, v169
v_exp_f32 v170, v170
v_exp_f32 v171, v171
v_exp_f32 v176, v176
v_exp_f32 v177, v177
v_exp_f32 v178, v178
v_exp_f32 v179, v179
v_exp_f32 v184, v184
v_exp_f32 v185, v185
v_exp_f32 v186, v186
v_exp_f32 v187, v187
s_waitcnt vmcnt(8)
ds_read_b64 v[224:225], v75 offset:2048
ds_read_b64 v[230:231], v75 offset:2560
ds_read_b64 v[236:237], v75 offset:3072
ds_read_b64 v[242:243], v75 offset:3584
v_cvt_pk_bf16_f32 v176, v176, v177
v_cvt_pk_bf16_f32 v178, v178, v179
v_perm_b32 v104, v176, v176, v51
v_perm_b32 v105, v176, v176, v55
v_perm_b32 v106, v178, v178, v51
v_perm_b32 v107, v178, v178, v55
v_cvt_pk_bf16_f32 v184, v184, v185
v_cvt_pk_bf16_f32 v186, v186, v187
v_perm_b32 v108, v184, v184, v51
v_perm_b32 v109, v184, v184, v55
v_perm_b32 v110, v186, v186, v51
v_perm_b32 v111, v186, v186, v55
v_cvt_pk_bf16_f32 v160, v160, v161
v_cvt_pk_bf16_f32 v162, v162, v163
v_perm_b32 v96, v160, v160, v51
v_perm_b32 v97, v160, v160, v55
v_perm_b32 v98, v162, v162, v51
v_perm_b32 v99, v162, v162, v55
v_cvt_pk_bf16_f32 v168, v168, v169
v_cvt_pk_bf16_f32 v170, v170, v171
v_perm_b32 v100, v168, v168, v51
v_perm_b32 v101, v168, v168, v55
v_perm_b32 v102, v170, v170, v51
v_perm_b32 v103, v170, v170, v55
v_mfma_f32_16x16x32_bf16 v[180:183], v[60:63], v[104:107], 0
v_mfma_f32_16x16x32_bf16 v[144:147], v[226:229], v[104:107], 0
v_mfma_f32_16x16x32_bf16 v[148:151], v[232:235], v[104:107], 0
v_mfma_f32_16x16x32_bf16 v[188:191], v[60:63], v[108:111], 0
v_mfma_f32_16x16x32_bf16 v[152:155], v[238:241], v[108:111], 0
v_mfma_f32_16x16x32_bf16 v[156:159], v[244:247], v[108:111], 0
v_mfma_f32_16x16x32_bf16 v[164:167], v[60:63], v[96:99], 0
s_waitcnt lgkmcnt(3)
v_mfma_f32_16x16x32_bf16 v[128:131], v[224:227], v[96:99], 0
s_waitcnt lgkmcnt(2)
v_mfma_f32_16x16x32_bf16 v[132:135], v[230:233], v[96:99], 0
v_mfma_f32_16x16x32_bf16 v[172:175], v[60:63], v[100:103], 0
s_waitcnt lgkmcnt(1)
v_mfma_f32_16x16x32_bf16 v[136:139], v[236:239], v[100:103], 0
s_waitcnt lgkmcnt(0)
v_mfma_f32_16x16x32_bf16 v[140:143], v[242:245], v[100:103], 0
v_rcp_f32 v116, v180
v_rcp_f32 v118, v188
v_rcp_f32 v112, v164
s_nop 0
v_rcp_f32 v114, v172
v_pk_mul_f32 v[144:145], v[144:145], v[116:117] op_sel_hi:[1,0]
v_pk_mul_f32 v[146:147], v[146:147], v[116:117] op_sel_hi:[1,0]
v_pk_mul_f32 v[148:149], v[148:149], v[116:117] op_sel_hi:[1,0]
v_pk_mul_f32 v[150:151], v[150:151], v[116:117] op_sel_hi:[1,0]
v_cvt_pk_bf16_f32 v88, v144, v145
v_cvt_pk_bf16_f32 v89, v146, v147
v_cvt_pk_bf16_f32 v90, v148, v149
v_cvt_pk_bf16_f32 v91, v150, v151
buffer_store_dwordx4 v[88:91], v46, s[60:63], s91 offen offset:1024 sc1
v_pk_mul_f32 v[152:153], v[152:153], v[118:119] op_sel_hi:[1,0]
v_pk_mul_f32 v[154:155], v[154:155], v[118:119] op_sel_hi:[1,0]
v_pk_mul_f32 v[156:157], v[156:157], v[118:119] op_sel_hi:[1,0]
v_pk_mul_f32 v[158:159], v[158:159], v[118:119] op_sel_hi:[1,0]
v_cvt_pk_bf16_f32 v92, v152, v153
v_cvt_pk_bf16_f32 v93, v154, v155
v_cvt_pk_bf16_f32 v94, v156, v157
v_cvt_pk_bf16_f32 v95, v158, v159
buffer_store_dwordx4 v[92:95], v46, s[60:63], s91 offen offset:3072 sc1
v_pk_mul_f32 v[128:129], v[128:129], v[112:113] op_sel_hi:[1,0]
v_pk_mul_f32 v[130:131], v[130:131], v[112:113] op_sel_hi:[1,0]
v_pk_mul_f32 v[132:133], v[132:133], v[112:113] op_sel_hi:[1,0]
v_pk_mul_f32 v[134:135], v[134:135], v[112:113] op_sel_hi:[1,0]
v_cvt_pk_bf16_f32 v80, v128, v129
v_cvt_pk_bf16_f32 v81, v130, v131
v_cvt_pk_bf16_f32 v82, v132, v133
v_cvt_pk_bf16_f32 v83, v134, v135
buffer_store_dwordx4 v[80:83], v46, s[60:63], s91 offen offset:0 sc1
v_pk_mul_f32 v[136:137], v[136:137], v[114:115] op_sel_hi:[1,0]
v_pk_mul_f32 v[138:139], v[138:139], v[114:115] op_sel_hi:[1,0]
v_pk_mul_f32 v[140:141], v[140:141], v[114:115] op_sel_hi:[1,0]
v_pk_mul_f32 v[142:143], v[142:143], v[114:115] op_sel_hi:[1,0]
v_cvt_pk_bf16_f32 v84, v136, v137
v_cvt_pk_bf16_f32 v85, v138, v139
v_cvt_pk_bf16_f32 v86, v140, v141
v_cvt_pk_bf16_f32 v87, v142, v143
buffer_store_dwordx4 v[84:87], v46, s[60:63], s91 offen offset:2048 sc1
s_cmp_lg_u32 s72, 1
s_cbranch_scc1 h0b_done
s_mov_b32 s81, 0
h0b_loop:
s_min_u32 s4, s4, s5
s_min_u32 s4, s4, s6
s_min_u32 s4, s4, s7
s_min_u32 s4, s4, s8
s_min_u32 s4, s4, s9
s_min_u32 s4, s4, s10
s_min_u32 s4, s4, s11
s_cmp_ge_u32 s4, 32
s_cbranch_scc1 h0b_done
s_mov_b32 s4, 0
s_atomic_add s4, s[60:61], s100 offset:16384 glc
s_mov_b32 s5, 0
s_atomic_add s5, s[60:61], s100 offset:18432 glc
s_mov_b32 s6, 0
s_atomic_add s6, s[60:61], s100 offset:20480 glc
s_mov_b32 s7, 0
s_atomic_add s7, s[60:61], s100 offset:22528 glc
s_mov_b32 s8, 0
s_atomic_add s8, s[60:61], s100 offset:24576 glc
s_mov_b32 s9, 0
s_atomic_add s9, s[60:61], s100 offset:26624 glc
s_mov_b32 s10, 0
s_atomic_add s10, s[60:61], s100 offset:28672 glc
s_mov_b32 s11, 0
s_atomic_add s11, s[60:61], s100 offset:30720 glc
s_add_u32 s81, s81, 1
s_cmp_lt_u32 s81, 0x400000
s_waitcnt lgkmcnt(0)
s_cbranch_scc1 h0b_loop
h0b_done:
s_waitcnt vmcnt(4)
s_barrier
v_lshlrev_b32 v2, 4, v0
s_mov_b32 s78, 0x91000
buffer_load_dwordx4 v[160:163], v2, s[60:63], s78 offen sc1
s_mov_b32 s78, 0x95000
buffer_load_dwordx4 v[164:167], v2, s[60:63], s78 offen sc1
s_mov_b32 s78, 0x99000
buffer_load_dwordx4 v[168:171], v2, s[60:63], s78 offen sc1
s_mov_b32 s78, 0x9d000
buffer_load_dwordx4 v[172:175], v2, s[60:63], s78 offen sc1
s_mov_b32 s78, 0x92000
buffer_load_dwordx4 v[176:179], v2, s[60:63], s78 offen sc1
s_mov_b32 s78, 0x96000
buffer_load_dwordx4 v[180:183], v2, s[60:63], s78 offen sc1
s_mov_b32 s78, 0x9a000
buffer_load_dwordx4 v[184:187], v2, s[60:63], s78 offen sc1
s_mov_b32 s78, 0x9e000
buffer_load_dwordx4 v[188:191], v2, s[60:63], s78 offen sc1
s_lshl_b32 s78, s75, 8
v_and_b32 v7, 15, v1
v_lshl_add_u32 v7, v7, 4, s78
v_bfe_u32 v6, v1, 4, 1
v_mul_u32_u24 v6, 12288, v6
v_add_u32 v7, v7, v6
s_mov_b32 s78, 0x90000
buffer_load_dwordx4 v[192:195], v7, s[60:63], s78 offen sc1
s_mov_b32 s78, 0x94000
buffer_load_dwordx4 v[196:199], v7, s[60:63], s78 offen sc1
s_mov_b32 s78, 0x98000
buffer_load_dwordx4 v[200:203], v7, s[60:63], s78 offen sc1
s_mov_b32 s78, 0x9c000
buffer_load_dwordx4 v[204:207], v7, s[60:63], s78 offen sc1
ds_read_b64_tr_b16 v[112:113], v10 offset:0
ds_read_b64_tr_b16 v[114:115], v10 offset:16384
ds_read_b64_tr_b16 v[116:117], v11 offset:0
ds_read_b64_tr_b16 v[118:119], v11 offset:16384
ds_read_b64_tr_b16 v[120:121], v12 offset:0
ds_read_b64_tr_b16 v[122:123], v12 offset:16384
ds_read_b64_tr_b16 v[124:125], v13 offset:0
ds_read_b64_tr_b16 v[126:127], v13 offset:16384
ds_read_b64_tr_b16 v[80:81], v10 offset:1024
ds_read_b64_tr_b16 v[82:83], v10 offset:17408
ds_read_b64_tr_b16 v[84:85], v11 offset:1024
ds_read_b64_tr_b16 v[86:87], v11 offset:17408
ds_read_b64_tr_b16 v[88:89], v12 offset:1024
ds_read_b64_tr_b16 v[90:91], v12 offset:17408
ds_read_b64_tr_b16 v[92:93], v13 offset:1024
ds_read_b64_tr_b16 v[94:95], v13 offset:17408
s_waitcnt vmcnt(12)
s_mov_b32 s87, 1
s_atomic_add s87, s[60:61], s90 glc
s_waitcnt lgkmcnt(0)
s_cmp_lt_u32 s87, 15
s_cbranch_scc1 pl_3_slow
pl_3_ok:
s_add_u32 s91, s88, 0x200000
buffer_load_dwordx4 a[0:3], v46, s[60:63], s91 offen offset:0 sc1
buffer_load_dwordx4 a[4:7], v46, s[60:63], s91 offen offset:1024 sc1
buffer_load_dwordx4 a[8:11], v46, s[60:63], s91 offen offset:2048 sc1
buffer_load_dwordx4 a[12:15], v46, s[60:63], s91 offen offset:3072 sc1
s_add_u32 s91, s88, 0x201000
buffer_load_dwordx4 a[16:19], v46, s[60:63], s91 offen offset:0 sc1
buffer_load_dwordx4 a[20:23], v46, s[60:63], s91 offen offset:1024 sc1
buffer_load_dwordx4 a[24:27], v46, s[60:63], s91 offen offset:2048 sc1
buffer_load_dwordx4 a[28:31], v46, s[60:63], s91 offen offset:3072 sc1
s_add_u32 s91, s88, 0x202000
buffer_load_dwordx4 a[32:35], v46, s[60:63], s91 offen offset:0 sc1
buffer_load_dwordx4 a[36:39], v46, s[60:63], s91 offen offset:1024 sc1
buffer_load_dwordx4 a[40:43], v46, s[60:63], s91 offen offset:2048 sc1
buffer_load_dwordx4 a[44:47], v46, s[60:63], s91 offen offset:3072 sc1
s_add_u32 s91, s88, 0x203000
buffer_load_dwordx4 a[48:51], v46, s[60:63], s91 offen offset:0 sc1
buffer_load_dwordx4 a[52:55], v46, s[60:63], s91 offen offset:1024 sc1
v_lshrrev_b32 v2, 3, v0
v_and_b32 v3, 3, v0
v_bfe_u32 v4, v0, 2, 1
v_mul_u32_u24 v5, 272, v2
v_lshl_add_u32 v5, v3, 6, v5
v_add_u32 v5, 131072, v5
v_mul_u32_u24 v6, 16392, v4
v_add_u32 v6, v5, v6
v_xor_b32 v5, 8, v6
v_mov_b32 v225, 0
v_mov_b32 v227, 0
v_mov_b32 v228, 0
v_mov_b32 v230, 0
s_waitcnt vmcnt(24)
v_pk_add_f32 v[160:161], v[160:161], v[164:165]
s_waitcnt vmcnt(22)
v_pk_add_f32 v[168:169], v[168:169], v[172:173]
v_pk_add_f32 v[162:163], v[162:163], v[166:167]
v_pk_add_f32 v[170:171], v[170:171], v[174:175]
v_pk_add_f32 v[160:161], v[160:161], v[168:169]
v_pk_add_f32 v[162:163], v[162:163], v[170:171]
s_waitcnt vmcnt(20)
v_pk_add_f32 v[176:177], v[176:177], v[180:181]
s_waitcnt vmcnt(18)
v_pk_add_f32 v[184:185], v[184:185], v[188:189]
v_pk_add_f32 v[178:179], v[178:179], v[182:183]
v_pk_add_f32 v[186:187], v[186:187], v[190:191]
v_pk_add_f32 v[176:177], v[176:177], v[184:185]
v_pk_add_f32 v[178:179], v[178:179], v[186:187]
v_cvt_pk_bf16_f32 v180, v176, v177
v_cvt_pk_bf16_f32 v182, v178, v179
v_lshlrev_b32 v176, 16, v180
v_and_b32 v177, 0xffff0000, v180
v_lshlrev_b32 v178, 16, v182
v_and_b32 v179, 0xffff0000, v182
v_add_f32 v176, 1.0, v176
v_add_f32 v177, 1.0, v177
v_add_f32 v178, 1.0, v178
v_add_f32 v179, 1.0, v179
v_cvt_pk_bf16_f32 v232, v160, v176
v_cvt_pk_bf16_f32 v233, v161, v177
v_cvt_pk_bf16_f32 v234, v162, v178
v_cvt_pk_bf16_f32 v235, v163, v179
v_lshrrev_b32 v224, 16, v232
v_and_b32 v226, 0xffff0000, v233
v_lshrrev_b32 v229, 16, v234
v_and_b32 v231, 0xffff0000, v235
ds_write_b64 v5, v[224:225] offset:0
ds_write_b64 v5, v[226:227] offset:16
ds_write_b64 v5, v[228:229] offset:32
ds_write_b64 v5, v[230:231] offset:48
ds_write2_b32 v6, v232, v225 offset0:0 offset1:1
ds_write2_b32 v6, v233, v225 offset0:4 offset1:5
ds_write2_b32 v6, v234, v225 offset0:8 offset1:9
ds_write2_b32 v6, v235, v225 offset0:12 offset1:13
s_waitcnt vmcnt(16)
v_pk_add_f32 v[192:193], v[192:193], v[196:197]
s_waitcnt vmcnt(14)
v_pk_add_f32 v[200:201], v[200:201], v[204:205]
v_pk_add_f32 v[194:195], v[194:195], v[198:199]
v_pk_add_f32 v[202:203], v[202:203], v[206:207]
v_pk_add_f32 v[192:193], v[192:193], v[200:201]
v_pk_add_f32 v[194:195], v[194:195], v[202:203]
v_cvt_pk_bf16_f32 v196, v192, v193
v_cvt_pk_bf16_f32 v198, v194, v195
v_lshlrev_b32 v192, 16, v196
S_O:
s_waitcnt vmcnt(13)
v_mfma_f32_16x16x32_bf16 v[128:131], v[112:115], a[0:3], 0
ds_read_b64_tr_b16 v[96:97], v10 offset:2048
ds_read_b64_tr_b16 v[98:99], v10 offset:18432
s_waitcnt vmcnt(12)
v_mfma_f32_16x16x32_bf16 v[144:147], v[112:115], a[4:7], 0
buffer_load_dwordx4 a[56:59], v46, s[60:63], s91 offen offset:2048 sc1
ds_read_b64_tr_b16 v[100:101], v11 offset:2048
v_mfma_f32_16x16x32_bf16 v[132:135], v[116:119], a[0:3], 0
ds_read_b64_tr_b16 v[102:103], v11 offset:18432
ds_read_b64_tr_b16 v[104:105], v12 offset:2048
ds_read_b64_tr_b16 v[106:107], v12 offset:18432
v_mfma_f32_16x16x32_bf16 v[148:151], v[116:119], a[4:7], 0
ds_read_b64_tr_b16 v[108:109], v13 offset:2048
v_and_b32 v193, 0xffff0000, v196
v_lshlrev_b32 v194, 16, v198
v_mfma_f32_16x16x32_bf16 v[136:139], v[120:123], a[0:3], 0
ds_read_b64_tr_b16 v[110:111], v13 offset:18432
ds_read_b64_tr_b16 v[112:113], v10 offset:3072
v_and_b32 v195, 0xffff0000, v198
v_mfma_f32_16x16x32_bf16 v[152:155], v[120:123], a[4:7], 0
buffer_load_dwordx4 a[60:63], v46, s[60:63], s91 offen offset:3072 sc1
ds_read_b64_tr_b16 v[114:115], v10 offset:19456
v_mfma_f32_16x16x32_bf16 v[140:143], v[124:127], a[0:3], 0
ds_read_b64_tr_b16 v[116:117], v11 offset:3072
v_and_b32 v7, 0x1f0, v46
v_add_u32 v7, 144384, v7
v_mfma_f32_16x16x32_bf16 v[156:159], v[124:127], a[4:7], 0
ds_write_b128 v7, v[192:195]
s_waitcnt vmcnt(13)
v_mfma_f32_16x16x32_bf16 v[128:131], v[80:83], a[8:11], v[128:131]
ds_read_b64_tr_b16 v[118:119], v11 offset:19456
ds_read_b64_tr_b16 v[120:121], v12 offset:3072
s_waitcnt vmcnt(12)
v_mfma_f32_16x16x32_bf16 v[144:147], v[80:83], a[12:15], v[144:147]
s_add_u32 s91, s88, 0x204000
buffer_load_dwordx4 a[64:67], v46, s[60:63], s91 offen offset:0 sc1
v_mfma_f32_16x16x32_bf16 v[132:135], v[84:87], a[8:11], v[132:135]
ds_read_b64_tr_b16 v[122:123], v12 offset:19456
ds_read_b64_tr_b16 v[124:125], v13 offset:3072
v_and_b32 v56, 48, v1
v_mfma_f32_16x16x32_bf16 v[148:151], v[84:87], a[12:15], v[148:151]
ds_read_b64_tr_b16 v[126:127], v13 offset:19456
v_add_u32 v56, 144384, v56
ds_read_b128 v[192:195], v56 offset:0
v_mfma_f32_16x16x32_bf16 v[136:139], v[88:91], a[8:11], v[136:139]
ds_read_b64_tr_b16 v[80:81], v10 offset:4096
ds_read_b128 v[196:199], v56 offset:64
ds_read_b128 v[200:203], v56 offset:128
v_mfma_f32_16x16x32_bf16 v[152:155], v[88:91], a[12:15], v[152:155]
buffer_load_dwordx4 a[68:71], v46, s[60:63], s91 offen offset:1024 sc1
ds_read_b64_tr_b16 v[82:83], v10 offset:20480
v_mfma_f32_16x16x32_bf16 v[140:143], v[92:95], a[8:11], v[140:143]
ds_read_b64_tr_b16 v[84:85], v11 offset:4096
ds_read_b128 v[204:207], v56 offset:192
v_lshlrev_b32 v160, 16, v216
v_mfma_f32_16x16x32_bf16 v[156:159], v[92:95], a[12:15], v[156:159]
ds_read_b64_tr_b16 v[86:87], v11 offset:20480
v_and_b32 v161, 0xffff0000, v216
s_waitcnt vmcnt(13) lgkmcnt(11)
v_mfma_f32_16x16x32_bf16 v[128:131], v[96:99], a[16:19], v[128:131]
ds_read_b64_tr_b16 v[88:89], v12 offset:4096
v_lshlrev_b32 v162, 16, v217
s_waitcnt vmcnt(12)
v_mfma_f32_16x16x32_bf16 v[144:147], v[96:99], a[20:23], v[144:147]
buffer_load_dwordx4 a[72:75], v46, s[60:63], s91 offen offset:2048 sc1
ds_read_b64_tr_b16 v[90:91], v12 offset:20480
v_mfma_f32_16x16x32_bf16 v[132:135], v[100:103], a[16:19], v[132:135]
ds_read_b64_tr_b16 v[92:93], v13 offset:4096
v_and_b32 v163, 0xffff0000, v217
v_lshlrev_b32 v164, 16, v218
v_mfma_f32_16x16x32_bf16 v[148:151], v[100:103], a[20:23], v[148:151]
ds_read_b64_tr_b16 v[94:95], v13 offset:20480
v_and_b32 v165, 0xffff0000, v218
v_lshlrev_b32 v166, 16, v219
v_mfma_f32_16x16x32_bf16 v[136:139], v[104:107], a[16:19], v[136:139]
ds_read_b64_tr_b16 v[96:97], v10 offset:5120
v_and_b32 v167, 0xffff0000, v219
v_lshlrev_b32 v168, 16, v220
v_mfma_f32_16x16x32_bf16 v[152:155], v[104:107], a[20:23], v[152:155]
buffer_load_dwordx4 a[76:79], v46, s[60:63], s91 offen offset:3072 sc1
ds_read_b64_tr_b16 v[98:99], v10 offset:21504
v_mfma_f32_16x16x32_bf16 v[140:143], v[108:111], a[16:19], v[140:143]
ds_read_b64_tr_b16 v[100:101], v11 offset:5120
v_and_b32 v169, 0xffff0000, v220
v_lshlrev_b32 v170, 16, v221
v_mfma_f32_16x16x32_bf16 v[156:159], v[108:111], a[20:23], v[156:159]
ds_read_b64_tr_b16 v[102:103], v11 offset:21504
v_and_b32 v171, 0xffff0000, v221
s_waitcnt vmcnt(13)
v_mfma_f32_16x16x32_bf16 v[128:131], v[112:115], a[24:27], v[128:131]
ds_read_b64_tr_b16 v[104:105], v12 offset:5120
v_lshlrev_b32 v172, 16, v222
s_waitcnt vmcnt(12)
v_mfma_f32_16x16x32_bf16 v[144:147], v[112:115], a[28:31], v[144:147]
s_add_u32 s91, s88, 0x205000
buffer_load_dwordx4 a[80:83], v46, s[60:63], s91 offen offset:0 sc1
v_mfma_f32_16x16x32_bf16 v[132:135], v[116:119], a[24:27], v[132:135]
ds_read_b64_tr_b16 v[106:107], v12 offset:21504
ds_read_b64_tr_b16 v[108:109], v13 offset:5120
v_and_b32 v173, 0xffff0000, v222
v_mfma_f32_16x16x32_bf16 v[148:151], v[116:119], a[28:31], v[148:151]
ds_read_b64_tr_b16 v[110:111], v13 offset:21504
v_lshlrev_b32 v174, 16, v223
s_waitcnt lgkmcnt(6)
v_mfma_f32_16x16x32_bf16 v[136:139], v[120:123], a[24:27], v[136:139]
ds_read_b64_tr_b16 v[112:113], v10 offset:6144
v_and_b32 v175, 0xffff0000, v223
v_lshlrev_b32 v176, 16, v248
v_mfma_f32_16x16x32_bf16 v[152:155], v[120:123], a[28:31], v[152:155]
buffer_load_dwordx4 a[84:87], v46, s[60:63], s91 offen offset:1024 sc1
ds_read_b64_tr_b16 v[114:115], v10 offset:22528
v_mfma_f32_16x16x32_bf16 v[140:143], v[124:127], a[24:27], v[140:143]
ds_read_b64_tr_b16 v[116:117], v11 offset:6144
v_and_b32 v177, 0xffff0000, v248
v_lshlrev_b32 v178, 16, v249
v_mfma_f32_16x16x32_bf16 v[156:159], v[124:127], a[28:31], v[156:159]
ds_read_b64_tr_b16 v[118:119], v11 offset:22528
v_and_b32 v179, 0xffff0000, v249
s_waitcnt vmcnt(13)
v_mfma_f32_16x16x32_bf16 v[128:131], v[80:83], a[32:35], v[128:131]
ds_read_b64_tr_b16 v[120:121], v12 offset:6144
v_lshlrev_b32 v180, 16, v250
s_waitcnt vmcnt(12)
v_mfma_f32_16x16x32_bf16 v[144:147], v[80:83], a[36:39], v[144:147]
buffer_load_dwordx4 a[88:91], v46, s[60:63], s91 offen offset:2048 sc1
ds_read_b64_tr_b16 v[122:123], v12 offset:22528
v_mfma_f32_16x16x32_bf16 v[132:135], v[84:87], a[32:35], v[132:135]
ds_read_b64_tr_b16 v[124:125], v13 offset:6144
v_and_b32 v181, 0xffff0000, v250
v_lshlrev_b32 v182, 16, v251
v_mfma_f32_16x16x32_bf16 v[148:151], v[84:87], a[36:39], v[148:151]
ds_read_b64_tr_b16 v[126:127], v13 offset:22528
v_and_b32 v183, 0xffff0000, v251
v_lshlrev_b32 v184, 16, v252
v_mfma_f32_16x16x32_bf16 v[136:139], v[88:91], a[32:35], v[136:139]
ds_read_b64_tr_b16 v[80:81], v10 offset:7168
v_and_b32 v185, 0xffff0000, v252
v_lshlrev_b32 v186, 16, v253
v_mfma_f32_16x16x32_bf16 v[152:155], v[88:91], a[36:39], v[152:155]
buffer_load_dwordx4 a[92:95], v46, s[60:63], s91 offen offset:3072 sc1
ds_read_b64_tr_b16 v[82:83], v10 offset:23552
v_mfma_f32_16x16x32_bf16 v[140:143], v[92:95], a[32:35], v[140:143]
ds_read_b64_tr_b16 v[84:85], v11 offset:7168
v_and_b32 v187, 0xffff0000, v253
v_lshlrev_b32 v188, 16, v254
v_mfma_f32_16x16x32_bf16 v[156:159], v[92:95], a[36:39], v[156:159]
ds_read_b64_tr_b16 v[86:87], v11 offset:23552
v_and_b32 v189, 0xffff0000, v254
s_waitcnt vmcnt(13)
v_mfma_f32_16x16x32_bf16 v[128:131], v[96:99], a[40:43], v[128:131]
ds_read_b64_tr_b16 v[88:89], v12 offset:7168
v_lshlrev_b32 v190, 16, v255
s_waitcnt vmcnt(12)
v_mfma_f32_16x16x32_bf16 v[144:147], v[96:99], a[44:47], v[144:147]
s_add_u32 s91, s88, 0x206000
buffer_load_dwordx4 a[96:99], v46, s[60:63], s91 offen offset:0 sc1
s_waitcnt lgkmcnt(5)
v_mfma_f32_16x16x32_bf16 v[132:135], v[100:103], a[40:43], v[132:135]
ds_read_b64_tr_b16 v[90:91], v12 offset:23552
ds_read_b64_tr_b16 v[92:93], v13 offset:7168
v_and_b32 v191, 0xffff0000, v255
v_mfma_f32_16x16x32_bf16 v[148:151], v[100:103], a[44:47], v[148:151]
ds_read_b64_tr_b16 v[94:95], v13 offset:23552
v_mov_b32 v208, 0x3f803f80
v_mov_b32 v209, 0x3f803f80
v_mfma_f32_16x16x32_bf16 v[136:139], v[104:107], a[40:43], v[136:139]
ds_read_b64_tr_b16 v[96:97], v10 offset:32768
v_mov_b32 v210, 0x3f803f80
v_mov_b32 v211, 0x3f803f80
v_mfma_f32_16x16x32_bf16 v[152:155], v[104:107], a[44:47], v[152:155]
buffer_load_dwordx4 a[100:103], v46, s[60:63], s91 offen offset:1024 sc1
ds_read_b64_tr_b16 v[98:99], v10 offset:49152
v_mfma_f32_16x16x32_bf16 v[140:143], v[108:111], a[40:43], v[140:143]
ds_read_b64_tr_b16 v[100:101], v11 offset:32768
v_and_b32 v2, 3, v1
v_cmp_eq_u32 s[4:5], 1, v2
v_mfma_f32_16x16x32_bf16 v[156:159], v[108:111], a[44:47], v[156:159]
ds_read_b64_tr_b16 v[102:103], v11 offset:49152
v_cmp_eq_u32 s[6:7], 2, v2
s_waitcnt vmcnt(13)
v_mfma_f32_16x16x32_bf16 v[128:131], v[112:115], a[48:51], v[128:131]
ds_read_b64_tr_b16 v[104:105], v12 offset:32768
v_cmp_eq_u32 s[8:9], 3, v2
s_waitcnt vmcnt(12)
v_mfma_f32_16x16x32_bf16 v[144:147], v[112:115], a[52:55], v[144:147]
buffer_load_dwordx4 a[104:107], v46, s[60:63], s91 offen offset:2048 sc1
ds_read_b64_tr_b16 v[106:107], v12 offset:49152
v_mfma_f32_16x16x32_bf16 v[132:135], v[116:119], a[48:51], v[132:135]
ds_read_b64_tr_b16 v[108:109], v13 offset:32768
s_lshl_b32 s85, s74, 6
s_add_u32 s85, s85, 6144
v_mfma_f32_16x16x32_bf16 v[148:151], v[116:119], a[52:55], v[148:151]
ds_read_b64_tr_b16 v[110:111], v13 offset:49152
s_lshl_b32 s78, s75, 12
s_add_u32 s78, s78, s88
v_mfma_f32_16x16x32_bf16 v[136:139], v[120:123], a[48:51], v[136:139]
ds_read_b64_tr_b16 v[112:113], v10 offset:33792
s_add_u32 s27, s78, 0x600000
s_lshr_b32 s78, s78, 4
v_mfma_f32_16x16x32_bf16 v[152:155], v[120:123], a[52:55], v[152:155]
buffer_load_dwordx4 a[108:111], v46, s[60:63], s91 offen offset:3072 sc1
ds_read_b64_tr_b16 v[114:115], v10 offset:50176
v_mfma_f32_16x16x32_bf16 v[140:143], v[124:127], a[48:51], v[140:143]
ds_read_b64_tr_b16 v[116:117], v11 offset:33792
s_add_u32 s78, s78, 0xb0000
s_lshr_b32 s11, s88, 4
v_mfma_f32_16x16x32_bf16 v[156:159], v[124:127], a[52:55], v[156:159]
ds_read_b64_tr_b16 v[118:119], v11 offset:50176
s_add_u32 s11, s11, 0xb0000
s_waitcnt vmcnt(13) lgkmcnt(6)
v_mfma_f32_16x16x32_bf16 v[128:131], v[80:83], a[56:59], v[128:131]
ds_read_b64_tr_b16 v[120:121], v12 offset:33792
v_and_b32 v2, 15, v1
s_waitcnt vmcnt(12)
v_mfma_f32_16x16x32_bf16 v[144:147], v[80:83], a[60:63], v[144:147]
s_add_u32 s91, s88, 0x207000
buffer_load_dwordx4 a[112:115], v46, s[60:63], s91 offen offset:0 sc1
v_mfma_f32_16x16x32_bf16 v[132:135], v[84:87], a[56:59], v[132:135]
ds_read_b64_tr_b16 v[122:123], v12 offset:50176
ds_read_b64_tr_b16 v[124:125], v13 offset:33792
v_lshl_add_u32 v3, v2, 4, s78
v_mfma_f32_16x16x32_bf16 v[148:151], v[84:87], a[60:63], v[148:151]
ds_read_b64_tr_b16 v[126:127], v13 offset:50176
v_lshrrev_b32 v5, 4, v1
v_lshlrev_b32 v55, 4, v2
v_mfma_f32_16x16x32_bf16 v[136:139], v[88:91], a[56:59], v[136:139]
ds_read_b64_tr_b16 v[80:81], v10 offset:34816
v_lshl_add_u32 v55, v5, 10, v55
v_lshrrev_b32 v4, 2, v2
v_mfma_f32_16x16x32_bf16 v[152:155], v[88:91], a[60:63], v[152:155]
buffer_load_dwordx4 a[116:119], v46, s[60:63], s91 offen offset:1024 sc1
ds_read_b64_tr_b16 v[82:83], v10 offset:51200
v_mfma_f32_16x16x32_bf16 v[140:143], v[92:95], a[56:59], v[140:143]
ds_read_b64_tr_b16 v[84:85], v11 offset:34816
v_mov_b32 v2, s96
ds_read_b64_tr_b16 v[86:87], v11 offset:51200
v_mfma_f32_16x16x32_bf16 v[156:159], v[92:95], a[60:63], v[156:159]
v_cmp_eq_u32 vcc, v4, v5
s_nop 1
v_cndmask_b32 v51, v2, v3, vcc
s_waitcnt vmcnt(13)
v_mfma_f32_16x16x32_bf16 v[128:131], v[96:99], a[64:67], v[128:131]
ds_read_b64_tr_b16 v[88:89], v12 offset:34816
v_lshrrev_b32 v2, 11, v26
s_waitcnt vmcnt(12)
v_mfma_f32_16x16x32_bf16 v[144:147], v[96:99], a[68:71], v[144:147]
buffer_load_dwordx4 a[120:123], v46, s[60:63], s91 offen offset:2048 sc1
ds_read_b64_tr_b16 v[90:91], v12 offset:51200
v_mfma_f32_16x16x32_bf16 v[132:135], v[100:103], a[64:67], v[132:135]
ds_read_b64_tr_b16 v[92:93], v13 offset:34816
s_movk_i32 s79, 5120
v_mfma_f32_16x16x32_bf16 v[148:151], v[100:103], a[68:71], v[148:151]
ds_read_b64_tr_b16 v[94:95], v13 offset:51200
v_mad_u32_u24 v30, v2, s79, v26
v_mfma_f32_16x16x32_bf16 v[136:139], v[104:107], a[64:67], v[136:139]
ds_read_b64_tr_b16 v[96:97], v10 offset:35840
v_add_u32 v31, 228352, v30
v_mfma_f32_16x16x32_bf16 v[152:155], v[104:107], a[68:71], v[152:155]
ds_read_b64_tr_b16 v[98:99], v10 offset:52224
s_waitcnt lgkmcnt(6)
v_mfma_f32_16x16x32_bf16 v[140:143], v[108:111], a[64:67], v[140:143]
buffer_load_dwordx4 a[124:127], v46, s[60:63], s91 offen offset:3072 sc1
v_mfma_f32_16x16x32_bf16 v[156:159], v[108:111], a[68:71], v[156:159]
ds_read_b64_tr_b16 v[100:101], v11 offset:35840
s_waitcnt vmcnt(13)
v_mfma_f32_16x16x32_bf16 v[128:131], v[112:115], a[72:75], v[128:131]
ds_read_b64_tr_b16 v[102:103], v11 offset:52224
s_waitcnt vmcnt(12)
v_mfma_f32_16x16x32_bf16 v[144:147], v[112:115], a[76:79], v[144:147]
s_add_u32 s91, s88, 0x208000
buffer_load_dwordx4 a[128:131], v46, s[60:63], s91 offen offset:0 sc1
v_mfma_f32_16x16x32_bf16 v[132:135], v[116:119], a[72:75], v[132:135]
ds_read_b64_tr_b16 v[104:105], v12 offset:35840
ds_read_b64_tr_b16 v[106:107], v12 offset:52224
v_mfma_f32_16x16x32_bf16 v[148:151], v[116:119], a[76:79], v[148:151]
ds_read_b64_tr_b16 v[108:109], v13 offset:35840
v_add_u32 v32, 456704, v30
v_mfma_f32_16x16x32_bf16 v[136:139], v[120:123], a[72:75], v[136:139]
ds_read_b64_tr_b16 v[110:111], v13 offset:52224
ds_read_b64_tr_b16 v[112:113], v10 offset:36864
v_mfma_f32_16x16x32_bf16 v[152:155], v[120:123], a[76:79], v[152:155]
buffer_load_dwordx4 a[132:135], v46, s[60:63], s91 offen offset:1024 sc1
v_mfma_f32_16x16x32_bf16 v[140:143], v[124:127], a[72:75], v[140:143]
ds_read_b64_tr_b16 v[114:115], v10 offset:53248
ds_read_b64_tr_b16 v[116:117], v11 offset:36864
v_mfma_f32_16x16x32_bf16 v[156:159], v[124:127], a[76:79], v[156:159]
ds_read_b64_tr_b16 v[118:119], v11 offset:53248
s_waitcnt vmcnt(13)
v_mfma_f32_16x16x32_bf16 v[128:131], v[80:83], a[80:83], v[128:131]
ds_read_b64_tr_b16 v[120:121], v12 offset:36864
s_waitcnt vmcnt(12)
v_mfma_f32_16x16x32_bf16 v[144:147], v[80:83], a[84:87], v[144:147]
buffer_load_dwordx4 a[136:139], v46, s[60:63], s91 offen offset:2048 sc1
v_mfma_f32_16x16x32_bf16 v[132:135], v[84:87], a[80:83], v[132:135]
ds_read_b64_tr_b16 v[122:123], v12 offset:53248
ds_read_b64_tr_b16 v[124:125], v13 offset:36864
v_mfma_f32_16x16x32_bf16 v[148:151], v[84:87], a[84:87], v[148:151]
ds_read_b64_tr_b16 v[126:127], v13 offset:53248
s_waitcnt lgkmcnt(7)
v_mfma_f32_16x16x32_bf16 v[136:139], v[88:91], a[80:83], v[136:139]
ds_read_b64_tr_b16 v[80:81], v10 offset:37888
v_add_u32 v33, 685056, v30
v_mfma_f32_16x16x32_bf16 v[152:155], v[88:91], a[84:87], v[152:155]
buffer_load_dwordx4 a[140:143], v46, s[60:63], s91 offen offset:3072 sc1
v_mfma_f32_16x16x32_bf16 v[140:143], v[92:95], a[80:83], v[140:143]
ds_read_b64_tr_b16 v[82:83], v10 offset:54272
ds_read_b64_tr_b16 v[84:85], v11 offset:37888
v_mfma_f32_16x16x32_bf16 v[156:159], v[92:95], a[84:87], v[156:159]
ds_read_b64_tr_b16 v[86:87], v11 offset:54272
s_waitcnt vmcnt(13)
v_mfma_f32_16x16x32_bf16 v[128:131], v[96:99], a[88:91], v[128:131]
ds_read_b64_tr_b16 v[88:89], v12 offset:37888
s_waitcnt vmcnt(12)
v_mfma_f32_16x16x32_bf16 v[144:147], v[96:99], a[92:95], v[144:147]
s_add_u32 s91, s88, 0x209000
buffer_load_dwordx4 a[144:147], v46, s[60:63], s91 offen offset:0 sc1
v_mfma_f32_16x16x32_bf16 v[132:135], v[100:103], a[88:91], v[132:135]
ds_read_b64_tr_b16 v[90:91], v12 offset:54272
ds_read_b64_tr_b16 v[92:93], v13 offset:37888
v_mfma_f32_16x16x32_bf16 v[148:151], v[100:103], a[92:95], v[148:151]
ds_read_b64_tr_b16 v[94:95], v13 offset:54272
v_lshrrev_b32 v2, 2, v1
v_mfma_f32_16x16x32_bf16 v[136:139], v[104:107], a[88:91], v[136:139]
ds_read_b64_tr_b16 v[96:97], v10 offset:38912
s_movk_i32 s80, 7168
v_mfma_f32_16x16x32_bf16 v[152:155], v[104:107], a[92:95], v[152:155]
buffer_load_dwordx4 a[148:151], v46, s[60:63], s91 offen offset:1024 sc1
v_mfma_f32_16x16x32_bf16 v[140:143], v[108:111], a[88:91], v[140:143]
ds_read_b64_tr_b16 v[98:99], v10 offset:55296
ds_read_b64_tr_b16 v[100:101], v11 offset:38912
v_mfma_f32_16x16x32_bf16 v[156:159], v[108:111], a[92:95], v[156:159]
ds_read_b64_tr_b16 v[102:103], v11 offset:55296
s_waitcnt vmcnt(13) lgkmcnt(7)
v_mfma_f32_16x16x32_bf16 v[128:131], v[112:115], a[96:99], v[128:131]
ds_read_b64_tr_b16 v[104:105], v12 offset:38912
s_waitcnt vmcnt(12)
v_mfma_f32_16x16x32_bf16 v[144:147], v[112:115], a[100:103], v[144:147]
buffer_load_dwordx4 a[152:155], v46, s[60:63], s91 offen offset:2048 sc1
v_mfma_f32_16x16x32_bf16 v[132:135], v[116:119], a[96:99], v[132:135]
ds_read_b64_tr_b16 v[106:107], v12 offset:55296
ds_read_b64_tr_b16 v[108:109], v13 offset:38912
v_mfma_f32_16x16x32_bf16 v[148:151], v[116:119], a[100:103], v[148:151]
ds_read_b64_tr_b16 v[110:111], v13 offset:55296
v_mul_u32_u24 v2, s80, v2
v_mfma_f32_16x16x32_bf16 v[136:139], v[120:123], a[96:99], v[136:139]
ds_read_b64_tr_b16 v[112:113], v10 offset:39936
v_bfe_u32 v3, v1, 4, 1
v_mfma_f32_16x16x32_bf16 v[152:155], v[120:123], a[100:103], v[152:155]
buffer_load_dwordx4 a[156:159], v46, s[60:63], s91 offen offset:3072 sc1
v_mfma_f32_16x16x32_bf16 v[140:143], v[124:127], a[96:99], v[140:143]
ds_read_b64_tr_b16 v[114:115], v10 offset:56320
ds_read_b64_tr_b16 v[116:117], v11 offset:39936
v_mfma_f32_16x16x32_bf16 v[156:159], v[124:127], a[100:103], v[156:159]
ds_read_b64_tr_b16 v[118:119], v11 offset:56320
s_waitcnt vmcnt(13)
v_mfma_f32_16x16x32_bf16 v[128:131], v[80:83], a[104:107], v[128:131]
ds_read_b64_tr_b16 v[120:121], v12 offset:39936
s_waitcnt vmcnt(12)
v_mfma_f32_16x16x32_bf16 v[144:147], v[80:83], a[108:111], v[144:147]
s_add_u32 s91, s88, 0x20a000
buffer_load_dwordx4 a[160:163], v46, s[60:63], s91 offen offset:0 sc1
v_mfma_f32_16x16x32_bf16 v[132:135], v[84:87], a[104:107], v[132:135]
ds_read_b64_tr_b16 v[122:123], v12 offset:56320
ds_read_b64_tr_b16 v[124:125], v13 offset:39936
v_mfma_f32_16x16x32_bf16 v[148:151], v[84:87], a[108:111], v[148:151]
ds_read_b64_tr_b16 v[126:127], v13 offset:56320
s_waitcnt lgkmcnt(7)
v_mfma_f32_16x16x32_bf16 v[136:139], v[88:91], a[104:107], v[136:139]
ds_read_b64_tr_b16 v[80:81], v14 offset:0
v_lshlrev_b32 v3, 1, v3
v_mfma_f32_16x16x32_bf16 v[152:155], v[88:91], a[108:111], v[152:155]
buffer_load_dwordx4 a[164:167], v46, s[60:63], s91 offen offset:1024 sc1
v_mfma_f32_16x16x32_bf16 v[140:143], v[92:95], a[104:107], v[140:143]
ds_read_b64_tr_b16 v[82:83], v14 offset:16384
ds_read_b64_tr_b16 v[84:85], v15 offset:0
v_mfma_f32_16x16x32_bf16 v[156:159], v[92:95], a[108:111], v[156:159]
ds_read_b64_tr_b16 v[86:87], v15 offset:16384
s_waitcnt vmcnt(13)
v_mfma_f32_16x16x32_bf16 v[128:131], v[96:99], a[112:115], v[128:131]
ds_read_b64_tr_b16 v[88:89], v16 offset:0
s_waitcnt vmcnt(12)
v_mfma_f32_16x16x32_bf16 v[144:147], v[96:99], a[116:119], v[144:147]
buffer_load_dwordx4 a[168:171], v46, s[60:63], s91 offen offset:2048 sc1
v_mfma_f32_16x16x32_bf16 v[132:135], v[100:103], a[112:115], v[132:135]
ds_read_b64_tr_b16 v[90:91], v16 offset:16384
ds_read_b64_tr_b16 v[92:93], v17 offset:0
v_mfma_f32_16x16x32_bf16 v[148:151], v[100:103], a[116:119], v[148:151]
ds_read_b64_tr_b16 v[94:95], v17 offset:16384
v_and_b32 v4, 3, v1
v_mfma_f32_16x16x32_bf16 v[136:139], v[104:107], a[112:115], v[136:139]
ds_read_b64_tr_b16 v[96:97], v14 offset:1024
v_xor_b32 v3, v3, v4
v_mfma_f32_16x16x32_bf16 v[152:155], v[104:107], a[116:119], v[152:155]
buffer_load_dwordx4 a[172:175], v46, s[60:63], s91 offen offset:3072 sc1
v_mfma_f32_16x16x32_bf16 v[140:143], v[108:111], a[112:115], v[140:143]
ds_read_b64_tr_b16 v[98:99], v14 offset:17408
ds_read_b64_tr_b16 v[100:101], v15 offset:1024
v_mfma_f32_16x16x32_bf16 v[156:159], v[108:111], a[116:119], v[156:159]
ds_read_b64_tr_b16 v[102:103], v15 offset:17408
s_waitcnt vmcnt(13) lgkmcnt(7)
v_mfma_f32_16x16x32_bf16 v[128:131], v[112:115], a[120:123], v[128:131]
ds_read_b64_tr_b16 v[104:105], v16 offset:1024
s_waitcnt vmcnt(12)
v_mfma_f32_16x16x32_bf16 v[144:147], v[112:115], a[124:127], v[144:147]
s_add_u32 s91, s88, 0x20b000
buffer_load_dwordx4 a[176:179], v46, s[60:63], s91 offen offset:0 sc1
v_mfma_f32_16x16x32_bf16 v[132:135], v[116:119], a[120:123], v[132:135]
ds_read_b64_tr_b16 v[106:107], v16 offset:17408
ds_read_b64_tr_b16 v[108:109], v17 offset:1024
v_mfma_f32_16x16x32_bf16 v[148:151], v[116:119], a[124:127], v[148:151]
ds_read_b64_tr_b16 v[110:111], v17 offset:17408
v_lshl_add_u32 v34, v3, 4, v2
v_mfma_f32_16x16x32_bf16 v[136:139], v[120:123], a[120:123], v[136:139]
ds_read_b64_tr_b16 v[112:113], v14 offset:2048
s_and_b32 s78, s72, 1
v_mfma_f32_16x16x32_bf16 v[152:155], v[120:123], a[124:127], v[152:155]
buffer_load_dwordx4 a[180:183], v46, s[60:63], s91 offen offset:1024 sc1
v_mfma_f32_16x16x32_bf16 v[140:143], v[124:127], a[120:123], v[140:143]
ds_read_b64_tr_b16 v[114:115], v14 offset:18432
ds_read_b64_tr_b16 v[116:117], v15 offset:2048
v_mfma_f32_16x16x32_bf16 v[156:159], v[124:127], a[124:127], v[156:159]
ds_read_b64_tr_b16 v[118:119], v15 offset:18432
s_waitcnt vmcnt(13)
v_mfma_f32_16x16x32_bf16 v[128:131], v[80:83], a[128:131], v[128:131]
ds_read_b64_tr_b16 v[120:121], v16 offset:2048
s_waitcnt vmcnt(12)
v_mfma_f32_16x16x32_bf16 v[144:147], v[80:83], a[132:135], v[144:147]
buffer_load_dwordx4 a[184:187], v46, s[60:63], s91 offen offset:2048 sc1
v_mfma_f32_16x16x32_bf16 v[132:135], v[84:87], a[128:131], v[132:135]
ds_read_b64_tr_b16 v[122:123], v16 offset:18432
ds_read_b64_tr_b16 v[124:125], v17 offset:2048
v_mfma_f32_16x16x32_bf16 v[148:151], v[84:87], a[132:135], v[148:151]
ds_read_b64_tr_b16 v[126:127], v17 offset:18432
s_waitcnt lgkmcnt(7)
v_mfma_f32_16x16x32_bf16 v[136:139], v[88:91], a[128:131], v[136:139]
ds_read_b64_tr_b16 v[80:81], v14 offset:3072
s_mul_i32 s78, s78, 114688
v_mfma_f32_16x16x32_bf16 v[152:155], v[88:91], a[132:135], v[152:155]
buffer_load_dwordx4 a[188:191], v46, s[60:63], s91 offen offset:3072 sc1
v_mfma_f32_16x16x32_bf16 v[140:143], v[92:95], a[128:131], v[140:143]
ds_read_b64_tr_b16 v[82:83], v14 offset:19456
ds_read_b64_tr_b16 v[84:85], v15 offset:3072
v_mfma_f32_16x16x32_bf16 v[156:159], v[92:95], a[132:135], v[156:159]
ds_read_b64_tr_b16 v[86:87], v15 offset:19456
s_waitcnt vmcnt(13)
v_mfma_f32_16x16x32_bf16 v[128:131], v[96:99], a[136:139], v[128:131]
ds_read_b64_tr_b16 v[88:89], v16 offset:3072
s_waitcnt vmcnt(12)
v_mfma_f32_16x16x32_bf16 v[144:147], v[96:99], a[140:143], v[144:147]
s_add_u32 s91, s88, 0x20c000
buffer_load_dwordx4 a[192:195], v46, s[60:63], s91 offen offset:0 sc1
v_mfma_f32_16x16x32_bf16 v[132:135], v[100:103], a[136:139], v[132:135]
ds_read_b64_tr_b16 v[90:91], v16 offset:19456
ds_read_b64_tr_b16 v[92:93], v17 offset:3072
v_mfma_f32_16x16x32_bf16 v[148:151], v[100:103], a[140:143], v[148:151]
ds_read_b64_tr_b16 v[94:95], v17 offset:19456
v_add_u32 v34, s78, v34
v_mfma_f32_16x16x32_bf16 v[136:139], v[104:107], a[136:139], v[136:139]
ds_read_b64_tr_b16 v[96:97], v14 offset:4096
v_add_u32 v35, 228352, v34
v_mfma_f32_16x16x32_bf16 v[152:155], v[104:107], a[140:143], v[152:155]
buffer_load_dwordx4 a[196:199], v46, s[60:63], s91 offen offset:1024 sc1
v_mfma_f32_16x16x32_bf16 v[140:143], v[108:111], a[136:139], v[140:143]
ds_read_b64_tr_b16 v[98:99], v14 offset:20480
ds_read_b64_tr_b16 v[100:101], v15 offset:4096
v_mfma_f32_16x16x32_bf16 v[156:159], v[108:111], a[140:143], v[156:159]
ds_read_b64_tr_b16 v[102:103], v15 offset:20480
s_waitcnt vmcnt(13) lgkmcnt(7)
v_mfma_f32_16x16x32_bf16 v[128:131], v[112:115], a[144:147], v[128:131]
ds_read_b64_tr_b16 v[104:105], v16 offset:4096
s_waitcnt vmcnt(12)
v_mfma_f32_16x16x32_bf16 v[144:147], v[112:115], a[148:151], v[144:147]
buffer_load_dwordx4 a[200:203], v46, s[60:63], s91 offen offset:2048 sc1
v_mfma_f32_16x16x32_bf16 v[132:135], v[116:119], a[144:147], v[132:135]
ds_read_b64_tr_b16 v[106:107], v16 offset:20480
ds_read_b64_tr_b16 v[108:109], v17 offset:4096
v_mfma_f32_16x16x32_bf16 v[148:151], v[116:119], a[148:151], v[148:151]
ds_read_b64_tr_b16 v[110:111], v17 offset:20480
v_add_u32 v36, 456704, v34
v_mfma_f32_16x16x32_bf16 v[136:139], v[120:123], a[144:147], v[136:139]
ds_read_b64_tr_b16 v[112:113], v14 offset:5120
v_add_u32 v37, 685056, v34
v_mfma_f32_16x16x32_bf16 v[152:155], v[120:123], a[148:151], v[152:155]
buffer_load_dwordx4 a[204:207], v46, s[60:63], s91 offen offset:3072 sc1
v_mfma_f32_16x16x32_bf16 v[140:143], v[124:127], a[144:147], v[140:143]
ds_read_b64_tr_b16 v[114:115], v14 offset:21504
ds_read_b64_tr_b16 v[116:117], v15 offset:5120
v_mfma_f32_16x16x32_bf16 v[156:159], v[124:127], a[148:151], v[156:159]
ds_read_b64_tr_b16 v[118:119], v15 offset:21504
s_waitcnt vmcnt(13)
v_mfma_f32_16x16x32_bf16 v[128:131], v[80:83], a[152:155], v[128:131]
ds_read_b64_tr_b16 v[120:121], v16 offset:5120
s_waitcnt vmcnt(12)
v_mfma_f32_16x16x32_bf16 v[144:147], v[80:83], a[156:159], v[144:147]
s_add_u32 s91, s88, 0x20d000
buffer_load_dwordx4 a[208:211], v46, s[60:63], s91 offen offset:0 sc1
v_mfma_f32_16x16x32_bf16 v[132:135], v[84:87], a[152:155], v[132:135]
ds_read_b64_tr_b16 v[122:123], v16 offset:21504
ds_read_b64_tr_b16 v[124:125], v17 offset:5120
v_mfma_f32_16x16x32_bf16 v[148:151], v[84:87], a[156:159], v[148:151]
ds_read_b64_tr_b16 v[126:127], v17 offset:21504
s_waitcnt lgkmcnt(7)
v_mfma_f32_16x16x32_bf16 v[136:139], v[88:91], a[152:155], v[136:139]
ds_read_b64_tr_b16 v[80:81], v14 offset:6144
ds_read_b64_tr_b16 v[82:83], v14 offset:22528
v_mfma_f32_16x16x32_bf16 v[152:155], v[88:91], a[156:159], v[152:155]
buffer_load_dwordx4 a[212:215], v46, s[60:63], s91 offen offset:1024 sc1
v_mfma_f32_16x16x32_bf16 v[140:143], v[92:95], a[152:155], v[140:143]
ds_read_b64_tr_b16 v[84:85], v15 offset:6144
ds_read_b64_tr_b16 v[86:87], v15 offset:22528
v_mfma_f32_16x16x32_bf16 v[156:159], v[92:95], a[156:159], v[156:159]
ds_read_b64_tr_b16 v[88:89], v16 offset:6144
s_waitcnt vmcnt(13)
v_mfma_f32_16x16x32_bf16 v[128:131], v[96:99], a[160:163], v[128:131]
ds_read_b64_tr_b16 v[90:91], v16 offset:22528
s_waitcnt vmcnt(12)
v_mfma_f32_16x16x32_bf16 v[144:147], v[96:99], a[164:167], v[144:147]
buffer_load_dwordx4 a[216:219], v46, s[60:63], s91 offen offset:2048 sc1
v_mfma_f32_16x16x32_bf16 v[132:135], v[100:103], a[160:163], v[132:135]
ds_read_b64_tr_b16 v[92:93], v17 offset:6144
ds_read_b64_tr_b16 v[94:95], v17 offset:22528
v_mfma_f32_16x16x32_bf16 v[148:151], v[100:103], a[164:167], v[148:151]
ds_read_b64_tr_b16 v[96:97], v14 offset:7168
v_mfma_f32_16x16x32_bf16 v[136:139], v[104:107], a[160:163], v[136:139]
ds_read_b64_tr_b16 v[98:99], v14 offset:23552
ds_read_b64_tr_b16 v[100:101], v15 offset:7168
v_mfma_f32_16x16x32_bf16 v[152:155], v[104:107], a[164:167], v[152:155]
buffer_load_dwordx4 a[220:223], v46, s[60:63], s91 offen offset:3072 sc1
v_mfma_f32_16x16x32_bf16 v[140:143], v[108:111], a[160:163], v[140:143]
ds_read_b64_tr_b16 v[102:103], v15 offset:23552
ds_read_b64_tr_b16 v[104:105], v16 offset:7168
v_mfma_f32_16x16x32_bf16 v[156:159], v[108:111], a[164:167], v[156:159]
ds_read_b64_tr_b16 v[106:107], v16 offset:23552
s_waitcnt vmcnt(13) lgkmcnt(8)
v_mfma_f32_16x16x32_bf16 v[128:131], v[112:115], a[168:171], v[128:131]
ds_read_b64_tr_b16 v[108:109], v17 offset:7168
s_waitcnt vmcnt(12)
v_mfma_f32_16x16x32_bf16 v[144:147], v[112:115], a[172:175], v[144:147]
s_add_u32 s91, s88, 0x20e000
buffer_load_dwordx4 a[224:227], v46, s[60:63], s91 offen offset:0 sc1
v_mfma_f32_16x16x32_bf16 v[132:135], v[116:119], a[168:171], v[132:135]
ds_read_b64_tr_b16 v[110:111], v17 offset:23552
ds_read_b64_tr_b16 v[112:113], v14 offset:32768
v_mfma_f32_16x16x32_bf16 v[148:151], v[116:119], a[172:175], v[148:151]
ds_read_b64_tr_b16 v[114:115], v14 offset:49152
v_mfma_f32_16x16x32_bf16 v[136:139], v[120:123], a[168:171], v[136:139]
ds_read_b64_tr_b16 v[116:117], v15 offset:32768
v_mfma_f32_16x16x32_bf16 v[152:155], v[120:123], a[172:175], v[152:155]
buffer_load_dwordx4 a[228:231], v46, s[60:63], s91 offen offset:1024 sc1
v_mfma_f32_16x16x32_bf16 v[140:143], v[124:127], a[168:171], v[140:143]
ds_read_b64_tr_b16 v[118:119], v15 offset:49152
ds_read_b64_tr_b16 v[120:121], v16 offset:32768
v_mfma_f32_16x16x32_bf16 v[156:159], v[124:127], a[172:175], v[156:159]
ds_read_b64_tr_b16 v[122:123], v16 offset:49152
s_waitcnt vmcnt(13)
v_mfma_f32_16x16x32_bf16 v[128:131], v[80:83], a[176:179], v[128:131]
ds_read_b64_tr_b16 v[124:125], v17 offset:32768
s_waitcnt vmcnt(12)
v_mfma_f32_16x16x32_bf16 v[144:147], v[80:83], a[180:183], v[144:147]
buffer_load_dwordx4 a[232:235], v46, s[60:63], s91 offen offset:2048 sc1
v_mfma_f32_16x16x32_bf16 v[132:135], v[84:87], a[176:179], v[132:135]
ds_read_b64_tr_b16 v[126:127], v17 offset:49152
ds_read_b64_tr_b16 v[80:81], v14 offset:33792
v_mfma_f32_16x16x32_bf16 v[148:151], v[84:87], a[180:183], v[148:151]
ds_read_b64_tr_b16 v[82:83], v14 offset:50176
v_mfma_f32_16x16x32_bf16 v[136:139], v[88:91], a[176:179], v[136:139]
ds_read_b64_tr_b16 v[84:85], v15 offset:33792
v_mfma_f32_16x16x32_bf16 v[152:155], v[88:91], a[180:183], v[152:155]
ds_read_b64_tr_b16 v[86:87], v15 offset:50176
s_waitcnt lgkmcnt(6)
v_mfma_f32_16x16x32_bf16 v[140:143], v[92:95], a[176:179], v[140:143]
buffer_load_dwordx4 a[236:239], v46, s[60:63], s91 offen offset:3072 sc1
v_mfma_f32_16x16x32_bf16 v[156:159], v[92:95], a[180:183], v[156:159]
ds_read_b64_tr_b16 v[88:89], v16 offset:33792
s_waitcnt vmcnt(13)
v_mfma_f32_16x16x32_bf16 v[128:131], v[96:99], a[184:187], v[128:131]
ds_read_b64_tr_b16 v[90:91], v16 offset:50176
s_waitcnt vmcnt(12)
v_mfma_f32_16x16x32_bf16 v[144:147], v[96:99], a[188:191], v[144:147]
s_add_u32 s91, s88, 0x20f000
buffer_load_dwordx4 a[240:243], v46, s[60:63], s91 offen offset:0 sc1
v_mfma_f32_16x16x32_bf16 v[132:135], v[100:103], a[184:187], v[132:135]
ds_read_b64_tr_b16 v[92:93], v17 offset:33792
ds_read_b64_tr_b16 v[94:95], v17 offset:50176
v_mfma_f32_16x16x32_bf16 v[148:151], v[100:103], a[188:191], v[148:151]
ds_read_b64_tr_b16 v[96:97], v14 offset:34816
v_mfma_f32_16x16x32_bf16 v[136:139], v[104:107], a[184:187], v[136:139]
ds_read_b64_tr_b16 v[98:99], v14 offset:51200
ds_read_b64_tr_b16 v[100:101], v15 offset:34816
v_mfma_f32_16x16x32_bf16 v[152:155], v[104:107], a[188:191], v[152:155]
buffer_load_dwordx4 a[244:247], v46, s[60:63], s91 offen offset:1024 sc1
v_mfma_f32_16x16x32_bf16 v[140:143], v[108:111], a[184:187], v[140:143]
ds_read_b64_tr_b16 v[102:103], v15 offset:51200
ds_read_b64_tr_b16 v[104:105], v16 offset:34816
v_mfma_f32_16x16x32_bf16 v[156:159], v[108:111], a[188:191], v[156:159]
ds_read_b64_tr_b16 v[106:107], v16 offset:51200
s_waitcnt vmcnt(13)
v_mfma_f32_16x16x32_bf16 v[128:131], v[112:115], a[192:195], v[128:131]
ds_read_b64_tr_b16 v[108:109], v17 offset:34816
s_waitcnt vmcnt(12)
v_mfma_f32_16x16x32_bf16 v[144:147], v[112:115], a[196:199], v[144:147]
buffer_load_dwordx4 a[248:251], v46, s[60:63], s91 offen offset:2048 sc1
v_mfma_f32_16x16x32_bf16 v[132:135], v[116:119], a[192:195], v[132:135]
ds_read_b64_tr_b16 v[110:111], v17 offset:51200
ds_read_b64_tr_b16 v[112:113], v14 offset:35840
v_mfma_f32_16x16x32_bf16 v[148:151], v[116:119], a[196:199], v[148:151]
ds_read_b64_tr_b16 v[114:115], v14 offset:52224
v_mfma_f32_16x16x32_bf16 v[136:139], v[120:123], a[192:195], v[136:139]
ds_read_b64_tr_b16 v[116:117], v15 offset:35840
v_mfma_f32_16x16x32_bf16 v[152:155], v[120:123], a[196:199], v[152:155]
ds_read_b64_tr_b16 v[118:119], v15 offset:52224
s_waitcnt lgkmcnt(6)
v_mfma_f32_16x16x32_bf16 v[140:143], v[124:127], a[192:195], v[140:143]
buffer_load_dwordx4 a[252:255], v46, s[60:63], s91 offen offset:3072 sc1
v_mfma_f32_16x16x32_bf16 v[156:159], v[124:127], a[196:199], v[156:159]
ds_read_b64_tr_b16 v[120:121], v16 offset:35840
s_waitcnt vmcnt(13)
v_mfma_f32_16x16x32_bf16 v[128:131], v[80:83], a[200:203], v[128:131]
ds_read_b64_tr_b16 v[122:123], v16 offset:52224
s_waitcnt vmcnt(12)
v_mfma_f32_16x16x32_bf16 v[144:147], v[80:83], a[204:207], v[144:147]
s_add_u32 s70, s0, T_wo - K_pc + 0
s_addc_u32 s71, s1, 0
global_load_dword v57, v9, s[70:71]
v_mfma_f32_16x16x32_bf16 v[132:135], v[84:87], a[200:203], v[132:135]
ds_read_b64_tr_b16 v[124:125], v17 offset:35840
ds_read_b64_tr_b16 v[126:127], v17 offset:52224
v_mfma_f32_16x16x32_bf16 v[148:151], v[84:87], a[204:207], v[148:151]
s_add_u32 s70, s0, T_wo - K_pc + 8192
s_addc_u32 s71, s1, 0
global_load_dword v57, v9, s[70:71]
v_mfma_f32_16x16x32_bf16 v[136:139], v[88:91], a[200:203], v[136:139]
ds_read_b64_tr_b16 v[80:81], v14 offset:36864
ds_read_b64_tr_b16 v[82:83], v14 offset:53248
v_mfma_f32_16x16x32_bf16 v[152:155], v[88:91], a[204:207], v[152:155]
ds_read_b64_tr_b16 v[84:85], v15 offset:36864
v_mfma_f32_16x16x32_bf16 v[140:143], v[92:95], a[200:203], v[140:143]
ds_read_b64_tr_b16 v[86:87], v15 offset:53248
ds_read_b64_tr_b16 v[88:89], v16 offset:36864
v_mfma_f32_16x16x32_bf16 v[156:159], v[92:95], a[204:207], v[156:159]
ds_read_b64_tr_b16 v[90:91], v16 offset:53248
s_waitcnt vmcnt(13)
v_mfma_f32_16x16x32_bf16 v[128:131], v[96:99], a[208:211], v[128:131]
ds_read_b64_tr_b16 v[92:93], v17 offset:36864
s_waitcnt vmcnt(12)
v_mfma_f32_16x16x32_bf16 v[144:147], v[96:99], a[212:215], v[144:147]
ds_read_b64_tr_b16 v[94:95], v17 offset:53248
v_mfma_f32_16x16x32_bf16 v[132:135], v[100:103], a[208:211], v[132:135]
ds_read_b64_tr_b16 v[96:97], v14 offset:37888
v_mfma_f32_16x16x32_bf16 v[148:151], v[100:103], a[212:215], v[148:151]
ds_read_b64_tr_b16 v[98:99], v14 offset:54272
v_mfma_f32_16x16x32_bf16 v[136:139], v[104:107], a[208:211], v[136:139]
ds_read_b64_tr_b16 v[100:101], v15 offset:37888
v_mfma_f32_16x16x32_bf16 v[152:155], v[104:107], a[212:215], v[152:155]
ds_read_b64_tr_b16 v[102:103], v15 offset:54272
s_waitcnt lgkmcnt(6)
v_mfma_f32_16x16x32_bf16 v[140:143], v[108:111], a[208:211], v[140:143]
ds_read_b64_tr_b16 v[104:105], v16 offset:37888
v_mfma_f32_16x16x32_bf16 v[156:159], v[108:111], a[212:215], v[156:159]
ds_read_b64_tr_b16 v[106:107], v16 offset:54272
s_waitcnt vmcnt(11)
v_mfma_f32_16x16x32_bf16 v[128:131], v[112:115], a[216:219], v[128:131]
ds_read_b64_tr_b16 v[108:109], v17 offset:37888
s_waitcnt vmcnt(10)
v_mfma_f32_16x16x32_bf16 v[144:147], v[112:115], a[220:223], v[144:147]
ds_read_b64_tr_b16 v[110:111], v17 offset:54272
v_mfma_f32_16x16x32_bf16 v[132:135], v[116:119], a[216:219], v[132:135]
ds_read_b64_tr_b16 v[112:113], v14 offset:38912
v_mfma_f32_16x16x32_bf16 v[148:151], v[116:119], a[220:223], v[148:151]
ds_read_b64_tr_b16 v[114:115], v14 offset:55296
v_mfma_f32_16x16x32_bf16 v[136:139], v[120:123], a[216:219], v[136:139]
ds_read_b64_tr_b16 v[116:117], v15 offset:38912
v_mfma_f32_16x16x32_bf16 v[152:155], v[120:123], a[220:223], v[152:155]
ds_read_b64_tr_b16 v[118:119], v15 offset:55296
v_mfma_f32_16x16x32_bf16 v[140:143], v[124:127], a[216:219], v[140:143]
ds_read_b64_tr_b16 v[120:121], v16 offset:38912
v_mfma_f32_16x16x32_bf16 v[156:159], v[124:127], a[220:223], v[156:159]
ds_read_b64_tr_b16 v[122:123], v16 offset:55296
s_waitcnt vmcnt(9)
v_mfma_f32_16x16x32_bf16 v[128:131], v[80:83], a[224:227], v[128:131]
ds_read_b64_tr_b16 v[124:125], v17 offset:38912
s_waitcnt vmcnt(8)
v_mfma_f32_16x16x32_bf16 v[144:147], v[80:83], a[228:231], v[144:147]
ds_read_b64_tr_b16 v[126:127], v17 offset:55296
v_mfma_f32_16x16x32_bf16 v[132:135], v[84:87], a[224:227], v[132:135]
ds_read_b64_tr_b16 v[80:81], v14 offset:39936
v_mfma_f32_16x16x32_bf16 v[148:151], v[84:87], a[228:231], v[148:151]
ds_read_b64_tr_b16 v[82:83], v14 offset:56320
v_mfma_f32_16x16x32_bf16 v[136:139], v[88:91], a[224:227], v[136:139]
ds_read_b64_tr_b16 v[84:85], v15 offset:39936
v_mfma_f32_16x16x32_bf16 v[152:155], v[88:91], a[228:231], v[152:155]
ds_read_b64_tr_b16 v[86:87], v15 offset:56320
s_waitcnt lgkmcnt(6)
v_mfma_f32_16x16x32_bf16 v[140:143], v[92:95], a[224:227], v[140:143]
ds_read_b64_tr_b16 v[88:89], v16 offset:39936
v_mfma_f32_16x16x32_bf16 v[156:159], v[92:95], a[228:231], v[156:159]
ds_read_b64_tr_b16 v[90:91], v16 offset:56320
s_waitcnt vmcnt(7)
v_mfma_f32_16x16x32_bf16 v[128:131], v[96:99], a[232:235], v[128:131]
ds_read_b64_tr_b16 v[92:93], v17 offset:39936
s_waitcnt vmcnt(6)
v_mfma_f32_16x16x32_bf16 v[144:147], v[96:99], a[236:239], v[144:147]
ds_read_b64_tr_b16 v[94:95], v17 offset:56320
v_mfma_f32_16x16x32_bf16 v[132:135], v[100:103], a[232:235], v[132:135]
v_mfma_f32_16x16x32_bf16 v[148:151], v[100:103], a[236:239], v[148:151]
v_mfma_f32_16x16x32_bf16 v[136:139], v[104:107], a[232:235], v[136:139]
v_mfma_f32_16x16x32_bf16 v[152:155], v[104:107], a[236:239], v[152:155]
v_mfma_f32_16x16x32_bf16 v[140:143], v[108:111], a[232:235], v[140:143]
v_mfma_f32_16x16x32_bf16 v[156:159], v[108:111], a[236:239], v[156:159]
s_waitcnt vmcnt(5)
v_mfma_f32_16x16x32_bf16 v[128:131], v[112:115], a[240:243], v[128:131]
s_waitcnt vmcnt(4)
v_mfma_f32_16x16x32_bf16 v[144:147], v[112:115], a[244:247], v[144:147]
v_mfma_f32_16x16x32_bf16 v[132:135], v[116:119], a[240:243], v[132:135]
v_mfma_f32_16x16x32_bf16 v[148:151], v[116:119], a[244:247], v[148:151]
v_mfma_f32_16x16x32_bf16 v[136:139], v[120:123], a[240:243], v[136:139]
v_mfma_f32_16x16x32_bf16 v[152:155], v[120:123], a[244:247], v[152:155]
s_waitcnt lgkmcnt(0)
v_mfma_f32_16x16x32_bf16 v[140:143], v[124:127], a[240:243], v[140:143]
v_mfma_f32_16x16x32_bf16 v[156:159], v[124:127], a[244:247], v[156:159]
s_waitcnt vmcnt(3)
v_mfma_f32_16x16x32_bf16 v[128:131], v[80:83], a[248:251], v[128:131]
s_waitcnt vmcnt(2)
v_mfma_f32_16x16x32_bf16 v[144:147], v[80:83], a[252:255], v[144:147]
v_mfma_f32_16x16x32_bf16 v[132:135], v[84:87], a[248:251], v[132:135]
v_mfma_f32_16x16x32_bf16 v[148:151], v[84:87], a[252:255], v[148:151]
v_mfma_f32_16x16x32_bf16 v[136:139], v[88:91], a[248:251], v[136:139]
v_mfma_f32_16x16x32_bf16 v[152:155], v[88:91], a[252:255], v[152:155]
v_mfma_f32_16x16x32_bf16 v[140:143], v[92:95], a[248:251], v[140:143]
v_mfma_f32_16x16x32_bf16 v[156:159], v[92:95], a[252:255], v[156:159]
T_wo:
v_pk_fma_f32 v[160:161], v[128:129], v[192:193], v[160:161]
v_pk_fma_f32 v[162:163], v[130:131], v[194:195], v[162:163]
s_nop 0
v_pk_fma_f32 v[164:165], v[132:133], v[196:197], v[164:165]
v_pk_fma_f32 v[166:167], v[134:135], v[198:199], v[166:167]
v_pk_fma_f32 v[168:169], v[136:137], v[200:201], v[168:169]
v_pk_fma_f32 v[170:171], v[138:139], v[202:203], v[170:171]
v_pk_fma_f32 v[172:173], v[140:141], v[204:205], v[172:173]
v_pk_fma_f32 v[174:175], v[142:143], v[206:207], v[174:175]
v_pk_fma_f32 v[176:177], v[144:145], v[192:193], v[176:177]
v_pk_fma_f32 v[178:179], v[146:147], v[194:195], v[178:179]
v_pk_fma_f32 v[180:181], v[148:149], v[196:197], v[180:181]
v_pk_fma_f32 v[182:183], v[150:151], v[198:199], v[182:183]
v_pk_fma_f32 v[184:185], v[152:153], v[200:201], v[184:185]
v_pk_fma_f32 v[186:187], v[154:155], v[202:203], v[186:187]
v_pk_fma_f32 v[188:189], v[156:157], v[204:205], v[188:189]
v_pk_fma_f32 v[190:191], v[158:159], v[206:207], v[190:191]
v_cvt_pk_bf16_f32 v224, v160, v161
v_cvt_pk_bf16_f32 v225, v162, v163
v_cvt_pk_bf16_f32 v226, v164, v165
v_cvt_pk_bf16_f32 v227, v166, v167
buffer_store_dwordx4 v[224:227], v46, s[60:63], s27 offen offset:0 sc1
s_nop 0
v_mfma_f32_16x16x32_bf16 v[220:223], v[224:227], v[224:227], 0
v_mfma_f32_16x16x32_bf16 v[212:215], v[208:211], v[224:227], 0
v_cvt_pk_bf16_f32 v228, v168, v169
v_cvt_pk_bf16_f32 v229, v170, v171
v_cvt_pk_bf16_f32 v230, v172, v173
v_cvt_pk_bf16_f32 v231, v174, v175
buffer_store_dwordx4 v[228:231], v46, s[60:63], s27 offen offset:2048 sc1
s_nop 0
v_mfma_f32_16x16x32_bf16 v[220:223], v[228:231], v[228:231], v[220:223]
v_mfma_f32_16x16x32_bf16 v[212:215], v[208:211], v[228:231], v[212:215]
v_cvt_pk_bf16_f32 v232, v176, v177
v_cvt_pk_bf16_f32 v233, v178, v179
v_cvt_pk_bf16_f32 v234, v180, v181
v_cvt_pk_bf16_f32 v235, v182, v183
buffer_store_dwordx4 v[232:235], v46, s[60:63], s27 offen offset:1024 sc1
s_nop 0
v_mfma_f32_16x16x32_bf16 v[76:79], v[232:235], v[232:235], 0
v_mfma_f32_16x16x32_bf16 v[216:219], v[208:211], v[232:235], 0
v_cvt_pk_bf16_f32 v236, v184, v185
v_cvt_pk_bf16_f32 v237, v186, v187
v_cvt_pk_bf16_f32 v238, v188, v189
v_cvt_pk_bf16_f32 v239, v190, v191
buffer_store_dwordx4 v[236:239], v46, s[60:63], s27 offen offset:3072 sc1
s_nop 0
v_mfma_f32_16x16x32_bf16 v[76:79], v[236:239], v[236:239], v[76:79]
v_mfma_f32_16x16x32_bf16 v[216:219], v[208:211], v[236:239], v[216:219]
v_cndmask_b32 v69, v220, v221, s[4:5]
v_cndmask_b32 v69, v69, v222, s[6:7]
v_cndmask_b32 v69, v69, v223, s[8:9]
v_mov_b32 v68, v212
s_nop 2
v_cndmask_b32 v71, v76, v77, s[4:5]
v_cndmask_b32 v71, v71, v78, s[6:7]
v_cndmask_b32 v71, v71, v79, s[8:9]
v_mov_b32 v70, v216
buffer_store_dwordx4 v[68:71], v51, s[60:63], 0 offen sc1
s_barrier
s_add_u32 m0, s76, 0
s_add_u32 s77, s82, 0x0
buffer_load_dwordx4 v30, s[40:43], s77 offen offset:0 lds
buffer_load_dwordx4 v31, s[40:43], s77 offen offset:1024 lds
buffer_load_dwordx4 v32, s[40:43], s77 offen offset:2048 lds
buffer_load_dwordx4 v33, s[40:43], s77 offen offset:3072 lds
s_add_u32 m0, s76, 4096
s_add_u32 s77, s82, 0xe0000
buffer_load_dwordx4 v30, s[40:43], s77 offen offset:0 lds
buffer_load_dwordx4 v31, s[40:43], s77 offen offset:1024 lds
buffer_load_dwordx4 v32, s[40:43], s77 offen offset:2048 lds
buffer_load_dwordx4 v33, s[40:43], s77 offen offset:3072 lds
v_and_b32 v2, 15, v1
v_lshrrev_b32 v3, 2, v2
v_lshrrev_b32 v4, 4, v1
v_cmp_eq_u32 vcc, v3, v4
v_lshlrev_b32 v3, 4, v2
v_mov_b32 v4, 131328
v_add_u32 v5, 131072, v3
v_add_u32 v6, 147456, v3
v_cndmask_b32 v53, v4, v5, vcc
v_cndmask_b32 v54, v4, v6, vcc
v_mov_b32 v161, 0
v_mov_b32 v167, 0
v_mov_b32 v173, 0
v_mov_b32 v179, 0
v_mov_b32 v185, 0
v_mov_b32 v191, 0
v_mov_b32 v193, 0
v_mov_b32 v199, 0
v_mov_b32 v205, 0
v_mov_b32 v211, 0
v_mov_b32 v217, 0
v_mov_b32 v223, 0
ds_read_b128 v[224:227], v53 offset:0
ds_read_b128 v[228:231], v54 offset:0
ds_read_b128 v[232:235], v53 offset:272
ds_read_b128 v[236:239], v54 offset:272
s_mov_b32 s3, s11
s_and_b32 s79, s74, 12
s_add_u32 s78, s74, 1
s_and_b32 s78, s78, 3
s_add_u32 s78, s78, s79
s_lshl_b32 s78, s78, 7
s_add_u32 s84, s78, 2048
s_add_u32 s78, s74, 2
s_and_b32 s78, s78, 3
s_add_u32 s78, s78, s79
s_lshl_b32 s78, s78, 7
s_add_u32 s25, s78, 4096
s_lshr_b32 s12, s74, 2
s_and_b32 s13, s74, 3
s_add_u32 s4, s89, 0xa00000
s_lshl_b32 s5, s85, 5
s_add_u32 s5, s5, s4
s_lshl_b32 s6, s12, 14
s_add_u32 s6, s6, s4
s_lshl_b32 s26, s12, 13
s_add_u32 s26, s26, s4
s_add_u32 s26, s26, 196608
s_lshl_b32 s14, s12, 18
v_add_u32 v38, s14, v26
v_add_u32 v39, s14, v27
v_add_u32 v40, s14, v28
v_add_u32 v41, s14, v29
s_lshl_b32 s78, s13, 9
s_add_u32 s14, s14, s78
s_lshr_b32 s15, s88, 12
s_lshl_b32 s17, s73, 14
s_waitcnt vmcnt(8)
s_mov_b32 s87, 1
s_atomic_add s87, s[60:61], s90 offset:4096 glc
s_add_u32 m0, s76, 32768
s_add_u32 s77, s82, 0x1c0000
buffer_load_dwordx4 v30, s[40:43], s77 offen offset:0 lds
buffer_load_dwordx4 v31, s[40:43], s77 offen offset:1024 lds
buffer_load_dwordx4 v32, s[40:43], s77 offen offset:2048 lds
buffer_load_dwordx4 v33, s[40:43], s77 offen offset:3072 lds
s_add_u32 m0, s76, 36864
s_add_u32 s77, s82, 0x2a0000
buffer_load_dwordx4 v30, s[40:43], s77 offen offset:0 lds
buffer_load_dwordx4 v31, s[40:43], s77 offen offset:1024 lds
buffer_load_dwordx4 v32, s[40:43], s77 offen offset:2048 lds
buffer_load_dwordx4 v33, s[40:43], s77 offen offset:3072 lds
s_add_u32 s70, s0, S_G0 - K_pc + 0
s_addc_u32 s71, s1, 0
global_load_dword v57, v9, s[70:71]
s_add_u32 s70, s0, S_G0 - K_pc + 8192
s_addc_u32 s71, s1, 0
global_load_dword v57, v9, s[70:71]
s_lshl_b32 s78, s72, 7
s_add_u32 s17, s17, 32768
s_add_u32 s18, s17, s78
s_add_u32 s79, s12, 1
s_and_b32 s79, s79, 3
s_lshl_b32 s78, s79, 7
s_add_u32 s97, s14, s78
s_lshl_b32 s79, s79, 2
s_add_u32 s16, s79, s13
s_add_u32 s78, s15, s16
s_mul_i32 s78, s78, 12288
s_add_u32 s8, s78, 0x1900000
s_lshl_b32 s16, s16, 10
s_add_u32 s20, s16, s18
s_add_u32 s79, s12, 2
s_and_b32 s79, s79, 3
s_lshl_b32 s78, s79, 7
s_add_u32 s98, s14, s78
s_lshl_b32 s79, s79, 2
s_add_u32 s16, s79, s13
s_add_u32 s78, s15, s16
s_mul_i32 s78, s78, 12288
s_add_u32 s9, s78, 0x1901000
s_lshl_b32 s16, s16, 10
s_add_u32 s21, s16, s18
s_add_u32 s79, s12, 3
s_and_b32 s79, s79, 3
s_lshl_b32 s78, s79, 7
s_add_u32 s99, s14, s78
s_lshl_b32 s79, s79, 2
s_add_u32 s16, s79, s13
s_add_u32 s78, s15, s16
s_mul_i32 s78, s78, 12288
s_add_u32 s10, s78, 0x1902000
s_lshl_b32 s16, s16, 10
s_add_u32 s22, s16, s18
s_add_u32 s79, s12, 4
s_and_b32 s79, s79, 3
s_lshl_b32 s78, s79, 7
s_add_u32 s100, s14, s78
s_lshl_b32 s79, s79, 2
s_add_u32 s16, s79, s13
s_add_u32 s78, s15, s16
s_mul_i32 s78, s78, 12288
s_add_u32 s11, s78, 0x1900000
s_lshl_b32 s16, s16, 10
s_add_u32 s23, s16, s18
s_and_b32 s79, s74, 12
s_add_u32 s79, s79, s72
s_lshl_b32 s79, s79, 10
s_add_u32 s24, s79, s17
s_waitcnt vmcnt(10) lgkmcnt(0)
s_barrier
ds_read_b64_tr_b16 v[96:97], v10 offset:0
ds_read_b64_tr_b16 v[98:99], v10 offset:16384
ds_read_b64_tr_b16 v[100:101], v11 offset:0
ds_read_b64_tr_b16 v[102:103], v11 offset:16384
ds_read_b64_tr_b16 v[104:105], v12 offset:0
ds_read_b64_tr_b16 v[106:107], v12 offset:16384
ds_read_b64_tr_b16 v[108:109], v13 offset:0
ds_read_b64_tr_b16 v[110:111], v13 offset:16384
ds_read_b64_tr_b16 v[112:113], v10 offset:1024
ds_read_b64_tr_b16 v[114:115], v10 offset:17408
ds_read_b64_tr_b16 v[116:117], v11 offset:1024
ds_read_b64_tr_b16 v[118:119], v11 offset:17408
s_cmp_lt_u32 s87, 15
s_cbranch_scc1 pl_4_slow
pl_4_ok:
buffer_load_dwordx4 v[128:131], v55, s[60:63], s3 offen offset:0 sc1
buffer_load_dwordx4 v[132:135], v55, s[60:63], s3 offen offset:256 sc1
buffer_load_dwordx4 v[136:139], v55, s[60:63], s3 offen offset:512 sc1
buffer_load_dwordx4 v[140:143], v55, s[60:63], s3 offen offset:768 sc1
s_add_u32 s91, s88, 0x600000
buffer_load_dwordx4 v[162:165], v46, s[60:63], s91 offen offset:0 sc1
buffer_load_dwordx4 v[194:197], v46, s[60:63], s91 offen offset:1024 sc1
buffer_load_dwordx4 v[168:171], v46, s[60:63], s91 offen offset:2048 sc1
buffer_load_dwordx4 v[200:203], v46, s[60:63], s91 offen offset:3072 sc1
s_add_u32 s91, s88, 0x601000
buffer_load_dwordx4 v[174:177], v46, s[60:63], s91 offen offset:0 sc1
buffer_load_dwordx4 v[206:209], v46, s[60:63], s91 offen offset:1024 sc1
buffer_load_dwordx4 v[180:183], v46, s[60:63], s91 offen offset:2048 sc1
buffer_load_dwordx4 v[212:215], v46, s[60:63], s91 offen offset:3072 sc1
s_add_u32 s91, s88, 0x602000
buffer_load_dwordx4 v[186:189], v46, s[60:63], s91 offen offset:0 sc1
buffer_load_dwordx4 v[218:221], v46, s[60:63], s91 offen offset:1024 sc1
s_waitcnt vmcnt(12)
v_pk_add_f32 v[128:129], v[128:129], v[132:133]
s_waitcnt vmcnt(10)
v_pk_add_f32 v[136:137], v[136:137], v[140:141]
v_pk_add_f32 v[130:131], v[130:131], v[134:135]
v_pk_add_f32 v[138:139], v[138:139], v[142:143]
v_pk_add_f32 v[128:129], v[128:129], v[136:137]
v_pk_add_f32 v[130:131], v[130:131], v[138:139]
v_mov_b32 v132, v128
v_mov_b32 v133, v129
v_mov_b32 v134, v130
v_mov_b32 v135, v131
v_permlane32_swap_b32 v128, v132
v_permlane32_swap_b32 v129, v133
v_permlane32_swap_b32 v130, v134
v_permlane32_swap_b32 v131, v135
v_add_f32 v128, v128, v132
v_add_f32 v129, v129, v133
v_add_f32 v130, v130, v134
v_add_f32 v131, v131, v135
v_mov_b32 v132, v128
v_mov_b32 v133, v129
v_mov_b32 v134, v130
v_mov_b32 v135, v131
v_permlane16_swap_b32 v128, v132
v_permlane16_swap_b32 v129, v133
v_permlane16_swap_b32 v130, v134
v_permlane16_swap_b32 v131, v135
v_add_f32 v128, v128, v132
v_add_f32 v129, v129, v133
v_add_f32 v130, v130, v134
v_add_f32 v131, v131, v135
v_mul_f32 v128, 0x3a800000, v128
v_mul_f32 v129, 0x3a800000, v129
v_mul_f32 v130, 0x3a800000, v130
v_mul_f32 v131, 0x3a800000, v131
v_mul_f32 v132, v128, v128
v_mul_f32 v133, v130, v130
v_sub_f32 v129, v129, v132
v_sub_f32 v131, v131, v133
v_max_f32 v129, 0, v129
v_max_f32 v131, 0, v131
v_cvt_pk_bf16_f32 v134, v129, v129
v_lshlrev_b32 v129, 16, v134
v_cvt_pk_bf16_f32 v135, v131, v131
v_lshlrev_b32 v131, 16, v135
v_add_f32 v129, 0x3727c5ac, v129
v_add_f32 v131, 0x3727c5ac, v131
v_cvt_pk_bf16_f32 v134, v129, v129
v_lshlrev_b32 v129, 16, v134
v_cvt_pk_bf16_f32 v135, v131, v131
v_lshlrev_b32 v131, 16, v135
v_sqrt_f32 v129, v129
v_sqrt_f32 v131, v131
v_sub_f32 v128, 0, v128
v_sub_f32 v130, 0, v130
v_cvt_pk_bf16_f32 v134, v129, v128
v_cvt_pk_bf16_f32 v135, v131, v130
v_lshlrev_b32 v76, 16, v134
v_lshlrev_b32 v77, 16, v135
v_rcp_f32 v58, v76
v_rcp_f32 v59, v77
v_mov_b32 v160, v134
v_mov_b32 v192, v135
v_mov_b32 v166, v134
v_mov_b32 v198, v135
v_mov_b32 v172, v134
v_mov_b32 v204, v135
v_mov_b32 v178, v134
v_mov_b32 v210, v135
v_mov_b32 v184, v134
v_mov_b32 v216, v135
v_mov_b32 v190, v134
v_mov_b32 v222, v135
s_waitcnt vmcnt(9)
v_mfma_f32_16x16x32_bf16 v[240:243], v[224:227], v[160:163], 0
v_mfma_f32_16x16x32_bf16 v[244:247], v[228:231], v[164:167], 0
buffer_load_dwordx4 v[162:165], v46, s[60:63], s91 offen offset:2048 sc1
v_mul_f32 v60, 0xbfb8aa3b, v58
v_mul_f32 v62, v76, v76
v_mul_f32 v61, 0xbfb8aa3b, v59
v_mul_f32 v63, v77, v77
s_waitcnt vmcnt(9)
v_mfma_f32_16x16x32_bf16 v[248:251], v[224:227], v[192:195], 0
v_mfma_f32_16x16x32_bf16 v[252:255], v[228:231], v[196:199], 0
buffer_load_dwordx4 v[194:197], v46, s[60:63], s91 offen offset:3072 sc1
ds_read_b128 v[224:227], v53 offset:544
ds_read_b128 v[228:231], v54 offset:544
v_cvt_pk_bf16_f32 v240, v240, v241
v_cvt_pk_bf16_f32 v241, v242, v243
v_cvt_pk_bf16_f32 v244, v244, v245
v_cvt_pk_bf16_f32 v245, v246, v247
v_accvgpr_write_b32 a0, v240
v_accvgpr_write_b32 a1, v241
v_accvgpr_write_b32 a2, v244
v_accvgpr_write_b32 a3, v245
s_waitcnt vmcnt(9)
v_mfma_f32_16x16x32_bf16 v[68:71], v[232:235], v[166:169], 0
v_mfma_f32_16x16x32_bf16 v[72:75], v[236:239], v[170:173], 0
s_add_u32 s91, s88, 0x603000
buffer_load_dwordx4 v[168:171], v46, s[60:63], s91 offen offset:0 sc1
v_cvt_pk_bf16_f32 v248, v248, v249
v_cvt_pk_bf16_f32 v249, v250, v251
v_cvt_pk_bf16_f32 v252, v252, v253
v_cvt_pk_bf16_f32 v253, v254, v255
v_accvgpr_write_b32 a4, v248
v_accvgpr_write_b32 a5, v249
v_accvgpr_write_b32 a6, v252
v_accvgpr_write_b32 a7, v253
s_waitcnt vmcnt(9)
v_mfma_f32_16x16x32_bf16 v[240:243], v[232:235], v[198:201], 0
v_mfma_f32_16x16x32_bf16 v[244:247], v[236:239], v[202:205], 0
buffer_load_dwordx4 v[200:203], v46, s[60:63], s91 offen offset:1024 sc1
ds_read_b128 v[232:235], v53 offset:816
ds_read_b128 v[236:239], v54 offset:816
v_cvt_pk_bf16_f32 v68, v68, v69
v_cvt_pk_bf16_f32 v69, v70, v71
v_cvt_pk_bf16_f32 v72, v72, v73
v_cvt_pk_bf16_f32 v73, v74, v75
v_accvgpr_write_b32 a8, v68
v_accvgpr_write_b32 a9, v69
v_accvgpr_write_b32 a10, v72
v_accvgpr_write_b32 a11, v73
S_G0:
s_waitcnt lgkmcnt(14)
v_mfma_f32_16x16x32_bf16 v[128:131], v[96:99], a[0:3], 0
ds_read_b64_tr_b16 v[120:121], v12 offset:1024
ds_read_b64_tr_b16 v[122:123], v12 offset:17408
ds_read_b64_tr_b16 v[124:125], v13 offset:1024
v_mfma_f32_16x16x32_bf16 v[144:147], v[96:99], a[4:7], 0
ds_read_b64_tr_b16 v[126:127], v13 offset:17408
s_add_u32 m0, s76, 65536
s_waitcnt lgkmcnt(15)
v_mfma_f32_16x16x32_bf16 v[132:135], v[100:103], a[0:3], 0
ds_read_b64_tr_b16 v[80:81], v10 offset:2048
s_add_u32 s77, s82, 0x380000
v_cvt_pk_bf16_f32 v240, v240, v241
v_mfma_f32_16x16x32_bf16 v[148:151], v[100:103], a[4:7], 0
buffer_load_dwordx4 v30, s[40:43], s77 offen offset:0 lds
s_waitcnt vmcnt(10) lgkmcnt(8)
v_mfma_f32_16x16x32_bf16 v[248:251], v[224:227], v[172:175], 0
ds_read_b64_tr_b16 v[82:83], v10 offset:18432
v_cvt_pk_bf16_f32 v241, v242, v243
s_waitcnt lgkmcnt(8)
v_mfma_f32_16x16x32_bf16 v[252:255], v[228:231], v[176:179], 0
buffer_load_dwordx4 v[174:177], v46, s[60:63], s91 offen offset:2048 sc1
ds_read_b64_tr_b16 v[84:85], v11 offset:2048
v_mfma_f32_16x16x32_bf16 v[136:139], v[104:107], a[0:3], 0
ds_read_b64_tr_b16 v[86:87], v11 offset:18432
v_cvt_pk_bf16_f32 v244, v244, v245
v_cvt_pk_bf16_f32 v245, v246, v247
v_mfma_f32_16x16x32_bf16 v[152:155], v[104:107], a[4:7], 0
s_add_u32 s70, s0, S_H0 - K_pc + 0
s_addc_u32 s71, s1, 0
global_load_dword v57, v9, s[70:71]
v_mfma_f32_16x16x32_bf16 v[140:143], v[108:111], a[0:3], 0
ds_read_b64_tr_b16 v[88:89], v12 offset:2048
v_accvgpr_write_b32 a12, v240
v_accvgpr_write_b32 a13, v241
v_mfma_f32_16x16x32_bf16 v[156:159], v[108:111], a[4:7], 0
ds_read_b64_tr_b16 v[90:91], v12 offset:18432
v_accvgpr_write_b32 a14, v244
s_waitcnt vmcnt(11)
v_mfma_f32_16x16x32_bf16 v[68:71], v[224:227], v[204:207], 0
ds_read_b64_tr_b16 v[92:93], v13 offset:2048
v_accvgpr_write_b32 a15, v245
v_cvt_pk_bf16_f32 v248, v248, v249
v_mfma_f32_16x16x32_bf16 v[72:75], v[228:231], v[208:211], 0
buffer_load_dwordx4 v[206:209], v46, s[60:63], s91 offen offset:3072 sc1
ds_read_b64_tr_b16 v[94:95], v13 offset:18432
v_mfma_f32_16x16x32_bf16 v[128:131], v[112:115], a[8:11], v[128:131]
ds_read_b64_tr_b16 v[96:97], v10 offset:3072
ds_read_b128 v[224:227], v53 offset:1088
ds_read_b128 v[228:231], v54 offset:1088
v_mfma_f32_16x16x32_bf16 v[144:147], v[112:115], a[12:15], v[144:147]
buffer_load_dwordx4 v31, s[40:43], s77 offen offset:1024 lds
ds_read_b64_tr_b16 v[98:99], v10 offset:19456
v_mfma_f32_16x16x32_bf16 v[132:135], v[116:119], a[8:11], v[132:135]
ds_read_b64_tr_b16 v[100:101], v11 offset:3072
v_cvt_pk_bf16_f32 v249, v250, v251
v_cvt_pk_bf16_f32 v252, v252, v253
v_mfma_f32_16x16x32_bf16 v[148:151], v[116:119], a[12:15], v[148:151]
ds_read_b64_tr_b16 v[102:103], v11 offset:19456
v_cvt_pk_bf16_f32 v253, v254, v255
s_waitcnt vmcnt(12) lgkmcnt(8)
v_mfma_f32_16x16x32_bf16 v[240:243], v[232:235], v[178:181], 0
ds_read_b64_tr_b16 v[104:105], v12 offset:3072
v_accvgpr_write_b32 a16, v248
v_accvgpr_write_b32 a17, v249
v_mfma_f32_16x16x32_bf16 v[244:247], v[236:239], v[182:185], 0
s_add_u32 s91, s88, 0x604000
buffer_load_dwordx4 v[180:183], v46, s[60:63], s91 offen offset:0 sc1
v_mfma_f32_16x16x32_bf16 v[136:139], v[120:123], a[8:11], v[136:139]
ds_read_b64_tr_b16 v[106:107], v12 offset:19456
v_accvgpr_write_b32 a18, v252
v_accvgpr_write_b32 a19, v253
v_mfma_f32_16x16x32_bf16 v[152:155], v[120:123], a[12:15], v[152:155]
ds_read_b64_tr_b16 v[108:109], v13 offset:3072
v_cvt_pk_bf16_f32 v68, v68, v69
v_cvt_pk_bf16_f32 v69, v70, v71
v_mfma_f32_16x16x32_bf16 v[140:143], v[124:127], a[8:11], v[140:143]
ds_read_b64_tr_b16 v[110:111], v13 offset:19456
v_cvt_pk_bf16_f32 v72, v72, v73
v_cvt_pk_bf16_f32 v73, v74, v75
v_mfma_f32_16x16x32_bf16 v[156:159], v[124:127], a[12:15], v[156:159]
ds_read_b64_tr_b16 v[112:113], v10 offset:4096
v_accvgpr_write_b32 a20, v68
s_waitcnt vmcnt(12)
v_mfma_f32_16x16x32_bf16 v[248:251], v[232:235], v[210:213], 0
ds_read_b64_tr_b16 v[114:115], v10 offset:20480
v_accvgpr_write_b32 a21, v69
v_accvgpr_write_b32 a22, v72
v_mfma_f32_16x16x32_bf16 v[252:255], v[236:239], v[214:217], 0
buffer_load_dwordx4 v32, s[40:43], s77 offen offset:2048 lds
ds_read_b64_tr_b16 v[116:117], v11 offset:4096
v_accvgpr_write_b32 a23, v73
v_mfma_f32_16x16x32_bf16 v[128:131], v[80:83], a[16:19], v[128:131]
ds_read_b64_tr_b16 v[118:119], v11 offset:20480
v_cvt_pk_bf16_f32 v240, v240, v241
v_cvt_pk_bf16_f32 v241, v242, v243
v_mfma_f32_16x16x32_bf16 v[144:147], v[80:83], a[20:23], v[144:147]
buffer_load_dwordx4 v[212:215], v46, s[60:63], s91 offen offset:1024 sc1
ds_read_b64_tr_b16 v[120:121], v12 offset:4096
v_mfma_f32_16x16x32_bf16 v[132:135], v[84:87], a[16:19], v[132:135]
ds_read_b64_tr_b16 v[122:123], v12 offset:20480
ds_read_b128 v[232:235], v53 offset:1360
ds_read_b128 v[236:239], v54 offset:1360
v_mfma_f32_16x16x32_bf16 v[148:151], v[84:87], a[20:23], v[148:151]
ds_read_b64_tr_b16 v[124:125], v13 offset:4096
v_cvt_pk_bf16_f32 v244, v244, v245
s_waitcnt vmcnt(13) lgkmcnt(8)
v_mfma_f32_16x16x32_bf16 v[68:71], v[224:227], v[184:187], 0
ds_read_b64_tr_b16 v[126:127], v13 offset:20480
v_cvt_pk_bf16_f32 v245, v246, v247
v_accvgpr_write_b32 a24, v240
v_mfma_f32_16x16x32_bf16 v[72:75], v[228:231], v[188:191], 0
buffer_load_dwordx4 v[186:189], v46, s[60:63], s91 offen offset:2048 sc1
ds_read_b64_tr_b16 v[80:81], v10 offset:5120
v_mfma_f32_16x16x32_bf16 v[136:139], v[88:91], a[16:19], v[136:139]
ds_read_b64_tr_b16 v[82:83], v10 offset:21504
v_accvgpr_write_b32 a25, v241
v_accvgpr_write_b32 a26, v244
v_mfma_f32_16x16x32_bf16 v[152:155], v[88:91], a[20:23], v[152:155]
ds_read_b64_tr_b16 v[84:85], v11 offset:5120
v_accvgpr_write_b32 a27, v245
v_cvt_pk_bf16_f32 v248, v248, v249
v_mfma_f32_16x16x32_bf16 v[140:143], v[92:95], a[16:19], v[140:143]
ds_read_b64_tr_b16 v[86:87], v11 offset:21504
v_cvt_pk_bf16_f32 v249, v250, v251
v_cvt_pk_bf16_f32 v252, v252, v253
v_mfma_f32_16x16x32_bf16 v[156:159], v[92:95], a[20:23], v[156:159]
buffer_load_dwordx4 v33, s[40:43], s77 offen offset:3072 lds
s_waitcnt vmcnt(10)
v_mfma_f32_16x16x32_bf16 v[240:243], v[224:227], v[216:219], 0
ds_read_b64_tr_b16 v[88:89], v12 offset:5120
v_cvt_pk_bf16_f32 v253, v254, v255
v_accvgpr_write_b32 a28, v248
v_mfma_f32_16x16x32_bf16 v[244:247], v[228:231], v[220:223], 0
buffer_load_dwordx4 v[218:221], v46, s[60:63], s91 offen offset:3072 sc1
ds_read_b64_tr_b16 v[90:91], v12 offset:21504
v_accvgpr_write_b32 a29, v249
v_accvgpr_write_b32 a30, v252
v_accvgpr_write_b32 a31, v253
v_mfma_f32_16x16x32_bf16 v[128:131], v[96:99], a[24:27], v[128:131]
ds_read_b64_tr_b16 v[92:93], v13 offset:5120
ds_read_b128 v[224:227], v53 offset:1632
ds_read_b128 v[228:231], v54 offset:1632
v_mfma_f32_16x16x32_bf16 v[144:147], v[96:99], a[28:31], v[144:147]
ds_read_b64_tr_b16 v[94:95], v13 offset:21504
v_cvt_pk_bf16_f32 v68, v68, v69
v_cvt_pk_bf16_f32 v69, v70, v71
v_mfma_f32_16x16x32_bf16 v[132:135], v[100:103], a[24:27], v[132:135]
ds_read_b64_tr_b16 v[96:97], v10 offset:6144
v_cvt_pk_bf16_f32 v72, v72, v73
v_cvt_pk_bf16_f32 v73, v74, v75
v_mfma_f32_16x16x32_bf16 v[148:151], v[100:103], a[28:31], v[148:151]
v_accvgpr_write_b32 a32, v68
v_accvgpr_write_b32 a33, v69
s_waitcnt lgkmcnt(7)
v_mfma_f32_16x16x32_bf16 v[248:251], v[232:235], v[160:163], 0
v_accvgpr_write_b32 a34, v72
s_add_u32 m0, s76, 69632
s_add_u32 s77, s82, 0x460000
v_mfma_f32_16x16x32_bf16 v[252:255], v[236:239], v[164:167], 0
s_add_u32 s91, s88, 0x605000
buffer_load_dwordx4 v[162:165], v46, s[60:63], s91 offen offset:0 sc1
v_mfma_f32_16x16x32_bf16 v[136:139], v[104:107], a[24:27], v[136:139]
ds_read_b64_tr_b16 v[98:99], v10 offset:22528
v_accvgpr_write_b32 a35, v73
v_cvt_pk_bf16_f32 v240, v240, v241
v_mfma_f32_16x16x32_bf16 v[152:155], v[104:107], a[28:31], v[152:155]
buffer_load_dwordx4 v30, s[40:43], s77 offen offset:0 lds
ds_read_b64_tr_b16 v[100:101], v11 offset:6144
v_mfma_f32_16x16x32_bf16 v[140:143], v[108:111], a[24:27], v[140:143]
ds_read_b64_tr_b16 v[102:103], v11 offset:22528
v_cvt_pk_bf16_f32 v241, v242, v243
v_cvt_pk_bf16_f32 v244, v244, v245
v_mfma_f32_16x16x32_bf16 v[156:159], v[108:111], a[28:31], v[156:159]
ds_read_b64_tr_b16 v[104:105], v12 offset:6144
v_cvt_pk_bf16_f32 v245, v246, v247
v_accvgpr_write_b32 a36, v240
v_mfma_f32_16x16x32_bf16 v[68:71], v[232:235], v[192:195], 0
v_accvgpr_write_b32 a37, v241
v_accvgpr_write_b32 a38, v244
v_accvgpr_write_b32 a39, v245
v_mfma_f32_16x16x32_bf16 v[72:75], v[236:239], v[196:199], 0
buffer_load_dwordx4 v[194:197], v46, s[60:63], s91 offen offset:1024 sc1
ds_read_b64_tr_b16 v[106:107], v12 offset:22528
v_mfma_f32_16x16x32_bf16 v[128:131], v[112:115], a[32:35], v[128:131]
ds_read_b64_tr_b16 v[108:109], v13 offset:6144
ds_read_b128 v[232:235], v53 offset:1904
ds_read_b128 v[236:239], v54 offset:1904
v_mfma_f32_16x16x32_bf16 v[144:147], v[112:115], a[36:39], v[144:147]
ds_read_b64_tr_b16 v[110:111], v13 offset:22528
v_cvt_pk_bf16_f32 v248, v248, v249
v_cvt_pk_bf16_f32 v249, v250, v251
v_mfma_f32_16x16x32_bf16 v[132:135], v[116:119], a[32:35], v[132:135]
ds_read_b64_tr_b16 v[112:113], v10 offset:7168
v_cvt_pk_bf16_f32 v252, v252, v253
v_cvt_pk_bf16_f32 v253, v254, v255
v_mfma_f32_16x16x32_bf16 v[148:151], v[116:119], a[36:39], v[148:151]
v_accvgpr_write_b32 a40, v248
v_accvgpr_write_b32 a41, v249
s_waitcnt lgkmcnt(6)
v_mfma_f32_16x16x32_bf16 v[240:243], v[224:227], v[166:169], 0
v_accvgpr_write_b32 a42, v252
v_accvgpr_write_b32 a43, v253
v_cvt_pk_bf16_f32 v68, v68, v69
v_mfma_f32_16x16x32_bf16 v[244:247], v[228:231], v[170:173], 0
buffer_load_dwordx4 v31, s[40:43], s77 offen offset:1024 lds
ds_read_b64_tr_b16 v[114:115], v10 offset:23552
v_mfma_f32_16x16x32_bf16 v[136:139], v[120:123], a[32:35], v[136:139]
ds_read_b64_tr_b16 v[116:117], v11 offset:7168
v_cvt_pk_bf16_f32 v69, v70, v71
v_cvt_pk_bf16_f32 v72, v72, v73
v_mfma_f32_16x16x32_bf16 v[152:155], v[120:123], a[36:39], v[152:155]
buffer_load_dwordx4 v[168:171], v46, s[60:63], s91 offen offset:2048 sc1
ds_read_b64_tr_b16 v[118:119], v11 offset:23552
v_mfma_f32_16x16x32_bf16 v[140:143], v[124:127], a[32:35], v[140:143]
ds_read_b64_tr_b16 v[120:121], v12 offset:7168
v_cvt_pk_bf16_f32 v73, v74, v75
v_accvgpr_write_b32 a44, v68
v_mfma_f32_16x16x32_bf16 v[156:159], v[124:127], a[36:39], v[156:159]
v_accvgpr_write_b32 a45, v69
v_accvgpr_write_b32 a46, v72
v_accvgpr_write_b32 a47, v73
v_mfma_f32_16x16x32_bf16 v[248:251], v[224:227], v[198:201], 0
v_cvt_pk_bf16_f32 v240, v240, v241
v_cvt_pk_bf16_f32 v241, v242, v243
v_cvt_pk_bf16_f32 v244, v244, v245
v_mfma_f32_16x16x32_bf16 v[252:255], v[228:231], v[202:205], 0
buffer_load_dwordx4 v[200:203], v46, s[60:63], s91 offen offset:3072 sc1
ds_read_b64_tr_b16 v[122:123], v12 offset:23552
v_mfma_f32_16x16x32_bf16 v[128:131], v[80:83], a[40:43], v[128:131]
ds_read_b64_tr_b16 v[124:125], v13 offset:7168
ds_read_b128 v[224:227], v53 offset:2176
ds_read_b128 v[228:231], v54 offset:2176
v_mfma_f32_16x16x32_bf16 v[144:147], v[80:83], a[44:47], v[144:147]
ds_read_b64_tr_b16 v[126:127], v13 offset:23552
v_cvt_pk_bf16_f32 v245, v246, v247
v_accvgpr_write_b32 a48, v240
v_mfma_f32_16x16x32_bf16 v[132:135], v[84:87], a[40:43], v[132:135]
v_accvgpr_write_b32 a49, v241
v_accvgpr_write_b32 a50, v244
v_accvgpr_write_b32 a51, v245
v_mfma_f32_16x16x32_bf16 v[148:151], v[84:87], a[44:47], v[148:151]
buffer_load_dwordx4 v32, s[40:43], s77 offen offset:2048 lds
s_waitcnt vmcnt(9) lgkmcnt(5)
v_mfma_f32_16x16x32_bf16 v[68:71], v[232:235], v[172:175], 0
v_cvt_pk_bf16_f32 v248, v248, v249
v_cvt_pk_bf16_f32 v249, v250, v251
v_cvt_pk_bf16_f32 v252, v252, v253
v_mfma_f32_16x16x32_bf16 v[72:75], v[236:239], v[176:179], 0
s_add_u32 s91, s88, 0x606000
buffer_load_dwordx4 v[174:177], v46, s[60:63], s91 offen offset:0 sc1
v_mfma_f32_16x16x32_bf16 v[136:139], v[88:91], a[40:43], v[136:139]
s_waitcnt lgkmcnt(0)
s_barrier
ds_read_b64_tr_b16 v[80:81], v10 offset:32768
v_mfma_f32_16x16x32_bf16 v[152:155], v[88:91], a[44:47], v[152:155]
buffer_load_dwordx4 v33, s[40:43], s77 offen offset:3072 lds
ds_read_b64_tr_b16 v[82:83], v10 offset:49152
v_mfma_f32_16x16x32_bf16 v[140:143], v[92:95], a[40:43], v[140:143]
ds_read_b64_tr_b16 v[84:85], v11 offset:32768
v_cvt_pk_bf16_f32 v253, v254, v255
v_accvgpr_write_b32 a52, v248
v_mfma_f32_16x16x32_bf16 v[156:159], v[92:95], a[44:47], v[156:159]
ds_read_b64_tr_b16 v[86:87], v11 offset:49152
v_accvgpr_write_b32 a53, v249
v_accvgpr_write_b32 a54, v252
v_mfma_f32_16x16x32_bf16 v[240:243], v[232:235], v[204:207], 0
ds_read_b64_tr_b16 v[88:89], v12 offset:32768
v_accvgpr_write_b32 a55, v253
v_cvt_pk_bf16_f32 v68, v68, v69
v_mfma_f32_16x16x32_bf16 v[244:247], v[236:239], v[208:211], 0
buffer_load_dwordx4 v[206:209], v46, s[60:63], s91 offen offset:1024 sc1
ds_read_b64_tr_b16 v[90:91], v12 offset:49152
v_mfma_f32_16x16x32_bf16 v[128:131], v[96:99], a[48:51], v[128:131]
ds_read_b64_tr_b16 v[92:93], v13 offset:32768
ds_read_b128 v[232:235], v53 offset:2448
ds_read_b128 v[236:239], v54 offset:2448
v_mfma_f32_16x16x32_bf16 v[144:147], v[96:99], a[52:55], v[144:147]
ds_read_b64_tr_b16 v[94:95], v13 offset:49152
v_cvt_pk_bf16_f32 v69, v70, v71
v_cvt_pk_bf16_f32 v72, v72, v73
v_mfma_f32_16x16x32_bf16 v[132:135], v[100:103], a[48:51], v[132:135]
ds_read_b64_tr_b16 v[96:97], v10 offset:33792
s_add_u32 m0, s76, 98304
s_add_u32 s77, s82, 0x540000
v_mfma_f32_16x16x32_bf16 v[148:151], v[100:103], a[52:55], v[148:151]
v_cvt_pk_bf16_f32 v73, v74, v75
v_accvgpr_write_b32 a56, v68
v_accvgpr_write_b32 a57, v69
v_mfma_f32_16x16x32_bf16 v[248:251], v[224:227], v[178:181], 0
v_accvgpr_write_b32 a58, v72
v_accvgpr_write_b32 a59, v73
v_cvt_pk_bf16_f32 v240, v240, v241
v_mfma_f32_16x16x32_bf16 v[252:255], v[228:231], v[182:185], 0
buffer_load_dwordx4 v30, s[40:43], s77 offen offset:0 lds
ds_read_b64_tr_b16 v[98:99], v10 offset:50176
v_mfma_f32_16x16x32_bf16 v[136:139], v[104:107], a[48:51], v[136:139]
ds_read_b64_tr_b16 v[100:101], v11 offset:33792
v_cvt_pk_bf16_f32 v241, v242, v243
v_cvt_pk_bf16_f32 v244, v244, v245
v_mfma_f32_16x16x32_bf16 v[152:155], v[104:107], a[52:55], v[152:155]
buffer_load_dwordx4 v[180:183], v46, s[60:63], s91 offen offset:2048 sc1
ds_read_b64_tr_b16 v[102:103], v11 offset:50176
v_mfma_f32_16x16x32_bf16 v[140:143], v[108:111], a[48:51], v[140:143]
ds_read_b64_tr_b16 v[104:105], v12 offset:33792
v_cvt_pk_bf16_f32 v245, v246, v247
v_accvgpr_write_b32 a60, v240
v_mfma_f32_16x16x32_bf16 v[156:159], v[108:111], a[52:55], v[156:159]
v_accvgpr_write_b32 a61, v241
v_accvgpr_write_b32 a62, v244
v_accvgpr_write_b32 a63, v245
v_mfma_f32_16x16x32_bf16 v[68:71], v[224:227], v[210:213], 0
v_cvt_pk_bf16_f32 v248, v248, v249
v_cvt_pk_bf16_f32 v249, v250, v251
v_cvt_pk_bf16_f32 v252, v252, v253
v_mfma_f32_16x16x32_bf16 v[72:75], v[228:231], v[214:217], 0
buffer_load_dwordx4 v[212:215], v46, s[60:63], s91 offen offset:3072 sc1
ds_read_b64_tr_b16 v[106:107], v12 offset:50176
v_mfma_f32_16x16x32_bf16 v[128:131], v[112:115], a[56:59], v[128:131]
ds_read_b64_tr_b16 v[108:109], v13 offset:33792
ds_read_b128 v[224:227], v53 offset:2720
ds_read_b128 v[228:231], v54 offset:2720
v_mfma_f32_16x16x32_bf16 v[144:147], v[112:115], a[60:63], v[144:147]
ds_read_b64_tr_b16 v[110:111], v13 offset:50176
v_cvt_pk_bf16_f32 v253, v254, v255
v_accvgpr_write_b32 a64, v248
v_mfma_f32_16x16x32_bf16 v[132:135], v[116:119], a[56:59], v[132:135]
ds_read_b64_tr_b16 v[112:113], v10 offset:34816
v_accvgpr_write_b32 a65, v249
v_accvgpr_write_b32 a66, v252
v_mfma_f32_16x16x32_bf16 v[148:151], v[116:119], a[60:63], v[148:151]
buffer_load_dwordx4 v31, s[40:43], s77 offen offset:1024 lds
s_waitcnt lgkmcnt(6)
v_mfma_f32_16x16x32_bf16 v[240:243], v[232:235], v[184:187], 0
v_accvgpr_write_b32 a67, v253
v_cvt_pk_bf16_f32 v68, v68, v69
v_cvt_pk_bf16_f32 v69, v70, v71
v_mfma_f32_16x16x32_bf16 v[244:247], v[236:239], v[188:191], 0
s_add_u32 s91, s88, 0x607000
buffer_load_dwordx4 v[186:189], v46, s[60:63], s91 offen offset:0 sc1
v_mfma_f32_16x16x32_bf16 v[136:139], v[120:123], a[56:59], v[136:139]
ds_read_b64_tr_b16 v[114:115], v10 offset:51200
v_cvt_pk_bf16_f32 v72, v72, v73
v_cvt_pk_bf16_f32 v73, v74, v75
v_mfma_f32_16x16x32_bf16 v[152:155], v[120:123], a[60:63], v[152:155]
ds_read_b64_tr_b16 v[116:117], v11 offset:34816
v_accvgpr_write_b32 a68, v68
v_accvgpr_write_b32 a69, v69
v_mfma_f32_16x16x32_bf16 v[140:143], v[124:127], a[56:59], v[140:143]
ds_read_b64_tr_b16 v[118:119], v11 offset:51200
v_accvgpr_write_b32 a70, v72
v_accvgpr_write_b32 a71, v73
v_mfma_f32_16x16x32_bf16 v[156:159], v[124:127], a[60:63], v[156:159]
ds_read_b64_tr_b16 v[120:121], v12 offset:34816
v_cvt_pk_bf16_f32 v240, v240, v241
s_waitcnt vmcnt(9)
v_mfma_f32_16x16x32_bf16 v[248:251], v[232:235], v[216:219], 0
v_cvt_pk_bf16_f32 v241, v242, v243
v_cvt_pk_bf16_f32 v244, v244, v245
v_cvt_pk_bf16_f32 v245, v246, v247
v_mfma_f32_16x16x32_bf16 v[252:255], v[236:239], v[220:223], 0
buffer_load_dwordx4 v[218:221], v46, s[60:63], s91 offen offset:1024 sc1
ds_read_b64_tr_b16 v[122:123], v12 offset:51200
v_mfma_f32_16x16x32_bf16 v[128:131], v[80:83], a[64:67], v[128:131]
ds_read_b64_tr_b16 v[124:125], v13 offset:34816
ds_read_b128 v[232:235], v53 offset:2992
ds_read_b128 v[236:239], v54 offset:2992
v_mfma_f32_16x16x32_bf16 v[144:147], v[80:83], a[68:71], v[144:147]
buffer_load_dwordx4 v32, s[40:43], s77 offen offset:2048 lds
ds_read_b64_tr_b16 v[126:127], v13 offset:51200
v_mfma_f32_16x16x32_bf16 v[132:135], v[84:87], a[64:67], v[132:135]
ds_read_b64_tr_b16 v[80:81], v10 offset:35840
v_accvgpr_write_b32 a72, v240
v_accvgpr_write_b32 a73, v241
v_mfma_f32_16x16x32_bf16 v[148:151], v[84:87], a[68:71], v[148:151]
v_accvgpr_write_b32 a74, v244
v_accvgpr_write_b32 a75, v245
s_waitcnt lgkmcnt(6)
v_mfma_f32_16x16x32_bf16 v[68:71], v[224:227], v[160:163], 0
v_cvt_pk_bf16_f32 v248, v248, v249
v_cvt_pk_bf16_f32 v249, v250, v251
v_cvt_pk_bf16_f32 v252, v252, v253
v_mfma_f32_16x16x32_bf16 v[72:75], v[228:231], v[164:167], 0
buffer_load_dwordx4 v[162:165], v46, s[60:63], s91 offen offset:2048 sc1
ds_read_b64_tr_b16 v[82:83], v10 offset:52224
v_mfma_f32_16x16x32_bf16 v[136:139], v[88:91], a[64:67], v[136:139]
ds_read_b64_tr_b16 v[84:85], v11 offset:35840
v_cvt_pk_bf16_f32 v253, v254, v255
v_accvgpr_write_b32 a76, v248
v_mfma_f32_16x16x32_bf16 v[152:155], v[88:91], a[68:71], v[152:155]
ds_read_b64_tr_b16 v[86:87], v11 offset:52224
v_accvgpr_write_b32 a77, v249
v_accvgpr_write_b32 a78, v252
v_mfma_f32_16x16x32_bf16 v[140:143], v[92:95], a[64:67], v[140:143]
ds_read_b64_tr_b16 v[88:89], v12 offset:35840
v_accvgpr_write_b32 a79, v253
v_cvt_pk_bf16_f32 v68, v68, v69
v_mfma_f32_16x16x32_bf16 v[156:159], v[92:95], a[68:71], v[156:159]
v_cvt_pk_bf16_f32 v69, v70, v71
v_cvt_pk_bf16_f32 v72, v72, v73
v_cvt_pk_bf16_f32 v73, v74, v75
v_mfma_f32_16x16x32_bf16 v[240:243], v[224:227], v[192:195], 0
v_accvgpr_write_b32 a80, v68
v_accvgpr_write_b32 a81, v69
v_accvgpr_write_b32 a82, v72
v_mfma_f32_16x16x32_bf16 v[244:247], v[228:231], v[196:199], 0
buffer_load_dwordx4 v33, s[40:43], s77 offen offset:3072 lds
ds_read_b64_tr_b16 v[90:91], v12 offset:52224
v_mfma_f32_16x16x32_bf16 v[128:131], v[96:99], a[72:75], v[128:131]
ds_read_b64_tr_b16 v[92:93], v13 offset:35840
v_accvgpr_write_b32 a83, v73
v_mfma_f32_16x16x32_bf16 v[144:147], v[96:99], a[76:79], v[144:147]
buffer_load_dwordx4 v[194:197], v46, s[60:63], s91 offen offset:3072 sc1
ds_read_b64_tr_b16 v[94:95], v13 offset:52224
v_mfma_f32_16x16x32_bf16 v[132:135], v[100:103], a[72:75], v[132:135]
ds_read_b64_tr_b16 v[96:97], v10 offset:36864
ds_read_b128 v[224:227], v53 offset:3264
ds_read_b128 v[228:231], v54 offset:3264
v_mfma_f32_16x16x32_bf16 v[148:151], v[100:103], a[76:79], v[148:151]
v_cvt_pk_bf16_f32 v240, v240, v241
v_cvt_pk_bf16_f32 v241, v242, v243
s_waitcnt lgkmcnt(6)
v_mfma_f32_16x16x32_bf16 v[248:251], v[232:235], v[166:169], 0
v_cvt_pk_bf16_f32 v244, v244, v245
v_cvt_pk_bf16_f32 v245, v246, v247
v_accvgpr_write_b32 a84, v240
v_mfma_f32_16x16x32_bf16 v[252:255], v[236:239], v[170:173], 0
s_add_u32 s91, s88, 0x608000
buffer_load_dwordx4 v[168:171], v46, s[60:63], s91 offen offset:0 sc1
v_mfma_f32_16x16x32_bf16 v[136:139], v[104:107], a[72:75], v[136:139]
ds_read_b64_tr_b16 v[98:99], v10 offset:53248
s_add_u32 m0, s76, 102400
s_add_u32 s77, s82, 0x620000
v_mfma_f32_16x16x32_bf16 v[152:155], v[104:107], a[76:79], v[152:155]
ds_read_b64_tr_b16 v[100:101], v11 offset:36864
v_accvgpr_write_b32 a85, v241
v_accvgpr_write_b32 a86, v244
v_mfma_f32_16x16x32_bf16 v[140:143], v[108:111], a[72:75], v[140:143]
ds_read_b64_tr_b16 v[102:103], v11 offset:53248
v_accvgpr_write_b32 a87, v245
v_cvt_pk_bf16_f32 v248, v248, v249
v_mfma_f32_16x16x32_bf16 v[156:159], v[108:111], a[76:79], v[156:159]
buffer_load_dwordx4 v30, s[40:43], s77 offen offset:0 lds
ds_read_b64_tr_b16 v[104:105], v12 offset:36864
v_mfma_f32_16x16x32_bf16 v[68:71], v[232:235], v[198:201], 0
v_cvt_pk_bf16_f32 v249, v250, v251
v_cvt_pk_bf16_f32 v252, v252, v253
v_cvt_pk_bf16_f32 v253, v254, v255
v_mfma_f32_16x16x32_bf16 v[72:75], v[236:239], v[202:205], 0
buffer_load_dwordx4 v[200:203], v46, s[60:63], s91 offen offset:1024 sc1
ds_read_b64_tr_b16 v[106:107], v12 offset:53248
v_mfma_f32_16x16x32_bf16 v[128:131], v[112:115], a[80:83], v[128:131]
ds_read_b64_tr_b16 v[108:109], v13 offset:36864
ds_read_b128 v[232:235], v53 offset:3536
ds_read_b128 v[236:239], v54 offset:3536
v_mfma_f32_16x16x32_bf16 v[144:147], v[112:115], a[84:87], v[144:147]
ds_read_b64_tr_b16 v[110:111], v13 offset:53248
v_accvgpr_write_b32 a88, v248
v_accvgpr_write_b32 a89, v249
v_mfma_f32_16x16x32_bf16 v[132:135], v[116:119], a[80:83], v[132:135]
ds_read_b64_tr_b16 v[112:113], v10 offset:37888
v_accvgpr_write_b32 a90, v252
v_accvgpr_write_b32 a91, v253
v_mfma_f32_16x16x32_bf16 v[148:151], v[116:119], a[84:87], v[148:151]
v_cvt_pk_bf16_f32 v68, v68, v69
v_cvt_pk_bf16_f32 v69, v70, v71
s_waitcnt vmcnt(8) lgkmcnt(6)
v_mfma_f32_16x16x32_bf16 v[240:243], v[224:227], v[172:175], 0
v_cvt_pk_bf16_f32 v72, v72, v73
v_cvt_pk_bf16_f32 v73, v74, v75
v_accvgpr_write_b32 a92, v68
v_mfma_f32_16x16x32_bf16 v[244:247], v[228:231], v[176:179], 0
buffer_load_dwordx4 v[174:177], v46, s[60:63], s91 offen offset:2048 sc1
ds_read_b64_tr_b16 v[114:115], v10 offset:54272
v_mfma_f32_16x16x32_bf16 v[136:139], v[120:123], a[80:83], v[136:139]
ds_read_b64_tr_b16 v[116:117], v11 offset:37888
v_accvgpr_write_b32 a93, v69
v_accvgpr_write_b32 a94, v72
v_mfma_f32_16x16x32_bf16 v[152:155], v[120:123], a[84:87], v[152:155]
buffer_load_dwordx4 v31, s[40:43], s77 offen offset:1024 lds
ds_read_b64_tr_b16 v[118:119], v11 offset:54272
v_mfma_f32_16x16x32_bf16 v[140:143], v[124:127], a[80:83], v[140:143]
ds_read_b64_tr_b16 v[120:121], v12 offset:37888
v_accvgpr_write_b32 a95, v73
v_cvt_pk_bf16_f32 v240, v240, v241
v_mfma_f32_16x16x32_bf16 v[156:159], v[124:127], a[84:87], v[156:159]
v_cvt_pk_bf16_f32 v241, v242, v243
v_cvt_pk_bf16_f32 v244, v244, v245
v_cvt_pk_bf16_f32 v245, v246, v247
v_mfma_f32_16x16x32_bf16 v[248:251], v[224:227], v[204:207], 0
v_accvgpr_write_b32 a96, v240
v_accvgpr_write_b32 a97, v241
v_accvgpr_write_b32 a98, v244
v_mfma_f32_16x16x32_bf16 v[252:255], v[228:231], v[208:211], 0
buffer_load_dwordx4 v[206:209], v46, s[60:63], s91 offen offset:3072 sc1
ds_read_b64_tr_b16 v[122:123], v12 offset:54272
v_mfma_f32_16x16x32_bf16 v[128:131], v[80:83], a[88:91], v[128:131]
ds_read_b64_tr_b16 v[124:125], v13 offset:37888
ds_read_b128 v[224:227], v53 offset:3808
ds_read_b128 v[228:231], v54 offset:3808
v_mfma_f32_16x16x32_bf16 v[144:147], v[80:83], a[92:95], v[144:147]
ds_read_b64_tr_b16 v[126:127], v13 offset:54272
v_accvgpr_write_b32 a99, v245
v_cvt_pk_bf16_f32 v248, v248, v249
v_mfma_f32_16x16x32_bf16 v[132:135], v[84:87], a[88:91], v[132:135]
ds_read_b64_tr_b16 v[80:81], v10 offset:38912
v_cvt_pk_bf16_f32 v249, v250, v251
v_cvt_pk_bf16_f32 v252, v252, v253
v_mfma_f32_16x16x32_bf16 v[148:151], v[84:87], a[92:95], v[148:151]
v_cvt_pk_bf16_f32 v253, v254, v255
v_accvgpr_write_b32 a100, v248
s_waitcnt lgkmcnt(6)
v_mfma_f32_16x16x32_bf16 v[68:71], v[232:235], v[178:181], 0
v_accvgpr_write_b32 a101, v249
v_accvgpr_write_b32 a102, v252
v_accvgpr_write_b32 a103, v253
v_mfma_f32_16x16x32_bf16 v[72:75], v[236:239], v[182:185], 0
buffer_load_dwordx4 v32, s[40:43], s77 offen offset:2048 lds
ds_read_b64_tr_b16 v[82:83], v10 offset:55296
v_mfma_f32_16x16x32_bf16 v[136:139], v[88:91], a[88:91], v[136:139]
ds_read_b64_tr_b16 v[84:85], v11 offset:38912
v_mfma_f32_16x16x32_bf16 v[152:155], v[88:91], a[92:95], v[152:155]
s_add_u32 s91, s88, 0x609000
buffer_load_dwordx4 v[180:183], v46, s[60:63], s91 offen offset:0 sc1
v_mfma_f32_16x16x32_bf16 v[140:143], v[92:95], a[88:91], v[140:143]
ds_read_b64_tr_b16 v[86:87], v11 offset:55296
v_cvt_pk_bf16_f32 v68, v68, v69
v_cvt_pk_bf16_f32 v69, v70, v71
v_mfma_f32_16x16x32_bf16 v[156:159], v[92:95], a[92:95], v[156:159]
ds_read_b64_tr_b16 v[88:89], v12 offset:38912
v_cvt_pk_bf16_f32 v72, v72, v73
v_cvt_pk_bf16_f32 v73, v74, v75
v_mfma_f32_16x16x32_bf16 v[240:243], v[232:235], v[210:213], 0
v_accvgpr_write_b32 a104, v68
v_accvgpr_write_b32 a105, v69
v_accvgpr_write_b32 a106, v72
v_mfma_f32_16x16x32_bf16 v[244:247], v[236:239], v[214:217], 0
buffer_load_dwordx4 v[212:215], v46, s[60:63], s91 offen offset:1024 sc1
ds_read_b64_tr_b16 v[90:91], v12 offset:55296
v_mfma_f32_16x16x32_bf16 v[128:131], v[96:99], a[96:99], v[128:131]
ds_read_b64_tr_b16 v[92:93], v13 offset:38912
ds_read_b128 v[232:235], v53 offset:4080
ds_read_b128 v[236:239], v54 offset:4080
v_mfma_f32_16x16x32_bf16 v[144:147], v[96:99], a[100:103], v[144:147]
ds_read_b64_tr_b16 v[94:95], v13 offset:55296
v_accvgpr_write_b32 a107, v73
v_cvt_pk_bf16_f32 v240, v240, v241
v_mfma_f32_16x16x32_bf16 v[132:135], v[100:103], a[96:99], v[132:135]
ds_read_b64_tr_b16 v[96:97], v10 offset:39936
v_cvt_pk_bf16_f32 v241, v242, v243
v_cvt_pk_bf16_f32 v244, v244, v245
v_mfma_f32_16x16x32_bf16 v[148:151], v[100:103], a[100:103], v[148:151]
buffer_load_dwordx4 v33, s[40:43], s77 offen offset:3072 lds
s_waitcnt lgkmcnt(6)
v_mfma_f32_16x16x32_bf16 v[248:251], v[224:227], v[184:187], 0
v_cvt_pk_bf16_f32 v245, v246, v247
v_accvgpr_write_b32 a108, v240
v_accvgpr_write_b32 a109, v241
v_mfma_f32_16x16x32_bf16 v[252:255], v[228:231], v[188:191], 0
buffer_load_dwordx4 v[186:189], v46, s[60:63], s91 offen offset:2048 sc1
ds_read_b64_tr_b16 v[98:99], v10 offset:56320
v_mfma_f32_16x16x32_bf16 v[136:139], v[104:107], a[96:99], v[136:139]
ds_read_b64_tr_b16 v[100:101], v11 offset:39936
v_accvgpr_write_b32 a110, v244
v_accvgpr_write_b32 a111, v245
v_mfma_f32_16x16x32_bf16 v[152:155], v[104:107], a[100:103], v[152:155]
ds_read_b64_tr_b16 v[102:103], v11 offset:56320
v_cvt_pk_bf16_f32 v248, v248, v249
v_cvt_pk_bf16_f32 v249, v250, v251
v_mfma_f32_16x16x32_bf16 v[140:143], v[108:111], a[96:99], v[140:143]
ds_read_b64_tr_b16 v[104:105], v12 offset:39936
v_cvt_pk_bf16_f32 v252, v252, v253
v_cvt_pk_bf16_f32 v253, v254, v255
v_mfma_f32_16x16x32_bf16 v[156:159], v[108:111], a[100:103], v[156:159]
v_accvgpr_write_b32 a112, v248
v_accvgpr_write_b32 a113, v249
s_waitcnt vmcnt(8)
v_mfma_f32_16x16x32_bf16 v[68:71], v[224:227], v[216:219], 0
v_accvgpr_write_b32 a114, v252
v_accvgpr_write_b32 a115, v253
v_mfma_f32_16x16x32_bf16 v[72:75], v[228:231], v[220:223], 0
buffer_load_dwordx4 v[218:221], v46, s[60:63], s91 offen offset:3072 sc1
ds_read_b64_tr_b16 v[106:107], v12 offset:56320
v_mfma_f32_16x16x32_bf16 v[128:131], v[112:115], a[104:107], v[128:131]
ds_read_b64_tr_b16 v[108:109], v13 offset:39936
s_add_u32 m0, s76, 0
s_add_u32 s77, s85, 0x0
v_mfma_f32_16x16x32_bf16 v[144:147], v[112:115], a[108:111], v[144:147]
ds_read_b64_tr_b16 v[110:111], v13 offset:56320
v_cvt_pk_bf16_f32 v68, v68, v69
v_cvt_pk_bf16_f32 v69, v70, v71
v_mfma_f32_16x16x32_bf16 v[132:135], v[116:119], a[104:107], v[132:135]
v_cvt_pk_bf16_f32 v72, v72, v73
v_cvt_pk_bf16_f32 v73, v74, v75
v_accvgpr_write_b32 a116, v68
v_mfma_f32_16x16x32_bf16 v[148:151], v[116:119], a[108:111], v[148:151]
buffer_load_dwordx4 v34, s[52:55], s77 offen offset:0 lds
s_waitcnt lgkmcnt(3)
v_mfma_f32_16x16x32_bf16 v[240:243], v[232:235], v[160:163], 0
v_accvgpr_write_b32 a117, v69
v_accvgpr_write_b32 a118, v72
v_accvgpr_write_b32 a119, v73
v_mfma_f32_16x16x32_bf16 v[244:247], v[236:239], v[164:167], 0
ds_read_b128 v[224:227], v53 offset:4352
ds_read_b128 v[228:231], v54 offset:4352
v_mfma_f32_16x16x32_bf16 v[136:139], v[120:123], a[104:107], v[136:139]
s_add_u32 s91, s88, 0x60a000
buffer_load_dwordx4 v[162:165], v46, s[60:63], s91 offen offset:0 sc1
v_mfma_f32_16x16x32_bf16 v[152:155], v[120:123], a[108:111], v[152:155]
v_cvt_pk_bf16_f32 v240, v240, v241
v_cvt_pk_bf16_f32 v241, v242, v243
v_cvt_pk_bf16_f32 v244, v244, v245
v_mfma_f32_16x16x32_bf16 v[140:143], v[124:127], a[104:107], v[140:143]
v_cvt_pk_bf16_f32 v245, v246, v247
v_accvgpr_write_b32 a120, v240
v_accvgpr_write_b32 a121, v241
v_mfma_f32_16x16x32_bf16 v[156:159], v[124:127], a[108:111], v[156:159]
v_accvgpr_write_b32 a122, v244
v_accvgpr_write_b32 a123, v245
v_mfma_f32_16x16x32_bf16 v[248:251], v[232:235], v[192:195], 0
s_waitcnt lgkmcnt(0)
s_barrier
ds_read_b64_tr_b16 v[112:113], v14 offset:0
v_mfma_f32_16x16x32_bf16 v[252:255], v[236:239], v[196:199], 0
buffer_load_dwordx4 v35, s[52:55], s77 offen offset:1024 lds
ds_read_b64_tr_b16 v[114:115], v14 offset:16384
v_mfma_f32_16x16x32_bf16 v[128:131], v[80:83], a[112:115], v[128:131]
ds_read_b64_tr_b16 v[116:117], v15 offset:0
ds_read_b64_tr_b16 v[118:119], v15 offset:16384
ds_read_b64_tr_b16 v[120:121], v16 offset:0
v_mfma_f32_16x16x32_bf16 v[144:147], v[80:83], a[116:119], v[144:147]
buffer_load_dwordx4 v[194:197], v46, s[60:63], s91 offen offset:1024 sc1
ds_read_b64_tr_b16 v[122:123], v16 offset:16384
v_mfma_f32_16x16x32_bf16 v[132:135], v[84:87], a[112:115], v[132:135]
ds_read_b64_tr_b16 v[124:125], v17 offset:0
ds_read_b128 v[232:235], v53 offset:4624
ds_read_b128 v[236:239], v54 offset:4624
v_mfma_f32_16x16x32_bf16 v[148:151], v[84:87], a[116:119], v[148:151]
ds_read_b64_tr_b16 v[126:127], v17 offset:16384
v_cvt_pk_bf16_f32 v248, v248, v249
v_cvt_pk_bf16_f32 v249, v250, v251
v_mfma_f32_16x16x32_bf16 v[68:71], v[224:227], v[166:169], 0
ds_read_b64_tr_b16 v[80:81], v14 offset:1024
v_cvt_pk_bf16_f32 v252, v252, v253
v_cvt_pk_bf16_f32 v253, v254, v255
v_mfma_f32_16x16x32_bf16 v[72:75], v[228:231], v[170:173], 0
buffer_load_dwordx4 v[168:171], v46, s[60:63], s91 offen offset:2048 sc1
ds_read_b64_tr_b16 v[82:83], v14 offset:17408
v_mfma_f32_16x16x32_bf16 v[136:139], v[88:91], a[112:115], v[136:139]
ds_read_b64_tr_b16 v[84:85], v15 offset:1024
v_accvgpr_write_b32 a124, v248
v_accvgpr_write_b32 a125, v249
v_mfma_f32_16x16x32_bf16 v[152:155], v[88:91], a[116:119], v[152:155]
ds_read_b64_tr_b16 v[86:87], v15 offset:17408
v_accvgpr_write_b32 a126, v252
v_accvgpr_write_b32 a127, v253
v_mfma_f32_16x16x32_bf16 v[140:143], v[92:95], a[112:115], v[140:143]
ds_read_b64_tr_b16 v[88:89], v16 offset:1024
v_cvt_pk_bf16_f32 v68, v68, v69
v_cvt_pk_bf16_f32 v69, v70, v71
v_mfma_f32_16x16x32_bf16 v[156:159], v[92:95], a[116:119], v[156:159]
buffer_load_dwordx4 v36, s[52:55], s77 offen offset:2048 lds
v_cvt_pk_bf16_f32 v72, v72, v73
v_mfma_f32_16x16x32_bf16 v[240:243], v[224:227], v[198:201], 0
v_cvt_pk_bf16_f32 v73, v74, v75
v_accvgpr_write_b32 a128, v68
v_accvgpr_write_b32 a129, v69
v_mfma_f32_16x16x32_bf16 v[244:247], v[228:231], v[202:205], 0
buffer_load_dwordx4 v[200:203], v46, s[60:63], s91 offen offset:3072 sc1
ds_read_b64_tr_b16 v[90:91], v16 offset:17408
v_mfma_f32_16x16x32_bf16 v[128:131], v[96:99], a[120:123], v[128:131]
ds_read_b64_tr_b16 v[92:93], v17 offset:1024
ds_read_b128 v[224:227], v53 offset:4896
ds_read_b128 v[228:231], v54 offset:4896
v_mfma_f32_16x16x32_bf16 v[144:147], v[96:99], a[124:127], v[144:147]
ds_read_b64_tr_b16 v[94:95], v17 offset:17408
v_accvgpr_write_b32 a130, v72
v_accvgpr_write_b32 a131, v73
v_mfma_f32_16x16x32_bf16 v[132:135], v[100:103], a[120:123], v[132:135]
ds_read_b64_tr_b16 v[96:97], v14 offset:2048
v_cvt_pk_bf16_f32 v240, v240, v241
v_cvt_pk_bf16_f32 v241, v242, v243
v_mfma_f32_16x16x32_bf16 v[148:151], v[100:103], a[124:127], v[148:151]
v_cvt_pk_bf16_f32 v244, v244, v245
v_cvt_pk_bf16_f32 v245, v246, v247
s_waitcnt vmcnt(8) lgkmcnt(6)
v_mfma_f32_16x16x32_bf16 v[248:251], v[232:235], v[172:175], 0
v_accvgpr_write_b32 a132, v240
v_accvgpr_write_b32 a133, v241
v_accvgpr_write_b32 a134, v244
v_mfma_f32_16x16x32_bf16 v[252:255], v[236:239], v[176:179], 0
s_add_u32 s91, s88, 0x60b000
buffer_load_dwordx4 v[174:177], v46, s[60:63], s91 offen offset:0 sc1
v_mfma_f32_16x16x32_bf16 v[136:139], v[104:107], a[120:123], v[136:139]
ds_read_b64_tr_b16 v[98:99], v14 offset:18432
v_accvgpr_write_b32 a135, v245
ds_read_b64_tr_b16 v[100:101], v15 offset:2048
v_mfma_f32_16x16x32_bf16 v[152:155], v[104:107], a[124:127], v[152:155]
buffer_load_dwordx4 v37, s[52:55], s77 offen offset:3072 lds
ds_read_b64_tr_b16 v[102:103], v15 offset:18432
v_mfma_f32_16x16x32_bf16 v[140:143], v[108:111], a[120:123], v[140:143]
ds_read_b64_tr_b16 v[104:105], v16 offset:2048
v_cvt_pk_bf16_f32 v248, v248, v249
v_cvt_pk_bf16_f32 v249, v250, v251
v_mfma_f32_16x16x32_bf16 v[156:159], v[108:111], a[124:127], v[156:159]
v_cvt_pk_bf16_f32 v252, v252, v253
v_cvt_pk_bf16_f32 v253, v254, v255
v_accvgpr_write_b32 a136, v248
v_mfma_f32_16x16x32_bf16 v[68:71], v[232:235], v[204:207], 0
v_accvgpr_write_b32 a137, v249
v_accvgpr_write_b32 a138, v252
v_accvgpr_write_b32 a139, v253
v_mfma_f32_16x16x32_bf16 v[72:75], v[236:239], v[208:211], 0
buffer_load_dwordx4 v[206:209], v46, s[60:63], s91 offen offset:1024 sc1
ds_read_b64_tr_b16 v[106:107], v16 offset:18432
v_mfma_f32_16x16x32_bf16 v[128:131], v[112:115], a[128:131], v[128:131]
ds_read_b64_tr_b16 v[108:109], v17 offset:2048
ds_read_b128 v[232:235], v53 offset:5168
ds_read_b128 v[236:239], v54 offset:5168
v_mfma_f32_16x16x32_bf16 v[144:147], v[112:115], a[132:135], v[144:147]
ds_read_b64_tr_b16 v[110:111], v17 offset:18432
v_cvt_pk_bf16_f32 v68, v68, v69
v_cvt_pk_bf16_f32 v69, v70, v71
v_mfma_f32_16x16x32_bf16 v[132:135], v[116:119], a[128:131], v[132:135]
ds_read_b64_tr_b16 v[112:113], v14 offset:3072
s_add_u32 m0, s76, 4096
s_add_u32 s77, s85, 0xe0000
v_mfma_f32_16x16x32_bf16 v[148:151], v[116:119], a[132:135], v[148:151]
v_cvt_pk_bf16_f32 v72, v72, v73
v_cvt_pk_bf16_f32 v73, v74, v75
s_waitcnt lgkmcnt(6)
v_mfma_f32_16x16x32_bf16 v[240:243], v[224:227], v[178:181], 0
v_accvgpr_write_b32 a140, v68
v_accvgpr_write_b32 a141, v69
v_accvgpr_write_b32 a142, v72
v_mfma_f32_16x16x32_bf16 v[244:247], v[228:231], v[182:185], 0
buffer_load_dwordx4 v34, s[52:55], s77 offen offset:0 lds
ds_read_b64_tr_b16 v[114:115], v14 offset:19456
v_mfma_f32_16x16x32_bf16 v[136:139], v[120:123], a[128:131], v[136:139]
ds_read_b64_tr_b16 v[116:117], v15 offset:3072
v_accvgpr_write_b32 a143, v73
v_mfma_f32_16x16x32_bf16 v[152:155], v[120:123], a[132:135], v[152:155]
buffer_load_dwordx4 v[180:183], v46, s[60:63], s91 offen offset:2048 sc1
ds_read_b64_tr_b16 v[118:119], v15 offset:19456
v_mfma_f32_16x16x32_bf16 v[140:143], v[124:127], a[128:131], v[140:143]
ds_read_b64_tr_b16 v[120:121], v16 offset:3072
v_cvt_pk_bf16_f32 v240, v240, v241
v_cvt_pk_bf16_f32 v241, v242, v243
v_mfma_f32_16x16x32_bf16 v[156:159], v[124:127], a[132:135], v[156:159]
v_cvt_pk_bf16_f32 v244, v244, v245
v_cvt_pk_bf16_f32 v245, v246, v247
v_accvgpr_write_b32 a144, v240
v_mfma_f32_16x16x32_bf16 v[248:251], v[224:227], v[210:213], 0
v_accvgpr_write_b32 a145, v241
v_accvgpr_write_b32 a146, v244
v_accvgpr_write_b32 a147, v245
v_mfma_f32_16x16x32_bf16 v[252:255], v[228:231], v[214:217], 0
buffer_load_dwordx4 v[212:215], v46, s[60:63], s91 offen offset:3072 sc1
ds_read_b64_tr_b16 v[122:123], v16 offset:19456
v_mfma_f32_16x16x32_bf16 v[128:131], v[80:83], a[136:139], v[128:131]
ds_read_b64_tr_b16 v[124:125], v17 offset:3072
ds_read_b128 v[224:227], v53 offset:5440
ds_read_b128 v[228:231], v54 offset:5440
v_mfma_f32_16x16x32_bf16 v[144:147], v[80:83], a[140:143], v[144:147]
ds_read_b64_tr_b16 v[126:127], v17 offset:19456
v_cvt_pk_bf16_f32 v248, v248, v249
v_cvt_pk_bf16_f32 v249, v250, v251
v_mfma_f32_16x16x32_bf16 v[132:135], v[84:87], a[136:139], v[132:135]
ds_read_b64_tr_b16 v[80:81], v14 offset:4096
v_cvt_pk_bf16_f32 v252, v252, v253
v_cvt_pk_bf16_f32 v253, v254, v255
v_mfma_f32_16x16x32_bf16 v[148:151], v[84:87], a[140:143], v[148:151]
buffer_load_dwordx4 v35, s[52:55], s77 offen offset:1024 lds
s_waitcnt lgkmcnt(6)
v_mfma_f32_16x16x32_bf16 v[68:71], v[232:235], v[184:187], 0
v_accvgpr_write_b32 a148, v248
v_accvgpr_write_b32 a149, v249
v_accvgpr_write_b32 a150, v252
v_mfma_f32_16x16x32_bf16 v[72:75], v[236:239], v[188:191], 0
s_add_u32 s91, s88, 0x60c000
buffer_load_dwordx4 v[186:189], v46, s[60:63], s91 offen offset:0 sc1
v_mfma_f32_16x16x32_bf16 v[136:139], v[88:91], a[136:139], v[136:139]
ds_read_b64_tr_b16 v[82:83], v14 offset:20480
v_accvgpr_write_b32 a151, v253
ds_read_b64_tr_b16 v[84:85], v15 offset:4096
v_mfma_f32_16x16x32_bf16 v[152:155], v[88:91], a[140:143], v[152:155]
ds_read_b64_tr_b16 v[86:87], v15 offset:20480
v_cvt_pk_bf16_f32 v68, v68, v69
v_cvt_pk_bf16_f32 v69, v70, v71
v_mfma_f32_16x16x32_bf16 v[140:143], v[92:95], a[136:139], v[140:143]
ds_read_b64_tr_b16 v[88:89], v16 offset:4096
v_cvt_pk_bf16_f32 v72, v72, v73
v_cvt_pk_bf16_f32 v73, v74, v75
v_mfma_f32_16x16x32_bf16 v[156:159], v[92:95], a[140:143], v[156:159]
v_accvgpr_write_b32 a152, v68
v_accvgpr_write_b32 a153, v69
s_waitcnt vmcnt(8)
v_mfma_f32_16x16x32_bf16 v[240:243], v[232:235], v[216:219], 0
v_accvgpr_write_b32 a154, v72
v_accvgpr_write_b32 a155, v73
v_mfma_f32_16x16x32_bf16 v[244:247], v[236:239], v[220:223], 0
buffer_load_dwordx4 v[218:221], v46, s[60:63], s91 offen offset:1024 sc1
ds_read_b64_tr_b16 v[90:91], v16 offset:20480
v_mfma_f32_16x16x32_bf16 v[128:131], v[96:99], a[144:147], v[128:131]
ds_read_b64_tr_b16 v[92:93], v17 offset:4096
ds_read_b128 v[232:235], v53 offset:5712
ds_read_b128 v[236:239], v54 offset:5712
v_mfma_f32_16x16x32_bf16 v[144:147], v[96:99], a[148:151], v[144:147]
buffer_load_dwordx4 v36, s[52:55], s77 offen offset:2048 lds
ds_read_b64_tr_b16 v[94:95], v17 offset:20480
v_mfma_f32_16x16x32_bf16 v[132:135], v[100:103], a[144:147], v[132:135]
ds_read_b64_tr_b16 v[96:97], v14 offset:5120
v_cvt_pk_bf16_f32 v240, v240, v241
v_cvt_pk_bf16_f32 v241, v242, v243
v_mfma_f32_16x16x32_bf16 v[148:151], v[100:103], a[148:151], v[148:151]
v_cvt_pk_bf16_f32 v244, v244, v245
v_cvt_pk_bf16_f32 v245, v246, v247
s_waitcnt lgkmcnt(6)
v_mfma_f32_16x16x32_bf16 v[248:251], v[224:227], v[160:163], 0
v_accvgpr_write_b32 a156, v240
v_accvgpr_write_b32 a157, v241
v_accvgpr_write_b32 a158, v244
v_mfma_f32_16x16x32_bf16 v[252:255], v[228:231], v[164:167], 0
buffer_load_dwordx4 v[162:165], v46, s[60:63], s91 offen offset:2048 sc1
ds_read_b64_tr_b16 v[98:99], v14 offset:21504
v_mfma_f32_16x16x32_bf16 v[136:139], v[104:107], a[144:147], v[136:139]
ds_read_b64_tr_b16 v[100:101], v15 offset:5120
v_accvgpr_write_b32 a159, v245
v_mfma_f32_16x16x32_bf16 v[152:155], v[104:107], a[148:151], v[152:155]
ds_read_b64_tr_b16 v[102:103], v15 offset:21504
v_cvt_pk_bf16_f32 v248, v248, v249
v_cvt_pk_bf16_f32 v249, v250, v251
v_mfma_f32_16x16x32_bf16 v[140:143], v[108:111], a[144:147], v[140:143]
ds_read_b64_tr_b16 v[104:105], v16 offset:5120
v_cvt_pk_bf16_f32 v252, v252, v253
v_cvt_pk_bf16_f32 v253, v254, v255
v_mfma_f32_16x16x32_bf16 v[156:159], v[108:111], a[148:151], v[156:159]
v_accvgpr_write_b32 a160, v248
v_accvgpr_write_b32 a161, v249
v_accvgpr_write_b32 a162, v252
v_mfma_f32_16x16x32_bf16 v[68:71], v[224:227], v[192:195], 0
v_accvgpr_write_b32 a163, v253
v_mfma_f32_16x16x32_bf16 v[72:75], v[228:231], v[196:199], 0
buffer_load_dwordx4 v37, s[52:55], s77 offen offset:3072 lds
ds_read_b64_tr_b16 v[106:107], v16 offset:21504
v_mfma_f32_16x16x32_bf16 v[128:131], v[112:115], a[152:155], v[128:131]
ds_read_b64_tr_b16 v[108:109], v17 offset:5120
v_mfma_f32_16x16x32_bf16 v[144:147], v[112:115], a[156:159], v[144:147]
buffer_load_dwordx4 v[194:197], v46, s[60:63], s91 offen offset:3072 sc1
ds_read_b64_tr_b16 v[110:111], v17 offset:21504
v_mfma_f32_16x16x32_bf16 v[132:135], v[116:119], a[152:155], v[132:135]
ds_read_b64_tr_b16 v[112:113], v14 offset:6144
ds_read_b128 v[224:227], v53 offset:5984
ds_read_b128 v[228:231], v54 offset:5984
v_mfma_f32_16x16x32_bf16 v[148:151], v[116:119], a[156:159], v[148:151]
v_cvt_pk_bf16_f32 v68, v68, v69
v_cvt_pk_bf16_f32 v69, v70, v71
s_waitcnt lgkmcnt(6)
v_mfma_f32_16x16x32_bf16 v[240:243], v[232:235], v[166:169], 0
v_cvt_pk_bf16_f32 v72, v72, v73
v_cvt_pk_bf16_f32 v73, v74, v75
v_accvgpr_write_b32 a164, v68
v_mfma_f32_16x16x32_bf16 v[244:247], v[236:239], v[170:173], 0
s_add_u32 s91, s88, 0x60d000
buffer_load_dwordx4 v[168:171], v46, s[60:63], s91 offen offset:0 sc1
v_mfma_f32_16x16x32_bf16 v[136:139], v[120:123], a[152:155], v[136:139]
ds_read_b64_tr_b16 v[114:115], v14 offset:22528
v_accvgpr_write_b32 a165, v69
v_accvgpr_write_b32 a166, v72
v_mfma_f32_16x16x32_bf16 v[152:155], v[120:123], a[156:159], v[152:155]
ds_read_b64_tr_b16 v[116:117], v15 offset:6144
v_accvgpr_write_b32 a167, v73
v_cvt_pk_bf16_f32 v240, v240, v241
v_mfma_f32_16x16x32_bf16 v[140:143], v[124:127], a[152:155], v[140:143]
ds_read_b64_tr_b16 v[118:119], v15 offset:22528
s_add_u32 m0, s76, 32768
s_add_u32 s77, s82, 0x0
v_mfma_f32_16x16x32_bf16 v[156:159], v[124:127], a[156:159], v[156:159]
ds_read_b64_tr_b16 v[120:121], v16 offset:6144
v_cvt_pk_bf16_f32 v241, v242, v243
v_cvt_pk_bf16_f32 v244, v244, v245
v_mfma_f32_16x16x32_bf16 v[248:251], v[232:235], v[198:201], 0
v_cvt_pk_bf16_f32 v245, v246, v247
v_accvgpr_write_b32 a168, v240
v_accvgpr_write_b32 a169, v241
v_mfma_f32_16x16x32_bf16 v[252:255], v[236:239], v[202:205], 0
buffer_load_dwordx4 v30, s[44:47], s77 offen offset:0 lds
ds_read_b64_tr_b16 v[122:123], v16 offset:22528
v_mfma_f32_16x16x32_bf16 v[128:131], v[80:83], a[160:163], v[128:131]
ds_read_b64_tr_b16 v[124:125], v17 offset:6144
v_accvgpr_write_b32 a170, v244
v_accvgpr_write_b32 a171, v245
v_mfma_f32_16x16x32_bf16 v[144:147], v[80:83], a[164:167], v[144:147]
buffer_load_dwordx4 v[200:203], v46, s[60:63], s91 offen offset:1024 sc1
ds_read_b64_tr_b16 v[126:127], v17 offset:22528
v_mfma_f32_16x16x32_bf16 v[132:135], v[84:87], a[160:163], v[132:135]
ds_read_b64_tr_b16 v[80:81], v14 offset:7168
ds_read_b128 v[232:235], v53 offset:6256
ds_read_b128 v[236:239], v54 offset:6256
v_mfma_f32_16x16x32_bf16 v[148:151], v[84:87], a[164:167], v[148:151]
v_cvt_pk_bf16_f32 v248, v248, v249
v_cvt_pk_bf16_f32 v249, v250, v251
s_waitcnt vmcnt(8) lgkmcnt(6)
v_mfma_f32_16x16x32_bf16 v[68:71], v[224:227], v[172:175], 0
v_cvt_pk_bf16_f32 v252, v252, v253
v_cvt_pk_bf16_f32 v253, v254, v255
v_accvgpr_write_b32 a172, v248
v_mfma_f32_16x16x32_bf16 v[72:75], v[228:231], v[176:179], 0
buffer_load_dwordx4 v[174:177], v46, s[60:63], s91 offen offset:2048 sc1
ds_read_b64_tr_b16 v[82:83], v14 offset:23552
v_mfma_f32_16x16x32_bf16 v[136:139], v[88:91], a[160:163], v[136:139]
ds_read_b64_tr_b16 v[84:85], v15 offset:7168
v_accvgpr_write_b32 a173, v249
v_accvgpr_write_b32 a174, v252
v_mfma_f32_16x16x32_bf16 v[152:155], v[88:91], a[164:167], v[152:155]
ds_read_b64_tr_b16 v[86:87], v15 offset:23552
v_accvgpr_write_b32 a175, v253
v_cvt_pk_bf16_f32 v68, v68, v69
v_mfma_f32_16x16x32_bf16 v[140:143], v[92:95], a[160:163], v[140:143]
ds_read_b64_tr_b16 v[88:89], v16 offset:7168
v_cvt_pk_bf16_f32 v69, v70, v71
v_cvt_pk_bf16_f32 v72, v72, v73
v_mfma_f32_16x16x32_bf16 v[156:159], v[92:95], a[164:167], v[156:159]
v_cvt_pk_bf16_f32 v73, v74, v75
v_accvgpr_write_b32 a176, v68
v_accvgpr_write_b32 a177, v69
v_mfma_f32_16x16x32_bf16 v[240:243], v[224:227], v[204:207], 0
v_accvgpr_write_b32 a178, v72
v_accvgpr_write_b32 a179, v73
v_mfma_f32_16x16x32_bf16 v[244:247], v[228:231], v[208:211], 0
buffer_load_dwordx4 v31, s[44:47], s77 offen offset:1024 lds
ds_read_b64_tr_b16 v[90:91], v16 offset:23552
v_mfma_f32_16x16x32_bf16 v[128:131], v[96:99], a[168:171], v[128:131]
ds_read_b64_tr_b16 v[92:93], v17 offset:7168
v_mfma_f32_16x16x32_bf16 v[144:147], v[96:99], a[172:175], v[144:147]
buffer_load_dwordx4 v[206:209], v46, s[60:63], s91 offen offset:3072 sc1
ds_read_b64_tr_b16 v[94:95], v17 offset:23552
v_mfma_f32_16x16x32_bf16 v[132:135], v[100:103], a[168:171], v[132:135]
v_cvt_pk_bf16_f32 v240, v240, v241
v_cvt_pk_bf16_f32 v241, v242, v243
v_cvt_pk_bf16_f32 v244, v244, v245
v_mfma_f32_16x16x32_bf16 v[148:151], v[100:103], a[172:175], v[148:151]
v_cvt_pk_bf16_f32 v245, v246, v247
v_accvgpr_write_b32 a180, v240
s_waitcnt lgkmcnt(3)
v_mfma_f32_16x16x32_bf16 v[248:251], v[232:235], v[178:181], 0
v_accvgpr_write_b32 a181, v241
v_accvgpr_write_b32 a182, v244
v_accvgpr_write_b32 a183, v245
v_mfma_f32_16x16x32_bf16 v[252:255], v[236:239], v[182:185], 0
ds_read_b128 v[224:227], v53 offset:6528
ds_read_b128 v[228:231], v54 offset:6528
v_mfma_f32_16x16x32_bf16 v[136:139], v[104:107], a[168:171], v[136:139]
s_add_u32 s91, s88, 0x60e000
buffer_load_dwordx4 v[180:183], v46, s[60:63], s91 offen offset:0 sc1
v_mfma_f32_16x16x32_bf16 v[152:155], v[104:107], a[172:175], v[152:155]
v_cvt_pk_bf16_f32 v248, v248, v249
v_cvt_pk_bf16_f32 v249, v250, v251
v_cvt_pk_bf16_f32 v252, v252, v253
v_mfma_f32_16x16x32_bf16 v[140:143], v[108:111], a[168:171], v[140:143]
v_cvt_pk_bf16_f32 v253, v254, v255
v_accvgpr_write_b32 a184, v248
v_accvgpr_write_b32 a185, v249
v_mfma_f32_16x16x32_bf16 v[156:159], v[108:111], a[172:175], v[156:159]
v_accvgpr_write_b32 a186, v252
v_accvgpr_write_b32 a187, v253
v_mfma_f32_16x16x32_bf16 v[68:71], v[232:235], v[210:213], 0
s_waitcnt lgkmcnt(0)
s_barrier
ds_read_b64_tr_b16 v[96:97], v14 offset:32768
v_mfma_f32_16x16x32_bf16 v[72:75], v[236:239], v[214:217], 0
buffer_load_dwordx4 v32, s[44:47], s77 offen offset:2048 lds
ds_read_b64_tr_b16 v[98:99], v14 offset:49152
v_mfma_f32_16x16x32_bf16 v[128:131], v[112:115], a[176:179], v[128:131]
ds_read_b64_tr_b16 v[100:101], v15 offset:32768
ds_read_b64_tr_b16 v[102:103], v15 offset:49152
ds_read_b64_tr_b16 v[104:105], v16 offset:32768
v_mfma_f32_16x16x32_bf16 v[144:147], v[112:115], a[180:183], v[144:147]
buffer_load_dwordx4 v[212:215], v46, s[60:63], s91 offen offset:1024 sc1
ds_read_b64_tr_b16 v[106:107], v16 offset:49152
v_mfma_f32_16x16x32_bf16 v[132:135], v[116:119], a[176:179], v[132:135]
ds_read_b64_tr_b16 v[108:109], v17 offset:32768
ds_read_b128 v[232:235], v53 offset:6800
ds_read_b128 v[236:239], v54 offset:6800
v_mfma_f32_16x16x32_bf16 v[148:151], v[116:119], a[180:183], v[148:151]
ds_read_b64_tr_b16 v[110:111], v17 offset:49152
v_cvt_pk_bf16_f32 v68, v68, v69
v_cvt_pk_bf16_f32 v69, v70, v71
v_mfma_f32_16x16x32_bf16 v[240:243], v[224:227], v[184:187], 0
ds_read_b64_tr_b16 v[112:113], v14 offset:33792
v_cvt_pk_bf16_f32 v72, v72, v73
v_cvt_pk_bf16_f32 v73, v74, v75
v_mfma_f32_16x16x32_bf16 v[244:247], v[228:231], v[188:191], 0
buffer_load_dwordx4 v[186:189], v46, s[60:63], s91 offen offset:2048 sc1
ds_read_b64_tr_b16 v[114:115], v14 offset:50176
v_mfma_f32_16x16x32_bf16 v[136:139], v[120:123], a[176:179], v[136:139]
ds_read_b64_tr_b16 v[116:117], v15 offset:33792
v_accvgpr_write_b32 a188, v68
v_accvgpr_write_b32 a189, v69
v_mfma_f32_16x16x32_bf16 v[152:155], v[120:123], a[180:183], v[152:155]
ds_read_b64_tr_b16 v[118:119], v15 offset:50176
v_accvgpr_write_b32 a190, v72
v_accvgpr_write_b32 a191, v73
v_mfma_f32_16x16x32_bf16 v[140:143], v[124:127], a[176:179], v[140:143]
ds_read_b64_tr_b16 v[120:121], v16 offset:33792
v_cvt_pk_bf16_f32 v240, v240, v241
v_cvt_pk_bf16_f32 v241, v242, v243
v_mfma_f32_16x16x32_bf16 v[156:159], v[124:127], a[180:183], v[156:159]
buffer_load_dwordx4 v33, s[44:47], s77 offen offset:3072 lds
s_waitcnt vmcnt(8)
v_mfma_f32_16x16x32_bf16 v[248:251], v[224:227], v[216:219], 0
v_cvt_pk_bf16_f32 v244, v244, v245
v_cvt_pk_bf16_f32 v245, v246, v247
v_accvgpr_write_b32 a192, v240
v_mfma_f32_16x16x32_bf16 v[252:255], v[228:231], v[220:223], 0
buffer_load_dwordx4 v[218:221], v46, s[60:63], s91 offen offset:3072 sc1
ds_read_b64_tr_b16 v[122:123], v16 offset:50176
v_mfma_f32_16x16x32_bf16 v[128:131], v[80:83], a[184:187], v[128:131]
ds_read_b64_tr_b16 v[124:125], v17 offset:33792
ds_read_b128 v[224:227], v53 offset:7072
ds_read_b128 v[228:231], v54 offset:7072
v_mfma_f32_16x16x32_bf16 v[144:147], v[80:83], a[188:191], v[144:147]
ds_read_b64_tr_b16 v[126:127], v17 offset:50176
v_accvgpr_write_b32 a193, v241
v_accvgpr_write_b32 a194, v244
v_mfma_f32_16x16x32_bf16 v[132:135], v[84:87], a[184:187], v[132:135]
ds_read_b64_tr_b16 v[80:81], v14 offset:34816
v_accvgpr_write_b32 a195, v245
v_cvt_pk_bf16_f32 v248, v248, v249
v_mfma_f32_16x16x32_bf16 v[148:151], v[84:87], a[188:191], v[148:151]
v_cvt_pk_bf16_f32 v249, v250, v251
v_cvt_pk_bf16_f32 v252, v252, v253
s_waitcnt lgkmcnt(6)
v_mfma_f32_16x16x32_bf16 v[68:71], v[232:235], v[160:163], 0
v_cvt_pk_bf16_f32 v253, v254, v255
s_add_u32 m0, s76, 36864
s_add_u32 s77, s82, 0xe0000
v_mfma_f32_16x16x32_bf16 v[72:75], v[236:239], v[164:167], 0
s_add_u32 s91, s88, 0x60f000
buffer_load_dwordx4 v[162:165], v46, s[60:63], s91 offen offset:0 sc1
v_mfma_f32_16x16x32_bf16 v[136:139], v[88:91], a[184:187], v[136:139]
ds_read_b64_tr_b16 v[82:83], v14 offset:51200
v_accvgpr_write_b32 a196, v248
v_accvgpr_write_b32 a197, v249
v_mfma_f32_16x16x32_bf16 v[152:155], v[88:91], a[188:191], v[152:155]
buffer_load_dwordx4 v30, s[44:47], s77 offen offset:0 lds
ds_read_b64_tr_b16 v[84:85], v15 offset:34816
v_mfma_f32_16x16x32_bf16 v[140:143], v[92:95], a[184:187], v[140:143]
ds_read_b64_tr_b16 v[86:87], v15 offset:51200
v_accvgpr_write_b32 a198, v252
v_accvgpr_write_b32 a199, v253
v_mfma_f32_16x16x32_bf16 v[156:159], v[92:95], a[188:191], v[156:159]
ds_read_b64_tr_b16 v[88:89], v16 offset:34816
v_cvt_pk_bf16_f32 v68, v68, v69
v_cvt_pk_bf16_f32 v69, v70, v71
v_mfma_f32_16x16x32_bf16 v[240:243], v[232:235], v[192:195], 0
v_cvt_pk_bf16_f32 v72, v72, v73
v_cvt_pk_bf16_f32 v73, v74, v75
v_accvgpr_write_b32 a200, v68
v_mfma_f32_16x16x32_bf16 v[244:247], v[236:239], v[196:199], 0
buffer_load_dwordx4 v[194:197], v46, s[60:63], s91 offen offset:1024 sc1
ds_read_b64_tr_b16 v[90:91], v16 offset:51200
v_mfma_f32_16x16x32_bf16 v[128:131], v[96:99], a[192:195], v[128:131]
ds_read_b64_tr_b16 v[92:93], v17 offset:34816
ds_read_b128 v[232:235], v53 offset:7344
ds_read_b128 v[236:239], v54 offset:7344
v_mfma_f32_16x16x32_bf16 v[144:147], v[96:99], a[196:199], v[144:147]
ds_read_b64_tr_b16 v[94:95], v17 offset:51200
v_accvgpr_write_b32 a201, v69
v_accvgpr_write_b32 a202, v72
v_mfma_f32_16x16x32_bf16 v[132:135], v[100:103], a[192:195], v[132:135]
ds_read_b64_tr_b16 v[96:97], v14 offset:35840
v_accvgpr_write_b32 a203, v73
v_cvt_pk_bf16_f32 v240, v240, v241
v_mfma_f32_16x16x32_bf16 v[148:151], v[100:103], a[196:199], v[148:151]
v_cvt_pk_bf16_f32 v241, v242, v243
v_cvt_pk_bf16_f32 v244, v244, v245
s_waitcnt lgkmcnt(6)
v_mfma_f32_16x16x32_bf16 v[248:251], v[224:227], v[166:169], 0
v_cvt_pk_bf16_f32 v245, v246, v247
v_accvgpr_write_b32 a204, v240
v_accvgpr_write_b32 a205, v241
v_mfma_f32_16x16x32_bf16 v[252:255], v[228:231], v[170:173], 0
buffer_load_dwordx4 v31, s[44:47], s77 offen offset:1024 lds
ds_read_b64_tr_b16 v[98:99], v14 offset:52224
v_mfma_f32_16x16x32_bf16 v[136:139], v[104:107], a[192:195], v[136:139]
ds_read_b64_tr_b16 v[100:101], v15 offset:35840
v_accvgpr_write_b32 a206, v244
v_accvgpr_write_b32 a207, v245
v_mfma_f32_16x16x32_bf16 v[152:155], v[104:107], a[196:199], v[152:155]
buffer_load_dwordx4 v[168:171], v46, s[60:63], s91 offen offset:2048 sc1
ds_read_b64_tr_b16 v[102:103], v15 offset:52224
v_mfma_f32_16x16x32_bf16 v[140:143], v[108:111], a[192:195], v[140:143]
ds_read_b64_tr_b16 v[104:105], v16 offset:35840
v_cvt_pk_bf16_f32 v248, v248, v249
v_cvt_pk_bf16_f32 v249, v250, v251
v_mfma_f32_16x16x32_bf16 v[156:159], v[108:111], a[196:199], v[156:159]
v_cvt_pk_bf16_f32 v252, v252, v253
v_cvt_pk_bf16_f32 v253, v254, v255
v_accvgpr_write_b32 a208, v248
v_mfma_f32_16x16x32_bf16 v[68:71], v[224:227], v[198:201], 0
v_accvgpr_write_b32 a209, v249
v_accvgpr_write_b32 a210, v252
v_accvgpr_write_b32 a211, v253
v_mfma_f32_16x16x32_bf16 v[72:75], v[228:231], v[202:205], 0
buffer_load_dwordx4 v[200:203], v46, s[60:63], s91 offen offset:3072 sc1
ds_read_b64_tr_b16 v[106:107], v16 offset:52224
v_mfma_f32_16x16x32_bf16 v[128:131], v[112:115], a[200:203], v[128:131]
ds_read_b64_tr_b16 v[108:109], v17 offset:35840
ds_read_b128 v[224:227], v53 offset:7616
ds_read_b128 v[228:231], v54 offset:7616
v_mfma_f32_16x16x32_bf16 v[144:147], v[112:115], a[204:207], v[144:147]
ds_read_b64_tr_b16 v[110:111], v17 offset:52224
v_cvt_pk_bf16_f32 v68, v68, v69
v_cvt_pk_bf16_f32 v69, v70, v71
v_mfma_f32_16x16x32_bf16 v[132:135], v[116:119], a[200:203], v[132:135]
ds_read_b64_tr_b16 v[112:113], v14 offset:36864
v_cvt_pk_bf16_f32 v72, v72, v73
v_cvt_pk_bf16_f32 v73, v74, v75
v_mfma_f32_16x16x32_bf16 v[148:151], v[116:119], a[204:207], v[148:151]
buffer_load_dwordx4 v32, s[44:47], s77 offen offset:2048 lds
s_waitcnt vmcnt(9) lgkmcnt(6)
v_mfma_f32_16x16x32_bf16 v[240:243], v[232:235], v[172:175], 0
v_accvgpr_write_b32 a212, v68
v_accvgpr_write_b32 a213, v69
v_accvgpr_write_b32 a214, v72
v_mfma_f32_16x16x32_bf16 v[244:247], v[236:239], v[176:179], 0
ds_read_b64_tr_b16 v[114:115], v14 offset:53248
v_accvgpr_write_b32 a215, v73
v_mfma_f32_16x16x32_bf16 v[136:139], v[120:123], a[200:203], v[136:139]
ds_read_b64_tr_b16 v[116:117], v15 offset:36864
v_mfma_f32_16x16x32_bf16 v[152:155], v[120:123], a[204:207], v[152:155]
ds_read_b64_tr_b16 v[118:119], v15 offset:53248
v_cvt_pk_bf16_f32 v240, v240, v241
v_cvt_pk_bf16_f32 v241, v242, v243
v_mfma_f32_16x16x32_bf16 v[140:143], v[124:127], a[200:203], v[140:143]
ds_read_b64_tr_b16 v[120:121], v16 offset:36864
v_cvt_pk_bf16_f32 v244, v244, v245
v_cvt_pk_bf16_f32 v245, v246, v247
v_mfma_f32_16x16x32_bf16 v[156:159], v[124:127], a[204:207], v[156:159]
v_accvgpr_write_b32 a216, v240
v_accvgpr_write_b32 a217, v241
v_accvgpr_write_b32 a218, v244
v_mfma_f32_16x16x32_bf16 v[248:251], v[232:235], v[204:207], 0
v_accvgpr_write_b32 a219, v245
v_mfma_f32_16x16x32_bf16 v[252:255], v[236:239], v[208:211], 0
ds_read_b64_tr_b16 v[122:123], v16 offset:53248
ds_read_b128 v[232:235], v53 offset:7888
ds_read_b128 v[236:239], v54 offset:7888
v_mfma_f32_16x16x32_bf16 v[128:131], v[80:83], a[208:211], v[128:131]
ds_read_b64_tr_b16 v[124:125], v17 offset:36864
v_mfma_f32_16x16x32_bf16 v[144:147], v[80:83], a[212:215], v[144:147]
buffer_load_dwordx4 v33, s[44:47], s77 offen offset:3072 lds
ds_read_b64_tr_b16 v[126:127], v17 offset:53248
v_mfma_f32_16x16x32_bf16 v[132:135], v[84:87], a[208:211], v[132:135]
ds_read_b64_tr_b16 v[80:81], v14 offset:37888
v_cvt_pk_bf16_f32 v248, v248, v249
v_cvt_pk_bf16_f32 v249, v250, v251
v_mfma_f32_16x16x32_bf16 v[148:151], v[84:87], a[212:215], v[148:151]
v_cvt_pk_bf16_f32 v252, v252, v253
v_cvt_pk_bf16_f32 v253, v254, v255
s_waitcnt lgkmcnt(6)
v_mfma_f32_16x16x32_bf16 v[68:71], v[224:227], v[178:181], 0
v_accvgpr_write_b32 a220, v248
v_accvgpr_write_b32 a221, v249
v_accvgpr_write_b32 a222, v252
v_mfma_f32_16x16x32_bf16 v[72:75], v[228:231], v[182:185], 0
ds_read_b64_tr_b16 v[82:83], v14 offset:54272
v_accvgpr_write_b32 a223, v253
v_mfma_f32_16x16x32_bf16 v[136:139], v[88:91], a[208:211], v[136:139]
ds_read_b64_tr_b16 v[84:85], v15 offset:37888
v_mfma_f32_16x16x32_bf16 v[152:155], v[88:91], a[212:215], v[152:155]
ds_read_b64_tr_b16 v[86:87], v15 offset:54272
v_cvt_pk_bf16_f32 v68, v68, v69
v_cvt_pk_bf16_f32 v69, v70, v71
v_mfma_f32_16x16x32_bf16 v[140:143], v[92:95], a[208:211], v[140:143]
ds_read_b64_tr_b16 v[88:89], v16 offset:37888
v_cvt_pk_bf16_f32 v72, v72, v73
v_cvt_pk_bf16_f32 v73, v74, v75
v_mfma_f32_16x16x32_bf16 v[156:159], v[92:95], a[212:215], v[156:159]
v_accvgpr_write_b32 a224, v68
v_accvgpr_write_b32 a225, v69
v_accvgpr_write_b32 a226, v72
v_mfma_f32_16x16x32_bf16 v[240:243], v[224:227], v[210:213], 0
v_accvgpr_write_b32 a227, v73
s_add_u32 m0, s76, 65536
s_add_u32 s77, s82, 0x1c0000
v_mfma_f32_16x16x32_bf16 v[244:247], v[228:231], v[214:217], 0
ds_read_b64_tr_b16 v[90:91], v16 offset:54272
ds_read_b128 v[224:227], v53 offset:8160
ds_read_b128 v[228:231], v54 offset:8160
v_mfma_f32_16x16x32_bf16 v[128:131], v[96:99], a[216:219], v[128:131]
ds_read_b64_tr_b16 v[92:93], v17 offset:37888
v_mfma_f32_16x16x32_bf16 v[144:147], v[96:99], a[220:223], v[144:147]
buffer_load_dwordx4 v30, s[44:47], s77 offen offset:0 lds
ds_read_b64_tr_b16 v[94:95], v17 offset:54272
v_mfma_f32_16x16x32_bf16 v[132:135], v[100:103], a[216:219], v[132:135]
ds_read_b64_tr_b16 v[96:97], v14 offset:38912
v_cvt_pk_bf16_f32 v240, v240, v241
v_cvt_pk_bf16_f32 v241, v242, v243
v_mfma_f32_16x16x32_bf16 v[148:151], v[100:103], a[220:223], v[148:151]
v_cvt_pk_bf16_f32 v244, v244, v245
v_cvt_pk_bf16_f32 v245, v246, v247
s_waitcnt lgkmcnt(6)
v_mfma_f32_16x16x32_bf16 v[248:251], v[232:235], v[184:187], 0
v_accvgpr_write_b32 a228, v240
v_accvgpr_write_b32 a229, v241
v_accvgpr_write_b32 a230, v244
v_mfma_f32_16x16x32_bf16 v[252:255], v[236:239], v[188:191], 0
ds_read_b64_tr_b16 v[98:99], v14 offset:55296
v_accvgpr_write_b32 a231, v245
v_mfma_f32_16x16x32_bf16 v[136:139], v[104:107], a[216:219], v[136:139]
ds_read_b64_tr_b16 v[100:101], v15 offset:38912
v_mfma_f32_16x16x32_bf16 v[152:155], v[104:107], a[220:223], v[152:155]
ds_read_b64_tr_b16 v[102:103], v15 offset:55296
v_cvt_pk_bf16_f32 v248, v248, v249
v_cvt_pk_bf16_f32 v249, v250, v251
v_mfma_f32_16x16x32_bf16 v[140:143], v[108:111], a[216:219], v[140:143]
ds_read_b64_tr_b16 v[104:105], v16 offset:38912
v_cvt_pk_bf16_f32 v252, v252, v253
v_cvt_pk_bf16_f32 v253, v254, v255
v_mfma_f32_16x16x32_bf16 v[156:159], v[108:111], a[220:223], v[156:159]
v_accvgpr_write_b32 a232, v248
v_accvgpr_write_b32 a233, v249
s_waitcnt vmcnt(3)
v_mfma_f32_16x16x32_bf16 v[68:71], v[232:235], v[216:219], 0
v_accvgpr_write_b32 a234, v252
v_accvgpr_write_b32 a235, v253
v_mfma_f32_16x16x32_bf16 v[72:75], v[236:239], v[220:223], 0
ds_read_b64_tr_b16 v[106:107], v16 offset:55296
ds_read_b128 v[232:235], v53 offset:8432
ds_read_b128 v[236:239], v54 offset:8432
v_mfma_f32_16x16x32_bf16 v[128:131], v[112:115], a[224:227], v[128:131]
ds_read_b64_tr_b16 v[108:109], v17 offset:38912
v_mfma_f32_16x16x32_bf16 v[144:147], v[112:115], a[228:231], v[144:147]
buffer_load_dwordx4 v31, s[44:47], s77 offen offset:1024 lds
ds_read_b64_tr_b16 v[110:111], v17 offset:55296
v_mfma_f32_16x16x32_bf16 v[132:135], v[116:119], a[224:227], v[132:135]
ds_read_b64_tr_b16 v[112:113], v14 offset:39936
v_cvt_pk_bf16_f32 v68, v68, v69
v_cvt_pk_bf16_f32 v69, v70, v71
v_mfma_f32_16x16x32_bf16 v[148:151], v[116:119], a[228:231], v[148:151]
v_cvt_pk_bf16_f32 v72, v72, v73
v_cvt_pk_bf16_f32 v73, v74, v75
s_waitcnt lgkmcnt(6)
v_mfma_f32_16x16x32_bf16 v[240:243], v[224:227], v[160:163], 0
v_accvgpr_write_b32 a236, v68
v_accvgpr_write_b32 a237, v69
v_accvgpr_write_b32 a238, v72
v_mfma_f32_16x16x32_bf16 v[244:247], v[228:231], v[164:167], 0
ds_read_b64_tr_b16 v[114:115], v14 offset:56320
v_accvgpr_write_b32 a239, v73
v_mfma_f32_16x16x32_bf16 v[136:139], v[120:123], a[224:227], v[136:139]
ds_read_b64_tr_b16 v[116:117], v15 offset:39936
v_mfma_f32_16x16x32_bf16 v[152:155], v[120:123], a[228:231], v[152:155]
ds_read_b64_tr_b16 v[118:119], v15 offset:56320
v_cvt_pk_bf16_f32 v240, v240, v241
v_cvt_pk_bf16_f32 v241, v242, v243
v_mfma_f32_16x16x32_bf16 v[140:143], v[124:127], a[224:227], v[140:143]
ds_read_b64_tr_b16 v[120:121], v16 offset:39936
v_cvt_pk_bf16_f32 v244, v244, v245
v_cvt_pk_bf16_f32 v245, v246, v247
v_mfma_f32_16x16x32_bf16 v[156:159], v[124:127], a[228:231], v[156:159]
v_accvgpr_write_b32 a240, v240
v_accvgpr_write_b32 a241, v241
v_accvgpr_write_b32 a242, v244
v_mfma_f32_16x16x32_bf16 v[248:251], v[224:227], v[192:195], 0
v_accvgpr_write_b32 a243, v245
v_mfma_f32_16x16x32_bf16 v[252:255], v[228:231], v[196:199], 0
ds_read_b64_tr_b16 v[122:123], v16 offset:56320
v_mfma_f32_16x16x32_bf16 v[128:131], v[80:83], a[232:235], v[128:131]
ds_read_b64_tr_b16 v[124:125], v17 offset:39936
v_mfma_f32_16x16x32_bf16 v[144:147], v[80:83], a[236:239], v[144:147]
buffer_load_dwordx4 v32, s[44:47], s77 offen offset:2048 lds
ds_read_b64_tr_b16 v[126:127], v17 offset:56320
v_mfma_f32_16x16x32_bf16 v[132:135], v[84:87], a[232:235], v[132:135]
v_cvt_pk_bf16_f32 v248, v248, v249
v_cvt_pk_bf16_f32 v249, v250, v251
v_cvt_pk_bf16_f32 v252, v252, v253
v_mfma_f32_16x16x32_bf16 v[148:151], v[84:87], a[236:239], v[148:151]
v_cvt_pk_bf16_f32 v253, v254, v255
v_accvgpr_write_b32 a244, v248
s_waitcnt lgkmcnt(3)
v_mfma_f32_16x16x32_bf16 v[68:71], v[232:235], v[166:169], 0
v_accvgpr_write_b32 a245, v249
v_accvgpr_write_b32 a246, v252
v_accvgpr_write_b32 a247, v253
v_mfma_f32_16x16x32_bf16 v[72:75], v[236:239], v[170:173], 0
v_mfma_f32_16x16x32_bf16 v[136:139], v[88:91], a[232:235], v[136:139]
s_waitcnt lgkmcnt(0)
s_barrier
ds_read_b64_tr_b16 v[80:81], v18 offset:0
v_mfma_f32_16x16x32_bf16 v[152:155], v[88:91], a[236:239], v[152:155]
buffer_load_dwordx4 v33, s[44:47], s77 offen offset:3072 lds
ds_read_b64_tr_b16 v[82:83], v18 offset:8192
v_mfma_f32_16x16x32_bf16 v[140:143], v[92:95], a[232:235], v[140:143]
ds_read_b64_tr_b16 v[84:85], v19 offset:0
v_cvt_pk_bf16_f32 v68, v68, v69
v_cvt_pk_bf16_f32 v69, v70, v71
v_mfma_f32_16x16x32_bf16 v[156:159], v[92:95], a[236:239], v[156:159]
ds_read_b64_tr_b16 v[86:87], v19 offset:8192
v_cvt_pk_bf16_f32 v72, v72, v73
v_cvt_pk_bf16_f32 v73, v74, v75
v_mfma_f32_16x16x32_bf16 v[240:243], v[232:235], v[198:201], 0
ds_read_b64_tr_b16 v[88:89], v18 offset:16384
v_accvgpr_write_b32 a248, v68
v_accvgpr_write_b32 a249, v69
v_mfma_f32_16x16x32_bf16 v[244:247], v[236:239], v[202:205], 0
ds_read_b64_tr_b16 v[90:91], v18 offset:24576
v_accvgpr_write_b32 a250, v72
v_accvgpr_write_b32 a251, v73
S_G0b:
v_mfma_f32_16x16x32_bf16 v[128:131], v[96:99], a[240:243], v[128:131]
ds_read_b64_tr_b16 v[92:93], v19 offset:16384
s_add_u32 m0, s76, 69632
v_mfma_f32_16x16x32_bf16 v[144:147], v[96:99], a[244:247], v[144:147]
ds_read_b64_tr_b16 v[94:95], v19 offset:24576
s_add_u32 s77, s82, 0x2a0000
v_mfma_f32_16x16x32_bf16 v[132:135], v[100:103], a[240:243], v[132:135]
buffer_load_dwordx4 v30, s[44:47], s77 offen offset:0 lds
v_mfma_f32_16x16x32_bf16 v[148:151], v[100:103], a[244:247], v[148:151]
ds_read_b64_tr_b16 v[96:97], v18 offset:1024
v_cvt_pk_bf16_f32 v240, v240, v241
v_mfma_f32_16x16x32_bf16 v[136:139], v[104:107], a[240:243], v[136:139]
ds_read_b64_tr_b16 v[98:99], v18 offset:9216
v_cvt_pk_bf16_f32 v241, v242, v243
v_mfma_f32_16x16x32_bf16 v[152:155], v[104:107], a[244:247], v[152:155]
ds_read_b64_tr_b16 v[100:101], v19 offset:1024
v_cvt_pk_bf16_f32 v244, v244, v245
v_mfma_f32_16x16x32_bf16 v[140:143], v[108:111], a[240:243], v[140:143]
buffer_load_dwordx4 v31, s[44:47], s77 offen offset:1024 lds
v_mfma_f32_16x16x32_bf16 v[156:159], v[108:111], a[244:247], v[156:159]
ds_read_b64_tr_b16 v[102:103], v19 offset:9216
v_cvt_pk_bf16_f32 v245, v246, v247
v_accvgpr_write_b32 a252, v240
v_accvgpr_write_b32 a253, v241
v_accvgpr_write_b32 a254, v244
v_accvgpr_write_b32 a255, v245
v_mfma_f32_16x16x32_bf16 v[128:131], v[112:115], a[248:251], v[128:131]
ds_read_b64_tr_b16 v[104:105], v18 offset:17408
ds_read_b64_tr_b16 v[106:107], v18 offset:25600
v_mfma_f32_16x16x32_bf16 v[144:147], v[112:115], a[252:255], v[144:147]
ds_read_b64_tr_b16 v[108:109], v19 offset:17408
v_mfma_f32_16x16x32_bf16 v[132:135], v[116:119], a[248:251], v[132:135]
buffer_load_dwordx4 v32, s[44:47], s77 offen offset:2048 lds
v_mfma_f32_16x16x32_bf16 v[148:151], v[116:119], a[252:255], v[148:151]
ds_read_b64_tr_b16 v[110:111], v19 offset:25600
ds_read_b64_tr_b16 v[112:113], v18 offset:2048
v_mfma_f32_16x16x32_bf16 v[136:139], v[120:123], a[248:251], v[136:139]
ds_read_b64_tr_b16 v[114:115], v18 offset:10240
v_mfma_f32_16x16x32_bf16 v[152:155], v[120:123], a[252:255], v[152:155]
ds_read_b64_tr_b16 v[116:117], v19 offset:2048
ds_read_b64_tr_b16 v[118:119], v19 offset:10240
v_mfma_f32_16x16x32_bf16 v[140:143], v[124:127], a[248:251], v[140:143]
buffer_load_dwordx4 v33, s[44:47], s77 offen offset:3072 lds
v_mfma_f32_16x16x32_bf16 v[156:159], v[124:127], a[252:255], v[156:159]
ds_read_b64_tr_b16 v[120:121], v18 offset:18432
ds_read_b64_tr_b16 v[122:123], v18 offset:26624
S_H0:
s_waitcnt lgkmcnt(7)
v_mfma_f32_16x16x32_bf16 v[224:227], v[80:83], a[0:3], 0
ds_read_b64_tr_b16 v[124:125], v19 offset:18432
v_mfma_f32_16x16x32_bf16 v[240:243], v[80:83], a[4:7], 0
ds_read_b64_tr_b16 v[126:127], v19 offset:26624
s_add_u32 m0, s76, 98304
v_mfma_f32_16x16x32_bf16 v[228:231], v[84:87], a[0:3], 0
ds_read_b64_tr_b16 v[80:81], v18 offset:3072
s_add_u32 s77, s82, 0x380000
v_mfma_f32_16x16x32_bf16 v[244:247], v[84:87], a[4:7], 0
s_add_u32 s70, s0, S_H1 - K_pc + 0
s_addc_u32 s71, s1, 0
global_load_dword v57, v9, s[70:71]
v_mfma_f32_16x16x32_bf16 v[232:235], v[88:91], a[0:3], 0
ds_read_b64_tr_b16 v[82:83], v18 offset:11264
v_mul_f32 v68, v60, v128
v_mfma_f32_16x16x32_bf16 v[248:251], v[88:91], a[4:7], 0
buffer_load_dwordx4 v30, s[44:47], s77 offen offset:0 lds
v_mfma_f32_16x16x32_bf16 v[236:239], v[92:95], a[0:3], 0
ds_read_b64_tr_b16 v[84:85], v19 offset:3072
v_mul_f32 v69, v60, v129
v_mfma_f32_16x16x32_bf16 v[252:255], v[92:95], a[4:7], 0
ds_read_b64_tr_b16 v[86:87], v19 offset:11264
s_mul_i32 s3, s101, 7168
v_mfma_f32_16x16x32_bf16 v[224:227], v[96:99], a[8:11], v[224:227]
ds_read_b64_tr_b16 v[88:89], v18 offset:19456
s_add_u32 s3, s3, 0x800
v_mfma_f32_16x16x32_bf16 v[240:243], v[96:99], a[12:15], v[240:243]
ds_read_b64_tr_b16 v[90:91], v18 offset:27648
v_mul_f32 v70, v60, v130
v_mfma_f32_16x16x32_bf16 v[228:231], v[100:103], a[8:11], v[228:231]
ds_read_b64_tr_b16 v[92:93], v19 offset:19456
v_mul_f32 v71, v60, v131
v_mfma_f32_16x16x32_bf16 v[244:247], v[100:103], a[12:15], v[244:247]
buffer_load_dwordx4 v31, s[44:47], s77 offen offset:1024 lds
v_mfma_f32_16x16x32_bf16 v[232:235], v[104:107], a[8:11], v[232:235]
ds_read_b64_tr_b16 v[94:95], v19 offset:27648
ds_read_b64_tr_b16 v[96:97], v18 offset:4096
v_mfma_f32_16x16x32_bf16 v[248:251], v[104:107], a[12:15], v[248:251]
ds_read_b64_tr_b16 v[98:99], v18 offset:12288
s_waitcnt lgkmcnt(6)
v_mfma_f32_16x16x32_bf16 v[236:239], v[108:111], a[8:11], v[236:239]
v_exp_f32 v68, v68
v_mfma_f32_16x16x32_bf16 v[252:255], v[108:111], a[12:15], v[252:255]
ds_read_b64_tr_b16 v[100:101], v19 offset:4096
ds_read_b64_tr_b16 v[102:103], v19 offset:12288
v_mfma_f32_16x16x32_bf16 v[224:227], v[112:115], a[16:19], v[224:227]
v_exp_f32 v69, v69
v_mfma_f32_16x16x32_bf16 v[240:243], v[112:115], a[20:23], v[240:243]
ds_read_b64_tr_b16 v[104:105], v18 offset:20480
ds_read_b64_tr_b16 v[106:107], v18 offset:28672
v_mfma_f32_16x16x32_bf16 v[228:231], v[116:119], a[16:19], v[228:231]
buffer_load_dwordx4 v32, s[44:47], s77 offen offset:2048 lds
v_mfma_f32_16x16x32_bf16 v[244:247], v[116:119], a[20:23], v[244:247]
ds_read_b64_tr_b16 v[108:109], v19 offset:20480
ds_read_b64_tr_b16 v[110:111], v19 offset:28672
v_mfma_f32_16x16x32_bf16 v[232:235], v[120:123], a[16:19], v[232:235]
v_exp_f32 v70, v70
v_mfma_f32_16x16x32_bf16 v[248:251], v[120:123], a[20:23], v[248:251]
ds_read_b64_tr_b16 v[112:113], v18 offset:5120
ds_read_b64_tr_b16 v[114:115], v18 offset:13312
v_mfma_f32_16x16x32_bf16 v[236:239], v[124:127], a[16:19], v[236:239]
v_exp_f32 v71, v71
v_mfma_f32_16x16x32_bf16 v[252:255], v[124:127], a[20:23], v[252:255]
ds_read_b64_tr_b16 v[116:117], v19 offset:5120
ds_read_b64_tr_b16 v[118:119], v19 offset:13312
v_mfma_f32_16x16x32_bf16 v[224:227], v[80:83], a[24:27], v[224:227]
buffer_load_dwordx4 v33, s[44:47], s77 offen offset:3072 lds
v_mfma_f32_16x16x32_bf16 v[240:243], v[80:83], a[28:31], v[240:243]
ds_read_b64_tr_b16 v[120:121], v18 offset:21504
ds_read_b64_tr_b16 v[122:123], v18 offset:29696
v_mfma_f32_16x16x32_bf16 v[228:231], v[84:87], a[24:27], v[228:231]
ds_read_b64_tr_b16 v[124:125], v19 offset:21504
v_fma_f32 v68, v68, v62, v62
v_mfma_f32_16x16x32_bf16 v[244:247], v[84:87], a[28:31], v[244:247]
ds_read_b64_tr_b16 v[126:127], v19 offset:29696
s_waitcnt lgkmcnt(6)
v_mfma_f32_16x16x32_bf16 v[232:235], v[88:91], a[24:27], v[232:235]
ds_read_b64_tr_b16 v[80:81], v18 offset:6144
s_add_u32 m0, s76, 102400
v_mfma_f32_16x16x32_bf16 v[248:251], v[88:91], a[28:31], v[248:251]
ds_read_b64_tr_b16 v[82:83], v18 offset:14336
s_add_u32 s77, s82, 0x460000
v_mfma_f32_16x16x32_bf16 v[236:239], v[92:95], a[24:27], v[236:239]
buffer_load_dwordx4 v30, s[44:47], s77 offen offset:0 lds
v_mfma_f32_16x16x32_bf16 v[252:255], v[92:95], a[28:31], v[252:255]
ds_read_b64_tr_b16 v[84:85], v19 offset:6144
ds_read_b64_tr_b16 v[86:87], v19 offset:14336
v_mfma_f32_16x16x32_bf16 v[224:227], v[96:99], a[32:35], v[224:227]
ds_read_b64_tr_b16 v[88:89], v18 offset:22528
v_fma_f32 v69, v69, v62, v62
v_mfma_f32_16x16x32_bf16 v[240:243], v[96:99], a[36:39], v[240:243]
ds_read_b64_tr_b16 v[90:91], v18 offset:30720
v_fma_f32 v70, v70, v62, v62
v_mfma_f32_16x16x32_bf16 v[228:231], v[100:103], a[32:35], v[228:231]
ds_read_b64_tr_b16 v[92:93], v19 offset:22528
v_fma_f32 v71, v71, v62, v62
v_mfma_f32_16x16x32_bf16 v[244:247], v[100:103], a[36:39], v[244:247]
v_rcp_f32 v68, v68
v_mfma_f32_16x16x32_bf16 v[232:235], v[104:107], a[32:35], v[232:235]
ds_read_b64_tr_b16 v[94:95], v19 offset:30720
ds_read_b64_tr_b16 v[96:97], v18 offset:7168
v_mfma_f32_16x16x32_bf16 v[248:251], v[104:107], a[36:39], v[248:251]
buffer_load_dwordx4 v31, s[44:47], s77 offen offset:1024 lds
v_mfma_f32_16x16x32_bf16 v[236:239], v[108:111], a[32:35], v[236:239]
ds_read_b64_tr_b16 v[98:99], v18 offset:15360
ds_read_b64_tr_b16 v[100:101], v19 offset:7168
v_mfma_f32_16x16x32_bf16 v[252:255], v[108:111], a[36:39], v[252:255]
v_rcp_f32 v69, v69
v_mfma_f32_16x16x32_bf16 v[224:227], v[112:115], a[40:43], v[224:227]
ds_read_b64_tr_b16 v[102:103], v19 offset:15360
ds_read_b64_tr_b16 v[104:105], v18 offset:23552
v_mfma_f32_16x16x32_bf16 v[240:243], v[112:115], a[44:47], v[240:243]
ds_read_b64_tr_b16 v[106:107], v18 offset:31744
s_waitcnt lgkmcnt(7)
v_mfma_f32_16x16x32_bf16 v[228:231], v[116:119], a[40:43], v[228:231]
v_rcp_f32 v70, v70
v_mfma_f32_16x16x32_bf16 v[244:247], v[116:119], a[44:47], v[244:247]
ds_read_b64_tr_b16 v[108:109], v19 offset:23552
ds_read_b64_tr_b16 v[110:111], v19 offset:31744
v_mfma_f32_16x16x32_bf16 v[232:235], v[120:123], a[40:43], v[232:235]
buffer_load_dwordx4 v32, s[44:47], s77 offen offset:2048 lds
v_mfma_f32_16x16x32_bf16 v[248:251], v[120:123], a[44:47], v[248:251]
v_rcp_f32 v71, v71
v_mfma_f32_16x16x32_bf16 v[236:239], v[124:127], a[40:43], v[236:239]
v_mul_f32 v128, v128, v68
v_mul_f32 v129, v129, v69
v_mfma_f32_16x16x32_bf16 v[252:255], v[124:127], a[44:47], v[252:255]
v_mul_f32 v130, v130, v70
v_mul_f32 v131, v131, v71
v_mfma_f32_16x16x32_bf16 v[224:227], v[80:83], a[48:51], v[224:227]
s_waitcnt vmcnt(16) lgkmcnt(0)
s_barrier
v_mfma_f32_16x16x32_bf16 v[240:243], v[80:83], a[52:55], v[240:243]
ds_read_b64_tr_b16 v[112:113], v10 offset:32768
ds_read_b64_tr_b16 v[114:115], v10 offset:49152
v_mfma_f32_16x16x32_bf16 v[228:231], v[84:87], a[48:51], v[228:231]
ds_read_b64_tr_b16 v[116:117], v11 offset:32768
v_mul_f32 v72, v60, v132
v_mfma_f32_16x16x32_bf16 v[244:247], v[84:87], a[52:55], v[244:247]
ds_read_b64_tr_b16 v[118:119], v11 offset:49152
ds_read_b64_tr_b16 v[120:121], v12 offset:32768
v_mfma_f32_16x16x32_bf16 v[232:235], v[88:91], a[48:51], v[232:235]
buffer_load_dwordx4 v33, s[44:47], s77 offen offset:3072 lds
v_mfma_f32_16x16x32_bf16 v[248:251], v[88:91], a[52:55], v[248:251]
ds_read_b64_tr_b16 v[122:123], v12 offset:49152
ds_read_b64_tr_b16 v[124:125], v13 offset:32768
v_mfma_f32_16x16x32_bf16 v[236:239], v[92:95], a[48:51], v[236:239]
ds_read_b64_tr_b16 v[126:127], v13 offset:49152
v_mul_f32 v73, v60, v133
v_mfma_f32_16x16x32_bf16 v[252:255], v[92:95], a[52:55], v[252:255]
ds_read_b64_tr_b16 v[80:81], v10 offset:33792
s_add_u32 m0, s76, 0
v_mfma_f32_16x16x32_bf16 v[224:227], v[96:99], a[56:59], v[224:227]
ds_read_b64_tr_b16 v[82:83], v10 offset:50176
s_add_u32 s77, s82, 0x540000
v_mfma_f32_16x16x32_bf16 v[240:243], v[96:99], a[60:63], v[240:243]
ds_read_b64_tr_b16 v[84:85], v11 offset:33792
ds_read_b64_tr_b16 v[86:87], v11 offset:50176
v_mfma_f32_16x16x32_bf16 v[228:231], v[100:103], a[56:59], v[228:231]
buffer_load_dwordx4 v30, s[44:47], s77 offen offset:0 lds
v_mfma_f32_16x16x32_bf16 v[244:247], v[100:103], a[60:63], v[244:247]
ds_read_b64_tr_b16 v[88:89], v12 offset:33792
ds_read_b64_tr_b16 v[90:91], v12 offset:50176
v_mfma_f32_16x16x32_bf16 v[232:235], v[104:107], a[56:59], v[232:235]
ds_read_b64_tr_b16 v[92:93], v13 offset:33792
v_mul_f32 v74, v60, v134
v_mfma_f32_16x16x32_bf16 v[248:251], v[104:107], a[60:63], v[248:251]
ds_read_b64_tr_b16 v[94:95], v13 offset:50176
ds_read_b64_tr_b16 v[96:97], v10 offset:34816
v_mfma_f32_16x16x32_bf16 v[236:239], v[108:111], a[56:59], v[236:239]
ds_read_b64_tr_b16 v[98:99], v10 offset:51200
v_mul_f32 v75, v60, v135
v_mfma_f32_16x16x32_bf16 v[252:255], v[108:111], a[60:63], v[252:255]
ds_read_b64_tr_b16 v[100:101], v11 offset:34816
s_waitcnt lgkmcnt(7)
v_mfma_f32_16x16x32_bf16 v[192:195], v[112:115], a[0:3], 0
buffer_load_dwordx4 v31, s[44:47], s77 offen offset:1024 lds
v_mfma_f32_16x16x32_bf16 v[208:211], v[112:115], a[4:7], 0
ds_read_b64_tr_b16 v[102:103], v11 offset:51200
ds_read_b64_tr_b16 v[104:105], v12 offset:34816
v_mfma_f32_16x16x32_bf16 v[196:199], v[116:119], a[0:3], 0
v_exp_f32 v72, v72
v_mfma_f32_16x16x32_bf16 v[212:215], v[116:119], a[4:7], 0
ds_read_b64_tr_b16 v[106:107], v12 offset:51200
ds_read_b64_tr_b16 v[108:109], v13 offset:34816
v_mfma_f32_16x16x32_bf16 v[200:203], v[120:123], a[0:3], 0
v_exp_f32 v73, v73
v_mfma_f32_16x16x32_bf16 v[216:219], v[120:123], a[4:7], 0
ds_read_b64_tr_b16 v[110:111], v13 offset:51200
ds_read_b64_tr_b16 v[112:113], v10 offset:35840
v_mfma_f32_16x16x32_bf16 v[204:207], v[124:127], a[0:3], 0
buffer_load_dwordx4 v32, s[44:47], s77 offen offset:2048 lds
v_mfma_f32_16x16x32_bf16 v[220:223], v[124:127], a[4:7], 0
ds_read_b64_tr_b16 v[114:115], v10 offset:52224
ds_read_b64_tr_b16 v[116:117], v11 offset:35840
v_mfma_f32_16x16x32_bf16 v[192:195], v[80:83], a[8:11], v[192:195]
v_exp_f32 v74, v74
v_mfma_f32_16x16x32_bf16 v[208:211], v[80:83], a[12:15], v[208:211]
ds_read_b64_tr_b16 v[118:119], v11 offset:52224
ds_read_b64_tr_b16 v[120:121], v12 offset:35840
v_mfma_f32_16x16x32_bf16 v[196:199], v[84:87], a[8:11], v[196:199]
v_exp_f32 v75, v75
v_mfma_f32_16x16x32_bf16 v[212:215], v[84:87], a[12:15], v[212:215]
ds_read_b64_tr_b16 v[122:123], v12 offset:52224
s_waitcnt lgkmcnt(5)
v_mfma_f32_16x16x32_bf16 v[200:203], v[88:91], a[8:11], v[200:203]
buffer_load_dwordx4 v33, s[44:47], s77 offen offset:3072 lds
v_mfma_f32_16x16x32_bf16 v[216:219], v[88:91], a[12:15], v[216:219]
ds_read_b64_tr_b16 v[124:125], v13 offset:35840
ds_read_b64_tr_b16 v[126:127], v13 offset:52224
v_mfma_f32_16x16x32_bf16 v[204:207], v[92:95], a[8:11], v[204:207]
ds_read_b64_tr_b16 v[80:81], v10 offset:36864
v_fma_f32 v72, v72, v62, v62
v_mfma_f32_16x16x32_bf16 v[220:223], v[92:95], a[12:15], v[220:223]
ds_read_b64_tr_b16 v[82:83], v10 offset:53248
s_add_u32 m0, s76, 4096
v_mfma_f32_16x16x32_bf16 v[192:195], v[96:99], a[16:19], v[192:195]
ds_read_b64_tr_b16 v[84:85], v11 offset:36864
s_add_u32 s77, s82, 0x620000
v_mfma_f32_16x16x32_bf16 v[208:211], v[96:99], a[20:23], v[208:211]
ds_read_b64_tr_b16 v[86:87], v11 offset:53248
ds_read_b64_tr_b16 v[88:89], v12 offset:36864
v_mfma_f32_16x16x32_bf16 v[196:199], v[100:103], a[16:19], v[196:199]
buffer_load_dwordx4 v30, s[44:47], s77 offen offset:0 lds
v_mfma_f32_16x16x32_bf16 v[212:215], v[100:103], a[20:23], v[212:215]
ds_read_b64_tr_b16 v[90:91], v12 offset:53248
ds_read_b64_tr_b16 v[92:93], v13 offset:36864
v_mfma_f32_16x16x32_bf16 v[200:203], v[104:107], a[16:19], v[200:203]
ds_read_b64_tr_b16 v[94:95], v13 offset:53248
v_fma_f32 v73, v73, v62, v62
v_mfma_f32_16x16x32_bf16 v[216:219], v[104:107], a[20:23], v[216:219]
ds_read_b64_tr_b16 v[96:97], v10 offset:37888
ds_read_b64_tr_b16 v[98:99], v10 offset:54272
v_mfma_f32_16x16x32_bf16 v[204:207], v[108:111], a[16:19], v[204:207]
ds_read_b64_tr_b16 v[100:101], v11 offset:37888
v_fma_f32 v74, v74, v62, v62
v_mfma_f32_16x16x32_bf16 v[220:223], v[108:111], a[20:23], v[220:223]
ds_read_b64_tr_b16 v[102:103], v11 offset:54272
s_waitcnt lgkmcnt(7)
v_mfma_f32_16x16x32_bf16 v[192:195], v[112:115], a[24:27], v[192:195]
buffer_load_dwordx4 v31, s[44:47], s77 offen offset:1024 lds
v_mfma_f32_16x16x32_bf16 v[208:211], v[112:115], a[28:31], v[208:211]
ds_read_b64_tr_b16 v[104:105], v12 offset:37888
ds_read_b64_tr_b16 v[106:107], v12 offset:54272
v_mfma_f32_16x16x32_bf16 v[196:199], v[116:119], a[24:27], v[196:199]
ds_read_b64_tr_b16 v[108:109], v13 offset:37888
v_fma_f32 v75, v75, v62, v62
v_mfma_f32_16x16x32_bf16 v[212:215], v[116:119], a[28:31], v[212:215]
v_rcp_f32 v72, v72
v_mfma_f32_16x16x32_bf16 v[200:203], v[120:123], a[24:27], v[200:203]
ds_read_b64_tr_b16 v[110:111], v13 offset:54272
ds_read_b64_tr_b16 v[112:113], v10 offset:38912
v_mfma_f32_16x16x32_bf16 v[216:219], v[120:123], a[28:31], v[216:219]
v_rcp_f32 v73, v73
v_mfma_f32_16x16x32_bf16 v[204:207], v[124:127], a[24:27], v[204:207]
ds_read_b64_tr_b16 v[114:115], v10 offset:55296
ds_read_b64_tr_b16 v[116:117], v11 offset:38912
v_mfma_f32_16x16x32_bf16 v[220:223], v[124:127], a[28:31], v[220:223]
buffer_load_dwordx4 v32, s[44:47], s77 offen offset:2048 lds
v_mfma_f32_16x16x32_bf16 v[192:195], v[80:83], a[32:35], v[192:195]
ds_read_b64_tr_b16 v[118:119], v11 offset:55296
ds_read_b64_tr_b16 v[120:121], v12 offset:38912
v_mfma_f32_16x16x32_bf16 v[208:211], v[80:83], a[36:39], v[208:211]
v_rcp_f32 v74, v74
v_mfma_f32_16x16x32_bf16 v[196:199], v[84:87], a[32:35], v[196:199]
ds_read_b64_tr_b16 v[122:123], v12 offset:55296
ds_read_b64_tr_b16 v[124:125], v13 offset:38912
v_mfma_f32_16x16x32_bf16 v[212:215], v[84:87], a[36:39], v[212:215]
ds_read_b64_tr_b16 v[126:127], v13 offset:55296
s_waitcnt lgkmcnt(7)
v_mfma_f32_16x16x32_bf16 v[200:203], v[88:91], a[32:35], v[200:203]
v_rcp_f32 v75, v75
v_mfma_f32_16x16x32_bf16 v[216:219], v[88:91], a[36:39], v[216:219]
ds_read_b64_tr_b16 v[80:81], v10 offset:39936
ds_read_b64_tr_b16 v[82:83], v10 offset:56320
v_mfma_f32_16x16x32_bf16 v[204:207], v[92:95], a[32:35], v[204:207]
buffer_load_dwordx4 v33, s[44:47], s77 offen offset:3072 lds
v_mfma_f32_16x16x32_bf16 v[220:223], v[92:95], a[36:39], v[220:223]
ds_read_b64_tr_b16 v[84:85], v11 offset:39936
ds_read_b64_tr_b16 v[86:87], v11 offset:56320
v_mfma_f32_16x16x32_bf16 v[192:195], v[96:99], a[40:43], v[192:195]
buffer_load_dword v57, v8, s[44:47], s3 offen
v_mfma_f32_16x16x32_bf16 v[208:211], v[96:99], a[44:47], v[208:211]
ds_read_b64_tr_b16 v[88:89], v12 offset:39936
ds_read_b64_tr_b16 v[90:91], v12 offset:56320
v_mfma_f32_16x16x32_bf16 v[196:199], v[100:103], a[40:43], v[196:199]
ds_read_b64_tr_b16 v[92:93], v13 offset:39936
s_mul_i32 s3, s101, 1024
v_mfma_f32_16x16x32_bf16 v[212:215], v[100:103], a[44:47], v[212:215]
ds_read_b64_tr_b16 v[94:95], v13 offset:56320
s_add_u32 s3, s3, 0x100000
v_mfma_f32_16x16x32_bf16 v[200:203], v[104:107], a[40:43], v[200:203]
buffer_load_dword v57, v50, s[48:51], s3 offen
v_mfma_f32_16x16x32_bf16 v[216:219], v[104:107], a[44:47], v[216:219]
s_mul_i32 s3, s101, 1024
s_add_u32 s3, s3, 0x200000
v_mfma_f32_16x16x32_bf16 v[204:207], v[108:111], a[40:43], v[204:207]
buffer_load_dword v57, v50, s[48:51], s3 offen
v_mfma_f32_16x16x32_bf16 v[220:223], v[108:111], a[44:47], v[220:223]
v_mul_f32 v132, v132, v72
s_waitcnt lgkmcnt(2)
v_mfma_f32_16x16x32_bf16 v[192:195], v[112:115], a[48:51], v[192:195]
s_waitcnt vmcnt(20) lgkmcnt(0)
s_barrier
v_mfma_f32_16x16x32_bf16 v[208:211], v[112:115], a[52:55], v[208:211]
ds_read_b64_tr_b16 v[96:97], v14 offset:0
ds_read_b64_tr_b16 v[98:99], v14 offset:16384
v_mfma_f32_16x16x32_bf16 v[196:199], v[116:119], a[48:51], v[196:199]
ds_read_b64_tr_b16 v[100:101], v15 offset:0
s_add_u32 m0, s76, 32768
v_mfma_f32_16x16x32_bf16 v[212:215], v[116:119], a[52:55], v[212:215]
ds_read_b64_tr_b16 v[102:103], v15 offset:16384
s_add_u32 s77, s85, 0x1c0000
v_mfma_f32_16x16x32_bf16 v[200:203], v[120:123], a[48:51], v[200:203]
ds_read_b64_tr_b16 v[104:105], v16 offset:0
ds_read_b64_tr_b16 v[106:107], v16 offset:16384
v_mfma_f32_16x16x32_bf16 v[216:219], v[120:123], a[52:55], v[216:219]
buffer_load_dwordx4 v34, s[52:55], s77 offen offset:0 lds
v_mfma_f32_16x16x32_bf16 v[204:207], v[124:127], a[48:51], v[204:207]
ds_read_b64_tr_b16 v[108:109], v17 offset:0
ds_read_b64_tr_b16 v[110:111], v17 offset:16384
v_mfma_f32_16x16x32_bf16 v[220:223], v[124:127], a[52:55], v[220:223]
ds_read_b64_tr_b16 v[112:113], v14 offset:1024
v_mul_f32 v133, v133, v73
v_mfma_f32_16x16x32_bf16 v[192:195], v[80:83], a[56:59], v[192:195]
ds_read_b64_tr_b16 v[114:115], v14 offset:17408
ds_read_b64_tr_b16 v[116:117], v15 offset:1024
v_mfma_f32_16x16x32_bf16 v[208:211], v[80:83], a[60:63], v[208:211]
ds_read_b64_tr_b16 v[118:119], v15 offset:17408
v_mul_f32 v134, v134, v74
v_mfma_f32_16x16x32_bf16 v[196:199], v[84:87], a[56:59], v[196:199]
ds_read_b64_tr_b16 v[120:121], v16 offset:1024
ds_read_b64_tr_b16 v[122:123], v16 offset:17408
v_mfma_f32_16x16x32_bf16 v[212:215], v[84:87], a[60:63], v[212:215]
buffer_load_dwordx4 v35, s[52:55], s77 offen offset:1024 lds
v_mfma_f32_16x16x32_bf16 v[200:203], v[88:91], a[56:59], v[200:203]
ds_read_b64_tr_b16 v[124:125], v17 offset:1024
ds_read_b64_tr_b16 v[126:127], v17 offset:17408
v_mfma_f32_16x16x32_bf16 v[216:219], v[88:91], a[60:63], v[216:219]
ds_read_b64_tr_b16 v[80:81], v14 offset:2048
v_mul_f32 v135, v135, v75
v_mfma_f32_16x16x32_bf16 v[204:207], v[92:95], a[56:59], v[204:207]
ds_read_b64_tr_b16 v[82:83], v14 offset:18432
ds_read_b64_tr_b16 v[84:85], v15 offset:2048
v_mfma_f32_16x16x32_bf16 v[220:223], v[92:95], a[60:63], v[220:223]
ds_read_b64_tr_b16 v[86:87], v15 offset:18432
s_waitcnt lgkmcnt(8)
v_mfma_f32_16x16x32_bf16 v[192:195], v[96:99], a[64:67], v[192:195]
ds_read_b64_tr_b16 v[88:89], v16 offset:2048
v_mul_f32 v68, v60, v136
v_mfma_f32_16x16x32_bf16 v[208:211], v[96:99], a[68:71], v[208:211]
buffer_load_dwordx4 v36, s[52:55], s77 offen offset:2048 lds
v_mfma_f32_16x16x32_bf16 v[196:199], v[100:103], a[64:67], v[196:199]
ds_read_b64_tr_b16 v[90:91], v16 offset:18432
ds_read_b64_tr_b16 v[92:93], v17 offset:2048
v_mfma_f32_16x16x32_bf16 v[212:215], v[100:103], a[68:71], v[212:215]
ds_read_b64_tr_b16 v[94:95], v17 offset:18432
v_mul_f32 v69, v60, v137
v_mfma_f32_16x16x32_bf16 v[200:203], v[104:107], a[64:67], v[200:203]
ds_read_b64_tr_b16 v[96:97], v14 offset:3072
v_mul_f32 v70, v60, v138
v_mfma_f32_16x16x32_bf16 v[216:219], v[104:107], a[68:71], v[216:219]
ds_read_b64_tr_b16 v[98:99], v14 offset:19456
v_mul_f32 v71, v60, v139
v_mfma_f32_16x16x32_bf16 v[204:207], v[108:111], a[64:67], v[204:207]
v_exp_f32 v68, v68
v_mfma_f32_16x16x32_bf16 v[220:223], v[108:111], a[68:71], v[220:223]
ds_read_b64_tr_b16 v[100:101], v15 offset:3072
ds_read_b64_tr_b16 v[102:103], v15 offset:19456
v_mfma_f32_16x16x32_bf16 v[192:195], v[112:115], a[72:75], v[192:195]
v_exp_f32 v69, v69
v_mfma_f32_16x16x32_bf16 v[208:211], v[112:115], a[76:79], v[208:211]
ds_read_b64_tr_b16 v[104:105], v16 offset:3072
ds_read_b64_tr_b16 v[106:107], v16 offset:19456
v_mfma_f32_16x16x32_bf16 v[196:199], v[116:119], a[72:75], v[196:199]
buffer_load_dwordx4 v37, s[52:55], s77 offen offset:3072 lds
v_mfma_f32_16x16x32_bf16 v[212:215], v[116:119], a[76:79], v[212:215]
ds_read_b64_tr_b16 v[108:109], v17 offset:3072
s_waitcnt lgkmcnt(5)
v_mfma_f32_16x16x32_bf16 v[200:203], v[120:123], a[72:75], v[200:203]
v_exp_f32 v70, v70
v_mfma_f32_16x16x32_bf16 v[216:219], v[120:123], a[76:79], v[216:219]
ds_read_b64_tr_b16 v[110:111], v17 offset:19456
ds_read_b64_tr_b16 v[112:113], v14 offset:4096
v_mfma_f32_16x16x32_bf16 v[204:207], v[124:127], a[72:75], v[204:207]
v_exp_f32 v71, v71
v_mfma_f32_16x16x32_bf16 v[220:223], v[124:127], a[76:79], v[220:223]
ds_read_b64_tr_b16 v[114:115], v14 offset:20480
ds_read_b64_tr_b16 v[116:117], v15 offset:4096
v_mfma_f32_16x16x32_bf16 v[192:195], v[80:83], a[80:83], v[192:195]
ds_read_b64_tr_b16 v[118:119], v15 offset:20480
s_add_u32 m0, s76, 36864
v_mfma_f32_16x16x32_bf16 v[208:211], v[80:83], a[84:87], v[208:211]
ds_read_b64_tr_b16 v[120:121], v16 offset:4096
s_add_u32 s77, s85, 0x2a0000
v_mfma_f32_16x16x32_bf16 v[196:199], v[84:87], a[80:83], v[196:199]
buffer_load_dwordx4 v34, s[52:55], s77 offen offset:0 lds
v_mfma_f32_16x16x32_bf16 v[212:215], v[84:87], a[84:87], v[212:215]
ds_read_b64_tr_b16 v[122:123], v16 offset:20480
ds_read_b64_tr_b16 v[124:125], v17 offset:4096
v_mfma_f32_16x16x32_bf16 v[200:203], v[88:91], a[80:83], v[200:203]
ds_read_b64_tr_b16 v[126:127], v17 offset:20480
v_fma_f32 v68, v68, v62, v62
v_mfma_f32_16x16x32_bf16 v[216:219], v[88:91], a[84:87], v[216:219]
ds_read_b64_tr_b16 v[80:81], v14 offset:5120
ds_read_b64_tr_b16 v[82:83], v14 offset:21504
v_mfma_f32_16x16x32_bf16 v[204:207], v[92:95], a[80:83], v[204:207]
ds_read_b64_tr_b16 v[84:85], v15 offset:5120
v_fma_f32 v69, v69, v62, v62
v_mfma_f32_16x16x32_bf16 v[220:223], v[92:95], a[84:87], v[220:223]
ds_read_b64_tr_b16 v[86:87], v15 offset:21504
v_fma_f32 v70, v70, v62, v62
v_mfma_f32_16x16x32_bf16 v[192:195], v[96:99], a[88:91], v[192:195]
ds_read_b64_tr_b16 v[88:89], v16 offset:5120
v_fma_f32 v71, v71, v62, v62
v_mfma_f32_16x16x32_bf16 v[208:211], v[96:99], a[92:95], v[208:211]
ds_read_b64_tr_b16 v[90:91], v16 offset:21504
s_waitcnt lgkmcnt(7)
v_mfma_f32_16x16x32_bf16 v[196:199], v[100:103], a[88:91], v[196:199]
v_rcp_f32 v68, v68
v_mfma_f32_16x16x32_bf16 v[212:215], v[100:103], a[92:95], v[212:215]
ds_read_b64_tr_b16 v[92:93], v17 offset:5120
ds_read_b64_tr_b16 v[94:95], v17 offset:21504
v_mfma_f32_16x16x32_bf16 v[200:203], v[104:107], a[88:91], v[200:203]
buffer_load_dwordx4 v35, s[52:55], s77 offen offset:1024 lds
v_mfma_f32_16x16x32_bf16 v[216:219], v[104:107], a[92:95], v[216:219]
ds_read_b64_tr_b16 v[96:97], v14 offset:6144
ds_read_b64_tr_b16 v[98:99], v14 offset:22528
v_mfma_f32_16x16x32_bf16 v[204:207], v[108:111], a[88:91], v[204:207]
v_rcp_f32 v69, v69
v_mfma_f32_16x16x32_bf16 v[220:223], v[108:111], a[92:95], v[220:223]
ds_read_b64_tr_b16 v[100:101], v15 offset:6144
ds_read_b64_tr_b16 v[102:103], v15 offset:22528
v_mfma_f32_16x16x32_bf16 v[192:195], v[112:115], a[96:99], v[192:195]
v_rcp_f32 v70, v70
v_mfma_f32_16x16x32_bf16 v[208:211], v[112:115], a[100:103], v[208:211]
ds_read_b64_tr_b16 v[104:105], v16 offset:6144
ds_read_b64_tr_b16 v[106:107], v16 offset:22528
v_mfma_f32_16x16x32_bf16 v[196:199], v[116:119], a[96:99], v[196:199]
v_rcp_f32 v71, v71
v_mfma_f32_16x16x32_bf16 v[212:215], v[116:119], a[100:103], v[212:215]
ds_read_b64_tr_b16 v[108:109], v17 offset:6144
ds_read_b64_tr_b16 v[110:111], v17 offset:22528
v_mfma_f32_16x16x32_bf16 v[200:203], v[120:123], a[96:99], v[200:203]
buffer_load_dwordx4 v36, s[52:55], s77 offen offset:2048 lds
v_mfma_f32_16x16x32_bf16 v[216:219], v[120:123], a[100:103], v[216:219]
ds_read_b64_tr_b16 v[112:113], v14 offset:7168
s_waitcnt lgkmcnt(5)
v_mfma_f32_16x16x32_bf16 v[204:207], v[124:127], a[96:99], v[204:207]
ds_read_b64_tr_b16 v[114:115], v14 offset:23552
ds_read_b64_tr_b16 v[116:117], v15 offset:7168
v_mfma_f32_16x16x32_bf16 v[220:223], v[124:127], a[100:103], v[220:223]
ds_read_b64_tr_b16 v[118:119], v15 offset:23552
v_mul_f32 v136, v136, v68
v_mfma_f32_16x16x32_bf16 v[192:195], v[80:83], a[104:107], v[192:195]
ds_read_b64_tr_b16 v[120:121], v16 offset:7168
v_mul_f32 v137, v137, v69
v_mfma_f32_16x16x32_bf16 v[208:211], v[80:83], a[108:111], v[208:211]
ds_read_b64_tr_b16 v[122:123], v16 offset:23552
v_mul_f32 v138, v138, v70
v_mfma_f32_16x16x32_bf16 v[196:199], v[84:87], a[104:107], v[196:199]
ds_read_b64_tr_b16 v[124:125], v17 offset:7168
v_mul_f32 v139, v139, v71
v_mfma_f32_16x16x32_bf16 v[212:215], v[84:87], a[108:111], v[212:215]
ds_read_b64_tr_b16 v[126:127], v17 offset:23552
v_mul_f32 v72, v60, v140
v_mfma_f32_16x16x32_bf16 v[200:203], v[88:91], a[104:107], v[200:203]
v_mul_f32 v73, v60, v141
v_mul_f32 v74, v60, v142
v_mfma_f32_16x16x32_bf16 v[216:219], v[88:91], a[108:111], v[216:219]
buffer_load_dwordx4 v37, s[52:55], s77 offen offset:3072 lds
v_mfma_f32_16x16x32_bf16 v[204:207], v[92:95], a[104:107], v[204:207]
v_mul_f32 v75, v60, v143
v_mfma_f32_16x16x32_bf16 v[220:223], v[92:95], a[108:111], v[220:223]
v_exp_f32 v72, v72
v_mfma_f32_16x16x32_bf16 v[192:195], v[96:99], a[112:115], v[192:195]
s_waitcnt vmcnt(19) lgkmcnt(0)
s_barrier
v_mfma_f32_16x16x32_bf16 v[208:211], v[96:99], a[116:119], v[208:211]
ds_read_b64_tr_b16 v[80:81], v14 offset:32768
ds_read_b64_tr_b16 v[82:83], v14 offset:49152
v_mfma_f32_16x16x32_bf16 v[196:199], v[100:103], a[112:115], v[196:199]
ds_read_b64_tr_b16 v[84:85], v15 offset:32768
v_mfma_f32_16x16x32_bf16 v[212:215], v[100:103], a[116:119], v[212:215]
ds_read_b64_tr_b16 v[86:87], v15 offset:49152
ds_read_b64_tr_b16 v[88:89], v16 offset:32768
v_mfma_f32_16x16x32_bf16 v[200:203], v[104:107], a[112:115], v[200:203]
v_exp_f32 v73, v73
v_mfma_f32_16x16x32_bf16 v[216:219], v[104:107], a[116:119], v[216:219]
ds_read_b64_tr_b16 v[90:91], v16 offset:49152
ds_read_b64_tr_b16 v[92:93], v17 offset:32768
v_mfma_f32_16x16x32_bf16 v[204:207], v[108:111], a[112:115], v[204:207]
v_exp_f32 v74, v74
v_mfma_f32_16x16x32_bf16 v[220:223], v[108:111], a[116:119], v[220:223]
ds_read_b64_tr_b16 v[94:95], v17 offset:49152
ds_read_b64_tr_b16 v[96:97], v14 offset:33792
v_mfma_f32_16x16x32_bf16 v[192:195], v[112:115], a[120:123], v[192:195]
v_exp_f32 v75, v75
v_mfma_f32_16x16x32_bf16 v[208:211], v[112:115], a[124:127], v[208:211]
ds_read_b64_tr_b16 v[98:99], v14 offset:50176
ds_read_b64_tr_b16 v[100:101], v15 offset:33792
v_mfma_f32_16x16x32_bf16 v[196:199], v[116:119], a[120:123], v[196:199]
ds_read_b64_tr_b16 v[102:103], v15 offset:50176
v_fma_f32 v72, v72, v62, v62
v_mfma_f32_16x16x32_bf16 v[212:215], v[116:119], a[124:127], v[212:215]
ds_read_b64_tr_b16 v[104:105], v16 offset:33792
ds_read_b64_tr_b16 v[106:107], v16 offset:50176
v_mfma_f32_16x16x32_bf16 v[200:203], v[120:123], a[120:123], v[200:203]
ds_read_b64_tr_b16 v[108:109], v17 offset:33792
v_fma_f32 v73, v73, v62, v62
v_mfma_f32_16x16x32_bf16 v[216:219], v[120:123], a[124:127], v[216:219]
ds_read_b64_tr_b16 v[110:111], v17 offset:50176
ds_read_b64_tr_b16 v[112:113], v14 offset:34816
v_mfma_f32_16x16x32_bf16 v[204:207], v[124:127], a[120:123], v[204:207]
ds_read_b64_tr_b16 v[114:115], v14 offset:51200
v_fma_f32 v74, v74, v62, v62
v_mfma_f32_16x16x32_bf16 v[220:223], v[124:127], a[124:127], v[220:223]
ds_read_b64_tr_b16 v[116:117], v15 offset:34816
s_waitcnt lgkmcnt(8)
v_mfma_f32_16x16x32_bf16 v[192:195], v[80:83], a[128:131], v[192:195]
ds_read_b64_tr_b16 v[118:119], v15 offset:51200
ds_read_b64_tr_b16 v[120:121], v16 offset:34816
v_mfma_f32_16x16x32_bf16 v[208:211], v[80:83], a[132:135], v[208:211]
ds_read_b64_tr_b16 v[122:123], v16 offset:51200
v_fma_f32 v75, v75, v62, v62
v_mfma_f32_16x16x32_bf16 v[196:199], v[84:87], a[128:131], v[196:199]
v_rcp_f32 v72, v72
v_mfma_f32_16x16x32_bf16 v[212:215], v[84:87], a[132:135], v[212:215]
ds_read_b64_tr_b16 v[124:125], v17 offset:34816
ds_read_b64_tr_b16 v[126:127], v17 offset:51200
v_mfma_f32_16x16x32_bf16 v[200:203], v[88:91], a[128:131], v[200:203]
v_rcp_f32 v73, v73
v_mfma_f32_16x16x32_bf16 v[216:219], v[88:91], a[132:135], v[216:219]
ds_read_b64_tr_b16 v[80:81], v14 offset:35840
ds_read_b64_tr_b16 v[82:83], v14 offset:52224
v_mfma_f32_16x16x32_bf16 v[204:207], v[92:95], a[128:131], v[204:207]
v_rcp_f32 v74, v74
v_mfma_f32_16x16x32_bf16 v[220:223], v[92:95], a[132:135], v[220:223]
ds_read_b64_tr_b16 v[84:85], v15 offset:35840
ds_read_b64_tr_b16 v[86:87], v15 offset:52224
v_mfma_f32_16x16x32_bf16 v[192:195], v[96:99], a[136:139], v[192:195]
v_rcp_f32 v75, v75
v_mfma_f32_16x16x32_bf16 v[208:211], v[96:99], a[140:143], v[208:211]
ds_read_b64_tr_b16 v[88:89], v16 offset:35840
s_waitcnt lgkmcnt(5)
v_mfma_f32_16x16x32_bf16 v[196:199], v[100:103], a[136:139], v[196:199]
ds_read_b64_tr_b16 v[90:91], v16 offset:52224
ds_read_b64_tr_b16 v[92:93], v17 offset:35840
v_mfma_f32_16x16x32_bf16 v[212:215], v[100:103], a[140:143], v[212:215]
ds_read_b64_tr_b16 v[94:95], v17 offset:52224
v_mul_f32 v140, v140, v72
v_mfma_f32_16x16x32_bf16 v[200:203], v[104:107], a[136:139], v[200:203]
ds_read_b64_tr_b16 v[96:97], v14 offset:36864
v_mul_f32 v141, v141, v73
v_mfma_f32_16x16x32_bf16 v[216:219], v[104:107], a[140:143], v[216:219]
ds_read_b64_tr_b16 v[98:99], v14 offset:53248
v_mul_f32 v142, v142, v74
v_mfma_f32_16x16x32_bf16 v[204:207], v[108:111], a[136:139], v[204:207]
ds_read_b64_tr_b16 v[100:101], v15 offset:36864
v_mul_f32 v143, v143, v75
v_mfma_f32_16x16x32_bf16 v[220:223], v[108:111], a[140:143], v[220:223]
ds_read_b64_tr_b16 v[102:103], v15 offset:53248
v_mul_f32 v68, v61, v144
v_mfma_f32_16x16x32_bf16 v[192:195], v[112:115], a[144:147], v[192:195]
ds_read_b64_tr_b16 v[104:105], v16 offset:36864
v_mul_f32 v69, v61, v145
v_mfma_f32_16x16x32_bf16 v[208:211], v[112:115], a[148:151], v[208:211]
ds_read_b64_tr_b16 v[106:107], v16 offset:53248
v_mul_f32 v70, v61, v146
v_mfma_f32_16x16x32_bf16 v[196:199], v[116:119], a[144:147], v[196:199]
ds_read_b64_tr_b16 v[108:109], v17 offset:36864
v_mul_f32 v71, v61, v147
v_mfma_f32_16x16x32_bf16 v[212:215], v[116:119], a[148:151], v[212:215]
v_exp_f32 v68, v68
v_mfma_f32_16x16x32_bf16 v[200:203], v[120:123], a[144:147], v[200:203]
ds_read_b64_tr_b16 v[110:111], v17 offset:53248
ds_read_b64_tr_b16 v[112:113], v14 offset:37888
v_mfma_f32_16x16x32_bf16 v[216:219], v[120:123], a[148:151], v[216:219]
v_exp_f32 v69, v69
v_mfma_f32_16x16x32_bf16 v[204:207], v[124:127], a[144:147], v[204:207]
ds_read_b64_tr_b16 v[114:115], v14 offset:54272
ds_read_b64_tr_b16 v[116:117], v15 offset:37888
v_mfma_f32_16x16x32_bf16 v[220:223], v[124:127], a[148:151], v[220:223]
ds_read_b64_tr_b16 v[118:119], v15 offset:54272
s_waitcnt lgkmcnt(6)
v_mfma_f32_16x16x32_bf16 v[192:195], v[80:83], a[152:155], v[192:195]
v_exp_f32 v70, v70
v_mfma_f32_16x16x32_bf16 v[208:211], v[80:83], a[156:159], v[208:211]
ds_read_b64_tr_b16 v[120:121], v16 offset:37888
ds_read_b64_tr_b16 v[122:123], v16 offset:54272
v_mfma_f32_16x16x32_bf16 v[196:199], v[84:87], a[152:155], v[196:199]
v_exp_f32 v71, v71
v_mfma_f32_16x16x32_bf16 v[212:215], v[84:87], a[156:159], v[212:215]
ds_read_b64_tr_b16 v[124:125], v17 offset:37888
ds_read_b64_tr_b16 v[126:127], v17 offset:54272
v_mfma_f32_16x16x32_bf16 v[200:203], v[88:91], a[152:155], v[200:203]
ds_read_b64_tr_b16 v[80:81], v14 offset:38912
v_fma_f32 v68, v68, v63, v63
v_mfma_f32_16x16x32_bf16 v[216:219], v[88:91], a[156:159], v[216:219]
ds_read_b64_tr_b16 v[82:83], v14 offset:55296
v_fma_f32 v69, v69, v63, v63
v_mfma_f32_16x16x32_bf16 v[204:207], v[92:95], a[152:155], v[204:207]
ds_read_b64_tr_b16 v[84:85], v15 offset:38912
v_fma_f32 v70, v70, v63, v63
v_mfma_f32_16x16x32_bf16 v[220:223], v[92:95], a[156:159], v[220:223]
ds_read_b64_tr_b16 v[86:87], v15 offset:55296
v_fma_f32 v71, v71, v63, v63
v_mfma_f32_16x16x32_bf16 v[192:195], v[96:99], a[160:163], v[192:195]
v_rcp_f32 v68, v68
v_mfma_f32_16x16x32_bf16 v[208:211], v[96:99], a[164:167], v[208:211]
ds_read_b64_tr_b16 v[88:89], v16 offset:38912
ds_read_b64_tr_b16 v[90:91], v16 offset:55296
v_mfma_f32_16x16x32_bf16 v[196:199], v[100:103], a[160:163], v[196:199]
v_rcp_f32 v69, v69
v_mfma_f32_16x16x32_bf16 v[212:215], v[100:103], a[164:167], v[212:215]
ds_read_b64_tr_b16 v[92:93], v17 offset:38912
ds_read_b64_tr_b16 v[94:95], v17 offset:55296
v_mfma_f32_16x16x32_bf16 v[200:203], v[104:107], a[160:163], v[200:203]
v_rcp_f32 v70, v70
v_mfma_f32_16x16x32_bf16 v[216:219], v[104:107], a[164:167], v[216:219]
ds_read_b64_tr_b16 v[96:97], v14 offset:39936
s_waitcnt lgkmcnt(5)
v_mfma_f32_16x16x32_bf16 v[204:207], v[108:111], a[160:163], v[204:207]
v_rcp_f32 v71, v71
v_mfma_f32_16x16x32_bf16 v[220:223], v[108:111], a[164:167], v[220:223]
ds_read_b64_tr_b16 v[98:99], v14 offset:56320
ds_read_b64_tr_b16 v[100:101], v15 offset:39936
v_mfma_f32_16x16x32_bf16 v[192:195], v[112:115], a[168:171], v[192:195]
ds_read_b64_tr_b16 v[102:103], v15 offset:56320
v_mul_f32 v144, v144, v68
v_mfma_f32_16x16x32_bf16 v[208:211], v[112:115], a[172:175], v[208:211]
ds_read_b64_tr_b16 v[104:105], v16 offset:39936
ds_read_b64_tr_b16 v[106:107], v16 offset:56320
v_mfma_f32_16x16x32_bf16 v[196:199], v[116:119], a[168:171], v[196:199]
ds_read_b64_tr_b16 v[108:109], v17 offset:39936
s_add_u32 m0, s76, 65536
v_mfma_f32_16x16x32_bf16 v[212:215], v[116:119], a[172:175], v[212:215]
ds_read_b64_tr_b16 v[110:111], v17 offset:56320
s_add_u32 s77, s84, 0x0
v_mfma_f32_16x16x32_bf16 v[200:203], v[120:123], a[168:171], v[200:203]
buffer_load_dwordx4 v30, s[40:43], s77 offen offset:0 lds
v_mfma_f32_16x16x32_bf16 v[216:219], v[120:123], a[172:175], v[216:219]
v_mul_f32 v145, v145, v69
v_mul_f32 v146, v146, v70
v_mfma_f32_16x16x32_bf16 v[204:207], v[124:127], a[168:171], v[204:207]
v_mul_f32 v147, v147, v71
v_mul_f32 v72, v61, v148
v_mfma_f32_16x16x32_bf16 v[220:223], v[124:127], a[172:175], v[220:223]
v_mul_f32 v73, v61, v149
v_mul_f32 v74, v61, v150
v_mfma_f32_16x16x32_bf16 v[192:195], v[80:83], a[176:179], v[192:195]
s_waitcnt vmcnt(12) lgkmcnt(0)
s_barrier
v_mfma_f32_16x16x32_bf16 v[208:211], v[80:83], a[180:183], v[208:211]
ds_read_b64_tr_b16 v[112:113], v10 offset:0
ds_read_b64_tr_b16 v[114:115], v10 offset:16384
v_mfma_f32_16x16x32_bf16 v[196:199], v[84:87], a[176:179], v[196:199]
ds_read_b64_tr_b16 v[116:117], v11 offset:0
v_mul_f32 v75, v61, v151
v_mfma_f32_16x16x32_bf16 v[212:215], v[84:87], a[180:183], v[212:215]
ds_read_b64_tr_b16 v[118:119], v11 offset:16384
ds_read_b64_tr_b16 v[120:121], v12 offset:0
v_mfma_f32_16x16x32_bf16 v[200:203], v[88:91], a[176:179], v[200:203]
buffer_load_dwordx4 v31, s[40:43], s77 offen offset:1024 lds
v_mfma_f32_16x16x32_bf16 v[216:219], v[88:91], a[180:183], v[216:219]
ds_read_b64_tr_b16 v[122:123], v12 offset:16384
ds_read_b64_tr_b16 v[124:125], v13 offset:0
v_mfma_f32_16x16x32_bf16 v[204:207], v[92:95], a[176:179], v[204:207]
v_exp_f32 v72, v72
v_mfma_f32_16x16x32_bf16 v[220:223], v[92:95], a[180:183], v[220:223]
ds_read_b64_tr_b16 v[126:127], v13 offset:16384
ds_read_b64_tr_b16 v[80:81], v10 offset:1024
v_mfma_f32_16x16x32_bf16 v[192:195], v[96:99], a[184:187], v[192:195]
buffer_load_dwordx4 v32, s[40:43], s77 offen offset:2048 lds
v_mfma_f32_16x16x32_bf16 v[208:211], v[96:99], a[188:191], v[208:211]
ds_read_b64_tr_b16 v[82:83], v10 offset:17408
ds_read_b64_tr_b16 v[84:85], v11 offset:1024
v_mfma_f32_16x16x32_bf16 v[196:199], v[100:103], a[184:187], v[196:199]
v_exp_f32 v73, v73
v_mfma_f32_16x16x32_bf16 v[212:215], v[100:103], a[188:191], v[212:215]
ds_read_b64_tr_b16 v[86:87], v11 offset:17408
ds_read_b64_tr_b16 v[88:89], v12 offset:1024
v_mfma_f32_16x16x32_bf16 v[200:203], v[104:107], a[184:187], v[200:203]
buffer_load_dwordx4 v33, s[40:43], s77 offen offset:3072 lds
v_mfma_f32_16x16x32_bf16 v[216:219], v[104:107], a[188:191], v[216:219]
ds_read_b64_tr_b16 v[90:91], v12 offset:17408
ds_read_b64_tr_b16 v[92:93], v13 offset:1024
v_mfma_f32_16x16x32_bf16 v[204:207], v[108:111], a[184:187], v[204:207]
v_exp_f32 v74, v74
v_mfma_f32_16x16x32_bf16 v[220:223], v[108:111], a[188:191], v[220:223]
ds_read_b64_tr_b16 v[94:95], v13 offset:17408
s_waitcnt lgkmcnt(5)
v_mfma_f32_16x16x32_bf16 v[192:195], v[112:115], a[192:195], v[192:195]
ds_read_b64_tr_b16 v[96:97], v10 offset:2048
s_add_u32 m0, s76, 69632
v_mfma_f32_16x16x32_bf16 v[208:211], v[112:115], a[196:199], v[208:211]
ds_read_b64_tr_b16 v[98:99], v10 offset:18432
s_add_u32 s77, s84, 0xe0000
v_mfma_f32_16x16x32_bf16 v[196:199], v[116:119], a[192:195], v[196:199]
ds_read_b64_tr_b16 v[100:101], v11 offset:2048
ds_read_b64_tr_b16 v[102:103], v11 offset:18432
v_mfma_f32_16x16x32_bf16 v[212:215], v[116:119], a[196:199], v[212:215]
buffer_load_dwordx4 v30, s[40:43], s77 offen offset:0 lds
v_mfma_f32_16x16x32_bf16 v[200:203], v[120:123], a[192:195], v[200:203]
ds_read_b64_tr_b16 v[104:105], v12 offset:2048
ds_read_b64_tr_b16 v[106:107], v12 offset:18432
v_mfma_f32_16x16x32_bf16 v[216:219], v[120:123], a[196:199], v[216:219]
v_exp_f32 v75, v75
v_mfma_f32_16x16x32_bf16 v[204:207], v[124:127], a[192:195], v[204:207]
ds_read_b64_tr_b16 v[108:109], v13 offset:2048
ds_read_b64_tr_b16 v[110:111], v13 offset:18432
v_mfma_f32_16x16x32_bf16 v[220:223], v[124:127], a[196:199], v[220:223]
buffer_load_dwordx4 v31, s[40:43], s77 offen offset:1024 lds
v_mfma_f32_16x16x32_bf16 v[192:195], v[80:83], a[200:203], v[192:195]
ds_read_b64_tr_b16 v[112:113], v10 offset:3072
ds_read_b64_tr_b16 v[114:115], v10 offset:19456
v_mfma_f32_16x16x32_bf16 v[208:211], v[80:83], a[204:207], v[208:211]
ds_read_b64_tr_b16 v[116:117], v11 offset:3072
s_waitcnt lgkmcnt(7)
v_mfma_f32_16x16x32_bf16 v[196:199], v[84:87], a[200:203], v[196:199]
ds_read_b64_tr_b16 v[118:119], v11 offset:19456
ds_read_b64_tr_b16 v[120:121], v12 offset:3072
v_mfma_f32_16x16x32_bf16 v[212:215], v[84:87], a[204:207], v[212:215]
buffer_load_dwordx4 v32, s[40:43], s77 offen offset:2048 lds
v_mfma_f32_16x16x32_bf16 v[200:203], v[88:91], a[200:203], v[200:203]
ds_read_b64_tr_b16 v[122:123], v12 offset:19456
ds_read_b64_tr_b16 v[124:125], v13 offset:3072
v_mfma_f32_16x16x32_bf16 v[216:219], v[88:91], a[204:207], v[216:219]
ds_read_b64_tr_b16 v[126:127], v13 offset:19456
v_fma_f32 v72, v72, v63, v63
v_mfma_f32_16x16x32_bf16 v[204:207], v[92:95], a[200:203], v[204:207]
ds_read_b64_tr_b16 v[80:81], v10 offset:4096
ds_read_b64_tr_b16 v[82:83], v10 offset:20480
v_mfma_f32_16x16x32_bf16 v[220:223], v[92:95], a[204:207], v[220:223]
buffer_load_dwordx4 v33, s[40:43], s77 offen offset:3072 lds
v_mfma_f32_16x16x32_bf16 v[192:195], v[96:99], a[208:211], v[192:195]
ds_read_b64_tr_b16 v[84:85], v11 offset:4096
ds_read_b64_tr_b16 v[86:87], v11 offset:20480
v_mfma_f32_16x16x32_bf16 v[208:211], v[96:99], a[212:215], v[208:211]
ds_read_b64_tr_b16 v[88:89], v12 offset:4096
s_add_u32 m0, s76, 98304
v_mfma_f32_16x16x32_bf16 v[196:199], v[100:103], a[208:211], v[196:199]
ds_read_b64_tr_b16 v[90:91], v12 offset:20480
s_add_u32 s77, s84, 0x1c0000
v_mfma_f32_16x16x32_bf16 v[212:215], v[100:103], a[212:215], v[212:215]
ds_read_b64_tr_b16 v[92:93], v13 offset:4096
s_waitcnt lgkmcnt(7)
v_mfma_f32_16x16x32_bf16 v[200:203], v[104:107], a[208:211], v[200:203]
buffer_load_dwordx4 v30, s[40:43], s77 offen offset:0 lds
v_mfma_f32_16x16x32_bf16 v[216:219], v[104:107], a[212:215], v[216:219]
ds_read_b64_tr_b16 v[94:95], v13 offset:20480
ds_read_b64_tr_b16 v[96:97], v10 offset:5120
v_mfma_f32_16x16x32_bf16 v[204:207], v[108:111], a[208:211], v[204:207]
ds_read_b64_tr_b16 v[98:99], v10 offset:21504
v_fma_f32 v73, v73, v63, v63
v_mfma_f32_16x16x32_bf16 v[220:223], v[108:111], a[212:215], v[220:223]
ds_read_b64_tr_b16 v[100:101], v11 offset:5120
ds_read_b64_tr_b16 v[102:103], v11 offset:21504
v_mfma_f32_16x16x32_bf16 v[192:195], v[112:115], a[216:219], v[192:195]
buffer_load_dwordx4 v31, s[40:43], s77 offen offset:1024 lds
v_mfma_f32_16x16x32_bf16 v[208:211], v[112:115], a[220:223], v[208:211]
ds_read_b64_tr_b16 v[104:105], v12 offset:5120
ds_read_b64_tr_b16 v[106:107], v12 offset:21504
v_mfma_f32_16x16x32_bf16 v[196:199], v[116:119], a[216:219], v[196:199]
ds_read_b64_tr_b16 v[108:109], v13 offset:5120
v_fma_f32 v74, v74, v63, v63
v_mfma_f32_16x16x32_bf16 v[212:215], v[116:119], a[220:223], v[212:215]
ds_read_b64_tr_b16 v[110:111], v13 offset:21504
v_fma_f32 v75, v75, v63, v63
v_mfma_f32_16x16x32_bf16 v[200:203], v[120:123], a[216:219], v[200:203]
buffer_load_dwordx4 v32, s[40:43], s77 offen offset:2048 lds
v_mfma_f32_16x16x32_bf16 v[216:219], v[120:123], a[220:223], v[216:219]
ds_read_b64_tr_b16 v[112:113], v10 offset:6144
ds_read_b64_tr_b16 v[114:115], v10 offset:22528
v_mfma_f32_16x16x32_bf16 v[204:207], v[124:127], a[216:219], v[204:207]
v_rcp_f32 v72, v72
v_mfma_f32_16x16x32_bf16 v[220:223], v[124:127], a[220:223], v[220:223]
ds_read_b64_tr_b16 v[116:117], v11 offset:6144
s_waitcnt lgkmcnt(5)
v_mfma_f32_16x16x32_bf16 v[192:195], v[80:83], a[224:227], v[192:195]
buffer_load_dwordx4 v33, s[40:43], s77 offen offset:3072 lds
v_mfma_f32_16x16x32_bf16 v[208:211], v[80:83], a[228:231], v[208:211]
ds_read_b64_tr_b16 v[118:119], v11 offset:22528
ds_read_b64_tr_b16 v[120:121], v12 offset:6144
v_mfma_f32_16x16x32_bf16 v[196:199], v[84:87], a[224:227], v[196:199]
v_rcp_f32 v73, v73
v_mfma_f32_16x16x32_bf16 v[212:215], v[84:87], a[228:231], v[212:215]
ds_read_b64_tr_b16 v[122:123], v12 offset:22528
ds_read_b64_tr_b16 v[124:125], v13 offset:6144
v_mfma_f32_16x16x32_bf16 v[200:203], v[88:91], a[224:227], v[200:203]
v_rcp_f32 v74, v74
v_mfma_f32_16x16x32_bf16 v[216:219], v[88:91], a[228:231], v[216:219]
ds_read_b64_tr_b16 v[126:127], v13 offset:22528
ds_read_b64_tr_b16 v[80:81], v10 offset:7168
v_mfma_f32_16x16x32_bf16 v[204:207], v[92:95], a[224:227], v[204:207]
v_rcp_f32 v75, v75
v_mfma_f32_16x16x32_bf16 v[220:223], v[92:95], a[228:231], v[220:223]
ds_read_b64_tr_b16 v[82:83], v10 offset:23552
ds_read_b64_tr_b16 v[84:85], v11 offset:7168
v_mfma_f32_16x16x32_bf16 v[192:195], v[96:99], a[232:235], v[192:195]
ds_read_b64_tr_b16 v[86:87], v11 offset:23552
s_add_u32 m0, s76, 102400
v_mfma_f32_16x16x32_bf16 v[208:211], v[96:99], a[236:239], v[208:211]
ds_read_b64_tr_b16 v[88:89], v12 offset:7168
s_add_u32 s77, s84, 0x2a0000
v_mfma_f32_16x16x32_bf16 v[196:199], v[100:103], a[232:235], v[196:199]
buffer_load_dwordx4 v30, s[40:43], s77 offen offset:0 lds
v_mfma_f32_16x16x32_bf16 v[212:215], v[100:103], a[236:239], v[212:215]
ds_read_b64_tr_b16 v[90:91], v12 offset:23552
ds_read_b64_tr_b16 v[92:93], v13 offset:7168
v_mfma_f32_16x16x32_bf16 v[200:203], v[104:107], a[232:235], v[200:203]
ds_read_b64_tr_b16 v[94:95], v13 offset:23552
v_mul_f32 v148, v148, v72
v_mfma_f32_16x16x32_bf16 v[216:219], v[104:107], a[236:239], v[216:219]
v_mul_f32 v149, v149, v73
s_waitcnt lgkmcnt(5)
v_mfma_f32_16x16x32_bf16 v[204:207], v[108:111], a[232:235], v[204:207]
buffer_load_dwordx4 v31, s[40:43], s77 offen offset:1024 lds
v_mfma_f32_16x16x32_bf16 v[220:223], v[108:111], a[236:239], v[220:223]
v_mul_f32 v150, v150, v74
v_mul_f32 v151, v151, v75
v_mfma_f32_16x16x32_bf16 v[192:195], v[112:115], a[240:243], v[192:195]
v_mul_f32 v68, v61, v152
v_mul_f32 v69, v61, v153
v_mfma_f32_16x16x32_bf16 v[208:211], v[112:115], a[244:247], v[208:211]
s_waitcnt vmcnt(14) lgkmcnt(0)
s_barrier
v_mfma_f32_16x16x32_bf16 v[196:199], v[116:119], a[240:243], v[196:199]
ds_read_b64_tr_b16 v[96:97], v18 offset:32768
ds_read_b64_tr_b16 v[98:99], v18 offset:40960
v_mfma_f32_16x16x32_bf16 v[212:215], v[116:119], a[244:247], v[212:215]
ds_read_b64_tr_b16 v[100:101], v19 offset:32768
ds_read_b64_tr_b16 v[102:103], v19 offset:40960
v_mfma_f32_16x16x32_bf16 v[200:203], v[120:123], a[240:243], v[200:203]
ds_read_b64_tr_b16 v[104:105], v18 offset:49152
v_mul_f32 v70, v61, v154
v_mfma_f32_16x16x32_bf16 v[216:219], v[120:123], a[244:247], v[216:219]
ds_read_b64_tr_b16 v[106:107], v18 offset:57344
ds_read_b64_tr_b16 v[108:109], v19 offset:49152
v_mfma_f32_16x16x32_bf16 v[204:207], v[124:127], a[240:243], v[204:207]
buffer_load_dwordx4 v32, s[40:43], s77 offen offset:2048 lds
v_mfma_f32_16x16x32_bf16 v[220:223], v[124:127], a[244:247], v[220:223]
ds_read_b64_tr_b16 v[110:111], v19 offset:57344
ds_read_b64_tr_b16 v[112:113], v18 offset:33792
v_mfma_f32_16x16x32_bf16 v[192:195], v[80:83], a[248:251], v[192:195]
ds_read_b64_tr_b16 v[114:115], v18 offset:41984
v_mul_f32 v71, v61, v155
v_mfma_f32_16x16x32_bf16 v[208:211], v[80:83], a[252:255], v[208:211]
v_exp_f32 v68, v68
v_mfma_f32_16x16x32_bf16 v[196:199], v[84:87], a[248:251], v[196:199]
ds_read_b64_tr_b16 v[116:117], v19 offset:33792
ds_read_b64_tr_b16 v[118:119], v19 offset:41984
v_mfma_f32_16x16x32_bf16 v[212:215], v[84:87], a[252:255], v[212:215]
buffer_load_dwordx4 v33, s[40:43], s77 offen offset:3072 lds
v_mfma_f32_16x16x32_bf16 v[200:203], v[88:91], a[248:251], v[200:203]
ds_read_b64_tr_b16 v[120:121], v18 offset:50176
ds_read_b64_tr_b16 v[122:123], v18 offset:58368
v_mfma_f32_16x16x32_bf16 v[216:219], v[88:91], a[252:255], v[216:219]
v_exp_f32 v69, v69
v_mfma_f32_16x16x32_bf16 v[204:207], v[92:95], a[248:251], v[204:207]
ds_read_b64_tr_b16 v[124:125], v19 offset:50176
ds_read_b64_tr_b16 v[126:127], v19 offset:58368
v_mfma_f32_16x16x32_bf16 v[220:223], v[92:95], a[252:255], v[220:223]
v_exp_f32 v70, v70
S_H1:
s_waitcnt lgkmcnt(6)
v_mfma_f32_16x16x32_bf16 v[224:227], v[96:99], a[64:67], v[224:227]
ds_read_b64_tr_b16 v[80:81], v18 offset:34816
ds_read_b64_tr_b16 v[82:83], v18 offset:43008
v_mfma_f32_16x16x32_bf16 v[240:243], v[96:99], a[68:71], v[240:243]
v_exp_f32 v71, v71
v_mfma_f32_16x16x32_bf16 v[228:231], v[100:103], a[64:67], v[228:231]
ds_read_b64_tr_b16 v[84:85], v19 offset:34816
ds_read_b64_tr_b16 v[86:87], v19 offset:43008
v_mfma_f32_16x16x32_bf16 v[244:247], v[100:103], a[68:71], v[244:247]
s_add_u32 s70, s0, S_H2 - K_pc + 0
s_addc_u32 s71, s1, 0
global_load_dword v57, v9, s[70:71]
v_mfma_f32_16x16x32_bf16 v[232:235], v[104:107], a[64:67], v[232:235]
ds_read_b64_tr_b16 v[88:89], v18 offset:51200
ds_read_b64_tr_b16 v[90:91], v18 offset:59392
v_mfma_f32_16x16x32_bf16 v[248:251], v[104:107], a[68:71], v[248:251]
ds_read_b64_tr_b16 v[92:93], v19 offset:51200
s_add_u32 m0, s76, 0
v_mfma_f32_16x16x32_bf16 v[236:239], v[108:111], a[64:67], v[236:239]
ds_read_b64_tr_b16 v[94:95], v19 offset:59392
s_add_u32 s77, s84, 0x380000
v_mfma_f32_16x16x32_bf16 v[252:255], v[108:111], a[68:71], v[252:255]
buffer_load_dwordx4 v30, s[40:43], s77 offen offset:0 lds
v_mfma_f32_16x16x32_bf16 v[224:227], v[112:115], a[72:75], v[224:227]
ds_read_b64_tr_b16 v[96:97], v18 offset:35840
ds_read_b64_tr_b16 v[98:99], v18 offset:44032
v_mfma_f32_16x16x32_bf16 v[240:243], v[112:115], a[76:79], v[240:243]
ds_read_b64_tr_b16 v[100:101], v19 offset:35840
s_waitcnt lgkmcnt(7)
v_mfma_f32_16x16x32_bf16 v[228:231], v[116:119], a[72:75], v[228:231]
ds_read_b64_tr_b16 v[102:103], v19 offset:44032
ds_read_b64_tr_b16 v[104:105], v18 offset:52224
v_mfma_f32_16x16x32_bf16 v[244:247], v[116:119], a[76:79], v[244:247]
buffer_load_dwordx4 v31, s[40:43], s77 offen offset:1024 lds
v_mfma_f32_16x16x32_bf16 v[232:235], v[120:123], a[72:75], v[232:235]
ds_read_b64_tr_b16 v[106:107], v18 offset:60416
ds_read_b64_tr_b16 v[108:109], v19 offset:52224
v_mfma_f32_16x16x32_bf16 v[248:251], v[120:123], a[76:79], v[248:251]
ds_read_b64_tr_b16 v[110:111], v19 offset:60416
s_mul_i32 s3, s101, 7168
v_mfma_f32_16x16x32_bf16 v[236:239], v[124:127], a[72:75], v[236:239]
ds_read_b64_tr_b16 v[112:113], v18 offset:36864
ds_read_b64_tr_b16 v[114:115], v18 offset:45056
v_mfma_f32_16x16x32_bf16 v[252:255], v[124:127], a[76:79], v[252:255]
buffer_load_dwordx4 v32, s[40:43], s77 offen offset:2048 lds
v_mfma_f32_16x16x32_bf16 v[224:227], v[80:83], a[80:83], v[224:227]
ds_read_b64_tr_b16 v[116:117], v19 offset:36864
ds_read_b64_tr_b16 v[118:119], v19 offset:45056
v_mfma_f32_16x16x32_bf16 v[240:243], v[80:83], a[84:87], v[240:243]
ds_read_b64_tr_b16 v[120:121], v18 offset:53248
s_add_u32 s3, s3, 0x1000
v_mfma_f32_16x16x32_bf16 v[228:231], v[84:87], a[80:83], v[228:231]
ds_read_b64_tr_b16 v[122:123], v18 offset:61440
ds_read_b64_tr_b16 v[124:125], v19 offset:53248
v_mfma_f32_16x16x32_bf16 v[244:247], v[84:87], a[84:87], v[244:247]
ds_read_b64_tr_b16 v[126:127], v19 offset:61440
s_waitcnt lgkmcnt(8)
v_mfma_f32_16x16x32_bf16 v[232:235], v[88:91], a[80:83], v[232:235]
buffer_load_dwordx4 v33, s[40:43], s77 offen offset:3072 lds
v_mfma_f32_16x16x32_bf16 v[248:251], v[88:91], a[84:87], v[248:251]
ds_read_b64_tr_b16 v[80:81], v18 offset:37888
ds_read_b64_tr_b16 v[82:83], v18 offset:46080
v_mfma_f32_16x16x32_bf16 v[236:239], v[92:95], a[80:83], v[236:239]
ds_read_b64_tr_b16 v[84:85], v19 offset:37888
s_add_u32 m0, s76, 4096
v_mfma_f32_16x16x32_bf16 v[252:255], v[92:95], a[84:87], v[252:255]
ds_read_b64_tr_b16 v[86:87], v19 offset:46080
s_add_u32 s77, s84, 0x460000
v_mfma_f32_16x16x32_bf16 v[224:227], v[96:99], a[88:91], v[224:227]
buffer_load_dwordx4 v30, s[40:43], s77 offen offset:0 lds
v_mfma_f32_16x16x32_bf16 v[240:243], v[96:99], a[92:95], v[240:243]
ds_read_b64_tr_b16 v[88:89], v18 offset:54272
ds_read_b64_tr_b16 v[90:91], v18 offset:62464
v_mfma_f32_16x16x32_bf16 v[228:231], v[100:103], a[88:91], v[228:231]
ds_read_b64_tr_b16 v[92:93], v19 offset:54272
v_fma_f32 v68, v68, v63, v63
v_mfma_f32_16x16x32_bf16 v[244:247], v[100:103], a[92:95], v[244:247]
ds_read_b64_tr_b16 v[94:95], v19 offset:62464
v_fma_f32 v69, v69, v63, v63
v_mfma_f32_16x16x32_bf16 v[232:235], v[104:107], a[88:91], v[232:235]
buffer_load_dwordx4 v31, s[40:43], s77 offen offset:1024 lds
v_mfma_f32_16x16x32_bf16 v[248:251], v[104:107], a[92:95], v[248:251]
ds_read_b64_tr_b16 v[96:97], v18 offset:38912
ds_read_b64_tr_b16 v[98:99], v18 offset:47104
v_mfma_f32_16x16x32_bf16 v[236:239], v[108:111], a[88:91], v[236:239]
ds_read_b64_tr_b16 v[100:101], v19 offset:38912
v_fma_f32 v70, v70, v63, v63
v_mfma_f32_16x16x32_bf16 v[252:255], v[108:111], a[92:95], v[252:255]
ds_read_b64_tr_b16 v[102:103], v19 offset:47104
s_waitcnt lgkmcnt(6)
v_mfma_f32_16x16x32_bf16 v[224:227], v[112:115], a[96:99], v[224:227]
buffer_load_dwordx4 v32, s[40:43], s77 offen offset:2048 lds
v_mfma_f32_16x16x32_bf16 v[240:243], v[112:115], a[100:103], v[240:243]
ds_read_b64_tr_b16 v[104:105], v18 offset:55296
ds_read_b64_tr_b16 v[106:107], v18 offset:63488
v_mfma_f32_16x16x32_bf16 v[228:231], v[116:119], a[96:99], v[228:231]
ds_read_b64_tr_b16 v[108:109], v19 offset:55296
v_fma_f32 v71, v71, v63, v63
v_mfma_f32_16x16x32_bf16 v[244:247], v[116:119], a[100:103], v[244:247]
v_rcp_f32 v68, v68
v_mfma_f32_16x16x32_bf16 v[232:235], v[120:123], a[96:99], v[232:235]
ds_read_b64_tr_b16 v[110:111], v19 offset:63488
ds_read_b64_tr_b16 v[112:113], v18 offset:39936
v_mfma_f32_16x16x32_bf16 v[248:251], v[120:123], a[100:103], v[248:251]
buffer_load_dwordx4 v33, s[40:43], s77 offen offset:3072 lds
v_mfma_f32_16x16x32_bf16 v[236:239], v[124:127], a[96:99], v[236:239]
ds_read_b64_tr_b16 v[114:115], v18 offset:48128
ds_read_b64_tr_b16 v[116:117], v19 offset:39936
v_mfma_f32_16x16x32_bf16 v[252:255], v[124:127], a[100:103], v[252:255]
buffer_load_dword v57, v8, s[40:43], s3 offen
v_mfma_f32_16x16x32_bf16 v[224:227], v[80:83], a[104:107], v[224:227]
ds_read_b64_tr_b16 v[118:119], v19 offset:48128
ds_read_b64_tr_b16 v[120:121], v18 offset:56320
v_mfma_f32_16x16x32_bf16 v[240:243], v[80:83], a[108:111], v[240:243]
ds_read_b64_tr_b16 v[122:123], v18 offset:64512
s_mul_i32 s3, s101, 1024
v_mfma_f32_16x16x32_bf16 v[228:231], v[84:87], a[104:107], v[228:231]
ds_read_b64_tr_b16 v[124:125], v19 offset:56320
s_add_u32 s3, s3, 0x300000
v_mfma_f32_16x16x32_bf16 v[244:247], v[84:87], a[108:111], v[244:247]
buffer_load_dword v57, v50, s[48:51], s3 offen
v_mfma_f32_16x16x32_bf16 v[232:235], v[88:91], a[104:107], v[232:235]
ds_read_b64_tr_b16 v[126:127], v19 offset:64512
s_mul_i32 s3, s101, 1024
v_mfma_f32_16x16x32_bf16 v[248:251], v[88:91], a[108:111], v[248:251]
s_add_u32 s3, s3, 0x400000
s_waitcnt lgkmcnt(5)
v_mfma_f32_16x16x32_bf16 v[236:239], v[92:95], a[104:107], v[236:239]
buffer_load_dword v57, v50, s[48:51], s3 offen
v_mfma_f32_16x16x32_bf16 v[252:255], v[92:95], a[108:111], v[252:255]
v_rcp_f32 v69, v69
v_mfma_f32_16x16x32_bf16 v[224:227], v[96:99], a[112:115], v[224:227]
v_rcp_f32 v70, v70
v_mfma_f32_16x16x32_bf16 v[240:243], v[96:99], a[116:119], v[240:243]
s_waitcnt vmcnt(20) lgkmcnt(0)
s_barrier
v_mfma_f32_16x16x32_bf16 v[228:231], v[100:103], a[112:115], v[228:231]
ds_read_b64_tr_b16 v[80:81], v14 offset:0
ds_read_b64_tr_b16 v[82:83], v14 offset:16384
v_mfma_f32_16x16x32_bf16 v[244:247], v[100:103], a[116:119], v[244:247]
ds_read_b64_tr_b16 v[84:85], v15 offset:0
ds_read_b64_tr_b16 v[86:87], v15 offset:16384
v_mfma_f32_16x16x32_bf16 v[232:235], v[104:107], a[112:115], v[232:235]
ds_read_b64_tr_b16 v[88:89], v16 offset:0
s_add_u32 m0, s76, 32768
v_mfma_f32_16x16x32_bf16 v[248:251], v[104:107], a[116:119], v[248:251]
ds_read_b64_tr_b16 v[90:91], v16 offset:16384
s_add_u32 s77, s84, 0x540000
v_mfma_f32_16x16x32_bf16 v[236:239], v[108:111], a[112:115], v[236:239]
ds_read_b64_tr_b16 v[92:93], v17 offset:0
ds_read_b64_tr_b16 v[94:95], v17 offset:16384
v_mfma_f32_16x16x32_bf16 v[252:255], v[108:111], a[116:119], v[252:255]
buffer_load_dwordx4 v30, s[40:43], s77 offen offset:0 lds
v_mfma_f32_16x16x32_bf16 v[224:227], v[112:115], a[120:123], v[224:227]
ds_read_b64_tr_b16 v[96:97], v14 offset:1024
ds_read_b64_tr_b16 v[98:99], v14 offset:17408
v_mfma_f32_16x16x32_bf16 v[240:243], v[112:115], a[124:127], v[240:243]
v_rcp_f32 v71, v71
v_mfma_f32_16x16x32_bf16 v[228:231], v[116:119], a[120:123], v[228:231]
ds_read_b64_tr_b16 v[100:101], v15 offset:1024
ds_read_b64_tr_b16 v[102:103], v15 offset:17408
v_mfma_f32_16x16x32_bf16 v[244:247], v[116:119], a[124:127], v[244:247]
ds_read_b64_tr_b16 v[104:105], v16 offset:1024
v_mul_f32 v152, v152, v68
v_mfma_f32_16x16x32_bf16 v[232:235], v[120:123], a[120:123], v[232:235]
ds_read_b64_tr_b16 v[106:107], v16 offset:17408
ds_read_b64_tr_b16 v[108:109], v17 offset:1024
v_mfma_f32_16x16x32_bf16 v[248:251], v[120:123], a[124:127], v[248:251]
buffer_load_dwordx4 v31, s[40:43], s77 offen offset:1024 lds
v_mfma_f32_16x16x32_bf16 v[236:239], v[124:127], a[120:123], v[236:239]
ds_read_b64_tr_b16 v[110:111], v17 offset:17408
ds_read_b64_tr_b16 v[112:113], v14 offset:2048
v_mfma_f32_16x16x32_bf16 v[252:255], v[124:127], a[124:127], v[252:255]
ds_read_b64_tr_b16 v[114:115], v14 offset:18432
s_waitcnt lgkmcnt(8)
v_mfma_f32_16x16x32_bf16 v[160:163], v[80:83], a[0:3], 0
ds_read_b64_tr_b16 v[116:117], v15 offset:2048
ds_read_b64_tr_b16 v[118:119], v15 offset:18432
v_mfma_f32_16x16x32_bf16 v[176:179], v[80:83], a[4:7], 0
ds_read_b64_tr_b16 v[120:121], v16 offset:2048
v_mul_f32 v153, v153, v69
v_mfma_f32_16x16x32_bf16 v[164:167], v[84:87], a[0:3], 0
ds_read_b64_tr_b16 v[122:123], v16 offset:18432
ds_read_b64_tr_b16 v[124:125], v17 offset:2048
v_mfma_f32_16x16x32_bf16 v[180:183], v[84:87], a[4:7], 0
buffer_load_dwordx4 v32, s[40:43], s77 offen offset:2048 lds
v_mfma_f32_16x16x32_bf16 v[168:171], v[88:91], a[0:3], 0
ds_read_b64_tr_b16 v[126:127], v17 offset:18432
ds_read_b64_tr_b16 v[80:81], v14 offset:3072
v_mfma_f32_16x16x32_bf16 v[184:187], v[88:91], a[4:7], 0
ds_read_b64_tr_b16 v[82:83], v14 offset:19456
v_mul_f32 v154, v154, v70
v_mfma_f32_16x16x32_bf16 v[172:175], v[92:95], a[0:3], 0
ds_read_b64_tr_b16 v[84:85], v15 offset:3072
v_mul_f32 v155, v155, v71
v_mfma_f32_16x16x32_bf16 v[188:191], v[92:95], a[4:7], 0
ds_read_b64_tr_b16 v[86:87], v15 offset:19456
v_mul_f32 v72, v61, v156
v_mfma_f32_16x16x32_bf16 v[160:163], v[96:99], a[8:11], v[160:163]
ds_read_b64_tr_b16 v[88:89], v16 offset:3072
v_mul_f32 v73, v61, v157
v_mfma_f32_16x16x32_bf16 v[176:179], v[96:99], a[12:15], v[176:179]
ds_read_b64_tr_b16 v[90:91], v16 offset:19456
s_waitcnt lgkmcnt(7)
v_mfma_f32_16x16x32_bf16 v[164:167], v[100:103], a[8:11], v[164:167]
buffer_load_dwordx4 v33, s[40:43], s77 offen offset:3072 lds
v_mfma_f32_16x16x32_bf16 v[180:183], v[100:103], a[12:15], v[180:183]
ds_read_b64_tr_b16 v[92:93], v17 offset:3072
ds_read_b64_tr_b16 v[94:95], v17 offset:19456
v_mfma_f32_16x16x32_bf16 v[168:171], v[104:107], a[8:11], v[168:171]
ds_read_b64_tr_b16 v[96:97], v14 offset:4096
v_mul_f32 v74, v61, v158
v_mfma_f32_16x16x32_bf16 v[184:187], v[104:107], a[12:15], v[184:187]
ds_read_b64_tr_b16 v[98:99], v14 offset:20480
s_add_u32 m0, s76, 36864
v_mfma_f32_16x16x32_bf16 v[172:175], v[108:111], a[8:11], v[172:175]
ds_read_b64_tr_b16 v[100:101], v15 offset:4096
s_add_u32 s77, s84, 0x620000
v_mfma_f32_16x16x32_bf16 v[188:191], v[108:111], a[12:15], v[188:191]
ds_read_b64_tr_b16 v[102:103], v15 offset:20480
v_mul_f32 v75, v61, v159
v_mfma_f32_16x16x32_bf16 v[160:163], v[112:115], a[16:19], v[160:163]
buffer_load_dwordx4 v30, s[40:43], s77 offen offset:0 lds
v_mfma_f32_16x16x32_bf16 v[176:179], v[112:115], a[20:23], v[176:179]
ds_read_b64_tr_b16 v[104:105], v16 offset:4096
ds_read_b64_tr_b16 v[106:107], v16 offset:20480
v_mfma_f32_16x16x32_bf16 v[164:167], v[116:119], a[16:19], v[164:167]
v_exp_f32 v72, v72
v_mfma_f32_16x16x32_bf16 v[180:183], v[116:119], a[20:23], v[180:183]
ds_read_b64_tr_b16 v[108:109], v17 offset:4096
ds_read_b64_tr_b16 v[110:111], v17 offset:20480
v_mfma_f32_16x16x32_bf16 v[168:171], v[120:123], a[16:19], v[168:171]
v_exp_f32 v73, v73
v_mfma_f32_16x16x32_bf16 v[184:187], v[120:123], a[20:23], v[184:187]
ds_read_b64_tr_b16 v[112:113], v14 offset:5120
s_waitcnt lgkmcnt(5)
v_mfma_f32_16x16x32_bf16 v[172:175], v[124:127], a[16:19], v[172:175]
buffer_load_dwordx4 v31, s[40:43], s77 offen offset:1024 lds
v_mfma_f32_16x16x32_bf16 v[188:191], v[124:127], a[20:23], v[188:191]
ds_read_b64_tr_b16 v[114:115], v14 offset:21504
ds_read_b64_tr_b16 v[116:117], v15 offset:5120
v_mfma_f32_16x16x32_bf16 v[160:163], v[80:83], a[24:27], v[160:163]
v_exp_f32 v74, v74
v_mfma_f32_16x16x32_bf16 v[176:179], v[80:83], a[28:31], v[176:179]
ds_read_b64_tr_b16 v[118:119], v15 offset:21504
ds_read_b64_tr_b16 v[120:121], v16 offset:5120
v_mfma_f32_16x16x32_bf16 v[164:167], v[84:87], a[24:27], v[164:167]
v_exp_f32 v75, v75
v_mfma_f32_16x16x32_bf16 v[180:183], v[84:87], a[28:31], v[180:183]
ds_read_b64_tr_b16 v[122:123], v16 offset:21504
ds_read_b64_tr_b16 v[124:125], v17 offset:5120
v_mfma_f32_16x16x32_bf16 v[168:171], v[88:91], a[24:27], v[168:171]
buffer_load_dwordx4 v32, s[40:43], s77 offen offset:2048 lds
v_mfma_f32_16x16x32_bf16 v[184:187], v[88:91], a[28:31], v[184:187]
ds_read_b64_tr_b16 v[126:127], v17 offset:21504
ds_read_b64_tr_b16 v[80:81], v14 offset:6144
v_mfma_f32_16x16x32_bf16 v[172:175], v[92:95], a[24:27], v[172:175]
ds_read_b64_tr_b16 v[82:83], v14 offset:22528
v_fma_f32 v72, v72, v63, v63
v_mfma_f32_16x16x32_bf16 v[188:191], v[92:95], a[28:31], v[188:191]
ds_read_b64_tr_b16 v[84:85], v15 offset:6144
ds_read_b64_tr_b16 v[86:87], v15 offset:22528
v_mfma_f32_16x16x32_bf16 v[160:163], v[96:99], a[32:35], v[160:163]
ds_read_b64_tr_b16 v[88:89], v16 offset:6144
v_fma_f32 v73, v73, v63, v63
v_mfma_f32_16x16x32_bf16 v[176:179], v[96:99], a[36:39], v[176:179]
ds_read_b64_tr_b16 v[90:91], v16 offset:22528
v_fma_f32 v74, v74, v63, v63
v_mfma_f32_16x16x32_bf16 v[164:167], v[100:103], a[32:35], v[164:167]
buffer_load_dwordx4 v33, s[40:43], s77 offen offset:3072 lds
v_mfma_f32_16x16x32_bf16 v[180:183], v[100:103], a[36:39], v[180:183]
ds_read_b64_tr_b16 v[92:93], v17 offset:6144
s_waitcnt lgkmcnt(6)
v_mfma_f32_16x16x32_bf16 v[168:171], v[104:107], a[32:35], v[168:171]
ds_read_b64_tr_b16 v[94:95], v17 offset:22528
ds_read_b64_tr_b16 v[96:97], v14 offset:7168
v_mfma_f32_16x16x32_bf16 v[184:187], v[104:107], a[36:39], v[184:187]
ds_read_b64_tr_b16 v[98:99], v14 offset:23552
v_fma_f32 v75, v75, v63, v63
v_mfma_f32_16x16x32_bf16 v[172:175], v[108:111], a[32:35], v[172:175]
v_rcp_f32 v72, v72
v_mfma_f32_16x16x32_bf16 v[188:191], v[108:111], a[36:39], v[188:191]
ds_read_b64_tr_b16 v[100:101], v15 offset:7168
ds_read_b64_tr_b16 v[102:103], v15 offset:23552
v_mfma_f32_16x16x32_bf16 v[160:163], v[112:115], a[40:43], v[160:163]
v_rcp_f32 v73, v73
v_mfma_f32_16x16x32_bf16 v[176:179], v[112:115], a[44:47], v[176:179]
ds_read_b64_tr_b16 v[104:105], v16 offset:7168
ds_read_b64_tr_b16 v[106:107], v16 offset:23552
v_mfma_f32_16x16x32_bf16 v[164:167], v[116:119], a[40:43], v[164:167]
v_rcp_f32 v74, v74
v_mfma_f32_16x16x32_bf16 v[180:183], v[116:119], a[44:47], v[180:183]
ds_read_b64_tr_b16 v[108:109], v17 offset:7168
ds_read_b64_tr_b16 v[110:111], v17 offset:23552
v_mfma_f32_16x16x32_bf16 v[168:171], v[120:123], a[40:43], v[168:171]
v_rcp_f32 v75, v75
v_mfma_f32_16x16x32_bf16 v[184:187], v[120:123], a[44:47], v[184:187]
v_mul_f32 v156, v156, v72
v_mul_f32 v157, v157, v73
v_mfma_f32_16x16x32_bf16 v[172:175], v[124:127], a[40:43], v[172:175]
v_mul_f32 v158, v158, v74
v_mul_f32 v159, v159, v75
v_mfma_f32_16x16x32_bf16 v[188:191], v[124:127], a[44:47], v[188:191]
s_waitcnt lgkmcnt(2)
v_mfma_f32_16x16x32_bf16 v[160:163], v[80:83], a[48:51], v[160:163]
s_waitcnt vmcnt(20) lgkmcnt(0)
s_barrier
v_mfma_f32_16x16x32_bf16 v[176:179], v[80:83], a[52:55], v[176:179]
ds_read_b64_tr_b16 v[112:113], v14 offset:32768
ds_read_b64_tr_b16 v[114:115], v14 offset:49152
v_mfma_f32_16x16x32_bf16 v[164:167], v[84:87], a[48:51], v[164:167]
ds_read_b64_tr_b16 v[116:117], v15 offset:32768
s_lshl_b32 s7, s82, 5
v_mfma_f32_16x16x32_bf16 v[180:183], v[84:87], a[52:55], v[180:183]
ds_read_b64_tr_b16 v[118:119], v15 offset:49152
ds_read_b64_tr_b16 v[120:121], v16 offset:32768
v_mfma_f32_16x16x32_bf16 v[168:171], v[88:91], a[48:51], v[168:171]
ds_read_b64_tr_b16 v[122:123], v16 offset:49152
s_add_u32 s7, s7, s4
v_mfma_f32_16x16x32_bf16 v[184:187], v[88:91], a[52:55], v[184:187]
ds_read_b64_tr_b16 v[124:125], v17 offset:32768
ds_read_b64_tr_b16 v[126:127], v17 offset:49152
v_mfma_f32_16x16x32_bf16 v[172:175], v[92:95], a[48:51], v[172:175]
ds_read_b64_tr_b16 v[80:81], v14 offset:33792
v_mul_f32 v192, v192, v128
v_mfma_f32_16x16x32_bf16 v[188:191], v[92:95], a[52:55], v[188:191]
ds_read_b64_tr_b16 v[82:83], v14 offset:50176
ds_read_b64_tr_b16 v[84:85], v15 offset:33792
v_mfma_f32_16x16x32_bf16 v[160:163], v[96:99], a[56:59], v[160:163]
ds_read_b64_tr_b16 v[86:87], v15 offset:50176
v_mul_f32 v193, v193, v129
v_mfma_f32_16x16x32_bf16 v[176:179], v[96:99], a[60:63], v[176:179]
ds_read_b64_tr_b16 v[88:89], v16 offset:33792
ds_read_b64_tr_b16 v[90:91], v16 offset:50176
v_mfma_f32_16x16x32_bf16 v[164:167], v[100:103], a[56:59], v[164:167]
ds_read_b64_tr_b16 v[92:93], v17 offset:33792
v_mul_f32 v194, v194, v130
v_mfma_f32_16x16x32_bf16 v[180:183], v[100:103], a[60:63], v[180:183]
ds_read_b64_tr_b16 v[94:95], v17 offset:50176
v_mul_f32 v195, v195, v131
v_mfma_f32_16x16x32_bf16 v[168:171], v[104:107], a[56:59], v[168:171]
ds_read_b64_tr_b16 v[96:97], v14 offset:34816
v_mul_f32 v196, v196, v132
v_mfma_f32_16x16x32_bf16 v[184:187], v[104:107], a[60:63], v[184:187]
ds_read_b64_tr_b16 v[98:99], v14 offset:51200
v_mul_f32 v197, v197, v133
v_mfma_f32_16x16x32_bf16 v[172:175], v[108:111], a[56:59], v[172:175]
ds_read_b64_tr_b16 v[100:101], v15 offset:34816
v_mul_f32 v198, v198, v134
v_mfma_f32_16x16x32_bf16 v[188:191], v[108:111], a[60:63], v[188:191]
ds_read_b64_tr_b16 v[102:103], v15 offset:51200
s_waitcnt lgkmcnt(6)
v_mfma_f32_16x16x32_bf16 v[160:163], v[112:115], a[64:67], v[160:163]
ds_read_b64_tr_b16 v[104:105], v16 offset:34816
v_mul_f32 v199, v199, v135
v_mfma_f32_16x16x32_bf16 v[176:179], v[112:115], a[68:71], v[176:179]
ds_read_b64_tr_b16 v[106:107], v16 offset:51200
v_cvt_pk_bf16_f32 v192, v192, v193
v_mfma_f32_16x16x32_bf16 v[164:167], v[116:119], a[64:67], v[164:167]
ds_read_b64_tr_b16 v[108:109], v17 offset:34816
v_cvt_pk_bf16_f32 v193, v194, v195
v_mfma_f32_16x16x32_bf16 v[180:183], v[116:119], a[68:71], v[180:183]
ds_read_b64_tr_b16 v[110:111], v17 offset:51200
v_cvt_pk_bf16_f32 v194, v196, v197
v_mfma_f32_16x16x32_bf16 v[168:171], v[120:123], a[64:67], v[168:171]
ds_read_b64_tr_b16 v[112:113], v14 offset:35840
v_cvt_pk_bf16_f32 v195, v198, v199
v_mfma_f32_16x16x32_bf16 v[184:187], v[120:123], a[68:71], v[184:187]
buffer_store_dwordx4 v[192:195], v46, s[60:63], s7 offen offset:0 sc1
v_mfma_f32_16x16x32_bf16 v[172:175], v[124:127], a[64:67], v[172:175]
ds_read_b64_tr_b16 v[114:115], v14 offset:52224
ds_read_b64_tr_b16 v[116:117], v15 offset:35840
v_mfma_f32_16x16x32_bf16 v[188:191], v[124:127], a[68:71], v[188:191]
ds_read_b64_tr_b16 v[118:119], v15 offset:52224
v_mul_f32 v200, v200, v136
v_mfma_f32_16x16x32_bf16 v[160:163], v[80:83], a[72:75], v[160:163]
ds_read_b64_tr_b16 v[120:121], v16 offset:35840
v_mul_f32 v201, v201, v137
v_mfma_f32_16x16x32_bf16 v[176:179], v[80:83], a[76:79], v[176:179]
ds_read_b64_tr_b16 v[122:123], v16 offset:52224
v_mul_f32 v202, v202, v138
v_mfma_f32_16x16x32_bf16 v[164:167], v[84:87], a[72:75], v[164:167]
ds_read_b64_tr_b16 v[124:125], v17 offset:35840
v_mul_f32 v203, v203, v139
v_mfma_f32_16x16x32_bf16 v[180:183], v[84:87], a[76:79], v[180:183]
ds_read_b64_tr_b16 v[126:127], v17 offset:52224
v_mul_f32 v204, v204, v140
v_mfma_f32_16x16x32_bf16 v[168:171], v[88:91], a[72:75], v[168:171]
ds_read_b64_tr_b16 v[80:81], v14 offset:36864
v_mul_f32 v205, v205, v141
v_mfma_f32_16x16x32_bf16 v[184:187], v[88:91], a[76:79], v[184:187]
ds_read_b64_tr_b16 v[82:83], v14 offset:53248
s_waitcnt lgkmcnt(6)
v_mfma_f32_16x16x32_bf16 v[172:175], v[92:95], a[72:75], v[172:175]
ds_read_b64_tr_b16 v[84:85], v15 offset:36864
v_mul_f32 v206, v206, v142
v_mfma_f32_16x16x32_bf16 v[188:191], v[92:95], a[76:79], v[188:191]
ds_read_b64_tr_b16 v[86:87], v15 offset:53248
v_mul_f32 v207, v207, v143
v_mfma_f32_16x16x32_bf16 v[160:163], v[96:99], a[80:83], v[160:163]
ds_read_b64_tr_b16 v[88:89], v16 offset:36864
v_cvt_pk_bf16_f32 v200, v200, v201
v_mfma_f32_16x16x32_bf16 v[176:179], v[96:99], a[84:87], v[176:179]
ds_read_b64_tr_b16 v[90:91], v16 offset:53248
v_cvt_pk_bf16_f32 v201, v202, v203
v_mfma_f32_16x16x32_bf16 v[164:167], v[100:103], a[80:83], v[164:167]
ds_read_b64_tr_b16 v[92:93], v17 offset:36864
v_cvt_pk_bf16_f32 v202, v204, v205
v_mfma_f32_16x16x32_bf16 v[180:183], v[100:103], a[84:87], v[180:183]
ds_read_b64_tr_b16 v[94:95], v17 offset:53248
v_cvt_pk_bf16_f32 v203, v206, v207
v_mfma_f32_16x16x32_bf16 v[168:171], v[104:107], a[80:83], v[168:171]
buffer_store_dwordx4 v[200:203], v46, s[60:63], s7 offen offset:2048 sc1
v_mfma_f32_16x16x32_bf16 v[184:187], v[104:107], a[84:87], v[184:187]
ds_read_b64_tr_b16 v[96:97], v14 offset:37888
ds_read_b64_tr_b16 v[98:99], v14 offset:54272
v_mfma_f32_16x16x32_bf16 v[172:175], v[108:111], a[80:83], v[172:175]
ds_read_b64_tr_b16 v[100:101], v15 offset:37888
v_mul_f32 v208, v208, v144
v_mfma_f32_16x16x32_bf16 v[188:191], v[108:111], a[84:87], v[188:191]
ds_read_b64_tr_b16 v[102:103], v15 offset:54272
v_mul_f32 v209, v209, v145
v_mfma_f32_16x16x32_bf16 v[160:163], v[112:115], a[88:91], v[160:163]
ds_read_b64_tr_b16 v[104:105], v16 offset:37888
v_mul_f32 v210, v210, v146
v_mfma_f32_16x16x32_bf16 v[176:179], v[112:115], a[92:95], v[176:179]
ds_read_b64_tr_b16 v[106:107], v16 offset:54272
v_mul_f32 v211, v211, v147
v_mfma_f32_16x16x32_bf16 v[164:167], v[116:119], a[88:91], v[164:167]
ds_read_b64_tr_b16 v[108:109], v17 offset:37888
v_mul_f32 v212, v212, v148
v_mfma_f32_16x16x32_bf16 v[180:183], v[116:119], a[92:95], v[180:183]
ds_read_b64_tr_b16 v[110:111], v17 offset:54272
s_waitcnt lgkmcnt(6)
v_mfma_f32_16x16x32_bf16 v[168:171], v[120:123], a[88:91], v[168:171]
ds_read_b64_tr_b16 v[112:113], v14 offset:38912
v_mul_f32 v213, v213, v149
v_mfma_f32_16x16x32_bf16 v[184:187], v[120:123], a[92:95], v[184:187]
ds_read_b64_tr_b16 v[114:115], v14 offset:55296
v_mul_f32 v214, v214, v150
v_mfma_f32_16x16x32_bf16 v[172:175], v[124:127], a[88:91], v[172:175]
ds_read_b64_tr_b16 v[116:117], v15 offset:38912
v_mul_f32 v215, v215, v151
v_mfma_f32_16x16x32_bf16 v[188:191], v[124:127], a[92:95], v[188:191]
ds_read_b64_tr_b16 v[118:119], v15 offset:55296
v_cvt_pk_bf16_f32 v208, v208, v209
v_mfma_f32_16x16x32_bf16 v[160:163], v[80:83], a[96:99], v[160:163]
ds_read_b64_tr_b16 v[120:121], v16 offset:38912
v_cvt_pk_bf16_f32 v209, v210, v211
v_mfma_f32_16x16x32_bf16 v[176:179], v[80:83], a[100:103], v[176:179]
ds_read_b64_tr_b16 v[122:123], v16 offset:55296
v_cvt_pk_bf16_f32 v210, v212, v213
v_mfma_f32_16x16x32_bf16 v[164:167], v[84:87], a[96:99], v[164:167]
ds_read_b64_tr_b16 v[124:125], v17 offset:38912
v_cvt_pk_bf16_f32 v211, v214, v215
v_mfma_f32_16x16x32_bf16 v[180:183], v[84:87], a[100:103], v[180:183]
buffer_store_dwordx4 v[208:211], v46, s[60:63], s7 offen offset:1024 sc1
v_mfma_f32_16x16x32_bf16 v[168:171], v[88:91], a[96:99], v[168:171]
ds_read_b64_tr_b16 v[126:127], v17 offset:55296
ds_read_b64_tr_b16 v[80:81], v14 offset:39936
v_mfma_f32_16x16x32_bf16 v[184:187], v[88:91], a[100:103], v[184:187]
ds_read_b64_tr_b16 v[82:83], v14 offset:56320
v_mul_f32 v216, v216, v152
v_mfma_f32_16x16x32_bf16 v[172:175], v[92:95], a[96:99], v[172:175]
ds_read_b64_tr_b16 v[84:85], v15 offset:39936
v_mul_f32 v217, v217, v153
v_mfma_f32_16x16x32_bf16 v[188:191], v[92:95], a[100:103], v[188:191]
ds_read_b64_tr_b16 v[86:87], v15 offset:56320
v_mul_f32 v218, v218, v154
v_mfma_f32_16x16x32_bf16 v[160:163], v[96:99], a[104:107], v[160:163]
ds_read_b64_tr_b16 v[88:89], v16 offset:39936
v_mul_f32 v219, v219, v155
v_mfma_f32_16x16x32_bf16 v[176:179], v[96:99], a[108:111], v[176:179]
ds_read_b64_tr_b16 v[90:91], v16 offset:56320
s_waitcnt lgkmcnt(7)
v_mfma_f32_16x16x32_bf16 v[164:167], v[100:103], a[104:107], v[164:167]
ds_read_b64_tr_b16 v[92:93], v17 offset:39936
s_add_u32 m0, s76, 65536
v_mfma_f32_16x16x32_bf16 v[180:183], v[100:103], a[108:111], v[180:183]
ds_read_b64_tr_b16 v[94:95], v17 offset:56320
s_add_u32 s77, s85, 0x380000
v_mfma_f32_16x16x32_bf16 v[168:171], v[104:107], a[104:107], v[168:171]
buffer_load_dwordx4 v34, s[52:55], s77 offen offset:0 lds
v_mfma_f32_16x16x32_bf16 v[184:187], v[104:107], a[108:111], v[184:187]
v_mul_f32 v220, v220, v156
v_mul_f32 v221, v221, v157
v_mfma_f32_16x16x32_bf16 v[172:175], v[108:111], a[104:107], v[172:175]
v_mul_f32 v222, v222, v158
v_mul_f32 v223, v223, v159
v_mfma_f32_16x16x32_bf16 v[188:191], v[108:111], a[108:111], v[188:191]
v_cvt_pk_bf16_f32 v216, v216, v217
v_cvt_pk_bf16_f32 v217, v218, v219
v_mfma_f32_16x16x32_bf16 v[160:163], v[112:115], a[112:115], v[160:163]
s_waitcnt vmcnt(15) lgkmcnt(0)
s_barrier
v_mfma_f32_16x16x32_bf16 v[176:179], v[112:115], a[116:119], v[176:179]
ds_read_b64_tr_b16 v[96:97], v10 offset:0
ds_read_b64_tr_b16 v[98:99], v10 offset:16384
v_mfma_f32_16x16x32_bf16 v[164:167], v[116:119], a[112:115], v[164:167]
ds_read_b64_tr_b16 v[100:101], v11 offset:0
v_cvt_pk_bf16_f32 v218, v220, v221
v_mfma_f32_16x16x32_bf16 v[180:183], v[116:119], a[116:119], v[180:183]
ds_read_b64_tr_b16 v[102:103], v11 offset:16384
ds_read_b64_tr_b16 v[104:105], v12 offset:0
v_mfma_f32_16x16x32_bf16 v[168:171], v[120:123], a[112:115], v[168:171]
buffer_load_dwordx4 v35, s[52:55], s77 offen offset:1024 lds
v_mfma_f32_16x16x32_bf16 v[184:187], v[120:123], a[116:119], v[184:187]
ds_read_b64_tr_b16 v[106:107], v12 offset:16384
ds_read_b64_tr_b16 v[108:109], v13 offset:0
v_mfma_f32_16x16x32_bf16 v[172:175], v[124:127], a[112:115], v[172:175]
ds_read_b64_tr_b16 v[110:111], v13 offset:16384
v_cvt_pk_bf16_f32 v219, v222, v223
v_mfma_f32_16x16x32_bf16 v[188:191], v[124:127], a[116:119], v[188:191]
buffer_store_dwordx4 v[216:219], v46, s[60:63], s7 offen offset:3072 sc1
v_mfma_f32_16x16x32_bf16 v[160:163], v[80:83], a[120:123], v[160:163]
ds_read_b64_tr_b16 v[112:113], v10 offset:1024
ds_read_b64_tr_b16 v[114:115], v10 offset:17408
v_mfma_f32_16x16x32_bf16 v[176:179], v[80:83], a[124:127], v[176:179]
buffer_load_dwordx4 v36, s[52:55], s77 offen offset:2048 lds
v_mfma_f32_16x16x32_bf16 v[164:167], v[84:87], a[120:123], v[164:167]
ds_read_b64_tr_b16 v[116:117], v11 offset:1024
ds_read_b64_tr_b16 v[118:119], v11 offset:17408
v_mfma_f32_16x16x32_bf16 v[180:183], v[84:87], a[124:127], v[180:183]
ds_read_b64_tr_b16 v[120:121], v12 offset:1024
v_mfma_f32_16x16x32_bf16 v[168:171], v[88:91], a[120:123], v[168:171]
ds_read_b64_tr_b16 v[122:123], v12 offset:17408
ds_read_b64_tr_b16 v[124:125], v13 offset:1024
v_mfma_f32_16x16x32_bf16 v[184:187], v[88:91], a[124:127], v[184:187]
ds_read_b64_tr_b16 v[126:127], v13 offset:17408
v_mfma_f32_16x16x32_bf16 v[172:175], v[92:95], a[120:123], v[172:175]
ds_read_b64_tr_b16 v[80:81], v10 offset:2048
ds_read_b64_tr_b16 v[82:83], v10 offset:18432
v_mfma_f32_16x16x32_bf16 v[188:191], v[92:95], a[124:127], v[188:191]
ds_read_b64_tr_b16 v[84:85], v11 offset:2048
s_waitcnt lgkmcnt(9)
v_mfma_f32_16x16x32_bf16 v[160:163], v[96:99], a[128:131], v[160:163]
ds_read_b64_tr_b16 v[86:87], v11 offset:18432
ds_read_b64_tr_b16 v[88:89], v12 offset:2048
v_mfma_f32_16x16x32_bf16 v[176:179], v[96:99], a[132:135], v[176:179]
ds_read_b64_tr_b16 v[90:91], v12 offset:18432
v_mfma_f32_16x16x32_bf16 v[164:167], v[100:103], a[128:131], v[164:167]
buffer_load_dwordx4 v37, s[52:55], s77 offen offset:3072 lds
v_mfma_f32_16x16x32_bf16 v[180:183], v[100:103], a[132:135], v[180:183]
ds_read_b64_tr_b16 v[92:93], v13 offset:2048
ds_read_b64_tr_b16 v[94:95], v13 offset:18432
v_mfma_f32_16x16x32_bf16 v[168:171], v[104:107], a[128:131], v[168:171]
ds_read_b64_tr_b16 v[96:97], v10 offset:3072
s_add_u32 m0, s76, 69632
v_mfma_f32_16x16x32_bf16 v[184:187], v[104:107], a[132:135], v[184:187]
ds_read_b64_tr_b16 v[98:99], v10 offset:19456
s_add_u32 s77, s85, 0x460000
v_mfma_f32_16x16x32_bf16 v[172:175], v[108:111], a[128:131], v[172:175]
ds_read_b64_tr_b16 v[100:101], v11 offset:3072
ds_read_b64_tr_b16 v[102:103], v11 offset:19456
v_mfma_f32_16x16x32_bf16 v[188:191], v[108:111], a[132:135], v[188:191]
ds_read_b64_tr_b16 v[104:105], v12 offset:3072
v_mfma_f32_16x16x32_bf16 v[160:163], v[112:115], a[136:139], v[160:163]
ds_read_b64_tr_b16 v[106:107], v12 offset:19456
ds_read_b64_tr_b16 v[108:109], v13 offset:3072
v_mfma_f32_16x16x32_bf16 v[176:179], v[112:115], a[140:143], v[176:179]
ds_read_b64_tr_b16 v[110:111], v13 offset:19456
s_waitcnt lgkmcnt(8)
v_mfma_f32_16x16x32_bf16 v[164:167], v[116:119], a[136:139], v[164:167]
ds_read_b64_tr_b16 v[112:113], v10 offset:4096
v_mfma_f32_16x16x32_bf16 v[180:183], v[116:119], a[140:143], v[180:183]
buffer_load_dwordx4 v34, s[52:55], s77 offen offset:0 lds
v_mfma_f32_16x16x32_bf16 v[168:171], v[120:123], a[136:139], v[168:171]
ds_read_b64_tr_b16 v[114:115], v10 offset:20480
ds_read_b64_tr_b16 v[116:117], v11 offset:4096
v_mfma_f32_16x16x32_bf16 v[184:187], v[120:123], a[140:143], v[184:187]
ds_read_b64_tr_b16 v[118:119], v11 offset:20480
v_mfma_f32_16x16x32_bf16 v[172:175], v[124:127], a[136:139], v[172:175]
ds_read_b64_tr_b16 v[120:121], v12 offset:4096
v_mfma_f32_16x16x32_bf16 v[188:191], v[124:127], a[140:143], v[188:191]
ds_read_b64_tr_b16 v[122:123], v12 offset:20480
v_mfma_f32_16x16x32_bf16 v[160:163], v[80:83], a[144:147], v[160:163]
ds_read_b64_tr_b16 v[124:125], v13 offset:4096
v_mfma_f32_16x16x32_bf16 v[176:179], v[80:83], a[148:151], v[176:179]
ds_read_b64_tr_b16 v[126:127], v13 offset:20480
v_mfma_f32_16x16x32_bf16 v[164:167], v[84:87], a[144:147], v[164:167]
ds_read_b64_tr_b16 v[80:81], v10 offset:5120
v_mfma_f32_16x16x32_bf16 v[180:183], v[84:87], a[148:151], v[180:183]
ds_read_b64_tr_b16 v[82:83], v10 offset:21504
v_mfma_f32_16x16x32_bf16 v[168:171], v[88:91], a[144:147], v[168:171]
buffer_load_dwordx4 v35, s[52:55], s77 offen offset:1024 lds
v_mfma_f32_16x16x32_bf16 v[184:187], v[88:91], a[148:151], v[184:187]
ds_read_b64_tr_b16 v[84:85], v11 offset:5120
ds_read_b64_tr_b16 v[86:87], v11 offset:21504
v_mfma_f32_16x16x32_bf16 v[172:175], v[92:95], a[144:147], v[172:175]
ds_read_b64_tr_b16 v[88:89], v12 offset:5120
v_mfma_f32_16x16x32_bf16 v[188:191], v[92:95], a[148:151], v[188:191]
ds_read_b64_tr_b16 v[90:91], v12 offset:21504
s_waitcnt lgkmcnt(6)
v_mfma_f32_16x16x32_bf16 v[160:163], v[96:99], a[152:155], v[160:163]
ds_read_b64_tr_b16 v[92:93], v13 offset:5120
v_mfma_f32_16x16x32_bf16 v[176:179], v[96:99], a[156:159], v[176:179]
ds_read_b64_tr_b16 v[94:95], v13 offset:21504
v_mfma_f32_16x16x32_bf16 v[164:167], v[100:103], a[152:155], v[164:167]
ds_read_b64_tr_b16 v[96:97], v10 offset:6144
v_mfma_f32_16x16x32_bf16 v[180:183], v[100:103], a[156:159], v[180:183]
ds_read_b64_tr_b16 v[98:99], v10 offset:22528
v_mfma_f32_16x16x32_bf16 v[168:171], v[104:107], a[152:155], v[168:171]
ds_read_b64_tr_b16 v[100:101], v11 offset:6144
v_mfma_f32_16x16x32_bf16 v[184:187], v[104:107], a[156:159], v[184:187]
buffer_load_dwordx4 v36, s[52:55], s77 offen offset:2048 lds
v_mfma_f32_16x16x32_bf16 v[172:175], v[108:111], a[152:155], v[172:175]
ds_read_b64_tr_b16 v[102:103], v11 offset:22528
ds_read_b64_tr_b16 v[104:105], v12 offset:6144
v_mfma_f32_16x16x32_bf16 v[188:191], v[108:111], a[156:159], v[188:191]
ds_read_b64_tr_b16 v[106:107], v12 offset:22528
v_mfma_f32_16x16x32_bf16 v[160:163], v[112:115], a[160:163], v[160:163]
ds_read_b64_tr_b16 v[108:109], v13 offset:6144
v_mfma_f32_16x16x32_bf16 v[176:179], v[112:115], a[164:167], v[176:179]
ds_read_b64_tr_b16 v[110:111], v13 offset:22528
v_mfma_f32_16x16x32_bf16 v[164:167], v[116:119], a[160:163], v[164:167]
ds_read_b64_tr_b16 v[112:113], v10 offset:7168
v_mfma_f32_16x16x32_bf16 v[180:183], v[116:119], a[164:167], v[180:183]
ds_read_b64_tr_b16 v[114:115], v10 offset:23552
v_mfma_f32_16x16x32_bf16 v[168:171], v[120:123], a[160:163], v[168:171]
ds_read_b64_tr_b16 v[116:117], v11 offset:7168
v_mfma_f32_16x16x32_bf16 v[184:187], v[120:123], a[164:167], v[184:187]
ds_read_b64_tr_b16 v[118:119], v11 offset:23552
v_mfma_f32_16x16x32_bf16 v[172:175], v[124:127], a[160:163], v[172:175]
buffer_load_dwordx4 v37, s[52:55], s77 offen offset:3072 lds
v_mfma_f32_16x16x32_bf16 v[188:191], v[124:127], a[164:167], v[188:191]
ds_read_b64_tr_b16 v[120:121], v12 offset:7168
s_waitcnt lgkmcnt(5)
v_mfma_f32_16x16x32_bf16 v[160:163], v[80:83], a[168:171], v[160:163]
ds_read_b64_tr_b16 v[122:123], v12 offset:23552
s_add_u32 m0, s76, 98304
v_mfma_f32_16x16x32_bf16 v[176:179], v[80:83], a[172:175], v[176:179]
ds_read_b64_tr_b16 v[124:125], v13 offset:7168
s_add_u32 s77, s84, 0x0
v_mfma_f32_16x16x32_bf16 v[164:167], v[84:87], a[168:171], v[164:167]
ds_read_b64_tr_b16 v[126:127], v13 offset:23552
v_mfma_f32_16x16x32_bf16 v[180:183], v[84:87], a[172:175], v[180:183]
v_mfma_f32_16x16x32_bf16 v[168:171], v[88:91], a[168:171], v[168:171]
v_mfma_f32_16x16x32_bf16 v[184:187], v[88:91], a[172:175], v[184:187]
v_mfma_f32_16x16x32_bf16 v[172:175], v[92:95], a[168:171], v[172:175]
v_mfma_f32_16x16x32_bf16 v[188:191], v[92:95], a[172:175], v[188:191]
s_waitcnt vmcnt(12) lgkmcnt(0)
s_barrier
v_mfma_f32_16x16x32_bf16 v[160:163], v[96:99], a[176:179], v[160:163]
ds_read_b64_tr_b16 v[80:81], v10 offset:32768
ds_read_b64_tr_b16 v[82:83], v10 offset:49152
v_mfma_f32_16x16x32_bf16 v[176:179], v[96:99], a[180:183], v[176:179]
buffer_load_dwordx4 v30, s[44:47], s77 offen offset:0 lds
v_mfma_f32_16x16x32_bf16 v[164:167], v[100:103], a[176:179], v[164:167]
ds_read_b64_tr_b16 v[84:85], v11 offset:32768
ds_read_b64_tr_b16 v[86:87], v11 offset:49152
v_mfma_f32_16x16x32_bf16 v[180:183], v[100:103], a[180:183], v[180:183]
ds_read_b64_tr_b16 v[88:89], v12 offset:32768
v_mfma_f32_16x16x32_bf16 v[168:171], v[104:107], a[176:179], v[168:171]
ds_read_b64_tr_b16 v[90:91], v12 offset:49152
ds_read_b64_tr_b16 v[92:93], v13 offset:32768
v_mfma_f32_16x16x32_bf16 v[184:187], v[104:107], a[180:183], v[184:187]
buffer_load_dwordx4 v31, s[44:47], s77 offen offset:1024 lds
v_mfma_f32_16x16x32_bf16 v[172:175], v[108:111], a[176:179], v[172:175]
ds_read_b64_tr_b16 v[94:95], v13 offset:49152
ds_read_b64_tr_b16 v[96:97], v10 offset:33792
v_mfma_f32_16x16x32_bf16 v[188:191], v[108:111], a[180:183], v[188:191]
ds_read_b64_tr_b16 v[98:99], v10 offset:50176
v_mfma_f32_16x16x32_bf16 v[160:163], v[112:115], a[184:187], v[160:163]
ds_read_b64_tr_b16 v[100:101], v11 offset:33792
ds_read_b64_tr_b16 v[102:103], v11 offset:50176
v_mfma_f32_16x16x32_bf16 v[176:179], v[112:115], a[188:191], v[176:179]
buffer_load_dwordx4 v32, s[44:47], s77 offen offset:2048 lds
v_mfma_f32_16x16x32_bf16 v[164:167], v[116:119], a[184:187], v[164:167]
ds_read_b64_tr_b16 v[104:105], v12 offset:33792
ds_read_b64_tr_b16 v[106:107], v12 offset:50176
v_mfma_f32_16x16x32_bf16 v[180:183], v[116:119], a[188:191], v[180:183]
ds_read_b64_tr_b16 v[108:109], v13 offset:33792
v_mfma_f32_16x16x32_bf16 v[168:171], v[120:123], a[184:187], v[168:171]
ds_read_b64_tr_b16 v[110:111], v13 offset:50176
ds_read_b64_tr_b16 v[112:113], v10 offset:34816
v_mfma_f32_16x16x32_bf16 v[184:187], v[120:123], a[188:191], v[184:187]
buffer_load_dwordx4 v33, s[44:47], s77 offen offset:3072 lds
v_mfma_f32_16x16x32_bf16 v[172:175], v[124:127], a[184:187], v[172:175]
ds_read_b64_tr_b16 v[114:115], v10 offset:51200
ds_read_b64_tr_b16 v[116:117], v11 offset:34816
v_mfma_f32_16x16x32_bf16 v[188:191], v[124:127], a[188:191], v[188:191]
ds_read_b64_tr_b16 v[118:119], v11 offset:51200
s_waitcnt lgkmcnt(8)
v_mfma_f32_16x16x32_bf16 v[160:163], v[80:83], a[192:195], v[160:163]
ds_read_b64_tr_b16 v[120:121], v12 offset:34816
s_add_u32 m0, s76, 102400
v_mfma_f32_16x16x32_bf16 v[176:179], v[80:83], a[196:199], v[176:179]
ds_read_b64_tr_b16 v[122:123], v12 offset:51200
s_add_u32 s77, s84, 0xe0000
v_mfma_f32_16x16x32_bf16 v[164:167], v[84:87], a[192:195], v[164:167]
buffer_load_dwordx4 v30, s[44:47], s77 offen offset:0 lds
v_mfma_f32_16x16x32_bf16 v[180:183], v[84:87], a[196:199], v[180:183]
ds_read_b64_tr_b16 v[124:125], v13 offset:34816
ds_read_b64_tr_b16 v[126:127], v13 offset:51200
v_mfma_f32_16x16x32_bf16 v[168:171], v[88:91], a[192:195], v[168:171]
ds_read_b64_tr_b16 v[80:81], v10 offset:35840
v_mfma_f32_16x16x32_bf16 v[184:187], v[88:91], a[196:199], v[184:187]
ds_read_b64_tr_b16 v[82:83], v10 offset:52224
ds_read_b64_tr_b16 v[84:85], v11 offset:35840
v_mfma_f32_16x16x32_bf16 v[172:175], v[92:95], a[192:195], v[172:175]
buffer_load_dwordx4 v31, s[44:47], s77 offen offset:1024 lds
v_mfma_f32_16x16x32_bf16 v[188:191], v[92:95], a[196:199], v[188:191]
ds_read_b64_tr_b16 v[86:87], v11 offset:52224
ds_read_b64_tr_b16 v[88:89], v12 offset:35840
v_mfma_f32_16x16x32_bf16 v[160:163], v[96:99], a[200:203], v[160:163]
ds_read_b64_tr_b16 v[90:91], v12 offset:52224
v_mfma_f32_16x16x32_bf16 v[176:179], v[96:99], a[204:207], v[176:179]
ds_read_b64_tr_b16 v[92:93], v13 offset:35840
ds_read_b64_tr_b16 v[94:95], v13 offset:52224
v_mfma_f32_16x16x32_bf16 v[164:167], v[100:103], a[200:203], v[164:167]
buffer_load_dwordx4 v32, s[44:47], s77 offen offset:2048 lds
v_mfma_f32_16x16x32_bf16 v[180:183], v[100:103], a[204:207], v[180:183]
ds_read_b64_tr_b16 v[96:97], v10 offset:36864
s_waitcnt lgkmcnt(6)
v_mfma_f32_16x16x32_bf16 v[168:171], v[104:107], a[200:203], v[168:171]
ds_read_b64_tr_b16 v[98:99], v10 offset:53248
ds_read_b64_tr_b16 v[100:101], v11 offset:36864
v_mfma_f32_16x16x32_bf16 v[184:187], v[104:107], a[204:207], v[184:187]
ds_read_b64_tr_b16 v[102:103], v11 offset:53248
v_mfma_f32_16x16x32_bf16 v[172:175], v[108:111], a[200:203], v[172:175]
buffer_load_dwordx4 v33, s[44:47], s77 offen offset:3072 lds
v_mfma_f32_16x16x32_bf16 v[188:191], v[108:111], a[204:207], v[188:191]
ds_read_b64_tr_b16 v[104:105], v12 offset:36864
s_add_u32 m0, s76, 0
v_mfma_f32_16x16x32_bf16 v[160:163], v[112:115], a[208:211], v[160:163]
ds_read_b64_tr_b16 v[106:107], v12 offset:53248
s_add_u32 s77, s84, 0x1c0000
v_mfma_f32_16x16x32_bf16 v[176:179], v[112:115], a[212:215], v[176:179]
ds_read_b64_tr_b16 v[108:109], v13 offset:36864
ds_read_b64_tr_b16 v[110:111], v13 offset:53248
v_mfma_f32_16x16x32_bf16 v[164:167], v[116:119], a[208:211], v[164:167]
ds_read_b64_tr_b16 v[112:113], v10 offset:37888
v_mfma_f32_16x16x32_bf16 v[180:183], v[116:119], a[212:215], v[180:183]
buffer_load_dwordx4 v30, s[44:47], s77 offen offset:0 lds
v_mfma_f32_16x16x32_bf16 v[168:171], v[120:123], a[208:211], v[168:171]
ds_read_b64_tr_b16 v[114:115], v10 offset:54272
ds_read_b64_tr_b16 v[116:117], v11 offset:37888
v_mfma_f32_16x16x32_bf16 v[184:187], v[120:123], a[212:215], v[184:187]
ds_read_b64_tr_b16 v[118:119], v11 offset:54272
v_mfma_f32_16x16x32_bf16 v[172:175], v[124:127], a[208:211], v[172:175]
ds_read_b64_tr_b16 v[120:121], v12 offset:37888
v_mfma_f32_16x16x32_bf16 v[188:191], v[124:127], a[212:215], v[188:191]
buffer_load_dwordx4 v31, s[44:47], s77 offen offset:1024 lds
v_mfma_f32_16x16x32_bf16 v[160:163], v[80:83], a[216:219], v[160:163]
ds_read_b64_tr_b16 v[122:123], v12 offset:54272
ds_read_b64_tr_b16 v[124:125], v13 offset:37888
v_mfma_f32_16x16x32_bf16 v[176:179], v[80:83], a[220:223], v[176:179]
ds_read_b64_tr_b16 v[126:127], v13 offset:54272
s_waitcnt lgkmcnt(7)
v_mfma_f32_16x16x32_bf16 v[164:167], v[84:87], a[216:219], v[164:167]
ds_read_b64_tr_b16 v[80:81], v10 offset:38912
v_mfma_f32_16x16x32_bf16 v[180:183], v[84:87], a[220:223], v[180:183]
ds_read_b64_tr_b16 v[82:83], v10 offset:55296
v_mfma_f32_16x16x32_bf16 v[168:171], v[88:91], a[216:219], v[168:171]
buffer_load_dwordx4 v32, s[44:47], s77 offen offset:2048 lds
v_mfma_f32_16x16x32_bf16 v[184:187], v[88:91], a[220:223], v[184:187]
ds_read_b64_tr_b16 v[84:85], v11 offset:38912
ds_read_b64_tr_b16 v[86:87], v11 offset:55296
v_mfma_f32_16x16x32_bf16 v[172:175], v[92:95], a[216:219], v[172:175]
ds_read_b64_tr_b16 v[88:89], v12 offset:38912
v_mfma_f32_16x16x32_bf16 v[188:191], v[92:95], a[220:223], v[188:191]
ds_read_b64_tr_b16 v[90:91], v12 offset:55296
v_mfma_f32_16x16x32_bf16 v[160:163], v[96:99], a[224:227], v[160:163]
buffer_load_dwordx4 v33, s[44:47], s77 offen offset:3072 lds
v_mfma_f32_16x16x32_bf16 v[176:179], v[96:99], a[228:231], v[176:179]
ds_read_b64_tr_b16 v[92:93], v13 offset:38912
s_add_u32 m0, s76, 4096
v_mfma_f32_16x16x32_bf16 v[164:167], v[100:103], a[224:227], v[164:167]
ds_read_b64_tr_b16 v[94:95], v13 offset:55296
s_add_u32 s77, s84, 0x2a0000
v_mfma_f32_16x16x32_bf16 v[180:183], v[100:103], a[228:231], v[180:183]
ds_read_b64_tr_b16 v[96:97], v10 offset:39936
ds_read_b64_tr_b16 v[98:99], v10 offset:56320
v_mfma_f32_16x16x32_bf16 v[168:171], v[104:107], a[224:227], v[168:171]
ds_read_b64_tr_b16 v[100:101], v11 offset:39936
v_mfma_f32_16x16x32_bf16 v[184:187], v[104:107], a[228:231], v[184:187]
buffer_load_dwordx4 v30, s[44:47], s77 offen offset:0 lds
v_mfma_f32_16x16x32_bf16 v[172:175], v[108:111], a[224:227], v[172:175]
ds_read_b64_tr_b16 v[102:103], v11 offset:56320
ds_read_b64_tr_b16 v[104:105], v12 offset:39936
v_mfma_f32_16x16x32_bf16 v[188:191], v[108:111], a[228:231], v[188:191]
ds_read_b64_tr_b16 v[106:107], v12 offset:56320
s_waitcnt lgkmcnt(7)
v_mfma_f32_16x16x32_bf16 v[160:163], v[112:115], a[232:235], v[160:163]
ds_read_b64_tr_b16 v[108:109], v13 offset:39936
v_mfma_f32_16x16x32_bf16 v[176:179], v[112:115], a[236:239], v[176:179]
buffer_load_dwordx4 v31, s[44:47], s77 offen offset:1024 lds
v_mfma_f32_16x16x32_bf16 v[164:167], v[116:119], a[232:235], v[164:167]
ds_read_b64_tr_b16 v[110:111], v13 offset:56320
v_mfma_f32_16x16x32_bf16 v[180:183], v[116:119], a[236:239], v[180:183]
v_mfma_f32_16x16x32_bf16 v[168:171], v[120:123], a[232:235], v[168:171]
v_mfma_f32_16x16x32_bf16 v[184:187], v[120:123], a[236:239], v[184:187]
v_mfma_f32_16x16x32_bf16 v[172:175], v[124:127], a[232:235], v[172:175]
buffer_load_dwordx4 v32, s[44:47], s77 offen offset:2048 lds
v_mfma_f32_16x16x32_bf16 v[188:191], v[124:127], a[236:239], v[188:191]
s_waitcnt vmcnt(15) lgkmcnt(0)
s_barrier
v_mfma_f32_16x16x32_bf16 v[160:163], v[80:83], a[240:243], v[160:163]
ds_read_b64_tr_b16 v[112:113], v20 offset:0
ds_read_b64_tr_b16 v[114:115], v20 offset:8192
v_mfma_f32_16x16x32_bf16 v[176:179], v[80:83], a[244:247], v[176:179]
ds_read_b64_tr_b16 v[116:117], v21 offset:0
v_mfma_f32_16x16x32_bf16 v[164:167], v[84:87], a[240:243], v[164:167]
buffer_load_dwordx4 v33, s[44:47], s77 offen offset:3072 lds
v_mfma_f32_16x16x32_bf16 v[180:183], v[84:87], a[244:247], v[180:183]
ds_read_b64_tr_b16 v[118:119], v21 offset:8192
ds_read_b64_tr_b16 v[120:121], v20 offset:16384
v_mfma_f32_16x16x32_bf16 v[168:171], v[88:91], a[240:243], v[168:171]
ds_read_b64_tr_b16 v[122:123], v20 offset:24576
s_add_u32 m0, s76, 32768
v_mfma_f32_16x16x32_bf16 v[184:187], v[88:91], a[244:247], v[184:187]
ds_read_b64_tr_b16 v[124:125], v21 offset:16384
s_add_u32 s77, s84, 0x380000
v_mfma_f32_16x16x32_bf16 v[172:175], v[92:95], a[240:243], v[172:175]
ds_read_b64_tr_b16 v[126:127], v21 offset:24576
ds_read_b64_tr_b16 v[80:81], v20 offset:1024
v_mfma_f32_16x16x32_bf16 v[188:191], v[92:95], a[244:247], v[188:191]
buffer_load_dwordx4 v30, s[44:47], s77 offen offset:0 lds
v_mfma_f32_16x16x32_bf16 v[160:163], v[96:99], a[248:251], v[160:163]
ds_read_b64_tr_b16 v[82:83], v20 offset:9216
ds_read_b64_tr_b16 v[84:85], v21 offset:1024
v_mfma_f32_16x16x32_bf16 v[176:179], v[96:99], a[252:255], v[176:179]
ds_read_b64_tr_b16 v[86:87], v21 offset:9216
v_mfma_f32_16x16x32_bf16 v[164:167], v[100:103], a[248:251], v[164:167]
ds_read_b64_tr_b16 v[88:89], v20 offset:17408
ds_read_b64_tr_b16 v[90:91], v20 offset:25600
v_mfma_f32_16x16x32_bf16 v[180:183], v[100:103], a[252:255], v[180:183]
buffer_load_dwordx4 v31, s[44:47], s77 offen offset:1024 lds
v_mfma_f32_16x16x32_bf16 v[168:171], v[104:107], a[248:251], v[168:171]
ds_read_b64_tr_b16 v[92:93], v21 offset:17408
ds_read_b64_tr_b16 v[94:95], v21 offset:25600
v_mfma_f32_16x16x32_bf16 v[184:187], v[104:107], a[252:255], v[184:187]
ds_read_b64_tr_b16 v[96:97], v20 offset:2048
v_mfma_f32_16x16x32_bf16 v[172:175], v[108:111], a[248:251], v[172:175]
ds_read_b64_tr_b16 v[98:99], v20 offset:10240
ds_read_b64_tr_b16 v[100:101], v21 offset:2048
v_mfma_f32_16x16x32_bf16 v[188:191], v[108:111], a[252:255], v[188:191]
ds_read_b64_tr_b16 v[102:103], v21 offset:10240
S_H2:
s_waitcnt lgkmcnt(8)
v_mfma_f32_16x16x32_bf16 v[224:227], v[112:115], a[128:131], v[224:227]
buffer_load_dwordx4 v32, s[44:47], s77 offen offset:2048 lds
v_mfma_f32_16x16x32_bf16 v[240:243], v[112:115], a[132:135], v[240:243]
ds_read_b64_tr_b16 v[104:105], v20 offset:18432
ds_read_b64_tr_b16 v[106:107], v20 offset:26624
v_mfma_f32_16x16x32_bf16 v[228:231], v[116:119], a[128:131], v[228:231]
ds_read_b64_tr_b16 v[108:109], v21 offset:18432
v_mfma_f32_16x16x32_bf16 v[244:247], v[116:119], a[132:135], v[244:247]
ds_read_b64_tr_b16 v[110:111], v21 offset:26624
v_mul_f32 v68, v60, v160
v_mfma_f32_16x16x32_bf16 v[232:235], v[120:123], a[128:131], v[232:235]
buffer_load_dwordx4 v33, s[44:47], s77 offen offset:3072 lds
v_mfma_f32_16x16x32_bf16 v[248:251], v[120:123], a[132:135], v[248:251]
ds_read_b64_tr_b16 v[112:113], v20 offset:3072
ds_read_b64_tr_b16 v[114:115], v20 offset:11264
v_mfma_f32_16x16x32_bf16 v[236:239], v[124:127], a[128:131], v[236:239]
ds_read_b64_tr_b16 v[116:117], v21 offset:3072
s_add_u32 m0, s76, 36864
v_mfma_f32_16x16x32_bf16 v[252:255], v[124:127], a[132:135], v[252:255]
ds_read_b64_tr_b16 v[118:119], v21 offset:11264
s_add_u32 s77, s84, 0x460000
v_mfma_f32_16x16x32_bf16 v[224:227], v[80:83], a[136:139], v[224:227]
ds_read_b64_tr_b16 v[120:121], v20 offset:19456
v_mul_f32 v69, v60, v161
v_mfma_f32_16x16x32_bf16 v[240:243], v[80:83], a[140:143], v[240:243]
buffer_load_dwordx4 v30, s[44:47], s77 offen offset:0 lds
v_mfma_f32_16x16x32_bf16 v[228:231], v[84:87], a[136:139], v[228:231]
ds_read_b64_tr_b16 v[122:123], v20 offset:27648
ds_read_b64_tr_b16 v[124:125], v21 offset:19456
v_mfma_f32_16x16x32_bf16 v[244:247], v[84:87], a[140:143], v[244:247]
ds_read_b64_tr_b16 v[126:127], v21 offset:27648
s_waitcnt lgkmcnt(6)
v_mfma_f32_16x16x32_bf16 v[232:235], v[88:91], a[136:139], v[232:235]
ds_read_b64_tr_b16 v[80:81], v20 offset:4096
v_mul_f32 v70, v60, v162
v_mfma_f32_16x16x32_bf16 v[248:251], v[88:91], a[140:143], v[248:251]
buffer_load_dwordx4 v31, s[44:47], s77 offen offset:1024 lds
v_mfma_f32_16x16x32_bf16 v[236:239], v[92:95], a[136:139], v[236:239]
ds_read_b64_tr_b16 v[82:83], v20 offset:12288
ds_read_b64_tr_b16 v[84:85], v21 offset:4096
v_mfma_f32_16x16x32_bf16 v[252:255], v[92:95], a[140:143], v[252:255]
ds_read_b64_tr_b16 v[86:87], v21 offset:12288
v_mul_f32 v71, v60, v163
v_mfma_f32_16x16x32_bf16 v[224:227], v[96:99], a[144:147], v[224:227]
v_exp_f32 v68, v68
v_mfma_f32_16x16x32_bf16 v[240:243], v[96:99], a[148:151], v[240:243]
ds_read_b64_tr_b16 v[88:89], v20 offset:20480
ds_read_b64_tr_b16 v[90:91], v20 offset:28672
v_mfma_f32_16x16x32_bf16 v[228:231], v[100:103], a[144:147], v[228:231]
buffer_load_dwordx4 v32, s[44:47], s77 offen offset:2048 lds
v_mfma_f32_16x16x32_bf16 v[244:247], v[100:103], a[148:151], v[244:247]
ds_read_b64_tr_b16 v[92:93], v21 offset:20480
ds_read_b64_tr_b16 v[94:95], v21 offset:28672
v_mfma_f32_16x16x32_bf16 v[232:235], v[104:107], a[144:147], v[232:235]
v_exp_f32 v69, v69
v_mfma_f32_16x16x32_bf16 v[248:251], v[104:107], a[148:151], v[248:251]
ds_read_b64_tr_b16 v[96:97], v20 offset:5120
ds_read_b64_tr_b16 v[98:99], v20 offset:13312
v_mfma_f32_16x16x32_bf16 v[236:239], v[108:111], a[144:147], v[236:239]
buffer_load_dwordx4 v33, s[44:47], s77 offen offset:3072 lds
v_mfma_f32_16x16x32_bf16 v[252:255], v[108:111], a[148:151], v[252:255]
ds_read_b64_tr_b16 v[100:101], v21 offset:5120
ds_read_b64_tr_b16 v[102:103], v21 offset:13312
v_mfma_f32_16x16x32_bf16 v[224:227], v[112:115], a[152:155], v[224:227]
v_exp_f32 v70, v70
v_mfma_f32_16x16x32_bf16 v[240:243], v[112:115], a[156:159], v[240:243]
ds_read_b64_tr_b16 v[104:105], v20 offset:21504
s_waitcnt lgkmcnt(5)
v_mfma_f32_16x16x32_bf16 v[228:231], v[116:119], a[152:155], v[228:231]
v_exp_f32 v71, v71
v_mfma_f32_16x16x32_bf16 v[244:247], v[116:119], a[156:159], v[244:247]
ds_read_b64_tr_b16 v[106:107], v20 offset:29696
ds_read_b64_tr_b16 v[108:109], v21 offset:21504
v_mfma_f32_16x16x32_bf16 v[232:235], v[120:123], a[152:155], v[232:235]
s_add_u32 s70, s0, S_H3 - K_pc + 0
s_addc_u32 s71, s1, 0
global_load_dword v57, v9, s[70:71]
v_mfma_f32_16x16x32_bf16 v[248:251], v[120:123], a[156:159], v[248:251]
ds_read_b64_tr_b16 v[110:111], v21 offset:29696
ds_read_b64_tr_b16 v[112:113], v20 offset:6144
v_mfma_f32_16x16x32_bf16 v[236:239], v[124:127], a[152:155], v[236:239]
ds_read_b64_tr_b16 v[114:115], v20 offset:14336
s_mul_i32 s3, s101, 7168
v_mfma_f32_16x16x32_bf16 v[252:255], v[124:127], a[156:159], v[252:255]
ds_read_b64_tr_b16 v[116:117], v21 offset:6144
ds_read_b64_tr_b16 v[118:119], v21 offset:14336
v_mfma_f32_16x16x32_bf16 v[224:227], v[80:83], a[160:163], v[224:227]
ds_read_b64_tr_b16 v[120:121], v20 offset:22528
s_add_u32 s3, s3, 0x1000
v_mfma_f32_16x16x32_bf16 v[240:243], v[80:83], a[164:167], v[240:243]
buffer_load_dword v57, v8, s[44:47], s3 offen
v_mfma_f32_16x16x32_bf16 v[228:231], v[84:87], a[160:163], v[228:231]
ds_read_b64_tr_b16 v[122:123], v20 offset:30720
ds_read_b64_tr_b16 v[124:125], v21 offset:22528
v_mfma_f32_16x16x32_bf16 v[244:247], v[84:87], a[164:167], v[244:247]
ds_read_b64_tr_b16 v[126:127], v21 offset:30720
s_mul_i32 s3, s101, 1024
v_mfma_f32_16x16x32_bf16 v[232:235], v[88:91], a[160:163], v[232:235]
ds_read_b64_tr_b16 v[80:81], v20 offset:7168
s_add_u32 s3, s3, 0x500000
v_mfma_f32_16x16x32_bf16 v[248:251], v[88:91], a[164:167], v[248:251]
buffer_load_dword v57, v50, s[48:51], s3 offen
v_mfma_f32_16x16x32_bf16 v[236:239], v[92:95], a[160:163], v[236:239]
ds_read_b64_tr_b16 v[82:83], v20 offset:15360
ds_read_b64_tr_b16 v[84:85], v21 offset:7168
v_mfma_f32_16x16x32_bf16 v[252:255], v[92:95], a[164:167], v[252:255]
ds_read_b64_tr_b16 v[86:87], v21 offset:15360
s_waitcnt lgkmcnt(7)
v_mfma_f32_16x16x32_bf16 v[224:227], v[96:99], a[168:171], v[224:227]
ds_read_b64_tr_b16 v[88:89], v20 offset:23552
s_mul_i32 s3, s101, 1024
v_mfma_f32_16x16x32_bf16 v[240:243], v[96:99], a[172:175], v[240:243]
ds_read_b64_tr_b16 v[90:91], v20 offset:31744
s_add_u32 s3, s3, 0x600000
v_mfma_f32_16x16x32_bf16 v[228:231], v[100:103], a[168:171], v[228:231]
buffer_load_dword v57, v50, s[48:51], s3 offen
v_mfma_f32_16x16x32_bf16 v[244:247], v[100:103], a[172:175], v[244:247]
ds_read_b64_tr_b16 v[92:93], v21 offset:23552
ds_read_b64_tr_b16 v[94:95], v21 offset:31744
v_mfma_f32_16x16x32_bf16 v[232:235], v[104:107], a[168:171], v[232:235]
v_fma_f32 v68, v68, v62, v62
v_fma_f32 v69, v69, v62, v62
v_mfma_f32_16x16x32_bf16 v[248:251], v[104:107], a[172:175], v[248:251]
v_fma_f32 v70, v70, v62, v62
v_fma_f32 v71, v71, v62, v62
v_mfma_f32_16x16x32_bf16 v[236:239], v[108:111], a[168:171], v[236:239]
v_rcp_f32 v68, v68
v_mfma_f32_16x16x32_bf16 v[252:255], v[108:111], a[172:175], v[252:255]
v_rcp_f32 v69, v69
v_mfma_f32_16x16x32_bf16 v[224:227], v[112:115], a[176:179], v[224:227]
s_waitcnt vmcnt(20) lgkmcnt(0)
s_barrier
v_mfma_f32_16x16x32_bf16 v[240:243], v[112:115], a[180:183], v[240:243]
ds_read_b64_tr_b16 v[96:97], v14 offset:32768
ds_read_b64_tr_b16 v[98:99], v14 offset:49152
v_mfma_f32_16x16x32_bf16 v[228:231], v[116:119], a[176:179], v[228:231]
ds_read_b64_tr_b16 v[100:101], v15 offset:32768
s_add_u32 m0, s76, 65536
v_mfma_f32_16x16x32_bf16 v[244:247], v[116:119], a[180:183], v[244:247]
ds_read_b64_tr_b16 v[102:103], v15 offset:49152
s_add_u32 s77, s84, 0x540000
v_mfma_f32_16x16x32_bf16 v[232:235], v[120:123], a[176:179], v[232:235]
ds_read_b64_tr_b16 v[104:105], v16 offset:32768
ds_read_b64_tr_b16 v[106:107], v16 offset:49152
v_mfma_f32_16x16x32_bf16 v[248:251], v[120:123], a[180:183], v[248:251]
buffer_load_dwordx4 v30, s[44:47], s77 offen offset:0 lds
v_mfma_f32_16x16x32_bf16 v[236:239], v[124:127], a[176:179], v[236:239]
ds_read_b64_tr_b16 v[108:109], v17 offset:32768
ds_read_b64_tr_b16 v[110:111], v17 offset:49152
v_mfma_f32_16x16x32_bf16 v[252:255], v[124:127], a[180:183], v[252:255]
v_rcp_f32 v70, v70
v_mfma_f32_16x16x32_bf16 v[224:227], v[80:83], a[184:187], v[224:227]
ds_read_b64_tr_b16 v[112:113], v14 offset:33792
ds_read_b64_tr_b16 v[114:115], v14 offset:50176
v_mfma_f32_16x16x32_bf16 v[240:243], v[80:83], a[188:191], v[240:243]
v_rcp_f32 v71, v71
v_mfma_f32_16x16x32_bf16 v[228:231], v[84:87], a[184:187], v[228:231]
ds_read_b64_tr_b16 v[116:117], v15 offset:33792
ds_read_b64_tr_b16 v[118:119], v15 offset:50176
v_mfma_f32_16x16x32_bf16 v[244:247], v[84:87], a[188:191], v[244:247]
buffer_load_dwordx4 v31, s[44:47], s77 offen offset:1024 lds
v_mfma_f32_16x16x32_bf16 v[232:235], v[88:91], a[184:187], v[232:235]
ds_read_b64_tr_b16 v[120:121], v16 offset:33792
ds_read_b64_tr_b16 v[122:123], v16 offset:50176
v_mfma_f32_16x16x32_bf16 v[248:251], v[88:91], a[188:191], v[248:251]
ds_read_b64_tr_b16 v[124:125], v17 offset:33792
v_mul_f32 v160, v160, v68
v_mfma_f32_16x16x32_bf16 v[236:239], v[92:95], a[184:187], v[236:239]
ds_read_b64_tr_b16 v[126:127], v17 offset:50176
ds_read_b64_tr_b16 v[80:81], v14 offset:34816
v_mfma_f32_16x16x32_bf16 v[252:255], v[92:95], a[188:191], v[252:255]
ds_read_b64_tr_b16 v[82:83], v14 offset:51200
s_waitcnt lgkmcnt(8)
v_mfma_f32_16x16x32_bf16 v[192:195], v[96:99], a[0:3], 0
ds_read_b64_tr_b16 v[84:85], v15 offset:34816
ds_read_b64_tr_b16 v[86:87], v15 offset:51200
v_mfma_f32_16x16x32_bf16 v[208:211], v[96:99], a[4:7], 0
buffer_load_dwordx4 v32, s[44:47], s77 offen offset:2048 lds
v_mfma_f32_16x16x32_bf16 v[196:199], v[100:103], a[0:3], 0
ds_read_b64_tr_b16 v[88:89], v16 offset:34816
ds_read_b64_tr_b16 v[90:91], v16 offset:51200
v_mfma_f32_16x16x32_bf16 v[212:215], v[100:103], a[4:7], 0
ds_read_b64_tr_b16 v[92:93], v17 offset:34816
v_mul_f32 v161, v161, v69
v_mfma_f32_16x16x32_bf16 v[200:203], v[104:107], a[0:3], 0
ds_read_b64_tr_b16 v[94:95], v17 offset:51200
ds_read_b64_tr_b16 v[96:97], v14 offset:35840
v_mfma_f32_16x16x32_bf16 v[216:219], v[104:107], a[4:7], 0
ds_read_b64_tr_b16 v[98:99], v14 offset:52224
v_mul_f32 v162, v162, v70
v_mfma_f32_16x16x32_bf16 v[204:207], v[108:111], a[0:3], 0
ds_read_b64_tr_b16 v[100:101], v15 offset:35840
v_mul_f32 v163, v163, v71
v_mfma_f32_16x16x32_bf16 v[220:223], v[108:111], a[4:7], 0
buffer_load_dwordx4 v33, s[44:47], s77 offen offset:3072 lds
v_mfma_f32_16x16x32_bf16 v[192:195], v[112:115], a[8:11], v[192:195]
ds_read_b64_tr_b16 v[102:103], v15 offset:52224
ds_read_b64_tr_b16 v[104:105], v16 offset:35840
v_mfma_f32_16x16x32_bf16 v[208:211], v[112:115], a[12:15], v[208:211]
ds_read_b64_tr_b16 v[106:107], v16 offset:52224
s_waitcnt lgkmcnt(7)
v_mfma_f32_16x16x32_bf16 v[196:199], v[116:119], a[8:11], v[196:199]
ds_read_b64_tr_b16 v[108:109], v17 offset:35840
s_add_u32 m0, s76, 69632
v_mfma_f32_16x16x32_bf16 v[212:215], v[116:119], a[12:15], v[212:215]
ds_read_b64_tr_b16 v[110:111], v17 offset:52224
s_add_u32 s77, s84, 0x620000
v_mfma_f32_16x16x32_bf16 v[200:203], v[120:123], a[8:11], v[200:203]
ds_read_b64_tr_b16 v[112:113], v14 offset:36864
v_mul_f32 v72, v60, v164
v_mfma_f32_16x16x32_bf16 v[216:219], v[120:123], a[12:15], v[216:219]
buffer_load_dwordx4 v30, s[44:47], s77 offen offset:0 lds
v_mfma_f32_16x16x32_bf16 v[204:207], v[124:127], a[8:11], v[204:207]
ds_read_b64_tr_b16 v[114:115], v14 offset:53248
ds_read_b64_tr_b16 v[116:117], v15 offset:36864
v_mfma_f32_16x16x32_bf16 v[220:223], v[124:127], a[12:15], v[220:223]
ds_read_b64_tr_b16 v[118:119], v15 offset:53248
v_mul_f32 v73, v60, v165
v_mfma_f32_16x16x32_bf16 v[192:195], v[80:83], a[16:19], v[192:195]
ds_read_b64_tr_b16 v[120:121], v16 offset:36864
v_mul_f32 v74, v60, v166
v_mfma_f32_16x16x32_bf16 v[208:211], v[80:83], a[20:23], v[208:211]
ds_read_b64_tr_b16 v[122:123], v16 offset:53248
v_mul_f32 v75, v60, v167
v_mfma_f32_16x16x32_bf16 v[196:199], v[84:87], a[16:19], v[196:199]
v_exp_f32 v72, v72
v_mfma_f32_16x16x32_bf16 v[212:215], v[84:87], a[20:23], v[212:215]
ds_read_b64_tr_b16 v[124:125], v17 offset:36864
ds_read_b64_tr_b16 v[126:127], v17 offset:53248
v_mfma_f32_16x16x32_bf16 v[200:203], v[88:91], a[16:19], v[200:203]
buffer_load_dwordx4 v31, s[44:47], s77 offen offset:1024 lds
v_mfma_f32_16x16x32_bf16 v[216:219], v[88:91], a[20:23], v[216:219]
ds_read_b64_tr_b16 v[80:81], v14 offset:37888
s_waitcnt lgkmcnt(5)
v_mfma_f32_16x16x32_bf16 v[204:207], v[92:95], a[16:19], v[204:207]
v_exp_f32 v73, v73
v_mfma_f32_16x16x32_bf16 v[220:223], v[92:95], a[20:23], v[220:223]
ds_read_b64_tr_b16 v[82:83], v14 offset:54272
ds_read_b64_tr_b16 v[84:85], v15 offset:37888
v_mfma_f32_16x16x32_bf16 v[192:195], v[96:99], a[24:27], v[192:195]
v_exp_f32 v74, v74
v_mfma_f32_16x16x32_bf16 v[208:211], v[96:99], a[28:31], v[208:211]
ds_read_b64_tr_b16 v[86:87], v15 offset:54272
ds_read_b64_tr_b16 v[88:89], v16 offset:37888
v_mfma_f32_16x16x32_bf16 v[196:199], v[100:103], a[24:27], v[196:199]
buffer_load_dwordx4 v32, s[44:47], s77 offen offset:2048 lds
v_mfma_f32_16x16x32_bf16 v[212:215], v[100:103], a[28:31], v[212:215]
ds_read_b64_tr_b16 v[90:91], v16 offset:54272
ds_read_b64_tr_b16 v[92:93], v17 offset:37888
v_mfma_f32_16x16x32_bf16 v[200:203], v[104:107], a[24:27], v[200:203]
v_exp_f32 v75, v75
v_mfma_f32_16x16x32_bf16 v[216:219], v[104:107], a[28:31], v[216:219]
ds_read_b64_tr_b16 v[94:95], v17 offset:54272
ds_read_b64_tr_b16 v[96:97], v14 offset:38912
v_mfma_f32_16x16x32_bf16 v[204:207], v[108:111], a[24:27], v[204:207]
ds_read_b64_tr_b16 v[98:99], v14 offset:55296
v_fma_f32 v72, v72, v62, v62
v_mfma_f32_16x16x32_bf16 v[220:223], v[108:111], a[28:31], v[220:223]
ds_read_b64_tr_b16 v[100:101], v15 offset:38912
ds_read_b64_tr_b16 v[102:103], v15 offset:55296
v_mfma_f32_16x16x32_bf16 v[192:195], v[112:115], a[32:35], v[192:195]
buffer_load_dwordx4 v33, s[44:47], s77 offen offset:3072 lds
v_mfma_f32_16x16x32_bf16 v[208:211], v[112:115], a[36:39], v[208:211]
ds_read_b64_tr_b16 v[104:105], v16 offset:38912
ds_read_b64_tr_b16 v[106:107], v16 offset:55296
v_mfma_f32_16x16x32_bf16 v[196:199], v[116:119], a[32:35], v[196:199]
ds_read_b64_tr_b16 v[108:109], v17 offset:38912
v_fma_f32 v73, v73, v62, v62
v_mfma_f32_16x16x32_bf16 v[212:215], v[116:119], a[36:39], v[212:215]
ds_read_b64_tr_b16 v[110:111], v17 offset:55296
s_waitcnt lgkmcnt(7)
v_mfma_f32_16x16x32_bf16 v[200:203], v[120:123], a[32:35], v[200:203]
ds_read_b64_tr_b16 v[112:113], v14 offset:39936
v_fma_f32 v74, v74, v62, v62
v_mfma_f32_16x16x32_bf16 v[216:219], v[120:123], a[36:39], v[216:219]
ds_read_b64_tr_b16 v[114:115], v14 offset:56320
v_fma_f32 v75, v75, v62, v62
v_mfma_f32_16x16x32_bf16 v[204:207], v[124:127], a[32:35], v[204:207]
v_rcp_f32 v72, v72
v_mfma_f32_16x16x32_bf16 v[220:223], v[124:127], a[36:39], v[220:223]
ds_read_b64_tr_b16 v[116:117], v15 offset:39936
ds_read_b64_tr_b16 v[118:119], v15 offset:56320
v_mfma_f32_16x16x32_bf16 v[192:195], v[80:83], a[40:43], v[192:195]
v_rcp_f32 v73, v73
v_mfma_f32_16x16x32_bf16 v[208:211], v[80:83], a[44:47], v[208:211]
ds_read_b64_tr_b16 v[120:121], v16 offset:39936
ds_read_b64_tr_b16 v[122:123], v16 offset:56320
v_mfma_f32_16x16x32_bf16 v[196:199], v[84:87], a[40:43], v[196:199]
v_rcp_f32 v74, v74
v_mfma_f32_16x16x32_bf16 v[212:215], v[84:87], a[44:47], v[212:215]
ds_read_b64_tr_b16 v[124:125], v17 offset:39936
ds_read_b64_tr_b16 v[126:127], v17 offset:56320
v_mfma_f32_16x16x32_bf16 v[200:203], v[88:91], a[40:43], v[200:203]
v_rcp_f32 v75, v75
v_mfma_f32_16x16x32_bf16 v[216:219], v[88:91], a[44:47], v[216:219]
v_mul_f32 v164, v164, v72
v_mul_f32 v165, v165, v73
v_mfma_f32_16x16x32_bf16 v[204:207], v[92:95], a[40:43], v[204:207]
v_mul_f32 v166, v166, v74
v_mul_f32 v167, v167, v75
v_mfma_f32_16x16x32_bf16 v[220:223], v[92:95], a[44:47], v[220:223]
v_mul_f32 v68, v60, v168
s_waitcnt lgkmcnt(2)
v_mfma_f32_16x16x32_bf16 v[192:195], v[96:99], a[48:51], v[192:195]
s_waitcnt vmcnt(20) lgkmcnt(0)
s_barrier
v_mfma_f32_16x16x32_bf16 v[208:211], v[96:99], a[52:55], v[208:211]
ds_read_b64_tr_b16 v[80:81], v10 offset:0
ds_read_b64_tr_b16 v[82:83], v10 offset:16384
v_mfma_f32_16x16x32_bf16 v[196:199], v[100:103], a[48:51], v[196:199]
ds_read_b64_tr_b16 v[84:85], v11 offset:0
v_mul_f32 v69, v60, v169
v_mfma_f32_16x16x32_bf16 v[212:215], v[100:103], a[52:55], v[212:215]
ds_read_b64_tr_b16 v[86:87], v11 offset:16384
ds_read_b64_tr_b16 v[88:89], v12 offset:0
v_mfma_f32_16x16x32_bf16 v[200:203], v[104:107], a[48:51], v[200:203]
ds_read_b64_tr_b16 v[90:91], v12 offset:16384
v_mul_f32 v70, v60, v170
v_mfma_f32_16x16x32_bf16 v[216:219], v[104:107], a[52:55], v[216:219]
ds_read_b64_tr_b16 v[92:93], v13 offset:0
ds_read_b64_tr_b16 v[94:95], v13 offset:16384
v_mfma_f32_16x16x32_bf16 v[204:207], v[108:111], a[48:51], v[204:207]
ds_read_b64_tr_b16 v[96:97], v10 offset:1024
v_mul_f32 v71, v60, v171
v_mfma_f32_16x16x32_bf16 v[220:223], v[108:111], a[52:55], v[220:223]
v_exp_f32 v68, v68
v_mfma_f32_16x16x32_bf16 v[192:195], v[112:115], a[56:59], v[192:195]
ds_read_b64_tr_b16 v[98:99], v10 offset:17408
ds_read_b64_tr_b16 v[100:101], v11 offset:1024
v_mfma_f32_16x16x32_bf16 v[208:211], v[112:115], a[60:63], v[208:211]
v_exp_f32 v69, v69
v_mfma_f32_16x16x32_bf16 v[196:199], v[116:119], a[56:59], v[196:199]
ds_read_b64_tr_b16 v[102:103], v11 offset:17408
ds_read_b64_tr_b16 v[104:105], v12 offset:1024
v_mfma_f32_16x16x32_bf16 v[212:215], v[116:119], a[60:63], v[212:215]
v_exp_f32 v70, v70
v_mfma_f32_16x16x32_bf16 v[200:203], v[120:123], a[56:59], v[200:203]
ds_read_b64_tr_b16 v[106:107], v12 offset:17408
ds_read_b64_tr_b16 v[108:109], v13 offset:1024
v_mfma_f32_16x16x32_bf16 v[216:219], v[120:123], a[60:63], v[216:219]
v_exp_f32 v71, v71
v_mfma_f32_16x16x32_bf16 v[204:207], v[124:127], a[56:59], v[204:207]
ds_read_b64_tr_b16 v[110:111], v13 offset:17408
ds_read_b64_tr_b16 v[112:113], v10 offset:2048
v_mfma_f32_16x16x32_bf16 v[220:223], v[124:127], a[60:63], v[220:223]
ds_read_b64_tr_b16 v[114:115], v10 offset:18432
s_waitcnt lgkmcnt(7)
v_mfma_f32_16x16x32_bf16 v[192:195], v[80:83], a[64:67], v[192:195]
ds_read_b64_tr_b16 v[116:117], v11 offset:2048
ds_read_b64_tr_b16 v[118:119], v11 offset:18432
v_mfma_f32_16x16x32_bf16 v[208:211], v[80:83], a[68:71], v[208:211]
ds_read_b64_tr_b16 v[120:121], v12 offset:2048
v_fma_f32 v68, v68, v62, v62
v_mfma_f32_16x16x32_bf16 v[196:199], v[84:87], a[64:67], v[196:199]
ds_read_b64_tr_b16 v[122:123], v12 offset:18432
ds_read_b64_tr_b16 v[124:125], v13 offset:2048
v_mfma_f32_16x16x32_bf16 v[212:215], v[84:87], a[68:71], v[212:215]
ds_read_b64_tr_b16 v[126:127], v13 offset:18432
v_fma_f32 v69, v69, v62, v62
v_mfma_f32_16x16x32_bf16 v[200:203], v[88:91], a[64:67], v[200:203]
ds_read_b64_tr_b16 v[80:81], v10 offset:3072
v_fma_f32 v70, v70, v62, v62
v_mfma_f32_16x16x32_bf16 v[216:219], v[88:91], a[68:71], v[216:219]
ds_read_b64_tr_b16 v[82:83], v10 offset:19456
v_fma_f32 v71, v71, v62, v62
v_mfma_f32_16x16x32_bf16 v[204:207], v[92:95], a[64:67], v[204:207]
v_rcp_f32 v68, v68
v_mfma_f32_16x16x32_bf16 v[220:223], v[92:95], a[68:71], v[220:223]
ds_read_b64_tr_b16 v[84:85], v11 offset:3072
ds_read_b64_tr_b16 v[86:87], v11 offset:19456
v_mfma_f32_16x16x32_bf16 v[192:195], v[96:99], a[72:75], v[192:195]
v_rcp_f32 v69, v69
v_mfma_f32_16x16x32_bf16 v[208:211], v[96:99], a[76:79], v[208:211]
ds_read_b64_tr_b16 v[88:89], v12 offset:3072
s_waitcnt lgkmcnt(5)
v_mfma_f32_16x16x32_bf16 v[196:199], v[100:103], a[72:75], v[196:199]
v_rcp_f32 v70, v70
v_mfma_f32_16x16x32_bf16 v[212:215], v[100:103], a[76:79], v[212:215]
ds_read_b64_tr_b16 v[90:91], v12 offset:19456
ds_read_b64_tr_b16 v[92:93], v13 offset:3072
v_mfma_f32_16x16x32_bf16 v[200:203], v[104:107], a[72:75], v[200:203]
v_rcp_f32 v71, v71
v_mfma_f32_16x16x32_bf16 v[216:219], v[104:107], a[76:79], v[216:219]
ds_read_b64_tr_b16 v[94:95], v13 offset:19456
ds_read_b64_tr_b16 v[96:97], v10 offset:4096
v_mfma_f32_16x16x32_bf16 v[204:207], v[108:111], a[72:75], v[204:207]
ds_read_b64_tr_b16 v[98:99], v10 offset:20480
v_mul_f32 v168, v168, v68
v_mfma_f32_16x16x32_bf16 v[220:223], v[108:111], a[76:79], v[220:223]
ds_read_b64_tr_b16 v[100:101], v11 offset:4096
ds_read_b64_tr_b16 v[102:103], v11 offset:20480
v_mfma_f32_16x16x32_bf16 v[192:195], v[112:115], a[80:83], v[192:195]
ds_read_b64_tr_b16 v[104:105], v12 offset:4096
v_mul_f32 v169, v169, v69
v_mfma_f32_16x16x32_bf16 v[208:211], v[112:115], a[84:87], v[208:211]
ds_read_b64_tr_b16 v[106:107], v12 offset:20480
v_mul_f32 v170, v170, v70
v_mfma_f32_16x16x32_bf16 v[196:199], v[116:119], a[80:83], v[196:199]
ds_read_b64_tr_b16 v[108:109], v13 offset:4096
v_mul_f32 v171, v171, v71
v_mfma_f32_16x16x32_bf16 v[212:215], v[116:119], a[84:87], v[212:215]
ds_read_b64_tr_b16 v[110:111], v13 offset:20480
v_mul_f32 v72, v60, v172
v_mfma_f32_16x16x32_bf16 v[200:203], v[120:123], a[80:83], v[200:203]
ds_read_b64_tr_b16 v[112:113], v10 offset:5120
v_mul_f32 v73, v60, v173
v_mfma_f32_16x16x32_bf16 v[216:219], v[120:123], a[84:87], v[216:219]
ds_read_b64_tr_b16 v[114:115], v10 offset:21504
v_mul_f32 v74, v60, v174
v_mfma_f32_16x16x32_bf16 v[204:207], v[124:127], a[80:83], v[204:207]
ds_read_b64_tr_b16 v[116:117], v11 offset:5120
v_mul_f32 v75, v60, v175
v_mfma_f32_16x16x32_bf16 v[220:223], v[124:127], a[84:87], v[220:223]
ds_read_b64_tr_b16 v[118:119], v11 offset:21504
s_waitcnt lgkmcnt(6)
v_mfma_f32_16x16x32_bf16 v[192:195], v[80:83], a[88:91], v[192:195]
v_exp_f32 v72, v72
v_mfma_f32_16x16x32_bf16 v[208:211], v[80:83], a[92:95], v[208:211]
ds_read_b64_tr_b16 v[120:121], v12 offset:5120
ds_read_b64_tr_b16 v[122:123], v12 offset:21504
v_mfma_f32_16x16x32_bf16 v[196:199], v[84:87], a[88:91], v[196:199]
v_exp_f32 v73, v73
v_mfma_f32_16x16x32_bf16 v[212:215], v[84:87], a[92:95], v[212:215]
ds_read_b64_tr_b16 v[124:125], v13 offset:5120
ds_read_b64_tr_b16 v[126:127], v13 offset:21504
v_mfma_f32_16x16x32_bf16 v[200:203], v[88:91], a[88:91], v[200:203]
v_exp_f32 v74, v74
v_mfma_f32_16x16x32_bf16 v[216:219], v[88:91], a[92:95], v[216:219]
ds_read_b64_tr_b16 v[80:81], v10 offset:6144
ds_read_b64_tr_b16 v[82:83], v10 offset:22528
v_mfma_f32_16x16x32_bf16 v[204:207], v[92:95], a[88:91], v[204:207]
v_exp_f32 v75, v75
v_mfma_f32_16x16x32_bf16 v[220:223], v[92:95], a[92:95], v[220:223]
ds_read_b64_tr_b16 v[84:85], v11 offset:6144
ds_read_b64_tr_b16 v[86:87], v11 offset:22528
v_mfma_f32_16x16x32_bf16 v[192:195], v[96:99], a[96:99], v[192:195]
ds_read_b64_tr_b16 v[88:89], v12 offset:6144
v_fma_f32 v72, v72, v62, v62
v_mfma_f32_16x16x32_bf16 v[208:211], v[96:99], a[100:103], v[208:211]
ds_read_b64_tr_b16 v[90:91], v12 offset:22528
v_fma_f32 v73, v73, v62, v62
v_mfma_f32_16x16x32_bf16 v[196:199], v[100:103], a[96:99], v[196:199]
ds_read_b64_tr_b16 v[92:93], v13 offset:6144
v_fma_f32 v74, v74, v62, v62
v_mfma_f32_16x16x32_bf16 v[212:215], v[100:103], a[100:103], v[212:215]
ds_read_b64_tr_b16 v[94:95], v13 offset:22528
s_add_u32 m0, s76, 98304
v_mfma_f32_16x16x32_bf16 v[200:203], v[104:107], a[96:99], v[200:203]
ds_read_b64_tr_b16 v[96:97], v10 offset:7168
s_add_u32 s77, s85, 0x540000
v_mfma_f32_16x16x32_bf16 v[216:219], v[104:107], a[100:103], v[216:219]
ds_read_b64_tr_b16 v[98:99], v10 offset:23552
s_waitcnt lgkmcnt(6)
v_mfma_f32_16x16x32_bf16 v[204:207], v[108:111], a[96:99], v[204:207]
buffer_load_dwordx4 v34, s[52:55], s77 offen offset:0 lds
v_mfma_f32_16x16x32_bf16 v[220:223], v[108:111], a[100:103], v[220:223]
ds_read_b64_tr_b16 v[100:101], v11 offset:7168
ds_read_b64_tr_b16 v[102:103], v11 offset:23552
v_mfma_f32_16x16x32_bf16 v[192:195], v[112:115], a[104:107], v[192:195]
ds_read_b64_tr_b16 v[104:105], v12 offset:7168
v_fma_f32 v75, v75, v62, v62
v_mfma_f32_16x16x32_bf16 v[208:211], v[112:115], a[108:111], v[208:211]
v_rcp_f32 v72, v72
v_mfma_f32_16x16x32_bf16 v[196:199], v[116:119], a[104:107], v[196:199]
ds_read_b64_tr_b16 v[106:107], v12 offset:23552
ds_read_b64_tr_b16 v[108:109], v13 offset:7168
v_mfma_f32_16x16x32_bf16 v[212:215], v[116:119], a[108:111], v[212:215]
buffer_load_dwordx4 v35, s[52:55], s77 offen offset:1024 lds
v_mfma_f32_16x16x32_bf16 v[200:203], v[120:123], a[104:107], v[200:203]
ds_read_b64_tr_b16 v[110:111], v13 offset:23552
v_mfma_f32_16x16x32_bf16 v[216:219], v[120:123], a[108:111], v[216:219]
v_rcp_f32 v73, v73
v_mfma_f32_16x16x32_bf16 v[204:207], v[124:127], a[104:107], v[204:207]
v_rcp_f32 v74, v74
v_mfma_f32_16x16x32_bf16 v[220:223], v[124:127], a[108:111], v[220:223]
buffer_load_dwordx4 v36, s[52:55], s77 offen offset:2048 lds
v_mfma_f32_16x16x32_bf16 v[192:195], v[80:83], a[112:115], v[192:195]
v_rcp_f32 v75, v75
v_mfma_f32_16x16x32_bf16 v[208:211], v[80:83], a[116:119], v[208:211]
s_waitcnt vmcnt(15) lgkmcnt(0)
s_barrier
v_mfma_f32_16x16x32_bf16 v[196:199], v[84:87], a[112:115], v[196:199]
ds_read_b64_tr_b16 v[112:113], v10 offset:32768
ds_read_b64_tr_b16 v[114:115], v10 offset:49152
v_mfma_f32_16x16x32_bf16 v[212:215], v[84:87], a[116:119], v[212:215]
ds_read_b64_tr_b16 v[116:117], v11 offset:32768
ds_read_b64_tr_b16 v[118:119], v11 offset:49152
v_mfma_f32_16x16x32_bf16 v[200:203], v[88:91], a[112:115], v[200:203]
ds_read_b64_tr_b16 v[120:121], v12 offset:32768
v_mul_f32 v172, v172, v72
v_mfma_f32_16x16x32_bf16 v[216:219], v[88:91], a[116:119], v[216:219]
ds_read_b64_tr_b16 v[122:123], v12 offset:49152
ds_read_b64_tr_b16 v[124:125], v13 offset:32768
v_mfma_f32_16x16x32_bf16 v[204:207], v[92:95], a[112:115], v[204:207]
ds_read_b64_tr_b16 v[126:127], v13 offset:49152
v_mul_f32 v173, v173, v73
v_mfma_f32_16x16x32_bf16 v[220:223], v[92:95], a[116:119], v[220:223]
buffer_load_dwordx4 v37, s[52:55], s77 offen offset:3072 lds
v_mfma_f32_16x16x32_bf16 v[192:195], v[96:99], a[120:123], v[192:195]
ds_read_b64_tr_b16 v[80:81], v10 offset:33792
ds_read_b64_tr_b16 v[82:83], v10 offset:50176
v_mfma_f32_16x16x32_bf16 v[208:211], v[96:99], a[124:127], v[208:211]
ds_read_b64_tr_b16 v[84:85], v11 offset:33792
s_add_u32 m0, s76, 102400
v_mfma_f32_16x16x32_bf16 v[196:199], v[100:103], a[120:123], v[196:199]
ds_read_b64_tr_b16 v[86:87], v11 offset:50176
s_add_u32 s77, s85, 0x620000
v_mfma_f32_16x16x32_bf16 v[212:215], v[100:103], a[124:127], v[212:215]
ds_read_b64_tr_b16 v[88:89], v12 offset:33792
ds_read_b64_tr_b16 v[90:91], v12 offset:50176
v_mfma_f32_16x16x32_bf16 v[200:203], v[104:107], a[120:123], v[200:203]
ds_read_b64_tr_b16 v[92:93], v13 offset:33792
v_mul_f32 v174, v174, v74
v_mfma_f32_16x16x32_bf16 v[216:219], v[104:107], a[124:127], v[216:219]
ds_read_b64_tr_b16 v[94:95], v13 offset:50176
ds_read_b64_tr_b16 v[96:97], v10 offset:34816
v_mfma_f32_16x16x32_bf16 v[204:207], v[108:111], a[120:123], v[204:207]
ds_read_b64_tr_b16 v[98:99], v10 offset:51200
v_mul_f32 v175, v175, v75
v_mfma_f32_16x16x32_bf16 v[220:223], v[108:111], a[124:127], v[220:223]
ds_read_b64_tr_b16 v[100:101], v11 offset:34816
s_waitcnt lgkmcnt(8)
v_mfma_f32_16x16x32_bf16 v[192:195], v[112:115], a[128:131], v[192:195]
buffer_load_dwordx4 v34, s[52:55], s77 offen offset:0 lds
v_mfma_f32_16x16x32_bf16 v[208:211], v[112:115], a[132:135], v[208:211]
ds_read_b64_tr_b16 v[102:103], v11 offset:51200
ds_read_b64_tr_b16 v[104:105], v12 offset:34816
v_mfma_f32_16x16x32_bf16 v[196:199], v[116:119], a[128:131], v[196:199]
ds_read_b64_tr_b16 v[106:107], v12 offset:51200
v_mul_f32 v68, v61, v176
v_mfma_f32_16x16x32_bf16 v[212:215], v[116:119], a[132:135], v[212:215]
ds_read_b64_tr_b16 v[108:109], v13 offset:34816
ds_read_b64_tr_b16 v[110:111], v13 offset:51200
v_mfma_f32_16x16x32_bf16 v[200:203], v[120:123], a[128:131], v[200:203]
ds_read_b64_tr_b16 v[112:113], v10 offset:35840
v_mul_f32 v69, v61, v177
v_mfma_f32_16x16x32_bf16 v[216:219], v[120:123], a[132:135], v[216:219]
ds_read_b64_tr_b16 v[114:115], v10 offset:52224
v_mul_f32 v70, v61, v178
v_mfma_f32_16x16x32_bf16 v[204:207], v[124:127], a[128:131], v[204:207]
ds_read_b64_tr_b16 v[116:117], v11 offset:35840
v_mul_f32 v71, v61, v179
v_mfma_f32_16x16x32_bf16 v[220:223], v[124:127], a[132:135], v[220:223]
v_exp_f32 v68, v68
v_mfma_f32_16x16x32_bf16 v[192:195], v[80:83], a[136:139], v[192:195]
ds_read_b64_tr_b16 v[118:119], v11 offset:52224
ds_read_b64_tr_b16 v[120:121], v12 offset:35840
v_mfma_f32_16x16x32_bf16 v[208:211], v[80:83], a[140:143], v[208:211]
ds_read_b64_tr_b16 v[122:123], v12 offset:52224
s_waitcnt lgkmcnt(6)
v_mfma_f32_16x16x32_bf16 v[196:199], v[84:87], a[136:139], v[196:199]
buffer_load_dwordx4 v35, s[52:55], s77 offen offset:1024 lds
v_mfma_f32_16x16x32_bf16 v[212:215], v[84:87], a[140:143], v[212:215]
ds_read_b64_tr_b16 v[124:125], v13 offset:35840
ds_read_b64_tr_b16 v[126:127], v13 offset:52224
v_mfma_f32_16x16x32_bf16 v[200:203], v[88:91], a[136:139], v[200:203]
v_exp_f32 v69, v69
v_mfma_f32_16x16x32_bf16 v[216:219], v[88:91], a[140:143], v[216:219]
ds_read_b64_tr_b16 v[80:81], v10 offset:36864
ds_read_b64_tr_b16 v[82:83], v10 offset:53248
v_mfma_f32_16x16x32_bf16 v[204:207], v[92:95], a[136:139], v[204:207]
v_exp_f32 v70, v70
v_mfma_f32_16x16x32_bf16 v[220:223], v[92:95], a[140:143], v[220:223]
ds_read_b64_tr_b16 v[84:85], v11 offset:36864
ds_read_b64_tr_b16 v[86:87], v11 offset:53248
v_mfma_f32_16x16x32_bf16 v[192:195], v[96:99], a[144:147], v[192:195]
v_exp_f32 v71, v71
v_mfma_f32_16x16x32_bf16 v[208:211], v[96:99], a[148:151], v[208:211]
ds_read_b64_tr_b16 v[88:89], v12 offset:36864
ds_read_b64_tr_b16 v[90:91], v12 offset:53248
v_mfma_f32_16x16x32_bf16 v[196:199], v[100:103], a[144:147], v[196:199]
buffer_load_dwordx4 v36, s[52:55], s77 offen offset:2048 lds
v_mfma_f32_16x16x32_bf16 v[212:215], v[100:103], a[148:151], v[212:215]
ds_read_b64_tr_b16 v[92:93], v13 offset:36864
ds_read_b64_tr_b16 v[94:95], v13 offset:53248
v_mfma_f32_16x16x32_bf16 v[200:203], v[104:107], a[144:147], v[200:203]
ds_read_b64_tr_b16 v[96:97], v10 offset:37888
v_fma_f32 v68, v68, v63, v63
v_mfma_f32_16x16x32_bf16 v[216:219], v[104:107], a[148:151], v[216:219]
ds_read_b64_tr_b16 v[98:99], v10 offset:54272
v_fma_f32 v69, v69, v63, v63
v_mfma_f32_16x16x32_bf16 v[204:207], v[108:111], a[144:147], v[204:207]
ds_read_b64_tr_b16 v[100:101], v11 offset:37888
v_fma_f32 v70, v70, v63, v63
v_mfma_f32_16x16x32_bf16 v[220:223], v[108:111], a[148:151], v[220:223]
ds_read_b64_tr_b16 v[102:103], v11 offset:54272
s_waitcnt lgkmcnt(6)
v_mfma_f32_16x16x32_bf16 v[192:195], v[112:115], a[152:155], v[192:195]
ds_read_b64_tr_b16 v[104:105], v12 offset:37888
v_fma_f32 v71, v71, v63, v63
v_mfma_f32_16x16x32_bf16 v[208:211], v[112:115], a[156:159], v[208:211]
v_rcp_f32 v68, v68
v_mfma_f32_16x16x32_bf16 v[196:199], v[116:119], a[152:155], v[196:199]
ds_read_b64_tr_b16 v[106:107], v12 offset:54272
ds_read_b64_tr_b16 v[108:109], v13 offset:37888
v_mfma_f32_16x16x32_bf16 v[212:215], v[116:119], a[156:159], v[212:215]
buffer_load_dwordx4 v37, s[52:55], s77 offen offset:3072 lds
v_mfma_f32_16x16x32_bf16 v[200:203], v[120:123], a[152:155], v[200:203]
ds_read_b64_tr_b16 v[110:111], v13 offset:54272
ds_read_b64_tr_b16 v[112:113], v10 offset:38912
v_mfma_f32_16x16x32_bf16 v[216:219], v[120:123], a[156:159], v[216:219]
v_rcp_f32 v69, v69
v_mfma_f32_16x16x32_bf16 v[204:207], v[124:127], a[152:155], v[204:207]
ds_read_b64_tr_b16 v[114:115], v10 offset:55296
ds_read_b64_tr_b16 v[116:117], v11 offset:38912
v_mfma_f32_16x16x32_bf16 v[220:223], v[124:127], a[156:159], v[220:223]
v_rcp_f32 v70, v70
v_mfma_f32_16x16x32_bf16 v[192:195], v[80:83], a[160:163], v[192:195]
ds_read_b64_tr_b16 v[118:119], v11 offset:55296
ds_read_b64_tr_b16 v[120:121], v12 offset:38912
v_mfma_f32_16x16x32_bf16 v[208:211], v[80:83], a[164:167], v[208:211]
v_rcp_f32 v71, v71
v_mfma_f32_16x16x32_bf16 v[196:199], v[84:87], a[160:163], v[196:199]
ds_read_b64_tr_b16 v[122:123], v12 offset:55296
ds_read_b64_tr_b16 v[124:125], v13 offset:38912
v_mfma_f32_16x16x32_bf16 v[212:215], v[84:87], a[164:167], v[212:215]
ds_read_b64_tr_b16 v[126:127], v13 offset:55296
s_add_u32 m0, s76, 0
v_mfma_f32_16x16x32_bf16 v[200:203], v[88:91], a[160:163], v[200:203]
ds_read_b64_tr_b16 v[80:81], v10 offset:39936
s_add_u32 s77, s25, 0x0
v_mfma_f32_16x16x32_bf16 v[216:219], v[88:91], a[164:167], v[216:219]
ds_read_b64_tr_b16 v[82:83], v10 offset:56320
s_waitcnt lgkmcnt(7)
v_mfma_f32_16x16x32_bf16 v[204:207], v[92:95], a[160:163], v[204:207]
buffer_load_dwordx4 v30, s[40:43], s77 offen offset:0 lds
v_mfma_f32_16x16x32_bf16 v[220:223], v[92:95], a[164:167], v[220:223]
ds_read_b64_tr_b16 v[84:85], v11 offset:39936
ds_read_b64_tr_b16 v[86:87], v11 offset:56320
v_mfma_f32_16x16x32_bf16 v[192:195], v[96:99], a[168:171], v[192:195]
ds_read_b64_tr_b16 v[88:89], v12 offset:39936
v_mul_f32 v176, v176, v68
v_mfma_f32_16x16x32_bf16 v[208:211], v[96:99], a[172:175], v[208:211]
ds_read_b64_tr_b16 v[90:91], v12 offset:56320
v_mul_f32 v177, v177, v69
v_mfma_f32_16x16x32_bf16 v[196:199], v[100:103], a[168:171], v[196:199]
buffer_load_dwordx4 v31, s[40:43], s77 offen offset:1024 lds
v_mfma_f32_16x16x32_bf16 v[212:215], v[100:103], a[172:175], v[212:215]
ds_read_b64_tr_b16 v[92:93], v13 offset:39936
ds_read_b64_tr_b16 v[94:95], v13 offset:56320
v_mfma_f32_16x16x32_bf16 v[200:203], v[104:107], a[168:171], v[200:203]
v_mul_f32 v178, v178, v70
v_mul_f32 v179, v179, v71
v_mfma_f32_16x16x32_bf16 v[216:219], v[104:107], a[172:175], v[216:219]
v_mul_f32 v72, v61, v180
v_mul_f32 v73, v61, v181
v_mfma_f32_16x16x32_bf16 v[204:207], v[108:111], a[168:171], v[204:207]
buffer_load_dwordx4 v32, s[40:43], s77 offen offset:2048 lds
v_mfma_f32_16x16x32_bf16 v[220:223], v[108:111], a[172:175], v[220:223]
v_mul_f32 v74, v61, v182
v_mul_f32 v75, v61, v183
v_mfma_f32_16x16x32_bf16 v[192:195], v[112:115], a[176:179], v[192:195]
s_waitcnt vmcnt(11) lgkmcnt(0)
s_barrier
v_mfma_f32_16x16x32_bf16 v[208:211], v[112:115], a[180:183], v[208:211]
ds_read_b64_tr_b16 v[96:97], v14 offset:0
ds_read_b64_tr_b16 v[98:99], v14 offset:16384
v_mfma_f32_16x16x32_bf16 v[196:199], v[116:119], a[176:179], v[196:199]
ds_read_b64_tr_b16 v[100:101], v15 offset:0
v_mfma_f32_16x16x32_bf16 v[212:215], v[116:119], a[180:183], v[212:215]
ds_read_b64_tr_b16 v[102:103], v15 offset:16384
ds_read_b64_tr_b16 v[104:105], v16 offset:0
v_mfma_f32_16x16x32_bf16 v[200:203], v[120:123], a[176:179], v[200:203]
buffer_load_dwordx4 v33, s[40:43], s77 offen offset:3072 lds
v_mfma_f32_16x16x32_bf16 v[216:219], v[120:123], a[180:183], v[216:219]
ds_read_b64_tr_b16 v[106:107], v16 offset:16384
ds_read_b64_tr_b16 v[108:109], v17 offset:0
v_mfma_f32_16x16x32_bf16 v[204:207], v[124:127], a[176:179], v[204:207]
v_exp_f32 v72, v72
v_mfma_f32_16x16x32_bf16 v[220:223], v[124:127], a[180:183], v[220:223]
ds_read_b64_tr_b16 v[110:111], v17 offset:16384
ds_read_b64_tr_b16 v[112:113], v14 offset:1024
v_mfma_f32_16x16x32_bf16 v[192:195], v[80:83], a[184:187], v[192:195]
v_exp_f32 v73, v73
v_mfma_f32_16x16x32_bf16 v[208:211], v[80:83], a[188:191], v[208:211]
ds_read_b64_tr_b16 v[114:115], v14 offset:17408
ds_read_b64_tr_b16 v[116:117], v15 offset:1024
v_mfma_f32_16x16x32_bf16 v[196:199], v[84:87], a[184:187], v[196:199]
v_exp_f32 v74, v74
v_mfma_f32_16x16x32_bf16 v[212:215], v[84:87], a[188:191], v[212:215]
ds_read_b64_tr_b16 v[118:119], v15 offset:17408
ds_read_b64_tr_b16 v[120:121], v16 offset:1024
v_mfma_f32_16x16x32_bf16 v[200:203], v[88:91], a[184:187], v[200:203]
v_exp_f32 v75, v75
v_mfma_f32_16x16x32_bf16 v[216:219], v[88:91], a[188:191], v[216:219]
ds_read_b64_tr_b16 v[122:123], v16 offset:17408
ds_read_b64_tr_b16 v[124:125], v17 offset:1024
v_mfma_f32_16x16x32_bf16 v[204:207], v[92:95], a[184:187], v[204:207]
ds_read_b64_tr_b16 v[126:127], v17 offset:17408
s_add_u32 m0, s76, 4096
v_mfma_f32_16x16x32_bf16 v[220:223], v[92:95], a[188:191], v[220:223]
ds_read_b64_tr_b16 v[80:81], v14 offset:2048
s_waitcnt lgkmcnt(6)
v_mfma_f32_16x16x32_bf16 v[192:195], v[96:99], a[192:195], v[192:195]
ds_read_b64_tr_b16 v[82:83], v14 offset:18432
s_add_u32 s77, s25, 0xe0000
v_mfma_f32_16x16x32_bf16 v[208:211], v[96:99], a[196:199], v[208:211]
buffer_load_dwordx4 v30, s[40:43], s77 offen offset:0 lds
v_mfma_f32_16x16x32_bf16 v[196:199], v[100:103], a[192:195], v[196:199]
ds_read_b64_tr_b16 v[84:85], v15 offset:2048
ds_read_b64_tr_b16 v[86:87], v15 offset:18432
v_mfma_f32_16x16x32_bf16 v[212:215], v[100:103], a[196:199], v[212:215]
ds_read_b64_tr_b16 v[88:89], v16 offset:2048
v_fma_f32 v72, v72, v63, v63
v_mfma_f32_16x16x32_bf16 v[200:203], v[104:107], a[192:195], v[200:203]
ds_read_b64_tr_b16 v[90:91], v16 offset:18432
ds_read_b64_tr_b16 v[92:93], v17 offset:2048
v_mfma_f32_16x16x32_bf16 v[216:219], v[104:107], a[196:199], v[216:219]
buffer_load_dwordx4 v31, s[40:43], s77 offen offset:1024 lds
v_mfma_f32_16x16x32_bf16 v[204:207], v[108:111], a[192:195], v[204:207]
ds_read_b64_tr_b16 v[94:95], v17 offset:18432
ds_read_b64_tr_b16 v[96:97], v14 offset:3072
v_mfma_f32_16x16x32_bf16 v[220:223], v[108:111], a[196:199], v[220:223]
ds_read_b64_tr_b16 v[98:99], v14 offset:19456
v_fma_f32 v73, v73, v63, v63
v_mfma_f32_16x16x32_bf16 v[192:195], v[112:115], a[200:203], v[192:195]
ds_read_b64_tr_b16 v[100:101], v15 offset:3072
ds_read_b64_tr_b16 v[102:103], v15 offset:19456
v_mfma_f32_16x16x32_bf16 v[208:211], v[112:115], a[204:207], v[208:211]
ds_read_b64_tr_b16 v[104:105], v16 offset:3072
s_waitcnt lgkmcnt(8)
v_mfma_f32_16x16x32_bf16 v[196:199], v[116:119], a[200:203], v[196:199]
buffer_load_dwordx4 v32, s[40:43], s77 offen offset:2048 lds
v_mfma_f32_16x16x32_bf16 v[212:215], v[116:119], a[204:207], v[212:215]
ds_read_b64_tr_b16 v[106:107], v16 offset:19456
ds_read_b64_tr_b16 v[108:109], v17 offset:3072
v_mfma_f32_16x16x32_bf16 v[200:203], v[120:123], a[200:203], v[200:203]
ds_read_b64_tr_b16 v[110:111], v17 offset:19456
v_fma_f32 v74, v74, v63, v63
v_mfma_f32_16x16x32_bf16 v[216:219], v[120:123], a[204:207], v[216:219]
ds_read_b64_tr_b16 v[112:113], v14 offset:4096
ds_read_b64_tr_b16 v[114:115], v14 offset:20480
v_mfma_f32_16x16x32_bf16 v[204:207], v[124:127], a[200:203], v[204:207]
buffer_load_dwordx4 v33, s[40:43], s77 offen offset:3072 lds
v_mfma_f32_16x16x32_bf16 v[220:223], v[124:127], a[204:207], v[220:223]
ds_read_b64_tr_b16 v[116:117], v15 offset:4096
ds_read_b64_tr_b16 v[118:119], v15 offset:20480
v_mfma_f32_16x16x32_bf16 v[192:195], v[80:83], a[208:211], v[192:195]
ds_read_b64_tr_b16 v[120:121], v16 offset:4096
s_add_u32 m0, s76, 32768
v_mfma_f32_16x16x32_bf16 v[208:211], v[80:83], a[212:215], v[208:211]
ds_read_b64_tr_b16 v[122:123], v16 offset:20480
s_add_u32 s77, s25, 0x1c0000
v_mfma_f32_16x16x32_bf16 v[196:199], v[84:87], a[208:211], v[196:199]
buffer_load_dwordx4 v30, s[40:43], s77 offen offset:0 lds
v_mfma_f32_16x16x32_bf16 v[212:215], v[84:87], a[212:215], v[212:215]
ds_read_b64_tr_b16 v[124:125], v17 offset:4096
s_waitcnt lgkmcnt(5)
v_mfma_f32_16x16x32_bf16 v[200:203], v[88:91], a[208:211], v[200:203]
ds_read_b64_tr_b16 v[126:127], v17 offset:20480
ds_read_b64_tr_b16 v[80:81], v14 offset:5120
v_mfma_f32_16x16x32_bf16 v[216:219], v[88:91], a[212:215], v[216:219]
ds_read_b64_tr_b16 v[82:83], v14 offset:21504
v_fma_f32 v75, v75, v63, v63
v_mfma_f32_16x16x32_bf16 v[204:207], v[92:95], a[208:211], v[204:207]
buffer_load_dwordx4 v31, s[40:43], s77 offen offset:1024 lds
v_mfma_f32_16x16x32_bf16 v[220:223], v[92:95], a[212:215], v[220:223]
ds_read_b64_tr_b16 v[84:85], v15 offset:5120
ds_read_b64_tr_b16 v[86:87], v15 offset:21504
v_mfma_f32_16x16x32_bf16 v[192:195], v[96:99], a[216:219], v[192:195]
v_rcp_f32 v72, v72
v_mfma_f32_16x16x32_bf16 v[208:211], v[96:99], a[220:223], v[208:211]
ds_read_b64_tr_b16 v[88:89], v16 offset:5120
ds_read_b64_tr_b16 v[90:91], v16 offset:21504
v_mfma_f32_16x16x32_bf16 v[196:199], v[100:103], a[216:219], v[196:199]
buffer_load_dwordx4 v32, s[40:43], s77 offen offset:2048 lds
v_mfma_f32_16x16x32_bf16 v[212:215], v[100:103], a[220:223], v[212:215]
ds_read_b64_tr_b16 v[92:93], v17 offset:5120
ds_read_b64_tr_b16 v[94:95], v17 offset:21504
v_mfma_f32_16x16x32_bf16 v[200:203], v[104:107], a[216:219], v[200:203]
v_rcp_f32 v73, v73
v_mfma_f32_16x16x32_bf16 v[216:219], v[104:107], a[220:223], v[216:219]
ds_read_b64_tr_b16 v[96:97], v14 offset:6144
ds_read_b64_tr_b16 v[98:99], v14 offset:22528
v_mfma_f32_16x16x32_bf16 v[204:207], v[108:111], a[216:219], v[204:207]
buffer_load_dwordx4 v33, s[40:43], s77 offen offset:3072 lds
v_mfma_f32_16x16x32_bf16 v[220:223], v[108:111], a[220:223], v[220:223]
ds_read_b64_tr_b16 v[100:101], v15 offset:6144
ds_read_b64_tr_b16 v[102:103], v15 offset:22528
v_mfma_f32_16x16x32_bf16 v[192:195], v[112:115], a[224:227], v[192:195]
v_rcp_f32 v74, v74
v_mfma_f32_16x16x32_bf16 v[208:211], v[112:115], a[228:231], v[208:211]
ds_read_b64_tr_b16 v[104:105], v16 offset:6144
s_waitcnt lgkmcnt(5)
v_mfma_f32_16x16x32_bf16 v[196:199], v[116:119], a[224:227], v[196:199]
v_rcp_f32 v75, v75
v_mfma_f32_16x16x32_bf16 v[212:215], v[116:119], a[228:231], v[212:215]
ds_read_b64_tr_b16 v[106:107], v16 offset:22528
ds_read_b64_tr_b16 v[108:109], v17 offset:6144
v_mfma_f32_16x16x32_bf16 v[200:203], v[120:123], a[224:227], v[200:203]
ds_read_b64_tr_b16 v[110:111], v17 offset:22528
s_add_u32 m0, s76, 36864
v_mfma_f32_16x16x32_bf16 v[216:219], v[120:123], a[228:231], v[216:219]
ds_read_b64_tr_b16 v[112:113], v14 offset:7168
s_add_u32 s77, s25, 0x2a0000
v_mfma_f32_16x16x32_bf16 v[204:207], v[124:127], a[224:227], v[204:207]
buffer_load_dwordx4 v30, s[40:43], s77 offen offset:0 lds
v_mfma_f32_16x16x32_bf16 v[220:223], v[124:127], a[228:231], v[220:223]
ds_read_b64_tr_b16 v[114:115], v14 offset:23552
ds_read_b64_tr_b16 v[116:117], v15 offset:7168
v_mfma_f32_16x16x32_bf16 v[192:195], v[80:83], a[232:235], v[192:195]
ds_read_b64_tr_b16 v[118:119], v15 offset:23552
v_mul_f32 v180, v180, v72
v_mfma_f32_16x16x32_bf16 v[208:211], v[80:83], a[236:239], v[208:211]
ds_read_b64_tr_b16 v[120:121], v16 offset:7168
ds_read_b64_tr_b16 v[122:123], v16 offset:23552
v_mfma_f32_16x16x32_bf16 v[196:199], v[84:87], a[232:235], v[196:199]
buffer_load_dwordx4 v31, s[40:43], s77 offen offset:1024 lds
v_mfma_f32_16x16x32_bf16 v[212:215], v[84:87], a[236:239], v[212:215]
ds_read_b64_tr_b16 v[124:125], v17 offset:7168
ds_read_b64_tr_b16 v[126:127], v17 offset:23552
v_mfma_f32_16x16x32_bf16 v[200:203], v[88:91], a[232:235], v[200:203]
v_mul_f32 v181, v181, v73
v_mul_f32 v182, v182, v74
v_mfma_f32_16x16x32_bf16 v[216:219], v[88:91], a[236:239], v[216:219]
v_mul_f32 v183, v183, v75
v_mul_f32 v68, v61, v184
v_mfma_f32_16x16x32_bf16 v[204:207], v[92:95], a[232:235], v[204:207]
buffer_load_dwordx4 v32, s[40:43], s77 offen offset:2048 lds
v_mfma_f32_16x16x32_bf16 v[220:223], v[92:95], a[236:239], v[220:223]
v_mul_f32 v69, v61, v185
s_waitcnt lgkmcnt(2)
v_mfma_f32_16x16x32_bf16 v[192:195], v[96:99], a[240:243], v[192:195]
s_waitcnt vmcnt(15) lgkmcnt(0)
s_barrier
v_mfma_f32_16x16x32_bf16 v[208:211], v[96:99], a[244:247], v[208:211]
ds_read_b64_tr_b16 v[80:81], v20 offset:32768
ds_read_b64_tr_b16 v[82:83], v20 offset:40960
v_mfma_f32_16x16x32_bf16 v[196:199], v[100:103], a[240:243], v[196:199]
ds_read_b64_tr_b16 v[84:85], v21 offset:32768
v_mul_f32 v70, v61, v186
v_mfma_f32_16x16x32_bf16 v[212:215], v[100:103], a[244:247], v[212:215]
ds_read_b64_tr_b16 v[86:87], v21 offset:40960
ds_read_b64_tr_b16 v[88:89], v20 offset:49152
v_mfma_f32_16x16x32_bf16 v[200:203], v[104:107], a[240:243], v[200:203]
buffer_load_dwordx4 v33, s[40:43], s77 offen offset:3072 lds
v_mfma_f32_16x16x32_bf16 v[216:219], v[104:107], a[244:247], v[216:219]
ds_read_b64_tr_b16 v[90:91], v20 offset:57344
ds_read_b64_tr_b16 v[92:93], v21 offset:49152
v_mfma_f32_16x16x32_bf16 v[204:207], v[108:111], a[240:243], v[204:207]
ds_read_b64_tr_b16 v[94:95], v21 offset:57344
s_add_u32 m0, s76, 65536
v_mfma_f32_16x16x32_bf16 v[220:223], v[108:111], a[244:247], v[220:223]
ds_read_b64_tr_b16 v[96:97], v20 offset:33792
s_add_u32 s77, s25, 0x380000
v_mfma_f32_16x16x32_bf16 v[192:195], v[112:115], a[248:251], v[192:195]
buffer_load_dwordx4 v30, s[40:43], s77 offen offset:0 lds
v_mfma_f32_16x16x32_bf16 v[208:211], v[112:115], a[252:255], v[208:211]
ds_read_b64_tr_b16 v[98:99], v20 offset:41984
ds_read_b64_tr_b16 v[100:101], v21 offset:33792
v_mfma_f32_16x16x32_bf16 v[196:199], v[116:119], a[248:251], v[196:199]
ds_read_b64_tr_b16 v[102:103], v21 offset:41984
v_mul_f32 v71, v61, v187
v_mfma_f32_16x16x32_bf16 v[212:215], v[116:119], a[252:255], v[212:215]
v_exp_f32 v68, v68
v_mfma_f32_16x16x32_bf16 v[200:203], v[120:123], a[248:251], v[200:203]
ds_read_b64_tr_b16 v[104:105], v20 offset:50176
ds_read_b64_tr_b16 v[106:107], v20 offset:58368
v_mfma_f32_16x16x32_bf16 v[216:219], v[120:123], a[252:255], v[216:219]
buffer_load_dwordx4 v31, s[40:43], s77 offen offset:1024 lds
v_mfma_f32_16x16x32_bf16 v[204:207], v[124:127], a[248:251], v[204:207]
ds_read_b64_tr_b16 v[108:109], v21 offset:50176
ds_read_b64_tr_b16 v[110:111], v21 offset:58368
v_mfma_f32_16x16x32_bf16 v[220:223], v[124:127], a[252:255], v[220:223]
v_exp_f32 v69, v69
S_H3:
s_waitcnt lgkmcnt(5)
v_mfma_f32_16x16x32_bf16 v[224:227], v[80:83], a[192:195], v[224:227]
ds_read_b64_tr_b16 v[112:113], v20 offset:34816
ds_read_b64_tr_b16 v[114:115], v20 offset:43008
ds_read_b64_tr_b16 v[116:117], v21 offset:34816
v_mfma_f32_16x16x32_bf16 v[240:243], v[80:83], a[196:199], v[240:243]
buffer_load_dwordx4 v32, s[40:43], s77 offen offset:2048 lds
ds_read_b64_tr_b16 v[118:119], v21 offset:43008
v_mfma_f32_16x16x32_bf16 v[228:231], v[84:87], a[192:195], v[228:231]
v_exp_f32 v70, v70
ds_read_b64_tr_b16 v[120:121], v20 offset:51200
v_mfma_f32_16x16x32_bf16 v[244:247], v[84:87], a[196:199], v[244:247]
s_add_u32 s70, s0, S_U2 - K_pc + 0
s_addc_u32 s71, s1, 0
global_load_dword v57, v9, s[70:71]
v_mfma_f32_16x16x32_bf16 v[232:235], v[88:91], a[192:195], v[232:235]
ds_read_b64_tr_b16 v[122:123], v20 offset:59392
ds_read_b64_tr_b16 v[124:125], v21 offset:51200
ds_read_b64_tr_b16 v[126:127], v21 offset:59392
v_mfma_f32_16x16x32_bf16 v[248:251], v[88:91], a[196:199], v[248:251]
buffer_load_dwordx4 v33, s[40:43], s77 offen offset:3072 lds
ds_read_b64_tr_b16 v[80:81], v20 offset:35840
v_mfma_f32_16x16x32_bf16 v[236:239], v[92:95], a[192:195], v[236:239]
v_exp_f32 v71, v71
s_add_u32 m0, s76, 69632
v_mfma_f32_16x16x32_bf16 v[252:255], v[92:95], a[196:199], v[252:255]
ds_read_b64_tr_b16 v[82:83], v20 offset:44032
ds_read_b64_tr_b16 v[84:85], v21 offset:35840
ds_read_b64_tr_b16 v[86:87], v21 offset:44032
v_mfma_f32_16x16x32_bf16 v[224:227], v[96:99], a[200:203], v[224:227]
ds_read_b64_tr_b16 v[88:89], v20 offset:52224
s_add_u32 s77, s25, 0x460000
v_fma_f32 v68, v68, v63, v63
v_mfma_f32_16x16x32_bf16 v[240:243], v[96:99], a[204:207], v[240:243]
buffer_load_dwordx4 v30, s[40:43], s77 offen offset:0 lds
s_waitcnt lgkmcnt(8)
v_mfma_f32_16x16x32_bf16 v[228:231], v[100:103], a[200:203], v[228:231]
ds_read_b64_tr_b16 v[90:91], v20 offset:60416
ds_read_b64_tr_b16 v[92:93], v21 offset:52224
v_fma_f32 v69, v69, v63, v63
v_mfma_f32_16x16x32_bf16 v[244:247], v[100:103], a[204:207], v[244:247]
ds_read_b64_tr_b16 v[94:95], v21 offset:60416
v_fma_f32 v70, v70, v63, v63
v_fma_f32 v71, v71, v63, v63
v_mfma_f32_16x16x32_bf16 v[232:235], v[104:107], a[200:203], v[232:235]
v_rcp_f32 v68, v68
ds_read_b64_tr_b16 v[96:97], v20 offset:36864
v_mfma_f32_16x16x32_bf16 v[248:251], v[104:107], a[204:207], v[248:251]
buffer_load_dwordx4 v31, s[40:43], s77 offen offset:1024 lds
ds_read_b64_tr_b16 v[98:99], v20 offset:45056
v_mfma_f32_16x16x32_bf16 v[236:239], v[108:111], a[200:203], v[236:239]
v_rcp_f32 v69, v69
ds_read_b64_tr_b16 v[100:101], v21 offset:36864
v_mfma_f32_16x16x32_bf16 v[252:255], v[108:111], a[204:207], v[252:255]
v_rcp_f32 v70, v70
ds_read_b64_tr_b16 v[102:103], v21 offset:45056
v_mfma_f32_16x16x32_bf16 v[224:227], v[112:115], a[208:211], v[224:227]
v_rcp_f32 v71, v71
ds_read_b64_tr_b16 v[104:105], v20 offset:53248
v_mfma_f32_16x16x32_bf16 v[240:243], v[112:115], a[212:215], v[240:243]
buffer_load_dwordx4 v32, s[40:43], s77 offen offset:2048 lds
ds_read_b64_tr_b16 v[106:107], v20 offset:61440
v_mfma_f32_16x16x32_bf16 v[228:231], v[116:119], a[208:211], v[228:231]
ds_read_b64_tr_b16 v[108:109], v21 offset:53248
v_mul_f32 v184, v184, v68
v_mul_f32 v185, v185, v69
v_mfma_f32_16x16x32_bf16 v[244:247], v[116:119], a[212:215], v[244:247]
ds_read_b64_tr_b16 v[110:111], v21 offset:61440
v_mul_f32 v186, v186, v70
s_waitcnt lgkmcnt(6)
v_mfma_f32_16x16x32_bf16 v[232:235], v[120:123], a[208:211], v[232:235]
ds_read_b64_tr_b16 v[112:113], v20 offset:37888
v_mul_f32 v187, v187, v71
v_mul_f32 v72, v61, v188
v_mfma_f32_16x16x32_bf16 v[248:251], v[120:123], a[212:215], v[248:251]
buffer_load_dwordx4 v33, s[40:43], s77 offen offset:3072 lds
ds_read_b64_tr_b16 v[114:115], v20 offset:46080
v_mfma_f32_16x16x32_bf16 v[236:239], v[124:127], a[208:211], v[236:239]
ds_read_b64_tr_b16 v[116:117], v21 offset:37888
v_mul_f32 v73, v61, v189
v_mul_f32 v74, v61, v190
v_mfma_f32_16x16x32_bf16 v[252:255], v[124:127], a[212:215], v[252:255]
ds_read_b64_tr_b16 v[118:119], v21 offset:46080
v_mul_f32 v75, v61, v191
ds_read_b64_tr_b16 v[120:121], v20 offset:54272
v_mfma_f32_16x16x32_bf16 v[224:227], v[80:83], a[216:219], v[224:227]
v_exp_f32 v72, v72
ds_read_b64_tr_b16 v[122:123], v20 offset:62464
v_mfma_f32_16x16x32_bf16 v[240:243], v[80:83], a[220:223], v[240:243]
v_exp_f32 v73, v73
ds_read_b64_tr_b16 v[124:125], v21 offset:54272
v_mfma_f32_16x16x32_bf16 v[228:231], v[84:87], a[216:219], v[228:231]
v_exp_f32 v74, v74
ds_read_b64_tr_b16 v[126:127], v21 offset:62464
v_mfma_f32_16x16x32_bf16 v[244:247], v[84:87], a[220:223], v[244:247]
v_exp_f32 v75, v75
ds_read_b64_tr_b16 v[80:81], v20 offset:38912
v_mfma_f32_16x16x32_bf16 v[232:235], v[88:91], a[216:219], v[232:235]
ds_read_b64_tr_b16 v[82:83], v20 offset:47104
v_fma_f32 v72, v72, v63, v63
v_fma_f32 v73, v73, v63, v63
v_mfma_f32_16x16x32_bf16 v[248:251], v[88:91], a[220:223], v[248:251]
ds_read_b64_tr_b16 v[84:85], v21 offset:38912
v_fma_f32 v74, v74, v63, v63
v_fma_f32 v75, v75, v63, v63
v_mfma_f32_16x16x32_bf16 v[236:239], v[92:95], a[216:219], v[236:239]
v_rcp_f32 v72, v72
ds_read_b64_tr_b16 v[86:87], v21 offset:47104
v_mfma_f32_16x16x32_bf16 v[252:255], v[92:95], a[220:223], v[252:255]
v_rcp_f32 v73, v73
ds_read_b64_tr_b16 v[88:89], v20 offset:55296
v_mfma_f32_16x16x32_bf16 v[224:227], v[96:99], a[224:227], v[224:227]
v_rcp_f32 v74, v74
ds_read_b64_tr_b16 v[90:91], v20 offset:63488
v_mfma_f32_16x16x32_bf16 v[240:243], v[96:99], a[228:231], v[240:243]
v_rcp_f32 v75, v75
s_waitcnt lgkmcnt(5)
v_mfma_f32_16x16x32_bf16 v[228:231], v[100:103], a[224:227], v[228:231]
ds_read_b64_tr_b16 v[92:93], v21 offset:55296
v_mul_f32 v188, v188, v72
v_mul_f32 v189, v189, v73
v_mfma_f32_16x16x32_bf16 v[244:247], v[100:103], a[228:231], v[244:247]
ds_read_b64_tr_b16 v[94:95], v21 offset:63488
v_mul_f32 v190, v190, v74
v_mul_f32 v191, v191, v75
v_mfma_f32_16x16x32_bf16 v[232:235], v[104:107], a[224:227], v[232:235]
ds_read_b64_tr_b16 v[96:97], v20 offset:39936
ds_read_b64_tr_b16 v[98:99], v20 offset:48128
ds_read_b64_tr_b16 v[100:101], v21 offset:39936
v_mfma_f32_16x16x32_bf16 v[248:251], v[104:107], a[228:231], v[248:251]
ds_read_b64_tr_b16 v[102:103], v21 offset:48128
v_mfma_f32_16x16x32_bf16 v[236:239], v[108:111], a[224:227], v[236:239]
ds_read_b64_tr_b16 v[104:105], v20 offset:56320
s_lshl_b32 s7, s84, 5
s_add_u32 s7, s7, s4
v_mfma_f32_16x16x32_bf16 v[252:255], v[108:111], a[228:231], v[252:255]
ds_read_b64_tr_b16 v[106:107], v20 offset:64512
v_mul_f32 v192, v192, v160
v_mul_f32 v193, v193, v161
v_mfma_f32_16x16x32_bf16 v[224:227], v[112:115], a[232:235], v[224:227]
ds_read_b64_tr_b16 v[108:109], v21 offset:56320
v_mul_f32 v194, v194, v162
v_mul_f32 v195, v195, v163
v_mfma_f32_16x16x32_bf16 v[240:243], v[112:115], a[236:239], v[240:243]
ds_read_b64_tr_b16 v[110:111], v21 offset:64512
v_mul_f32 v196, v196, v164
v_mul_f32 v197, v197, v165
v_mfma_f32_16x16x32_bf16 v[228:231], v[116:119], a[232:235], v[228:231]
v_mul_f32 v198, v198, v166
v_mul_f32 v199, v199, v167
v_cvt_pk_bf16_f32 v192, v192, v193
v_mfma_f32_16x16x32_bf16 v[244:247], v[116:119], a[236:239], v[244:247]
v_cvt_pk_bf16_f32 v193, v194, v195
v_cvt_pk_bf16_f32 v194, v196, v197
v_cvt_pk_bf16_f32 v195, v198, v199
v_mfma_f32_16x16x32_bf16 v[232:235], v[120:123], a[232:235], v[232:235]
buffer_store_dwordx4 v[192:195], v46, s[60:63], s7 offen offset:0 sc1
v_mul_f32 v200, v200, v168
v_mfma_f32_16x16x32_bf16 v[248:251], v[120:123], a[236:239], v[248:251]
v_mul_f32 v201, v201, v169
v_mul_f32 v202, v202, v170
v_mul_f32 v203, v203, v171
v_mfma_f32_16x16x32_bf16 v[236:239], v[124:127], a[232:235], v[236:239]
s_waitcnt vmcnt(18) lgkmcnt(0)
s_barrier
ds_read_b64_tr_b16 v[112:113], v10 offset:0
v_mfma_f32_16x16x32_bf16 v[252:255], v[124:127], a[236:239], v[252:255]
ds_read_b64_tr_b16 v[114:115], v10 offset:16384
s_add_u32 m0, s76, 98304
s_add_u32 s77, s25, 0x540000
v_mfma_f32_16x16x32_bf16 v[224:227], v[80:83], a[240:243], v[224:227]
buffer_load_dwordx4 v30, s[40:43], s77 offen offset:0 lds
ds_read_b64_tr_b16 v[116:117], v11 offset:0
v_mfma_f32_16x16x32_bf16 v[240:243], v[80:83], a[244:247], v[240:243]
ds_read_b64_tr_b16 v[118:119], v11 offset:16384
ds_read_b64_tr_b16 v[120:121], v12 offset:0
ds_read_b64_tr_b16 v[122:123], v12 offset:16384
v_mfma_f32_16x16x32_bf16 v[228:231], v[84:87], a[240:243], v[228:231]
ds_read_b64_tr_b16 v[124:125], v13 offset:0
v_mul_f32 v204, v204, v172
v_mul_f32 v205, v205, v173
v_mfma_f32_16x16x32_bf16 v[244:247], v[84:87], a[244:247], v[244:247]
ds_read_b64_tr_b16 v[126:127], v13 offset:16384
v_mul_f32 v206, v206, v174
v_mul_f32 v207, v207, v175
v_mfma_f32_16x16x32_bf16 v[232:235], v[88:91], a[240:243], v[232:235]
ds_read_b64_tr_b16 v[80:81], v10 offset:1024
v_cvt_pk_bf16_f32 v200, v200, v201
v_cvt_pk_bf16_f32 v201, v202, v203
v_mfma_f32_16x16x32_bf16 v[248:251], v[88:91], a[244:247], v[248:251]
ds_read_b64_tr_b16 v[82:83], v10 offset:17408
v_cvt_pk_bf16_f32 v202, v204, v205
v_cvt_pk_bf16_f32 v203, v206, v207
v_mfma_f32_16x16x32_bf16 v[236:239], v[92:95], a[240:243], v[236:239]
buffer_load_dwordx4 v31, s[40:43], s77 offen offset:1024 lds
ds_read_b64_tr_b16 v[84:85], v11 offset:1024
v_mfma_f32_16x16x32_bf16 v[252:255], v[92:95], a[244:247], v[252:255]
ds_read_b64_tr_b16 v[86:87], v11 offset:17408
ds_read_b64_tr_b16 v[88:89], v12 offset:1024
ds_read_b64_tr_b16 v[90:91], v12 offset:17408
v_mfma_f32_16x16x32_bf16 v[224:227], v[96:99], a[248:251], v[224:227]
buffer_store_dwordx4 v[200:203], v46, s[60:63], s7 offen offset:2048 sc1
ds_read_b64_tr_b16 v[92:93], v13 offset:1024
v_mfma_f32_16x16x32_bf16 v[240:243], v[96:99], a[252:255], v[240:243]
ds_read_b64_tr_b16 v[94:95], v13 offset:17408
v_mul_f32 v208, v208, v176
v_mul_f32 v209, v209, v177
v_mfma_f32_16x16x32_bf16 v[228:231], v[100:103], a[248:251], v[228:231]
ds_read_b64_tr_b16 v[96:97], v10 offset:2048
v_mul_f32 v210, v210, v178
v_mul_f32 v211, v211, v179
v_mfma_f32_16x16x32_bf16 v[244:247], v[100:103], a[252:255], v[244:247]
ds_read_b64_tr_b16 v[98:99], v10 offset:18432
v_mul_f32 v212, v212, v180
v_mul_f32 v213, v213, v181
v_mfma_f32_16x16x32_bf16 v[232:235], v[104:107], a[248:251], v[232:235]
buffer_load_dwordx4 v32, s[40:43], s77 offen offset:2048 lds
ds_read_b64_tr_b16 v[100:101], v11 offset:2048
v_mfma_f32_16x16x32_bf16 v[248:251], v[104:107], a[252:255], v[248:251]
ds_read_b64_tr_b16 v[102:103], v11 offset:18432
v_mul_f32 v214, v214, v182
v_mul_f32 v215, v215, v183
v_mfma_f32_16x16x32_bf16 v[236:239], v[108:111], a[248:251], v[236:239]
ds_read_b64_tr_b16 v[104:105], v12 offset:2048
v_cvt_pk_bf16_f32 v208, v208, v209
v_cvt_pk_bf16_f32 v209, v210, v211
v_mfma_f32_16x16x32_bf16 v[252:255], v[108:111], a[252:255], v[252:255]
ds_read_b64_tr_b16 v[106:107], v12 offset:18432
v_cvt_pk_bf16_f32 v210, v212, v213
s_waitcnt lgkmcnt(6)
v_mfma_f32_16x16x32_bf16 v[128:131], v[112:115], a[0:3], 0
ds_read_b64_tr_b16 v[108:109], v13 offset:2048
v_cvt_pk_bf16_f32 v211, v214, v215
v_mfma_f32_16x16x32_bf16 v[144:147], v[112:115], a[4:7], 0
buffer_store_dwordx4 v[208:211], v46, s[60:63], s7 offen offset:1024 sc1
ds_read_b64_tr_b16 v[110:111], v13 offset:18432
v_mfma_f32_16x16x32_bf16 v[132:135], v[116:119], a[0:3], 0
ds_read_b64_tr_b16 v[112:113], v10 offset:3072
v_mul_f32 v216, v216, v184
v_mul_f32 v217, v217, v185
v_mfma_f32_16x16x32_bf16 v[148:151], v[116:119], a[4:7], 0
buffer_load_dwordx4 v33, s[40:43], s77 offen offset:3072 lds
ds_read_b64_tr_b16 v[114:115], v10 offset:19456
v_mfma_f32_16x16x32_bf16 v[136:139], v[120:123], a[0:3], 0
ds_read_b64_tr_b16 v[116:117], v11 offset:3072
v_mul_f32 v218, v218, v186
v_mul_f32 v219, v219, v187
v_mfma_f32_16x16x32_bf16 v[152:155], v[120:123], a[4:7], 0
ds_read_b64_tr_b16 v[118:119], v11 offset:19456
v_mul_f32 v220, v220, v188
v_mul_f32 v221, v221, v189
v_mfma_f32_16x16x32_bf16 v[140:143], v[124:127], a[0:3], 0
ds_read_b64_tr_b16 v[120:121], v12 offset:3072
s_add_u32 m0, s76, 102400
s_add_u32 s77, s25, 0x620000
v_mfma_f32_16x16x32_bf16 v[156:159], v[124:127], a[4:7], 0
ds_read_b64_tr_b16 v[122:123], v12 offset:19456
v_mul_f32 v222, v222, v190
v_mul_f32 v223, v223, v191
v_mfma_f32_16x16x32_bf16 v[128:131], v[80:83], a[8:11], v[128:131]
ds_read_b64_tr_b16 v[124:125], v13 offset:3072
v_cvt_pk_bf16_f32 v216, v216, v217
v_cvt_pk_bf16_f32 v217, v218, v219
v_mfma_f32_16x16x32_bf16 v[144:147], v[80:83], a[12:15], v[144:147]
buffer_load_dwordx4 v30, s[40:43], s77 offen offset:0 lds
ds_read_b64_tr_b16 v[126:127], v13 offset:19456
v_mfma_f32_16x16x32_bf16 v[132:135], v[84:87], a[8:11], v[132:135]
ds_read_b64_tr_b16 v[80:81], v10 offset:4096
v_cvt_pk_bf16_f32 v218, v220, v221
v_cvt_pk_bf16_f32 v219, v222, v223
v_mfma_f32_16x16x32_bf16 v[148:151], v[84:87], a[12:15], v[148:151]
buffer_store_dwordx4 v[216:219], v46, s[60:63], s7 offen offset:3072 sc1
ds_read_b64_tr_b16 v[82:83], v10 offset:20480
v_mfma_f32_16x16x32_bf16 v[136:139], v[88:91], a[8:11], v[136:139]
ds_read_b64_tr_b16 v[84:85], v11 offset:4096
v_mul_f32 v68, v60, v224
v_mul_f32 v69, v60, v225
v_mfma_f32_16x16x32_bf16 v[152:155], v[88:91], a[12:15], v[152:155]
ds_read_b64_tr_b16 v[86:87], v11 offset:20480
v_mul_f32 v70, v60, v226
v_mul_f32 v71, v60, v227
v_mfma_f32_16x16x32_bf16 v[140:143], v[92:95], a[8:11], v[140:143]
v_exp_f32 v68, v68
ds_read_b64_tr_b16 v[88:89], v12 offset:4096
v_mfma_f32_16x16x32_bf16 v[156:159], v[92:95], a[12:15], v[156:159]
buffer_load_dwordx4 v31, s[40:43], s77 offen offset:1024 lds
s_waitcnt lgkmcnt(5)
v_mfma_f32_16x16x32_bf16 v[128:131], v[96:99], a[16:19], v[128:131]
v_exp_f32 v69, v69
ds_read_b64_tr_b16 v[90:91], v12 offset:20480
v_mfma_f32_16x16x32_bf16 v[144:147], v[96:99], a[20:23], v[144:147]
v_exp_f32 v70, v70
ds_read_b64_tr_b16 v[92:93], v13 offset:4096
v_mfma_f32_16x16x32_bf16 v[132:135], v[100:103], a[16:19], v[132:135]
v_exp_f32 v71, v71
ds_read_b64_tr_b16 v[94:95], v13 offset:20480
v_mfma_f32_16x16x32_bf16 v[148:151], v[100:103], a[20:23], v[148:151]
ds_read_b64_tr_b16 v[96:97], v10 offset:5120
v_fma_f32 v68, v68, v62, v62
v_fma_f32 v69, v69, v62, v62
v_mfma_f32_16x16x32_bf16 v[136:139], v[104:107], a[16:19], v[136:139]
ds_read_b64_tr_b16 v[98:99], v10 offset:21504
v_fma_f32 v70, v70, v62, v62
v_fma_f32 v71, v71, v62, v62
v_mfma_f32_16x16x32_bf16 v[152:155], v[104:107], a[20:23], v[152:155]
buffer_load_dwordx4 v32, s[40:43], s77 offen offset:2048 lds
ds_read_b64_tr_b16 v[100:101], v11 offset:5120
v_mfma_f32_16x16x32_bf16 v[140:143], v[108:111], a[16:19], v[140:143]
v_rcp_f32 v68, v68
ds_read_b64_tr_b16 v[102:103], v11 offset:21504
v_mfma_f32_16x16x32_bf16 v[156:159], v[108:111], a[20:23], v[156:159]
v_rcp_f32 v69, v69
ds_read_b64_tr_b16 v[104:105], v12 offset:5120
v_mfma_f32_16x16x32_bf16 v[128:131], v[112:115], a[24:27], v[128:131]
v_rcp_f32 v70, v70
v_mfma_f32_16x16x32_bf16 v[144:147], v[112:115], a[28:31], v[144:147]
ds_read_b64_tr_b16 v[106:107], v12 offset:21504
ds_read_b64_tr_b16 v[108:109], v13 offset:5120
v_mfma_f32_16x16x32_bf16 v[132:135], v[116:119], a[24:27], v[132:135]
v_rcp_f32 v71, v71
v_mfma_f32_16x16x32_bf16 v[148:151], v[116:119], a[28:31], v[148:151]
ds_read_b64_tr_b16 v[110:111], v13 offset:21504
v_mul_f32 v224, v224, v68
v_mfma_f32_16x16x32_bf16 v[136:139], v[120:123], a[24:27], v[136:139]
buffer_load_dwordx4 v33, s[40:43], s77 offen offset:3072 lds
v_mfma_f32_16x16x32_bf16 v[152:155], v[120:123], a[28:31], v[152:155]
ds_read_b64_tr_b16 v[112:113], v10 offset:6144
ds_read_b64_tr_b16 v[114:115], v10 offset:22528
v_mfma_f32_16x16x32_bf16 v[140:143], v[124:127], a[24:27], v[140:143]
ds_read_b64_tr_b16 v[116:117], v11 offset:6144
v_mul_f32 v225, v225, v69
v_mfma_f32_16x16x32_bf16 v[156:159], v[124:127], a[28:31], v[156:159]
ds_read_b64_tr_b16 v[118:119], v11 offset:22528
s_waitcnt lgkmcnt(5)
v_mfma_f32_16x16x32_bf16 v[128:131], v[80:83], a[32:35], v[128:131]
ds_read_b64_tr_b16 v[120:121], v12 offset:6144
v_mul_f32 v226, v226, v70
v_mfma_f32_16x16x32_bf16 v[144:147], v[80:83], a[36:39], v[144:147]
ds_read_b64_tr_b16 v[122:123], v12 offset:22528
v_mul_f32 v227, v227, v71
v_mfma_f32_16x16x32_bf16 v[132:135], v[84:87], a[32:35], v[132:135]
ds_read_b64_tr_b16 v[124:125], v13 offset:6144
v_mul_f32 v72, v60, v228
v_mfma_f32_16x16x32_bf16 v[148:151], v[84:87], a[36:39], v[148:151]
ds_read_b64_tr_b16 v[126:127], v13 offset:22528
v_mul_f32 v73, v60, v229
v_mfma_f32_16x16x32_bf16 v[136:139], v[88:91], a[32:35], v[136:139]
ds_read_b64_tr_b16 v[80:81], v10 offset:7168
v_mul_f32 v74, v60, v230
v_mfma_f32_16x16x32_bf16 v[152:155], v[88:91], a[36:39], v[152:155]
ds_read_b64_tr_b16 v[82:83], v10 offset:23552
v_mul_f32 v75, v60, v231
v_mfma_f32_16x16x32_bf16 v[140:143], v[92:95], a[32:35], v[140:143]
v_exp_f32 v72, v72
v_mfma_f32_16x16x32_bf16 v[156:159], v[92:95], a[36:39], v[156:159]
ds_read_b64_tr_b16 v[84:85], v11 offset:7168
ds_read_b64_tr_b16 v[86:87], v11 offset:23552
v_mfma_f32_16x16x32_bf16 v[128:131], v[96:99], a[40:43], v[128:131]
v_exp_f32 v73, v73
v_mfma_f32_16x16x32_bf16 v[144:147], v[96:99], a[44:47], v[144:147]
ds_read_b64_tr_b16 v[88:89], v12 offset:7168
ds_read_b64_tr_b16 v[90:91], v12 offset:23552
v_mfma_f32_16x16x32_bf16 v[132:135], v[100:103], a[40:43], v[132:135]
v_exp_f32 v74, v74
v_mfma_f32_16x16x32_bf16 v[148:151], v[100:103], a[44:47], v[148:151]
ds_read_b64_tr_b16 v[92:93], v13 offset:7168
ds_read_b64_tr_b16 v[94:95], v13 offset:23552
v_mfma_f32_16x16x32_bf16 v[136:139], v[104:107], a[40:43], v[136:139]
v_exp_f32 v75, v75
v_mfma_f32_16x16x32_bf16 v[152:155], v[104:107], a[44:47], v[152:155]
v_fma_f32 v72, v72, v62, v62
s_waitcnt lgkmcnt(4)
v_mfma_f32_16x16x32_bf16 v[140:143], v[108:111], a[40:43], v[140:143]
v_fma_f32 v73, v73, v62, v62
v_fma_f32 v74, v74, v62, v62
v_mfma_f32_16x16x32_bf16 v[156:159], v[108:111], a[44:47], v[156:159]
v_fma_f32 v75, v75, v62, v62
v_mfma_f32_16x16x32_bf16 v[128:131], v[112:115], a[48:51], v[128:131]
s_waitcnt vmcnt(21) lgkmcnt(0)
s_barrier
v_mfma_f32_16x16x32_bf16 v[144:147], v[112:115], a[52:55], v[144:147]
ds_read_b64_tr_b16 v[96:97], v10 offset:32768
ds_read_b64_tr_b16 v[98:99], v10 offset:49152
v_mfma_f32_16x16x32_bf16 v[132:135], v[116:119], a[48:51], v[132:135]
ds_read_b64_tr_b16 v[100:101], v11 offset:32768
s_add_u32 m0, s76, 0
v_mfma_f32_16x16x32_bf16 v[148:151], v[116:119], a[52:55], v[148:151]
ds_read_b64_tr_b16 v[102:103], v11 offset:49152
s_add_u32 s77, s25, 0x0
v_mfma_f32_16x16x32_bf16 v[136:139], v[120:123], a[48:51], v[136:139]
ds_read_b64_tr_b16 v[104:105], v12 offset:32768
ds_read_b64_tr_b16 v[106:107], v12 offset:49152
v_mfma_f32_16x16x32_bf16 v[152:155], v[120:123], a[52:55], v[152:155]
buffer_load_dwordx4 v30, s[44:47], s77 offen offset:0 lds
v_mfma_f32_16x16x32_bf16 v[140:143], v[124:127], a[48:51], v[140:143]
ds_read_b64_tr_b16 v[108:109], v13 offset:32768
ds_read_b64_tr_b16 v[110:111], v13 offset:49152
v_mfma_f32_16x16x32_bf16 v[156:159], v[124:127], a[52:55], v[156:159]
v_rcp_f32 v72, v72
v_mfma_f32_16x16x32_bf16 v[128:131], v[80:83], a[56:59], v[128:131]
ds_read_b64_tr_b16 v[112:113], v10 offset:33792
ds_read_b64_tr_b16 v[114:115], v10 offset:50176
v_mfma_f32_16x16x32_bf16 v[144:147], v[80:83], a[60:63], v[144:147]
v_rcp_f32 v73, v73
v_mfma_f32_16x16x32_bf16 v[132:135], v[84:87], a[56:59], v[132:135]
ds_read_b64_tr_b16 v[116:117], v11 offset:33792
ds_read_b64_tr_b16 v[118:119], v11 offset:50176
v_mfma_f32_16x16x32_bf16 v[148:151], v[84:87], a[60:63], v[148:151]
buffer_load_dwordx4 v31, s[44:47], s77 offen offset:1024 lds
v_mfma_f32_16x16x32_bf16 v[136:139], v[88:91], a[56:59], v[136:139]
ds_read_b64_tr_b16 v[120:121], v12 offset:33792
ds_read_b64_tr_b16 v[122:123], v12 offset:50176
v_mfma_f32_16x16x32_bf16 v[152:155], v[88:91], a[60:63], v[152:155]
v_rcp_f32 v74, v74
v_mfma_f32_16x16x32_bf16 v[140:143], v[92:95], a[56:59], v[140:143]
ds_read_b64_tr_b16 v[124:125], v13 offset:33792
ds_read_b64_tr_b16 v[126:127], v13 offset:50176
v_mfma_f32_16x16x32_bf16 v[156:159], v[92:95], a[60:63], v[156:159]
ds_read_b64_tr_b16 v[80:81], v10 offset:34816
s_waitcnt lgkmcnt(7)
v_mfma_f32_16x16x32_bf16 v[128:131], v[96:99], a[64:67], v[128:131]
v_rcp_f32 v75, v75
v_mfma_f32_16x16x32_bf16 v[144:147], v[96:99], a[68:71], v[144:147]
ds_read_b64_tr_b16 v[82:83], v10 offset:51200
ds_read_b64_tr_b16 v[84:85], v11 offset:34816
v_mfma_f32_16x16x32_bf16 v[132:135], v[100:103], a[64:67], v[132:135]
buffer_load_dwordx4 v32, s[44:47], s77 offen offset:2048 lds
v_mfma_f32_16x16x32_bf16 v[148:151], v[100:103], a[68:71], v[148:151]
ds_read_b64_tr_b16 v[86:87], v11 offset:51200
ds_read_b64_tr_b16 v[88:89], v12 offset:34816
v_mfma_f32_16x16x32_bf16 v[136:139], v[104:107], a[64:67], v[136:139]
ds_read_b64_tr_b16 v[90:91], v12 offset:51200
v_mul_f32 v228, v228, v72
v_mfma_f32_16x16x32_bf16 v[152:155], v[104:107], a[68:71], v[152:155]
ds_read_b64_tr_b16 v[92:93], v13 offset:34816
ds_read_b64_tr_b16 v[94:95], v13 offset:51200
v_mfma_f32_16x16x32_bf16 v[140:143], v[108:111], a[64:67], v[140:143]
ds_read_b64_tr_b16 v[96:97], v10 offset:35840
v_mul_f32 v229, v229, v73
v_mfma_f32_16x16x32_bf16 v[156:159], v[108:111], a[68:71], v[156:159]
s_waitcnt vmcnt(6)
s_atomic_add s69, s[60:61], s24 offset:772
v_mfma_f32_16x16x32_bf16 v[128:131], v[112:115], a[72:75], v[128:131]
ds_read_b64_tr_b16 v[98:99], v10 offset:52224
ds_read_b64_tr_b16 v[100:101], v11 offset:35840
v_mfma_f32_16x16x32_bf16 v[144:147], v[112:115], a[76:79], v[144:147]
ds_read_b64_tr_b16 v[102:103], v11 offset:52224
s_waitcnt lgkmcnt(7)
v_mfma_f32_16x16x32_bf16 v[132:135], v[116:119], a[72:75], v[132:135]
buffer_load_dwordx4 v33, s[44:47], s77 offen offset:3072 lds
v_mfma_f32_16x16x32_bf16 v[148:151], v[116:119], a[76:79], v[148:151]
ds_read_b64_tr_b16 v[104:105], v12 offset:35840
ds_read_b64_tr_b16 v[106:107], v12 offset:52224
v_mfma_f32_16x16x32_bf16 v[136:139], v[120:123], a[72:75], v[136:139]
ds_read_b64_tr_b16 v[108:109], v13 offset:35840
v_mul_f32 v230, v230, v74
v_mfma_f32_16x16x32_bf16 v[152:155], v[120:123], a[76:79], v[152:155]
ds_read_b64_tr_b16 v[110:111], v13 offset:52224
s_add_u32 m0, s76, 4096
v_mfma_f32_16x16x32_bf16 v[140:143], v[124:127], a[72:75], v[140:143]
ds_read_b64_tr_b16 v[112:113], v10 offset:36864
s_add_u32 s77, s25, 0xe0000
v_mfma_f32_16x16x32_bf16 v[156:159], v[124:127], a[76:79], v[156:159]
ds_read_b64_tr_b16 v[114:115], v10 offset:53248
ds_read_b64_tr_b16 v[116:117], v11 offset:36864
v_mfma_f32_16x16x32_bf16 v[128:131], v[80:83], a[80:83], v[128:131]
buffer_load_dwordx4 v30, s[44:47], s77 offen offset:0 lds
v_mfma_f32_16x16x32_bf16 v[144:147], v[80:83], a[84:87], v[144:147]
ds_read_b64_tr_b16 v[118:119], v11 offset:53248
ds_read_b64_tr_b16 v[120:121], v12 offset:36864
v_mfma_f32_16x16x32_bf16 v[132:135], v[84:87], a[80:83], v[132:135]
ds_read_b64_tr_b16 v[122:123], v12 offset:53248
v_mul_f32 v231, v231, v75
v_mfma_f32_16x16x32_bf16 v[148:151], v[84:87], a[84:87], v[148:151]
ds_read_b64_tr_b16 v[124:125], v13 offset:36864
s_waitcnt lgkmcnt(7)
v_mfma_f32_16x16x32_bf16 v[136:139], v[88:91], a[80:83], v[136:139]
ds_read_b64_tr_b16 v[126:127], v13 offset:53248
ds_read_b64_tr_b16 v[80:81], v10 offset:37888
v_mfma_f32_16x16x32_bf16 v[152:155], v[88:91], a[84:87], v[152:155]
ds_read_b64_tr_b16 v[82:83], v10 offset:54272
v_mul_f32 v68, v61, v240
v_mfma_f32_16x16x32_bf16 v[140:143], v[92:95], a[80:83], v[140:143]
buffer_load_dwordx4 v31, s[44:47], s77 offen offset:1024 lds
v_mfma_f32_16x16x32_bf16 v[156:159], v[92:95], a[84:87], v[156:159]
ds_read_b64_tr_b16 v[84:85], v11 offset:37888
ds_read_b64_tr_b16 v[86:87], v11 offset:54272
v_mfma_f32_16x16x32_bf16 v[128:131], v[96:99], a[88:91], v[128:131]
ds_read_b64_tr_b16 v[88:89], v12 offset:37888
v_mul_f32 v69, v61, v241
v_mfma_f32_16x16x32_bf16 v[144:147], v[96:99], a[92:95], v[144:147]
ds_read_b64_tr_b16 v[90:91], v12 offset:54272
v_mul_f32 v70, v61, v242
v_mfma_f32_16x16x32_bf16 v[132:135], v[100:103], a[88:91], v[132:135]
ds_read_b64_tr_b16 v[92:93], v13 offset:37888
v_mul_f32 v71, v61, v243
v_mfma_f32_16x16x32_bf16 v[148:151], v[100:103], a[92:95], v[148:151]
v_exp_f32 v68, v68
v_mfma_f32_16x16x32_bf16 v[136:139], v[104:107], a[88:91], v[136:139]
ds_read_b64_tr_b16 v[94:95], v13 offset:54272
ds_read_b64_tr_b16 v[96:97], v10 offset:38912
v_mfma_f32_16x16x32_bf16 v[152:155], v[104:107], a[92:95], v[152:155]
buffer_load_dwordx4 v32, s[44:47], s77 offen offset:2048 lds
v_mfma_f32_16x16x32_bf16 v[140:143], v[108:111], a[88:91], v[140:143]
ds_read_b64_tr_b16 v[98:99], v10 offset:55296
ds_read_b64_tr_b16 v[100:101], v11 offset:38912
v_mfma_f32_16x16x32_bf16 v[156:159], v[108:111], a[92:95], v[156:159]
ds_read_b64_tr_b16 v[102:103], v11 offset:55296
s_waitcnt lgkmcnt(6)
v_mfma_f32_16x16x32_bf16 v[128:131], v[112:115], a[96:99], v[128:131]
v_exp_f32 v69, v69
v_mfma_f32_16x16x32_bf16 v[144:147], v[112:115], a[100:103], v[144:147]
ds_read_b64_tr_b16 v[104:105], v12 offset:38912
ds_read_b64_tr_b16 v[106:107], v12 offset:55296
v_mfma_f32_16x16x32_bf16 v[132:135], v[116:119], a[96:99], v[132:135]
v_exp_f32 v70, v70
v_mfma_f32_16x16x32_bf16 v[148:151], v[116:119], a[100:103], v[148:151]
ds_read_b64_tr_b16 v[108:109], v13 offset:38912
ds_read_b64_tr_b16 v[110:111], v13 offset:55296
v_mfma_f32_16x16x32_bf16 v[136:139], v[120:123], a[96:99], v[136:139]
buffer_load_dwordx4 v33, s[44:47], s77 offen offset:3072 lds
v_mfma_f32_16x16x32_bf16 v[152:155], v[120:123], a[100:103], v[152:155]
ds_read_b64_tr_b16 v[112:113], v10 offset:39936
ds_read_b64_tr_b16 v[114:115], v10 offset:56320
v_mfma_f32_16x16x32_bf16 v[140:143], v[124:127], a[96:99], v[140:143]
v_exp_f32 v71, v71
v_mfma_f32_16x16x32_bf16 v[156:159], v[124:127], a[100:103], v[156:159]
ds_read_b64_tr_b16 v[116:117], v11 offset:39936
ds_read_b64_tr_b16 v[118:119], v11 offset:56320
v_mfma_f32_16x16x32_bf16 v[128:131], v[80:83], a[104:107], v[128:131]
ds_read_b64_tr_b16 v[120:121], v12 offset:39936
v_fma_f32 v68, v68, v63, v63
v_mfma_f32_16x16x32_bf16 v[144:147], v[80:83], a[108:111], v[144:147]
ds_read_b64_tr_b16 v[122:123], v12 offset:56320
v_fma_f32 v69, v69, v63, v63
v_mfma_f32_16x16x32_bf16 v[132:135], v[84:87], a[104:107], v[132:135]
ds_read_b64_tr_b16 v[124:125], v13 offset:39936
v_fma_f32 v70, v70, v63, v63
v_mfma_f32_16x16x32_bf16 v[148:151], v[84:87], a[108:111], v[148:151]
ds_read_b64_tr_b16 v[126:127], v13 offset:56320
v_fma_f32 v71, v71, v63, v63
v_mfma_f32_16x16x32_bf16 v[136:139], v[88:91], a[104:107], v[136:139]
v_rcp_f32 v68, v68
v_mfma_f32_16x16x32_bf16 v[152:155], v[88:91], a[108:111], v[152:155]
s_waitcnt lgkmcnt(4)
v_mfma_f32_16x16x32_bf16 v[140:143], v[92:95], a[104:107], v[140:143]
v_rcp_f32 v69, v69
v_mfma_f32_16x16x32_bf16 v[156:159], v[92:95], a[108:111], v[156:159]
v_rcp_f32 v70, v70
v_mfma_f32_16x16x32_bf16 v[128:131], v[96:99], a[112:115], v[128:131]
s_waitcnt lgkmcnt(0)
s_barrier
v_mfma_f32_16x16x32_bf16 v[144:147], v[96:99], a[116:119], v[144:147]
ds_read_b64_tr_b16 v[80:81], v14 offset:0
ds_read_b64_tr_b16 v[82:83], v14 offset:16384
v_mfma_f32_16x16x32_bf16 v[132:135], v[100:103], a[112:115], v[132:135]
ds_read_b64_tr_b16 v[84:85], v15 offset:0
s_add_u32 m0, s76, 32768
v_mfma_f32_16x16x32_bf16 v[148:151], v[100:103], a[116:119], v[148:151]
ds_read_b64_tr_b16 v[86:87], v15 offset:16384
s_add_u32 s77, s25, 0x1c0000
v_mfma_f32_16x16x32_bf16 v[136:139], v[104:107], a[112:115], v[136:139]
ds_read_b64_tr_b16 v[88:89], v16 offset:0
ds_read_b64_tr_b16 v[90:91], v16 offset:16384
v_mfma_f32_16x16x32_bf16 v[152:155], v[104:107], a[116:119], v[152:155]
buffer_load_dwordx4 v30, s[44:47], s77 offen offset:0 lds
v_mfma_f32_16x16x32_bf16 v[140:143], v[108:111], a[112:115], v[140:143]
ds_read_b64_tr_b16 v[92:93], v17 offset:0
ds_read_b64_tr_b16 v[94:95], v17 offset:16384
v_mfma_f32_16x16x32_bf16 v[156:159], v[108:111], a[116:119], v[156:159]
v_rcp_f32 v71, v71
v_mfma_f32_16x16x32_bf16 v[128:131], v[112:115], a[120:123], v[128:131]
ds_read_b64_tr_b16 v[96:97], v14 offset:1024
ds_read_b64_tr_b16 v[98:99], v14 offset:17408
v_mfma_f32_16x16x32_bf16 v[144:147], v[112:115], a[124:127], v[144:147]
ds_read_b64_tr_b16 v[100:101], v15 offset:1024
v_mul_f32 v240, v240, v68
v_mfma_f32_16x16x32_bf16 v[132:135], v[116:119], a[120:123], v[132:135]
ds_read_b64_tr_b16 v[102:103], v15 offset:17408
ds_read_b64_tr_b16 v[104:105], v16 offset:1024
v_mfma_f32_16x16x32_bf16 v[148:151], v[116:119], a[124:127], v[148:151]
buffer_load_dwordx4 v31, s[44:47], s77 offen offset:1024 lds
v_mfma_f32_16x16x32_bf16 v[136:139], v[120:123], a[120:123], v[136:139]
ds_read_b64_tr_b16 v[106:107], v16 offset:17408
ds_read_b64_tr_b16 v[108:109], v17 offset:1024
v_mfma_f32_16x16x32_bf16 v[152:155], v[120:123], a[124:127], v[152:155]
ds_read_b64_tr_b16 v[110:111], v17 offset:17408
v_mul_f32 v241, v241, v69
v_mfma_f32_16x16x32_bf16 v[140:143], v[124:127], a[120:123], v[140:143]
ds_read_b64_tr_b16 v[112:113], v14 offset:2048
ds_read_b64_tr_b16 v[114:115], v14 offset:18432
v_mfma_f32_16x16x32_bf16 v[156:159], v[124:127], a[124:127], v[156:159]
ds_read_b64_tr_b16 v[116:117], v15 offset:2048
s_waitcnt lgkmcnt(8)
v_mfma_f32_16x16x32_bf16 v[128:131], v[80:83], a[128:131], v[128:131]
ds_read_b64_tr_b16 v[118:119], v15 offset:18432
ds_read_b64_tr_b16 v[120:121], v16 offset:2048
v_mfma_f32_16x16x32_bf16 v[144:147], v[80:83], a[132:135], v[144:147]
buffer_load_dwordx4 v32, s[44:47], s77 offen offset:2048 lds
v_mfma_f32_16x16x32_bf16 v[132:135], v[84:87], a[128:131], v[132:135]
ds_read_b64_tr_b16 v[122:123], v16 offset:18432
ds_read_b64_tr_b16 v[124:125], v17 offset:2048
v_mfma_f32_16x16x32_bf16 v[148:151], v[84:87], a[132:135], v[148:151]
ds_read_b64_tr_b16 v[126:127], v17 offset:18432
v_mul_f32 v242, v242, v70
v_mfma_f32_16x16x32_bf16 v[136:139], v[88:91], a[128:131], v[136:139]
ds_read_b64_tr_b16 v[80:81], v14 offset:3072
v_mul_f32 v243, v243, v71
v_mfma_f32_16x16x32_bf16 v[152:155], v[88:91], a[132:135], v[152:155]
ds_read_b64_tr_b16 v[82:83], v14 offset:19456
v_mul_f32 v72, v61, v244
v_mfma_f32_16x16x32_bf16 v[140:143], v[92:95], a[128:131], v[140:143]
ds_read_b64_tr_b16 v[84:85], v15 offset:3072
v_mul_f32 v73, v61, v245
v_mfma_f32_16x16x32_bf16 v[156:159], v[92:95], a[132:135], v[156:159]
buffer_load_dwordx4 v33, s[44:47], s77 offen offset:3072 lds
v_mfma_f32_16x16x32_bf16 v[128:131], v[96:99], a[136:139], v[128:131]
ds_read_b64_tr_b16 v[86:87], v15 offset:19456
ds_read_b64_tr_b16 v[88:89], v16 offset:3072
v_mfma_f32_16x16x32_bf16 v[144:147], v[96:99], a[140:143], v[144:147]
ds_read_b64_tr_b16 v[90:91], v16 offset:19456
s_waitcnt lgkmcnt(6)
v_mfma_f32_16x16x32_bf16 v[132:135], v[100:103], a[136:139], v[132:135]
ds_read_b64_tr_b16 v[92:93], v17 offset:3072
s_add_u32 m0, s76, 36864
v_mfma_f32_16x16x32_bf16 v[148:151], v[100:103], a[140:143], v[148:151]
ds_read_b64_tr_b16 v[94:95], v17 offset:19456
s_add_u32 s77, s25, 0x2a0000
v_mfma_f32_16x16x32_bf16 v[136:139], v[104:107], a[136:139], v[136:139]
ds_read_b64_tr_b16 v[96:97], v14 offset:4096
v_mul_f32 v74, v61, v246
v_mfma_f32_16x16x32_bf16 v[152:155], v[104:107], a[140:143], v[152:155]
buffer_load_dwordx4 v30, s[44:47], s77 offen offset:0 lds
v_mfma_f32_16x16x32_bf16 v[140:143], v[108:111], a[136:139], v[140:143]
ds_read_b64_tr_b16 v[98:99], v14 offset:20480
ds_read_b64_tr_b16 v[100:101], v15 offset:4096
v_mfma_f32_16x16x32_bf16 v[156:159], v[108:111], a[140:143], v[156:159]
ds_read_b64_tr_b16 v[102:103], v15 offset:20480
v_mul_f32 v75, v61, v247
v_mfma_f32_16x16x32_bf16 v[128:131], v[112:115], a[144:147], v[128:131]
v_exp_f32 v72, v72
v_mfma_f32_16x16x32_bf16 v[144:147], v[112:115], a[148:151], v[144:147]
ds_read_b64_tr_b16 v[104:105], v16 offset:4096
ds_read_b64_tr_b16 v[106:107], v16 offset:20480
v_mfma_f32_16x16x32_bf16 v[132:135], v[116:119], a[144:147], v[132:135]
v_exp_f32 v73, v73
v_mfma_f32_16x16x32_bf16 v[148:151], v[116:119], a[148:151], v[148:151]
ds_read_b64_tr_b16 v[108:109], v17 offset:4096
ds_read_b64_tr_b16 v[110:111], v17 offset:20480
v_mfma_f32_16x16x32_bf16 v[136:139], v[120:123], a[144:147], v[136:139]
buffer_load_dwordx4 v31, s[44:47], s77 offen offset:1024 lds
v_mfma_f32_16x16x32_bf16 v[152:155], v[120:123], a[148:151], v[152:155]
ds_read_b64_tr_b16 v[112:113], v14 offset:5120
ds_read_b64_tr_b16 v[114:115], v14 offset:21504
v_mfma_f32_16x16x32_bf16 v[140:143], v[124:127], a[144:147], v[140:143]
v_exp_f32 v74, v74
v_mfma_f32_16x16x32_bf16 v[156:159], v[124:127], a[148:151], v[156:159]
ds_read_b64_tr_b16 v[116:117], v15 offset:5120
s_waitcnt lgkmcnt(5)
v_mfma_f32_16x16x32_bf16 v[128:131], v[80:83], a[152:155], v[128:131]
v_exp_f32 v75, v75
v_mfma_f32_16x16x32_bf16 v[144:147], v[80:83], a[156:159], v[144:147]
ds_read_b64_tr_b16 v[118:119], v15 offset:21504
ds_read_b64_tr_b16 v[120:121], v16 offset:5120
v_mfma_f32_16x16x32_bf16 v[132:135], v[84:87], a[152:155], v[132:135]
buffer_load_dwordx4 v32, s[44:47], s77 offen offset:2048 lds
v_mfma_f32_16x16x32_bf16 v[148:151], v[84:87], a[156:159], v[148:151]
ds_read_b64_tr_b16 v[122:123], v16 offset:21504
ds_read_b64_tr_b16 v[124:125], v17 offset:5120
v_mfma_f32_16x16x32_bf16 v[136:139], v[88:91], a[152:155], v[136:139]
ds_read_b64_tr_b16 v[126:127], v17 offset:21504
v_fma_f32 v72, v72, v63, v63
v_mfma_f32_16x16x32_bf16 v[152:155], v[88:91], a[156:159], v[152:155]
ds_read_b64_tr_b16 v[80:81], v14 offset:6144
ds_read_b64_tr_b16 v[82:83], v14 offset:22528
v_mfma_f32_16x16x32_bf16 v[140:143], v[92:95], a[152:155], v[140:143]
ds_read_b64_tr_b16 v[84:85], v15 offset:6144
v_fma_f32 v73, v73, v63, v63
v_mfma_f32_16x16x32_bf16 v[156:159], v[92:95], a[156:159], v[156:159]
ds_read_b64_tr_b16 v[86:87], v15 offset:22528
v_fma_f32 v74, v74, v63, v63
v_mfma_f32_16x16x32_bf16 v[128:131], v[96:99], a[160:163], v[128:131]
buffer_load_dwordx4 v33, s[44:47], s77 offen offset:3072 lds
v_mfma_f32_16x16x32_bf16 v[144:147], v[96:99], a[164:167], v[144:147]
ds_read_b64_tr_b16 v[88:89], v16 offset:6144
ds_read_b64_tr_b16 v[90:91], v16 offset:22528
v_mfma_f32_16x16x32_bf16 v[132:135], v[100:103], a[160:163], v[132:135]
ds_read_b64_tr_b16 v[92:93], v17 offset:6144
v_fma_f32 v75, v75, v63, v63
v_mfma_f32_16x16x32_bf16 v[148:151], v[100:103], a[164:167], v[148:151]
v_rcp_f32 v72, v72
v_mfma_f32_16x16x32_bf16 v[136:139], v[104:107], a[160:163], v[136:139]
ds_read_b64_tr_b16 v[94:95], v17 offset:22528
ds_read_b64_tr_b16 v[96:97], v14 offset:7168
v_mfma_f32_16x16x32_bf16 v[152:155], v[104:107], a[164:167], v[152:155]
ds_read_b64_tr_b16 v[98:99], v14 offset:23552
s_waitcnt lgkmcnt(6)
v_mfma_f32_16x16x32_bf16 v[140:143], v[108:111], a[160:163], v[140:143]
v_rcp_f32 v73, v73
v_mfma_f32_16x16x32_bf16 v[156:159], v[108:111], a[164:167], v[156:159]
ds_read_b64_tr_b16 v[100:101], v15 offset:7168
ds_read_b64_tr_b16 v[102:103], v15 offset:23552
v_mfma_f32_16x16x32_bf16 v[128:131], v[112:115], a[168:171], v[128:131]
v_rcp_f32 v74, v74
v_mfma_f32_16x16x32_bf16 v[144:147], v[112:115], a[172:175], v[144:147]
ds_read_b64_tr_b16 v[104:105], v16 offset:7168
ds_read_b64_tr_b16 v[106:107], v16 offset:23552
v_mfma_f32_16x16x32_bf16 v[132:135], v[116:119], a[168:171], v[132:135]
v_rcp_f32 v75, v75
v_mfma_f32_16x16x32_bf16 v[148:151], v[116:119], a[172:175], v[148:151]
ds_read_b64_tr_b16 v[108:109], v17 offset:7168
ds_read_b64_tr_b16 v[110:111], v17 offset:23552
v_mfma_f32_16x16x32_bf16 v[136:139], v[120:123], a[168:171], v[136:139]
v_mul_f32 v244, v244, v72
v_mul_f32 v245, v245, v73
v_mfma_f32_16x16x32_bf16 v[152:155], v[120:123], a[172:175], v[152:155]
v_mul_f32 v246, v246, v74
v_mul_f32 v247, v247, v75
v_mfma_f32_16x16x32_bf16 v[140:143], v[124:127], a[168:171], v[140:143]
v_mul_f32 v232, v232, v224
v_mul_f32 v233, v233, v225
v_mfma_f32_16x16x32_bf16 v[156:159], v[124:127], a[172:175], v[156:159]
v_mul_f32 v234, v234, v226
v_mul_f32 v235, v235, v227
v_mfma_f32_16x16x32_bf16 v[128:131], v[80:83], a[176:179], v[128:131]
s_waitcnt vmcnt(16) lgkmcnt(0)
s_barrier
v_mfma_f32_16x16x32_bf16 v[144:147], v[80:83], a[180:183], v[144:147]
ds_read_b64_tr_b16 v[112:113], v14 offset:32768
ds_read_b64_tr_b16 v[114:115], v14 offset:49152
v_mfma_f32_16x16x32_bf16 v[132:135], v[84:87], a[176:179], v[132:135]
ds_read_b64_tr_b16 v[116:117], v15 offset:32768
s_add_u32 m0, s76, 65536
v_mfma_f32_16x16x32_bf16 v[148:151], v[84:87], a[180:183], v[148:151]
ds_read_b64_tr_b16 v[118:119], v15 offset:49152
s_add_u32 s77, s25, 0x380000
v_mfma_f32_16x16x32_bf16 v[136:139], v[88:91], a[176:179], v[136:139]
ds_read_b64_tr_b16 v[120:121], v16 offset:32768
ds_read_b64_tr_b16 v[122:123], v16 offset:49152
v_mfma_f32_16x16x32_bf16 v[152:155], v[88:91], a[180:183], v[152:155]
buffer_load_dwordx4 v30, s[44:47], s77 offen offset:0 lds
v_mfma_f32_16x16x32_bf16 v[140:143], v[92:95], a[176:179], v[140:143]
ds_read_b64_tr_b16 v[124:125], v17 offset:32768
ds_read_b64_tr_b16 v[126:127], v17 offset:49152
v_mfma_f32_16x16x32_bf16 v[156:159], v[92:95], a[180:183], v[156:159]
ds_read_b64_tr_b16 v[80:81], v14 offset:33792
v_mul_f32 v236, v236, v228
v_mfma_f32_16x16x32_bf16 v[128:131], v[96:99], a[184:187], v[128:131]
ds_read_b64_tr_b16 v[82:83], v14 offset:50176
ds_read_b64_tr_b16 v[84:85], v15 offset:33792
v_mfma_f32_16x16x32_bf16 v[144:147], v[96:99], a[188:191], v[144:147]
ds_read_b64_tr_b16 v[86:87], v15 offset:50176
v_mul_f32 v237, v237, v229
v_mfma_f32_16x16x32_bf16 v[132:135], v[100:103], a[184:187], v[132:135]
ds_read_b64_tr_b16 v[88:89], v16 offset:33792
ds_read_b64_tr_b16 v[90:91], v16 offset:50176
v_mfma_f32_16x16x32_bf16 v[148:151], v[100:103], a[188:191], v[148:151]
buffer_load_dwordx4 v31, s[44:47], s77 offen offset:1024 lds
v_mfma_f32_16x16x32_bf16 v[136:139], v[104:107], a[184:187], v[136:139]
ds_read_b64_tr_b16 v[92:93], v17 offset:33792
ds_read_b64_tr_b16 v[94:95], v17 offset:50176
v_mfma_f32_16x16x32_bf16 v[152:155], v[104:107], a[188:191], v[152:155]
ds_read_b64_tr_b16 v[96:97], v14 offset:34816
v_mul_f32 v238, v238, v230
v_mfma_f32_16x16x32_bf16 v[140:143], v[108:111], a[184:187], v[140:143]
ds_read_b64_tr_b16 v[98:99], v14 offset:51200
ds_read_b64_tr_b16 v[100:101], v15 offset:34816
v_mfma_f32_16x16x32_bf16 v[156:159], v[108:111], a[188:191], v[156:159]
ds_read_b64_tr_b16 v[102:103], v15 offset:51200
s_waitcnt lgkmcnt(8)
v_mfma_f32_16x16x32_bf16 v[128:131], v[112:115], a[192:195], v[128:131]
ds_read_b64_tr_b16 v[104:105], v16 offset:34816
v_mul_f32 v239, v239, v231
v_mfma_f32_16x16x32_bf16 v[144:147], v[112:115], a[196:199], v[144:147]
buffer_load_dwordx4 v32, s[44:47], s77 offen offset:2048 lds
v_mfma_f32_16x16x32_bf16 v[132:135], v[116:119], a[192:195], v[132:135]
ds_read_b64_tr_b16 v[106:107], v16 offset:51200
ds_read_b64_tr_b16 v[108:109], v17 offset:34816
v_mfma_f32_16x16x32_bf16 v[148:151], v[116:119], a[196:199], v[148:151]
ds_read_b64_tr_b16 v[110:111], v17 offset:51200
v_cvt_pk_bf16_f32 v232, v232, v233
v_mfma_f32_16x16x32_bf16 v[136:139], v[120:123], a[192:195], v[136:139]
ds_read_b64_tr_b16 v[112:113], v14 offset:35840
v_cvt_pk_bf16_f32 v233, v234, v235
v_mfma_f32_16x16x32_bf16 v[152:155], v[120:123], a[196:199], v[152:155]
ds_read_b64_tr_b16 v[114:115], v14 offset:52224
v_cvt_pk_bf16_f32 v234, v236, v237
v_mfma_f32_16x16x32_bf16 v[140:143], v[124:127], a[192:195], v[140:143]
ds_read_b64_tr_b16 v[116:117], v15 offset:35840
v_cvt_pk_bf16_f32 v235, v238, v239
v_mfma_f32_16x16x32_bf16 v[156:159], v[124:127], a[196:199], v[156:159]
buffer_load_dwordx4 v33, s[44:47], s77 offen offset:3072 lds
v_mfma_f32_16x16x32_bf16 v[128:131], v[80:83], a[200:203], v[128:131]
ds_read_b64_tr_b16 v[118:119], v15 offset:52224
ds_read_b64_tr_b16 v[120:121], v16 offset:35840
v_mfma_f32_16x16x32_bf16 v[144:147], v[80:83], a[204:207], v[144:147]
buffer_store_dwordx4 v[232:235], v46, s[60:63], s5 offen offset:0 sc1
v_mfma_f32_16x16x32_bf16 v[132:135], v[84:87], a[200:203], v[132:135]
ds_read_b64_tr_b16 v[122:123], v16 offset:52224
ds_read_b64_tr_b16 v[124:125], v17 offset:35840
v_mfma_f32_16x16x32_bf16 v[148:151], v[84:87], a[204:207], v[148:151]
ds_read_b64_tr_b16 v[126:127], v17 offset:52224
s_waitcnt lgkmcnt(6)
v_mfma_f32_16x16x32_bf16 v[136:139], v[88:91], a[200:203], v[136:139]
ds_read_b64_tr_b16 v[80:81], v14 offset:36864
s_add_u32 m0, s76, 69632
v_mfma_f32_16x16x32_bf16 v[152:155], v[88:91], a[204:207], v[152:155]
ds_read_b64_tr_b16 v[82:83], v14 offset:53248
s_add_u32 s77, s25, 0x460000
v_mfma_f32_16x16x32_bf16 v[140:143], v[92:95], a[200:203], v[140:143]
buffer_load_dwordx4 v30, s[44:47], s77 offen offset:0 lds
v_mfma_f32_16x16x32_bf16 v[156:159], v[92:95], a[204:207], v[156:159]
ds_read_b64_tr_b16 v[84:85], v15 offset:36864
ds_read_b64_tr_b16 v[86:87], v15 offset:53248
v_mfma_f32_16x16x32_bf16 v[128:131], v[96:99], a[208:211], v[128:131]
ds_read_b64_tr_b16 v[88:89], v16 offset:36864
v_mul_f32 v248, v248, v240
v_mfma_f32_16x16x32_bf16 v[144:147], v[96:99], a[212:215], v[144:147]
ds_read_b64_tr_b16 v[90:91], v16 offset:53248
v_mul_f32 v249, v249, v241
v_mfma_f32_16x16x32_bf16 v[132:135], v[100:103], a[208:211], v[132:135]
ds_read_b64_tr_b16 v[92:93], v17 offset:36864
v_mul_f32 v250, v250, v242
v_mfma_f32_16x16x32_bf16 v[148:151], v[100:103], a[212:215], v[148:151]
ds_read_b64_tr_b16 v[94:95], v17 offset:53248
v_mul_f32 v251, v251, v243
v_mfma_f32_16x16x32_bf16 v[136:139], v[104:107], a[208:211], v[136:139]
buffer_load_dwordx4 v31, s[44:47], s77 offen offset:1024 lds
v_mfma_f32_16x16x32_bf16 v[152:155], v[104:107], a[212:215], v[152:155]
ds_read_b64_tr_b16 v[96:97], v14 offset:37888
ds_read_b64_tr_b16 v[98:99], v14 offset:54272
v_mfma_f32_16x16x32_bf16 v[140:143], v[108:111], a[208:211], v[140:143]
ds_read_b64_tr_b16 v[100:101], v15 offset:37888
v_mul_f32 v252, v252, v244
v_mfma_f32_16x16x32_bf16 v[156:159], v[108:111], a[212:215], v[156:159]
ds_read_b64_tr_b16 v[102:103], v15 offset:54272
v_mul_f32 v253, v253, v245
v_mfma_f32_16x16x32_bf16 v[128:131], v[112:115], a[216:219], v[128:131]
ds_read_b64_tr_b16 v[104:105], v16 offset:37888
v_mul_f32 v254, v254, v246
v_mfma_f32_16x16x32_bf16 v[144:147], v[112:115], a[220:223], v[144:147]
ds_read_b64_tr_b16 v[106:107], v16 offset:54272
s_waitcnt lgkmcnt(6)
v_mfma_f32_16x16x32_bf16 v[132:135], v[116:119], a[216:219], v[132:135]
buffer_load_dwordx4 v32, s[44:47], s77 offen offset:2048 lds
v_mfma_f32_16x16x32_bf16 v[148:151], v[116:119], a[220:223], v[148:151]
ds_read_b64_tr_b16 v[108:109], v17 offset:37888
ds_read_b64_tr_b16 v[110:111], v17 offset:54272
v_mfma_f32_16x16x32_bf16 v[136:139], v[120:123], a[216:219], v[136:139]
ds_read_b64_tr_b16 v[112:113], v14 offset:38912
v_mul_f32 v255, v255, v247
v_mfma_f32_16x16x32_bf16 v[152:155], v[120:123], a[220:223], v[152:155]
ds_read_b64_tr_b16 v[114:115], v14 offset:55296
v_cvt_pk_bf16_f32 v248, v248, v249
v_mfma_f32_16x16x32_bf16 v[140:143], v[124:127], a[216:219], v[140:143]
ds_read_b64_tr_b16 v[116:117], v15 offset:38912
v_cvt_pk_bf16_f32 v249, v250, v251
v_mfma_f32_16x16x32_bf16 v[156:159], v[124:127], a[220:223], v[156:159]
ds_read_b64_tr_b16 v[118:119], v15 offset:55296
v_cvt_pk_bf16_f32 v250, v252, v253
v_mfma_f32_16x16x32_bf16 v[128:131], v[80:83], a[224:227], v[128:131]
buffer_load_dwordx4 v33, s[44:47], s77 offen offset:3072 lds
v_mfma_f32_16x16x32_bf16 v[144:147], v[80:83], a[228:231], v[144:147]
ds_read_b64_tr_b16 v[120:121], v16 offset:38912
ds_read_b64_tr_b16 v[122:123], v16 offset:55296
v_mfma_f32_16x16x32_bf16 v[132:135], v[84:87], a[224:227], v[132:135]
ds_read_b64_tr_b16 v[124:125], v17 offset:38912
v_cvt_pk_bf16_f32 v251, v254, v255
v_mfma_f32_16x16x32_bf16 v[148:151], v[84:87], a[228:231], v[148:151]
buffer_store_dwordx4 v[248:251], v46, s[60:63], s5 offen offset:1024 sc1
v_mfma_f32_16x16x32_bf16 v[136:139], v[88:91], a[224:227], v[136:139]
ds_read_b64_tr_b16 v[126:127], v17 offset:55296
ds_read_b64_tr_b16 v[80:81], v14 offset:39936
v_mfma_f32_16x16x32_bf16 v[152:155], v[88:91], a[228:231], v[152:155]
ds_read_b64_tr_b16 v[82:83], v14 offset:56320
v_mfma_f32_16x16x32_bf16 v[140:143], v[92:95], a[224:227], v[140:143]
ds_read_b64_tr_b16 v[84:85], v15 offset:39936
ds_read_b64_tr_b16 v[86:87], v15 offset:56320
v_mfma_f32_16x16x32_bf16 v[156:159], v[92:95], a[228:231], v[156:159]
ds_read_b64_tr_b16 v[88:89], v16 offset:39936
s_waitcnt lgkmcnt(7)
v_mfma_f32_16x16x32_bf16 v[128:131], v[96:99], a[232:235], v[128:131]
ds_read_b64_tr_b16 v[90:91], v16 offset:56320
ds_read_b64_tr_b16 v[92:93], v17 offset:39936
v_mfma_f32_16x16x32_bf16 v[144:147], v[96:99], a[236:239], v[144:147]
ds_read_b64_tr_b16 v[94:95], v17 offset:56320
v_mfma_f32_16x16x32_bf16 v[132:135], v[100:103], a[232:235], v[132:135]
v_mfma_f32_16x16x32_bf16 v[148:151], v[100:103], a[236:239], v[148:151]
v_mfma_f32_16x16x32_bf16 v[136:139], v[104:107], a[232:235], v[136:139]
v_mfma_f32_16x16x32_bf16 v[152:155], v[104:107], a[236:239], v[152:155]
v_mfma_f32_16x16x32_bf16 v[140:143], v[108:111], a[232:235], v[140:143]
s_waitcnt vmcnt(18) lgkmcnt(0)
s_barrier
v_mfma_f32_16x16x32_bf16 v[156:159], v[108:111], a[236:239], v[156:159]
ds_read_b64_tr_b16 v[96:97], v10 offset:0
ds_read_b64_tr_b16 v[98:99], v10 offset:16384
v_mfma_f32_16x16x32_bf16 v[128:131], v[112:115], a[240:243], v[128:131]
ds_read_b64_tr_b16 v[100:101], v11 offset:0
s_add_u32 m0, s76, 98304
v_mfma_f32_16x16x32_bf16 v[144:147], v[112:115], a[244:247], v[144:147]
ds_read_b64_tr_b16 v[102:103], v11 offset:16384
s_add_u32 s77, s25, 0x540000
v_mfma_f32_16x16x32_bf16 v[132:135], v[116:119], a[240:243], v[132:135]
buffer_load_dwordx4 v30, s[44:47], s77 offen offset:0 lds
v_mfma_f32_16x16x32_bf16 v[148:151], v[116:119], a[244:247], v[148:151]
ds_read_b64_tr_b16 v[104:105], v12 offset:0
ds_read_b64_tr_b16 v[106:107], v12 offset:16384
v_mfma_f32_16x16x32_bf16 v[136:139], v[120:123], a[240:243], v[136:139]
ds_read_b64_tr_b16 v[108:109], v13 offset:0
v_mfma_f32_16x16x32_bf16 v[152:155], v[120:123], a[244:247], v[152:155]
ds_read_b64_tr_b16 v[110:111], v13 offset:16384
ds_read_b64_tr_b16 v[112:113], v10 offset:1024
v_mfma_f32_16x16x32_bf16 v[140:143], v[124:127], a[240:243], v[140:143]
ds_read_b64_tr_b16 v[114:115], v10 offset:17408
v_mfma_f32_16x16x32_bf16 v[156:159], v[124:127], a[244:247], v[156:159]
ds_read_b64_tr_b16 v[116:117], v11 offset:1024
ds_read_b64_tr_b16 v[118:119], v11 offset:17408
v_mfma_f32_16x16x32_bf16 v[128:131], v[80:83], a[248:251], v[128:131]
buffer_load_dwordx4 v31, s[44:47], s77 offen offset:1024 lds
v_mfma_f32_16x16x32_bf16 v[144:147], v[80:83], a[252:255], v[144:147]
ds_read_b64_tr_b16 v[120:121], v12 offset:1024
ds_read_b64_tr_b16 v[122:123], v12 offset:17408
v_mfma_f32_16x16x32_bf16 v[132:135], v[84:87], a[248:251], v[132:135]
ds_read_b64_tr_b16 v[124:125], v13 offset:1024
v_mfma_f32_16x16x32_bf16 v[148:151], v[84:87], a[252:255], v[148:151]
ds_read_b64_tr_b16 v[126:127], v13 offset:17408
ds_read_b64_tr_b16 v[80:81], v10 offset:2048
v_mfma_f32_16x16x32_bf16 v[136:139], v[88:91], a[248:251], v[136:139]
ds_read_b64_tr_b16 v[82:83], v10 offset:18432
v_mfma_f32_16x16x32_bf16 v[152:155], v[88:91], a[252:255], v[152:155]
ds_read_b64_tr_b16 v[84:85], v11 offset:2048
ds_read_b64_tr_b16 v[86:87], v11 offset:18432
v_mfma_f32_16x16x32_bf16 v[140:143], v[92:95], a[248:251], v[140:143]
buffer_load_dwordx4 v32, s[44:47], s77 offen offset:2048 lds
v_mfma_f32_16x16x32_bf16 v[156:159], v[92:95], a[252:255], v[156:159]
ds_read_b64_tr_b16 v[88:89], v12 offset:2048
ds_read_b64_tr_b16 v[90:91], v12 offset:18432
S_U2:
s_waitcnt lgkmcnt(8)
v_mfma_f32_16x16x32_bf16 v[192:195], v[96:99], a[0:3], 0
s_mov_b32 s87, 0
s_atomic_add s87, s[60:61], s24 offset:772 glc
v_mfma_f32_16x16x32_bf16 v[208:211], v[96:99], a[4:7], 0
ds_read_b64_tr_b16 v[92:93], v13 offset:2048
ds_read_b64_tr_b16 v[94:95], v13 offset:18432
v_mfma_f32_16x16x32_bf16 v[196:199], v[100:103], a[0:3], 0
ds_read_b64_tr_b16 v[96:97], v10 offset:3072
v_mfma_f32_16x16x32_bf16 v[212:215], v[100:103], a[4:7], 0
s_add_u32 s70, s0, S_DA - K_pc + 0
s_addc_u32 s71, s1, 0
global_load_dword v57, v9, s[70:71]
v_mfma_f32_16x16x32_bf16 v[200:203], v[104:107], a[0:3], 0
ds_read_b64_tr_b16 v[98:99], v10 offset:19456
v_mul_f32 v68, v60, v128
v_mfma_f32_16x16x32_bf16 v[216:219], v[104:107], a[4:7], 0
buffer_load_dwordx4 v33, s[44:47], s77 offen offset:3072 lds
v_mfma_f32_16x16x32_bf16 v[204:207], v[108:111], a[0:3], 0
ds_read_b64_tr_b16 v[100:101], v11 offset:3072
v_mul_f32 v69, v60, v129
v_mfma_f32_16x16x32_bf16 v[220:223], v[108:111], a[4:7], 0
s_add_u32 s70, s0, S_DA - K_pc + 8192
s_addc_u32 s71, s1, 0
global_load_dword v57, v9, s[70:71]
v_mfma_f32_16x16x32_bf16 v[192:195], v[112:115], a[8:11], v[192:195]
ds_read_b64_tr_b16 v[102:103], v11 offset:19456
ds_read_b64_tr_b16 v[104:105], v12 offset:3072
v_mfma_f32_16x16x32_bf16 v[208:211], v[112:115], a[12:15], v[208:211]
ds_read_b64_tr_b16 v[106:107], v12 offset:19456
s_add_u32 m0, s76, 102400
v_mfma_f32_16x16x32_bf16 v[196:199], v[116:119], a[8:11], v[196:199]
ds_read_b64_tr_b16 v[108:109], v13 offset:3072
s_add_u32 s77, s25, 0x620000
v_mfma_f32_16x16x32_bf16 v[212:215], v[116:119], a[12:15], v[212:215]
buffer_load_dwordx4 v30, s[44:47], s77 offen offset:0 lds
v_mfma_f32_16x16x32_bf16 v[200:203], v[120:123], a[8:11], v[200:203]
ds_read_b64_tr_b16 v[110:111], v13 offset:19456
ds_read_b64_tr_b16 v[112:113], v10 offset:4096
v_mfma_f32_16x16x32_bf16 v[216:219], v[120:123], a[12:15], v[216:219]
ds_read_b64_tr_b16 v[114:115], v10 offset:20480
s_waitcnt lgkmcnt(7)
v_mfma_f32_16x16x32_bf16 v[204:207], v[124:127], a[8:11], v[204:207]
ds_read_b64_tr_b16 v[116:117], v11 offset:4096
v_mul_f32 v70, v60, v130
v_mfma_f32_16x16x32_bf16 v[220:223], v[124:127], a[12:15], v[220:223]
ds_read_b64_tr_b16 v[118:119], v11 offset:20480
v_mul_f32 v71, v60, v131
v_mfma_f32_16x16x32_bf16 v[192:195], v[80:83], a[16:19], v[192:195]
v_exp_f32 v68, v68
v_mfma_f32_16x16x32_bf16 v[208:211], v[80:83], a[20:23], v[208:211]
ds_read_b64_tr_b16 v[120:121], v12 offset:4096
ds_read_b64_tr_b16 v[122:123], v12 offset:20480
v_mfma_f32_16x16x32_bf16 v[196:199], v[84:87], a[16:19], v[196:199]
buffer_load_dwordx4 v31, s[44:47], s77 offen offset:1024 lds
v_mfma_f32_16x16x32_bf16 v[212:215], v[84:87], a[20:23], v[212:215]
ds_read_b64_tr_b16 v[124:125], v13 offset:4096
ds_read_b64_tr_b16 v[126:127], v13 offset:20480
v_mfma_f32_16x16x32_bf16 v[200:203], v[88:91], a[16:19], v[200:203]
v_exp_f32 v69, v69
v_mfma_f32_16x16x32_bf16 v[216:219], v[88:91], a[20:23], v[216:219]
ds_read_b64_tr_b16 v[80:81], v10 offset:5120
ds_read_b64_tr_b16 v[82:83], v10 offset:21504
v_mfma_f32_16x16x32_bf16 v[204:207], v[92:95], a[16:19], v[204:207]
v_exp_f32 v70, v70
v_mfma_f32_16x16x32_bf16 v[220:223], v[92:95], a[20:23], v[220:223]
ds_read_b64_tr_b16 v[84:85], v11 offset:5120
ds_read_b64_tr_b16 v[86:87], v11 offset:21504
v_mfma_f32_16x16x32_bf16 v[192:195], v[96:99], a[24:27], v[192:195]
buffer_load_dwordx4 v32, s[44:47], s77 offen offset:2048 lds
v_mfma_f32_16x16x32_bf16 v[208:211], v[96:99], a[28:31], v[208:211]
ds_read_b64_tr_b16 v[88:89], v12 offset:5120
s_waitcnt lgkmcnt(5)
v_mfma_f32_16x16x32_bf16 v[196:199], v[100:103], a[24:27], v[196:199]
v_exp_f32 v71, v71
v_mfma_f32_16x16x32_bf16 v[212:215], v[100:103], a[28:31], v[212:215]
ds_read_b64_tr_b16 v[90:91], v12 offset:21504
ds_read_b64_tr_b16 v[92:93], v13 offset:5120
v_mfma_f32_16x16x32_bf16 v[200:203], v[104:107], a[24:27], v[200:203]
ds_read_b64_tr_b16 v[94:95], v13 offset:21504
v_fma_f32 v68, v68, v62, v62
v_mfma_f32_16x16x32_bf16 v[216:219], v[104:107], a[28:31], v[216:219]
ds_read_b64_tr_b16 v[96:97], v10 offset:6144
ds_read_b64_tr_b16 v[98:99], v10 offset:22528
v_mfma_f32_16x16x32_bf16 v[204:207], v[108:111], a[24:27], v[204:207]
buffer_load_dwordx4 v33, s[44:47], s77 offen offset:3072 lds
v_mfma_f32_16x16x32_bf16 v[220:223], v[108:111], a[28:31], v[220:223]
ds_read_b64_tr_b16 v[100:101], v11 offset:6144
ds_read_b64_tr_b16 v[102:103], v11 offset:22528
v_mfma_f32_16x16x32_bf16 v[192:195], v[112:115], a[32:35], v[192:195]
ds_read_b64_tr_b16 v[104:105], v12 offset:6144
v_fma_f32 v69, v69, v62, v62
v_mfma_f32_16x16x32_bf16 v[208:211], v[112:115], a[36:39], v[208:211]
ds_read_b64_tr_b16 v[106:107], v12 offset:22528
v_fma_f32 v70, v70, v62, v62
v_mfma_f32_16x16x32_bf16 v[196:199], v[116:119], a[32:35], v[196:199]
ds_read_b64_tr_b16 v[108:109], v13 offset:6144
v_fma_f32 v71, v71, v62, v62
v_mfma_f32_16x16x32_bf16 v[212:215], v[116:119], a[36:39], v[212:215]
v_rcp_f32 v68, v68
v_mfma_f32_16x16x32_bf16 v[200:203], v[120:123], a[32:35], v[200:203]
ds_read_b64_tr_b16 v[110:111], v13 offset:22528
ds_read_b64_tr_b16 v[112:113], v10 offset:7168
v_mfma_f32_16x16x32_bf16 v[216:219], v[120:123], a[36:39], v[216:219]
v_rcp_f32 v69, v69
v_mfma_f32_16x16x32_bf16 v[204:207], v[124:127], a[32:35], v[204:207]
ds_read_b64_tr_b16 v[114:115], v10 offset:23552
ds_read_b64_tr_b16 v[116:117], v11 offset:7168
v_mfma_f32_16x16x32_bf16 v[220:223], v[124:127], a[36:39], v[220:223]
ds_read_b64_tr_b16 v[118:119], v11 offset:23552
s_waitcnt lgkmcnt(6)
v_mfma_f32_16x16x32_bf16 v[192:195], v[80:83], a[40:43], v[192:195]
v_rcp_f32 v70, v70
v_mfma_f32_16x16x32_bf16 v[208:211], v[80:83], a[44:47], v[208:211]
ds_read_b64_tr_b16 v[120:121], v12 offset:7168
ds_read_b64_tr_b16 v[122:123], v12 offset:23552
v_mfma_f32_16x16x32_bf16 v[196:199], v[84:87], a[40:43], v[196:199]
v_rcp_f32 v71, v71
v_mfma_f32_16x16x32_bf16 v[212:215], v[84:87], a[44:47], v[212:215]
ds_read_b64_tr_b16 v[124:125], v13 offset:7168
ds_read_b64_tr_b16 v[126:127], v13 offset:23552
v_mfma_f32_16x16x32_bf16 v[200:203], v[88:91], a[40:43], v[200:203]
v_mul_f32 v128, v128, v68
v_mul_f32 v129, v129, v69
v_mfma_f32_16x16x32_bf16 v[216:219], v[88:91], a[44:47], v[216:219]
v_mul_f32 v130, v130, v70
v_mul_f32 v131, v131, v71
v_mfma_f32_16x16x32_bf16 v[204:207], v[92:95], a[40:43], v[204:207]
v_mul_f32 v72, v60, v132
v_mul_f32 v73, v60, v133
v_mfma_f32_16x16x32_bf16 v[220:223], v[92:95], a[44:47], v[220:223]
v_mul_f32 v74, v60, v134
v_mul_f32 v75, v60, v135
v_mfma_f32_16x16x32_bf16 v[192:195], v[96:99], a[48:51], v[192:195]
s_waitcnt vmcnt(20) lgkmcnt(0)
s_barrier
s_cmp_lt_u32 s87, 4
s_cbranch_scc1 pl_5_slow
pl_5_ok:
s_waitcnt vmcnt(10)
s_atomic_add s69, s[60:61], s24 offset:768
v_mfma_f32_16x16x32_bf16 v[208:211], v[96:99], a[52:55], v[208:211]
ds_read_b64_tr_b16 v[80:81], v10 offset:32768
ds_read_b64_tr_b16 v[82:83], v10 offset:49152
v_mfma_f32_16x16x32_bf16 v[196:199], v[100:103], a[48:51], v[196:199]
ds_read_b64_tr_b16 v[84:85], v11 offset:32768
s_add_u32 m0, s76, 0
v_mfma_f32_16x16x32_bf16 v[212:215], v[100:103], a[52:55], v[212:215]
ds_read_b64_tr_b16 v[86:87], v11 offset:49152
s_add_u32 s77, s97, 0x0
v_mfma_f32_16x16x32_bf16 v[200:203], v[104:107], a[48:51], v[200:203]
ds_read_b64_tr_b16 v[88:89], v12 offset:32768
ds_read_b64_tr_b16 v[90:91], v12 offset:49152
v_mfma_f32_16x16x32_bf16 v[216:219], v[104:107], a[52:55], v[216:219]
buffer_load_dwordx4 v38, s[48:51], s77 offen offset:0 lds
v_mfma_f32_16x16x32_bf16 v[204:207], v[108:111], a[48:51], v[204:207]
ds_read_b64_tr_b16 v[92:93], v13 offset:32768
ds_read_b64_tr_b16 v[94:95], v13 offset:49152
v_mfma_f32_16x16x32_bf16 v[220:223], v[108:111], a[52:55], v[220:223]
ds_read_b64_tr_b16 v[96:97], v10 offset:33792
s_add_u32 s91, s6, 0
v_mfma_f32_16x16x32_bf16 v[192:195], v[112:115], a[56:59], v[192:195]
buffer_load_dwordx4 a[0:3], v46, s[60:63], s91 offen offset:0 sc1
v_mfma_f32_16x16x32_bf16 v[208:211], v[112:115], a[60:63], v[208:211]
ds_read_b64_tr_b16 v[98:99], v10 offset:50176
ds_read_b64_tr_b16 v[100:101], v11 offset:33792
v_mfma_f32_16x16x32_bf16 v[196:199], v[116:119], a[56:59], v[196:199]
buffer_load_dwordx4 a[4:7], v46, s[60:63], s91 offen offset:1024 sc1
v_mfma_f32_16x16x32_bf16 v[212:215], v[116:119], a[60:63], v[212:215]
ds_read_b64_tr_b16 v[102:103], v11 offset:50176
ds_read_b64_tr_b16 v[104:105], v12 offset:33792
v_mfma_f32_16x16x32_bf16 v[200:203], v[120:123], a[56:59], v[200:203]
buffer_load_dwordx4 v39, s[48:51], s77 offen offset:1024 lds
v_mfma_f32_16x16x32_bf16 v[216:219], v[120:123], a[60:63], v[216:219]
ds_read_b64_tr_b16 v[106:107], v12 offset:50176
ds_read_b64_tr_b16 v[108:109], v13 offset:33792
v_mfma_f32_16x16x32_bf16 v[204:207], v[124:127], a[56:59], v[204:207]
v_exp_f32 v72, v72
v_mfma_f32_16x16x32_bf16 v[220:223], v[124:127], a[60:63], v[220:223]
ds_read_b64_tr_b16 v[110:111], v13 offset:50176
s_waitcnt lgkmcnt(5)
v_mfma_f32_16x16x32_bf16 v[192:195], v[80:83], a[64:67], v[192:195]
ds_read_b64_tr_b16 v[112:113], v10 offset:34816
ds_read_b64_tr_b16 v[114:115], v10 offset:51200
v_mfma_f32_16x16x32_bf16 v[208:211], v[80:83], a[68:71], v[208:211]
v_exp_f32 v73, v73
v_mfma_f32_16x16x32_bf16 v[196:199], v[84:87], a[64:67], v[196:199]
ds_read_b64_tr_b16 v[116:117], v11 offset:34816
ds_read_b64_tr_b16 v[118:119], v11 offset:51200
v_mfma_f32_16x16x32_bf16 v[212:215], v[84:87], a[68:71], v[212:215]
buffer_load_dwordx4 v40, s[48:51], s77 offen offset:2048 lds
v_mfma_f32_16x16x32_bf16 v[200:203], v[88:91], a[64:67], v[200:203]
ds_read_b64_tr_b16 v[120:121], v12 offset:34816
ds_read_b64_tr_b16 v[122:123], v12 offset:51200
v_mfma_f32_16x16x32_bf16 v[216:219], v[88:91], a[68:71], v[216:219]
v_exp_f32 v74, v74
v_mfma_f32_16x16x32_bf16 v[204:207], v[92:95], a[64:67], v[204:207]
ds_read_b64_tr_b16 v[124:125], v13 offset:34816
ds_read_b64_tr_b16 v[126:127], v13 offset:51200
v_mfma_f32_16x16x32_bf16 v[220:223], v[92:95], a[68:71], v[220:223]
v_exp_f32 v75, v75
v_mfma_f32_16x16x32_bf16 v[192:195], v[96:99], a[72:75], v[192:195]
ds_read_b64_tr_b16 v[80:81], v10 offset:35840
ds_read_b64_tr_b16 v[82:83], v10 offset:52224
v_mfma_f32_16x16x32_bf16 v[208:211], v[96:99], a[76:79], v[208:211]
ds_read_b64_tr_b16 v[84:85], v11 offset:35840
s_waitcnt lgkmcnt(7)
v_mfma_f32_16x16x32_bf16 v[196:199], v[100:103], a[72:75], v[196:199]
buffer_load_dwordx4 v41, s[48:51], s77 offen offset:3072 lds
v_mfma_f32_16x16x32_bf16 v[212:215], v[100:103], a[76:79], v[212:215]
ds_read_b64_tr_b16 v[86:87], v11 offset:52224
ds_read_b64_tr_b16 v[88:89], v12 offset:35840
v_mfma_f32_16x16x32_bf16 v[200:203], v[104:107], a[72:75], v[200:203]
buffer_load_dwordx4 a[8:11], v46, s[60:63], s91 offen offset:2048 sc1
v_mfma_f32_16x16x32_bf16 v[216:219], v[104:107], a[76:79], v[216:219]
ds_read_b64_tr_b16 v[90:91], v12 offset:52224
ds_read_b64_tr_b16 v[92:93], v13 offset:35840
v_mfma_f32_16x16x32_bf16 v[204:207], v[108:111], a[72:75], v[204:207]
buffer_load_dwordx4 a[12:15], v46, s[60:63], s91 offen offset:3072 sc1
v_mfma_f32_16x16x32_bf16 v[220:223], v[108:111], a[76:79], v[220:223]
ds_read_b64_tr_b16 v[94:95], v13 offset:52224
ds_read_b64_tr_b16 v[96:97], v10 offset:36864
v_mfma_f32_16x16x32_bf16 v[192:195], v[112:115], a[80:83], v[192:195]
ds_read_b64_tr_b16 v[98:99], v10 offset:53248
s_add_u32 m0, s76, 4096
v_mfma_f32_16x16x32_bf16 v[208:211], v[112:115], a[84:87], v[208:211]
ds_read_b64_tr_b16 v[100:101], v11 offset:36864
s_add_u32 s77, s98, 0x0
v_mfma_f32_16x16x32_bf16 v[196:199], v[116:119], a[80:83], v[196:199]
buffer_load_dwordx4 v38, s[48:51], s77 offen offset:0 lds
v_mfma_f32_16x16x32_bf16 v[212:215], v[116:119], a[84:87], v[212:215]
ds_read_b64_tr_b16 v[102:103], v11 offset:53248
s_waitcnt lgkmcnt(5)
v_mfma_f32_16x16x32_bf16 v[200:203], v[120:123], a[80:83], v[200:203]
ds_read_b64_tr_b16 v[104:105], v12 offset:36864
ds_read_b64_tr_b16 v[106:107], v12 offset:53248
v_mfma_f32_16x16x32_bf16 v[216:219], v[120:123], a[84:87], v[216:219]
ds_read_b64_tr_b16 v[108:109], v13 offset:36864
v_fma_f32 v72, v72, v62, v62
v_mfma_f32_16x16x32_bf16 v[204:207], v[124:127], a[80:83], v[204:207]
ds_read_b64_tr_b16 v[110:111], v13 offset:53248
ds_read_b64_tr_b16 v[112:113], v10 offset:37888
v_mfma_f32_16x16x32_bf16 v[220:223], v[124:127], a[84:87], v[220:223]
ds_read_b64_tr_b16 v[114:115], v10 offset:54272
v_fma_f32 v73, v73, v62, v62
v_mfma_f32_16x16x32_bf16 v[192:195], v[80:83], a[88:91], v[192:195]
buffer_load_dwordx4 v39, s[48:51], s77 offen offset:1024 lds
v_mfma_f32_16x16x32_bf16 v[208:211], v[80:83], a[92:95], v[208:211]
ds_read_b64_tr_b16 v[116:117], v11 offset:37888
ds_read_b64_tr_b16 v[118:119], v11 offset:54272
v_mfma_f32_16x16x32_bf16 v[196:199], v[84:87], a[88:91], v[196:199]
ds_read_b64_tr_b16 v[120:121], v12 offset:37888
v_fma_f32 v74, v74, v62, v62
v_mfma_f32_16x16x32_bf16 v[212:215], v[84:87], a[92:95], v[212:215]
ds_read_b64_tr_b16 v[122:123], v12 offset:54272
ds_read_b64_tr_b16 v[124:125], v13 offset:37888
v_mfma_f32_16x16x32_bf16 v[200:203], v[88:91], a[88:91], v[200:203]
ds_read_b64_tr_b16 v[126:127], v13 offset:54272
s_add_u32 s91, s6, 4096
v_mfma_f32_16x16x32_bf16 v[216:219], v[88:91], a[92:95], v[216:219]
ds_read_b64_tr_b16 v[80:81], v10 offset:38912
s_waitcnt lgkmcnt(7)
v_mfma_f32_16x16x32_bf16 v[204:207], v[92:95], a[88:91], v[204:207]
buffer_load_dwordx4 v40, s[48:51], s77 offen offset:2048 lds
v_mfma_f32_16x16x32_bf16 v[220:223], v[92:95], a[92:95], v[220:223]
ds_read_b64_tr_b16 v[82:83], v10 offset:55296
ds_read_b64_tr_b16 v[84:85], v11 offset:38912
v_mfma_f32_16x16x32_bf16 v[192:195], v[96:99], a[96:99], v[192:195]
buffer_load_dwordx4 a[16:19], v46, s[60:63], s91 offen offset:0 sc1
v_mfma_f32_16x16x32_bf16 v[208:211], v[96:99], a[100:103], v[208:211]
ds_read_b64_tr_b16 v[86:87], v11 offset:55296
ds_read_b64_tr_b16 v[88:89], v12 offset:38912
v_mfma_f32_16x16x32_bf16 v[196:199], v[100:103], a[96:99], v[196:199]
buffer_load_dwordx4 a[20:23], v46, s[60:63], s91 offen offset:1024 sc1
v_mfma_f32_16x16x32_bf16 v[212:215], v[100:103], a[100:103], v[212:215]
ds_read_b64_tr_b16 v[90:91], v12 offset:55296
ds_read_b64_tr_b16 v[92:93], v13 offset:38912
v_mfma_f32_16x16x32_bf16 v[200:203], v[104:107], a[96:99], v[200:203]
ds_read_b64_tr_b16 v[94:95], v13 offset:55296
v_fma_f32 v75, v75, v62, v62
v_mfma_f32_16x16x32_bf16 v[216:219], v[104:107], a[100:103], v[216:219]
v_rcp_f32 v72, v72
v_mfma_f32_16x16x32_bf16 v[204:207], v[108:111], a[96:99], v[204:207]
ds_read_b64_tr_b16 v[96:97], v10 offset:39936
ds_read_b64_tr_b16 v[98:99], v10 offset:56320
v_mfma_f32_16x16x32_bf16 v[220:223], v[108:111], a[100:103], v[220:223]
buffer_load_dwordx4 v41, s[48:51], s77 offen offset:3072 lds
v_mfma_f32_16x16x32_bf16 v[192:195], v[112:115], a[104:107], v[192:195]
ds_read_b64_tr_b16 v[100:101], v11 offset:39936
ds_read_b64_tr_b16 v[102:103], v11 offset:56320
v_mfma_f32_16x16x32_bf16 v[208:211], v[112:115], a[108:111], v[208:211]
ds_read_b64_tr_b16 v[104:105], v12 offset:39936
s_waitcnt lgkmcnt(6)
v_mfma_f32_16x16x32_bf16 v[196:199], v[116:119], a[104:107], v[196:199]
v_rcp_f32 v73, v73
v_mfma_f32_16x16x32_bf16 v[212:215], v[116:119], a[108:111], v[212:215]
ds_read_b64_tr_b16 v[106:107], v12 offset:56320
ds_read_b64_tr_b16 v[108:109], v13 offset:39936
v_mfma_f32_16x16x32_bf16 v[200:203], v[120:123], a[104:107], v[200:203]
v_rcp_f32 v74, v74
v_mfma_f32_16x16x32_bf16 v[216:219], v[120:123], a[108:111], v[216:219]
ds_read_b64_tr_b16 v[110:111], v13 offset:56320
v_mfma_f32_16x16x32_bf16 v[204:207], v[124:127], a[104:107], v[204:207]
buffer_load_dwordx4 a[24:27], v46, s[60:63], s91 offen offset:2048 sc1
v_mfma_f32_16x16x32_bf16 v[220:223], v[124:127], a[108:111], v[220:223]
v_rcp_f32 v75, v75
v_mfma_f32_16x16x32_bf16 v[192:195], v[80:83], a[112:115], v[192:195]
buffer_load_dwordx4 a[28:31], v46, s[60:63], s91 offen offset:3072 sc1
v_mfma_f32_16x16x32_bf16 v[208:211], v[80:83], a[116:119], v[208:211]
v_mul_f32 v132, v132, v72
v_mul_f32 v133, v133, v73
v_mfma_f32_16x16x32_bf16 v[196:199], v[84:87], a[112:115], v[196:199]
s_waitcnt lgkmcnt(0)
s_barrier
v_mfma_f32_16x16x32_bf16 v[212:215], v[84:87], a[116:119], v[212:215]
ds_read_b64_tr_b16 v[112:113], v14 offset:0
ds_read_b64_tr_b16 v[114:115], v14 offset:16384
v_mfma_f32_16x16x32_bf16 v[200:203], v[88:91], a[112:115], v[200:203]
ds_read_b64_tr_b16 v[116:117], v15 offset:0
ds_read_b64_tr_b16 v[118:119], v15 offset:16384
v_mfma_f32_16x16x32_bf16 v[216:219], v[88:91], a[116:119], v[216:219]
ds_read_b64_tr_b16 v[120:121], v16 offset:0
ds_read_b64_tr_b16 v[122:123], v16 offset:16384
v_mfma_f32_16x16x32_bf16 v[204:207], v[92:95], a[112:115], v[204:207]
ds_read_b64_tr_b16 v[124:125], v17 offset:0
s_add_u32 m0, s76, 32768
v_mfma_f32_16x16x32_bf16 v[220:223], v[92:95], a[116:119], v[220:223]
ds_read_b64_tr_b16 v[126:127], v17 offset:16384
s_add_u32 s77, s99, 0x0
v_mfma_f32_16x16x32_bf16 v[192:195], v[96:99], a[120:123], v[192:195]
ds_read_b64_tr_b16 v[80:81], v14 offset:1024
ds_read_b64_tr_b16 v[82:83], v14 offset:17408
v_mfma_f32_16x16x32_bf16 v[208:211], v[96:99], a[124:127], v[208:211]
buffer_load_dwordx4 v38, s[48:51], s77 offen offset:0 lds
v_mfma_f32_16x16x32_bf16 v[196:199], v[100:103], a[120:123], v[196:199]
ds_read_b64_tr_b16 v[84:85], v15 offset:1024
ds_read_b64_tr_b16 v[86:87], v15 offset:17408
v_mfma_f32_16x16x32_bf16 v[212:215], v[100:103], a[124:127], v[212:215]
ds_read_b64_tr_b16 v[88:89], v16 offset:1024
v_mul_f32 v134, v134, v74
v_mfma_f32_16x16x32_bf16 v[200:203], v[104:107], a[120:123], v[200:203]
ds_read_b64_tr_b16 v[90:91], v16 offset:17408
ds_read_b64_tr_b16 v[92:93], v17 offset:1024
v_mfma_f32_16x16x32_bf16 v[216:219], v[104:107], a[124:127], v[216:219]
ds_read_b64_tr_b16 v[94:95], v17 offset:17408
v_mul_f32 v135, v135, v75
v_mfma_f32_16x16x32_bf16 v[204:207], v[108:111], a[120:123], v[204:207]
ds_read_b64_tr_b16 v[96:97], v14 offset:2048
ds_read_b64_tr_b16 v[98:99], v14 offset:18432
v_mfma_f32_16x16x32_bf16 v[220:223], v[108:111], a[124:127], v[220:223]
ds_read_b64_tr_b16 v[100:101], v15 offset:2048
s_waitcnt lgkmcnt(9)
v_mfma_f32_16x16x32_bf16 v[192:195], v[112:115], a[128:131], v[192:195]
buffer_load_dwordx4 v39, s[48:51], s77 offen offset:1024 lds
v_mfma_f32_16x16x32_bf16 v[208:211], v[112:115], a[132:135], v[208:211]
ds_read_b64_tr_b16 v[102:103], v15 offset:18432
ds_read_b64_tr_b16 v[104:105], v16 offset:2048
v_mfma_f32_16x16x32_bf16 v[196:199], v[116:119], a[128:131], v[196:199]
ds_read_b64_tr_b16 v[106:107], v16 offset:18432
s_add_u32 s91, s6, 8192
v_mfma_f32_16x16x32_bf16 v[212:215], v[116:119], a[132:135], v[212:215]
buffer_load_dwordx4 a[32:35], v46, s[60:63], s91 offen offset:0 sc1
v_mfma_f32_16x16x32_bf16 v[200:203], v[120:123], a[128:131], v[200:203]
ds_read_b64_tr_b16 v[108:109], v17 offset:2048
ds_read_b64_tr_b16 v[110:111], v17 offset:18432
v_mfma_f32_16x16x32_bf16 v[216:219], v[120:123], a[132:135], v[216:219]
buffer_load_dwordx4 a[36:39], v46, s[60:63], s91 offen offset:1024 sc1
v_mfma_f32_16x16x32_bf16 v[204:207], v[124:127], a[128:131], v[204:207]
ds_read_b64_tr_b16 v[112:113], v14 offset:3072
ds_read_b64_tr_b16 v[114:115], v14 offset:19456
v_mfma_f32_16x16x32_bf16 v[220:223], v[124:127], a[132:135], v[220:223]
buffer_load_dwordx4 v40, s[48:51], s77 offen offset:2048 lds
v_mfma_f32_16x16x32_bf16 v[192:195], v[80:83], a[136:139], v[192:195]
ds_read_b64_tr_b16 v[116:117], v15 offset:3072
ds_read_b64_tr_b16 v[118:119], v15 offset:19456
v_mfma_f32_16x16x32_bf16 v[208:211], v[80:83], a[140:143], v[208:211]
ds_read_b64_tr_b16 v[120:121], v16 offset:3072
s_waitcnt lgkmcnt(7)
v_mfma_f32_16x16x32_bf16 v[196:199], v[84:87], a[136:139], v[196:199]
ds_read_b64_tr_b16 v[122:123], v16 offset:19456
ds_read_b64_tr_b16 v[124:125], v17 offset:3072
v_mfma_f32_16x16x32_bf16 v[212:215], v[84:87], a[140:143], v[212:215]
ds_read_b64_tr_b16 v[126:127], v17 offset:19456
v_mul_f32 v68, v60, v136
v_mfma_f32_16x16x32_bf16 v[200:203], v[88:91], a[136:139], v[200:203]
ds_read_b64_tr_b16 v[80:81], v14 offset:4096
v_mul_f32 v69, v60, v137
v_mfma_f32_16x16x32_bf16 v[216:219], v[88:91], a[140:143], v[216:219]
buffer_load_dwordx4 v41, s[48:51], s77 offen offset:3072 lds
v_mfma_f32_16x16x32_bf16 v[204:207], v[92:95], a[136:139], v[204:207]
ds_read_b64_tr_b16 v[82:83], v14 offset:20480
ds_read_b64_tr_b16 v[84:85], v15 offset:4096
v_mfma_f32_16x16x32_bf16 v[220:223], v[92:95], a[140:143], v[220:223]
ds_read_b64_tr_b16 v[86:87], v15 offset:20480
v_mul_f32 v70, v60, v138
v_mfma_f32_16x16x32_bf16 v[192:195], v[96:99], a[144:147], v[192:195]
ds_read_b64_tr_b16 v[88:89], v16 offset:4096
s_add_u32 m0, s76, 36864
v_mfma_f32_16x16x32_bf16 v[208:211], v[96:99], a[148:151], v[208:211]
buffer_load_dwordx4 a[40:43], v46, s[60:63], s91 offen offset:2048 sc1
v_mfma_f32_16x16x32_bf16 v[196:199], v[100:103], a[144:147], v[196:199]
ds_read_b64_tr_b16 v[90:91], v16 offset:20480
ds_read_b64_tr_b16 v[92:93], v17 offset:4096
v_mfma_f32_16x16x32_bf16 v[212:215], v[100:103], a[148:151], v[212:215]
buffer_load_dwordx4 a[44:47], v46, s[60:63], s91 offen offset:3072 sc1
v_mfma_f32_16x16x32_bf16 v[200:203], v[104:107], a[144:147], v[200:203]
ds_read_b64_tr_b16 v[94:95], v17 offset:20480
ds_read_b64_tr_b16 v[96:97], v14 offset:5120
v_mfma_f32_16x16x32_bf16 v[216:219], v[104:107], a[148:151], v[216:219]
ds_read_b64_tr_b16 v[98:99], v14 offset:21504
s_waitcnt lgkmcnt(6)
v_mfma_f32_16x16x32_bf16 v[204:207], v[108:111], a[144:147], v[204:207]
ds_read_b64_tr_b16 v[100:101], v15 offset:5120
s_add_u32 s77, s97, 0x40000
v_mfma_f32_16x16x32_bf16 v[220:223], v[108:111], a[148:151], v[220:223]
buffer_load_dwordx4 v38, s[48:51], s77 offen offset:0 lds
v_mfma_f32_16x16x32_bf16 v[192:195], v[112:115], a[152:155], v[192:195]
ds_read_b64_tr_b16 v[102:103], v15 offset:21504
ds_read_b64_tr_b16 v[104:105], v16 offset:5120
v_mfma_f32_16x16x32_bf16 v[208:211], v[112:115], a[156:159], v[208:211]
ds_read_b64_tr_b16 v[106:107], v16 offset:21504
v_mul_f32 v71, v60, v139
v_mfma_f32_16x16x32_bf16 v[196:199], v[116:119], a[152:155], v[196:199]
v_exp_f32 v68, v68
v_mfma_f32_16x16x32_bf16 v[212:215], v[116:119], a[156:159], v[212:215]
ds_read_b64_tr_b16 v[108:109], v17 offset:5120
ds_read_b64_tr_b16 v[110:111], v17 offset:21504
v_mfma_f32_16x16x32_bf16 v[200:203], v[120:123], a[152:155], v[200:203]
v_exp_f32 v69, v69
v_mfma_f32_16x16x32_bf16 v[216:219], v[120:123], a[156:159], v[216:219]
ds_read_b64_tr_b16 v[112:113], v14 offset:6144
ds_read_b64_tr_b16 v[114:115], v14 offset:22528
v_mfma_f32_16x16x32_bf16 v[204:207], v[124:127], a[152:155], v[204:207]
buffer_load_dwordx4 v39, s[48:51], s77 offen offset:1024 lds
v_mfma_f32_16x16x32_bf16 v[220:223], v[124:127], a[156:159], v[220:223]
ds_read_b64_tr_b16 v[116:117], v15 offset:6144
ds_read_b64_tr_b16 v[118:119], v15 offset:22528
v_mfma_f32_16x16x32_bf16 v[192:195], v[80:83], a[160:163], v[192:195]
v_exp_f32 v70, v70
v_mfma_f32_16x16x32_bf16 v[208:211], v[80:83], a[164:167], v[208:211]
ds_read_b64_tr_b16 v[120:121], v16 offset:6144
ds_read_b64_tr_b16 v[122:123], v16 offset:22528
v_mfma_f32_16x16x32_bf16 v[196:199], v[84:87], a[160:163], v[196:199]
v_exp_f32 v71, v71
v_mfma_f32_16x16x32_bf16 v[212:215], v[84:87], a[164:167], v[212:215]
ds_read_b64_tr_b16 v[124:125], v17 offset:6144
s_waitcnt lgkmcnt(5)
v_mfma_f32_16x16x32_bf16 v[200:203], v[88:91], a[160:163], v[200:203]
buffer_load_dwordx4 v40, s[48:51], s77 offen offset:2048 lds
v_mfma_f32_16x16x32_bf16 v[216:219], v[88:91], a[164:167], v[216:219]
ds_read_b64_tr_b16 v[126:127], v17 offset:22528
ds_read_b64_tr_b16 v[80:81], v14 offset:7168
v_mfma_f32_16x16x32_bf16 v[204:207], v[92:95], a[160:163], v[204:207]
ds_read_b64_tr_b16 v[82:83], v14 offset:23552
s_add_u32 s91, s6, 12288
v_mfma_f32_16x16x32_bf16 v[220:223], v[92:95], a[164:167], v[220:223]
buffer_load_dwordx4 a[48:51], v46, s[60:63], s91 offen offset:0 sc1
v_mfma_f32_16x16x32_bf16 v[192:195], v[96:99], a[168:171], v[192:195]
ds_read_b64_tr_b16 v[84:85], v15 offset:7168
ds_read_b64_tr_b16 v[86:87], v15 offset:23552
v_mfma_f32_16x16x32_bf16 v[208:211], v[96:99], a[172:175], v[208:211]
buffer_load_dwordx4 a[52:55], v46, s[60:63], s91 offen offset:1024 sc1
v_mfma_f32_16x16x32_bf16 v[196:199], v[100:103], a[168:171], v[196:199]
ds_read_b64_tr_b16 v[88:89], v16 offset:7168
ds_read_b64_tr_b16 v[90:91], v16 offset:23552
v_mfma_f32_16x16x32_bf16 v[212:215], v[100:103], a[172:175], v[212:215]
ds_read_b64_tr_b16 v[92:93], v17 offset:7168
v_fma_f32 v68, v68, v62, v62
v_mfma_f32_16x16x32_bf16 v[200:203], v[104:107], a[168:171], v[200:203]
ds_read_b64_tr_b16 v[94:95], v17 offset:23552
v_fma_f32 v69, v69, v62, v62
v_mfma_f32_16x16x32_bf16 v[216:219], v[104:107], a[172:175], v[216:219]
v_fma_f32 v70, v70, v62, v62
v_fma_f32 v71, v71, v62, v62
v_mfma_f32_16x16x32_bf16 v[204:207], v[108:111], a[168:171], v[204:207]
buffer_load_dwordx4 v41, s[48:51], s77 offen offset:3072 lds
v_mfma_f32_16x16x32_bf16 v[220:223], v[108:111], a[172:175], v[220:223]
v_rcp_f32 v68, v68
v_mfma_f32_16x16x32_bf16 v[192:195], v[112:115], a[176:179], v[192:195]
v_rcp_f32 v69, v69
v_mfma_f32_16x16x32_bf16 v[208:211], v[112:115], a[180:183], v[208:211]
s_waitcnt vmcnt(30) lgkmcnt(0)
s_barrier
v_mfma_f32_16x16x32_bf16 v[196:199], v[116:119], a[176:179], v[196:199]
ds_read_b64_tr_b16 v[96:97], v14 offset:32768
ds_read_b64_tr_b16 v[98:99], v14 offset:49152
v_mfma_f32_16x16x32_bf16 v[212:215], v[116:119], a[180:183], v[212:215]
ds_read_b64_tr_b16 v[100:101], v15 offset:32768
ds_read_b64_tr_b16 v[102:103], v15 offset:49152
v_mfma_f32_16x16x32_bf16 v[200:203], v[120:123], a[176:179], v[200:203]
ds_read_b64_tr_b16 v[104:105], v16 offset:32768
s_add_u32 m0, s76, 65536
v_mfma_f32_16x16x32_bf16 v[216:219], v[120:123], a[180:183], v[216:219]
ds_read_b64_tr_b16 v[106:107], v16 offset:49152
s_add_u32 s77, s98, 0x40000
v_mfma_f32_16x16x32_bf16 v[204:207], v[124:127], a[176:179], v[204:207]
ds_read_b64_tr_b16 v[108:109], v17 offset:32768
ds_read_b64_tr_b16 v[110:111], v17 offset:49152
v_mfma_f32_16x16x32_bf16 v[220:223], v[124:127], a[180:183], v[220:223]
buffer_load_dwordx4 v38, s[48:51], s77 offen offset:0 lds
v_mfma_f32_16x16x32_bf16 v[192:195], v[80:83], a[184:187], v[192:195]
ds_read_b64_tr_b16 v[112:113], v14 offset:33792
ds_read_b64_tr_b16 v[114:115], v14 offset:50176
v_mfma_f32_16x16x32_bf16 v[208:211], v[80:83], a[188:191], v[208:211]
buffer_load_dwordx4 a[56:59], v46, s[60:63], s91 offen offset:2048 sc1
v_mfma_f32_16x16x32_bf16 v[196:199], v[84:87], a[184:187], v[196:199]
ds_read_b64_tr_b16 v[116:117], v15 offset:33792
ds_read_b64_tr_b16 v[118:119], v15 offset:50176
v_mfma_f32_16x16x32_bf16 v[212:215], v[84:87], a[188:191], v[212:215]
buffer_load_dwordx4 a[60:63], v46, s[60:63], s91 offen offset:3072 sc1
v_mfma_f32_16x16x32_bf16 v[200:203], v[88:91], a[184:187], v[200:203]
ds_read_b64_tr_b16 v[120:121], v16 offset:33792
ds_read_b64_tr_b16 v[122:123], v16 offset:50176
v_mfma_f32_16x16x32_bf16 v[216:219], v[88:91], a[188:191], v[216:219]
v_rcp_f32 v70, v70
v_mfma_f32_16x16x32_bf16 v[204:207], v[92:95], a[184:187], v[204:207]
ds_read_b64_tr_b16 v[124:125], v17 offset:33792
ds_read_b64_tr_b16 v[126:127], v17 offset:50176
v_mfma_f32_16x16x32_bf16 v[220:223], v[92:95], a[188:191], v[220:223]
ds_read_b64_tr_b16 v[80:81], v14 offset:34816
s_waitcnt lgkmcnt(7)
v_mfma_f32_16x16x32_bf16 v[192:195], v[96:99], a[192:195], v[192:195]
buffer_load_dwordx4 v39, s[48:51], s77 offen offset:1024 lds
v_mfma_f32_16x16x32_bf16 v[208:211], v[96:99], a[196:199], v[208:211]
ds_read_b64_tr_b16 v[82:83], v14 offset:51200
ds_read_b64_tr_b16 v[84:85], v15 offset:34816
v_mfma_f32_16x16x32_bf16 v[196:199], v[100:103], a[192:195], v[196:199]
v_rcp_f32 v71, v71
v_mfma_f32_16x16x32_bf16 v[212:215], v[100:103], a[196:199], v[212:215]
ds_read_b64_tr_b16 v[86:87], v15 offset:51200
ds_read_b64_tr_b16 v[88:89], v16 offset:34816
v_mfma_f32_16x16x32_bf16 v[200:203], v[104:107], a[192:195], v[200:203]
ds_read_b64_tr_b16 v[90:91], v16 offset:51200
v_mul_f32 v136, v136, v68
v_mfma_f32_16x16x32_bf16 v[216:219], v[104:107], a[196:199], v[216:219]
ds_read_b64_tr_b16 v[92:93], v17 offset:34816
ds_read_b64_tr_b16 v[94:95], v17 offset:51200
v_mfma_f32_16x16x32_bf16 v[204:207], v[108:111], a[192:195], v[204:207]
buffer_load_dwordx4 v40, s[48:51], s77 offen offset:2048 lds
v_mfma_f32_16x16x32_bf16 v[220:223], v[108:111], a[196:199], v[220:223]
ds_read_b64_tr_b16 v[96:97], v14 offset:35840
ds_read_b64_tr_b16 v[98:99], v14 offset:52224
v_mfma_f32_16x16x32_bf16 v[192:195], v[112:115], a[200:203], v[192:195]
ds_read_b64_tr_b16 v[100:101], v15 offset:35840
s_add_u32 s91, s6, 65536
v_mfma_f32_16x16x32_bf16 v[208:211], v[112:115], a[204:207], v[208:211]
ds_read_b64_tr_b16 v[102:103], v15 offset:52224
s_waitcnt lgkmcnt(7)
v_mfma_f32_16x16x32_bf16 v[196:199], v[116:119], a[200:203], v[196:199]
buffer_load_dwordx4 a[64:67], v46, s[60:63], s91 offen offset:0 sc1
v_mfma_f32_16x16x32_bf16 v[212:215], v[116:119], a[204:207], v[212:215]
ds_read_b64_tr_b16 v[104:105], v16 offset:35840
ds_read_b64_tr_b16 v[106:107], v16 offset:52224
v_mfma_f32_16x16x32_bf16 v[200:203], v[120:123], a[200:203], v[200:203]
ds_read_b64_tr_b16 v[108:109], v17 offset:35840
v_mul_f32 v137, v137, v69
v_mfma_f32_16x16x32_bf16 v[216:219], v[120:123], a[204:207], v[216:219]
buffer_load_dwordx4 v41, s[48:51], s77 offen offset:3072 lds
v_mfma_f32_16x16x32_bf16 v[204:207], v[124:127], a[200:203], v[204:207]
ds_read_b64_tr_b16 v[110:111], v17 offset:52224
ds_read_b64_tr_b16 v[112:113], v14 offset:36864
v_mfma_f32_16x16x32_bf16 v[220:223], v[124:127], a[204:207], v[220:223]
ds_read_b64_tr_b16 v[114:115], v14 offset:53248
v_mul_f32 v138, v138, v70
v_mfma_f32_16x16x32_bf16 v[192:195], v[80:83], a[208:211], v[192:195]
ds_read_b64_tr_b16 v[116:117], v15 offset:36864
s_add_u32 m0, s76, 69632
v_mfma_f32_16x16x32_bf16 v[208:211], v[80:83], a[212:215], v[208:211]
ds_read_b64_tr_b16 v[118:119], v15 offset:53248
s_add_u32 s77, s99, 0x40000
v_mfma_f32_16x16x32_bf16 v[196:199], v[84:87], a[208:211], v[196:199]
buffer_load_dwordx4 a[68:71], v46, s[60:63], s91 offen offset:1024 sc1
v_mfma_f32_16x16x32_bf16 v[212:215], v[84:87], a[212:215], v[212:215]
ds_read_b64_tr_b16 v[120:121], v16 offset:36864
s_waitcnt lgkmcnt(6)
v_mfma_f32_16x16x32_bf16 v[200:203], v[88:91], a[208:211], v[200:203]
ds_read_b64_tr_b16 v[122:123], v16 offset:53248
ds_read_b64_tr_b16 v[124:125], v17 offset:36864
v_mfma_f32_16x16x32_bf16 v[216:219], v[88:91], a[212:215], v[216:219]
ds_read_b64_tr_b16 v[126:127], v17 offset:53248
v_mul_f32 v139, v139, v71
v_mfma_f32_16x16x32_bf16 v[204:207], v[92:95], a[208:211], v[204:207]
buffer_load_dwordx4 v38, s[48:51], s77 offen offset:0 lds
v_mfma_f32_16x16x32_bf16 v[220:223], v[92:95], a[212:215], v[220:223]
ds_read_b64_tr_b16 v[80:81], v14 offset:37888
ds_read_b64_tr_b16 v[82:83], v14 offset:54272
v_mfma_f32_16x16x32_bf16 v[192:195], v[96:99], a[216:219], v[192:195]
ds_read_b64_tr_b16 v[84:85], v15 offset:37888
v_mul_f32 v72, v60, v140
v_mfma_f32_16x16x32_bf16 v[208:211], v[96:99], a[220:223], v[208:211]
ds_read_b64_tr_b16 v[86:87], v15 offset:54272
ds_read_b64_tr_b16 v[88:89], v16 offset:37888
v_mfma_f32_16x16x32_bf16 v[196:199], v[100:103], a[216:219], v[196:199]
ds_read_b64_tr_b16 v[90:91], v16 offset:54272
v_mul_f32 v73, v60, v141
v_mfma_f32_16x16x32_bf16 v[212:215], v[100:103], a[220:223], v[212:215]
buffer_load_dwordx4 a[72:75], v46, s[60:63], s91 offen offset:2048 sc1
v_mfma_f32_16x16x32_bf16 v[200:203], v[104:107], a[216:219], v[200:203]
ds_read_b64_tr_b16 v[92:93], v17 offset:37888
ds_read_b64_tr_b16 v[94:95], v17 offset:54272
v_mfma_f32_16x16x32_bf16 v[216:219], v[104:107], a[220:223], v[216:219]
ds_read_b64_tr_b16 v[96:97], v14 offset:38912
s_waitcnt lgkmcnt(7)
v_mfma_f32_16x16x32_bf16 v[204:207], v[108:111], a[216:219], v[204:207]
ds_read_b64_tr_b16 v[98:99], v14 offset:55296
ds_read_b64_tr_b16 v[100:101], v15 offset:38912
v_mfma_f32_16x16x32_bf16 v[220:223], v[108:111], a[220:223], v[220:223]
buffer_load_dwordx4 v39, s[48:51], s77 offen offset:1024 lds
v_mfma_f32_16x16x32_bf16 v[192:195], v[112:115], a[224:227], v[192:195]
ds_read_b64_tr_b16 v[102:103], v15 offset:55296
ds_read_b64_tr_b16 v[104:105], v16 offset:38912
v_mfma_f32_16x16x32_bf16 v[208:211], v[112:115], a[228:231], v[208:211]
ds_read_b64_tr_b16 v[106:107], v16 offset:55296
v_mul_f32 v74, v60, v142
v_mfma_f32_16x16x32_bf16 v[196:199], v[116:119], a[224:227], v[196:199]
ds_read_b64_tr_b16 v[108:109], v17 offset:38912
v_mul_f32 v75, v60, v143
v_mfma_f32_16x16x32_bf16 v[212:215], v[116:119], a[228:231], v[212:215]
v_exp_f32 v72, v72
v_mfma_f32_16x16x32_bf16 v[200:203], v[120:123], a[224:227], v[200:203]
ds_read_b64_tr_b16 v[110:111], v17 offset:55296
ds_read_b64_tr_b16 v[112:113], v14 offset:39936
v_mfma_f32_16x16x32_bf16 v[216:219], v[120:123], a[228:231], v[216:219]
buffer_load_dwordx4 v40, s[48:51], s77 offen offset:2048 lds
v_mfma_f32_16x16x32_bf16 v[204:207], v[124:127], a[224:227], v[204:207]
ds_read_b64_tr_b16 v[114:115], v14 offset:56320
ds_read_b64_tr_b16 v[116:117], v15 offset:39936
v_mfma_f32_16x16x32_bf16 v[220:223], v[124:127], a[228:231], v[220:223]
v_exp_f32 v73, v73
v_mfma_f32_16x16x32_bf16 v[192:195], v[80:83], a[232:235], v[192:195]
ds_read_b64_tr_b16 v[118:119], v15 offset:56320
ds_read_b64_tr_b16 v[120:121], v16 offset:39936
v_mfma_f32_16x16x32_bf16 v[208:211], v[80:83], a[236:239], v[208:211]
ds_read_b64_tr_b16 v[122:123], v16 offset:56320
s_waitcnt lgkmcnt(7)
v_mfma_f32_16x16x32_bf16 v[196:199], v[84:87], a[232:235], v[196:199]
buffer_load_dwordx4 a[76:79], v46, s[60:63], s91 offen offset:3072 sc1
v_mfma_f32_16x16x32_bf16 v[212:215], v[84:87], a[236:239], v[212:215]
ds_read_b64_tr_b16 v[124:125], v17 offset:39936
ds_read_b64_tr_b16 v[126:127], v17 offset:56320
v_mfma_f32_16x16x32_bf16 v[200:203], v[88:91], a[232:235], v[200:203]
v_exp_f32 v74, v74
v_mfma_f32_16x16x32_bf16 v[216:219], v[88:91], a[236:239], v[216:219]
buffer_load_dwordx4 v41, s[48:51], s77 offen offset:3072 lds
v_mfma_f32_16x16x32_bf16 v[204:207], v[92:95], a[232:235], v[204:207]
v_exp_f32 v75, v75
v_mfma_f32_16x16x32_bf16 v[220:223], v[92:95], a[236:239], v[220:223]
v_fma_f32 v72, v72, v62, v62
v_fma_f32 v73, v73, v62, v62
v_mfma_f32_16x16x32_bf16 v[192:195], v[96:99], a[240:243], v[192:195]
s_waitcnt vmcnt(30) lgkmcnt(0)
s_barrier
v_mfma_f32_16x16x32_bf16 v[208:211], v[96:99], a[244:247], v[208:211]
ds_read_b64_tr_b16 v[80:81], v10 offset:0
ds_read_b64_tr_b16 v[82:83], v10 offset:16384
v_mfma_f32_16x16x32_bf16 v[196:199], v[100:103], a[240:243], v[196:199]
ds_read_b64_tr_b16 v[84:85], v11 offset:0
s_add_u32 m0, s76, 98304
v_mfma_f32_16x16x32_bf16 v[212:215], v[100:103], a[244:247], v[212:215]
ds_read_b64_tr_b16 v[86:87], v11 offset:16384
s_add_u32 s77, s97, 0x200000
v_mfma_f32_16x16x32_bf16 v[200:203], v[104:107], a[240:243], v[200:203]
ds_read_b64_tr_b16 v[88:89], v12 offset:0
ds_read_b64_tr_b16 v[90:91], v12 offset:16384
v_mfma_f32_16x16x32_bf16 v[216:219], v[104:107], a[244:247], v[216:219]
buffer_load_dwordx4 v38, s[48:51], s77 offen offset:0 lds
v_mfma_f32_16x16x32_bf16 v[204:207], v[108:111], a[240:243], v[204:207]
ds_read_b64_tr_b16 v[92:93], v13 offset:0
ds_read_b64_tr_b16 v[94:95], v13 offset:16384
v_mfma_f32_16x16x32_bf16 v[220:223], v[108:111], a[244:247], v[220:223]
ds_read_b64_tr_b16 v[96:97], v10 offset:1024
v_fma_f32 v74, v74, v62, v62
v_mfma_f32_16x16x32_bf16 v[192:195], v[112:115], a[248:251], v[192:195]
ds_read_b64_tr_b16 v[98:99], v10 offset:17408
ds_read_b64_tr_b16 v[100:101], v11 offset:1024
v_mfma_f32_16x16x32_bf16 v[208:211], v[112:115], a[252:255], v[208:211]
ds_read_b64_tr_b16 v[102:103], v11 offset:17408
v_fma_f32 v75, v75, v62, v62
v_mfma_f32_16x16x32_bf16 v[196:199], v[116:119], a[248:251], v[196:199]
v_rcp_f32 v72, v72
v_mfma_f32_16x16x32_bf16 v[212:215], v[116:119], a[252:255], v[212:215]
ds_read_b64_tr_b16 v[104:105], v12 offset:1024
ds_read_b64_tr_b16 v[106:107], v12 offset:17408
v_mfma_f32_16x16x32_bf16 v[200:203], v[120:123], a[248:251], v[200:203]
buffer_load_dwordx4 v39, s[48:51], s77 offen offset:1024 lds
v_mfma_f32_16x16x32_bf16 v[216:219], v[120:123], a[252:255], v[216:219]
ds_read_b64_tr_b16 v[108:109], v13 offset:1024
ds_read_b64_tr_b16 v[110:111], v13 offset:17408
v_mfma_f32_16x16x32_bf16 v[204:207], v[124:127], a[248:251], v[204:207]
v_rcp_f32 v73, v73
v_mfma_f32_16x16x32_bf16 v[220:223], v[124:127], a[252:255], v[220:223]
ds_read_b64_tr_b16 v[112:113], v10 offset:2048
ds_read_b64_tr_b16 v[114:115], v10 offset:18432
S_DA:
s_waitcnt lgkmcnt(6)
v_mfma_f32_16x16x32_bf16 v[160:163], v[80:83], a[0:3], 0
s_mov_b32 s87, 0
s_atomic_add s87, s[60:61], s24 offset:768 glc
ds_read_b64_tr_b16 v[116:117], v11 offset:2048
v_mfma_f32_16x16x32_bf16 v[176:179], v[80:83], a[4:7], 0
ds_read_b64_tr_b16 v[118:119], v11 offset:18432
ds_read_b64_tr_b16 v[120:121], v12 offset:2048
ds_read_b64_tr_b16 v[122:123], v12 offset:18432
v_mfma_f32_16x16x32_bf16 v[164:167], v[84:87], a[0:3], 0
buffer_load_dwordx4 v40, s[48:51], s77 offen offset:2048 lds
ds_read_b64_tr_b16 v[124:125], v13 offset:2048
v_mfma_f32_16x16x32_bf16 v[180:183], v[84:87], a[4:7], 0
ds_read_b64_tr_b16 v[126:127], v13 offset:18432
s_add_u32 s91, s6, 69632
ds_read_b64_tr_b16 v[80:81], v10 offset:3072
v_mfma_f32_16x16x32_bf16 v[168:171], v[88:91], a[0:3], 0
buffer_load_dwordx4 a[80:83], v46, s[60:63], s91 offen offset:0 sc1
ds_read_b64_tr_b16 v[82:83], v10 offset:19456
v_mfma_f32_16x16x32_bf16 v[184:187], v[88:91], a[4:7], 0
v_rcp_f32 v74, v74
ds_read_b64_tr_b16 v[84:85], v11 offset:3072
v_mfma_f32_16x16x32_bf16 v[172:175], v[92:95], a[0:3], 0
buffer_load_dwordx4 a[84:87], v46, s[60:63], s91 offen offset:1024 sc1
ds_read_b64_tr_b16 v[86:87], v11 offset:19456
v_mfma_f32_16x16x32_bf16 v[188:191], v[92:95], a[4:7], 0
v_rcp_f32 v75, v75
ds_read_b64_tr_b16 v[88:89], v12 offset:3072
v_mfma_f32_16x16x32_bf16 v[160:163], v[96:99], a[8:11], v[160:163]
buffer_load_dwordx4 v41, s[48:51], s77 offen offset:3072 lds
ds_read_b64_tr_b16 v[90:91], v12 offset:19456
v_mfma_f32_16x16x32_bf16 v[176:179], v[96:99], a[12:15], v[176:179]
ds_read_b64_tr_b16 v[92:93], v13 offset:3072
v_mul_f32 v140, v140, v72
v_mul_f32 v141, v141, v73
v_mfma_f32_16x16x32_bf16 v[164:167], v[100:103], a[8:11], v[164:167]
ds_read_b64_tr_b16 v[94:95], v13 offset:19456
v_mul_f32 v142, v142, v74
v_mul_f32 v143, v143, v75
v_mfma_f32_16x16x32_bf16 v[180:183], v[100:103], a[12:15], v[180:183]
ds_read_b64_tr_b16 v[96:97], v10 offset:4096
s_add_u32 m0, s76, 102400
s_waitcnt lgkmcnt(6)
v_mfma_f32_16x16x32_bf16 v[168:171], v[104:107], a[8:11], v[168:171]
ds_read_b64_tr_b16 v[98:99], v10 offset:20480
s_add_u32 s77, s98, 0x200000
v_mul_f32 v68, v61, v144
v_mfma_f32_16x16x32_bf16 v[184:187], v[104:107], a[12:15], v[184:187]
ds_read_b64_tr_b16 v[100:101], v11 offset:4096
v_mul_f32 v69, v61, v145
v_mul_f32 v70, v61, v146
v_mfma_f32_16x16x32_bf16 v[172:175], v[108:111], a[8:11], v[172:175]
buffer_load_dwordx4 v38, s[48:51], s77 offen offset:0 lds
ds_read_b64_tr_b16 v[102:103], v11 offset:20480
v_mfma_f32_16x16x32_bf16 v[188:191], v[108:111], a[12:15], v[188:191]
ds_read_b64_tr_b16 v[104:105], v12 offset:4096
v_mul_f32 v71, v61, v147
ds_read_b64_tr_b16 v[106:107], v12 offset:20480
v_mfma_f32_16x16x32_bf16 v[160:163], v[112:115], a[16:19], v[160:163]
v_exp_f32 v68, v68
ds_read_b64_tr_b16 v[108:109], v13 offset:4096
v_mfma_f32_16x16x32_bf16 v[176:179], v[112:115], a[20:23], v[176:179]
buffer_load_dwordx4 a[88:91], v46, s[60:63], s91 offen offset:2048 sc1
ds_read_b64_tr_b16 v[110:111], v13 offset:20480
v_mfma_f32_16x16x32_bf16 v[164:167], v[116:119], a[16:19], v[164:167]
v_exp_f32 v69, v69
ds_read_b64_tr_b16 v[112:113], v10 offset:5120
v_mfma_f32_16x16x32_bf16 v[180:183], v[116:119], a[20:23], v[180:183]
v_exp_f32 v70, v70
ds_read_b64_tr_b16 v[114:115], v10 offset:21504
v_mfma_f32_16x16x32_bf16 v[168:171], v[120:123], a[16:19], v[168:171]
v_exp_f32 v71, v71
ds_read_b64_tr_b16 v[116:117], v11 offset:5120
v_mfma_f32_16x16x32_bf16 v[184:187], v[120:123], a[20:23], v[184:187]
buffer_load_dwordx4 v39, s[48:51], s77 offen offset:1024 lds
ds_read_b64_tr_b16 v[118:119], v11 offset:21504
v_mfma_f32_16x16x32_bf16 v[172:175], v[124:127], a[16:19], v[172:175]
ds_read_b64_tr_b16 v[120:121], v12 offset:5120
v_fma_f32 v68, v68, v63, v63
v_fma_f32 v69, v69, v63, v63
v_mfma_f32_16x16x32_bf16 v[188:191], v[124:127], a[20:23], v[188:191]
ds_read_b64_tr_b16 v[122:123], v12 offset:21504
v_fma_f32 v70, v70, v63, v63
s_waitcnt vmcnt(13)
v_mfma_f32_16x16x32_bf16 v[160:163], v[80:83], a[24:27], v[160:163]
ds_read_b64_tr_b16 v[124:125], v13 offset:5120
v_fma_f32 v71, v71, v63, v63
v_mfma_f32_16x16x32_bf16 v[176:179], v[80:83], a[28:31], v[176:179]
v_rcp_f32 v68, v68
s_waitcnt lgkmcnt(5)
v_mfma_f32_16x16x32_bf16 v[164:167], v[84:87], a[24:27], v[164:167]
buffer_load_dwordx4 a[92:95], v46, s[60:63], s91 offen offset:3072 sc1
ds_read_b64_tr_b16 v[126:127], v13 offset:21504
v_mfma_f32_16x16x32_bf16 v[180:183], v[84:87], a[28:31], v[180:183]
v_rcp_f32 v69, v69
ds_read_b64_tr_b16 v[80:81], v10 offset:6144
v_mfma_f32_16x16x32_bf16 v[168:171], v[88:91], a[24:27], v[168:171]
v_rcp_f32 v70, v70
ds_read_b64_tr_b16 v[82:83], v10 offset:22528
v_mfma_f32_16x16x32_bf16 v[184:187], v[88:91], a[28:31], v[184:187]
v_rcp_f32 v71, v71
ds_read_b64_tr_b16 v[84:85], v11 offset:6144
v_mfma_f32_16x16x32_bf16 v[172:175], v[92:95], a[24:27], v[172:175]
buffer_load_dwordx4 v40, s[48:51], s77 offen offset:2048 lds
ds_read_b64_tr_b16 v[86:87], v11 offset:22528
v_mfma_f32_16x16x32_bf16 v[188:191], v[92:95], a[28:31], v[188:191]
ds_read_b64_tr_b16 v[88:89], v12 offset:6144
v_mul_f32 v144, v144, v68
v_mul_f32 v145, v145, v69
v_mfma_f32_16x16x32_bf16 a[224:227], v[96:99], a[0:3], 0
ds_read_b64_tr_b16 v[90:91], v12 offset:22528
v_mul_f32 v146, v146, v70
v_mul_f32 v147, v147, v71
v_mfma_f32_16x16x32_bf16 a[240:243], v[96:99], a[4:7], 0
ds_read_b64_tr_b16 v[92:93], v13 offset:6144
v_mul_f32 v72, v61, v148
v_mul_f32 v73, v61, v149
v_mfma_f32_16x16x32_bf16 a[228:231], v[100:103], a[0:3], 0
ds_read_b64_tr_b16 v[94:95], v13 offset:22528
v_mul_f32 v74, v61, v150
v_mul_f32 v75, v61, v151
v_mfma_f32_16x16x32_bf16 a[244:247], v[100:103], a[4:7], 0
ds_read_b64_tr_b16 v[96:97], v10 offset:7168
s_add_u32 s91, s6, 73728
ds_read_b64_tr_b16 v[98:99], v10 offset:23552
v_mfma_f32_16x16x32_bf16 a[232:235], v[104:107], a[0:3], 0
buffer_load_dwordx4 v41, s[48:51], s77 offen offset:3072 lds
ds_read_b64_tr_b16 v[100:101], v11 offset:7168
v_mfma_f32_16x16x32_bf16 a[248:251], v[104:107], a[4:7], 0
v_exp_f32 v72, v72
ds_read_b64_tr_b16 v[102:103], v11 offset:23552
v_mfma_f32_16x16x32_bf16 a[236:239], v[108:111], a[0:3], 0
v_exp_f32 v73, v73
ds_read_b64_tr_b16 v[104:105], v12 offset:7168
v_mfma_f32_16x16x32_bf16 a[252:255], v[108:111], a[4:7], 0
buffer_load_dwordx4 a[96:99], v46, s[60:63], s91 offen offset:0 sc1
ds_read_b64_tr_b16 v[106:107], v12 offset:23552
v_mfma_f32_16x16x32_bf16 a[224:227], v[112:115], a[8:11], a[224:227]
v_exp_f32 v74, v74
ds_read_b64_tr_b16 v[108:109], v13 offset:7168
v_mfma_f32_16x16x32_bf16 a[240:243], v[112:115], a[12:15], a[240:243]
v_exp_f32 v75, v75
s_waitcnt lgkmcnt(5)
v_mfma_f32_16x16x32_bf16 a[228:231], v[116:119], a[8:11], a[228:231]
ds_read_b64_tr_b16 v[110:111], v13 offset:23552
v_fma_f32 v72, v72, v63, v63
v_fma_f32 v73, v73, v63, v63
v_mfma_f32_16x16x32_bf16 a[244:247], v[116:119], a[12:15], a[244:247]
v_fma_f32 v74, v74, v63, v63
v_fma_f32 v75, v75, v63, v63
v_mfma_f32_16x16x32_bf16 a[232:235], v[120:123], a[8:11], a[232:235]
buffer_load_dwordx4 a[100:103], v46, s[60:63], s91 offen offset:1024 sc1
v_mfma_f32_16x16x32_bf16 a[248:251], v[120:123], a[12:15], a[248:251]
v_rcp_f32 v72, v72
v_mfma_f32_16x16x32_bf16 a[236:239], v[124:127], a[8:11], a[236:239]
v_rcp_f32 v73, v73
v_mfma_f32_16x16x32_bf16 a[252:255], v[124:127], a[12:15], a[252:255]
s_waitcnt lgkmcnt(0)
s_barrier
ds_read_b64_tr_b16 v[112:113], v10 offset:32768
v_mfma_f32_16x16x32_bf16 a[224:227], v[80:83], a[16:19], a[224:227]
v_rcp_f32 v74, v74
s_add_u32 m0, s76, 0
v_mfma_f32_16x16x32_bf16 a[240:243], v[80:83], a[20:23], a[240:243]
ds_read_b64_tr_b16 v[114:115], v10 offset:49152
ds_read_b64_tr_b16 v[116:117], v11 offset:32768
ds_read_b64_tr_b16 v[118:119], v11 offset:49152
v_mfma_f32_16x16x32_bf16 a[228:231], v[84:87], a[16:19], a[228:231]
v_rcp_f32 v75, v75
s_add_u32 s77, s99, 0x200000
v_mfma_f32_16x16x32_bf16 a[244:247], v[84:87], a[20:23], a[244:247]
ds_read_b64_tr_b16 v[120:121], v12 offset:32768
ds_read_b64_tr_b16 v[122:123], v12 offset:49152
ds_read_b64_tr_b16 v[124:125], v13 offset:32768
v_mfma_f32_16x16x32_bf16 a[232:235], v[88:91], a[16:19], a[232:235]
buffer_load_dwordx4 v38, s[48:51], s77 offen offset:0 lds
ds_read_b64_tr_b16 v[126:127], v13 offset:49152
v_mfma_f32_16x16x32_bf16 a[248:251], v[88:91], a[20:23], a[248:251]
ds_read_b64_tr_b16 v[80:81], v10 offset:33792
ds_read_b64_tr_b16 v[82:83], v10 offset:50176
v_mul_f32 v148, v148, v72
v_mfma_f32_16x16x32_bf16 a[236:239], v[92:95], a[16:19], a[236:239]
buffer_load_dwordx4 a[104:107], v46, s[60:63], s91 offen offset:2048 sc1
ds_read_b64_tr_b16 v[84:85], v11 offset:33792
v_mfma_f32_16x16x32_bf16 a[252:255], v[92:95], a[20:23], a[252:255]
ds_read_b64_tr_b16 v[86:87], v11 offset:50176
v_mul_f32 v149, v149, v73
v_mul_f32 v150, v150, v74
v_mfma_f32_16x16x32_bf16 a[224:227], v[96:99], a[24:27], a[224:227]
ds_read_b64_tr_b16 v[88:89], v12 offset:33792
v_mul_f32 v151, v151, v75
v_mul_f32 v68, v61, v152
v_mfma_f32_16x16x32_bf16 a[240:243], v[96:99], a[28:31], a[240:243]
buffer_load_dwordx4 a[108:111], v46, s[60:63], s91 offen offset:3072 sc1
ds_read_b64_tr_b16 v[90:91], v12 offset:50176
v_mfma_f32_16x16x32_bf16 a[228:231], v[100:103], a[24:27], a[228:231]
ds_read_b64_tr_b16 v[92:93], v13 offset:33792
v_mul_f32 v69, v61, v153
v_mul_f32 v70, v61, v154
v_mfma_f32_16x16x32_bf16 a[244:247], v[100:103], a[28:31], a[244:247]
ds_read_b64_tr_b16 v[94:95], v13 offset:50176
v_mul_f32 v71, v61, v155
ds_read_b64_tr_b16 v[96:97], v10 offset:34816
v_mfma_f32_16x16x32_bf16 a[232:235], v[104:107], a[24:27], a[232:235]
v_exp_f32 v68, v68
ds_read_b64_tr_b16 v[98:99], v10 offset:51200
v_mfma_f32_16x16x32_bf16 a[248:251], v[104:107], a[28:31], a[248:251]
v_exp_f32 v69, v69
ds_read_b64_tr_b16 v[100:101], v11 offset:34816
v_mfma_f32_16x16x32_bf16 a[236:239], v[108:111], a[24:27], a[236:239]
buffer_load_dwordx4 v39, s[48:51], s77 offen offset:1024 lds
ds_read_b64_tr_b16 v[102:103], v11 offset:51200
v_mfma_f32_16x16x32_bf16 a[252:255], v[108:111], a[28:31], a[252:255]
v_exp_f32 v70, v70
s_waitcnt lgkmcnt(6)
v_mfma_f32_16x16x32_bf16 v[224:227], v[112:115], a[0:3], 0
ds_read_b64_tr_b16 v[104:105], v12 offset:34816
v_exp_f32 v71, v71
v_mfma_f32_16x16x32_bf16 v[240:243], v[112:115], a[4:7], 0
ds_read_b64_tr_b16 v[106:107], v12 offset:51200
v_fma_f32 v68, v68, v63, v63
v_fma_f32 v69, v69, v63, v63
v_mfma_f32_16x16x32_bf16 v[228:231], v[116:119], a[0:3], 0
ds_read_b64_tr_b16 v[108:109], v13 offset:34816
v_fma_f32 v70, v70, v63, v63
v_fma_f32 v71, v71, v63, v63
v_mfma_f32_16x16x32_bf16 v[244:247], v[116:119], a[4:7], 0
v_rcp_f32 v68, v68
ds_read_b64_tr_b16 v[110:111], v13 offset:51200
v_mfma_f32_16x16x32_bf16 v[232:235], v[120:123], a[0:3], 0
buffer_load_dwordx4 v40, s[48:51], s77 offen offset:2048 lds
ds_read_b64_tr_b16 v[112:113], v10 offset:35840
v_mfma_f32_16x16x32_bf16 v[248:251], v[120:123], a[4:7], 0
v_rcp_f32 v69, v69
ds_read_b64_tr_b16 v[114:115], v10 offset:52224
v_mfma_f32_16x16x32_bf16 v[236:239], v[124:127], a[0:3], 0
v_rcp_f32 v70, v70
ds_read_b64_tr_b16 v[116:117], v11 offset:35840
v_mfma_f32_16x16x32_bf16 v[252:255], v[124:127], a[4:7], 0
ds_read_b64_tr_b16 v[118:119], v11 offset:52224
s_add_u32 s91, s6, 77824
ds_read_b64_tr_b16 v[120:121], v12 offset:35840
v_mfma_f32_16x16x32_bf16 v[224:227], v[80:83], a[8:11], v[224:227]
buffer_load_dwordx4 a[112:115], v46, s[60:63], s91 offen offset:0 sc1
ds_read_b64_tr_b16 v[122:123], v12 offset:52224
v_mfma_f32_16x16x32_bf16 v[240:243], v[80:83], a[12:15], v[240:243]
v_rcp_f32 v71, v71
ds_read_b64_tr_b16 v[124:125], v13 offset:35840
v_mfma_f32_16x16x32_bf16 v[228:231], v[84:87], a[8:11], v[228:231]
ds_read_b64_tr_b16 v[126:127], v13 offset:52224
v_mul_f32 v152, v152, v68
v_mul_f32 v153, v153, v69
v_mfma_f32_16x16x32_bf16 v[244:247], v[84:87], a[12:15], v[244:247]
buffer_load_dwordx4 v41, s[48:51], s77 offen offset:3072 lds
ds_read_b64_tr_b16 v[80:81], v10 offset:36864
v_mfma_f32_16x16x32_bf16 v[232:235], v[88:91], a[8:11], v[232:235]
ds_read_b64_tr_b16 v[82:83], v10 offset:53248
v_mul_f32 v154, v154, v70
v_mul_f32 v155, v155, v71
v_mfma_f32_16x16x32_bf16 v[248:251], v[88:91], a[12:15], v[248:251]
ds_read_b64_tr_b16 v[84:85], v11 offset:36864
v_mul_f32 v72, v61, v156
s_waitcnt lgkmcnt(6)
v_mfma_f32_16x16x32_bf16 v[236:239], v[92:95], a[8:11], v[236:239]
ds_read_b64_tr_b16 v[86:87], v11 offset:53248
s_add_u32 m0, s76, 4096
s_add_u32 s77, s97, 0x240000
v_mfma_f32_16x16x32_bf16 v[252:255], v[92:95], a[12:15], v[252:255]
ds_read_b64_tr_b16 v[88:89], v12 offset:36864
v_mul_f32 v73, v61, v157
v_mul_f32 v74, v61, v158
v_mfma_f32_16x16x32_bf16 v[224:227], v[96:99], a[16:19], v[224:227]
buffer_load_dwordx4 a[116:119], v46, s[60:63], s91 offen offset:1024 sc1
ds_read_b64_tr_b16 v[90:91], v12 offset:53248
v_mfma_f32_16x16x32_bf16 v[240:243], v[96:99], a[20:23], v[240:243]
ds_read_b64_tr_b16 v[92:93], v13 offset:36864
v_mul_f32 v75, v61, v159
ds_read_b64_tr_b16 v[94:95], v13 offset:53248
v_mfma_f32_16x16x32_bf16 v[228:231], v[100:103], a[16:19], v[228:231]
v_exp_f32 v72, v72
ds_read_b64_tr_b16 v[96:97], v10 offset:37888
v_mfma_f32_16x16x32_bf16 v[244:247], v[100:103], a[20:23], v[244:247]
v_exp_f32 v73, v73
ds_read_b64_tr_b16 v[98:99], v10 offset:54272
v_mfma_f32_16x16x32_bf16 v[232:235], v[104:107], a[16:19], v[232:235]
buffer_load_dwordx4 v38, s[48:51], s77 offen offset:0 lds
ds_read_b64_tr_b16 v[100:101], v11 offset:37888
v_mfma_f32_16x16x32_bf16 v[248:251], v[104:107], a[20:23], v[248:251]
v_exp_f32 v74, v74
ds_read_b64_tr_b16 v[102:103], v11 offset:54272
v_mfma_f32_16x16x32_bf16 v[236:239], v[108:111], a[16:19], v[236:239]
v_exp_f32 v75, v75
ds_read_b64_tr_b16 v[104:105], v12 offset:37888
v_mfma_f32_16x16x32_bf16 v[252:255], v[108:111], a[20:23], v[252:255]
ds_read_b64_tr_b16 v[106:107], v12 offset:54272
v_fma_f32 v72, v72, v63, v63
v_fma_f32 v73, v73, v63, v63
v_mfma_f32_16x16x32_bf16 v[224:227], v[112:115], a[24:27], v[224:227]
ds_read_b64_tr_b16 v[108:109], v13 offset:37888
v_fma_f32 v74, v74, v63, v63
v_fma_f32 v75, v75, v63, v63
v_mfma_f32_16x16x32_bf16 v[240:243], v[112:115], a[28:31], v[240:243]
buffer_load_dwordx4 a[120:123], v46, s[60:63], s91 offen offset:2048 sc1
ds_read_b64_tr_b16 v[110:111], v13 offset:54272
v_mfma_f32_16x16x32_bf16 v[228:231], v[116:119], a[24:27], v[228:231]
v_rcp_f32 v72, v72
ds_read_b64_tr_b16 v[112:113], v10 offset:38912
v_mfma_f32_16x16x32_bf16 v[244:247], v[116:119], a[28:31], v[244:247]
v_rcp_f32 v73, v73
s_waitcnt lgkmcnt(5)
v_mfma_f32_16x16x32_bf16 v[232:235], v[120:123], a[24:27], v[232:235]
v_rcp_f32 v74, v74
ds_read_b64_tr_b16 v[114:115], v10 offset:55296
v_mfma_f32_16x16x32_bf16 v[248:251], v[120:123], a[28:31], v[248:251]
buffer_load_dwordx4 v39, s[48:51], s77 offen offset:1024 lds
ds_read_b64_tr_b16 v[116:117], v11 offset:38912
v_mfma_f32_16x16x32_bf16 v[236:239], v[124:127], a[24:27], v[236:239]
v_rcp_f32 v75, v75
ds_read_b64_tr_b16 v[118:119], v11 offset:55296
v_mfma_f32_16x16x32_bf16 v[252:255], v[124:127], a[28:31], v[252:255]
ds_read_b64_tr_b16 v[120:121], v12 offset:38912
v_mul_f32 v156, v156, v72
v_mul_f32 v157, v157, v73
v_mfma_f32_16x16x32_bf16 v[160:163], v[80:83], a[32:35], v[160:163]
ds_read_b64_tr_b16 v[122:123], v12 offset:55296
v_mul_f32 v158, v158, v74
v_mul_f32 v159, v159, v75
v_mfma_f32_16x16x32_bf16 v[176:179], v[80:83], a[36:39], v[176:179]
ds_read_b64_tr_b16 v[124:125], v13 offset:38912
ds_read_b64_tr_b16 v[126:127], v13 offset:55296
v_mfma_f32_16x16x32_bf16 v[164:167], v[84:87], a[32:35], v[164:167]
buffer_load_dwordx4 a[124:127], v46, s[60:63], s91 offen offset:3072 sc1
s_cmp_lt_u32 s87, 4
s_cbranch_scc1 pl_6_slow
pl_6_ok:
v_mfma_f32_16x16x32_bf16 v[180:183], v[84:87], a[36:39], v[180:183]
ds_read_b64_tr_b16 v[80:81], v10 offset:39936
s_lshl_b32 s7, s25, 5
s_add_u32 s7, s7, s4
v_mfma_f32_16x16x32_bf16 v[168:171], v[88:91], a[32:35], v[168:171]
ds_read_b64_tr_b16 v[82:83], v10 offset:56320
v_mul_f32 v192, v192, v128
v_mul_f32 v193, v193, v129
v_mfma_f32_16x16x32_bf16 v[184:187], v[88:91], a[36:39], v[184:187]
ds_read_b64_tr_b16 v[84:85], v11 offset:39936
v_mul_f32 v194, v194, v130
v_mul_f32 v195, v195, v131
v_mfma_f32_16x16x32_bf16 v[172:175], v[92:95], a[32:35], v[172:175]
buffer_load_dwordx4 v40, s[48:51], s77 offen offset:2048 lds
ds_read_b64_tr_b16 v[86:87], v11 offset:56320
v_mfma_f32_16x16x32_bf16 v[188:191], v[92:95], a[36:39], v[188:191]
ds_read_b64_tr_b16 v[88:89], v12 offset:39936
v_mul_f32 v196, v196, v132
v_mul_f32 v197, v197, v133
v_mfma_f32_16x16x32_bf16 v[160:163], v[96:99], a[40:43], v[160:163]
ds_read_b64_tr_b16 v[90:91], v12 offset:56320
v_mul_f32 v198, v198, v134
v_mul_f32 v199, v199, v135
v_mfma_f32_16x16x32_bf16 v[176:179], v[96:99], a[44:47], v[176:179]
ds_read_b64_tr_b16 v[92:93], v13 offset:39936
v_cvt_pk_bf16_f32 v192, v192, v193
v_cvt_pk_bf16_f32 v193, v194, v195
v_mfma_f32_16x16x32_bf16 v[164:167], v[100:103], a[40:43], v[164:167]
ds_read_b64_tr_b16 v[94:95], v13 offset:56320
v_cvt_pk_bf16_f32 v194, v196, v197
v_cvt_pk_bf16_f32 v195, v198, v199
v_mfma_f32_16x16x32_bf16 v[180:183], v[100:103], a[44:47], v[180:183]
s_add_u32 s91, s26, 0
s_waitcnt lgkmcnt(5)
v_mfma_f32_16x16x32_bf16 v[168:171], v[104:107], a[40:43], v[168:171]
buffer_load_dwordx4 v41, s[48:51], s77 offen offset:3072 lds
v_mfma_f32_16x16x32_bf16 v[184:187], v[104:107], a[44:47], v[184:187]
v_mfma_f32_16x16x32_bf16 v[172:175], v[108:111], a[40:43], v[172:175]
buffer_store_dwordx4 v[192:195], v46, s[60:63], s7 offen offset:0 sc1
v_mul_f32 v200, v200, v136
v_mfma_f32_16x16x32_bf16 v[188:191], v[108:111], a[44:47], v[188:191]
s_waitcnt vmcnt(29) lgkmcnt(0)
s_barrier
ds_read_b64_tr_b16 v[96:97], v14 offset:0
v_mfma_f32_16x16x32_bf16 v[160:163], v[112:115], a[48:51], v[160:163]
ds_read_b64_tr_b16 v[98:99], v14 offset:16384
s_add_u32 m0, s76, 32768
s_add_u32 s77, s98, 0x240000
v_mfma_f32_16x16x32_bf16 v[176:179], v[112:115], a[52:55], v[176:179]
ds_read_b64_tr_b16 v[100:101], v15 offset:0
ds_read_b64_tr_b16 v[102:103], v15 offset:16384
ds_read_b64_tr_b16 v[104:105], v16 offset:0
v_mfma_f32_16x16x32_bf16 v[164:167], v[116:119], a[48:51], v[164:167]
ds_read_b64_tr_b16 v[106:107], v16 offset:16384
v_mul_f32 v201, v201, v137
v_mul_f32 v202, v202, v138
v_mfma_f32_16x16x32_bf16 v[180:183], v[116:119], a[52:55], v[180:183]
ds_read_b64_tr_b16 v[108:109], v17 offset:0
ds_read_b64_tr_b16 v[110:111], v17 offset:16384
v_mul_f32 v203, v203, v139
v_mfma_f32_16x16x32_bf16 v[168:171], v[120:123], a[48:51], v[168:171]
buffer_load_dwordx4 v38, s[48:51], s77 offen offset:0 lds
ds_read_b64_tr_b16 v[112:113], v14 offset:1024
v_mfma_f32_16x16x32_bf16 v[184:187], v[120:123], a[52:55], v[184:187]
ds_read_b64_tr_b16 v[114:115], v14 offset:17408
v_mul_f32 v204, v204, v140
v_mul_f32 v205, v205, v141
v_mfma_f32_16x16x32_bf16 v[172:175], v[124:127], a[48:51], v[172:175]
ds_read_b64_tr_b16 v[116:117], v15 offset:1024
v_mul_f32 v206, v206, v142
v_mul_f32 v207, v207, v143
v_mfma_f32_16x16x32_bf16 v[188:191], v[124:127], a[52:55], v[188:191]
ds_read_b64_tr_b16 v[118:119], v15 offset:17408
v_cvt_pk_bf16_f32 v200, v200, v201
v_cvt_pk_bf16_f32 v201, v202, v203
v_mfma_f32_16x16x32_bf16 v[160:163], v[80:83], a[56:59], v[160:163]
buffer_load_dwordx4 a[128:131], v46, s[60:63], s91 offen offset:0 sc1
ds_read_b64_tr_b16 v[120:121], v16 offset:1024
v_mfma_f32_16x16x32_bf16 v[176:179], v[80:83], a[60:63], v[176:179]
ds_read_b64_tr_b16 v[122:123], v16 offset:17408
v_cvt_pk_bf16_f32 v202, v204, v205
v_cvt_pk_bf16_f32 v203, v206, v207
v_mfma_f32_16x16x32_bf16 v[164:167], v[84:87], a[56:59], v[164:167]
buffer_store_dwordx4 v[200:203], v46, s[60:63], s7 offen offset:2048 sc1
ds_read_b64_tr_b16 v[124:125], v17 offset:1024
v_mfma_f32_16x16x32_bf16 v[180:183], v[84:87], a[60:63], v[180:183]
ds_read_b64_tr_b16 v[126:127], v17 offset:17408
v_mul_f32 v208, v208, v144
v_mul_f32 v209, v209, v145
v_mfma_f32_16x16x32_bf16 v[168:171], v[88:91], a[56:59], v[168:171]
ds_read_b64_tr_b16 v[80:81], v14 offset:2048
v_mul_f32 v210, v210, v146
v_mul_f32 v211, v211, v147
v_mfma_f32_16x16x32_bf16 v[184:187], v[88:91], a[60:63], v[184:187]
ds_read_b64_tr_b16 v[82:83], v14 offset:18432
v_mul_f32 v212, v212, v148
v_mul_f32 v213, v213, v149
v_mfma_f32_16x16x32_bf16 v[172:175], v[92:95], a[56:59], v[172:175]
ds_read_b64_tr_b16 v[84:85], v15 offset:2048
v_mul_f32 v214, v214, v150
v_mul_f32 v215, v215, v151
v_mfma_f32_16x16x32_bf16 v[188:191], v[92:95], a[60:63], v[188:191]
ds_read_b64_tr_b16 v[86:87], v15 offset:18432
v_cvt_pk_bf16_f32 v208, v208, v209
s_waitcnt lgkmcnt(6)
v_mfma_f32_16x16x32_bf16 a[224:227], v[96:99], a[32:35], a[224:227]
ds_read_b64_tr_b16 v[88:89], v16 offset:2048
v_cvt_pk_bf16_f32 v209, v210, v211
v_cvt_pk_bf16_f32 v210, v212, v213
v_mfma_f32_16x16x32_bf16 a[240:243], v[96:99], a[36:39], a[240:243]
buffer_load_dwordx4 v39, s[48:51], s77 offen offset:1024 lds
ds_read_b64_tr_b16 v[90:91], v16 offset:18432
v_mfma_f32_16x16x32_bf16 a[228:231], v[100:103], a[32:35], a[228:231]
ds_read_b64_tr_b16 v[92:93], v17 offset:2048
v_cvt_pk_bf16_f32 v211, v214, v215
ds_read_b64_tr_b16 v[94:95], v17 offset:18432
v_mfma_f32_16x16x32_bf16 a[244:247], v[100:103], a[36:39], a[244:247]
buffer_store_dwordx4 v[208:211], v46, s[60:63], s7 offen offset:1024 sc1
ds_read_b64_tr_b16 v[96:97], v14 offset:3072
v_mfma_f32_16x16x32_bf16 a[232:235], v[104:107], a[32:35], a[232:235]
ds_read_b64_tr_b16 v[98:99], v14 offset:19456
v_mul_f32 v216, v216, v152
v_mul_f32 v217, v217, v153
v_mfma_f32_16x16x32_bf16 a[248:251], v[104:107], a[36:39], a[248:251]
ds_read_b64_tr_b16 v[100:101], v15 offset:3072
v_mul_f32 v218, v218, v154
v_mul_f32 v219, v219, v155
v_mfma_f32_16x16x32_bf16 a[236:239], v[108:111], a[32:35], a[236:239]
ds_read_b64_tr_b16 v[102:103], v15 offset:19456
v_mul_f32 v220, v220, v156
v_mul_f32 v221, v221, v157
v_mfma_f32_16x16x32_bf16 a[252:255], v[108:111], a[36:39], a[252:255]
ds_read_b64_tr_b16 v[104:105], v16 offset:3072
v_mul_f32 v222, v222, v158
v_mul_f32 v223, v223, v159
v_mfma_f32_16x16x32_bf16 a[224:227], v[112:115], a[40:43], a[224:227]
ds_read_b64_tr_b16 v[106:107], v16 offset:19456
v_cvt_pk_bf16_f32 v216, v216, v217
v_cvt_pk_bf16_f32 v217, v218, v219
v_mfma_f32_16x16x32_bf16 a[240:243], v[112:115], a[44:47], a[240:243]
ds_read_b64_tr_b16 v[108:109], v17 offset:3072
v_cvt_pk_bf16_f32 v218, v220, v221
v_cvt_pk_bf16_f32 v219, v222, v223
v_mfma_f32_16x16x32_bf16 a[228:231], v[116:119], a[40:43], a[228:231]
buffer_load_dwordx4 v40, s[48:51], s77 offen offset:2048 lds
ds_read_b64_tr_b16 v[110:111], v17 offset:19456
v_mfma_f32_16x16x32_bf16 a[244:247], v[116:119], a[44:47], a[244:247]
ds_read_b64_tr_b16 v[112:113], v14 offset:4096
ds_read_b64_tr_b16 v[114:115], v14 offset:20480
v_mfma_f32_16x16x32_bf16 a[232:235], v[120:123], a[40:43], a[232:235]
buffer_store_dwordx4 v[216:219], v46, s[60:63], s7 offen offset:3072 sc1
ds_read_b64_tr_b16 v[116:117], v15 offset:4096
v_mfma_f32_16x16x32_bf16 a[248:251], v[120:123], a[44:47], a[248:251]
ds_read_b64_tr_b16 v[118:119], v15 offset:20480
s_waitcnt lgkmcnt(7)
v_mfma_f32_16x16x32_bf16 a[236:239], v[124:127], a[40:43], a[236:239]
ds_read_b64_tr_b16 v[120:121], v16 offset:4096
v_mfma_f32_16x16x32_bf16 a[252:255], v[124:127], a[44:47], a[252:255]
ds_read_b64_tr_b16 v[122:123], v16 offset:20480
v_mfma_f32_16x16x32_bf16 a[224:227], v[80:83], a[48:51], a[224:227]
ds_read_b64_tr_b16 v[124:125], v17 offset:4096
v_mfma_f32_16x16x32_bf16 a[240:243], v[80:83], a[52:55], a[240:243]
ds_read_b64_tr_b16 v[126:127], v17 offset:20480
v_mfma_f32_16x16x32_bf16 a[228:231], v[84:87], a[48:51], a[228:231]
ds_read_b64_tr_b16 v[80:81], v14 offset:5120
v_mfma_f32_16x16x32_bf16 a[244:247], v[84:87], a[52:55], a[244:247]
buffer_load_dwordx4 v41, s[48:51], s77 offen offset:3072 lds
v_mfma_f32_16x16x32_bf16 a[232:235], v[88:91], a[48:51], a[232:235]
ds_read_b64_tr_b16 v[82:83], v14 offset:21504
ds_read_b64_tr_b16 v[84:85], v15 offset:5120
v_mfma_f32_16x16x32_bf16 a[248:251], v[88:91], a[52:55], a[248:251]
ds_read_b64_tr_b16 v[86:87], v15 offset:21504
v_mfma_f32_16x16x32_bf16 a[236:239], v[92:95], a[48:51], a[236:239]
ds_read_b64_tr_b16 v[88:89], v16 offset:5120
s_add_u32 m0, s76, 36864
v_mfma_f32_16x16x32_bf16 a[252:255], v[92:95], a[52:55], a[252:255]
ds_read_b64_tr_b16 v[90:91], v16 offset:21504
s_add_u32 s77, s97, 0x600000
v_mfma_f32_16x16x32_bf16 a[224:227], v[96:99], a[56:59], a[224:227]
buffer_load_dwordx4 a[132:135], v46, s[60:63], s91 offen offset:1024 sc1
v_mfma_f32_16x16x32_bf16 a[240:243], v[96:99], a[60:63], a[240:243]
ds_read_b64_tr_b16 v[92:93], v17 offset:5120
ds_read_b64_tr_b16 v[94:95], v17 offset:21504
v_mfma_f32_16x16x32_bf16 a[228:231], v[100:103], a[56:59], a[228:231]
ds_read_b64_tr_b16 v[96:97], v14 offset:6144
v_mfma_f32_16x16x32_bf16 a[244:247], v[100:103], a[60:63], a[244:247]
ds_read_b64_tr_b16 v[98:99], v14 offset:22528
s_waitcnt lgkmcnt(6)
v_mfma_f32_16x16x32_bf16 a[232:235], v[104:107], a[56:59], a[232:235]
buffer_load_dwordx4 v26, s[48:51], s77 offen offset:0 lds
v_mfma_f32_16x16x32_bf16 a[248:251], v[104:107], a[60:63], a[248:251]
ds_read_b64_tr_b16 v[100:101], v15 offset:6144
ds_read_b64_tr_b16 v[102:103], v15 offset:22528
v_mfma_f32_16x16x32_bf16 a[236:239], v[108:111], a[56:59], a[236:239]
ds_read_b64_tr_b16 v[104:105], v16 offset:6144
v_mfma_f32_16x16x32_bf16 a[252:255], v[108:111], a[60:63], a[252:255]
ds_read_b64_tr_b16 v[106:107], v16 offset:22528
v_mfma_f32_16x16x32_bf16 v[224:227], v[112:115], a[32:35], v[224:227]
ds_read_b64_tr_b16 v[108:109], v17 offset:6144
v_mfma_f32_16x16x32_bf16 v[240:243], v[112:115], a[36:39], v[240:243]
buffer_load_dwordx4 a[136:139], v46, s[60:63], s91 offen offset:2048 sc1
v_mfma_f32_16x16x32_bf16 v[228:231], v[116:119], a[32:35], v[228:231]
ds_read_b64_tr_b16 v[110:111], v17 offset:22528
ds_read_b64_tr_b16 v[112:113], v14 offset:7168
v_mfma_f32_16x16x32_bf16 v[244:247], v[116:119], a[36:39], v[244:247]
ds_read_b64_tr_b16 v[114:115], v14 offset:23552
v_mfma_f32_16x16x32_bf16 v[232:235], v[120:123], a[32:35], v[232:235]
ds_read_b64_tr_b16 v[116:117], v15 offset:7168
v_mfma_f32_16x16x32_bf16 v[248:251], v[120:123], a[36:39], v[248:251]
buffer_load_dwordx4 v27, s[48:51], s77 offen offset:1024 lds
v_mfma_f32_16x16x32_bf16 v[236:239], v[124:127], a[32:35], v[236:239]
ds_read_b64_tr_b16 v[118:119], v15 offset:23552
ds_read_b64_tr_b16 v[120:121], v16 offset:7168
v_mfma_f32_16x16x32_bf16 v[252:255], v[124:127], a[36:39], v[252:255]
ds_read_b64_tr_b16 v[122:123], v16 offset:23552
v_mfma_f32_16x16x32_bf16 v[224:227], v[80:83], a[40:43], v[224:227]
ds_read_b64_tr_b16 v[124:125], v17 offset:7168
v_mfma_f32_16x16x32_bf16 v[240:243], v[80:83], a[44:47], v[240:243]
ds_read_b64_tr_b16 v[126:127], v17 offset:23552
v_mfma_f32_16x16x32_bf16 v[228:231], v[84:87], a[40:43], v[228:231]
buffer_load_dwordx4 a[140:143], v46, s[60:63], s91 offen offset:3072 sc1
v_mfma_f32_16x16x32_bf16 v[244:247], v[84:87], a[44:47], v[244:247]
s_add_u32 s91, s26, 4096
s_waitcnt lgkmcnt(5)
v_mfma_f32_16x16x32_bf16 v[232:235], v[88:91], a[40:43], v[232:235]
v_mfma_f32_16x16x32_bf16 v[248:251], v[88:91], a[44:47], v[248:251]
v_mfma_f32_16x16x32_bf16 v[236:239], v[92:95], a[40:43], v[236:239]
s_waitcnt vmcnt(30) lgkmcnt(0)
s_barrier
v_mfma_f32_16x16x32_bf16 v[252:255], v[92:95], a[44:47], v[252:255]
ds_read_b64_tr_b16 v[80:81], v14 offset:32768
ds_read_b64_tr_b16 v[82:83], v14 offset:49152
v_mfma_f32_16x16x32_bf16 v[224:227], v[96:99], a[48:51], v[224:227]
buffer_load_dwordx4 v28, s[48:51], s77 offen offset:2048 lds
v_mfma_f32_16x16x32_bf16 v[240:243], v[96:99], a[52:55], v[240:243]
ds_read_b64_tr_b16 v[84:85], v15 offset:32768
ds_read_b64_tr_b16 v[86:87], v15 offset:49152
v_mfma_f32_16x16x32_bf16 v[228:231], v[100:103], a[48:51], v[228:231]
ds_read_b64_tr_b16 v[88:89], v16 offset:32768
v_mfma_f32_16x16x32_bf16 v[244:247], v[100:103], a[52:55], v[244:247]
buffer_load_dwordx4 a[144:147], v46, s[60:63], s91 offen offset:0 sc1
v_mfma_f32_16x16x32_bf16 v[232:235], v[104:107], a[48:51], v[232:235]
ds_read_b64_tr_b16 v[90:91], v16 offset:49152
ds_read_b64_tr_b16 v[92:93], v17 offset:32768
v_mfma_f32_16x16x32_bf16 v[248:251], v[104:107], a[52:55], v[248:251]
ds_read_b64_tr_b16 v[94:95], v17 offset:49152
v_mfma_f32_16x16x32_bf16 v[236:239], v[108:111], a[48:51], v[236:239]
ds_read_b64_tr_b16 v[96:97], v14 offset:33792
ds_read_b64_tr_b16 v[98:99], v14 offset:50176
v_mfma_f32_16x16x32_bf16 v[252:255], v[108:111], a[52:55], v[252:255]
buffer_load_dwordx4 v29, s[48:51], s77 offen offset:3072 lds
v_mfma_f32_16x16x32_bf16 v[224:227], v[112:115], a[56:59], v[224:227]
s_waitcnt vmcnt(9)
s_atomic_add s69, s[60:61], s24 offset:896
v_mfma_f32_16x16x32_bf16 v[240:243], v[112:115], a[60:63], v[240:243]
ds_read_b64_tr_b16 v[100:101], v15 offset:33792
ds_read_b64_tr_b16 v[102:103], v15 offset:50176
v_mfma_f32_16x16x32_bf16 v[228:231], v[116:119], a[56:59], v[228:231]
ds_read_b64_tr_b16 v[104:105], v16 offset:33792
s_add_u32 m0, s76, 65536
v_mfma_f32_16x16x32_bf16 v[244:247], v[116:119], a[60:63], v[244:247]
ds_read_b64_tr_b16 v[106:107], v16 offset:50176
s_add_u32 s77, s98, 0x600000
v_mfma_f32_16x16x32_bf16 v[232:235], v[120:123], a[56:59], v[232:235]
buffer_load_dwordx4 a[148:151], v46, s[60:63], s91 offen offset:1024 sc1
v_mfma_f32_16x16x32_bf16 v[248:251], v[120:123], a[60:63], v[248:251]
ds_read_b64_tr_b16 v[108:109], v17 offset:33792
ds_read_b64_tr_b16 v[110:111], v17 offset:50176
v_mfma_f32_16x16x32_bf16 v[236:239], v[124:127], a[56:59], v[236:239]
ds_read_b64_tr_b16 v[112:113], v14 offset:34816
v_mfma_f32_16x16x32_bf16 v[252:255], v[124:127], a[60:63], v[252:255]
ds_read_b64_tr_b16 v[114:115], v14 offset:51200
s_waitcnt lgkmcnt(6)
v_mfma_f32_16x16x32_bf16 v[160:163], v[80:83], a[64:67], v[160:163]
buffer_load_dwordx4 v26, s[48:51], s77 offen offset:0 lds
v_mfma_f32_16x16x32_bf16 v[176:179], v[80:83], a[68:71], v[176:179]
ds_read_b64_tr_b16 v[116:117], v15 offset:34816
ds_read_b64_tr_b16 v[118:119], v15 offset:51200
v_mfma_f32_16x16x32_bf16 v[164:167], v[84:87], a[64:67], v[164:167]
ds_read_b64_tr_b16 v[120:121], v16 offset:34816
v_mfma_f32_16x16x32_bf16 v[180:183], v[84:87], a[68:71], v[180:183]
ds_read_b64_tr_b16 v[122:123], v16 offset:51200
ds_read_b64_tr_b16 v[124:125], v17 offset:34816
v_mfma_f32_16x16x32_bf16 v[168:171], v[88:91], a[64:67], v[168:171]
ds_read_b64_tr_b16 v[126:127], v17 offset:51200
v_mfma_f32_16x16x32_bf16 v[184:187], v[88:91], a[68:71], v[184:187]
buffer_load_dwordx4 a[152:155], v46, s[60:63], s91 offen offset:2048 sc1
v_mfma_f32_16x16x32_bf16 v[172:175], v[92:95], a[64:67], v[172:175]
ds_read_b64_tr_b16 v[80:81], v14 offset:35840
ds_read_b64_tr_b16 v[82:83], v14 offset:52224
v_mfma_f32_16x16x32_bf16 v[188:191], v[92:95], a[68:71], v[188:191]
ds_read_b64_tr_b16 v[84:85], v15 offset:35840
v_mfma_f32_16x16x32_bf16 v[160:163], v[96:99], a[72:75], v[160:163]
ds_read_b64_tr_b16 v[86:87], v15 offset:52224
ds_read_b64_tr_b16 v[88:89], v16 offset:35840
v_mfma_f32_16x16x32_bf16 v[176:179], v[96:99], a[76:79], v[176:179]
buffer_load_dwordx4 v27, s[48:51], s77 offen offset:1024 lds
v_mfma_f32_16x16x32_bf16 v[164:167], v[100:103], a[72:75], v[164:167]
ds_read_b64_tr_b16 v[90:91], v16 offset:52224
ds_read_b64_tr_b16 v[92:93], v17 offset:35840
v_mfma_f32_16x16x32_bf16 v[180:183], v[100:103], a[76:79], v[180:183]
ds_read_b64_tr_b16 v[94:95], v17 offset:52224
s_waitcnt lgkmcnt(8)
v_mfma_f32_16x16x32_bf16 v[168:171], v[104:107], a[72:75], v[168:171]
ds_read_b64_tr_b16 v[96:97], v14 offset:36864
ds_read_b64_tr_b16 v[98:99], v14 offset:53248
v_mfma_f32_16x16x32_bf16 v[184:187], v[104:107], a[76:79], v[184:187]
ds_read_b64_tr_b16 v[100:101], v15 offset:36864
v_mfma_f32_16x16x32_bf16 v[172:175], v[108:111], a[72:75], v[172:175]
buffer_load_dwordx4 a[156:159], v46, s[60:63], s91 offen offset:3072 sc1
v_mfma_f32_16x16x32_bf16 v[188:191], v[108:111], a[76:79], v[188:191]
ds_read_b64_tr_b16 v[102:103], v15 offset:53248
ds_read_b64_tr_b16 v[104:105], v16 offset:36864
v_mfma_f32_16x16x32_bf16 v[160:163], v[112:115], a[80:83], v[160:163]
ds_read_b64_tr_b16 v[106:107], v16 offset:53248
v_mfma_f32_16x16x32_bf16 v[176:179], v[112:115], a[84:87], v[176:179]
ds_read_b64_tr_b16 v[108:109], v17 offset:36864
ds_read_b64_tr_b16 v[110:111], v17 offset:53248
v_mfma_f32_16x16x32_bf16 v[164:167], v[116:119], a[80:83], v[164:167]
buffer_load_dwordx4 v28, s[48:51], s77 offen offset:2048 lds
v_mfma_f32_16x16x32_bf16 v[180:183], v[116:119], a[84:87], v[180:183]
ds_read_b64_tr_b16 v[112:113], v14 offset:37888
ds_read_b64_tr_b16 v[114:115], v14 offset:54272
v_mfma_f32_16x16x32_bf16 v[168:171], v[120:123], a[80:83], v[168:171]
ds_read_b64_tr_b16 v[116:117], v15 offset:37888
v_mfma_f32_16x16x32_bf16 v[184:187], v[120:123], a[84:87], v[184:187]
ds_read_b64_tr_b16 v[118:119], v15 offset:54272
v_mfma_f32_16x16x32_bf16 v[172:175], v[124:127], a[80:83], v[172:175]
ds_read_b64_tr_b16 v[120:121], v16 offset:37888
v_mfma_f32_16x16x32_bf16 v[188:191], v[124:127], a[84:87], v[188:191]
ds_read_b64_tr_b16 v[122:123], v16 offset:54272
s_waitcnt lgkmcnt(6)
v_mfma_f32_16x16x32_bf16 v[160:163], v[80:83], a[88:91], v[160:163]
buffer_load_dwordx4 v29, s[48:51], s77 offen offset:3072 lds
v_mfma_f32_16x16x32_bf16 v[176:179], v[80:83], a[92:95], v[176:179]
ds_read_b64_tr_b16 v[124:125], v17 offset:37888
ds_read_b64_tr_b16 v[126:127], v17 offset:54272
v_mfma_f32_16x16x32_bf16 v[164:167], v[84:87], a[88:91], v[164:167]
ds_read_b64_tr_b16 v[80:81], v14 offset:38912
v_mfma_f32_16x16x32_bf16 v[180:183], v[84:87], a[92:95], v[180:183]
ds_read_b64_tr_b16 v[82:83], v14 offset:55296
s_add_u32 m0, s76, 69632
v_mfma_f32_16x16x32_bf16 v[168:171], v[88:91], a[88:91], v[168:171]
ds_read_b64_tr_b16 v[84:85], v15 offset:38912
s_add_u32 s77, s97, 0x400000
v_mfma_f32_16x16x32_bf16 v[184:187], v[88:91], a[92:95], v[184:187]
ds_read_b64_tr_b16 v[86:87], v15 offset:55296
ds_read_b128 v[60:63], v56 offset:256
v_mfma_f32_16x16x32_bf16 v[172:175], v[92:95], a[88:91], v[172:175]
buffer_load_dwordx4 v38, s[48:51], s77 offen offset:0 lds
v_mfma_f32_16x16x32_bf16 v[188:191], v[92:95], a[92:95], v[188:191]
ds_read_b64_tr_b16 v[88:89], v16 offset:38912
ds_read_b128 v[64:67], v56 offset:320
v_mfma_f32_16x16x32_bf16 a[224:227], v[96:99], a[64:67], a[224:227]
ds_read_b64_tr_b16 v[90:91], v16 offset:55296
ds_read_b128 v[68:71], v56 offset:384
v_mfma_f32_16x16x32_bf16 a[240:243], v[96:99], a[68:71], a[240:243]
ds_read_b64_tr_b16 v[92:93], v17 offset:38912
ds_read_b128 v[72:75], v56 offset:448
v_mfma_f32_16x16x32_bf16 a[228:231], v[100:103], a[64:67], a[228:231]
ds_read_b64_tr_b16 v[94:95], v17 offset:55296
v_and_b32 v2, 15, v1
v_mfma_f32_16x16x32_bf16 a[244:247], v[100:103], a[68:71], a[244:247]
ds_read_b64_tr_b16 v[96:97], v14 offset:39936
v_lshrrev_b32 v3, 2, v2
v_mfma_f32_16x16x32_bf16 a[232:235], v[104:107], a[64:67], a[232:235]
buffer_load_dwordx4 v39, s[48:51], s77 offen offset:1024 lds
v_mfma_f32_16x16x32_bf16 a[248:251], v[104:107], a[68:71], a[248:251]
ds_read_b64_tr_b16 v[98:99], v14 offset:56320
v_lshrrev_b32 v4, 4, v1
v_mfma_f32_16x16x32_bf16 a[236:239], v[108:111], a[64:67], a[236:239]
ds_read_b64_tr_b16 v[100:101], v15 offset:39936
v_and_b32 v5, 1, v1
v_mfma_f32_16x16x32_bf16 a[252:255], v[108:111], a[68:71], a[252:255]
ds_read_b64_tr_b16 v[102:103], v15 offset:56320
s_waitcnt lgkmcnt(5)
v_mfma_f32_16x16x32_bf16 a[224:227], v[112:115], a[72:75], a[224:227]
ds_read_b64_tr_b16 v[104:105], v16 offset:39936
v_lshlrev_b32 v5, 4, v5
v_mfma_f32_16x16x32_bf16 a[240:243], v[112:115], a[76:79], a[240:243]
ds_read_b64_tr_b16 v[106:107], v16 offset:56320
v_mov_b32 v6, 0x3f80
v_mfma_f32_16x16x32_bf16 a[228:231], v[116:119], a[72:75], a[228:231]
buffer_load_dwordx4 v40, s[48:51], s77 offen offset:2048 lds
v_mfma_f32_16x16x32_bf16 a[244:247], v[116:119], a[76:79], a[244:247]
ds_read_b64_tr_b16 v[108:109], v17 offset:39936
ds_read_b64_tr_b16 v[110:111], v17 offset:56320
v_mfma_f32_16x16x32_bf16 a[232:235], v[120:123], a[72:75], a[232:235]
v_lshlrev_b32 v5, v5, v6
v_mfma_f32_16x16x32_bf16 a[248:251], v[120:123], a[76:79], a[248:251]
v_cmp_eq_u32 vcc, v3, v4
s_nop 1
v_cndmask_b32 v5, 0, v5, vcc
v_mfma_f32_16x16x32_bf16 a[236:239], v[124:127], a[72:75], a[236:239]
v_and_b32 v6, 2, v1
v_mfma_f32_16x16x32_bf16 a[252:255], v[124:127], a[76:79], a[252:255]
v_cmp_eq_u32 vcc, 0, v6
s_nop 1
v_cndmask_b32 v76, 0, v5, vcc
v_mfma_f32_16x16x32_bf16 a[224:227], v[80:83], a[80:83], a[224:227]
s_waitcnt lgkmcnt(0)
s_barrier
s_mov_b32 s87, 0
s_atomic_add s87, s[60:61], s24 offset:896 glc
v_mfma_f32_16x16x32_bf16 a[240:243], v[80:83], a[84:87], a[240:243]
ds_read_b64_tr_b16 v[112:113], v10 offset:0
ds_read_b64_tr_b16 v[114:115], v10 offset:16384
v_mfma_f32_16x16x32_bf16 a[228:231], v[84:87], a[80:83], a[228:231]
ds_read_b64_tr_b16 v[116:117], v11 offset:0
v_sub_u32 v77, v5, v76
v_mfma_f32_16x16x32_bf16 a[244:247], v[84:87], a[84:87], a[244:247]
ds_read_b64_tr_b16 v[118:119], v11 offset:16384
ds_read_b64_tr_b16 v[120:121], v12 offset:0
v_mfma_f32_16x16x32_bf16 a[232:235], v[88:91], a[80:83], a[232:235]
buffer_load_dwordx4 v41, s[48:51], s77 offen offset:3072 lds
v_mfma_f32_16x16x32_bf16 a[248:251], v[88:91], a[84:87], a[248:251]
ds_read_b64_tr_b16 v[122:123], v12 offset:16384
ds_read_b64_tr_b16 v[124:125], v13 offset:0
v_mfma_f32_16x16x32_bf16 a[236:239], v[92:95], a[80:83], a[236:239]
ds_read_b64_tr_b16 v[126:127], v13 offset:16384
v_lshlrev_b32 v2, 11, v2
v_mfma_f32_16x16x32_bf16 a[252:255], v[92:95], a[84:87], a[252:255]
ds_read_b64_tr_b16 v[80:81], v10 offset:1024
s_add_u32 m0, s76, 98304
v_mfma_f32_16x16x32_bf16 a[224:227], v[96:99], a[88:91], a[224:227]
ds_read_b64_tr_b16 v[82:83], v10 offset:17408
s_add_u32 s77, s98, 0x400000
v_mfma_f32_16x16x32_bf16 a[240:243], v[96:99], a[92:95], a[240:243]
ds_read_b64_tr_b16 v[84:85], v11 offset:1024
ds_read_b64_tr_b16 v[86:87], v11 offset:17408
v_mfma_f32_16x16x32_bf16 a[228:231], v[100:103], a[88:91], a[228:231]
buffer_load_dwordx4 v38, s[48:51], s77 offen offset:0 lds
v_mfma_f32_16x16x32_bf16 a[244:247], v[100:103], a[92:95], a[244:247]
ds_read_b64_tr_b16 v[88:89], v12 offset:1024
ds_read_b64_tr_b16 v[90:91], v12 offset:17408
v_mfma_f32_16x16x32_bf16 a[232:235], v[104:107], a[88:91], a[232:235]
ds_read_b64_tr_b16 v[92:93], v13 offset:1024
v_bfe_u32 v3, v1, 4, 1
v_mfma_f32_16x16x32_bf16 a[248:251], v[104:107], a[92:95], a[248:251]
ds_read_b64_tr_b16 v[94:95], v13 offset:17408
ds_read_b64_tr_b16 v[96:97], v10 offset:2048
v_mfma_f32_16x16x32_bf16 a[236:239], v[108:111], a[88:91], a[236:239]
ds_read_b64_tr_b16 v[98:99], v10 offset:18432
v_lshl_add_u32 v2, v3, 5, v2
v_mfma_f32_16x16x32_bf16 a[252:255], v[108:111], a[92:95], a[252:255]
ds_read_b64_tr_b16 v[100:101], v11 offset:2048
s_waitcnt lgkmcnt(7)
v_mfma_f32_16x16x32_bf16 v[224:227], v[112:115], a[64:67], v[224:227]
buffer_load_dwordx4 v39, s[48:51], s77 offen offset:1024 lds
v_mfma_f32_16x16x32_bf16 v[240:243], v[112:115], a[68:71], v[240:243]
ds_read_b64_tr_b16 v[102:103], v11 offset:18432
ds_read_b64_tr_b16 v[104:105], v12 offset:2048
v_mfma_f32_16x16x32_bf16 v[228:231], v[116:119], a[64:67], v[228:231]
ds_read_b64_tr_b16 v[106:107], v12 offset:18432
v_bfe_u32 v3, v1, 5, 1
v_mfma_f32_16x16x32_bf16 v[244:247], v[116:119], a[68:71], v[244:247]
ds_read_b64_tr_b16 v[108:109], v13 offset:2048
ds_read_b64_tr_b16 v[110:111], v13 offset:18432
v_mfma_f32_16x16x32_bf16 v[232:235], v[120:123], a[64:67], v[232:235]
ds_read_b64_tr_b16 v[112:113], v10 offset:3072
v_lshl_add_u32 v2, v3, 4, v2
v_mfma_f32_16x16x32_bf16 v[248:251], v[120:123], a[68:71], v[248:251]
ds_read_b64_tr_b16 v[114:115], v10 offset:19456
s_add_u32 s12, s88, s83
v_mfma_f32_16x16x32_bf16 v[236:239], v[124:127], a[64:67], v[236:239]
buffer_load_dwordx4 v40, s[48:51], s77 offen offset:2048 lds
v_mfma_f32_16x16x32_bf16 v[252:255], v[124:127], a[68:71], v[252:255]
ds_read_b64_tr_b16 v[116:117], v11 offset:3072
ds_read_b64_tr_b16 v[118:119], v11 offset:19456
v_mfma_f32_16x16x32_bf16 v[224:227], v[80:83], a[72:75], v[224:227]
ds_read_b64_tr_b16 v[120:121], v12 offset:3072
s_add_u32 s13, s12, 32768
v_mfma_f32_16x16x32_bf16 v[240:243], v[80:83], a[76:79], v[240:243]
ds_read_b64_tr_b16 v[122:123], v12 offset:19456
s_add_u32 s14, s11, 4096
v_mfma_f32_16x16x32_bf16 v[228:231], v[84:87], a[72:75], v[228:231]
ds_read_b64_tr_b16 v[124:125], v13 offset:3072
s_add_u32 s15, s11, 8192
v_mfma_f32_16x16x32_bf16 v[244:247], v[84:87], a[76:79], v[244:247]
ds_read_b64_tr_b16 v[126:127], v13 offset:19456
s_waitcnt lgkmcnt(6)
v_mfma_f32_16x16x32_bf16 v[232:235], v[88:91], a[72:75], v[232:235]
buffer_load_dwordx4 v41, s[48:51], s77 offen offset:3072 lds
v_mfma_f32_16x16x32_bf16 v[248:251], v[88:91], a[76:79], v[248:251]
ds_read_b64_tr_b16 v[80:81], v10 offset:4096
ds_read_b64_tr_b16 v[82:83], v10 offset:20480
v_mfma_f32_16x16x32_bf16 v[236:239], v[92:95], a[72:75], v[236:239]
buffer_load_dwordx4 v[128:131], v46, s[60:63], s27 offen offset:0 sc1
v_mfma_f32_16x16x32_bf16 v[252:255], v[92:95], a[76:79], v[252:255]
ds_read_b64_tr_b16 v[84:85], v11 offset:4096
ds_read_b64_tr_b16 v[86:87], v11 offset:20480
v_mfma_f32_16x16x32_bf16 v[224:227], v[96:99], a[80:83], v[224:227]
buffer_load_dwordx4 v[132:135], v46, s[60:63], s27 offen offset:2048 sc1
v_mfma_f32_16x16x32_bf16 v[240:243], v[96:99], a[84:87], v[240:243]
ds_read_b64_tr_b16 v[88:89], v12 offset:4096
ds_read_b64_tr_b16 v[90:91], v12 offset:20480
v_mfma_f32_16x16x32_bf16 v[228:231], v[100:103], a[80:83], v[228:231]
buffer_load_dwordx4 v[136:139], v46, s[60:63], s27 offen offset:1024 sc1
v_mfma_f32_16x16x32_bf16 v[244:247], v[100:103], a[84:87], v[244:247]
ds_read_b64_tr_b16 v[92:93], v13 offset:4096
ds_read_b64_tr_b16 v[94:95], v13 offset:20480
v_mfma_f32_16x16x32_bf16 v[232:235], v[104:107], a[80:83], v[232:235]
buffer_load_dwordx4 v[140:143], v46, s[60:63], s27 offen offset:3072 sc1
v_mfma_f32_16x16x32_bf16 v[248:251], v[104:107], a[84:87], v[248:251]
ds_read_b64_tr_b16 v[96:97], v10 offset:5120
ds_read_b64_tr_b16 v[98:99], v10 offset:21504
v_mfma_f32_16x16x32_bf16 v[236:239], v[108:111], a[80:83], v[236:239]
ds_read_b64_tr_b16 v[100:101], v11 offset:5120
s_add_u32 m0, s76, 102400
v_mfma_f32_16x16x32_bf16 v[252:255], v[108:111], a[84:87], v[252:255]
ds_read_b64_tr_b16 v[102:103], v11 offset:21504
s_add_u32 s77, s97, 0x440000
v_mfma_f32_16x16x32_bf16 v[224:227], v[112:115], a[88:91], v[224:227]
ds_read_b64_tr_b16 v[104:105], v12 offset:5120
ds_read_b64_tr_b16 v[106:107], v12 offset:21504
v_mfma_f32_16x16x32_bf16 v[240:243], v[112:115], a[92:95], v[240:243]
ds_read_b64_tr_b16 v[108:109], v13 offset:5120
s_waitcnt lgkmcnt(7)
v_mfma_f32_16x16x32_bf16 v[228:231], v[116:119], a[88:91], v[228:231]
buffer_load_dwordx4 v38, s[48:51], s77 offen offset:0 lds
v_mfma_f32_16x16x32_bf16 v[244:247], v[116:119], a[92:95], v[244:247]
ds_read_b64_tr_b16 v[110:111], v13 offset:21504
ds_read_b64_tr_b16 v[112:113], v10 offset:6144
v_mfma_f32_16x16x32_bf16 v[232:235], v[120:123], a[88:91], v[232:235]
ds_read_b64_tr_b16 v[114:115], v10 offset:22528
v_mfma_f32_16x16x32_bf16 v[248:251], v[120:123], a[92:95], v[248:251]
ds_read_b64_tr_b16 v[116:117], v11 offset:6144
ds_read_b64_tr_b16 v[118:119], v11 offset:22528
v_mfma_f32_16x16x32_bf16 v[236:239], v[124:127], a[88:91], v[236:239]
ds_read_b64_tr_b16 v[120:121], v12 offset:6144
v_mfma_f32_16x16x32_bf16 v[252:255], v[124:127], a[92:95], v[252:255]
ds_read_b64_tr_b16 v[122:123], v12 offset:22528
v_mfma_f32_16x16x32_bf16 v[160:163], v[80:83], a[96:99], v[160:163]
buffer_load_dwordx4 v39, s[48:51], s77 offen offset:1024 lds
v_mfma_f32_16x16x32_bf16 v[176:179], v[80:83], a[100:103], v[176:179]
ds_read_b64_tr_b16 v[124:125], v13 offset:6144
ds_read_b64_tr_b16 v[126:127], v13 offset:22528
v_mfma_f32_16x16x32_bf16 v[164:167], v[84:87], a[96:99], v[164:167]
ds_read_b64_tr_b16 v[80:81], v10 offset:7168
v_mfma_f32_16x16x32_bf16 v[180:183], v[84:87], a[100:103], v[180:183]
ds_read_b64_tr_b16 v[82:83], v10 offset:23552
v_mfma_f32_16x16x32_bf16 v[168:171], v[88:91], a[96:99], v[168:171]
ds_read_b64_tr_b16 v[84:85], v11 offset:7168
v_mfma_f32_16x16x32_bf16 v[184:187], v[88:91], a[100:103], v[184:187]
ds_read_b64_tr_b16 v[86:87], v11 offset:23552
v_mfma_f32_16x16x32_bf16 v[172:175], v[92:95], a[96:99], v[172:175]
buffer_load_dwordx4 v40, s[48:51], s77 offen offset:2048 lds
v_mfma_f32_16x16x32_bf16 v[188:191], v[92:95], a[100:103], v[188:191]
ds_read_b64_tr_b16 v[88:89], v12 offset:7168
s_waitcnt lgkmcnt(5)
v_mfma_f32_16x16x32_bf16 v[160:163], v[96:99], a[104:107], v[160:163]
ds_read_b64_tr_b16 v[90:91], v12 offset:23552
ds_read_b64_tr_b16 v[92:93], v13 offset:7168
v_mfma_f32_16x16x32_bf16 v[176:179], v[96:99], a[108:111], v[176:179]
ds_read_b64_tr_b16 v[94:95], v13 offset:23552
v_mfma_f32_16x16x32_bf16 v[164:167], v[100:103], a[104:107], v[164:167]
v_mfma_f32_16x16x32_bf16 v[180:183], v[100:103], a[108:111], v[180:183]
s_add_u32 s70, s0, S_D3 - K_pc + 0
s_addc_u32 s71, s1, 0
global_load_dword v57, v9, s[70:71]
v_mfma_f32_16x16x32_bf16 v[168:171], v[104:107], a[104:107], v[168:171]
v_mfma_f32_16x16x32_bf16 v[184:187], v[104:107], a[108:111], v[184:187]
buffer_load_dwordx4 v41, s[48:51], s77 offen offset:3072 lds
v_mfma_f32_16x16x32_bf16 v[172:175], v[108:111], a[104:107], v[172:175]
s_waitcnt vmcnt(24) lgkmcnt(0)
s_barrier
s_cmp_lt_u32 s87, 4
s_cbranch_scc1 pl_7_slow
pl_7_ok:
v_mfma_f32_16x16x32_bf16 v[188:191], v[108:111], a[108:111], v[188:191]
ds_read_b64_tr_b16 v[96:97], v10 offset:32768
ds_read_b64_tr_b16 v[98:99], v10 offset:49152
v_mfma_f32_16x16x32_bf16 v[160:163], v[112:115], a[112:115], v[160:163]
ds_read_b64_tr_b16 v[100:101], v11 offset:32768
s_add_u32 m0, s76, 0
v_mfma_f32_16x16x32_bf16 v[176:179], v[112:115], a[116:119], v[176:179]
ds_read_b64_tr_b16 v[102:103], v11 offset:49152
s_add_u32 s77, s98, 0x440000
v_mfma_f32_16x16x32_bf16 v[164:167], v[116:119], a[112:115], v[164:167]
buffer_load_dwordx4 v38, s[48:51], s77 offen offset:0 lds
v_mfma_f32_16x16x32_bf16 v[180:183], v[116:119], a[116:119], v[180:183]
ds_read_b64_tr_b16 v[104:105], v12 offset:32768
ds_read_b64_tr_b16 v[106:107], v12 offset:49152
v_mfma_f32_16x16x32_bf16 v[168:171], v[120:123], a[112:115], v[168:171]
ds_read_b64_tr_b16 v[108:109], v13 offset:32768
s_add_u32 s19, s6, 131072
v_mfma_f32_16x16x32_bf16 v[184:187], v[120:123], a[116:119], v[184:187]
buffer_load_dwordx4 a[160:163], v46, s[60:63], s19 offen offset:0 sc1
v_mfma_f32_16x16x32_bf16 v[172:175], v[124:127], a[112:115], v[172:175]
ds_read_b64_tr_b16 v[110:111], v13 offset:49152
ds_read_b64_tr_b16 v[112:113], v10 offset:33792
v_mfma_f32_16x16x32_bf16 v[188:191], v[124:127], a[116:119], v[188:191]
ds_read_b64_tr_b16 v[114:115], v10 offset:50176
v_mfma_f32_16x16x32_bf16 v[160:163], v[80:83], a[120:123], v[160:163]
buffer_load_dwordx4 v39, s[48:51], s77 offen offset:1024 lds
v_mfma_f32_16x16x32_bf16 v[176:179], v[80:83], a[124:127], v[176:179]
ds_read_b64_tr_b16 v[116:117], v11 offset:33792
ds_read_b64_tr_b16 v[118:119], v11 offset:50176
v_mfma_f32_16x16x32_bf16 v[164:167], v[84:87], a[120:123], v[164:167]
ds_read_b64_tr_b16 v[120:121], v12 offset:33792
v_mfma_f32_16x16x32_bf16 v[180:183], v[84:87], a[124:127], v[180:183]
ds_read_b64_tr_b16 v[122:123], v12 offset:50176
ds_read_b64_tr_b16 v[124:125], v13 offset:33792
v_mfma_f32_16x16x32_bf16 v[168:171], v[88:91], a[120:123], v[168:171]
ds_read_b64_tr_b16 v[126:127], v13 offset:50176
v_mfma_f32_16x16x32_bf16 v[184:187], v[88:91], a[124:127], v[184:187]
buffer_load_dwordx4 a[164:167], v46, s[60:63], s19 offen offset:1024 sc1
v_mfma_f32_16x16x32_bf16 v[172:175], v[92:95], a[120:123], v[172:175]
ds_read_b64_tr_b16 v[80:81], v10 offset:34816
ds_read_b64_tr_b16 v[82:83], v10 offset:51200
v_mfma_f32_16x16x32_bf16 v[188:191], v[92:95], a[124:127], v[188:191]
ds_read_b64_tr_b16 v[84:85], v11 offset:34816
s_waitcnt lgkmcnt(7)
v_mfma_f32_16x16x32_bf16 a[224:227], v[96:99], a[96:99], a[224:227]
ds_read_b64_tr_b16 v[86:87], v11 offset:51200
ds_read_b64_tr_b16 v[88:89], v12 offset:34816
v_mfma_f32_16x16x32_bf16 a[240:243], v[96:99], a[100:103], a[240:243]
buffer_load_dwordx4 v40, s[48:51], s77 offen offset:2048 lds
v_mfma_f32_16x16x32_bf16 a[228:231], v[100:103], a[96:99], a[228:231]
ds_read_b64_tr_b16 v[90:91], v12 offset:51200
ds_read_b64_tr_b16 v[92:93], v13 offset:34816
v_mfma_f32_16x16x32_bf16 a[244:247], v[100:103], a[100:103], a[244:247]
ds_read_b64_tr_b16 v[94:95], v13 offset:51200
v_mfma_f32_16x16x32_bf16 a[232:235], v[104:107], a[96:99], a[232:235]
ds_read_b64_tr_b16 v[96:97], v10 offset:35840
ds_read_b64_tr_b16 v[98:99], v10 offset:52224
v_mfma_f32_16x16x32_bf16 a[248:251], v[104:107], a[100:103], a[248:251]
ds_read_b64_tr_b16 v[100:101], v11 offset:35840
v_mfma_f32_16x16x32_bf16 a[236:239], v[108:111], a[96:99], a[236:239]
buffer_load_dwordx4 a[168:171], v46, s[60:63], s19 offen offset:2048 sc1
v_mfma_f32_16x16x32_bf16 a[252:255], v[108:111], a[100:103], a[252:255]
ds_read_b64_tr_b16 v[102:103], v11 offset:52224
ds_read_b64_tr_b16 v[104:105], v12 offset:35840
v_mfma_f32_16x16x32_bf16 a[224:227], v[112:115], a[104:107], a[224:227]
ds_read_b64_tr_b16 v[106:107], v12 offset:52224
v_mfma_f32_16x16x32_bf16 a[240:243], v[112:115], a[108:111], a[240:243]
ds_read_b64_tr_b16 v[108:109], v13 offset:35840
ds_read_b64_tr_b16 v[110:111], v13 offset:52224
v_mfma_f32_16x16x32_bf16 a[228:231], v[116:119], a[104:107], a[228:231]
buffer_load_dwordx4 v41, s[48:51], s77 offen offset:3072 lds
v_mfma_f32_16x16x32_bf16 a[244:247], v[116:119], a[108:111], a[244:247]
ds_read_b64_tr_b16 v[112:113], v10 offset:36864
s_waitcnt lgkmcnt(6)
v_mfma_f32_16x16x32_bf16 a[232:235], v[120:123], a[104:107], a[232:235]
ds_read_b64_tr_b16 v[114:115], v10 offset:53248
ds_read_b64_tr_b16 v[116:117], v11 offset:36864
v_mfma_f32_16x16x32_bf16 a[248:251], v[120:123], a[108:111], a[248:251]
ds_read_b64_tr_b16 v[118:119], v11 offset:53248
s_add_u32 m0, s76, 4096
v_mfma_f32_16x16x32_bf16 a[236:239], v[124:127], a[104:107], a[236:239]
ds_read_b64_tr_b16 v[120:121], v12 offset:36864
s_add_u32 s77, s99, 0x240000
v_mfma_f32_16x16x32_bf16 a[252:255], v[124:127], a[108:111], a[252:255]
buffer_load_dwordx4 a[172:175], v46, s[60:63], s19 offen offset:3072 sc1
v_mfma_f32_16x16x32_bf16 a[224:227], v[80:83], a[112:115], a[224:227]
ds_read_b64_tr_b16 v[122:123], v12 offset:53248
s_add_u32 s19, s6, 135168
v_mfma_f32_16x16x32_bf16 a[240:243], v[80:83], a[116:119], a[240:243]
ds_read_b64_tr_b16 v[124:125], v13 offset:36864
s_waitcnt vmcnt(13)
v_lshlrev_b32 v192, 16, v128
v_mfma_f32_16x16x32_bf16 a[228:231], v[84:87], a[112:115], a[228:231]
ds_read_b64_tr_b16 v[126:127], v13 offset:53248
v_and_b32 v193, 0xffff0000, v128
v_mfma_f32_16x16x32_bf16 a[244:247], v[84:87], a[116:119], a[244:247]
buffer_load_dwordx4 v38, s[48:51], s77 offen offset:0 lds
v_mfma_f32_16x16x32_bf16 a[232:235], v[88:91], a[112:115], a[232:235]
ds_read_b64_tr_b16 v[80:81], v10 offset:37888
v_lshlrev_b32 v194, 16, v129
v_mfma_f32_16x16x32_bf16 a[248:251], v[88:91], a[116:119], a[248:251]
ds_read_b64_tr_b16 v[82:83], v10 offset:54272
v_and_b32 v195, 0xffff0000, v129
v_mfma_f32_16x16x32_bf16 a[236:239], v[92:95], a[112:115], a[236:239]
ds_read_b64_tr_b16 v[84:85], v11 offset:37888
v_lshlrev_b32 v196, 16, v130
v_mfma_f32_16x16x32_bf16 a[252:255], v[92:95], a[116:119], a[252:255]
ds_read_b64_tr_b16 v[86:87], v11 offset:54272
v_and_b32 v197, 0xffff0000, v130
v_mfma_f32_16x16x32_bf16 a[224:227], v[96:99], a[120:123], a[224:227]
buffer_load_dwordx4 a[176:179], v46, s[60:63], s19 offen offset:0 sc1
v_mfma_f32_16x16x32_bf16 a[240:243], v[96:99], a[124:127], a[240:243]
ds_read_b64_tr_b16 v[88:89], v12 offset:37888
s_waitcnt lgkmcnt(5)
v_mfma_f32_16x16x32_bf16 a[228:231], v[100:103], a[120:123], a[228:231]
ds_read_b64_tr_b16 v[90:91], v12 offset:54272
ds_read_b64_tr_b16 v[92:93], v13 offset:37888
v_mfma_f32_16x16x32_bf16 a[244:247], v[100:103], a[124:127], a[244:247]
ds_read_b64_tr_b16 v[94:95], v13 offset:54272
v_lshlrev_b32 v198, 16, v131
v_mfma_f32_16x16x32_bf16 a[232:235], v[104:107], a[120:123], a[232:235]
buffer_load_dwordx4 v39, s[48:51], s77 offen offset:1024 lds
v_mfma_f32_16x16x32_bf16 a[248:251], v[104:107], a[124:127], a[248:251]
ds_read_b64_tr_b16 v[96:97], v10 offset:38912
ds_read_b64_tr_b16 v[98:99], v10 offset:55296
v_mfma_f32_16x16x32_bf16 a[236:239], v[108:111], a[120:123], a[236:239]
ds_read_b64_tr_b16 v[100:101], v11 offset:38912
v_and_b32 v199, 0xffff0000, v131
v_mfma_f32_16x16x32_bf16 a[252:255], v[108:111], a[124:127], a[252:255]
ds_read_b64_tr_b16 v[102:103], v11 offset:55296
v_lshlrev_b32 v200, 16, v132
v_mfma_f32_16x16x32_bf16 v[160:163], v[112:115], a[128:131], v[160:163]
ds_read_b64_tr_b16 v[104:105], v12 offset:38912
v_and_b32 v201, 0xffff0000, v132
v_mfma_f32_16x16x32_bf16 v[176:179], v[112:115], a[132:135], v[176:179]
buffer_load_dwordx4 a[180:183], v46, s[60:63], s19 offen offset:1024 sc1
v_mfma_f32_16x16x32_bf16 v[164:167], v[116:119], a[128:131], v[164:167]
ds_read_b64_tr_b16 v[106:107], v12 offset:55296
ds_read_b64_tr_b16 v[108:109], v13 offset:38912
v_mfma_f32_16x16x32_bf16 v[180:183], v[116:119], a[132:135], v[180:183]
ds_read_b64_tr_b16 v[110:111], v13 offset:55296
v_lshlrev_b32 v202, 16, v133
v_mfma_f32_16x16x32_bf16 v[168:171], v[120:123], a[128:131], v[168:171]
ds_read_b64_tr_b16 v[112:113], v10 offset:39936
v_and_b32 v203, 0xffff0000, v133
v_mfma_f32_16x16x32_bf16 v[184:187], v[120:123], a[132:135], v[184:187]
buffer_load_dwordx4 v40, s[48:51], s77 offen offset:2048 lds
v_mfma_f32_16x16x32_bf16 v[172:175], v[124:127], a[128:131], v[172:175]
ds_read_b64_tr_b16 v[114:115], v10 offset:56320
ds_read_b64_tr_b16 v[116:117], v11 offset:39936
v_mfma_f32_16x16x32_bf16 v[188:191], v[124:127], a[132:135], v[188:191]
ds_read_b64_tr_b16 v[118:119], v11 offset:56320
s_waitcnt lgkmcnt(7)
v_mfma_f32_16x16x32_bf16 v[160:163], v[80:83], a[136:139], v[160:163]
ds_read_b64_tr_b16 v[120:121], v12 offset:39936
v_lshlrev_b32 v204, 16, v134
v_mfma_f32_16x16x32_bf16 v[176:179], v[80:83], a[140:143], v[176:179]
ds_read_b64_tr_b16 v[122:123], v12 offset:56320
v_and_b32 v205, 0xffff0000, v134
v_mfma_f32_16x16x32_bf16 v[164:167], v[84:87], a[136:139], v[164:167]
buffer_load_dwordx4 a[184:187], v46, s[60:63], s19 offen offset:2048 sc1
v_mfma_f32_16x16x32_bf16 v[180:183], v[84:87], a[140:143], v[180:183]
ds_read_b64_tr_b16 v[124:125], v13 offset:39936
ds_read_b64_tr_b16 v[126:127], v13 offset:56320
v_mfma_f32_16x16x32_bf16 v[168:171], v[88:91], a[136:139], v[168:171]
v_lshlrev_b32 v206, 16, v135
v_and_b32 v207, 0xffff0000, v135
v_mfma_f32_16x16x32_bf16 v[184:187], v[88:91], a[140:143], v[184:187]
v_lshlrev_b32 v208, 16, v136
v_and_b32 v209, 0xffff0000, v136
v_mfma_f32_16x16x32_bf16 v[172:175], v[92:95], a[136:139], v[172:175]
buffer_load_dwordx4 v41, s[48:51], s77 offen offset:3072 lds
v_mfma_f32_16x16x32_bf16 v[188:191], v[92:95], a[140:143], v[188:191]
v_lshlrev_b32 v210, 16, v137
v_and_b32 v211, 0xffff0000, v137
v_mfma_f32_16x16x32_bf16 v[160:163], v[96:99], a[144:147], v[160:163]
s_waitcnt lgkmcnt(0)
s_barrier
v_mfma_f32_16x16x32_bf16 v[176:179], v[96:99], a[148:151], v[176:179]
ds_read_b64_tr_b16 v[80:81], v14 offset:0
ds_read_b64_tr_b16 v[82:83], v14 offset:16384
v_mfma_f32_16x16x32_bf16 v[164:167], v[100:103], a[144:147], v[164:167]
ds_read_b64_tr_b16 v[84:85], v15 offset:0
s_add_u32 m0, s76, 32768
v_mfma_f32_16x16x32_bf16 v[180:183], v[100:103], a[148:151], v[180:183]
ds_read_b64_tr_b16 v[86:87], v15 offset:16384
s_add_u32 s77, s99, 0x600000
v_mfma_f32_16x16x32_bf16 v[168:171], v[104:107], a[144:147], v[168:171]
ds_read_b64_tr_b16 v[88:89], v16 offset:0
ds_read_b64_tr_b16 v[90:91], v16 offset:16384
v_mfma_f32_16x16x32_bf16 v[184:187], v[104:107], a[148:151], v[184:187]
buffer_load_dwordx4 v26, s[48:51], s77 offen offset:0 lds
v_mfma_f32_16x16x32_bf16 v[172:175], v[108:111], a[144:147], v[172:175]
ds_read_b64_tr_b16 v[92:93], v17 offset:0
ds_read_b64_tr_b16 v[94:95], v17 offset:16384
v_mfma_f32_16x16x32_bf16 v[188:191], v[108:111], a[148:151], v[188:191]
buffer_load_dwordx4 a[188:191], v46, s[60:63], s19 offen offset:3072 sc1
v_mfma_f32_16x16x32_bf16 v[160:163], v[112:115], a[152:155], v[160:163]
ds_read_b64_tr_b16 v[96:97], v14 offset:1024
ds_read_b64_tr_b16 v[98:99], v14 offset:17408
v_mfma_f32_16x16x32_bf16 v[176:179], v[112:115], a[156:159], v[176:179]
ds_read_b64_tr_b16 v[100:101], v15 offset:1024
s_add_u32 s19, s6, 139264
v_mfma_f32_16x16x32_bf16 v[164:167], v[116:119], a[152:155], v[164:167]
ds_read_b64_tr_b16 v[102:103], v15 offset:17408
ds_read_b64_tr_b16 v[104:105], v16 offset:1024
v_mfma_f32_16x16x32_bf16 v[180:183], v[116:119], a[156:159], v[180:183]
ds_read_b64_tr_b16 v[106:107], v16 offset:17408
v_lshlrev_b32 v212, 16, v138
v_mfma_f32_16x16x32_bf16 v[168:171], v[120:123], a[152:155], v[168:171]
buffer_load_dwordx4 v27, s[48:51], s77 offen offset:1024 lds
v_mfma_f32_16x16x32_bf16 v[184:187], v[120:123], a[156:159], v[184:187]
ds_read_b64_tr_b16 v[108:109], v17 offset:1024
ds_read_b64_tr_b16 v[110:111], v17 offset:17408
v_mfma_f32_16x16x32_bf16 v[172:175], v[124:127], a[152:155], v[172:175]
ds_read_b64_tr_b16 v[112:113], v14 offset:2048
v_and_b32 v213, 0xffff0000, v138
v_mfma_f32_16x16x32_bf16 v[188:191], v[124:127], a[156:159], v[188:191]
ds_read_b64_tr_b16 v[114:115], v14 offset:18432
s_waitcnt lgkmcnt(7)
v_mfma_f32_16x16x32_bf16 a[224:227], v[80:83], a[128:131], a[224:227]
buffer_load_dwordx4 a[192:195], v46, s[60:63], s19 offen offset:0 sc1
v_mfma_f32_16x16x32_bf16 a[240:243], v[80:83], a[132:135], a[240:243]
ds_read_b64_tr_b16 v[116:117], v15 offset:2048
ds_read_b64_tr_b16 v[118:119], v15 offset:18432
v_mfma_f32_16x16x32_bf16 a[228:231], v[84:87], a[128:131], a[228:231]
ds_read_b64_tr_b16 v[120:121], v16 offset:2048
v_lshlrev_b32 v214, 16, v139
v_mfma_f32_16x16x32_bf16 a[244:247], v[84:87], a[132:135], a[244:247]
ds_read_b64_tr_b16 v[122:123], v16 offset:18432
ds_read_b64_tr_b16 v[124:125], v17 offset:2048
v_mfma_f32_16x16x32_bf16 a[232:235], v[88:91], a[128:131], a[232:235]
ds_read_b64_tr_b16 v[126:127], v17 offset:18432
v_and_b32 v215, 0xffff0000, v139
v_mfma_f32_16x16x32_bf16 a[248:251], v[88:91], a[132:135], a[248:251]
buffer_load_dwordx4 v28, s[48:51], s77 offen offset:2048 lds
v_mfma_f32_16x16x32_bf16 a[236:239], v[92:95], a[128:131], a[236:239]
ds_read_b64_tr_b16 v[80:81], v14 offset:3072
ds_read_b64_tr_b16 v[82:83], v14 offset:19456
v_mfma_f32_16x16x32_bf16 a[252:255], v[92:95], a[132:135], a[252:255]
ds_read_b64_tr_b16 v[84:85], v15 offset:3072
v_lshlrev_b32 v216, 16, v140
v_mfma_f32_16x16x32_bf16 a[224:227], v[96:99], a[136:139], a[224:227]
ds_read_b64_tr_b16 v[86:87], v15 offset:19456
ds_read_b64_tr_b16 v[88:89], v16 offset:3072
v_mfma_f32_16x16x32_bf16 a[240:243], v[96:99], a[140:143], a[240:243]
ds_read_b64_tr_b16 v[90:91], v16 offset:19456
s_waitcnt lgkmcnt(7)
v_mfma_f32_16x16x32_bf16 a[228:231], v[100:103], a[136:139], a[228:231]
buffer_load_dwordx4 a[196:199], v46, s[60:63], s19 offen offset:1024 sc1
v_mfma_f32_16x16x32_bf16 a[244:247], v[100:103], a[140:143], a[244:247]
ds_read_b64_tr_b16 v[92:93], v17 offset:3072
ds_read_b64_tr_b16 v[94:95], v17 offset:19456
v_mfma_f32_16x16x32_bf16 a[232:235], v[104:107], a[136:139], a[232:235]
ds_read_b64_tr_b16 v[96:97], v14 offset:4096
v_and_b32 v217, 0xffff0000, v140
v_mfma_f32_16x16x32_bf16 a[248:251], v[104:107], a[140:143], a[248:251]
ds_read_b64_tr_b16 v[98:99], v14 offset:20480
v_lshlrev_b32 v218, 16, v141
v_mfma_f32_16x16x32_bf16 a[236:239], v[108:111], a[136:139], a[236:239]
buffer_load_dwordx4 v29, s[48:51], s77 offen offset:3072 lds
v_mfma_f32_16x16x32_bf16 a[252:255], v[108:111], a[140:143], a[252:255]
ds_read_b64_tr_b16 v[100:101], v15 offset:4096
ds_read_b64_tr_b16 v[102:103], v15 offset:20480
v_mfma_f32_16x16x32_bf16 a[224:227], v[112:115], a[144:147], a[224:227]
ds_read_b64_tr_b16 v[104:105], v16 offset:4096
v_and_b32 v219, 0xffff0000, v141
v_mfma_f32_16x16x32_bf16 a[240:243], v[112:115], a[148:151], a[240:243]
ds_read_b64_tr_b16 v[106:107], v16 offset:20480
s_add_u32 m0, s76, 36864
v_mfma_f32_16x16x32_bf16 a[228:231], v[116:119], a[144:147], a[228:231]
buffer_load_dwordx4 a[200:203], v46, s[60:63], s19 offen offset:2048 sc1
v_mfma_f32_16x16x32_bf16 a[244:247], v[116:119], a[148:151], a[244:247]
ds_read_b64_tr_b16 v[108:109], v17 offset:4096
ds_read_b64_tr_b16 v[110:111], v17 offset:20480
v_mfma_f32_16x16x32_bf16 a[232:235], v[120:123], a[144:147], a[232:235]
ds_read_b64_tr_b16 v[112:113], v14 offset:5120
s_add_u32 s77, s99, 0x400000
v_mfma_f32_16x16x32_bf16 a[248:251], v[120:123], a[148:151], a[248:251]
ds_read_b64_tr_b16 v[114:115], v14 offset:21504
s_waitcnt lgkmcnt(6)
v_mfma_f32_16x16x32_bf16 a[236:239], v[124:127], a[144:147], a[236:239]
ds_read_b64_tr_b16 v[116:117], v15 offset:5120
v_lshlrev_b32 v220, 16, v142
v_mfma_f32_16x16x32_bf16 a[252:255], v[124:127], a[148:151], a[252:255]
buffer_load_dwordx4 v38, s[48:51], s77 offen offset:0 lds
v_mfma_f32_16x16x32_bf16 a[224:227], v[80:83], a[152:155], a[224:227]
ds_read_b64_tr_b16 v[118:119], v15 offset:21504
ds_read_b64_tr_b16 v[120:121], v16 offset:5120
v_mfma_f32_16x16x32_bf16 a[240:243], v[80:83], a[156:159], a[240:243]
ds_read_b64_tr_b16 v[122:123], v16 offset:21504
v_and_b32 v221, 0xffff0000, v142
v_mfma_f32_16x16x32_bf16 a[228:231], v[84:87], a[152:155], a[228:231]
ds_read_b64_tr_b16 v[124:125], v17 offset:5120
v_lshlrev_b32 v222, 16, v143
v_mfma_f32_16x16x32_bf16 a[244:247], v[84:87], a[156:159], a[244:247]
buffer_load_dwordx4 a[204:207], v46, s[60:63], s19 offen offset:3072 sc1
v_mfma_f32_16x16x32_bf16 a[232:235], v[88:91], a[152:155], a[232:235]
ds_read_b64_tr_b16 v[126:127], v17 offset:21504
ds_read_b64_tr_b16 v[80:81], v14 offset:6144
v_mfma_f32_16x16x32_bf16 a[248:251], v[88:91], a[156:159], a[248:251]
ds_read_b64_tr_b16 v[82:83], v14 offset:22528
s_add_u32 s19, s6, 143360
v_mfma_f32_16x16x32_bf16 a[236:239], v[92:95], a[152:155], a[236:239]
ds_read_b64_tr_b16 v[84:85], v15 offset:6144
v_and_b32 v223, 0xffff0000, v143
v_mfma_f32_16x16x32_bf16 a[252:255], v[92:95], a[156:159], a[252:255]
ds_read_b64_tr_b16 v[86:87], v15 offset:22528
s_waitcnt vmcnt(11)
v_mfma_f32_16x16x32_bf16 v[160:163], v[96:99], a[160:163], v[160:163]
buffer_load_dwordx4 v39, s[48:51], s77 offen offset:1024 lds
v_mfma_f32_16x16x32_bf16 v[176:179], v[96:99], a[164:167], v[176:179]
ds_read_b64_tr_b16 v[88:89], v16 offset:6144
ds_read_b64_tr_b16 v[90:91], v16 offset:22528
v_mfma_f32_16x16x32_bf16 v[164:167], v[100:103], a[160:163], v[164:167]
ds_read_b64_tr_b16 v[92:93], v17 offset:6144
v_mfma_f32_16x16x32_bf16 v[180:183], v[100:103], a[164:167], v[180:183]
ds_read_b64_tr_b16 v[94:95], v17 offset:22528
s_waitcnt lgkmcnt(6)
v_mfma_f32_16x16x32_bf16 v[168:171], v[104:107], a[160:163], v[168:171]
buffer_load_dwordx4 a[208:211], v46, s[60:63], s19 offen offset:0 sc1
v_mfma_f32_16x16x32_bf16 v[184:187], v[104:107], a[164:167], v[184:187]
ds_read_b64_tr_b16 v[96:97], v14 offset:7168
ds_read_b64_tr_b16 v[98:99], v14 offset:23552
v_mfma_f32_16x16x32_bf16 v[172:175], v[108:111], a[160:163], v[172:175]
ds_read_b64_tr_b16 v[100:101], v15 offset:7168
v_mfma_f32_16x16x32_bf16 v[188:191], v[108:111], a[164:167], v[188:191]
ds_read_b64_tr_b16 v[102:103], v15 offset:23552
ds_read_b64_tr_b16 v[104:105], v16 offset:7168
v_mfma_f32_16x16x32_bf16 v[160:163], v[112:115], a[168:171], v[160:163]
ds_read_b64_tr_b16 v[106:107], v16 offset:23552
v_mfma_f32_16x16x32_bf16 v[176:179], v[112:115], a[172:175], v[176:179]
buffer_load_dwordx4 v40, s[48:51], s77 offen offset:2048 lds
v_mfma_f32_16x16x32_bf16 v[164:167], v[116:119], a[168:171], v[164:167]
ds_read_b64_tr_b16 v[108:109], v17 offset:7168
ds_read_b64_tr_b16 v[110:111], v17 offset:23552
v_mfma_f32_16x16x32_bf16 v[180:183], v[116:119], a[172:175], v[180:183]
v_mfma_f32_16x16x32_bf16 v[168:171], v[120:123], a[168:171], v[168:171]
v_mfma_f32_16x16x32_bf16 v[184:187], v[120:123], a[172:175], v[184:187]
buffer_load_dwordx4 a[212:215], v46, s[60:63], s19 offen offset:1024 sc1
v_mfma_f32_16x16x32_bf16 v[172:175], v[124:127], a[168:171], v[172:175]
v_mfma_f32_16x16x32_bf16 v[188:191], v[124:127], a[172:175], v[188:191]
s_waitcnt lgkmcnt(0)
s_barrier
v_mfma_f32_16x16x32_bf16 v[160:163], v[80:83], a[176:179], v[160:163]
ds_read_b64_tr_b16 v[112:113], v14 offset:32768
ds_read_b64_tr_b16 v[114:115], v14 offset:49152
v_mfma_f32_16x16x32_bf16 v[176:179], v[80:83], a[180:183], v[176:179]
ds_read_b64_tr_b16 v[116:117], v15 offset:32768
v_mfma_f32_16x16x32_bf16 v[164:167], v[84:87], a[176:179], v[164:167]
buffer_load_dwordx4 v41, s[48:51], s77 offen offset:3072 lds
v_mfma_f32_16x16x32_bf16 v[180:183], v[84:87], a[180:183], v[180:183]
ds_read_b64_tr_b16 v[118:119], v15 offset:49152
ds_read_b64_tr_b16 v[120:121], v16 offset:32768
v_mfma_f32_16x16x32_bf16 v[168:171], v[88:91], a[176:179], v[168:171]
ds_read_b64_tr_b16 v[122:123], v16 offset:49152
v_mfma_f32_16x16x32_bf16 v[184:187], v[88:91], a[180:183], v[184:187]
ds_read_b64_tr_b16 v[124:125], v17 offset:32768
s_add_u32 m0, s76, 65536
v_mfma_f32_16x16x32_bf16 v[172:175], v[92:95], a[176:179], v[172:175]
buffer_load_dwordx4 a[216:219], v46, s[60:63], s19 offen offset:2048 sc1
v_mfma_f32_16x16x32_bf16 v[188:191], v[92:95], a[180:183], v[188:191]
ds_read_b64_tr_b16 v[126:127], v17 offset:49152
ds_read_b64_tr_b16 v[80:81], v14 offset:33792
v_mfma_f32_16x16x32_bf16 v[160:163], v[96:99], a[184:187], v[160:163]
ds_read_b64_tr_b16 v[82:83], v14 offset:50176
s_waitcnt vmcnt(12)
v_mfma_f32_16x16x32_bf16 v[176:179], v[96:99], a[188:191], v[176:179]
ds_read_b64_tr_b16 v[84:85], v15 offset:33792
s_add_u32 s77, s99, 0x440000
v_mfma_f32_16x16x32_bf16 v[164:167], v[100:103], a[184:187], v[164:167]
ds_read_b64_tr_b16 v[86:87], v15 offset:50176
ds_read_b64_tr_b16 v[88:89], v16 offset:33792
v_mfma_f32_16x16x32_bf16 v[180:183], v[100:103], a[188:191], v[180:183]
buffer_load_dwordx4 v38, s[48:51], s77 offen offset:0 lds
v_mfma_f32_16x16x32_bf16 v[168:171], v[104:107], a[184:187], v[168:171]
ds_read_b64_tr_b16 v[90:91], v16 offset:50176
ds_read_b64_tr_b16 v[92:93], v17 offset:33792
v_mfma_f32_16x16x32_bf16 v[184:187], v[104:107], a[188:191], v[184:187]
ds_read_b64_tr_b16 v[94:95], v17 offset:50176
v_mfma_f32_16x16x32_bf16 v[172:175], v[108:111], a[184:187], v[172:175]
ds_read_b64_tr_b16 v[96:97], v14 offset:34816
ds_read_b64_tr_b16 v[98:99], v14 offset:51200
v_mfma_f32_16x16x32_bf16 v[188:191], v[108:111], a[188:191], v[188:191]
ds_read_b64_tr_b16 v[100:101], v15 offset:34816
s_waitcnt lgkmcnt(8)
v_mfma_f32_16x16x32_bf16 a[224:227], v[112:115], a[160:163], a[224:227]
buffer_load_dwordx4 a[220:223], v46, s[60:63], s19 offen offset:3072 sc1
v_mfma_f32_16x16x32_bf16 a[240:243], v[112:115], a[164:167], a[240:243]
ds_read_b64_tr_b16 v[102:103], v15 offset:51200
ds_read_b64_tr_b16 v[104:105], v16 offset:34816
v_mfma_f32_16x16x32_bf16 a[228:231], v[116:119], a[160:163], a[228:231]
ds_read_b64_tr_b16 v[106:107], v16 offset:51200
v_mfma_f32_16x16x32_bf16 a[244:247], v[116:119], a[164:167], a[244:247]
ds_read_b64_tr_b16 v[108:109], v17 offset:34816
ds_read_b64_tr_b16 v[110:111], v17 offset:51200
v_mfma_f32_16x16x32_bf16 a[232:235], v[120:123], a[160:163], a[232:235]
buffer_load_dwordx4 v39, s[48:51], s77 offen offset:1024 lds
v_mfma_f32_16x16x32_bf16 a[248:251], v[120:123], a[164:167], a[248:251]
ds_read_b64_tr_b16 v[112:113], v14 offset:35840
ds_read_b64_tr_b16 v[114:115], v14 offset:52224
v_mfma_f32_16x16x32_bf16 a[236:239], v[124:127], a[160:163], a[236:239]
ds_read_b64_tr_b16 v[116:117], v15 offset:35840
v_mfma_f32_16x16x32_bf16 a[252:255], v[124:127], a[164:167], a[252:255]
ds_read_b64_tr_b16 v[118:119], v15 offset:52224
ds_read_b64_tr_b16 v[120:121], v16 offset:35840
v_mfma_f32_16x16x32_bf16 a[224:227], v[80:83], a[168:171], a[224:227]
ds_read_b64_tr_b16 v[122:123], v16 offset:52224
v_mfma_f32_16x16x32_bf16 a[240:243], v[80:83], a[172:175], a[240:243]
ds_read_b64_tr_b16 v[124:125], v17 offset:35840
s_waitcnt lgkmcnt(7)
v_mfma_f32_16x16x32_bf16 a[228:231], v[84:87], a[168:171], a[228:231]
buffer_load_dwordx4 v40, s[48:51], s77 offen offset:2048 lds
v_mfma_f32_16x16x32_bf16 a[244:247], v[84:87], a[172:175], a[244:247]
ds_read_b64_tr_b16 v[126:127], v17 offset:52224
ds_read_b64_tr_b16 v[80:81], v14 offset:36864
v_mfma_f32_16x16x32_bf16 a[232:235], v[88:91], a[168:171], a[232:235]
ds_read_b64_tr_b16 v[82:83], v14 offset:53248
v_mfma_f32_16x16x32_bf16 a[248:251], v[88:91], a[172:175], a[248:251]
ds_read_b64_tr_b16 v[84:85], v15 offset:36864
ds_read_b64_tr_b16 v[86:87], v15 offset:53248
v_mfma_f32_16x16x32_bf16 a[236:239], v[92:95], a[168:171], a[236:239]
ds_read_b64_tr_b16 v[88:89], v16 offset:36864
v_mfma_f32_16x16x32_bf16 a[252:255], v[92:95], a[172:175], a[252:255]
ds_read_b64_tr_b16 v[90:91], v16 offset:53248
v_mfma_f32_16x16x32_bf16 a[224:227], v[96:99], a[176:179], a[224:227]
buffer_load_dwordx4 v41, s[48:51], s77 offen offset:3072 lds
v_mfma_f32_16x16x32_bf16 a[240:243], v[96:99], a[180:183], a[240:243]
ds_read_b64_tr_b16 v[92:93], v17 offset:36864
ds_read_b64_tr_b16 v[94:95], v17 offset:53248
v_mfma_f32_16x16x32_bf16 a[228:231], v[100:103], a[176:179], a[228:231]
ds_read_b64_tr_b16 v[96:97], v14 offset:37888
v_mfma_f32_16x16x32_bf16 a[244:247], v[100:103], a[180:183], a[244:247]
ds_read_b64_tr_b16 v[98:99], v14 offset:54272
s_add_u32 m0, s76, 69632
v_mfma_f32_16x16x32_bf16 a[232:235], v[104:107], a[176:179], a[232:235]
ds_read_b64_tr_b16 v[100:101], v15 offset:37888
s_add_u32 s77, s100, 0x0
v_mfma_f32_16x16x32_bf16 a[248:251], v[104:107], a[180:183], a[248:251]
ds_read_b64_tr_b16 v[102:103], v15 offset:54272
v_mfma_f32_16x16x32_bf16 a[236:239], v[108:111], a[176:179], a[236:239]
buffer_load_dwordx4 v38, s[48:51], s77 offen offset:0 lds
v_mfma_f32_16x16x32_bf16 a[252:255], v[108:111], a[180:183], a[252:255]
ds_read_b64_tr_b16 v[104:105], v16 offset:37888
s_waitcnt lgkmcnt(5)
v_mfma_f32_16x16x32_bf16 a[224:227], v[112:115], a[184:187], a[224:227]
ds_read_b64_tr_b16 v[106:107], v16 offset:54272
ds_read_b64_tr_b16 v[108:109], v17 offset:37888
v_mfma_f32_16x16x32_bf16 a[240:243], v[112:115], a[188:191], a[240:243]
ds_read_b64_tr_b16 v[110:111], v17 offset:54272
v_mfma_f32_16x16x32_bf16 a[228:231], v[116:119], a[184:187], a[228:231]
ds_read_b64_tr_b16 v[112:113], v14 offset:38912
v_mfma_f32_16x16x32_bf16 a[244:247], v[116:119], a[188:191], a[244:247]
ds_read_b64_tr_b16 v[114:115], v14 offset:55296
v_mfma_f32_16x16x32_bf16 a[232:235], v[120:123], a[184:187], a[232:235]
buffer_load_dwordx4 v39, s[48:51], s77 offen offset:1024 lds
v_mfma_f32_16x16x32_bf16 a[248:251], v[120:123], a[188:191], a[248:251]
ds_read_b64_tr_b16 v[116:117], v15 offset:38912
ds_read_b64_tr_b16 v[118:119], v15 offset:55296
v_mfma_f32_16x16x32_bf16 a[236:239], v[124:127], a[184:187], a[236:239]
ds_read_b64_tr_b16 v[120:121], v16 offset:38912
v_mfma_f32_16x16x32_bf16 a[252:255], v[124:127], a[188:191], a[252:255]
ds_read_b64_tr_b16 v[122:123], v16 offset:55296
v_mfma_f32_16x16x32_bf16 v[160:163], v[80:83], a[192:195], v[160:163]
ds_read_b64_tr_b16 v[124:125], v17 offset:38912
s_waitcnt vmcnt(9)
v_mfma_f32_16x16x32_bf16 v[176:179], v[80:83], a[196:199], v[176:179]
ds_read_b64_tr_b16 v[126:127], v17 offset:55296
v_mfma_f32_16x16x32_bf16 v[164:167], v[84:87], a[192:195], v[164:167]
buffer_load_dwordx4 v40, s[48:51], s77 offen offset:2048 lds
v_mfma_f32_16x16x32_bf16 v[180:183], v[84:87], a[196:199], v[180:183]
ds_read_b64_tr_b16 v[80:81], v14 offset:39936
ds_read_b64_tr_b16 v[82:83], v14 offset:56320
v_mfma_f32_16x16x32_bf16 v[168:171], v[88:91], a[192:195], v[168:171]
ds_read_b64_tr_b16 v[84:85], v15 offset:39936
v_mfma_f32_16x16x32_bf16 v[184:187], v[88:91], a[196:199], v[184:187]
ds_read_b64_tr_b16 v[86:87], v15 offset:56320
v_mfma_f32_16x16x32_bf16 v[172:175], v[92:95], a[192:195], v[172:175]
ds_read_b64_tr_b16 v[88:89], v16 offset:39936
v_mfma_f32_16x16x32_bf16 v[188:191], v[92:95], a[196:199], v[188:191]
ds_read_b64_tr_b16 v[90:91], v16 offset:56320
s_waitcnt lgkmcnt(6)
v_mfma_f32_16x16x32_bf16 v[160:163], v[96:99], a[200:203], v[160:163]
buffer_load_dwordx4 v41, s[48:51], s77 offen offset:3072 lds
v_mfma_f32_16x16x32_bf16 v[176:179], v[96:99], a[204:207], v[176:179]
ds_read_b64_tr_b16 v[92:93], v17 offset:39936
ds_read_b64_tr_b16 v[94:95], v17 offset:56320
v_mfma_f32_16x16x32_bf16 v[164:167], v[100:103], a[200:203], v[164:167]
v_mfma_f32_16x16x32_bf16 v[180:183], v[100:103], a[204:207], v[180:183]
v_mfma_f32_16x16x32_bf16 v[168:171], v[104:107], a[200:203], v[168:171]
v_mfma_f32_16x16x32_bf16 v[184:187], v[104:107], a[204:207], v[184:187]
v_mfma_f32_16x16x32_bf16 v[172:175], v[108:111], a[200:203], v[172:175]
s_waitcnt lgkmcnt(0)
s_barrier
v_mfma_f32_16x16x32_bf16 v[188:191], v[108:111], a[204:207], v[188:191]
ds_read_b64_tr_b16 v[96:97], v10 offset:0
ds_read_b64_tr_b16 v[98:99], v10 offset:16384
v_mfma_f32_16x16x32_bf16 v[160:163], v[112:115], a[208:211], v[160:163]
ds_read_b64_tr_b16 v[100:101], v11 offset:0
s_add_u32 m0, s76, 98304
v_mfma_f32_16x16x32_bf16 v[176:179], v[112:115], a[212:215], v[176:179]
ds_read_b64_tr_b16 v[102:103], v11 offset:16384
s_add_u32 s77, s100, 0x40000
v_mfma_f32_16x16x32_bf16 v[164:167], v[116:119], a[208:211], v[164:167]
buffer_load_dwordx4 v38, s[48:51], s77 offen offset:0 lds
v_mfma_f32_16x16x32_bf16 v[180:183], v[116:119], a[212:215], v[180:183]
ds_read_b64_tr_b16 v[104:105], v12 offset:0
ds_read_b64_tr_b16 v[106:107], v12 offset:16384
v_mfma_f32_16x16x32_bf16 v[168:171], v[120:123], a[208:211], v[168:171]
ds_read_b64_tr_b16 v[108:109], v13 offset:0
v_mfma_f32_16x16x32_bf16 v[184:187], v[120:123], a[212:215], v[184:187]
ds_read_b64_tr_b16 v[110:111], v13 offset:16384
ds_read_b64_tr_b16 v[112:113], v10 offset:1024
v_mfma_f32_16x16x32_bf16 v[172:175], v[124:127], a[208:211], v[172:175]
ds_read_b64_tr_b16 v[114:115], v10 offset:17408
v_mfma_f32_16x16x32_bf16 v[188:191], v[124:127], a[212:215], v[188:191]
ds_read_b64_tr_b16 v[116:117], v11 offset:1024
s_waitcnt vmcnt(8)
v_mfma_f32_16x16x32_bf16 v[160:163], v[80:83], a[216:219], v[160:163]
buffer_load_dwordx4 v39, s[48:51], s77 offen offset:1024 lds
v_mfma_f32_16x16x32_bf16 v[176:179], v[80:83], a[220:223], v[176:179]
ds_read_b64_tr_b16 v[118:119], v11 offset:17408
ds_read_b64_tr_b16 v[120:121], v12 offset:1024
v_mfma_f32_16x16x32_bf16 v[164:167], v[84:87], a[216:219], v[164:167]
ds_read_b64_tr_b16 v[122:123], v12 offset:17408
v_mfma_f32_16x16x32_bf16 v[180:183], v[84:87], a[220:223], v[180:183]
ds_read_b64_tr_b16 v[124:125], v13 offset:1024
ds_read_b64_tr_b16 v[126:127], v13 offset:17408
v_mfma_f32_16x16x32_bf16 v[168:171], v[88:91], a[216:219], v[168:171]
ds_read_b64_tr_b16 v[80:81], v10 offset:2048
v_mfma_f32_16x16x32_bf16 v[184:187], v[88:91], a[220:223], v[184:187]
ds_read_b64_tr_b16 v[82:83], v10 offset:18432
ds_read_b64_tr_b16 v[84:85], v11 offset:2048
v_mfma_f32_16x16x32_bf16 v[172:175], v[92:95], a[216:219], v[172:175]
buffer_load_dwordx4 v40, s[48:51], s77 offen offset:2048 lds
v_mfma_f32_16x16x32_bf16 v[188:191], v[92:95], a[220:223], v[188:191]
ds_read_b64_tr_b16 v[86:87], v11 offset:18432
s_waitcnt lgkmcnt(7)
v_mfma_f32_16x16x32_bf16 a[224:227], v[96:99], a[192:195], a[224:227]
ds_read_b64_tr_b16 v[88:89], v12 offset:2048
ds_read_b64_tr_b16 v[90:91], v12 offset:18432
v_mfma_f32_16x16x32_bf16 a[240:243], v[96:99], a[196:199], a[240:243]
ds_read_b64_tr_b16 v[92:93], v13 offset:2048
v_mfma_f32_16x16x32_bf16 a[228:231], v[100:103], a[192:195], a[228:231]
ds_read_b64_tr_b16 v[94:95], v13 offset:18432
ds_read_b64_tr_b16 v[96:97], v10 offset:3072
v_mfma_f32_16x16x32_bf16 a[244:247], v[100:103], a[196:199], a[244:247]
ds_read_b64_tr_b16 v[98:99], v10 offset:19456
v_cvt_pk_bf16_f32 v160, v160, v161
v_mfma_f32_16x16x32_bf16 a[232:235], v[104:107], a[192:195], a[232:235]
buffer_load_dwordx4 v41, s[48:51], s77 offen offset:3072 lds
v_mfma_f32_16x16x32_bf16 a[248:251], v[104:107], a[196:199], a[248:251]
ds_read_b64_tr_b16 v[100:101], v11 offset:3072
v_cvt_pk_bf16_f32 v161, v162, v163
v_mfma_f32_16x16x32_bf16 a[236:239], v[108:111], a[192:195], a[236:239]
ds_read_b64_tr_b16 v[102:103], v11 offset:19456
v_cvt_pk_bf16_f32 v162, v164, v165
v_mfma_f32_16x16x32_bf16 a[252:255], v[108:111], a[196:199], a[252:255]
ds_read_b64_tr_b16 v[104:105], v12 offset:3072
s_add_u32 m0, s76, 102400
v_mfma_f32_16x16x32_bf16 a[224:227], v[112:115], a[200:203], a[224:227]
ds_read_b64_tr_b16 v[106:107], v12 offset:19456
s_add_u32 s77, s100, 0x200000
v_mfma_f32_16x16x32_bf16 a[240:243], v[112:115], a[204:207], a[240:243]
ds_read_b64_tr_b16 v[108:109], v13 offset:3072
v_cvt_pk_bf16_f32 v163, v166, v167
v_mfma_f32_16x16x32_bf16 a[228:231], v[116:119], a[200:203], a[228:231]
buffer_load_dwordx4 v38, s[48:51], s77 offen offset:0 lds
v_mfma_f32_16x16x32_bf16 a[244:247], v[116:119], a[204:207], a[244:247]
ds_read_b64_tr_b16 v[110:111], v13 offset:19456
s_waitcnt lgkmcnt(5)
v_mfma_f32_16x16x32_bf16 a[232:235], v[120:123], a[200:203], a[232:235]
buffer_store_dwordx4 v[160:163], v46, s[60:63], s8 offen offset:0 sc1
v_mfma_f32_16x16x32_bf16 a[248:251], v[120:123], a[204:207], a[248:251]
ds_read_b64_tr_b16 v[112:113], v10 offset:4096
ds_read_b64_tr_b16 v[114:115], v10 offset:20480
v_mfma_f32_16x16x32_bf16 a[236:239], v[124:127], a[200:203], a[236:239]
ds_read_b64_tr_b16 v[116:117], v11 offset:4096
v_cvt_pk_bf16_f32 v168, v168, v169
v_mfma_f32_16x16x32_bf16 a[252:255], v[124:127], a[204:207], a[252:255]
ds_read_b64_tr_b16 v[118:119], v11 offset:20480
v_cvt_pk_bf16_f32 v169, v170, v171
v_mfma_f32_16x16x32_bf16 a[224:227], v[80:83], a[208:211], a[224:227]
buffer_load_dwordx4 v39, s[48:51], s77 offen offset:1024 lds
v_mfma_f32_16x16x32_bf16 a[240:243], v[80:83], a[212:215], a[240:243]
ds_read_b64_tr_b16 v[120:121], v12 offset:4096
ds_read_b64_tr_b16 v[122:123], v12 offset:20480
v_mfma_f32_16x16x32_bf16 a[228:231], v[84:87], a[208:211], a[228:231]
ds_read_b64_tr_b16 v[124:125], v13 offset:4096
v_cvt_pk_bf16_f32 v170, v172, v173
v_mfma_f32_16x16x32_bf16 a[244:247], v[84:87], a[212:215], a[244:247]
ds_read_b64_tr_b16 v[126:127], v13 offset:20480
v_cvt_pk_bf16_f32 v171, v174, v175
v_mfma_f32_16x16x32_bf16 a[232:235], v[88:91], a[208:211], a[232:235]
buffer_store_dwordx4 v[168:171], v46, s[60:63], s8 offen offset:1024 sc1
v_mfma_f32_16x16x32_bf16 a[248:251], v[88:91], a[212:215], a[248:251]
ds_read_b64_tr_b16 v[80:81], v10 offset:5120
ds_read_b64_tr_b16 v[82:83], v10 offset:21504
v_mfma_f32_16x16x32_bf16 a[236:239], v[92:95], a[208:211], a[236:239]
buffer_load_dwordx4 v40, s[48:51], s77 offen offset:2048 lds
v_mfma_f32_16x16x32_bf16 a[252:255], v[92:95], a[212:215], a[252:255]
ds_read_b64_tr_b16 v[84:85], v11 offset:5120
ds_read_b64_tr_b16 v[86:87], v11 offset:21504
v_mfma_f32_16x16x32_bf16 a[224:227], v[96:99], a[216:219], a[224:227]
ds_read_b64_tr_b16 v[88:89], v12 offset:5120
v_cvt_pk_bf16_f32 v176, v176, v177
v_mfma_f32_16x16x32_bf16 a[240:243], v[96:99], a[220:223], a[240:243]
ds_read_b64_tr_b16 v[90:91], v12 offset:21504
s_waitcnt lgkmcnt(6)
v_mfma_f32_16x16x32_bf16 a[228:231], v[100:103], a[216:219], a[228:231]
ds_read_b64_tr_b16 v[92:93], v13 offset:5120
v_cvt_pk_bf16_f32 v177, v178, v179
v_mfma_f32_16x16x32_bf16 a[244:247], v[100:103], a[220:223], a[244:247]
ds_read_b64_tr_b16 v[94:95], v13 offset:21504
v_cvt_pk_bf16_f32 v178, v180, v181
v_mfma_f32_16x16x32_bf16 a[232:235], v[104:107], a[216:219], a[232:235]
buffer_load_dwordx4 v41, s[48:51], s77 offen offset:3072 lds
v_mfma_f32_16x16x32_bf16 a[248:251], v[104:107], a[220:223], a[248:251]
ds_read_b64_tr_b16 v[96:97], v10 offset:6144
ds_read_b64_tr_b16 v[98:99], v10 offset:22528
v_mfma_f32_16x16x32_bf16 a[236:239], v[108:111], a[216:219], a[236:239]
ds_read_b64_tr_b16 v[100:101], v11 offset:6144
v_cvt_pk_bf16_f32 v179, v182, v183
v_mfma_f32_16x16x32_bf16 a[252:255], v[108:111], a[220:223], a[252:255]
buffer_store_dwordx4 v[176:179], v46, s[60:63], s8 offen offset:2048 sc1
v_mfma_f32_16x16x32_bf16 v[224:227], v[112:115], a[96:99], v[224:227]
ds_read_b64_tr_b16 v[102:103], v11 offset:22528
ds_read_b64_tr_b16 v[104:105], v12 offset:6144
v_mfma_f32_16x16x32_bf16 v[240:243], v[112:115], a[100:103], v[240:243]
ds_read_b64_tr_b16 v[106:107], v12 offset:22528
v_cvt_pk_bf16_f32 v184, v184, v185
v_mfma_f32_16x16x32_bf16 v[228:231], v[116:119], a[96:99], v[228:231]
ds_read_b64_tr_b16 v[108:109], v13 offset:6144
v_cvt_pk_bf16_f32 v185, v186, v187
v_mfma_f32_16x16x32_bf16 v[244:247], v[116:119], a[100:103], v[244:247]
ds_read_b64_tr_b16 v[110:111], v13 offset:22528
v_cvt_pk_bf16_f32 v186, v188, v189
v_mfma_f32_16x16x32_bf16 v[232:235], v[120:123], a[96:99], v[232:235]
ds_read_b64_tr_b16 v[112:113], v10 offset:7168
v_cvt_pk_bf16_f32 v187, v190, v191
v_mfma_f32_16x16x32_bf16 v[248:251], v[120:123], a[100:103], v[248:251]
buffer_store_dwordx4 v[184:187], v46, s[60:63], s8 offen offset:3072 sc1
v_mfma_f32_16x16x32_bf16 v[236:239], v[124:127], a[96:99], v[236:239]
ds_read_b64_tr_b16 v[114:115], v10 offset:23552
ds_read_b64_tr_b16 v[116:117], v11 offset:7168
v_mfma_f32_16x16x32_bf16 v[252:255], v[124:127], a[100:103], v[252:255]
ds_read_b64_tr_b16 v[118:119], v11 offset:23552
s_waitcnt lgkmcnt(6)
v_mfma_f32_16x16x32_bf16 v[224:227], v[80:83], a[104:107], v[224:227]
ds_read_b64_tr_b16 v[120:121], v12 offset:7168
v_accvgpr_read_b32 v160, a224
v_mfma_f32_16x16x32_bf16 v[240:243], v[80:83], a[108:111], v[240:243]
ds_read_b64_tr_b16 v[122:123], v12 offset:23552
v_accvgpr_read_b32 v161, a225
v_mfma_f32_16x16x32_bf16 v[228:231], v[84:87], a[104:107], v[228:231]
ds_read_b64_tr_b16 v[124:125], v13 offset:7168
v_accvgpr_read_b32 v162, a226
v_mfma_f32_16x16x32_bf16 v[244:247], v[84:87], a[108:111], v[244:247]
ds_read_b64_tr_b16 v[126:127], v13 offset:23552
v_accvgpr_read_b32 v163, a227
v_mfma_f32_16x16x32_bf16 v[232:235], v[88:91], a[104:107], v[232:235]
v_accvgpr_read_b32 v164, a228
v_accvgpr_read_b32 v165, a229
v_mfma_f32_16x16x32_bf16 v[248:251], v[88:91], a[108:111], v[248:251]
v_accvgpr_read_b32 v166, a230
v_accvgpr_read_b32 v167, a231
v_mfma_f32_16x16x32_bf16 v[236:239], v[92:95], a[104:107], v[236:239]
v_cvt_pk_bf16_f32 v160, v160, v161
v_cvt_pk_bf16_f32 v161, v162, v163
v_mfma_f32_16x16x32_bf16 v[252:255], v[92:95], a[108:111], v[252:255]
v_cvt_pk_bf16_f32 v162, v164, v165
v_cvt_pk_bf16_f32 v163, v166, v167
v_mfma_f32_16x16x32_bf16 v[224:227], v[96:99], a[112:115], v[224:227]
s_waitcnt lgkmcnt(0)
s_barrier
v_mfma_f32_16x16x32_bf16 v[240:243], v[96:99], a[116:119], v[240:243]
ds_read_b64_tr_b16 v[80:81], v10 offset:32768
ds_read_b64_tr_b16 v[82:83], v10 offset:49152
v_mfma_f32_16x16x32_bf16 v[228:231], v[100:103], a[112:115], v[228:231]
ds_read_b64_tr_b16 v[84:85], v11 offset:32768
s_add_u32 m0, s76, 0
v_mfma_f32_16x16x32_bf16 v[244:247], v[100:103], a[116:119], v[244:247]
ds_read_b64_tr_b16 v[86:87], v11 offset:49152
s_add_u32 s77, s100, 0x240000
v_mfma_f32_16x16x32_bf16 v[232:235], v[104:107], a[112:115], v[232:235]
ds_read_b64_tr_b16 v[88:89], v12 offset:32768
ds_read_b64_tr_b16 v[90:91], v12 offset:49152
v_mfma_f32_16x16x32_bf16 v[248:251], v[104:107], a[116:119], v[248:251]
buffer_load_dwordx4 v38, s[48:51], s77 offen offset:0 lds
v_mfma_f32_16x16x32_bf16 v[236:239], v[108:111], a[112:115], v[236:239]
ds_read_b64_tr_b16 v[92:93], v13 offset:32768
ds_read_b64_tr_b16 v[94:95], v13 offset:49152
v_mfma_f32_16x16x32_bf16 v[252:255], v[108:111], a[116:119], v[252:255]
buffer_store_dwordx4 v[160:163], v46, s[60:63], s9 offen offset:0 sc1
v_mfma_f32_16x16x32_bf16 v[224:227], v[112:115], a[120:123], v[224:227]
ds_read_b64_tr_b16 v[96:97], v10 offset:33792
ds_read_b64_tr_b16 v[98:99], v10 offset:50176
v_mfma_f32_16x16x32_bf16 v[240:243], v[112:115], a[124:127], v[240:243]
ds_read_b64_tr_b16 v[100:101], v11 offset:33792
v_accvgpr_read_b32 v168, a232
v_mfma_f32_16x16x32_bf16 v[228:231], v[116:119], a[120:123], v[228:231]
ds_read_b64_tr_b16 v[102:103], v11 offset:50176
ds_read_b64_tr_b16 v[104:105], v12 offset:33792
v_mfma_f32_16x16x32_bf16 v[244:247], v[116:119], a[124:127], v[244:247]
buffer_load_dwordx4 v39, s[48:51], s77 offen offset:1024 lds
v_mfma_f32_16x16x32_bf16 v[232:235], v[120:123], a[120:123], v[232:235]
ds_read_b64_tr_b16 v[106:107], v12 offset:50176
ds_read_b64_tr_b16 v[108:109], v13 offset:33792
v_mfma_f32_16x16x32_bf16 v[248:251], v[120:123], a[124:127], v[248:251]
ds_read_b64_tr_b16 v[110:111], v13 offset:50176
v_accvgpr_read_b32 v169, a233
v_mfma_f32_16x16x32_bf16 v[236:239], v[124:127], a[120:123], v[236:239]
ds_read_b64_tr_b16 v[112:113], v10 offset:34816
ds_read_b64_tr_b16 v[114:115], v10 offset:51200
v_mfma_f32_16x16x32_bf16 v[252:255], v[124:127], a[124:127], v[252:255]
ds_read_b64_tr_b16 v[116:117], v11 offset:34816
s_waitcnt lgkmcnt(8)
v_mfma_f32_16x16x32_bf16 v[224:227], v[80:83], a[128:131], v[224:227]
ds_read_b64_tr_b16 v[118:119], v11 offset:51200
ds_read_b64_tr_b16 v[120:121], v12 offset:34816
v_mfma_f32_16x16x32_bf16 v[240:243], v[80:83], a[132:135], v[240:243]
buffer_load_dwordx4 v40, s[48:51], s77 offen offset:2048 lds
v_mfma_f32_16x16x32_bf16 v[228:231], v[84:87], a[128:131], v[228:231]
ds_read_b64_tr_b16 v[122:123], v12 offset:51200
ds_read_b64_tr_b16 v[124:125], v13 offset:34816
v_mfma_f32_16x16x32_bf16 v[244:247], v[84:87], a[132:135], v[244:247]
ds_read_b64_tr_b16 v[126:127], v13 offset:51200
v_accvgpr_read_b32 v170, a234
v_mfma_f32_16x16x32_bf16 v[232:235], v[88:91], a[128:131], v[232:235]
ds_read_b64_tr_b16 v[80:81], v10 offset:35840
v_accvgpr_read_b32 v171, a235
v_mfma_f32_16x16x32_bf16 v[248:251], v[88:91], a[132:135], v[248:251]
ds_read_b64_tr_b16 v[82:83], v10 offset:52224
v_accvgpr_read_b32 v172, a236
v_mfma_f32_16x16x32_bf16 v[236:239], v[92:95], a[128:131], v[236:239]
ds_read_b64_tr_b16 v[84:85], v11 offset:35840
v_accvgpr_read_b32 v173, a237
v_mfma_f32_16x16x32_bf16 v[252:255], v[92:95], a[132:135], v[252:255]
buffer_load_dwordx4 v41, s[48:51], s77 offen offset:3072 lds
v_mfma_f32_16x16x32_bf16 v[224:227], v[96:99], a[136:139], v[224:227]
ds_read_b64_tr_b16 v[86:87], v11 offset:52224
ds_read_b64_tr_b16 v[88:89], v12 offset:35840
v_mfma_f32_16x16x32_bf16 v[240:243], v[96:99], a[140:143], v[240:243]
ds_read_b64_tr_b16 v[90:91], v12 offset:52224
s_waitcnt lgkmcnt(6)
v_mfma_f32_16x16x32_bf16 v[228:231], v[100:103], a[136:139], v[228:231]
ds_read_b64_tr_b16 v[92:93], v13 offset:35840
s_add_u32 m0, s76, 4096
v_mfma_f32_16x16x32_bf16 v[244:247], v[100:103], a[140:143], v[244:247]
ds_read_b64_tr_b16 v[94:95], v13 offset:52224
s_add_u32 s77, s100, 0x600000
v_mfma_f32_16x16x32_bf16 v[232:235], v[104:107], a[136:139], v[232:235]
ds_read_b64_tr_b16 v[96:97], v10 offset:36864
v_accvgpr_read_b32 v174, a238
v_mfma_f32_16x16x32_bf16 v[248:251], v[104:107], a[140:143], v[248:251]
buffer_load_dwordx4 v26, s[48:51], s77 offen offset:0 lds
v_mfma_f32_16x16x32_bf16 v[236:239], v[108:111], a[136:139], v[236:239]
ds_read_b64_tr_b16 v[98:99], v10 offset:53248
ds_read_b64_tr_b16 v[100:101], v11 offset:36864
v_mfma_f32_16x16x32_bf16 v[252:255], v[108:111], a[140:143], v[252:255]
ds_read_b64_tr_b16 v[102:103], v11 offset:53248
v_accvgpr_read_b32 v175, a239
v_mfma_f32_16x16x32_bf16 v[224:227], v[112:115], a[144:147], v[224:227]
ds_read_b64_tr_b16 v[104:105], v12 offset:36864
v_cvt_pk_bf16_f32 v168, v168, v169
v_mfma_f32_16x16x32_bf16 v[240:243], v[112:115], a[148:151], v[240:243]
ds_read_b64_tr_b16 v[106:107], v12 offset:53248
v_cvt_pk_bf16_f32 v169, v170, v171
v_mfma_f32_16x16x32_bf16 v[228:231], v[116:119], a[144:147], v[228:231]
ds_read_b64_tr_b16 v[108:109], v13 offset:36864
v_cvt_pk_bf16_f32 v170, v172, v173
v_mfma_f32_16x16x32_bf16 v[244:247], v[116:119], a[148:151], v[244:247]
buffer_load_dwordx4 v27, s[48:51], s77 offen offset:1024 lds
v_mfma_f32_16x16x32_bf16 v[232:235], v[120:123], a[144:147], v[232:235]
ds_read_b64_tr_b16 v[110:111], v13 offset:53248
ds_read_b64_tr_b16 v[112:113], v10 offset:37888
v_mfma_f32_16x16x32_bf16 v[248:251], v[120:123], a[148:151], v[248:251]
ds_read_b64_tr_b16 v[114:115], v10 offset:54272
v_cvt_pk_bf16_f32 v171, v174, v175
v_mfma_f32_16x16x32_bf16 v[236:239], v[124:127], a[144:147], v[236:239]
buffer_store_dwordx4 v[168:171], v46, s[60:63], s9 offen offset:1024 sc1
v_mfma_f32_16x16x32_bf16 v[252:255], v[124:127], a[148:151], v[252:255]
ds_read_b64_tr_b16 v[116:117], v11 offset:37888
s_waitcnt lgkmcnt(5)
v_mfma_f32_16x16x32_bf16 v[224:227], v[80:83], a[152:155], v[224:227]
ds_read_b64_tr_b16 v[118:119], v11 offset:54272
ds_read_b64_tr_b16 v[120:121], v12 offset:37888
v_mfma_f32_16x16x32_bf16 v[240:243], v[80:83], a[156:159], v[240:243]
buffer_load_dwordx4 v28, s[48:51], s77 offen offset:2048 lds
v_mfma_f32_16x16x32_bf16 v[228:231], v[84:87], a[152:155], v[228:231]
ds_read_b64_tr_b16 v[122:123], v12 offset:54272
ds_read_b64_tr_b16 v[124:125], v13 offset:37888
v_mfma_f32_16x16x32_bf16 v[244:247], v[84:87], a[156:159], v[244:247]
ds_read_b64_tr_b16 v[126:127], v13 offset:54272
v_accvgpr_read_b32 v176, a240
v_mfma_f32_16x16x32_bf16 v[232:235], v[88:91], a[152:155], v[232:235]
ds_read_b64_tr_b16 v[80:81], v10 offset:38912
v_accvgpr_read_b32 v177, a241
v_mfma_f32_16x16x32_bf16 v[248:251], v[88:91], a[156:159], v[248:251]
ds_read_b64_tr_b16 v[82:83], v10 offset:55296
v_accvgpr_read_b32 v178, a242
v_mfma_f32_16x16x32_bf16 v[236:239], v[92:95], a[152:155], v[236:239]
ds_read_b64_tr_b16 v[84:85], v11 offset:38912
v_accvgpr_read_b32 v179, a243
v_mfma_f32_16x16x32_bf16 v[252:255], v[92:95], a[156:159], v[252:255]
buffer_load_dwordx4 v29, s[48:51], s77 offen offset:3072 lds
v_mfma_f32_16x16x32_bf16 v[224:227], v[96:99], a[160:163], v[224:227]
ds_read_b64_tr_b16 v[86:87], v11 offset:55296
ds_read_b64_tr_b16 v[88:89], v12 offset:38912
v_mfma_f32_16x16x32_bf16 v[240:243], v[96:99], a[164:167], v[240:243]
ds_read_b64_tr_b16 v[90:91], v12 offset:55296
v_accvgpr_read_b32 v180, a244
v_mfma_f32_16x16x32_bf16 v[228:231], v[100:103], a[160:163], v[228:231]
ds_read_b64_tr_b16 v[92:93], v13 offset:38912
v_accvgpr_read_b32 v181, a245
v_mfma_f32_16x16x32_bf16 v[244:247], v[100:103], a[164:167], v[244:247]
ds_read_b64_tr_b16 v[94:95], v13 offset:55296
v_accvgpr_read_b32 v182, a246
v_mfma_f32_16x16x32_bf16 v[232:235], v[104:107], a[160:163], v[232:235]
ds_read_b64_tr_b16 v[96:97], v10 offset:39936
v_accvgpr_read_b32 v183, a247
v_mfma_f32_16x16x32_bf16 v[248:251], v[104:107], a[164:167], v[248:251]
ds_read_b64_tr_b16 v[98:99], v10 offset:56320
s_waitcnt lgkmcnt(7)
v_mfma_f32_16x16x32_bf16 v[236:239], v[108:111], a[160:163], v[236:239]
ds_read_b64_tr_b16 v[100:101], v11 offset:39936
v_cvt_pk_bf16_f32 v176, v176, v177
v_mfma_f32_16x16x32_bf16 v[252:255], v[108:111], a[164:167], v[252:255]
ds_read_b64_tr_b16 v[102:103], v11 offset:56320
v_cvt_pk_bf16_f32 v177, v178, v179
v_mfma_f32_16x16x32_bf16 v[224:227], v[112:115], a[168:171], v[224:227]
ds_read_b64_tr_b16 v[104:105], v12 offset:39936
v_cvt_pk_bf16_f32 v178, v180, v181
v_mfma_f32_16x16x32_bf16 v[240:243], v[112:115], a[172:175], v[240:243]
ds_read_b64_tr_b16 v[106:107], v12 offset:56320
v_cvt_pk_bf16_f32 v179, v182, v183
v_mfma_f32_16x16x32_bf16 v[228:231], v[116:119], a[168:171], v[228:231]
buffer_store_dwordx4 v[176:179], v46, s[60:63], s9 offen offset:2048 sc1
v_mfma_f32_16x16x32_bf16 v[244:247], v[116:119], a[172:175], v[244:247]
ds_read_b64_tr_b16 v[108:109], v13 offset:39936
ds_read_b64_tr_b16 v[110:111], v13 offset:56320
v_mfma_f32_16x16x32_bf16 v[232:235], v[120:123], a[168:171], v[232:235]
v_accvgpr_read_b32 v184, a248
v_accvgpr_read_b32 v185, a249
v_mfma_f32_16x16x32_bf16 v[248:251], v[120:123], a[172:175], v[248:251]
v_accvgpr_read_b32 v186, a250
v_accvgpr_read_b32 v187, a251
v_mfma_f32_16x16x32_bf16 v[236:239], v[124:127], a[168:171], v[236:239]
v_accvgpr_read_b32 v188, a252
v_accvgpr_read_b32 v189, a253
v_mfma_f32_16x16x32_bf16 v[252:255], v[124:127], a[172:175], v[252:255]
v_accvgpr_read_b32 v190, a254
v_accvgpr_read_b32 v191, a255
v_mfma_f32_16x16x32_bf16 v[224:227], v[80:83], a[176:179], v[224:227]
s_waitcnt vmcnt(23) lgkmcnt(0)
s_barrier
v_mfma_f32_16x16x32_bf16 v[240:243], v[80:83], a[180:183], v[240:243]
ds_read_b64_tr_b16 v[112:113], v14 offset:0
ds_read_b64_tr_b16 v[114:115], v14 offset:16384
v_mfma_f32_16x16x32_bf16 v[228:231], v[84:87], a[176:179], v[228:231]
ds_read_b64_tr_b16 v[116:117], v15 offset:0
s_add_u32 m0, s76, 32768
v_mfma_f32_16x16x32_bf16 v[244:247], v[84:87], a[180:183], v[244:247]
ds_read_b64_tr_b16 v[118:119], v15 offset:16384
s_add_u32 s77, s100, 0x400000
v_mfma_f32_16x16x32_bf16 v[232:235], v[88:91], a[176:179], v[232:235]
ds_read_b64_tr_b16 v[120:121], v16 offset:0
ds_read_b64_tr_b16 v[122:123], v16 offset:16384
v_mfma_f32_16x16x32_bf16 v[248:251], v[88:91], a[180:183], v[248:251]
buffer_load_dwordx4 v38, s[48:51], s77 offen offset:0 lds
v_mfma_f32_16x16x32_bf16 v[236:239], v[92:95], a[176:179], v[236:239]
ds_read_b64_tr_b16 v[124:125], v17 offset:0
ds_read_b64_tr_b16 v[126:127], v17 offset:16384
v_mfma_f32_16x16x32_bf16 v[252:255], v[92:95], a[180:183], v[252:255]
ds_read_b64_tr_b16 v[80:81], v14 offset:1024
v_cvt_pk_bf16_f32 v184, v184, v185
v_mfma_f32_16x16x32_bf16 v[224:227], v[96:99], a[184:187], v[224:227]
ds_read_b64_tr_b16 v[82:83], v14 offset:17408
ds_read_b64_tr_b16 v[84:85], v15 offset:1024
v_mfma_f32_16x16x32_bf16 v[240:243], v[96:99], a[188:191], v[240:243]
ds_read_b64_tr_b16 v[86:87], v15 offset:17408
v_cvt_pk_bf16_f32 v185, v186, v187
v_mfma_f32_16x16x32_bf16 v[228:231], v[100:103], a[184:187], v[228:231]
ds_read_b64_tr_b16 v[88:89], v16 offset:1024
ds_read_b64_tr_b16 v[90:91], v16 offset:17408
v_mfma_f32_16x16x32_bf16 v[244:247], v[100:103], a[188:191], v[244:247]
buffer_load_dwordx4 v39, s[48:51], s77 offen offset:1024 lds
v_mfma_f32_16x16x32_bf16 v[232:235], v[104:107], a[184:187], v[232:235]
ds_read_b64_tr_b16 v[92:93], v17 offset:1024
ds_read_b64_tr_b16 v[94:95], v17 offset:17408
v_mfma_f32_16x16x32_bf16 v[248:251], v[104:107], a[188:191], v[248:251]
ds_read_b64_tr_b16 v[96:97], v14 offset:2048
v_cvt_pk_bf16_f32 v186, v188, v189
v_mfma_f32_16x16x32_bf16 v[236:239], v[108:111], a[184:187], v[236:239]
ds_read_b64_tr_b16 v[98:99], v14 offset:18432
ds_read_b64_tr_b16 v[100:101], v15 offset:2048
v_mfma_f32_16x16x32_bf16 v[252:255], v[108:111], a[188:191], v[252:255]
ds_read_b64_tr_b16 v[102:103], v15 offset:18432
s_waitcnt lgkmcnt(8)
v_mfma_f32_16x16x32_bf16 v[224:227], v[112:115], a[192:195], v[224:227]
ds_read_b64_tr_b16 v[104:105], v16 offset:2048
v_cvt_pk_bf16_f32 v187, v190, v191
v_mfma_f32_16x16x32_bf16 v[240:243], v[112:115], a[196:199], v[240:243]
buffer_load_dwordx4 v40, s[48:51], s77 offen offset:2048 lds
v_mfma_f32_16x16x32_bf16 v[228:231], v[116:119], a[192:195], v[228:231]
ds_read_b64_tr_b16 v[106:107], v16 offset:18432
ds_read_b64_tr_b16 v[108:109], v17 offset:2048
v_mfma_f32_16x16x32_bf16 v[244:247], v[116:119], a[196:199], v[244:247]
buffer_store_dwordx4 v[184:187], v46, s[60:63], s9 offen offset:3072 sc1
v_mfma_f32_16x16x32_bf16 v[232:235], v[120:123], a[192:195], v[232:235]
ds_read_b64_tr_b16 v[110:111], v17 offset:18432
ds_read_b64_tr_b16 v[112:113], v14 offset:3072
v_mfma_f32_16x16x32_bf16 v[248:251], v[120:123], a[196:199], v[248:251]
ds_read_b64_tr_b16 v[114:115], v14 offset:19456
v_mfma_f32_16x16x32_bf16 v[236:239], v[124:127], a[192:195], v[236:239]
ds_read_b64_tr_b16 v[116:117], v15 offset:3072
ds_read_b64_tr_b16 v[118:119], v15 offset:19456
v_mfma_f32_16x16x32_bf16 v[252:255], v[124:127], a[196:199], v[252:255]
buffer_load_dwordx4 v41, s[48:51], s77 offen offset:3072 lds
v_mfma_f32_16x16x32_bf16 v[224:227], v[80:83], a[200:203], v[224:227]
ds_read_b64_tr_b16 v[120:121], v16 offset:3072
ds_read_b64_tr_b16 v[122:123], v16 offset:19456
v_mfma_f32_16x16x32_bf16 v[240:243], v[80:83], a[204:207], v[240:243]
ds_read_b64_tr_b16 v[124:125], v17 offset:3072
v_mfma_f32_16x16x32_bf16 v[228:231], v[84:87], a[200:203], v[228:231]
ds_read_b64_tr_b16 v[126:127], v17 offset:19456
s_add_u32 m0, s76, 36864
v_mfma_f32_16x16x32_bf16 v[244:247], v[84:87], a[204:207], v[244:247]
ds_read_b64_tr_b16 v[80:81], v14 offset:4096
s_waitcnt lgkmcnt(7)
v_mfma_f32_16x16x32_bf16 v[232:235], v[88:91], a[200:203], v[232:235]
ds_read_b64_tr_b16 v[82:83], v14 offset:20480
s_add_u32 s77, s100, 0x440000
v_mfma_f32_16x16x32_bf16 v[248:251], v[88:91], a[204:207], v[248:251]
buffer_load_dwordx4 v38, s[48:51], s77 offen offset:0 lds
v_mfma_f32_16x16x32_bf16 v[236:239], v[92:95], a[200:203], v[236:239]
ds_read_b64_tr_b16 v[84:85], v15 offset:4096
ds_read_b64_tr_b16 v[86:87], v15 offset:20480
v_mfma_f32_16x16x32_bf16 v[252:255], v[92:95], a[204:207], v[252:255]
ds_read_b64_tr_b16 v[88:89], v16 offset:4096
v_mfma_f32_16x16x32_bf16 v[224:227], v[96:99], a[208:211], v[224:227]
ds_read_b64_tr_b16 v[90:91], v16 offset:20480
ds_read_b64_tr_b16 v[92:93], v17 offset:4096
v_mfma_f32_16x16x32_bf16 v[240:243], v[96:99], a[212:215], v[240:243]
ds_read_b64_tr_b16 v[94:95], v17 offset:20480
v_mfma_f32_16x16x32_bf16 v[228:231], v[100:103], a[208:211], v[228:231]
ds_read_b64_tr_b16 v[96:97], v14 offset:5120
v_mfma_f32_16x16x32_bf16 v[244:247], v[100:103], a[212:215], v[244:247]
buffer_load_dwordx4 v39, s[48:51], s77 offen offset:1024 lds
v_mfma_f32_16x16x32_bf16 v[232:235], v[104:107], a[208:211], v[232:235]
ds_read_b64_tr_b16 v[98:99], v14 offset:21504
ds_read_b64_tr_b16 v[100:101], v15 offset:5120
v_mfma_f32_16x16x32_bf16 v[248:251], v[104:107], a[212:215], v[248:251]
ds_read_b64_tr_b16 v[102:103], v15 offset:21504
v_mfma_f32_16x16x32_bf16 v[236:239], v[108:111], a[208:211], v[236:239]
ds_read_b64_tr_b16 v[104:105], v16 offset:5120
v_mfma_f32_16x16x32_bf16 v[252:255], v[108:111], a[212:215], v[252:255]
ds_read_b64_tr_b16 v[106:107], v16 offset:21504
v_mfma_f32_16x16x32_bf16 v[224:227], v[112:115], a[216:219], v[224:227]
ds_read_b64_tr_b16 v[108:109], v17 offset:5120
v_mfma_f32_16x16x32_bf16 v[240:243], v[112:115], a[220:223], v[240:243]
ds_read_b64_tr_b16 v[110:111], v17 offset:21504
s_waitcnt lgkmcnt(7)
v_mfma_f32_16x16x32_bf16 v[228:231], v[116:119], a[216:219], v[228:231]
buffer_load_dwordx4 v40, s[48:51], s77 offen offset:2048 lds
v_mfma_f32_16x16x32_bf16 v[244:247], v[116:119], a[220:223], v[244:247]
ds_read_b64_tr_b16 v[112:113], v14 offset:6144
ds_read_b64_tr_b16 v[114:115], v14 offset:22528
v_mfma_f32_16x16x32_bf16 v[232:235], v[120:123], a[216:219], v[232:235]
ds_read_b64_tr_b16 v[116:117], v15 offset:6144
v_mfma_f32_16x16x32_bf16 v[248:251], v[120:123], a[220:223], v[248:251]
ds_read_b64_tr_b16 v[118:119], v15 offset:22528
v_mfma_f32_16x16x32_bf16 v[236:239], v[124:127], a[216:219], v[236:239]
ds_read_b64_tr_b16 v[120:121], v16 offset:6144
v_mfma_f32_16x16x32_bf16 v[252:255], v[124:127], a[220:223], v[252:255]
ds_read_b64_tr_b16 v[122:123], v16 offset:22528
S_D3:
v_mfma_f32_16x16x32_bf16 v[128:131], v[80:83], a[0:3], 0
buffer_load_dwordx4 v41, s[48:51], s77 offen offset:3072 lds
ds_read_b64_tr_b16 v[124:125], v17 offset:6144
v_mfma_f32_16x16x32_bf16 v[144:147], v[80:83], a[4:7], 0
ds_read_b64_tr_b16 v[126:127], v17 offset:22528
s_lshl_b32 s78, s72, 12
s_add_u32 s78, s78, 147456
v_mfma_f32_16x16x32_bf16 v[132:135], v[84:87], a[0:3], 0
ds_read_b64_tr_b16 v[80:81], v14 offset:7168
v_and_b32 v2, 15, v1
v_lshrrev_b32 v3, 5, v1
v_mfma_f32_16x16x32_bf16 v[148:151], v[84:87], a[4:7], 0
s_waitcnt vmcnt(5)
s_atomic_add s69, s[60:61], s20 offset:128
s_atomic_add s69, s[60:61], s21 offset:128
v_mfma_f32_16x16x32_bf16 v[136:139], v[88:91], a[0:3], 0
ds_read_b64_tr_b16 v[82:83], v14 offset:23552
v_cvt_pk_bf16_f32 v224, v224, v225
v_cvt_pk_bf16_f32 v225, v226, v227
v_mfma_f32_16x16x32_bf16 v[152:155], v[88:91], a[4:7], 0
ds_read_b64_tr_b16 v[84:85], v15 offset:7168
v_cvt_pk_bf16_f32 v226, v228, v229
v_cvt_pk_bf16_f32 v227, v230, v231
v_mfma_f32_16x16x32_bf16 v[140:143], v[92:95], a[0:3], 0
buffer_store_dwordx4 v[224:227], v46, s[60:63], s10 offen offset:0 sc1
ds_read_b64_tr_b16 v[86:87], v15 offset:23552
v_mfma_f32_16x16x32_bf16 v[156:159], v[92:95], a[4:7], 0
ds_read_b64_tr_b16 v[88:89], v16 offset:7168
v_cvt_pk_bf16_f32 v232, v232, v233
s_waitcnt lgkmcnt(5)
v_mfma_f32_16x16x32_bf16 v[128:131], v[96:99], a[8:11], v[128:131]
ds_read_b64_tr_b16 v[90:91], v16 offset:23552
v_cvt_pk_bf16_f32 v233, v234, v235
v_cvt_pk_bf16_f32 v234, v236, v237
v_mfma_f32_16x16x32_bf16 v[144:147], v[96:99], a[12:15], v[144:147]
ds_read_b64_tr_b16 v[92:93], v17 offset:7168
v_cvt_pk_bf16_f32 v235, v238, v239
v_and_b32 v4, 7, v1
v_mfma_f32_16x16x32_bf16 v[132:135], v[100:103], a[8:11], v[132:135]
buffer_store_dwordx4 v[232:235], v46, s[60:63], s10 offen offset:1024 sc1
ds_read_b64_tr_b16 v[94:95], v17 offset:23552
v_mfma_f32_16x16x32_bf16 v[148:151], v[100:103], a[12:15], v[148:151]
s_barrier
ds_read_b64_tr_b16 v[96:97], v14 offset:32768
v_mfma_f32_16x16x32_bf16 v[136:139], v[104:107], a[8:11], v[136:139]
ds_read_b64_tr_b16 v[98:99], v14 offset:49152
v_cvt_pk_bf16_f32 v240, v240, v241
v_cvt_pk_bf16_f32 v241, v242, v243
v_mfma_f32_16x16x32_bf16 v[152:155], v[104:107], a[12:15], v[152:155]
ds_read_b64_tr_b16 v[100:101], v15 offset:32768
v_cvt_pk_bf16_f32 v242, v244, v245
v_cvt_pk_bf16_f32 v243, v246, v247
v_mfma_f32_16x16x32_bf16 v[140:143], v[108:111], a[8:11], v[140:143]
buffer_store_dwordx4 v[240:243], v46, s[60:63], s10 offen offset:2048 sc1
ds_read_b64_tr_b16 v[102:103], v15 offset:49152
v_mfma_f32_16x16x32_bf16 v[156:159], v[108:111], a[12:15], v[156:159]
ds_read_b64_tr_b16 v[104:105], v16 offset:32768
v_cvt_pk_bf16_f32 v248, v248, v249
v_mfma_f32_16x16x32_bf16 v[128:131], v[112:115], a[16:19], v[128:131]
ds_read_b64_tr_b16 v[106:107], v16 offset:49152
v_cvt_pk_bf16_f32 v249, v250, v251
v_mfma_f32_16x16x32_bf16 v[144:147], v[112:115], a[20:23], v[144:147]
ds_read_b64_tr_b16 v[108:109], v17 offset:32768
v_cvt_pk_bf16_f32 v250, v252, v253
v_mfma_f32_16x16x32_bf16 v[132:135], v[116:119], a[16:19], v[132:135]
ds_read_b64_tr_b16 v[110:111], v17 offset:49152
v_cvt_pk_bf16_f32 v251, v254, v255
v_mfma_f32_16x16x32_bf16 v[148:151], v[116:119], a[20:23], v[148:151]
buffer_store_dwordx4 v[248:251], v46, s[60:63], s10 offen offset:3072 sc1
v_mfma_f32_16x16x32_bf16 v[136:139], v[120:123], a[16:19], v[136:139]
ds_read_b64_tr_b16 v[112:113], v14 offset:33792
v_xor_b32 v3, v3, v4
v_mfma_f32_16x16x32_bf16 v[152:155], v[120:123], a[20:23], v[152:155]
ds_read_b64_tr_b16 v[114:115], v14 offset:50176
v_lshlrev_b32 v3, 4, v3
v_mfma_f32_16x16x32_bf16 v[140:143], v[124:127], a[16:19], v[140:143]
ds_read_b64_tr_b16 v[116:117], v15 offset:33792
v_lshl_add_u32 v3, v2, 7, v3
v_mfma_f32_16x16x32_bf16 v[156:159], v[124:127], a[20:23], v[156:159]
ds_read_b64_tr_b16 v[118:119], v15 offset:50176
s_waitcnt lgkmcnt(5)
v_mfma_f32_16x16x32_bf16 v[128:131], v[80:83], a[24:27], v[128:131]
ds_read_b64_tr_b16 v[120:121], v16 offset:33792
v_bfe_u32 v2, v1, 4, 1
v_mfma_f32_16x16x32_bf16 v[144:147], v[80:83], a[28:31], v[144:147]
ds_read_b64_tr_b16 v[122:123], v16 offset:50176
v_lshl_add_u32 v3, v2, 3, v3
v_mfma_f32_16x16x32_bf16 v[132:135], v[84:87], a[24:27], v[132:135]
ds_read_b64_tr_b16 v[124:125], v17 offset:33792
v_add_u32 v53, s78, v3
v_mfma_f32_16x16x32_bf16 v[148:151], v[84:87], a[28:31], v[148:151]
ds_read_b64_tr_b16 v[126:127], v17 offset:50176
v_xor_b32 v54, 32, v53
v_mfma_f32_16x16x32_bf16 v[136:139], v[88:91], a[24:27], v[136:139]
ds_read_b64_tr_b16 v[80:81], v14 offset:34816
v_xor_b32 v55, 64, v53
v_mfma_f32_16x16x32_bf16 v[152:155], v[88:91], a[28:31], v[152:155]
ds_read_b64_tr_b16 v[82:83], v14 offset:51200
v_xor_b32 v51, 96, v53
v_mfma_f32_16x16x32_bf16 v[140:143], v[92:95], a[24:27], v[140:143]
ds_read_b64_tr_b16 v[84:85], v15 offset:34816
v_add_u32 v49, s78, v46
v_mfma_f32_16x16x32_bf16 v[156:159], v[92:95], a[28:31], v[156:159]
ds_read_b64_tr_b16 v[86:87], v15 offset:51200
v_lshrrev_b32 v2, 3, v1
v_mfma_f32_16x16x32_bf16 v[128:131], v[96:99], a[32:35], v[128:131]
ds_read_b64_tr_b16 v[88:89], v16 offset:34816
v_xor_b32 v4, v4, v2
v_mfma_f32_16x16x32_bf16 v[144:147], v[96:99], a[36:39], v[144:147]
ds_read_b64_tr_b16 v[90:91], v16 offset:51200
v_lshlrev_b32 v4, 4, v4
v_mfma_f32_16x16x32_bf16 v[132:135], v[100:103], a[32:35], v[132:135]
ds_read_b64_tr_b16 v[92:93], v17 offset:34816
v_lshl_add_u32 v2, v2, 11, v4
v_mfma_f32_16x16x32_bf16 v[148:151], v[100:103], a[36:39], v[148:151]
ds_read_b64_tr_b16 v[94:95], v17 offset:51200
s_add_u32 s16, s12, 16384
v_mfma_f32_16x16x32_bf16 v[136:139], v[104:107], a[32:35], v[136:139]
ds_read_b64_tr_b16 v[96:97], v14 offset:35840
s_add_u32 s17, s13, 16384
v_mfma_f32_16x16x32_bf16 v[152:155], v[104:107], a[36:39], v[152:155]
ds_read_b64_tr_b16 v[98:99], v14 offset:52224
s_waitcnt lgkmcnt(6)
v_mfma_f32_16x16x32_bf16 v[140:143], v[108:111], a[32:35], v[140:143]
ds_read_b64_tr_b16 v[100:101], v15 offset:35840
ds_read_b64_tr_b16 v[102:103], v15 offset:52224
v_mfma_f32_16x16x32_bf16 v[156:159], v[108:111], a[36:39], v[156:159]
ds_read_b64_tr_b16 v[104:105], v16 offset:35840
v_mfma_f32_16x16x32_bf16 v[128:131], v[112:115], a[40:43], v[128:131]
ds_read_b64_tr_b16 v[106:107], v16 offset:52224
ds_read_b64_tr_b16 v[108:109], v17 offset:35840
v_mfma_f32_16x16x32_bf16 v[144:147], v[112:115], a[44:47], v[144:147]
ds_read_b64_tr_b16 v[110:111], v17 offset:52224
v_mfma_f32_16x16x32_bf16 v[132:135], v[116:119], a[40:43], v[132:135]
ds_read_b64_tr_b16 v[112:113], v14 offset:36864
v_mfma_f32_16x16x32_bf16 v[148:151], v[116:119], a[44:47], v[148:151]
ds_read_b64_tr_b16 v[114:115], v14 offset:53248
v_mfma_f32_16x16x32_bf16 v[136:139], v[120:123], a[40:43], v[136:139]
ds_read_b64_tr_b16 v[116:117], v15 offset:36864
v_mfma_f32_16x16x32_bf16 v[152:155], v[120:123], a[44:47], v[152:155]
ds_read_b64_tr_b16 v[118:119], v15 offset:53248
v_mfma_f32_16x16x32_bf16 v[140:143], v[124:127], a[40:43], v[140:143]
ds_read_b64_tr_b16 v[120:121], v16 offset:36864
v_mfma_f32_16x16x32_bf16 v[156:159], v[124:127], a[44:47], v[156:159]
ds_read_b64_tr_b16 v[122:123], v16 offset:53248
v_mfma_f32_16x16x32_bf16 v[128:131], v[80:83], a[48:51], v[128:131]
ds_read_b64_tr_b16 v[124:125], v17 offset:36864
v_mfma_f32_16x16x32_bf16 v[144:147], v[80:83], a[52:55], v[144:147]
ds_read_b64_tr_b16 v[126:127], v17 offset:53248
v_mfma_f32_16x16x32_bf16 v[132:135], v[84:87], a[48:51], v[132:135]
ds_read_b64_tr_b16 v[80:81], v14 offset:37888
v_mfma_f32_16x16x32_bf16 v[148:151], v[84:87], a[52:55], v[148:151]
ds_read_b64_tr_b16 v[82:83], v14 offset:54272
s_waitcnt lgkmcnt(6)
v_mfma_f32_16x16x32_bf16 v[136:139], v[88:91], a[48:51], v[136:139]
ds_read_b64_tr_b16 v[84:85], v15 offset:37888
v_mfma_f32_16x16x32_bf16 v[152:155], v[88:91], a[52:55], v[152:155]
ds_read_b64_tr_b16 v[86:87], v15 offset:54272
v_mfma_f32_16x16x32_bf16 v[140:143], v[92:95], a[48:51], v[140:143]
ds_read_b64_tr_b16 v[88:89], v16 offset:37888
v_mfma_f32_16x16x32_bf16 v[156:159], v[92:95], a[52:55], v[156:159]
ds_read_b64_tr_b16 v[90:91], v16 offset:54272
v_mfma_f32_16x16x32_bf16 v[128:131], v[96:99], a[56:59], v[128:131]
ds_read_b64_tr_b16 v[92:93], v17 offset:37888
v_mfma_f32_16x16x32_bf16 v[144:147], v[96:99], a[60:63], v[144:147]
ds_read_b64_tr_b16 v[94:95], v17 offset:54272
v_mfma_f32_16x16x32_bf16 v[132:135], v[100:103], a[56:59], v[132:135]
ds_read_b64_tr_b16 v[96:97], v14 offset:38912
v_mfma_f32_16x16x32_bf16 v[148:151], v[100:103], a[60:63], v[148:151]
ds_read_b64_tr_b16 v[98:99], v14 offset:55296
v_mfma_f32_16x16x32_bf16 v[136:139], v[104:107], a[56:59], v[136:139]
ds_read_b64_tr_b16 v[100:101], v15 offset:38912
v_mfma_f32_16x16x32_bf16 v[152:155], v[104:107], a[60:63], v[152:155]
ds_read_b64_tr_b16 v[102:103], v15 offset:55296
v_mfma_f32_16x16x32_bf16 v[140:143], v[108:111], a[56:59], v[140:143]
ds_read_b64_tr_b16 v[104:105], v16 offset:38912
v_mfma_f32_16x16x32_bf16 v[156:159], v[108:111], a[60:63], v[156:159]
ds_read_b64_tr_b16 v[106:107], v16 offset:55296
v_mfma_f32_16x16x32_bf16 v[128:131], v[112:115], a[64:67], v[128:131]
ds_read_b64_tr_b16 v[108:109], v17 offset:38912
v_mfma_f32_16x16x32_bf16 v[144:147], v[112:115], a[68:71], v[144:147]
ds_read_b64_tr_b16 v[110:111], v17 offset:55296
v_mfma_f32_16x16x32_bf16 v[132:135], v[116:119], a[64:67], v[132:135]
ds_read_b64_tr_b16 v[112:113], v14 offset:39936
v_mfma_f32_16x16x32_bf16 v[148:151], v[116:119], a[68:71], v[148:151]
ds_read_b64_tr_b16 v[114:115], v14 offset:56320
s_waitcnt lgkmcnt(6)
v_mfma_f32_16x16x32_bf16 v[136:139], v[120:123], a[64:67], v[136:139]
ds_read_b64_tr_b16 v[116:117], v15 offset:39936
v_mfma_f32_16x16x32_bf16 v[152:155], v[120:123], a[68:71], v[152:155]
ds_read_b64_tr_b16 v[118:119], v15 offset:56320
v_mfma_f32_16x16x32_bf16 v[140:143], v[124:127], a[64:67], v[140:143]
ds_read_b64_tr_b16 v[120:121], v16 offset:39936
v_mfma_f32_16x16x32_bf16 v[156:159], v[124:127], a[68:71], v[156:159]
ds_read_b64_tr_b16 v[122:123], v16 offset:56320
v_mfma_f32_16x16x32_bf16 v[128:131], v[80:83], a[72:75], v[128:131]
ds_read_b64_tr_b16 v[124:125], v17 offset:39936
v_mfma_f32_16x16x32_bf16 v[144:147], v[80:83], a[76:79], v[144:147]
ds_read_b64_tr_b16 v[126:127], v17 offset:56320
v_mfma_f32_16x16x32_bf16 v[132:135], v[84:87], a[72:75], v[132:135]
s_barrier
v_mfma_f32_16x16x32_bf16 v[148:151], v[84:87], a[76:79], v[148:151]
ds_read_b64_tr_b16 v[80:81], v10 offset:0
ds_read_b64_tr_b16 v[82:83], v10 offset:16384
v_mfma_f32_16x16x32_bf16 v[136:139], v[88:91], a[72:75], v[136:139]
ds_read_b64_tr_b16 v[84:85], v11 offset:0
v_mfma_f32_16x16x32_bf16 v[152:155], v[88:91], a[76:79], v[152:155]
ds_read_b64_tr_b16 v[86:87], v11 offset:16384
v_mfma_f32_16x16x32_bf16 v[140:143], v[92:95], a[72:75], v[140:143]
ds_read_b64_tr_b16 v[88:89], v12 offset:0
v_mfma_f32_16x16x32_bf16 v[156:159], v[92:95], a[76:79], v[156:159]
s_waitcnt vmcnt(0)
s_atomic_add s69, s[60:61], s22 offset:132
s_mov_b32 s87, 0
s_atomic_add s87, s[60:61], s23 offset:128 glc
v_mfma_f32_16x16x32_bf16 v[128:131], v[96:99], a[80:83], v[128:131]
ds_read_b64_tr_b16 v[90:91], v12 offset:16384
ds_read_b64_tr_b16 v[92:93], v13 offset:0
v_mfma_f32_16x16x32_bf16 v[144:147], v[96:99], a[84:87], v[144:147]
ds_read_b64_tr_b16 v[94:95], v13 offset:16384
v_mfma_f32_16x16x32_bf16 v[132:135], v[100:103], a[80:83], v[132:135]
ds_read_b64_tr_b16 v[96:97], v10 offset:1024
v_mfma_f32_16x16x32_bf16 v[148:151], v[100:103], a[84:87], v[148:151]
ds_read_b64_tr_b16 v[98:99], v10 offset:17408
s_waitcnt lgkmcnt(6)
v_mfma_f32_16x16x32_bf16 v[136:139], v[104:107], a[80:83], v[136:139]
ds_read_b64_tr_b16 v[100:101], v11 offset:1024
v_mfma_f32_16x16x32_bf16 v[152:155], v[104:107], a[84:87], v[152:155]
ds_read_b64_tr_b16 v[102:103], v11 offset:17408
v_mfma_f32_16x16x32_bf16 v[140:143], v[108:111], a[80:83], v[140:143]
ds_read_b64_tr_b16 v[104:105], v12 offset:1024
v_mfma_f32_16x16x32_bf16 v[156:159], v[108:111], a[84:87], v[156:159]
ds_read_b64_tr_b16 v[106:107], v12 offset:17408
v_mfma_f32_16x16x32_bf16 v[128:131], v[112:115], a[88:91], v[128:131]
ds_read_b64_tr_b16 v[108:109], v13 offset:1024
v_mfma_f32_16x16x32_bf16 v[144:147], v[112:115], a[92:95], v[144:147]
ds_read_b64_tr_b16 v[110:111], v13 offset:17408
v_mfma_f32_16x16x32_bf16 v[132:135], v[116:119], a[88:91], v[132:135]
ds_read_b64_tr_b16 v[112:113], v10 offset:2048
v_mfma_f32_16x16x32_bf16 v[148:151], v[116:119], a[92:95], v[148:151]
ds_read_b64_tr_b16 v[114:115], v10 offset:18432
v_mfma_f32_16x16x32_bf16 v[136:139], v[120:123], a[88:91], v[136:139]
ds_read_b64_tr_b16 v[116:117], v11 offset:2048
v_mfma_f32_16x16x32_bf16 v[152:155], v[120:123], a[92:95], v[152:155]
ds_read_b64_tr_b16 v[118:119], v11 offset:18432
v_mfma_f32_16x16x32_bf16 v[140:143], v[124:127], a[88:91], v[140:143]
ds_read_b64_tr_b16 v[120:121], v12 offset:2048
v_mfma_f32_16x16x32_bf16 v[156:159], v[124:127], a[92:95], v[156:159]
ds_read_b64_tr_b16 v[122:123], v12 offset:18432
v_mfma_f32_16x16x32_bf16 v[128:131], v[80:83], a[96:99], v[128:131]
ds_read_b64_tr_b16 v[124:125], v13 offset:2048
v_mfma_f32_16x16x32_bf16 v[144:147], v[80:83], a[100:103], v[144:147]
ds_read_b64_tr_b16 v[126:127], v13 offset:18432
v_mfma_f32_16x16x32_bf16 v[132:135], v[84:87], a[96:99], v[132:135]
ds_read_b64_tr_b16 v[80:81], v10 offset:3072
v_mfma_f32_16x16x32_bf16 v[148:151], v[84:87], a[100:103], v[148:151]
ds_read_b64_tr_b16 v[82:83], v10 offset:19456
s_waitcnt lgkmcnt(6)
v_mfma_f32_16x16x32_bf16 v[136:139], v[88:91], a[96:99], v[136:139]
ds_read_b64_tr_b16 v[84:85], v11 offset:3072
v_mfma_f32_16x16x32_bf16 v[152:155], v[88:91], a[100:103], v[152:155]
ds_read_b64_tr_b16 v[86:87], v11 offset:19456
v_mfma_f32_16x16x32_bf16 v[140:143], v[92:95], a[96:99], v[140:143]
ds_read_b64_tr_b16 v[88:89], v12 offset:3072
v_mfma_f32_16x16x32_bf16 v[156:159], v[92:95], a[100:103], v[156:159]
ds_read_b64_tr_b16 v[90:91], v12 offset:19456
v_mfma_f32_16x16x32_bf16 v[128:131], v[96:99], a[104:107], v[128:131]
ds_read_b64_tr_b16 v[92:93], v13 offset:3072
v_mfma_f32_16x16x32_bf16 v[144:147], v[96:99], a[108:111], v[144:147]
ds_read_b64_tr_b16 v[94:95], v13 offset:19456
v_mfma_f32_16x16x32_bf16 v[132:135], v[100:103], a[104:107], v[132:135]
ds_read_b64_tr_b16 v[96:97], v10 offset:4096
v_mfma_f32_16x16x32_bf16 v[148:151], v[100:103], a[108:111], v[148:151]
ds_read_b64_tr_b16 v[98:99], v10 offset:20480
v_mfma_f32_16x16x32_bf16 v[136:139], v[104:107], a[104:107], v[136:139]
ds_read_b64_tr_b16 v[100:101], v11 offset:4096
v_mfma_f32_16x16x32_bf16 v[152:155], v[104:107], a[108:111], v[152:155]
ds_read_b64_tr_b16 v[102:103], v11 offset:20480
v_mfma_f32_16x16x32_bf16 v[140:143], v[108:111], a[104:107], v[140:143]
ds_read_b64_tr_b16 v[104:105], v12 offset:4096
v_mfma_f32_16x16x32_bf16 v[156:159], v[108:111], a[108:111], v[156:159]
ds_read_b64_tr_b16 v[106:107], v12 offset:20480
v_mfma_f32_16x16x32_bf16 v[128:131], v[112:115], a[112:115], v[128:131]
ds_read_b64_tr_b16 v[108:109], v13 offset:4096
v_mfma_f32_16x16x32_bf16 v[144:147], v[112:115], a[116:119], v[144:147]
ds_read_b64_tr_b16 v[110:111], v13 offset:20480
v_mfma_f32_16x16x32_bf16 v[132:135], v[116:119], a[112:115], v[132:135]
ds_read_b64_tr_b16 v[112:113], v10 offset:5120
v_mfma_f32_16x16x32_bf16 v[148:151], v[116:119], a[116:119], v[148:151]
s_waitcnt lgkmcnt(0)
s_cmp_lt_u32 s87, 2
s_cbranch_scc1 pl_8_slow
pl_8_ok:
v_mfma_f32_16x16x32_bf16 v[136:139], v[120:123], a[112:115], v[136:139]
buffer_load_dwordx4 a[224:227], v46, s[60:63], s11 offen offset:0 sc1
v_mfma_f32_16x16x32_bf16 v[152:155], v[120:123], a[116:119], v[152:155]
ds_read_b64_tr_b16 v[114:115], v10 offset:21504
ds_read_b64_tr_b16 v[116:117], v11 offset:5120
v_mfma_f32_16x16x32_bf16 v[140:143], v[124:127], a[112:115], v[140:143]
buffer_load_dwordx4 a[240:243], v46, s[60:63], s14 offen offset:0 sc1
v_mfma_f32_16x16x32_bf16 v[156:159], v[124:127], a[116:119], v[156:159]
ds_read_b64_tr_b16 v[118:119], v11 offset:21504
ds_read_b64_tr_b16 v[120:121], v12 offset:5120
v_mfma_f32_16x16x32_bf16 v[128:131], v[80:83], a[120:123], v[128:131]
buffer_load_dwordx4 a[228:231], v46, s[60:63], s11 offen offset:1024 sc1
v_mfma_f32_16x16x32_bf16 v[144:147], v[80:83], a[124:127], v[144:147]
ds_read_b64_tr_b16 v[122:123], v12 offset:21504
ds_read_b64_tr_b16 v[124:125], v13 offset:5120
v_mfma_f32_16x16x32_bf16 v[132:135], v[84:87], a[120:123], v[132:135]
buffer_load_dwordx4 a[244:247], v46, s[60:63], s14 offen offset:1024 sc1
v_mfma_f32_16x16x32_bf16 v[148:151], v[84:87], a[124:127], v[148:151]
ds_read_b64_tr_b16 v[126:127], v13 offset:21504
ds_read_b64_tr_b16 v[80:81], v10 offset:6144
v_mfma_f32_16x16x32_bf16 v[136:139], v[88:91], a[120:123], v[136:139]
buffer_load_dwordx4 a[232:235], v46, s[60:63], s11 offen offset:2048 sc1
v_mfma_f32_16x16x32_bf16 v[152:155], v[88:91], a[124:127], v[152:155]
ds_read_b64_tr_b16 v[82:83], v10 offset:22528
ds_read_b64_tr_b16 v[84:85], v11 offset:6144
v_mfma_f32_16x16x32_bf16 v[140:143], v[92:95], a[120:123], v[140:143]
ds_read_b64_tr_b16 v[86:87], v11 offset:22528
v_mfma_f32_16x16x32_bf16 v[156:159], v[92:95], a[124:127], v[156:159]
ds_read_b64_tr_b16 v[88:89], v12 offset:6144
ds_read_b64_tr_b16 v[90:91], v12 offset:22528
v_mfma_f32_16x16x32_bf16 v[128:131], v[96:99], a[128:131], v[128:131]
ds_read_b64_tr_b16 v[92:93], v13 offset:6144
v_mfma_f32_16x16x32_bf16 v[144:147], v[96:99], a[132:135], v[144:147]
buffer_load_dwordx4 a[248:251], v46, s[60:63], s14 offen offset:2048 sc1
v_mfma_f32_16x16x32_bf16 v[132:135], v[100:103], a[128:131], v[132:135]
ds_read_b64_tr_b16 v[94:95], v13 offset:22528
ds_read_b64_tr_b16 v[96:97], v10 offset:7168
v_mfma_f32_16x16x32_bf16 v[148:151], v[100:103], a[132:135], v[148:151]
ds_read_b64_tr_b16 v[98:99], v10 offset:23552
v_mfma_f32_16x16x32_bf16 v[136:139], v[104:107], a[128:131], v[136:139]
ds_read_b64_tr_b16 v[100:101], v11 offset:7168
v_mfma_f32_16x16x32_bf16 v[152:155], v[104:107], a[132:135], v[152:155]
buffer_load_dwordx4 a[236:239], v46, s[60:63], s11 offen offset:3072 sc1
v_mfma_f32_16x16x32_bf16 v[140:143], v[108:111], a[128:131], v[140:143]
ds_read_b64_tr_b16 v[102:103], v11 offset:23552
ds_read_b64_tr_b16 v[104:105], v12 offset:7168
v_mfma_f32_16x16x32_bf16 v[156:159], v[108:111], a[132:135], v[156:159]
ds_read_b64_tr_b16 v[106:107], v12 offset:23552
s_waitcnt lgkmcnt(7)
v_mfma_f32_16x16x32_bf16 v[128:131], v[112:115], a[136:139], v[128:131]
ds_read_b64_tr_b16 v[108:109], v13 offset:7168
v_mfma_f32_16x16x32_bf16 v[144:147], v[112:115], a[140:143], v[144:147]
ds_read_b64_tr_b16 v[110:111], v13 offset:23552
v_mfma_f32_16x16x32_bf16 v[132:135], v[116:119], a[136:139], v[132:135]
s_barrier
v_mfma_f32_16x16x32_bf16 v[148:151], v[116:119], a[140:143], v[148:151]
buffer_load_dwordx4 a[252:255], v46, s[60:63], s14 offen offset:3072 sc1
v_mfma_f32_16x16x32_bf16 v[136:139], v[120:123], a[136:139], v[136:139]
ds_read_b64_tr_b16 v[112:113], v10 offset:32768
ds_read_b64_tr_b16 v[114:115], v10 offset:49152
v_mfma_f32_16x16x32_bf16 v[152:155], v[120:123], a[140:143], v[152:155]
ds_read_b64_tr_b16 v[116:117], v11 offset:32768
v_mfma_f32_16x16x32_bf16 v[140:143], v[124:127], a[136:139], v[140:143]
ds_read_b64_tr_b16 v[118:119], v11 offset:49152
ds_read_b64_tr_b16 v[120:121], v12 offset:32768
v_mfma_f32_16x16x32_bf16 v[156:159], v[124:127], a[140:143], v[156:159]
ds_read_b64_tr_b16 v[122:123], v12 offset:49152
v_mfma_f32_16x16x32_bf16 v[128:131], v[80:83], a[144:147], v[128:131]
ds_read_b64_tr_b16 v[124:125], v13 offset:32768
v_mfma_f32_16x16x32_bf16 v[144:147], v[80:83], a[148:151], v[144:147]
ds_read_b64_tr_b16 v[126:127], v13 offset:49152
v_mfma_f32_16x16x32_bf16 v[132:135], v[84:87], a[144:147], v[132:135]
ds_read_b64_tr_b16 v[80:81], v10 offset:33792
v_mfma_f32_16x16x32_bf16 v[148:151], v[84:87], a[148:151], v[148:151]
ds_read_b64_tr_b16 v[82:83], v10 offset:50176
v_mfma_f32_16x16x32_bf16 v[136:139], v[88:91], a[144:147], v[136:139]
ds_read_b64_tr_b16 v[84:85], v11 offset:33792
v_mfma_f32_16x16x32_bf16 v[152:155], v[88:91], a[148:151], v[152:155]
ds_read_b64_tr_b16 v[86:87], v11 offset:50176
s_waitcnt lgkmcnt(6)
v_mfma_f32_16x16x32_bf16 v[140:143], v[92:95], a[144:147], v[140:143]
ds_read_b64_tr_b16 v[88:89], v12 offset:33792
v_mfma_f32_16x16x32_bf16 v[156:159], v[92:95], a[148:151], v[156:159]
ds_read_b64_tr_b16 v[90:91], v12 offset:50176
v_mfma_f32_16x16x32_bf16 v[128:131], v[96:99], a[152:155], v[128:131]
ds_read_b64_tr_b16 v[92:93], v13 offset:33792
v_mfma_f32_16x16x32_bf16 v[144:147], v[96:99], a[156:159], v[144:147]
ds_read_b64_tr_b16 v[94:95], v13 offset:50176
v_mfma_f32_16x16x32_bf16 v[132:135], v[100:103], a[152:155], v[132:135]
ds_read_b64_tr_b16 v[96:97], v10 offset:34816
v_mfma_f32_16x16x32_bf16 v[148:151], v[100:103], a[156:159], v[148:151]
s_mov_b32 s87, 0
s_atomic_add s87, s[60:61], s23 offset:132 glc
v_mfma_f32_16x16x32_bf16 v[136:139], v[104:107], a[152:155], v[136:139]
ds_read_b64_tr_b16 v[98:99], v10 offset:51200
ds_read_b64_tr_b16 v[100:101], v11 offset:34816
v_mfma_f32_16x16x32_bf16 v[152:155], v[104:107], a[156:159], v[152:155]
ds_read_b64_tr_b16 v[102:103], v11 offset:51200
v_mfma_f32_16x16x32_bf16 v[140:143], v[108:111], a[152:155], v[140:143]
ds_read_b64_tr_b16 v[104:105], v12 offset:34816
v_mfma_f32_16x16x32_bf16 v[156:159], v[108:111], a[156:159], v[156:159]
ds_read_b64_tr_b16 v[106:107], v12 offset:51200
v_mfma_f32_16x16x32_bf16 v[128:131], v[112:115], a[160:163], v[128:131]
ds_read_b64_tr_b16 v[108:109], v13 offset:34816
v_mfma_f32_16x16x32_bf16 v[144:147], v[112:115], a[164:167], v[144:147]
ds_read_b64_tr_b16 v[110:111], v13 offset:51200
v_mfma_f32_16x16x32_bf16 v[132:135], v[116:119], a[160:163], v[132:135]
ds_read_b64_tr_b16 v[112:113], v10 offset:35840
v_mfma_f32_16x16x32_bf16 v[148:151], v[116:119], a[164:167], v[148:151]
ds_read_b64_tr_b16 v[114:115], v10 offset:52224
v_mfma_f32_16x16x32_bf16 v[136:139], v[120:123], a[160:163], v[136:139]
ds_read_b64_tr_b16 v[116:117], v11 offset:35840
v_mfma_f32_16x16x32_bf16 v[152:155], v[120:123], a[164:167], v[152:155]
ds_read_b64_tr_b16 v[118:119], v11 offset:52224
s_waitcnt lgkmcnt(6)
v_mfma_f32_16x16x32_bf16 v[140:143], v[124:127], a[160:163], v[140:143]
ds_read_b64_tr_b16 v[120:121], v12 offset:35840
v_mfma_f32_16x16x32_bf16 v[156:159], v[124:127], a[164:167], v[156:159]
ds_read_b64_tr_b16 v[122:123], v12 offset:52224
v_mfma_f32_16x16x32_bf16 v[128:131], v[80:83], a[168:171], v[128:131]
ds_read_b64_tr_b16 v[124:125], v13 offset:35840
v_mfma_f32_16x16x32_bf16 v[144:147], v[80:83], a[172:175], v[144:147]
ds_read_b64_tr_b16 v[126:127], v13 offset:52224
v_mfma_f32_16x16x32_bf16 v[132:135], v[84:87], a[168:171], v[132:135]
ds_read_b64_tr_b16 v[80:81], v10 offset:36864
v_mfma_f32_16x16x32_bf16 v[148:151], v[84:87], a[172:175], v[148:151]
ds_read_b64_tr_b16 v[82:83], v10 offset:53248
v_mfma_f32_16x16x32_bf16 v[136:139], v[88:91], a[168:171], v[136:139]
ds_read_b64_tr_b16 v[84:85], v11 offset:36864
v_mfma_f32_16x16x32_bf16 v[152:155], v[88:91], a[172:175], v[152:155]
ds_read_b64_tr_b16 v[86:87], v11 offset:53248
v_mfma_f32_16x16x32_bf16 v[140:143], v[92:95], a[168:171], v[140:143]
ds_read_b64_tr_b16 v[88:89], v12 offset:36864
v_mfma_f32_16x16x32_bf16 v[156:159], v[92:95], a[172:175], v[156:159]
ds_read_b64_tr_b16 v[90:91], v12 offset:53248
v_mfma_f32_16x16x32_bf16 v[128:131], v[96:99], a[176:179], v[128:131]
ds_read_b64_tr_b16 v[92:93], v13 offset:36864
v_mfma_f32_16x16x32_bf16 v[144:147], v[96:99], a[180:183], v[144:147]
ds_read_b64_tr_b16 v[94:95], v13 offset:53248
v_mfma_f32_16x16x32_bf16 v[132:135], v[100:103], a[176:179], v[132:135]
ds_read_b64_tr_b16 v[96:97], v10 offset:37888
v_mfma_f32_16x16x32_bf16 v[148:151], v[100:103], a[180:183], v[148:151]
ds_read_b64_tr_b16 v[98:99], v10 offset:54272
v_mfma_f32_16x16x32_bf16 v[136:139], v[104:107], a[176:179], v[136:139]
ds_read_b64_tr_b16 v[100:101], v11 offset:37888
v_mfma_f32_16x16x32_bf16 v[152:155], v[104:107], a[180:183], v[152:155]
ds_read_b64_tr_b16 v[102:103], v11 offset:54272
s_waitcnt lgkmcnt(6)
v_mfma_f32_16x16x32_bf16 v[140:143], v[108:111], a[176:179], v[140:143]
ds_read_b64_tr_b16 v[104:105], v12 offset:37888
v_mfma_f32_16x16x32_bf16 v[156:159], v[108:111], a[180:183], v[156:159]
ds_read_b64_tr_b16 v[106:107], v12 offset:54272
v_mfma_f32_16x16x32_bf16 v[128:131], v[112:115], a[184:187], v[128:131]
ds_read_b64_tr_b16 v[108:109], v13 offset:37888
v_mfma_f32_16x16x32_bf16 v[144:147], v[112:115], a[188:191], v[144:147]
ds_read_b64_tr_b16 v[110:111], v13 offset:54272
v_mfma_f32_16x16x32_bf16 v[132:135], v[116:119], a[184:187], v[132:135]
ds_read_b64_tr_b16 v[112:113], v10 offset:38912
v_mfma_f32_16x16x32_bf16 v[148:151], v[116:119], a[188:191], v[148:151]
ds_read_b64_tr_b16 v[114:115], v10 offset:55296
v_mfma_f32_16x16x32_bf16 v[136:139], v[120:123], a[184:187], v[136:139]
ds_read_b64_tr_b16 v[116:117], v11 offset:38912
v_mfma_f32_16x16x32_bf16 v[152:155], v[120:123], a[188:191], v[152:155]
ds_read_b64_tr_b16 v[118:119], v11 offset:55296
v_mfma_f32_16x16x32_bf16 v[140:143], v[124:127], a[184:187], v[140:143]
ds_read_b64_tr_b16 v[120:121], v12 offset:38912
v_mfma_f32_16x16x32_bf16 v[156:159], v[124:127], a[188:191], v[156:159]
s_waitcnt lgkmcnt(0)
s_cmp_lt_u32 s87, 1
s_cbranch_scc1 pl_9_slow
pl_9_ok:
v_mfma_f32_16x16x32_bf16 v[128:131], v[80:83], a[192:195], v[128:131]
buffer_load_dwordx4 v[160:163], v46, s[60:63], s15 offen offset:0 sc1
v_mfma_f32_16x16x32_bf16 v[144:147], v[80:83], a[196:199], v[144:147]
ds_read_b64_tr_b16 v[122:123], v12 offset:55296
ds_read_b64_tr_b16 v[124:125], v13 offset:38912
v_mfma_f32_16x16x32_bf16 v[132:135], v[84:87], a[192:195], v[132:135]
buffer_load_dwordx4 v[164:167], v46, s[60:63], s15 offen offset:1024 sc1
v_mfma_f32_16x16x32_bf16 v[148:151], v[84:87], a[196:199], v[148:151]
ds_read_b64_tr_b16 v[126:127], v13 offset:55296
ds_read_b64_tr_b16 v[80:81], v10 offset:39936
v_mfma_f32_16x16x32_bf16 v[136:139], v[88:91], a[192:195], v[136:139]
buffer_load_dwordx4 v[168:171], v46, s[60:63], s15 offen offset:2048 sc1
v_mfma_f32_16x16x32_bf16 v[152:155], v[88:91], a[196:199], v[152:155]
ds_read_b64_tr_b16 v[82:83], v10 offset:56320
ds_read_b64_tr_b16 v[84:85], v11 offset:39936
v_mfma_f32_16x16x32_bf16 v[140:143], v[92:95], a[192:195], v[140:143]
buffer_load_dwordx4 v[172:175], v46, s[60:63], s15 offen offset:3072 sc1
v_mfma_f32_16x16x32_bf16 v[156:159], v[92:95], a[196:199], v[156:159]
ds_read_b64_tr_b16 v[86:87], v11 offset:56320
ds_read_b64_tr_b16 v[88:89], v12 offset:39936
v_mfma_f32_16x16x32_bf16 v[128:131], v[96:99], a[200:203], v[128:131]
ds_read_b64_tr_b16 v[90:91], v12 offset:56320
v_mfma_f32_16x16x32_bf16 v[144:147], v[96:99], a[204:207], v[144:147]
ds_read_b64_tr_b16 v[92:93], v13 offset:39936
ds_read_b64_tr_b16 v[94:95], v13 offset:56320
v_mfma_f32_16x16x32_bf16 v[132:135], v[100:103], a[200:203], v[132:135]
v_mfma_f32_16x16x32_bf16 v[148:151], v[100:103], a[204:207], v[148:151]
v_mfma_f32_16x16x32_bf16 v[136:139], v[104:107], a[200:203], v[136:139]
v_mfma_f32_16x16x32_bf16 v[152:155], v[104:107], a[204:207], v[152:155]
v_mfma_f32_16x16x32_bf16 v[140:143], v[108:111], a[200:203], v[140:143]
v_mfma_f32_16x16x32_bf16 v[156:159], v[108:111], a[204:207], v[156:159]
v_mfma_f32_16x16x32_bf16 v[128:131], v[112:115], a[208:211], v[128:131]
v_mfma_f32_16x16x32_bf16 v[144:147], v[112:115], a[212:215], v[144:147]
v_mfma_f32_16x16x32_bf16 v[132:135], v[116:119], a[208:211], v[132:135]
v_mfma_f32_16x16x32_bf16 v[148:151], v[116:119], a[212:215], v[148:151]
s_waitcnt lgkmcnt(0)
v_mfma_f32_16x16x32_bf16 v[136:139], v[120:123], a[208:211], v[136:139]
v_mfma_f32_16x16x32_bf16 v[152:155], v[120:123], a[212:215], v[152:155]
v_mfma_f32_16x16x32_bf16 v[140:143], v[124:127], a[208:211], v[140:143]
v_mfma_f32_16x16x32_bf16 v[156:159], v[124:127], a[212:215], v[156:159]
v_mfma_f32_16x16x32_bf16 v[128:131], v[80:83], a[216:219], v[128:131]
v_mfma_f32_16x16x32_bf16 v[144:147], v[80:83], a[220:223], v[144:147]
v_mfma_f32_16x16x32_bf16 v[132:135], v[84:87], a[216:219], v[132:135]
v_mfma_f32_16x16x32_bf16 v[148:151], v[84:87], a[220:223], v[148:151]
v_mfma_f32_16x16x32_bf16 v[136:139], v[88:91], a[216:219], v[136:139]
v_mfma_f32_16x16x32_bf16 v[152:155], v[88:91], a[220:223], v[152:155]
v_mfma_f32_16x16x32_bf16 v[140:143], v[92:95], a[216:219], v[140:143]
v_mfma_f32_16x16x32_bf16 v[156:159], v[92:95], a[220:223], v[156:159]
s_waitcnt vmcnt(4)
v_mfma_f32_16x16x16_bf16 v[128:131], v[76:77], a[224:225], v[128:131]
v_mfma_f32_16x16x16_bf16 v[132:135], v[76:77], a[226:227], v[132:135]
v_mfma_f32_16x16x16_bf16 v[128:131], v[76:77], a[240:241], v[128:131]
v_mfma_f32_16x16x16_bf16 v[132:135], v[76:77], a[242:243], v[132:135]
s_waitcnt vmcnt(3)
v_mfma_f32_16x16x16_bf16 v[128:131], v[76:77], v[160:161], v[128:131]
v_mfma_f32_16x16x16_bf16 v[132:135], v[76:77], v[162:163], v[132:135]
v_mfma_f32_16x16x16_bf16 v[136:139], v[76:77], a[228:229], v[136:139]
v_mfma_f32_16x16x16_bf16 v[140:143], v[76:77], a[230:231], v[140:143]
v_mfma_f32_16x16x16_bf16 v[136:139], v[76:77], a[244:245], v[136:139]
s_nop 3
v_fma_f32 v128, v128, v60, v192
v_fma_f32 v129, v129, v61, v193
v_fma_f32 v130, v130, v62, v194
v_mfma_f32_16x16x16_bf16 v[140:143], v[76:77], a[246:247], v[140:143]
v_fma_f32 v131, v131, v63, v195
v_fma_f32 v132, v132, v64, v196
v_fma_f32 v133, v133, v65, v197
s_waitcnt vmcnt(2)
v_mfma_f32_16x16x16_bf16 v[136:139], v[76:77], v[164:165], v[136:139]
v_fma_f32 v134, v134, v66, v198
v_fma_f32 v135, v135, v67, v199
v_cvt_pk_bf16_f32 v128, v128, v129
v_mfma_f32_16x16x16_bf16 v[140:143], v[76:77], v[166:167], v[140:143]
v_cvt_pk_bf16_f32 v129, v130, v131
v_cvt_pk_bf16_f32 v130, v132, v133
v_cvt_pk_bf16_f32 v131, v134, v135
v_mfma_f32_16x16x16_bf16 v[144:147], v[76:77], a[232:233], v[144:147]
ds_write_b64 v53, v[128:129] offset:0
ds_write_b64 v54, v[130:131] offset:0
v_fma_f32 v136, v136, v68, v200
v_mfma_f32_16x16x16_bf16 v[148:151], v[76:77], a[234:235], v[148:151]
v_fma_f32 v137, v137, v69, v201
v_fma_f32 v138, v138, v70, v202
v_fma_f32 v139, v139, v71, v203
v_mfma_f32_16x16x16_bf16 v[144:147], v[76:77], a[248:249], v[144:147]
v_fma_f32 v140, v140, v72, v204
v_fma_f32 v141, v141, v73, v205
v_fma_f32 v142, v142, v74, v206
v_mfma_f32_16x16x16_bf16 v[148:151], v[76:77], a[250:251], v[148:151]
v_fma_f32 v143, v143, v75, v207
v_cvt_pk_bf16_f32 v136, v136, v137
v_cvt_pk_bf16_f32 v137, v138, v139
s_waitcnt vmcnt(1)
v_mfma_f32_16x16x16_bf16 v[144:147], v[76:77], v[168:169], v[144:147]
v_cvt_pk_bf16_f32 v138, v140, v141
v_cvt_pk_bf16_f32 v139, v142, v143
ds_write_b64 v55, v[136:137] offset:0
v_mfma_f32_16x16x16_bf16 v[148:151], v[76:77], v[170:171], v[148:151]
ds_write_b64 v51, v[138:139] offset:0
v_mfma_f32_16x16x16_bf16 v[152:155], v[76:77], a[236:237], v[152:155]
s_nop 1
v_fma_f32 v144, v144, v60, v208
v_fma_f32 v145, v145, v61, v209
v_fma_f32 v146, v146, v62, v210
v_mfma_f32_16x16x16_bf16 v[156:159], v[76:77], a[238:239], v[156:159]
v_fma_f32 v147, v147, v63, v211
v_fma_f32 v148, v148, v64, v212
v_fma_f32 v149, v149, v65, v213
v_mfma_f32_16x16x16_bf16 v[152:155], v[76:77], a[252:253], v[152:155]
v_fma_f32 v150, v150, v66, v214
v_fma_f32 v151, v151, v67, v215
v_cvt_pk_bf16_f32 v144, v144, v145
v_mfma_f32_16x16x16_bf16 v[156:159], v[76:77], a[254:255], v[156:159]
v_cvt_pk_bf16_f32 v145, v146, v147
v_cvt_pk_bf16_f32 v146, v148, v149
v_cvt_pk_bf16_f32 v147, v150, v151
s_waitcnt vmcnt(0)
v_mfma_f32_16x16x16_bf16 v[152:155], v[76:77], v[172:173], v[152:155]
ds_write_b64 v53, v[144:145] offset:2048
ds_write_b64 v54, v[146:147] offset:2048
v_mfma_f32_16x16x16_bf16 v[156:159], v[76:77], v[174:175], v[156:159]
s_nop 4
v_fma_f32 v152, v152, v68, v216
v_fma_f32 v153, v153, v69, v217
v_fma_f32 v154, v154, v70, v218
v_fma_f32 v155, v155, v71, v219
v_fma_f32 v156, v156, v72, v220
v_fma_f32 v157, v157, v73, v221
v_fma_f32 v158, v158, v74, v222
v_fma_f32 v159, v159, v75, v223
v_cvt_pk_bf16_f32 v152, v152, v153
v_cvt_pk_bf16_f32 v153, v154, v155
v_cvt_pk_bf16_f32 v154, v156, v157
v_cvt_pk_bf16_f32 v155, v158, v159
ds_write_b64 v55, v[152:153] offset:2048
ds_write_b64 v51, v[154:155] offset:2048
s_waitcnt lgkmcnt(4)
ds_read_b128 v[80:83], v49 offset:0
ds_read_b128 v[84:87], v49 offset:1024
s_waitcnt lgkmcnt(2)
ds_read_b128 v[88:91], v49 offset:2048
ds_read_b128 v[92:95], v49 offset:3072
s_waitcnt lgkmcnt(3)
buffer_store_dwordx4 v[80:83], v2, s[64:67], s12 offen nt
s_waitcnt lgkmcnt(2)
buffer_store_dwordx4 v[84:87], v2, s[64:67], s16 offen nt
s_waitcnt lgkmcnt(1)
buffer_store_dwordx4 v[88:91], v2, s[64:67], s13 offen nt
s_waitcnt lgkmcnt(0)
buffer_store_dwordx4 v[92:95], v2, s[64:67], s17 offen nt
K_fin:
K_end:
s_endpgm
pl_1_slow:
s_mov_b32 s81, 0
pl_1_loop:
s_mov_b32 s87, 0
s_atomic_add s87, s[60:61], s98 glc
s_add_u32 s81, s81, 1
s_waitcnt lgkmcnt(0)
s_cmp_ge_u32 s87, s99
s_cbranch_scc1 pl_1_ok
s_cmp_lt_u32 s81, 0x400000
s_cbranch_scc1 pl_1_loop
s_branch pl_1_ok
pl_2_slow:
s_mov_b32 s81, 0
pl_2_loop:
s_mov_b32 s87, 0
s_atomic_add s87, s[60:61], s98 glc
s_add_u32 s81, s81, 1
s_waitcnt lgkmcnt(0)
s_cmp_ge_u32 s87, s99
s_cbranch_scc1 pl_2_ok
s_cmp_lt_u32 s81, 0x400000
s_cbranch_scc1 pl_2_loop
s_branch pl_2_ok
pl_3_slow:
s_mov_b32 s81, 0
pl_3_loop:
s_mov_b32 s87, 0
s_atomic_add s87, s[60:61], s90 glc
s_add_u32 s81, s81, 1
s_waitcnt lgkmcnt(0)
s_cmp_ge_u32 s87, 16
s_cbranch_scc1 pl_3_ok
s_cmp_lt_u32 s81, 0x400000
s_cbranch_scc1 pl_3_loop
s_branch pl_3_ok
pl_4_slow:
s_mov_b32 s81, 0
pl_4_loop:
s_mov_b32 s87, 0
s_atomic_add s87, s[60:61], s90 offset:4096 glc
s_add_u32 s81, s81, 1
s_waitcnt lgkmcnt(0)
s_cmp_ge_u32 s87, 16
s_cbranch_scc1 pl_4_ok
s_cmp_lt_u32 s81, 0x400000
s_cbranch_scc1 pl_4_loop
s_branch pl_4_ok
pl_5_slow:
s_mov_b32 s81, 0
pl_5_loop:
s_mov_b32 s87, 0
s_atomic_add s87, s[60:61], s24 offset:772 glc
s_add_u32 s81, s81, 1
s_waitcnt lgkmcnt(0)
s_cmp_ge_u32 s87, 4
s_cbranch_scc1 pl_5_ok
s_cmp_lt_u32 s81, 0x400000
s_cbranch_scc1 pl_5_loop
s_branch pl_5_ok
pl_6_slow:
s_mov_b32 s81, 0
pl_6_loop:
s_mov_b32 s87, 0
s_atomic_add s87, s[60:61], s24 offset:768 glc
s_add_u32 s81, s81, 1
s_waitcnt lgkmcnt(0)
s_cmp_ge_u32 s87, 4
s_cbranch_scc1 pl_6_ok
s_cmp_lt_u32 s81, 0x400000
s_cbranch_scc1 pl_6_loop
s_branch pl_6_ok
pl_7_slow:
s_mov_b32 s81, 0
pl_7_loop:
s_mov_b32 s87, 0
s_atomic_add s87, s[60:61], s24 offset:896 glc
s_add_u32 s81, s81, 1
s_waitcnt lgkmcnt(0)
s_cmp_ge_u32 s87, 4
s_cbranch_scc1 pl_7_ok
s_cmp_lt_u32 s81, 0x400000
s_cbranch_scc1 pl_7_loop
s_branch pl_7_ok
pl_8_slow:
s_mov_b32 s81, 0
pl_8_loop:
s_mov_b32 s87, 0
s_atomic_add s87, s[60:61], s23 offset:128 glc
s_add_u32 s81, s81, 1
s_waitcnt lgkmcnt(0)
s_cmp_ge_u32 s87, 2
s_cbranch_scc1 pl_8_ok
s_cmp_lt_u32 s81, 0x400000
s_cbranch_scc1 pl_8_loop
s_branch pl_8_ok
pl_9_slow:
s_mov_b32 s81, 0
pl_9_loop:
s_mov_b32 s87, 0
s_atomic_add s87, s[60:61], s23 offset:132 glc
s_add_u32 s81, s81, 1
s_waitcnt lgkmcnt(0)
s_cmp_ge_u32 s87, 1
s_cbranch_scc1 pl_9_ok
s_cmp_lt_u32 s81, 0x400000
s_cbranch_scc1 pl_9_loop
s_branch pl_9_ok
K_last:
.fill 4096, 4, 0xbf800000
.section .rodata,"a"
.p2align 6
.amdhsa_kernel adaLN_cond__sliding_local_dilated__glu_gated_swiglu__prompt_kernel
  .amdhsa_next_free_vgpr 512
  .amdhsa_next_free_sgpr 102
  .amdhsa_accum_offset 256
  .amdhsa_group_segment_fixed_size 0
  .amdhsa_kernarg_size 96
  .amdhsa_user_sgpr_count 2
  .amdhsa_user_sgpr_kernarg_segment_ptr 1
  .amdhsa_system_sgpr_workgroup_id_x 1
  .amdhsa_float_denorm_mode_32 3
.end_amdhsa_kernel
```
